```python
import torch

def _softmax(x, axis=-1):
    return torch.softmax(x, dim=axis)
def _gelu(x):
    return torch.nn.functional.gelu(x, approximate="tanh")
def _silu(x):
    return torch.nn.functional.silu(x)
def _sigmoid(x):
    return torch.sigmoid(x)
def _layernorm(x, axis=-1, eps=1e-5):
    m = x.mean(dim=axis, keepdim=True)
    v = x.var(dim=axis, keepdim=True, unbiased=False)
    return (x - m) / torch.sqrt(v + eps)
def _scatter_add(tgt, idx, src, axis=0):
    return tgt.clone().index_add_(axis, idx, src)
def _segment_sum(src, seg, n):
    out = torch.zeros((n,) + src.shape[1:], dtype=src.dtype)
    return out.index_add_(0, seg, src)
def _pad(x, pw):
    flat = tuple(v for pair in reversed(pw) for v in pair)
    return torch.nn.functional.pad(x, flat)

kernel_name = 'standalone__mha_softmax__near_ridge'

def setup_inputs():

    _w = (lambda a: (lambda t: t.to(torch.bfloat16) if t.is_floating_point() else t)(torch.as_tensor(a)))
    B, H, Sq, Sk, D = 16, 32, 288, 1024, 128
    return {
        "q": _w((lambda *s: torch.randn(*s, dtype=torch.bfloat16) * 0.8)(B, H, Sq, D)),
        "k": _w((lambda *s: torch.randn(*s, dtype=torch.bfloat16) * 0.8)(B, H, Sk, D)),
        "v": _w((lambda *s: torch.randn(*s, dtype=torch.bfloat16) * 0.05)(B, H, Sk, D)),
    }

def reference(q, k, v):
    scale = q.shape[-1] ** -0.5
    scores = torch.einsum("bhqd,bhkd->bhqk", q, k) * scale
    p = _softmax(scores, axis=-1)
    return torch.einsum("bhqk,bhkd->bhqd", p, v)
```

```asm
; @launch grid=(256,1,1) block=(256,1,1) lds=163840
.amdgcn_target "amdgcn-amd-amdhsa--gfx950"
.text
.globl standalone__mha_softmax__near_ridge_kernel
.p2align 12
.p2align 8
.type standalone__mha_softmax__near_ridge_kernel,@function
standalone__mha_softmax__near_ridge_kernel:
s_cmp_ge_u32 s2,256
s_cbranch_scc1 L_end
s_load_dwordx4 s[4:7],s[0:1],0
s_load_dwordx4 s[8:11],s[0:1],16
v_lshrrev_b32 v128,6,v0
v_and_b32 v129,63,v0
v_readfirstlane_b32 s3,v128
v_lshlrev_b32 v228,4,v129
s_mul_i32 s28,s2,147456
s_lshl_b32 s29,s2,19
s_lshl_b32 s64,s3,14
s_add_u32 s65,s64,4096
s_add_u32 s66,s64,8192
s_add_u32 s67,s64,12288
s_lshr_b32 s68,s3,1
s_lshl_b32 s68,s68,12
s_add_u32 s68,s68,65536
v_lshrrev_b32 v131,4,v129
v_lshlrev_b32 v132,6,v131
v_bfe_u32 v133,v129,2,2
v_lshl_add_u32 v132,v133,8,v132
v_lshlrev_b32 v135,12,v128
v_add_u32 v132,v135,v132
v_and_b32 v134,1,v128
v_and_b32 v133,3,v129
v_lshlrev_b32 v133,4,v133
v_lshlrev_b32 v227,5,v134
v_xor_b32 v133,v133,v227
v_add_u32 v227,v132,v133
s_lshl_b32 s30,s3,12
s_waitcnt lgkmcnt(0)
s_add_u32 s12,s4,s28
s_addc_u32 s13,s5,0
s_mov_b32 s14,147456
s_mov_b32 s15,0x20000
buffer_load_dwordx4 v[0:3],v228,s[12:15],s64 offen nt
buffer_load_dwordx4 v[4:7],v228,s[12:15],s64 offen offset:1024 nt
buffer_load_dwordx4 v[8:11],v228,s[12:15],s64 offen offset:2048 nt
buffer_load_dwordx4 v[12:15],v228,s[12:15],s64 offen offset:3072 nt
s_add_u32 s16,s6,s29
s_addc_u32 s17,s7,0
s_mov_b32 s18,524288
s_mov_b32 s19,0x20000
s_add_u32 s20,s8,s29
s_addc_u32 s21,s9,0
s_mov_b32 s22,524288
s_mov_b32 s23,0x20000
s_add_u32 s24,s10,s28
s_addc_u32 s25,s11,0
s_mov_b32 s26,147456
s_mov_b32 s27,0x20000
buffer_load_dwordx4 v[16:19],v228,s[12:15],s65 offen nt
buffer_load_dwordx4 v[20:23],v228,s[12:15],s65 offen offset:1024 nt
buffer_load_dwordx4 v[24:27],v228,s[12:15],s65 offen offset:2048 nt
buffer_load_dwordx4 v[28:31],v228,s[12:15],s65 offen offset:3072 nt
buffer_load_dwordx4 v[32:35],v228,s[12:15],s66 offen nt
buffer_load_dwordx4 v[36:39],v228,s[12:15],s66 offen offset:1024 nt
buffer_load_dwordx4 v[40:43],v228,s[12:15],s66 offen offset:2048 nt
buffer_load_dwordx4 v[44:47],v228,s[12:15],s66 offen offset:3072 nt
s_mov_b32 s72,s64
s_mov_b32 s73,s65
s_mov_b32 s74,s66
s_mov_b32 s75,s67
s_lshl_b32 s76,s3,11
s_add_u32 s76,s76,65536
s_and_b32 s37,s3,1
v_and_b32 v130,15,v129
v_lshrrev_b32 v133,2,v130
v_lshlrev_b32 v132,12,v133
v_and_b32 v133,1,v133
v_lshlrev_b32 v133,1,v133
v_xor_b32 v133,v133,v131
v_lshl_add_u32 v132,v133,4,v132
v_and_b32 v133,3,v130
v_lshl_add_u32 v132,v133,6,v132
v_lshl_add_u32 v224,v134,11,v132
v_lshlrev_b32 v132,12,v131
v_lshl_add_u32 v132,v133,3,v132
v_lshrrev_b32 v133,2,v130
v_lshl_add_u32 v132,v133,6,v132
v_and_b32 v133,1,v131
v_lshl_add_u32 v132,v133,5,v132
v_lshl_add_u32 v132,v134,11,v132
v_add_u32 v225,16384,v132
v_xor_b32 v226,32,v225
s_mov_b32 s80,0x3e0293ee
s_mov_b32 s81,0x3e0293ee
v_add_u32 v136,0x18000,v135
v_xor_b32 v132,v130,v131
v_lshl_add_u32 v132,v132,4,v136
v_lshl_add_u32 v229,v131,8,v132
v_xor_b32 v230,64,v229
v_and_b32 v133,7,v130
v_xor_b32 v132,v133,v131
v_lshlrev_b32 v132,4,v132
v_lshl_add_u32 v235,v133,9,v132
v_lshl_add_u32 v132,v130,8,v132
v_add_u32 v231,v132,v136
v_xor_b32 v232,64,v231
v_and_b32 v132,1,v131
v_lshlrev_b32 v132,1,v132
v_xor_b32 v132,v132,v133
v_lshrrev_b32 v133,1,v131
v_xor_b32 v132,v132,v133
v_lshl_add_u32 v132,v132,4,v136
v_lshl_add_u32 v233,v130,8,v132
v_xor_b32 v234,64,v233
v_and_b32 v132,1,v131
v_lshl_add_u32 v132,v132,1,v133
v_lshlrev_b32 v132,4,v132
v_lshl_add_u32 v165,v130,8,v132
v_lshrrev_b32 v133,3,v130
v_and_b32 v132,2,v128
v_or_b32 v132,v132,v133
v_lshlrev_b32 v132,12,v132
v_add_u32 v235,v235,v132
v_lshl_add_u32 v235,v134,14,v235
v_add_u32 v235,0x18000,v235
v_xor_b32 v159,64,v235
v_lshl_add_u32 v132,v134,6,v132
v_and_b32 v133,3,v130
v_lshl_add_u32 v132,v133,4,v132
v_bfe_u32 v133,v130,2,1
v_lshl_add_u32 v237,v133,3,v132
v_add_u32 v237,0x24000,v237
v_lshl_add_u32 v238,v131,4,v136
v_add_u32 v238,0xc000,v238
v_lshlrev_b32 v132,1,v130
v_xor_b32 v132,v132,v131
v_lshl_add_u32 v132,v132,4,v135
v_lshl_add_u32 v236,v131,9,v132
v_add_u32 v236,0x18000,v236
v_and_b32 v133,3,v129
v_mov_b32 v128,0x3f803f80
v_cmp_eq_u32 vcc,0,v133
s_nop 1
v_cndmask_b32 v132,0,v128,vcc
v_accvgpr_write_b32 a176,v132
v_accvgpr_write_b32 a177,v132
v_accvgpr_write_b32 a178,v132
v_accvgpr_write_b32 a179,v132
v_cmp_eq_u32 vcc,1,v133
s_nop 1
v_cndmask_b32 v132,0,v128,vcc
v_accvgpr_write_b32 a180,v132
v_accvgpr_write_b32 a181,v132
v_accvgpr_write_b32 a182,v132
v_accvgpr_write_b32 a183,v132
v_cmp_eq_u32 vcc,2,v133
s_nop 1
v_cndmask_b32 v132,0,v128,vcc
v_accvgpr_write_b32 a184,v132
v_accvgpr_write_b32 a185,v132
v_accvgpr_write_b32 a186,v132
v_accvgpr_write_b32 a187,v132
v_cmp_eq_u32 vcc,3,v133
s_nop 1
v_cndmask_b32 v132,0,v128,vcc
v_accvgpr_write_b32 a188,v132
v_accvgpr_write_b32 a189,v132
v_accvgpr_write_b32 a190,v132
v_accvgpr_write_b32 a191,v132
buffer_load_dwordx4 v[48:51],v228,s[12:15],s67 offen nt
buffer_load_dwordx4 v[52:55],v228,s[12:15],s67 offen offset:1024 nt
buffer_load_dwordx4 v[56:59],v228,s[12:15],s67 offen offset:2048 nt
buffer_load_dwordx4 v[60:63],v228,s[12:15],s67 offen offset:3072 nt
s_waitcnt vmcnt(14)
v_lshlrev_b32 v188,16,v0
v_and_b32 v189,0xffff0000,v0
v_lshlrev_b32 v190,16,v1
v_and_b32 v191,0xffff0000,v1
v_lshlrev_b32 v192,16,v2
v_and_b32 v193,0xffff0000,v2
v_lshlrev_b32 v194,16,v3
v_and_b32 v195,0xffff0000,v3
v_pk_mul_f32 v[188:189],v[188:189],s[80:81]
v_pk_mul_f32 v[190:191],v[190:191],s[80:81]
v_pk_mul_f32 v[192:193],v[192:193],s[80:81]
v_pk_mul_f32 v[194:195],v[194:195],s[80:81]
v_cvt_pk_bf16_f32 v0,v188,v189
v_cvt_pk_bf16_f32 v1,v190,v191
v_cvt_pk_bf16_f32 v2,v192,v193
v_cvt_pk_bf16_f32 v3,v194,v195
ds_write_b128 v229,v[0:3] offset:32768
buffer_load_dwordx4 v[240:243],v228,s[12:15],s68 offen nt
v_lshlrev_b32 v196,16,v4
v_and_b32 v197,0xffff0000,v4
v_lshlrev_b32 v198,16,v5
v_and_b32 v199,0xffff0000,v5
v_lshlrev_b32 v200,16,v6
v_and_b32 v201,0xffff0000,v6
v_lshlrev_b32 v202,16,v7
v_and_b32 v203,0xffff0000,v7
v_pk_mul_f32 v[196:197],v[196:197],s[80:81]
v_pk_mul_f32 v[198:199],v[198:199],s[80:81]
v_pk_mul_f32 v[200:201],v[200:201],s[80:81]
v_pk_mul_f32 v[202:203],v[202:203],s[80:81]
v_cvt_pk_bf16_f32 v4,v196,v197
v_cvt_pk_bf16_f32 v5,v198,v199
v_cvt_pk_bf16_f32 v6,v200,v201
v_cvt_pk_bf16_f32 v7,v202,v203
ds_write_b128 v230,v[4:7] offset:33792
buffer_load_dwordx4 v[244:247],v228,s[12:15],s68 offen offset:1024 nt
s_waitcnt vmcnt(14)
v_lshlrev_b32 v188,16,v8
v_and_b32 v189,0xffff0000,v8
v_lshlrev_b32 v190,16,v9
v_and_b32 v191,0xffff0000,v9
v_lshlrev_b32 v192,16,v10
v_and_b32 v193,0xffff0000,v10
v_lshlrev_b32 v194,16,v11
v_and_b32 v195,0xffff0000,v11
v_pk_mul_f32 v[188:189],v[188:189],s[80:81]
v_pk_mul_f32 v[190:191],v[190:191],s[80:81]
v_pk_mul_f32 v[192:193],v[192:193],s[80:81]
v_pk_mul_f32 v[194:195],v[194:195],s[80:81]
v_cvt_pk_bf16_f32 v8,v188,v189
v_cvt_pk_bf16_f32 v9,v190,v191
v_cvt_pk_bf16_f32 v10,v192,v193
v_cvt_pk_bf16_f32 v11,v194,v195
ds_write_b128 v229,v[8:11] offset:34816
buffer_load_dwordx4 v[248:251],v228,s[12:15],s68 offen offset:2048 nt
v_lshlrev_b32 v196,16,v12
v_and_b32 v197,0xffff0000,v12
v_lshlrev_b32 v198,16,v13
v_and_b32 v199,0xffff0000,v13
v_lshlrev_b32 v200,16,v14
v_and_b32 v201,0xffff0000,v14
v_lshlrev_b32 v202,16,v15
v_and_b32 v203,0xffff0000,v15
v_pk_mul_f32 v[196:197],v[196:197],s[80:81]
v_pk_mul_f32 v[198:199],v[198:199],s[80:81]
v_pk_mul_f32 v[200:201],v[200:201],s[80:81]
v_pk_mul_f32 v[202:203],v[202:203],s[80:81]
v_cvt_pk_bf16_f32 v12,v196,v197
v_cvt_pk_bf16_f32 v13,v198,v199
v_cvt_pk_bf16_f32 v14,v200,v201
v_cvt_pk_bf16_f32 v15,v202,v203
ds_write_b128 v230,v[12:15] offset:35840
buffer_load_dwordx4 v[252:255],v228,s[12:15],s68 offen offset:3072 nt
ds_read_b128 v[64:67],v231 offset:32768
ds_read_b128 v[68:71],v232 offset:32768
ds_read_b128 v[72:75],v231 offset:32896
ds_read_b128 v[76:79],v232 offset:32896
s_waitcnt vmcnt(14)
v_lshlrev_b32 v188,16,v16
v_and_b32 v189,0xffff0000,v16
v_lshlrev_b32 v190,16,v17
v_and_b32 v191,0xffff0000,v17
v_lshlrev_b32 v192,16,v18
v_and_b32 v193,0xffff0000,v18
v_lshlrev_b32 v194,16,v19
v_and_b32 v195,0xffff0000,v19
v_pk_mul_f32 v[188:189],v[188:189],s[80:81]
v_pk_mul_f32 v[190:191],v[190:191],s[80:81]
v_pk_mul_f32 v[192:193],v[192:193],s[80:81]
v_pk_mul_f32 v[194:195],v[194:195],s[80:81]
v_cvt_pk_bf16_f32 v16,v188,v189
v_cvt_pk_bf16_f32 v17,v190,v191
v_cvt_pk_bf16_f32 v18,v192,v193
v_cvt_pk_bf16_f32 v19,v194,v195
ds_write_b128 v229,v[16:19] offset:32768
s_add_u32 m0,s30,0
s_mov_b32 s34,0
buffer_load_dwordx4 v227,s[16:19],s34 offen nt lds
v_lshlrev_b32 v196,16,v20
v_and_b32 v197,0xffff0000,v20
v_lshlrev_b32 v198,16,v21
v_and_b32 v199,0xffff0000,v21
v_lshlrev_b32 v200,16,v22
v_and_b32 v201,0xffff0000,v22
v_lshlrev_b32 v202,16,v23
v_and_b32 v203,0xffff0000,v23
v_pk_mul_f32 v[196:197],v[196:197],s[80:81]
v_pk_mul_f32 v[198:199],v[198:199],s[80:81]
v_pk_mul_f32 v[200:201],v[200:201],s[80:81]
v_pk_mul_f32 v[202:203],v[202:203],s[80:81]
v_cvt_pk_bf16_f32 v20,v196,v197
v_cvt_pk_bf16_f32 v21,v198,v199
v_cvt_pk_bf16_f32 v22,v200,v201
v_cvt_pk_bf16_f32 v23,v202,v203
ds_write_b128 v230,v[20:23] offset:33792
buffer_load_dwordx4 v227,s[16:19],s34 offen offset:1024 nt lds
s_waitcnt vmcnt(14)
v_lshlrev_b32 v188,16,v24
v_and_b32 v189,0xffff0000,v24
v_lshlrev_b32 v190,16,v25
v_and_b32 v191,0xffff0000,v25
v_lshlrev_b32 v192,16,v26
v_and_b32 v193,0xffff0000,v26
v_lshlrev_b32 v194,16,v27
v_and_b32 v195,0xffff0000,v27
v_pk_mul_f32 v[188:189],v[188:189],s[80:81]
v_pk_mul_f32 v[190:191],v[190:191],s[80:81]
v_pk_mul_f32 v[192:193],v[192:193],s[80:81]
v_pk_mul_f32 v[194:195],v[194:195],s[80:81]
v_cvt_pk_bf16_f32 v24,v188,v189
v_cvt_pk_bf16_f32 v25,v190,v191
v_cvt_pk_bf16_f32 v26,v192,v193
v_cvt_pk_bf16_f32 v27,v194,v195
ds_write_b128 v229,v[24:27] offset:34816
buffer_load_dwordx4 v227,s[16:19],s34 offen offset:2048 nt lds
v_lshlrev_b32 v196,16,v28
v_and_b32 v197,0xffff0000,v28
v_lshlrev_b32 v198,16,v29
v_and_b32 v199,0xffff0000,v29
v_lshlrev_b32 v200,16,v30
v_and_b32 v201,0xffff0000,v30
v_lshlrev_b32 v202,16,v31
v_and_b32 v203,0xffff0000,v31
v_pk_mul_f32 v[196:197],v[196:197],s[80:81]
v_pk_mul_f32 v[198:199],v[198:199],s[80:81]
v_pk_mul_f32 v[200:201],v[200:201],s[80:81]
v_pk_mul_f32 v[202:203],v[202:203],s[80:81]
v_cvt_pk_bf16_f32 v28,v196,v197
v_cvt_pk_bf16_f32 v29,v198,v199
v_cvt_pk_bf16_f32 v30,v200,v201
v_cvt_pk_bf16_f32 v31,v202,v203
ds_write_b128 v230,v[28:31] offset:35840
buffer_load_dwordx4 v227,s[16:19],s34 offen offset:3072 nt lds
ds_read_b128 v[80:83],v231 offset:32768
ds_read_b128 v[84:87],v232 offset:32768
ds_read_b128 v[88:91],v231 offset:32896
ds_read_b128 v[92:95],v232 offset:32896
s_waitcnt vmcnt(14)
v_lshlrev_b32 v188,16,v32
v_and_b32 v189,0xffff0000,v32
v_lshlrev_b32 v190,16,v33
v_and_b32 v191,0xffff0000,v33
v_lshlrev_b32 v192,16,v34
v_and_b32 v193,0xffff0000,v34
v_lshlrev_b32 v194,16,v35
v_and_b32 v195,0xffff0000,v35
v_pk_mul_f32 v[188:189],v[188:189],s[80:81]
v_pk_mul_f32 v[190:191],v[190:191],s[80:81]
v_pk_mul_f32 v[192:193],v[192:193],s[80:81]
v_pk_mul_f32 v[194:195],v[194:195],s[80:81]
v_cvt_pk_bf16_f32 v32,v188,v189
v_cvt_pk_bf16_f32 v33,v190,v191
v_cvt_pk_bf16_f32 v34,v192,v193
v_cvt_pk_bf16_f32 v35,v194,v195
ds_write_b128 v229,v[32:35] offset:32768
s_add_u32 m0,s30,16384
s_mov_b32 s34,0
buffer_load_dwordx4 v227,s[20:23],s34 offen nt lds
v_lshlrev_b32 v196,16,v36
v_and_b32 v197,0xffff0000,v36
v_lshlrev_b32 v198,16,v37
v_and_b32 v199,0xffff0000,v37
v_lshlrev_b32 v200,16,v38
v_and_b32 v201,0xffff0000,v38
v_lshlrev_b32 v202,16,v39
v_and_b32 v203,0xffff0000,v39
v_pk_mul_f32 v[196:197],v[196:197],s[80:81]
v_pk_mul_f32 v[198:199],v[198:199],s[80:81]
v_pk_mul_f32 v[200:201],v[200:201],s[80:81]
v_pk_mul_f32 v[202:203],v[202:203],s[80:81]
v_cvt_pk_bf16_f32 v36,v196,v197
v_cvt_pk_bf16_f32 v37,v198,v199
v_cvt_pk_bf16_f32 v38,v200,v201
v_cvt_pk_bf16_f32 v39,v202,v203
ds_write_b128 v230,v[36:39] offset:33792
buffer_load_dwordx4 v227,s[20:23],s34 offen offset:1024 nt lds
s_waitcnt vmcnt(14)
v_lshlrev_b32 v188,16,v40
v_and_b32 v189,0xffff0000,v40
v_lshlrev_b32 v190,16,v41
v_and_b32 v191,0xffff0000,v41
v_lshlrev_b32 v192,16,v42
v_and_b32 v193,0xffff0000,v42
v_lshlrev_b32 v194,16,v43
v_and_b32 v195,0xffff0000,v43
v_pk_mul_f32 v[188:189],v[188:189],s[80:81]
v_pk_mul_f32 v[190:191],v[190:191],s[80:81]
v_pk_mul_f32 v[192:193],v[192:193],s[80:81]
v_pk_mul_f32 v[194:195],v[194:195],s[80:81]
v_cvt_pk_bf16_f32 v40,v188,v189
v_cvt_pk_bf16_f32 v41,v190,v191
v_cvt_pk_bf16_f32 v42,v192,v193
v_cvt_pk_bf16_f32 v43,v194,v195
ds_write_b128 v229,v[40:43] offset:34816
buffer_load_dwordx4 v227,s[20:23],s34 offen offset:2048 nt lds
v_lshlrev_b32 v196,16,v44
v_and_b32 v197,0xffff0000,v44
v_lshlrev_b32 v198,16,v45
v_and_b32 v199,0xffff0000,v45
v_lshlrev_b32 v200,16,v46
v_and_b32 v201,0xffff0000,v46
v_lshlrev_b32 v202,16,v47
v_and_b32 v203,0xffff0000,v47
v_pk_mul_f32 v[196:197],v[196:197],s[80:81]
v_pk_mul_f32 v[198:199],v[198:199],s[80:81]
v_pk_mul_f32 v[200:201],v[200:201],s[80:81]
v_pk_mul_f32 v[202:203],v[202:203],s[80:81]
v_cvt_pk_bf16_f32 v44,v196,v197
v_cvt_pk_bf16_f32 v45,v198,v199
v_cvt_pk_bf16_f32 v46,v200,v201
v_cvt_pk_bf16_f32 v47,v202,v203
ds_write_b128 v230,v[44:47] offset:35840
buffer_load_dwordx4 v227,s[20:23],s34 offen offset:3072 nt lds
ds_read_b128 v[96:99],v231 offset:32768
ds_read_b128 v[100:103],v232 offset:32768
ds_read_b128 v[104:107],v231 offset:32896
ds_read_b128 v[108:111],v232 offset:32896
s_waitcnt vmcnt(14)
v_lshlrev_b32 v188,16,v48
v_and_b32 v189,0xffff0000,v48
v_lshlrev_b32 v190,16,v49
v_and_b32 v191,0xffff0000,v49
v_lshlrev_b32 v192,16,v50
v_and_b32 v193,0xffff0000,v50
v_lshlrev_b32 v194,16,v51
v_and_b32 v195,0xffff0000,v51
v_pk_mul_f32 v[188:189],v[188:189],s[80:81]
v_pk_mul_f32 v[190:191],v[190:191],s[80:81]
v_pk_mul_f32 v[192:193],v[192:193],s[80:81]
v_pk_mul_f32 v[194:195],v[194:195],s[80:81]
v_cvt_pk_bf16_f32 v48,v188,v189
v_cvt_pk_bf16_f32 v49,v190,v191
v_cvt_pk_bf16_f32 v50,v192,v193
v_cvt_pk_bf16_f32 v51,v194,v195
ds_write_b128 v229,v[48:51] offset:32768
v_lshlrev_b32 v196,16,v52
v_and_b32 v197,0xffff0000,v52
v_lshlrev_b32 v198,16,v53
v_and_b32 v199,0xffff0000,v53
v_lshlrev_b32 v200,16,v54
v_and_b32 v201,0xffff0000,v54
v_lshlrev_b32 v202,16,v55
v_and_b32 v203,0xffff0000,v55
v_pk_mul_f32 v[196:197],v[196:197],s[80:81]
v_pk_mul_f32 v[198:199],v[198:199],s[80:81]
v_pk_mul_f32 v[200:201],v[200:201],s[80:81]
v_pk_mul_f32 v[202:203],v[202:203],s[80:81]
v_cvt_pk_bf16_f32 v52,v196,v197
v_cvt_pk_bf16_f32 v53,v198,v199
v_cvt_pk_bf16_f32 v54,v200,v201
v_cvt_pk_bf16_f32 v55,v202,v203
ds_write_b128 v230,v[52:55] offset:33792
s_waitcnt vmcnt(12)
v_lshlrev_b32 v188,16,v56
v_and_b32 v189,0xffff0000,v56
v_lshlrev_b32 v190,16,v57
v_and_b32 v191,0xffff0000,v57
v_lshlrev_b32 v192,16,v58
v_and_b32 v193,0xffff0000,v58
v_lshlrev_b32 v194,16,v59
v_and_b32 v195,0xffff0000,v59
v_pk_mul_f32 v[188:189],v[188:189],s[80:81]
v_pk_mul_f32 v[190:191],v[190:191],s[80:81]
v_pk_mul_f32 v[192:193],v[192:193],s[80:81]
v_pk_mul_f32 v[194:195],v[194:195],s[80:81]
v_cvt_pk_bf16_f32 v56,v188,v189
v_cvt_pk_bf16_f32 v57,v190,v191
v_cvt_pk_bf16_f32 v58,v192,v193
v_cvt_pk_bf16_f32 v59,v194,v195
ds_write_b128 v229,v[56:59] offset:34816
v_lshlrev_b32 v196,16,v60
v_and_b32 v197,0xffff0000,v60
v_lshlrev_b32 v198,16,v61
v_and_b32 v199,0xffff0000,v61
v_lshlrev_b32 v200,16,v62
v_and_b32 v201,0xffff0000,v62
v_lshlrev_b32 v202,16,v63
v_and_b32 v203,0xffff0000,v63
v_pk_mul_f32 v[196:197],v[196:197],s[80:81]
v_pk_mul_f32 v[198:199],v[198:199],s[80:81]
v_pk_mul_f32 v[200:201],v[200:201],s[80:81]
v_pk_mul_f32 v[202:203],v[202:203],s[80:81]
v_cvt_pk_bf16_f32 v60,v196,v197
v_cvt_pk_bf16_f32 v61,v198,v199
v_cvt_pk_bf16_f32 v62,v200,v201
v_cvt_pk_bf16_f32 v63,v202,v203
ds_write_b128 v230,v[60:63] offset:35840
ds_read_b128 v[112:115],v231 offset:32768
ds_read_b128 v[116:119],v232 offset:32768
ds_read_b128 v[120:123],v231 offset:32896
ds_read_b128 v[124:127],v232 offset:32896
s_waitcnt vmcnt(10)
v_lshlrev_b32 v188,16,v240
v_and_b32 v189,0xffff0000,v240
v_lshlrev_b32 v190,16,v241
v_and_b32 v191,0xffff0000,v241
v_lshlrev_b32 v192,16,v242
v_and_b32 v193,0xffff0000,v242
v_lshlrev_b32 v194,16,v243
v_and_b32 v195,0xffff0000,v243
v_pk_mul_f32 v[188:189],v[188:189],s[80:81]
v_pk_mul_f32 v[190:191],v[190:191],s[80:81]
v_pk_mul_f32 v[192:193],v[192:193],s[80:81]
v_pk_mul_f32 v[194:195],v[194:195],s[80:81]
v_cvt_pk_bf16_f32 v240,v188,v189
v_cvt_pk_bf16_f32 v241,v190,v191
v_cvt_pk_bf16_f32 v242,v192,v193
v_cvt_pk_bf16_f32 v243,v194,v195
ds_write_b128 v229,v[240:243] offset:32768
v_lshlrev_b32 v196,16,v244
v_and_b32 v197,0xffff0000,v244
v_lshlrev_b32 v198,16,v245
v_and_b32 v199,0xffff0000,v245
v_lshlrev_b32 v200,16,v246
v_and_b32 v201,0xffff0000,v246
v_lshlrev_b32 v202,16,v247
v_and_b32 v203,0xffff0000,v247
v_pk_mul_f32 v[196:197],v[196:197],s[80:81]
v_pk_mul_f32 v[198:199],v[198:199],s[80:81]
v_pk_mul_f32 v[200:201],v[200:201],s[80:81]
v_pk_mul_f32 v[202:203],v[202:203],s[80:81]
v_cvt_pk_bf16_f32 v244,v196,v197
v_cvt_pk_bf16_f32 v245,v198,v199
v_cvt_pk_bf16_f32 v246,v200,v201
v_cvt_pk_bf16_f32 v247,v202,v203
ds_write_b128 v230,v[244:247] offset:33792
s_waitcnt vmcnt(8)
v_lshlrev_b32 v188,16,v248
v_and_b32 v189,0xffff0000,v248
v_lshlrev_b32 v190,16,v249
v_and_b32 v191,0xffff0000,v249
v_lshlrev_b32 v192,16,v250
v_and_b32 v193,0xffff0000,v250
v_lshlrev_b32 v194,16,v251
v_and_b32 v195,0xffff0000,v251
v_pk_mul_f32 v[188:189],v[188:189],s[80:81]
v_pk_mul_f32 v[190:191],v[190:191],s[80:81]
v_pk_mul_f32 v[192:193],v[192:193],s[80:81]
v_pk_mul_f32 v[194:195],v[194:195],s[80:81]
v_cvt_pk_bf16_f32 v248,v188,v189
v_cvt_pk_bf16_f32 v249,v190,v191
v_cvt_pk_bf16_f32 v250,v192,v193
v_cvt_pk_bf16_f32 v251,v194,v195
ds_write_b128 v229,v[248:251] offset:34816
v_lshlrev_b32 v196,16,v252
v_and_b32 v197,0xffff0000,v252
v_lshlrev_b32 v198,16,v253
v_and_b32 v199,0xffff0000,v253
v_lshlrev_b32 v200,16,v254
v_and_b32 v201,0xffff0000,v254
v_lshlrev_b32 v202,16,v255
v_and_b32 v203,0xffff0000,v255
v_pk_mul_f32 v[196:197],v[196:197],s[80:81]
v_pk_mul_f32 v[198:199],v[198:199],s[80:81]
v_pk_mul_f32 v[200:201],v[200:201],s[80:81]
v_pk_mul_f32 v[202:203],v[202:203],s[80:81]
v_cvt_pk_bf16_f32 v252,v196,v197
v_cvt_pk_bf16_f32 v253,v198,v199
v_cvt_pk_bf16_f32 v254,v200,v201
v_cvt_pk_bf16_f32 v255,v202,v203
ds_write_b128 v230,v[252:255] offset:35840
ds_read_b128 a[96:99],v231 offset:32768
ds_read_b128 a[100:103],v232 offset:32768
ds_read_b128 a[104:107],v231 offset:32896
ds_read_b128 a[108:111],v232 offset:32896
s_add_u32 s64,s64,73728
s_add_u32 s65,s65,73728
s_add_u32 s66,s66,73728
s_add_u32 s67,s67,73728
s_add_u32 s68,s68,73728
s_lshr_b32 s39,s2,3
s_lshl_b32 s39,s39,2
s_add_u32 s39,s39,s3
s_mov_b64 exec,0
T0_0:
s_bitcmp1_b32 s39,6
s_cbranch_scc1 T1_1
s_branch T1_0
T1_0:
s_bitcmp1_b32 s39,5
s_cbranch_scc1 T2_1
s_branch T2_0
T1_1:
s_bitcmp1_b32 s39,5
s_cbranch_scc1 T2_3
s_branch T2_2
T2_0:
s_bitcmp1_b32 s39,4
s_cbranch_scc1 T3_1
s_branch T3_0
T2_1:
s_bitcmp1_b32 s39,4
s_cbranch_scc1 T3_3
s_branch T3_2
T2_2:
s_bitcmp1_b32 s39,4
s_cbranch_scc1 T3_5
s_branch T3_4
T2_3:
s_bitcmp1_b32 s39,4
s_cbranch_scc1 T3_7
s_branch T3_6
T3_0:
s_bitcmp1_b32 s39,3
s_cbranch_scc1 T4_1
s_branch T4_0
T3_1:
s_bitcmp1_b32 s39,3
s_cbranch_scc1 T4_3
s_branch T4_2
T3_2:
s_bitcmp1_b32 s39,3
s_cbranch_scc1 T4_5
s_branch T4_4
T3_3:
s_bitcmp1_b32 s39,3
s_cbranch_scc1 T4_7
s_branch T4_6
T3_4:
s_bitcmp1_b32 s39,3
s_cbranch_scc1 T4_9
s_branch T4_8
T3_5:
s_bitcmp1_b32 s39,3
s_cbranch_scc1 T4_11
s_branch T4_10
T3_6:
s_bitcmp1_b32 s39,3
s_cbranch_scc1 T4_13
s_branch T4_12
T3_7:
s_bitcmp1_b32 s39,3
s_cbranch_scc1 T4_15
s_branch T4_14
T4_0:
s_bitcmp1_b32 s39,2
s_cbranch_scc1 T5_1
s_bitcmp1_b32 s39,1
s_cbranch_scc1 T6_1
s_bitcmp1_b32 s39,0
s_cbranch_scc1 P1
s_branch P0
T6_1:
s_bitcmp1_b32 s39,0
s_cbranch_scc1 P3
s_branch P2
T5_1:
s_bitcmp1_b32 s39,1
s_cbranch_scc1 T6_3
s_bitcmp1_b32 s39,0
s_cbranch_scc1 P5
s_branch P4
T6_3:
s_bitcmp1_b32 s39,0
s_cbranch_scc1 P7
s_branch P6
T4_1:
s_bitcmp1_b32 s39,2
s_cbranch_scc1 T5_3
s_bitcmp1_b32 s39,1
s_cbranch_scc1 T6_5
s_bitcmp1_b32 s39,0
s_cbranch_scc1 P9
s_branch P8
T6_5:
s_bitcmp1_b32 s39,0
s_cbranch_scc1 P11
s_branch P10
T5_3:
s_bitcmp1_b32 s39,1
s_cbranch_scc1 T6_7
s_bitcmp1_b32 s39,0
s_cbranch_scc1 P13
s_branch P12
T6_7:
s_bitcmp1_b32 s39,0
s_cbranch_scc1 P15
s_branch P14
T4_2:
s_bitcmp1_b32 s39,2
s_cbranch_scc1 T5_5
s_bitcmp1_b32 s39,1
s_cbranch_scc1 T6_9
s_bitcmp1_b32 s39,0
s_cbranch_scc1 P17
s_branch P16
T6_9:
s_bitcmp1_b32 s39,0
s_cbranch_scc1 P19
s_branch P18
T5_5:
s_bitcmp1_b32 s39,1
s_cbranch_scc1 T6_11
s_bitcmp1_b32 s39,0
s_cbranch_scc1 P21
s_branch P20
T6_11:
s_bitcmp1_b32 s39,0
s_cbranch_scc1 P23
s_branch P22
T4_3:
s_bitcmp1_b32 s39,2
s_cbranch_scc1 T5_7
s_bitcmp1_b32 s39,1
s_cbranch_scc1 T6_13
s_bitcmp1_b32 s39,0
s_cbranch_scc1 P25
s_branch P24
T6_13:
s_bitcmp1_b32 s39,0
s_cbranch_scc1 P27
s_branch P26
T5_7:
s_bitcmp1_b32 s39,1
s_cbranch_scc1 T6_15
s_bitcmp1_b32 s39,0
s_cbranch_scc1 P29
s_branch P28
T6_15:
s_bitcmp1_b32 s39,0
s_cbranch_scc1 P31
s_branch P30
T4_4:
s_bitcmp1_b32 s39,2
s_cbranch_scc1 T5_9
s_bitcmp1_b32 s39,1
s_cbranch_scc1 T6_17
s_bitcmp1_b32 s39,0
s_cbranch_scc1 P33
s_branch P32
T6_17:
s_bitcmp1_b32 s39,0
s_cbranch_scc1 P35
s_branch P34
T5_9:
s_bitcmp1_b32 s39,1
s_cbranch_scc1 T6_19
s_bitcmp1_b32 s39,0
s_cbranch_scc1 P37
s_branch P36
T6_19:
s_bitcmp1_b32 s39,0
s_cbranch_scc1 P39
s_branch P38
T4_5:
s_bitcmp1_b32 s39,2
s_cbranch_scc1 T5_11
s_bitcmp1_b32 s39,1
s_cbranch_scc1 T6_21
s_bitcmp1_b32 s39,0
s_cbranch_scc1 P41
s_branch P40
T6_21:
s_bitcmp1_b32 s39,0
s_cbranch_scc1 P43
s_branch P42
T5_11:
s_bitcmp1_b32 s39,1
s_cbranch_scc1 T6_23
s_bitcmp1_b32 s39,0
s_cbranch_scc1 P45
s_branch P44
T6_23:
s_bitcmp1_b32 s39,0
s_cbranch_scc1 P47
s_branch P46
T4_6:
s_bitcmp1_b32 s39,2
s_cbranch_scc1 T5_13
s_bitcmp1_b32 s39,1
s_cbranch_scc1 T6_25
s_bitcmp1_b32 s39,0
s_cbranch_scc1 P49
s_branch P48
T6_25:
s_bitcmp1_b32 s39,0
s_cbranch_scc1 P51
s_branch P50
T5_13:
s_bitcmp1_b32 s39,1
s_cbranch_scc1 T6_27
s_bitcmp1_b32 s39,0
s_cbranch_scc1 P53
s_branch P52
T6_27:
s_bitcmp1_b32 s39,0
s_cbranch_scc1 P55
s_branch P54
T4_7:
s_bitcmp1_b32 s39,2
s_cbranch_scc1 T5_15
s_bitcmp1_b32 s39,1
s_cbranch_scc1 T6_29
s_bitcmp1_b32 s39,0
s_cbranch_scc1 P57
s_branch P56
T6_29:
s_bitcmp1_b32 s39,0
s_cbranch_scc1 P59
s_branch P58
T5_15:
s_bitcmp1_b32 s39,1
s_cbranch_scc1 T6_31
s_bitcmp1_b32 s39,0
s_cbranch_scc1 P61
s_branch P60
T6_31:
s_bitcmp1_b32 s39,0
s_cbranch_scc1 P63
s_branch P62
T4_8:
s_bitcmp1_b32 s39,2
s_cbranch_scc1 T5_17
s_bitcmp1_b32 s39,1
s_cbranch_scc1 T6_33
s_bitcmp1_b32 s39,0
s_cbranch_scc1 P65
s_branch P64
T6_33:
s_bitcmp1_b32 s39,0
s_cbranch_scc1 P67
s_branch P66
T5_17:
s_bitcmp1_b32 s39,1
s_cbranch_scc1 T6_35
s_bitcmp1_b32 s39,0
s_cbranch_scc1 P69
s_branch P68
T6_35:
s_bitcmp1_b32 s39,0
s_cbranch_scc1 P71
s_branch P70
T4_9:
s_bitcmp1_b32 s39,2
s_cbranch_scc1 T5_19
s_bitcmp1_b32 s39,1
s_cbranch_scc1 T6_37
s_bitcmp1_b32 s39,0
s_cbranch_scc1 P73
s_branch P72
T6_37:
s_bitcmp1_b32 s39,0
s_cbranch_scc1 P75
s_branch P74
T5_19:
s_bitcmp1_b32 s39,1
s_cbranch_scc1 T6_39
s_bitcmp1_b32 s39,0
s_cbranch_scc1 P77
s_branch P76
T6_39:
s_bitcmp1_b32 s39,0
s_cbranch_scc1 P79
s_branch P78
T4_10:
s_bitcmp1_b32 s39,2
s_cbranch_scc1 T5_21
s_bitcmp1_b32 s39,1
s_cbranch_scc1 T6_41
s_bitcmp1_b32 s39,0
s_cbranch_scc1 P81
s_branch P80
T6_41:
s_bitcmp1_b32 s39,0
s_cbranch_scc1 P83
s_branch P82
T5_21:
s_bitcmp1_b32 s39,1
s_cbranch_scc1 T6_43
s_bitcmp1_b32 s39,0
s_cbranch_scc1 P85
s_branch P84
T6_43:
s_bitcmp1_b32 s39,0
s_cbranch_scc1 P87
s_branch P86
T4_11:
s_bitcmp1_b32 s39,2
s_cbranch_scc1 T5_23
s_bitcmp1_b32 s39,1
s_cbranch_scc1 T6_45
s_bitcmp1_b32 s39,0
s_cbranch_scc1 P89
s_branch P88
T6_45:
s_bitcmp1_b32 s39,0
s_cbranch_scc1 P91
s_branch P90
T5_23:
s_bitcmp1_b32 s39,1
s_cbranch_scc1 T6_47
s_bitcmp1_b32 s39,0
s_cbranch_scc1 P93
s_branch P92
T6_47:
s_bitcmp1_b32 s39,0
s_cbranch_scc1 P95
s_branch P94
T4_12:
s_bitcmp1_b32 s39,2
s_cbranch_scc1 T5_25
s_bitcmp1_b32 s39,1
s_cbranch_scc1 T6_49
s_bitcmp1_b32 s39,0
s_cbranch_scc1 P97
s_branch P96
T6_49:
s_bitcmp1_b32 s39,0
s_cbranch_scc1 P99
s_branch P98
T5_25:
s_bitcmp1_b32 s39,1
s_cbranch_scc1 T6_51
s_bitcmp1_b32 s39,0
s_cbranch_scc1 P101
s_branch P100
T6_51:
s_bitcmp1_b32 s39,0
s_cbranch_scc1 P103
s_branch P102
T4_13:
s_bitcmp1_b32 s39,2
s_cbranch_scc1 T5_27
s_bitcmp1_b32 s39,1
s_cbranch_scc1 T6_53
s_bitcmp1_b32 s39,0
s_cbranch_scc1 P105
s_branch P104
T6_53:
s_bitcmp1_b32 s39,0
s_cbranch_scc1 P107
s_branch P106
T5_27:
s_bitcmp1_b32 s39,1
s_cbranch_scc1 T6_55
s_bitcmp1_b32 s39,0
s_cbranch_scc1 P109
s_branch P108
T6_55:
s_bitcmp1_b32 s39,0
s_cbranch_scc1 P111
s_branch P110
T4_14:
s_bitcmp1_b32 s39,2
s_cbranch_scc1 T5_29
s_bitcmp1_b32 s39,1
s_cbranch_scc1 T6_57
s_bitcmp1_b32 s39,0
s_cbranch_scc1 P113
s_branch P112
T6_57:
s_bitcmp1_b32 s39,0
s_cbranch_scc1 P115
s_branch P114
T5_29:
s_bitcmp1_b32 s39,1
s_cbranch_scc1 T6_59
s_bitcmp1_b32 s39,0
s_cbranch_scc1 P117
s_branch P116
T6_59:
s_bitcmp1_b32 s39,0
s_cbranch_scc1 P119
s_branch P118
T4_15:
s_bitcmp1_b32 s39,2
s_cbranch_scc1 T5_31
s_bitcmp1_b32 s39,1
s_cbranch_scc1 T6_61
s_bitcmp1_b32 s39,0
s_cbranch_scc1 P121
s_branch P120
T6_61:
s_bitcmp1_b32 s39,0
s_cbranch_scc1 P123
s_branch P122
T5_31:
s_bitcmp1_b32 s39,1
s_cbranch_scc1 T6_63
s_bitcmp1_b32 s39,0
s_cbranch_scc1 P125
s_branch P124
T6_63:
s_bitcmp1_b32 s39,0
s_cbranch_scc1 P127
s_branch P126
L_back:
s_mov_b64 exec,-1
s_add_u32 m0,s30,32768
s_mov_b32 s34,16384
buffer_load_dwordx4 v227,s[16:19],s34 offen nt lds
buffer_load_dwordx4 v227,s[16:19],s34 offen offset:1024 nt lds
buffer_load_dwordx4 v227,s[16:19],s34 offen offset:2048 nt lds
buffer_load_dwordx4 v227,s[16:19],s34 offen offset:3072 nt lds
s_add_u32 m0,s30,49152
s_mov_b32 s34,16384
buffer_load_dwordx4 v227,s[20:23],s34 offen nt lds
buffer_load_dwordx4 v227,s[20:23],s34 offen offset:1024 nt lds
buffer_load_dwordx4 v227,s[20:23],s34 offen offset:2048 nt lds
buffer_load_dwordx4 v227,s[20:23],s34 offen offset:3072 nt lds
s_waitcnt vmcnt(8) lgkmcnt(0)
s_barrier
ds_read_b128 a[112:115],v224
ds_read_b128 a[116:119],v224 offset:256
ds_read_b128 a[120:123],v224 offset:512
ds_read_b128 a[124:127],v224 offset:768
ds_read_b128 a[128:131],v224 offset:1792
ds_read_b128 a[132:135],v224 offset:1536
ds_read_b128 a[136:139],v224 offset:1280
ds_read_b128 a[140:143],v224 offset:1024
s_waitcnt lgkmcnt(7)
v_mfma_f32_16x16x32_bf16 v[128:131],a[112:115],v[64:67],0
s_waitcnt lgkmcnt(6)
v_xor_b32 v224,0x800,v224
v_mfma_f32_16x16x32_bf16 v[128:131],a[116:119],v[68:71],v[128:131]
s_waitcnt lgkmcnt(5)
v_mfma_f32_16x16x32_bf16 v[128:131],a[120:123],v[72:75],v[128:131]
s_waitcnt lgkmcnt(4)
v_mfma_f32_16x16x32_bf16 v[128:131],a[124:127],v[76:79],v[128:131]
s_waitcnt lgkmcnt(3)
s_add_u32 m0,s30,147456
v_mfma_f32_16x16x32_bf16 v[132:135],a[128:131],v[76:79],0
s_waitcnt lgkmcnt(2)
s_mov_b32 s34,32768
buffer_load_dwordx4 v227,s[16:19],s34 offen nt lds
ds_read_b64_tr_b16 a[144:145],v225
ds_read_b64_tr_b16 a[146:147],v225 offset:1024
v_mfma_f32_16x16x32_bf16 v[132:135],a[132:135],v[72:75],v[132:135]
s_waitcnt lgkmcnt(2)
P0:
s_cbranch_execz P128
v_mfma_f32_16x16x32_bf16 v[132:135],a[136:139],v[68:71],v[132:135]
v_mfma_f32_16x16x32_bf16 v[132:135],a[140:143],v[64:67],v[132:135]
v_max3_f32 v156,v128,v129,v130
s_nop 6
v_max3_f32 v157,v131,v132,v133
v_max3_f32 v156,v156,v134,v135
v_max_f32 v156,v156,v157
v_mov_b32 v157,v156
s_nop 1
v_permlane32_swap_b32 v156,v157
v_max_f32 v156,v156,v157
v_mov_b32 v157,v156
s_nop 1
v_permlane16_swap_b32 v156,v157
v_max_f32 v156,v156,v157
v_sub_f32 v128,v128,v156
v_sub_f32 v129,v129,v156
v_sub_f32 v130,v130,v156
v_sub_f32 v131,v131,v156
v_sub_f32 v132,v132,v156
v_sub_f32 v133,v133,v156
v_sub_f32 v134,v134,v156
v_sub_f32 v135,v135,v156
v_sub_f32 v188,0,v156
v_sub_f32 v189,0,v156
v_sub_f32 v190,0,v156
v_sub_f32 v191,0,v156
v_exp_f32 v128,v128
v_exp_f32 v129,v129
v_exp_f32 v130,v130
v_exp_f32 v131,v131
v_mfma_f32_16x16x32_bf16 v[136:139],a[112:115],v[80:83],0
ds_read_b64_tr_b16 a[148:149],v226
ds_read_b64_tr_b16 a[150:151],v226 offset:1024
v_cvt_pk_bf16_f32 v168,v128,v129
v_cvt_pk_bf16_f32 v169,v130,v131
v_exp_f32 v132,v132
v_exp_f32 v133,v133
v_mfma_f32_16x16x32_bf16 v[136:139],a[116:119],v[84:87],v[136:139]
v_mfma_f32_16x16x32_bf16 v[136:139],a[120:123],v[88:91],v[136:139]
v_mfma_f32_16x16x32_bf16 v[136:139],a[124:127],v[92:95],v[136:139]
v_mfma_f32_16x16x32_bf16 v[140:143],a[128:131],v[92:95],0
ds_read_b64_tr_b16 a[152:153],v225 offset:256
ds_read_b64_tr_b16 a[154:155],v225 offset:1280
v_exp_f32 v134,v134
v_exp_f32 v135,v135
v_cvt_pk_bf16_f32 v170,v132,v133
v_cvt_pk_bf16_f32 v171,v134,v135
v_mfma_f32_16x16x32_bf16 v[140:143],a[132:135],v[88:91],v[140:143]
P1:
s_cbranch_execz P129
v_mfma_f32_16x16x32_bf16 v[140:143],a[136:139],v[84:87],v[140:143]
v_mfma_f32_16x16x32_bf16 v[140:143],a[140:143],v[80:83],v[140:143]
v_max3_f32 v156,v136,v137,v138
s_nop 6
v_max3_f32 v157,v139,v140,v141
v_max3_f32 v156,v156,v142,v143
v_max_f32 v156,v156,v157
v_mov_b32 v157,v156
s_nop 1
v_permlane32_swap_b32 v156,v157
v_max_f32 v156,v156,v157
v_mov_b32 v157,v156
s_nop 1
v_permlane16_swap_b32 v156,v157
v_max_f32 v156,v156,v157
v_sub_f32 v136,v136,v156
v_sub_f32 v137,v137,v156
v_sub_f32 v138,v138,v156
v_sub_f32 v139,v139,v156
v_sub_f32 v140,v140,v156
v_sub_f32 v141,v141,v156
v_sub_f32 v142,v142,v156
v_sub_f32 v143,v143,v156
v_sub_f32 v192,0,v156
v_sub_f32 v193,0,v156
v_sub_f32 v194,0,v156
v_sub_f32 v195,0,v156
v_exp_f32 v136,v136
v_exp_f32 v137,v137
v_exp_f32 v138,v138
v_mfma_f32_16x16x32_bf16 v[144:147],a[112:115],v[96:99],0
ds_read_b64_tr_b16 a[156:157],v226 offset:256
ds_read_b64_tr_b16 a[158:159],v226 offset:1280
v_exp_f32 v139,v139
v_cvt_pk_bf16_f32 v172,v136,v137
v_cvt_pk_bf16_f32 v173,v138,v139
v_exp_f32 v140,v140
v_mfma_f32_16x16x32_bf16 v[144:147],a[116:119],v[100:103],v[144:147]
v_mfma_f32_16x16x32_bf16 v[144:147],a[120:123],v[104:107],v[144:147]
v_mfma_f32_16x16x32_bf16 v[144:147],a[124:127],v[108:111],v[144:147]
v_exp_f32 v141,v141
v_mfma_f32_16x16x32_bf16 v[148:151],a[128:131],v[108:111],0
ds_read_b64_tr_b16 a[160:161],v225 offset:512
ds_read_b64_tr_b16 a[162:163],v225 offset:1536
buffer_load_dwordx4 v227,s[16:19],s34 offen offset:1024 nt lds
P2:
s_cbranch_execz P130
v_exp_f32 v142,v142
v_exp_f32 v143,v143
v_mfma_f32_16x16x32_bf16 v[148:151],a[132:135],v[104:107],v[148:151]
v_mfma_f32_16x16x32_bf16 v[148:151],a[136:139],v[100:103],v[148:151]
v_cvt_pk_bf16_f32 v174,v140,v141
v_mfma_f32_16x16x32_bf16 v[148:151],a[140:143],v[96:99],v[148:151]
ds_read_b64_tr_b16 a[164:165],v226 offset:512
v_cvt_pk_bf16_f32 v175,v142,v143
v_max3_f32 v156,v144,v145,v146
v_mfma_f32_16x16x32_bf16 v[128:131],a[112:115],v[112:115],0
ds_read_b64_tr_b16 a[166:167],v226 offset:1536
s_nop 2
v_max3_f32 v157,v147,v148,v149
v_max3_f32 v156,v156,v150,v151
v_max_f32 v156,v156,v157
v_mov_b32 v157,v156
v_mfma_f32_16x16x32_bf16 v[128:131],a[116:119],v[116:119],v[128:131]
v_mfma_f32_16x16x32_bf16 v[128:131],a[120:123],v[120:123],v[128:131]
ds_read_b64_tr_b16 a[168:169],v225 offset:768
ds_read_b64_tr_b16 a[170:171],v225 offset:1792
v_permlane32_swap_b32 v156,v157
v_mfma_f32_16x16x32_bf16 v[128:131],a[124:127],v[124:127],v[128:131]
v_max_f32 v156,v156,v157
v_mfma_f32_16x16x32_bf16 v[132:135],a[128:131],v[124:127],0
ds_read_b128 a[112:115],v224
ds_read_b64_tr_b16 a[172:173],v226 offset:768
ds_read_b128 a[116:119],v224 offset:256
ds_read_b64_tr_b16 a[174:175],v226 offset:1792
v_mov_b32 v157,v156
v_xor_b32 v225,0x800,v225
v_xor_b32 v226,0x800,v226
v_mfma_f32_16x16x32_bf16 v[132:135],a[132:135],v[120:123],v[132:135]
v_permlane16_swap_b32 v156,v157
v_mfma_f32_16x16x32_bf16 v[132:135],a[136:139],v[116:119],v[132:135]
v_max_f32 v156,v156,v157
v_sub_f32 v144,v144,v156
v_mfma_f32_16x16x32_bf16 v[132:135],a[140:143],v[112:115],v[132:135]
P3:
s_cbranch_execz P131
ds_read_b128 a[120:123],v224 offset:512
ds_read_b128 a[124:127],v224 offset:768
v_sub_f32 v145,v145,v156
v_sub_f32 v146,v146,v156
v_mfma_f32_16x16x32_bf16 v[208:211],a[176:179],v[168:171],0
s_waitcnt lgkmcnt(6)
v_sub_f32 v147,v147,v156
v_sub_f32 v148,v148,v156
v_sub_f32 v149,v149,v156
v_sub_f32 v150,v150,v156
v_sub_f32 v151,v151,v156
v_sub_f32 v196,0,v156
v_sub_f32 v197,0,v156
v_sub_f32 v198,0,v156
v_mfma_f32_16x16x32_bf16 v[0:3],a[144:147],v[168:171],0
ds_read_b128 a[128:131],v224 offset:1792
v_mfma_f32_16x16x32_bf16 v[4:7],a[148:151],v[168:171],0
ds_read_b128 a[132:135],v224 offset:1536
v_mfma_f32_16x16x32_bf16 v[8:11],a[152:155],v[168:171],0
v_mfma_f32_16x16x32_bf16 v[12:15],a[156:159],v[168:171],0
ds_read_b128 a[136:139],v224 offset:1280
ds_read_b128 a[140:143],v224 offset:1024
v_sub_f32 v199,0,v156
v_exp_f32 v144,v144
v_exp_f32 v145,v145
v_xor_b32 v224,0x8800,v224
v_mfma_f32_16x16x32_bf16 v[16:19],a[160:163],v[168:171],0
v_mfma_f32_16x16x32_bf16 v[20:23],a[164:167],v[168:171],0
v_mfma_f32_16x16x32_bf16 v[24:27],a[168:171],v[168:171],0
s_waitcnt lgkmcnt(3)
buffer_load_dwordx4 v227,s[16:19],s34 offen offset:2048 nt lds
v_exp_f32 v146,v146
v_mfma_f32_16x16x32_bf16 v[28:31],a[172:175],v[168:171],0
v_exp_f32 v147,v147
v_cvt_pk_bf16_f32 v176,v144,v145
v_cvt_pk_bf16_f32 v177,v146,v147
v_exp_f32 v148,v148
v_exp_f32 v149,v149
v_mfma_f32_16x16x32_bf16 v[136:139],a[112:115],a[96:99],0
P4:
s_cbranch_execz P132
v_mfma_f32_16x16x32_bf16 v[136:139],a[116:119],a[100:103],v[136:139]
v_mfma_f32_16x16x32_bf16 v[136:139],a[120:123],a[104:107],v[136:139]
v_mfma_f32_16x16x32_bf16 v[136:139],a[124:127],a[108:111],v[136:139]
v_exp_f32 v150,v150
v_exp_f32 v151,v151
v_cvt_pk_bf16_f32 v178,v148,v149
v_cvt_pk_bf16_f32 v179,v150,v151
v_max3_f32 v156,v128,v129,v130
v_max3_f32 v157,v131,v132,v133
v_mfma_f32_16x16x32_bf16 v[140:143],a[128:131],a[108:111],0
s_waitcnt lgkmcnt(0)
v_mfma_f32_16x16x32_bf16 v[140:143],a[132:135],a[104:107],v[140:143]
v_mfma_f32_16x16x32_bf16 v[140:143],a[136:139],a[100:103],v[140:143]
v_mfma_f32_16x16x32_bf16 v[140:143],a[140:143],a[96:99],v[140:143]
v_max3_f32 v156,v156,v134,v135
v_max_f32 v156,v156,v157
v_mov_b32 v157,v156
v_mfma_f32_16x16x32_bf16 v[208:211],a[180:183],v[172:175],v[208:211]
v_mfma_f32_16x16x32_bf16 v[32:35],a[144:147],v[172:175],0
v_permlane32_swap_b32 v156,v157
v_mfma_f32_16x16x32_bf16 v[36:39],a[148:151],v[172:175],0
v_max_f32 v156,v156,v157
v_mfma_f32_16x16x32_bf16 v[40:43],a[152:155],v[172:175],0
v_mov_b32 v157,v156
v_mfma_f32_16x16x32_bf16 v[44:47],a[156:159],v[172:175],0
s_nop 0
v_permlane16_swap_b32 v156,v157
v_mfma_f32_16x16x32_bf16 v[48:51],a[160:163],v[172:175],0
v_max_f32 v156,v156,v157
v_sub_f32 v128,v128,v156
v_mfma_f32_16x16x32_bf16 v[52:55],a[164:167],v[172:175],0
v_sub_f32 v129,v129,v156
v_sub_f32 v130,v130,v156
v_mfma_f32_16x16x32_bf16 v[56:59],a[168:171],v[172:175],0
buffer_load_dwordx4 v227,s[16:19],s34 offen offset:3072 nt lds
v_sub_f32 v131,v131,v156
v_sub_f32 v132,v132,v156
v_sub_f32 v133,v133,v156
v_sub_f32 v134,v134,v156
v_sub_f32 v135,v135,v156
v_sub_f32 v200,0,v156
v_mfma_f32_16x16x32_bf16 v[60:63],a[172:175],v[172:175],0
P5:
s_cbranch_execz P133
v_mfma_f32_16x16x32_bf16 v[144:147],a[112:115],v[64:67],v[188:191]
v_mfma_f32_16x16x32_bf16 v[144:147],a[116:119],v[68:71],v[144:147]
v_sub_f32 v201,0,v156
v_sub_f32 v202,0,v156
v_mfma_f32_16x16x32_bf16 v[144:147],a[120:123],v[72:75],v[144:147]
s_mov_b64 exec,0
s_bitcmp1_b32 s3,1
s_cbranch_scc1 ZT0
s_bitcmp1_b32 s3,0
s_cbranch_scc1 Z1
s_branch Z0
ZT0:
s_bitcmp1_b32 s3,0
s_cbranch_scc1 Z3
s_branch Z2
ZB0:
s_mov_b64 exec,-1
v_sub_f32 v203,0,v156
v_exp_f32 v128,v128
v_exp_f32 v129,v129
v_exp_f32 v130,v130
v_mfma_f32_16x16x32_bf16 v[144:147],a[124:127],v[76:79],v[144:147]
v_mfma_f32_16x16x32_bf16 v[148:151],a[128:131],v[76:79],v[188:191]
v_mfma_f32_16x16x32_bf16 v[148:151],a[132:135],v[72:75],v[148:151]
s_add_u32 m0,s30,114688
v_mfma_f32_16x16x32_bf16 v[148:151],a[136:139],v[68:71],v[148:151]
s_mov_b32 s34,32768
v_exp_f32 v131,v131
v_cvt_pk_bf16_f32 v180,v128,v129
v_cvt_pk_bf16_f32 v181,v130,v131
v_exp_f32 v132,v132
v_exp_f32 v133,v133
v_mfma_f32_16x16x32_bf16 v[148:151],a[140:143],v[64:67],v[148:151]
v_mfma_f32_16x16x32_bf16 v[208:211],a[184:187],v[176:179],v[208:211]
v_mfma_f32_16x16x32_bf16 a[32:35],a[144:147],v[176:179],0
v_mfma_f32_16x16x32_bf16 a[36:39],a[148:151],v[176:179],0
v_exp_f32 v134,v134
v_exp_f32 v135,v135
v_cvt_pk_bf16_f32 v182,v132,v133
v_cvt_pk_bf16_f32 v183,v134,v135
v_max3_f32 v156,v136,v137,v138
v_max3_f32 v157,v139,v140,v141
v_mfma_f32_16x16x32_bf16 a[40:43],a[152:155],v[176:179],0
P6:
s_cbranch_execz P134
v_mfma_f32_16x16x32_bf16 a[44:47],a[156:159],v[176:179],0
v_mfma_f32_16x16x32_bf16 a[48:51],a[160:163],v[176:179],0
v_mfma_f32_16x16x32_bf16 a[52:55],a[164:167],v[176:179],0
buffer_load_dwordx4 v227,s[20:23],s34 offen nt lds
v_max3_f32 v156,v156,v142,v143
v_max_f32 v156,v156,v157
v_mov_b32 v157,v156
v_mfma_f32_16x16x32_bf16 a[56:59],a[168:171],v[176:179],0
v_mfma_f32_16x16x32_bf16 a[60:63],a[172:175],v[176:179],0
v_permlane32_swap_b32 v156,v157
v_mfma_f32_16x16x32_bf16 v[128:131],a[112:115],v[80:83],v[192:195]
v_max_f32 v156,v156,v157
v_mfma_f32_16x16x32_bf16 v[128:131],a[116:119],v[84:87],v[128:131]
v_mov_b32 v157,v156
v_mfma_f32_16x16x32_bf16 v[128:131],a[120:123],v[88:91],v[128:131]
s_nop 0
v_permlane16_swap_b32 v156,v157
v_mfma_f32_16x16x32_bf16 v[128:131],a[124:127],v[92:95],v[128:131]
v_max_f32 v156,v156,v157
v_sub_f32 v136,v136,v156
v_mfma_f32_16x16x32_bf16 v[132:135],a[128:131],v[92:95],v[192:195]
v_sub_f32 v137,v137,v156
v_sub_f32 v138,v138,v156
v_mfma_f32_16x16x32_bf16 v[132:135],a[132:135],v[88:91],v[132:135]
v_sub_f32 v139,v139,v156
v_sub_f32 v140,v140,v156
v_sub_f32 v141,v141,v156
v_sub_f32 v142,v142,v156
v_sub_f32 v143,v143,v156
v_sub_f32 v204,0,v156
v_sub_f32 v205,0,v156
v_sub_f32 v206,0,v156
v_mfma_f32_16x16x32_bf16 v[132:135],a[136:139],v[84:87],v[132:135]
v_mfma_f32_16x16x32_bf16 v[132:135],a[140:143],v[80:83],v[132:135]
v_mfma_f32_16x16x32_bf16 v[208:211],a[188:191],v[180:183],v[208:211]
v_mfma_f32_16x16x32_bf16 a[64:67],a[144:147],v[180:183],0
ds_read_b64_tr_b16 a[144:145],v225
ds_read_b64_tr_b16 a[146:147],v225 offset:1024
v_sub_f32 v207,0,v156
v_exp_f32 v136,v136
v_exp_f32 v137,v137
v_mfma_f32_16x16x32_bf16 a[68:71],a[148:151],v[180:183],0
ds_read_b64_tr_b16 a[148:149],v226
ds_read_b64_tr_b16 a[150:151],v226 offset:1024
v_mfma_f32_16x16x32_bf16 a[72:75],a[152:155],v[180:183],0
P7:
s_cbranch_execz P135
ds_read_b64_tr_b16 a[152:153],v225 offset:256
ds_read_b64_tr_b16 a[154:155],v225 offset:1280
v_mfma_f32_16x16x32_bf16 a[76:79],a[156:159],v[180:183],0
ds_read_b64_tr_b16 a[156:157],v226 offset:256
ds_read_b64_tr_b16 a[158:159],v226 offset:1280
v_exp_f32 v138,v138
v_mfma_f32_16x16x32_bf16 a[80:83],a[160:163],v[180:183],0
buffer_load_dwordx4 v227,s[20:23],s34 offen offset:1024 nt lds
v_exp_f32 v139,v139
v_cvt_pk_bf16_f32 v184,v136,v137
v_cvt_pk_bf16_f32 v185,v138,v139
v_exp_f32 v140,v140
v_mfma_f32_16x16x32_bf16 a[84:87],a[164:167],v[180:183],0
ds_read_b64_tr_b16 a[160:161],v225 offset:512
ds_read_b64_tr_b16 a[162:163],v225 offset:1536
v_mfma_f32_16x16x32_bf16 a[88:91],a[168:171],v[180:183],0
v_mfma_f32_16x16x32_bf16 a[92:95],a[172:175],v[180:183],0
ds_read_b64_tr_b16 a[164:165],v226 offset:512
v_exp_f32 v141,v141
v_mfma_f32_16x16x32_bf16 v[136:139],a[112:115],v[96:99],v[196:199]
ds_read_b64_tr_b16 a[166:167],v226 offset:1536
v_exp_f32 v142,v142
v_exp_f32 v143,v143
v_cvt_pk_bf16_f32 v186,v140,v141
v_cvt_pk_bf16_f32 v187,v142,v143
v_mfma_f32_16x16x32_bf16 v[136:139],a[116:119],v[100:103],v[136:139]
v_mfma_f32_16x16x32_bf16 v[136:139],a[120:123],v[104:107],v[136:139]
ds_read_b64_tr_b16 a[168:169],v225 offset:768
ds_read_b64_tr_b16 a[170:171],v225 offset:1792
v_mfma_f32_16x16x32_bf16 v[136:139],a[124:127],v[108:111],v[136:139]
P8:
s_cbranch_execz P136
v_mfma_f32_16x16x32_bf16 v[140:143],a[128:131],v[108:111],v[196:199]
ds_read_b64_tr_b16 a[172:173],v226 offset:768
ds_read_b64_tr_b16 a[174:175],v226 offset:1792
v_exp_f32 v144,v144
v_exp_f32 v145,v145
v_exp_f32 v146,v146
v_mfma_f32_16x16x32_bf16 v[140:143],a[132:135],v[104:107],v[140:143]
v_mfma_f32_16x16x32_bf16 v[140:143],a[136:139],v[100:103],v[140:143]
v_mfma_f32_16x16x32_bf16 v[140:143],a[140:143],v[96:99],v[140:143]
v_mfma_f32_16x16x32_bf16 v[212:215],a[176:179],v[184:187],0
s_waitcnt lgkmcnt(2)
v_exp_f32 v147,v147
v_cvt_pk_bf16_f32 v168,v144,v145
v_cvt_pk_bf16_f32 v169,v146,v147
v_exp_f32 v148,v148
v_exp_f32 v149,v149
v_mfma_f32_16x16x32_bf16 a[0:3],a[144:147],v[184:187],0
v_mfma_f32_16x16x32_bf16 a[4:7],a[148:151],v[184:187],0
v_mfma_f32_16x16x32_bf16 a[8:11],a[152:155],v[184:187],0
v_mfma_f32_16x16x32_bf16 a[12:15],a[156:159],v[184:187],0
v_exp_f32 v150,v150
v_exp_f32 v151,v151
v_cvt_pk_bf16_f32 v170,v148,v149
v_cvt_pk_bf16_f32 v171,v150,v151
v_exp_f32 v128,v128
v_mfma_f32_16x16x32_bf16 a[16:19],a[160:163],v[184:187],0
v_mfma_f32_16x16x32_bf16 a[20:23],a[164:167],v[184:187],0
v_mfma_f32_16x16x32_bf16 a[24:27],a[168:171],v[184:187],0
s_waitcnt vmcnt(6) lgkmcnt(0)
s_barrier
buffer_load_dwordx4 v227,s[20:23],s34 offen offset:2048 nt lds
v_mfma_f32_16x16x32_bf16 a[28:31],a[172:175],v[184:187],0
v_exp_f32 v129,v129
v_exp_f32 v130,v130
v_exp_f32 v131,v131
v_cvt_pk_bf16_f32 v172,v128,v129
v_cvt_pk_bf16_f32 v173,v130,v131
v_mfma_f32_16x16x32_bf16 v[144:147],a[112:115],v[112:115],v[200:203]
v_mfma_f32_16x16x32_bf16 v[144:147],a[116:119],v[116:119],v[144:147]
P9:
s_cbranch_execz P137
v_mfma_f32_16x16x32_bf16 v[144:147],a[120:123],v[120:123],v[144:147]
v_mfma_f32_16x16x32_bf16 v[144:147],a[124:127],v[124:127],v[144:147]
ds_read_b128 a[112:115],v224
ds_read_b128 a[116:119],v224 offset:256
v_exp_f32 v132,v132
v_exp_f32 v133,v133
v_exp_f32 v134,v134
v_mfma_f32_16x16x32_bf16 v[148:151],a[128:131],v[124:127],v[200:203]
v_mfma_f32_16x16x32_bf16 v[148:151],a[132:135],v[120:123],v[148:151]
v_mfma_f32_16x16x32_bf16 v[148:151],a[136:139],v[116:119],v[148:151]
v_mfma_f32_16x16x32_bf16 v[148:151],a[140:143],v[112:115],v[148:151]
ds_read_b128 a[120:123],v224 offset:512
ds_read_b128 a[124:127],v224 offset:768
v_exp_f32 v135,v135
v_cvt_pk_bf16_f32 v174,v132,v133
v_cvt_pk_bf16_f32 v175,v134,v135
v_exp_f32 v136,v136
v_mfma_f32_16x16x32_bf16 v[208:211],a[176:179],v[168:171],v[208:211]
v_mfma_f32_16x16x32_bf16 v[0:3],a[144:147],v[168:171],v[0:3]
ds_read_b128 a[128:131],v224 offset:1792
v_mfma_f32_16x16x32_bf16 v[4:7],a[148:151],v[168:171],v[4:7]
ds_read_b128 a[132:135],v224 offset:1536
v_mfma_f32_16x16x32_bf16 v[8:11],a[152:155],v[168:171],v[8:11]
v_exp_f32 v137,v137
v_exp_f32 v138,v138
v_exp_f32 v139,v139
v_cvt_pk_bf16_f32 v176,v136,v137
v_cvt_pk_bf16_f32 v177,v138,v139
v_mfma_f32_16x16x32_bf16 v[12:15],a[156:159],v[168:171],v[12:15]
ds_read_b128 a[136:139],v224 offset:1280
v_mfma_f32_16x16x32_bf16 v[16:19],a[160:163],v[168:171],v[16:19]
ds_read_b128 a[140:143],v224 offset:1024
v_mfma_f32_16x16x32_bf16 v[20:23],a[164:167],v[168:171],v[20:23]
v_mfma_f32_16x16x32_bf16 v[24:27],a[168:171],v[168:171],v[24:27]
buffer_load_dwordx4 v227,s[20:23],s34 offen offset:3072 nt lds
v_xor_b32 v224,0x800,v224
v_exp_f32 v140,v140
v_exp_f32 v141,v141
v_xor_b32 v225,0x8800,v225
v_mfma_f32_16x16x32_bf16 v[28:31],a[172:175],v[168:171],v[28:31]
s_waitcnt lgkmcnt(2)
P10:
s_cbranch_execz P138
v_mfma_f32_16x16x32_bf16 v[128:131],a[112:115],v[64:67],v[188:191]
s_add_u32 m0,s30,98304
v_mfma_f32_16x16x32_bf16 v[128:131],a[116:119],v[68:71],v[128:131]
v_mfma_f32_16x16x32_bf16 v[128:131],a[120:123],v[72:75],v[128:131]
ds_read_b128 a[192:195],v224
ds_read_b128 a[196:199],v224 offset:256
v_exp_f32 v142,v142
v_exp_f32 v143,v143
v_cvt_pk_bf16_f32 v178,v140,v141
v_cvt_pk_bf16_f32 v179,v142,v143
v_mfma_f32_16x16x32_bf16 v[128:131],a[124:127],v[76:79],v[128:131]
v_mfma_f32_16x16x32_bf16 v[132:135],a[128:131],v[76:79],v[188:191]
s_mov_b32 s34,49152
v_mfma_f32_16x16x32_bf16 v[132:135],a[132:135],v[72:75],v[132:135]
s_waitcnt lgkmcnt(2)
v_mfma_f32_16x16x32_bf16 v[132:135],a[136:139],v[68:71],v[132:135]
ds_read_b128 a[200:203],v224 offset:512
ds_read_b128 a[204:207],v224 offset:768
v_exp_f32 v144,v144
v_exp_f32 v145,v145
v_exp_f32 v146,v146
v_mfma_f32_16x16x32_bf16 v[132:135],a[140:143],v[64:67],v[132:135]
v_mfma_f32_16x16x32_bf16 v[208:211],a[180:183],v[172:175],v[208:211]
v_mfma_f32_16x16x32_bf16 v[32:35],a[144:147],v[172:175],v[32:35]
ds_read_b128 a[208:211],v224 offset:1792
v_mfma_f32_16x16x32_bf16 v[36:39],a[148:151],v[172:175],v[36:39]
ds_read_b128 a[212:215],v224 offset:1536
buffer_load_dwordx4 v227,s[16:19],s34 offen nt lds
v_exp_f32 v147,v147
v_cvt_pk_bf16_f32 v180,v144,v145
v_cvt_pk_bf16_f32 v181,v146,v147
v_xor_b32 v226,0x8800,v226
v_mfma_f32_16x16x32_bf16 v[40:43],a[152:155],v[172:175],v[40:43]
P11:
s_cbranch_execz P139
Z0:
s_cbranch_execz Z4
v_mfma_f32_16x16x32_bf16 v[44:47],a[156:159],v[172:175],v[44:47]
ds_read_b128 a[216:219],v224 offset:1280
v_mfma_f32_16x16x32_bf16 v[48:51],a[160:163],v[172:175],v[48:51]
ds_read_b128 a[220:223],v224 offset:1024
v_mfma_f32_16x16x32_bf16 v[52:55],a[164:167],v[172:175],v[52:55]
buffer_load_dwordx4 v227,s[16:19],s34 offen offset:1024 nt lds
v_exp_f32 v148,v148
v_exp_f32 v149,v149
v_exp_f32 v150,v150
v_mfma_f32_16x16x32_bf16 v[56:59],a[168:171],v[172:175],v[56:59]
v_mfma_f32_16x16x32_bf16 v[60:63],a[172:175],v[172:175],v[60:63]
s_waitcnt lgkmcnt(2)
v_mfma_f32_16x16x32_bf16 v[136:139],a[192:195],v[64:67],v[188:191]
v_mfma_f32_16x16x32_bf16 v[136:139],a[196:199],v[68:71],v[136:139]
buffer_load_dwordx4 v227,s[16:19],s34 offen offset:2048 nt lds
v_exp_f32 v151,v151
v_cvt_pk_bf16_f32 v182,v148,v149
v_cvt_pk_bf16_f32 v183,v150,v151
v_exp_f32 v128,v128
v_mfma_f32_16x16x32_bf16 v[136:139],a[200:203],v[72:75],v[136:139]
v_mfma_f32_16x16x32_bf16 v[136:139],a[204:207],v[76:79],v[136:139]
v_mfma_f32_16x16x32_bf16 v[140:143],a[208:211],v[76:79],v[188:191]
v_mfma_f32_16x16x32_bf16 v[140:143],a[212:215],v[72:75],v[140:143]
s_waitcnt lgkmcnt(0)
v_exp_f32 v129,v129
v_exp_f32 v130,v130
v_exp_f32 v131,v131
v_cvt_pk_bf16_f32 v168,v128,v129
v_cvt_pk_bf16_f32 v169,v130,v131
v_mfma_f32_16x16x32_bf16 v[140:143],a[216:219],v[68:71],v[140:143]
v_mfma_f32_16x16x32_bf16 v[140:143],a[220:223],v[64:67],v[140:143]
v_mfma_f32_16x16x32_bf16 a[32:35],a[144:147],v[176:179],a[32:35]
v_mfma_f32_16x16x32_bf16 a[36:39],a[148:151],v[176:179],a[36:39]
v_exp_f32 v132,v132
v_exp_f32 v133,v133
v_exp_f32 v134,v134
v_exp_f32 v135,v135
v_mfma_f32_16x16x32_bf16 a[40:43],a[152:155],v[176:179],a[40:43]
P12:
s_cbranch_execz P140
v_mfma_f32_16x16x32_bf16 a[44:47],a[156:159],v[176:179],a[44:47]
v_cvt_pk_bf16_f32 v170,v132,v133
v_cvt_pk_bf16_f32 v171,v134,v135
v_exp_f32 v136,v136
v_mfma_f32_16x16x32_bf16 a[48:51],a[160:163],v[176:179],a[48:51]
v_mfma_f32_16x16x32_bf16 a[52:55],a[164:167],v[176:179],a[52:55]
v_exp_f32 v137,v137
v_exp_f32 v138,v138
v_mfma_f32_16x16x32_bf16 a[56:59],a[168:171],v[176:179],a[56:59]
v_mfma_f32_16x16x32_bf16 a[60:63],a[172:175],v[176:179],a[60:63]
v_exp_f32 v139,v139
v_cvt_pk_bf16_f32 v172,v136,v137
v_cvt_pk_bf16_f32 v173,v138,v139
v_mfma_f32_16x16x32_bf16 v[208:211],a[184:187],v[176:179],v[208:211]
v_mfma_f32_16x16x32_bf16 v[208:211],a[188:191],v[180:183],v[208:211]
buffer_load_dwordx4 v227,s[16:19],s34 offen offset:3072 nt lds
v_exp_f32 v140,v140
v_mfma_f32_16x16x32_bf16 a[64:67],a[144:147],v[180:183],a[64:67]
ds_read_b64_tr_b16 a[144:145],v225
ds_read_b64_tr_b16 a[146:147],v225 offset:1024
v_mfma_f32_16x16x32_bf16 a[68:71],a[148:151],v[180:183],a[68:71]
ds_read_b64_tr_b16 a[148:149],v226
ds_read_b64_tr_b16 a[150:151],v226 offset:1024
v_exp_f32 v141,v141
v_mfma_f32_16x16x32_bf16 a[72:75],a[152:155],v[180:183],a[72:75]
ds_read_b64_tr_b16 a[152:153],v225 offset:256
ds_read_b64_tr_b16 a[154:155],v225 offset:1280
v_mfma_f32_16x16x32_bf16 a[76:79],a[156:159],v[180:183],a[76:79]
ds_read_b64_tr_b16 a[156:157],v226 offset:256
ds_read_b64_tr_b16 a[158:159],v226 offset:1280
v_exp_f32 v142,v142
v_mfma_f32_16x16x32_bf16 a[80:83],a[160:163],v[180:183],a[80:83]
ds_read_b64_tr_b16 a[160:161],v225 offset:512
ds_read_b64_tr_b16 a[162:163],v225 offset:1536
v_mfma_f32_16x16x32_bf16 a[84:87],a[164:167],v[180:183],a[84:87]
ds_read_b64_tr_b16 a[164:165],v226 offset:512
ds_read_b64_tr_b16 a[166:167],v226 offset:1536
v_exp_f32 v143,v143
v_mfma_f32_16x16x32_bf16 a[88:91],a[168:171],v[180:183],a[88:91]
P13:
s_cbranch_execz P141
v_mfma_f32_16x16x32_bf16 a[92:95],a[172:175],v[180:183],a[92:95]
ds_read_b64_tr_b16 a[168:169],v225 offset:768
ds_read_b64_tr_b16 a[170:171],v225 offset:1792
v_cvt_pk_bf16_f32 v174,v140,v141
v_cvt_pk_bf16_f32 v175,v142,v143
v_mfma_f32_16x16x32_bf16 v[144:147],a[112:115],v[80:83],v[192:195]
s_add_u32 m0,s30,65536
v_mfma_f32_16x16x32_bf16 v[144:147],a[116:119],v[84:87],v[144:147]
ds_read_b64_tr_b16 a[172:173],v226 offset:768
ds_read_b64_tr_b16 a[174:175],v226 offset:1792
v_xor_b32 v225,0x800,v225
v_xor_b32 v226,0x800,v226
v_mfma_f32_16x16x32_bf16 v[144:147],a[120:123],v[88:91],v[144:147]
s_mov_b32 s34,49152
v_mfma_f32_16x16x32_bf16 v[144:147],a[124:127],v[92:95],v[144:147]
ds_read_b64_tr_b16 a[224:225],v225
ds_read_b64_tr_b16 a[226:227],v225 offset:1024
v_xor_b32 v224,0x2c800,v224
v_mfma_f32_16x16x32_bf16 v[148:151],a[128:131],v[92:95],v[192:195]
v_mfma_f32_16x16x32_bf16 v[148:151],a[132:135],v[88:91],v[148:151]
ds_read_b64_tr_b16 a[228:229],v226
ds_read_b64_tr_b16 a[230:231],v226 offset:1024
v_mfma_f32_16x16x32_bf16 v[148:151],a[136:139],v[84:87],v[148:151]
v_mfma_f32_16x16x32_bf16 v[148:151],a[140:143],v[80:83],v[148:151]
buffer_load_dwordx4 v227,s[20:23],s34 offen nt lds
ds_read_b64_tr_b16 a[232:233],v225 offset:256
ds_read_b64_tr_b16 a[234:235],v225 offset:1280
v_mfma_f32_16x16x32_bf16 v[128:131],a[192:195],v[80:83],v[192:195]
P14:
s_cbranch_execz P142
v_mfma_f32_16x16x32_bf16 v[128:131],a[196:199],v[84:87],v[128:131]
ds_read_b64_tr_b16 a[236:237],v226 offset:256
ds_read_b64_tr_b16 a[238:239],v226 offset:1280
v_exp_f32 v144,v144
v_mfma_f32_16x16x32_bf16 v[128:131],a[200:203],v[88:91],v[128:131]
v_mfma_f32_16x16x32_bf16 v[128:131],a[204:207],v[92:95],v[128:131]
ds_read_b64_tr_b16 a[240:241],v225 offset:512
ds_read_b64_tr_b16 a[242:243],v225 offset:1536
v_exp_f32 v145,v145
v_mfma_f32_16x16x32_bf16 v[132:135],a[208:211],v[92:95],v[192:195]
v_mfma_f32_16x16x32_bf16 v[132:135],a[212:215],v[88:91],v[132:135]
ds_read_b64_tr_b16 a[244:245],v226 offset:512
ds_read_b64_tr_b16 a[246:247],v226 offset:1536
v_exp_f32 v146,v146
v_mfma_f32_16x16x32_bf16 v[132:135],a[216:219],v[84:87],v[132:135]
v_mfma_f32_16x16x32_bf16 v[132:135],a[220:223],v[80:83],v[132:135]
ds_read_b64_tr_b16 a[248:249],v225 offset:768
ds_read_b64_tr_b16 a[250:251],v225 offset:1792
v_exp_f32 v147,v147
v_mfma_f32_16x16x32_bf16 v[208:211],a[176:179],v[168:171],v[208:211]
v_mfma_f32_16x16x32_bf16 v[208:211],a[176:179],v[172:175],v[208:211]
s_waitcnt lgkmcnt(4)
ds_read_b64_tr_b16 a[252:253],v226 offset:768
ds_read_b64_tr_b16 a[254:255],v226 offset:1792
v_cvt_pk_bf16_f32 v176,v144,v145
v_cvt_pk_bf16_f32 v177,v146,v147
v_mfma_f32_16x16x32_bf16 v[0:3],a[224:227],v[172:175],v[0:3]
v_mfma_f32_16x16x32_bf16 v[0:3],a[144:147],v[168:171],v[0:3]
v_exp_f32 v148,v148
v_exp_f32 v149,v149
v_mfma_f32_16x16x32_bf16 v[4:7],a[148:151],v[168:171],v[4:7]
v_mfma_f32_16x16x32_bf16 v[4:7],a[228:231],v[172:175],v[4:7]
v_exp_f32 v150,v150
v_exp_f32 v151,v151
v_mfma_f32_16x16x32_bf16 v[8:11],a[232:235],v[172:175],v[8:11]
P15:
s_cbranch_execz P143
v_mfma_f32_16x16x32_bf16 v[8:11],a[152:155],v[168:171],v[8:11]
buffer_load_dwordx4 v227,s[20:23],s34 offen offset:1024 nt lds
v_cvt_pk_bf16_f32 v178,v148,v149
v_cvt_pk_bf16_f32 v179,v150,v151
v_mfma_f32_16x16x32_bf16 v[12:15],a[156:159],v[168:171],v[12:15]
v_mfma_f32_16x16x32_bf16 v[12:15],a[236:239],v[172:175],v[12:15]
v_exp_f32 v128,v128
v_exp_f32 v129,v129
v_mfma_f32_16x16x32_bf16 v[16:19],a[240:243],v[172:175],v[16:19]
v_mfma_f32_16x16x32_bf16 v[16:19],a[160:163],v[168:171],v[16:19]
v_exp_f32 v130,v130
v_exp_f32 v131,v131
v_mfma_f32_16x16x32_bf16 v[20:23],a[164:167],v[168:171],v[20:23]
s_waitcnt lgkmcnt(0)
v_mfma_f32_16x16x32_bf16 v[20:23],a[244:247],v[172:175],v[20:23]
v_cvt_pk_bf16_f32 v180,v128,v129
v_cvt_pk_bf16_f32 v181,v130,v131
v_exp_f32 v132,v132
v_mfma_f32_16x16x32_bf16 v[24:27],a[248:251],v[172:175],v[24:27]
v_mfma_f32_16x16x32_bf16 v[24:27],a[168:171],v[168:171],v[24:27]
v_exp_f32 v133,v133
v_exp_f32 v134,v134
v_mfma_f32_16x16x32_bf16 v[28:31],a[172:175],v[168:171],v[28:31]
v_mfma_f32_16x16x32_bf16 v[28:31],a[252:255],v[172:175],v[28:31]
v_exp_f32 v135,v135
v_cvt_pk_bf16_f32 v182,v132,v133
v_cvt_pk_bf16_f32 v183,v134,v135
v_mfma_f32_16x16x32_bf16 v[136:139],a[192:195],a[96:99],v[204:207]
v_mfma_f32_16x16x32_bf16 v[136:139],a[196:199],a[100:103],v[136:139]
v_xor_b32 v225,0x10800,v225
v_xor_b32 v226,0x10800,v226
v_mfma_f32_16x16x32_bf16 v[136:139],a[200:203],a[104:107],v[136:139]
v_mfma_f32_16x16x32_bf16 v[136:139],a[204:207],a[108:111],v[136:139]
v_mfma_f32_16x16x32_bf16 v[140:143],a[208:211],a[108:111],v[204:207]
v_mfma_f32_16x16x32_bf16 v[140:143],a[212:215],a[104:107],v[140:143]
P16:
s_cbranch_execz P144
buffer_load_dwordx4 v227,s[20:23],s34 offen offset:2048 nt lds
v_mfma_f32_16x16x32_bf16 v[140:143],a[216:219],a[100:103],v[140:143]
v_mfma_f32_16x16x32_bf16 v[140:143],a[220:223],a[96:99],v[140:143]
v_mfma_f32_16x16x32_bf16 v[208:211],a[180:183],v[176:179],v[208:211]
v_mfma_f32_16x16x32_bf16 v[208:211],a[180:183],v[180:183],v[208:211]
v_exp_f32 v136,v136
v_exp_f32 v137,v137
v_mfma_f32_16x16x32_bf16 v[32:35],a[224:227],v[180:183],v[32:35]
v_mfma_f32_16x16x32_bf16 v[32:35],a[144:147],v[176:179],v[32:35]
v_exp_f32 v138,v138
v_exp_f32 v139,v139
v_mfma_f32_16x16x32_bf16 v[36:39],a[148:151],v[176:179],v[36:39]
v_mfma_f32_16x16x32_bf16 v[36:39],a[228:231],v[180:183],v[36:39]
v_cvt_pk_bf16_f32 v184,v136,v137
v_cvt_pk_bf16_f32 v185,v138,v139
v_exp_f32 v140,v140
v_mfma_f32_16x16x32_bf16 v[40:43],a[232:235],v[180:183],v[40:43]
v_mfma_f32_16x16x32_bf16 v[40:43],a[152:155],v[176:179],v[40:43]
v_exp_f32 v141,v141
v_exp_f32 v142,v142
v_mfma_f32_16x16x32_bf16 v[44:47],a[156:159],v[176:179],v[44:47]
v_mfma_f32_16x16x32_bf16 v[44:47],a[236:239],v[180:183],v[44:47]
v_exp_f32 v143,v143
v_cvt_pk_bf16_f32 v186,v140,v141
v_cvt_pk_bf16_f32 v187,v142,v143
v_mfma_f32_16x16x32_bf16 v[48:51],a[240:243],v[180:183],v[48:51]
v_mfma_f32_16x16x32_bf16 v[48:51],a[160:163],v[176:179],v[48:51]
v_mfma_f32_16x16x32_bf16 v[52:55],a[164:167],v[176:179],v[52:55]
v_mfma_f32_16x16x32_bf16 v[52:55],a[244:247],v[180:183],v[52:55]
buffer_load_dwordx4 v227,s[20:23],s34 offen offset:3072 nt lds
v_mfma_f32_16x16x32_bf16 v[56:59],a[248:251],v[180:183],v[56:59]
v_mfma_f32_16x16x32_bf16 v[56:59],a[168:171],v[176:179],v[56:59]
v_mfma_f32_16x16x32_bf16 v[60:63],a[172:175],v[176:179],v[60:63]
v_mfma_f32_16x16x32_bf16 v[60:63],a[252:255],v[180:183],v[60:63]
v_mfma_f32_16x16x32_bf16 v[144:147],a[112:115],v[96:99],v[196:199]
v_mfma_f32_16x16x32_bf16 v[144:147],a[116:119],v[100:103],v[144:147]
P17:
s_cbranch_execz P145
v_mfma_f32_16x16x32_bf16 v[144:147],a[120:123],v[104:107],v[144:147]
v_mfma_f32_16x16x32_bf16 v[144:147],a[124:127],v[108:111],v[144:147]
v_mfma_f32_16x16x32_bf16 v[148:151],a[128:131],v[108:111],v[196:199]
v_mfma_f32_16x16x32_bf16 v[148:151],a[132:135],v[104:107],v[148:151]
v_mfma_f32_16x16x32_bf16 v[148:151],a[136:139],v[100:103],v[148:151]
v_mfma_f32_16x16x32_bf16 v[148:151],a[140:143],v[96:99],v[148:151]
v_mfma_f32_16x16x32_bf16 v[128:131],a[192:195],v[96:99],v[196:199]
v_mfma_f32_16x16x32_bf16 v[128:131],a[196:199],v[100:103],v[128:131]
v_mfma_f32_16x16x32_bf16 v[128:131],a[200:203],v[104:107],v[128:131]
v_mfma_f32_16x16x32_bf16 v[128:131],a[204:207],v[108:111],v[128:131]
v_exp_f32 v144,v144
v_exp_f32 v145,v145
v_mfma_f32_16x16x32_bf16 v[132:135],a[208:211],v[108:111],v[196:199]
v_mfma_f32_16x16x32_bf16 v[132:135],a[212:215],v[104:107],v[132:135]
v_exp_f32 v146,v146
v_exp_f32 v147,v147
v_mfma_f32_16x16x32_bf16 v[132:135],a[216:219],v[100:103],v[132:135]
v_mfma_f32_16x16x32_bf16 v[132:135],a[220:223],v[96:99],v[132:135]
v_cvt_pk_bf16_f32 v168,v144,v145
v_cvt_pk_bf16_f32 v169,v146,v147
v_exp_f32 v148,v148
v_mfma_f32_16x16x32_bf16 v[212:215],a[176:179],v[184:187],v[212:215]
v_mfma_f32_16x16x32_bf16 a[0:3],a[224:227],v[184:187],a[0:3]
v_exp_f32 v149,v149
v_exp_f32 v150,v150
v_mfma_f32_16x16x32_bf16 a[4:7],a[228:231],v[184:187],a[4:7]
v_mfma_f32_16x16x32_bf16 a[8:11],a[232:235],v[184:187],a[8:11]
s_add_u32 m0,s30,81920
v_exp_f32 v151,v151
v_cvt_pk_bf16_f32 v170,v148,v149
v_cvt_pk_bf16_f32 v171,v150,v151
v_mfma_f32_16x16x32_bf16 a[12:15],a[236:239],v[184:187],a[12:15]
s_mov_b32 s34,65536
v_mfma_f32_16x16x32_bf16 a[16:19],a[240:243],v[184:187],a[16:19]
v_exp_f32 v128,v128
v_exp_f32 v129,v129
v_mfma_f32_16x16x32_bf16 a[20:23],a[244:247],v[184:187],a[20:23]
P18:
s_cbranch_execz P146
v_mfma_f32_16x16x32_bf16 a[24:27],a[248:251],v[184:187],a[24:27]
s_waitcnt vmcnt(8) lgkmcnt(0)
s_barrier
v_exp_f32 v130,v130
v_mfma_f32_16x16x32_bf16 a[28:31],a[252:255],v[184:187],a[28:31]
v_mfma_f32_16x16x32_bf16 v[136:139],a[112:115],v[112:115],v[200:203]
v_exp_f32 v131,v131
v_cvt_pk_bf16_f32 v172,v128,v129
v_cvt_pk_bf16_f32 v173,v130,v131
v_mfma_f32_16x16x32_bf16 v[136:139],a[116:119],v[116:119],v[136:139]
v_mfma_f32_16x16x32_bf16 v[136:139],a[120:123],v[120:123],v[136:139]
buffer_load_dwordx4 v227,s[16:19],s34 offen nt lds
v_exp_f32 v132,v132
v_mfma_f32_16x16x32_bf16 v[136:139],a[124:127],v[124:127],v[136:139]
v_mfma_f32_16x16x32_bf16 v[140:143],a[128:131],v[124:127],v[200:203]
ds_read_b128 a[112:115],v224
ds_read_b128 a[116:119],v224 offset:256
v_exp_f32 v133,v133
v_mfma_f32_16x16x32_bf16 v[140:143],a[132:135],v[120:123],v[140:143]
v_mfma_f32_16x16x32_bf16 v[140:143],a[136:139],v[116:119],v[140:143]
ds_read_b128 a[120:123],v224 offset:512
ds_read_b128 a[124:127],v224 offset:768
v_exp_f32 v134,v134
v_mfma_f32_16x16x32_bf16 v[140:143],a[140:143],v[112:115],v[140:143]
v_mfma_f32_16x16x32_bf16 v[144:147],a[192:195],v[112:115],v[200:203]
ds_read_b128 a[128:131],v224 offset:1792
ds_read_b128 a[132:135],v224 offset:1536
v_exp_f32 v135,v135
v_mfma_f32_16x16x32_bf16 v[144:147],a[196:199],v[116:119],v[144:147]
v_mfma_f32_16x16x32_bf16 v[144:147],a[200:203],v[120:123],v[144:147]
ds_read_b128 a[136:139],v224 offset:1280
ds_read_b128 a[140:143],v224 offset:1024
v_cvt_pk_bf16_f32 v174,v132,v133
v_cvt_pk_bf16_f32 v175,v134,v135
v_mfma_f32_16x16x32_bf16 v[144:147],a[204:207],v[124:127],v[144:147]
P19:
s_cbranch_execz P147
v_mfma_f32_16x16x32_bf16 v[148:151],a[208:211],v[124:127],v[200:203]
v_exp_f32 v136,v136
v_exp_f32 v137,v137
v_mfma_f32_16x16x32_bf16 v[148:151],a[212:215],v[120:123],v[148:151]
v_mfma_f32_16x16x32_bf16 v[148:151],a[216:219],v[116:119],v[148:151]
v_xor_b32 v224,0x800,v224
v_exp_f32 v138,v138
v_mfma_f32_16x16x32_bf16 v[148:151],a[220:223],v[112:115],v[148:151]
v_mfma_f32_16x16x32_bf16 v[208:211],a[184:187],v[168:171],v[208:211]
ds_read_b128 a[192:195],v224
ds_read_b128 a[196:199],v224 offset:256
v_exp_f32 v139,v139
v_mfma_f32_16x16x32_bf16 v[208:211],a[184:187],v[172:175],v[208:211]
v_mfma_f32_16x16x32_bf16 a[32:35],a[224:227],v[172:175],a[32:35]
ds_read_b128 a[200:203],v224 offset:512
ds_read_b128 a[204:207],v224 offset:768
v_cvt_pk_bf16_f32 v176,v136,v137
v_cvt_pk_bf16_f32 v177,v138,v139
v_mfma_f32_16x16x32_bf16 a[32:35],a[144:147],v[168:171],a[32:35]
v_mfma_f32_16x16x32_bf16 a[36:39],a[148:151],v[168:171],a[36:39]
buffer_load_dwordx4 v227,s[16:19],s34 offen offset:1024 nt lds
v_exp_f32 v140,v140
v_mfma_f32_16x16x32_bf16 a[36:39],a[228:231],v[172:175],a[36:39]
v_mfma_f32_16x16x32_bf16 a[40:43],a[232:235],v[172:175],a[40:43]
ds_read_b128 a[208:211],v224 offset:1792
ds_read_b128 a[212:215],v224 offset:1536
v_exp_f32 v141,v141
v_mfma_f32_16x16x32_bf16 a[40:43],a[152:155],v[168:171],a[40:43]
v_mfma_f32_16x16x32_bf16 a[44:47],a[156:159],v[168:171],a[44:47]
ds_read_b128 a[216:219],v224 offset:1280
ds_read_b128 a[220:223],v224 offset:1024
v_exp_f32 v142,v142
v_mfma_f32_16x16x32_bf16 a[44:47],a[236:239],v[172:175],a[44:47]
v_mfma_f32_16x16x32_bf16 a[48:51],a[240:243],v[172:175],a[48:51]
v_exp_f32 v143,v143
v_cvt_pk_bf16_f32 v178,v140,v141
v_cvt_pk_bf16_f32 v179,v142,v143
v_mfma_f32_16x16x32_bf16 a[48:51],a[160:163],v[168:171],a[48:51]
P20:
s_cbranch_execz P148
v_mfma_f32_16x16x32_bf16 a[52:55],a[164:167],v[168:171],a[52:55]
v_exp_f32 v144,v144
v_exp_f32 v145,v145
v_mfma_f32_16x16x32_bf16 a[52:55],a[244:247],v[172:175],a[52:55]
v_mfma_f32_16x16x32_bf16 a[56:59],a[248:251],v[172:175],a[56:59]
v_exp_f32 v146,v146
v_exp_f32 v147,v147
v_mfma_f32_16x16x32_bf16 a[56:59],a[168:171],v[168:171],a[56:59]
v_mfma_f32_16x16x32_bf16 a[60:63],a[172:175],v[168:171],a[60:63]
v_cvt_pk_bf16_f32 v180,v144,v145
v_cvt_pk_bf16_f32 v181,v146,v147
v_exp_f32 v148,v148
v_mfma_f32_16x16x32_bf16 a[60:63],a[252:255],v[172:175],a[60:63]
s_waitcnt lgkmcnt(0)
v_mfma_f32_16x16x32_bf16 v[128:131],a[112:115],v[64:67],v[188:191]
v_exp_f32 v149,v149
v_exp_f32 v150,v150
v_mfma_f32_16x16x32_bf16 v[128:131],a[116:119],v[68:71],v[128:131]
v_mfma_f32_16x16x32_bf16 v[128:131],a[120:123],v[72:75],v[128:131]
buffer_load_dwordx4 v227,s[16:19],s34 offen offset:2048 nt lds
v_exp_f32 v151,v151
v_mfma_f32_16x16x32_bf16 v[128:131],a[124:127],v[76:79],v[128:131]
v_mfma_f32_16x16x32_bf16 v[132:135],a[128:131],v[76:79],v[188:191]
v_cvt_pk_bf16_f32 v182,v148,v149
v_cvt_pk_bf16_f32 v183,v150,v151
v_xor_b32 v224,0x3c800,v224
v_mfma_f32_16x16x32_bf16 v[132:135],a[132:135],v[72:75],v[132:135]
v_mfma_f32_16x16x32_bf16 v[132:135],a[136:139],v[68:71],v[132:135]
v_mfma_f32_16x16x32_bf16 v[132:135],a[140:143],v[64:67],v[132:135]
v_mfma_f32_16x16x32_bf16 v[136:139],a[192:195],v[64:67],v[188:191]
v_exp_f32 v128,v128
v_exp_f32 v129,v129
v_mfma_f32_16x16x32_bf16 v[136:139],a[196:199],v[68:71],v[136:139]
v_mfma_f32_16x16x32_bf16 v[136:139],a[200:203],v[72:75],v[136:139]
P21:
s_cbranch_execz P149
v_exp_f32 v130,v130
v_mfma_f32_16x16x32_bf16 v[136:139],a[204:207],v[76:79],v[136:139]
v_mfma_f32_16x16x32_bf16 v[140:143],a[208:211],v[76:79],v[188:191]
v_exp_f32 v131,v131
v_cvt_pk_bf16_f32 v168,v128,v129
v_cvt_pk_bf16_f32 v169,v130,v131
v_mfma_f32_16x16x32_bf16 v[140:143],a[212:215],v[72:75],v[140:143]
v_mfma_f32_16x16x32_bf16 v[140:143],a[216:219],v[68:71],v[140:143]
v_exp_f32 v132,v132
v_exp_f32 v133,v133
v_mfma_f32_16x16x32_bf16 v[140:143],a[220:223],v[64:67],v[140:143]
v_mfma_f32_16x16x32_bf16 v[208:211],a[188:191],v[176:179],v[208:211]
v_exp_f32 v134,v134
v_exp_f32 v135,v135
v_mfma_f32_16x16x32_bf16 v[208:211],a[188:191],v[180:183],v[208:211]
v_mfma_f32_16x16x32_bf16 a[64:67],a[224:227],v[180:183],a[64:67]
v_cvt_pk_bf16_f32 v170,v132,v133
v_cvt_pk_bf16_f32 v171,v134,v135
v_mfma_f32_16x16x32_bf16 a[64:67],a[144:147],v[176:179],a[64:67]
ds_read_b64_tr_b16 a[144:145],v225
ds_read_b64_tr_b16 a[146:147],v225 offset:1024
v_mfma_f32_16x16x32_bf16 a[68:71],a[148:151],v[176:179],a[68:71]
ds_read_b64_tr_b16 a[148:149],v226
ds_read_b64_tr_b16 a[150:151],v226 offset:1024
v_mfma_f32_16x16x32_bf16 a[68:71],a[228:231],v[180:183],a[68:71]
buffer_load_dwordx4 v227,s[16:19],s34 offen offset:3072 nt lds
v_mfma_f32_16x16x32_bf16 a[72:75],a[232:235],v[180:183],a[72:75]
v_exp_f32 v136,v136
v_mfma_f32_16x16x32_bf16 a[72:75],a[152:155],v[176:179],a[72:75]
ds_read_b64_tr_b16 a[152:153],v225 offset:256
ds_read_b64_tr_b16 a[154:155],v225 offset:1280
v_mfma_f32_16x16x32_bf16 a[76:79],a[156:159],v[176:179],a[76:79]
v_exp_f32 v137,v137
v_mfma_f32_16x16x32_bf16 a[76:79],a[236:239],v[180:183],a[76:79]
ds_read_b64_tr_b16 a[156:157],v226 offset:256
ds_read_b64_tr_b16 a[158:159],v226 offset:1280
v_mfma_f32_16x16x32_bf16 a[80:83],a[240:243],v[180:183],a[80:83]
P22:
s_cbranch_execz P150
v_mfma_f32_16x16x32_bf16 a[80:83],a[160:163],v[176:179],a[80:83]
ds_read_b64_tr_b16 a[160:161],v225 offset:512
ds_read_b64_tr_b16 a[162:163],v225 offset:1536
v_mfma_f32_16x16x32_bf16 a[84:87],a[164:167],v[176:179],a[84:87]
s_add_u32 m0,s30,0
v_exp_f32 v138,v138
v_mfma_f32_16x16x32_bf16 a[84:87],a[244:247],v[180:183],a[84:87]
s_mov_b32 s34,65536
ds_read_b64_tr_b16 a[164:165],v226 offset:512
ds_read_b64_tr_b16 a[166:167],v226 offset:1536
v_mfma_f32_16x16x32_bf16 a[88:91],a[248:251],v[180:183],a[88:91]
v_exp_f32 v139,v139
v_mfma_f32_16x16x32_bf16 a[88:91],a[168:171],v[176:179],a[88:91]
ds_read_b64_tr_b16 a[168:169],v225 offset:768
ds_read_b64_tr_b16 a[170:171],v225 offset:1792
v_mfma_f32_16x16x32_bf16 a[92:95],a[172:175],v[176:179],a[92:95]
v_cvt_pk_bf16_f32 v172,v136,v137
v_cvt_pk_bf16_f32 v173,v138,v139
v_mfma_f32_16x16x32_bf16 a[92:95],a[252:255],v[180:183],a[92:95]
ds_read_b64_tr_b16 a[172:173],v226 offset:768
ds_read_b64_tr_b16 a[174:175],v226 offset:1792
v_mfma_f32_16x16x32_bf16 v[144:147],a[112:115],v[80:83],v[192:195]
v_xor_b32 v225,0x800,v225
v_xor_b32 v226,0x800,v226
v_mfma_f32_16x16x32_bf16 v[144:147],a[116:119],v[84:87],v[144:147]
ds_read_b64_tr_b16 a[224:225],v225
ds_read_b64_tr_b16 a[226:227],v225 offset:1024
v_mfma_f32_16x16x32_bf16 v[144:147],a[120:123],v[88:91],v[144:147]
buffer_load_dwordx4 v227,s[20:23],s34 offen nt lds
v_mfma_f32_16x16x32_bf16 v[144:147],a[124:127],v[92:95],v[144:147]
ds_read_b64_tr_b16 a[228:229],v226
ds_read_b64_tr_b16 a[230:231],v226 offset:1024
v_mfma_f32_16x16x32_bf16 v[148:151],a[128:131],v[92:95],v[192:195]
P23:
s_cbranch_execz P151
v_mfma_f32_16x16x32_bf16 v[148:151],a[132:135],v[88:91],v[148:151]
ds_read_b64_tr_b16 a[232:233],v225 offset:256
ds_read_b64_tr_b16 a[234:235],v225 offset:1280
v_mfma_f32_16x16x32_bf16 v[148:151],a[136:139],v[84:87],v[148:151]
v_exp_f32 v140,v140
v_mfma_f32_16x16x32_bf16 v[148:151],a[140:143],v[80:83],v[148:151]
ds_read_b64_tr_b16 a[236:237],v226 offset:256
ds_read_b64_tr_b16 a[238:239],v226 offset:1280
v_mfma_f32_16x16x32_bf16 v[128:131],a[192:195],v[80:83],v[192:195]
v_exp_f32 v141,v141
v_mfma_f32_16x16x32_bf16 v[128:131],a[196:199],v[84:87],v[128:131]
v_exp_f32 v142,v142
v_mfma_f32_16x16x32_bf16 v[128:131],a[200:203],v[88:91],v[128:131]
ds_read_b64_tr_b16 a[240:241],v225 offset:512
ds_read_b64_tr_b16 a[242:243],v225 offset:1536
v_mfma_f32_16x16x32_bf16 v[128:131],a[204:207],v[92:95],v[128:131]
v_exp_f32 v143,v143
v_mfma_f32_16x16x32_bf16 v[132:135],a[208:211],v[92:95],v[192:195]
ds_read_b64_tr_b16 a[244:245],v226 offset:512
v_cvt_pk_bf16_f32 v174,v140,v141
v_mfma_f32_16x16x32_bf16 v[132:135],a[212:215],v[88:91],v[132:135]
ds_read_b64_tr_b16 a[246:247],v226 offset:1536
v_cvt_pk_bf16_f32 v175,v142,v143
v_mfma_f32_16x16x32_bf16 v[132:135],a[216:219],v[84:87],v[132:135]
v_exp_f32 v144,v144
v_mfma_f32_16x16x32_bf16 v[132:135],a[220:223],v[80:83],v[132:135]
ds_read_b64_tr_b16 a[248:249],v225 offset:768
ds_read_b64_tr_b16 a[250:251],v225 offset:1792
v_mfma_f32_16x16x32_bf16 v[208:211],a[176:179],v[168:171],v[208:211]
v_exp_f32 v145,v145
v_mfma_f32_16x16x32_bf16 v[208:211],a[176:179],v[172:175],v[208:211]
s_waitcnt lgkmcnt(4)
ds_read_b64_tr_b16 a[252:253],v226 offset:768
ds_read_b64_tr_b16 a[254:255],v226 offset:1792
v_mfma_f32_16x16x32_bf16 v[0:3],a[224:227],v[172:175],v[0:3]
P24:
s_cbranch_execz P152
v_mfma_f32_16x16x32_bf16 v[0:3],a[144:147],v[168:171],v[0:3]
buffer_load_dwordx4 v227,s[20:23],s34 offen offset:1024 nt lds
v_mfma_f32_16x16x32_bf16 v[4:7],a[148:151],v[168:171],v[4:7]
v_exp_f32 v146,v146
v_mfma_f32_16x16x32_bf16 v[4:7],a[228:231],v[172:175],v[4:7]
v_exp_f32 v147,v147
v_mfma_f32_16x16x32_bf16 v[8:11],a[232:235],v[172:175],v[8:11]
v_cvt_pk_bf16_f32 v176,v144,v145
v_cvt_pk_bf16_f32 v177,v146,v147
v_mfma_f32_16x16x32_bf16 v[8:11],a[152:155],v[168:171],v[8:11]
v_exp_f32 v148,v148
v_mfma_f32_16x16x32_bf16 v[12:15],a[156:159],v[168:171],v[12:15]
v_exp_f32 v149,v149
v_mfma_f32_16x16x32_bf16 v[12:15],a[236:239],v[172:175],v[12:15]
v_exp_f32 v150,v150
v_mfma_f32_16x16x32_bf16 v[16:19],a[240:243],v[172:175],v[16:19]
v_exp_f32 v151,v151
v_mfma_f32_16x16x32_bf16 v[16:19],a[160:163],v[168:171],v[16:19]
v_cvt_pk_bf16_f32 v178,v148,v149
v_cvt_pk_bf16_f32 v179,v150,v151
v_mfma_f32_16x16x32_bf16 v[20:23],a[164:167],v[168:171],v[20:23]
s_waitcnt lgkmcnt(0)
v_exp_f32 v128,v128
v_mfma_f32_16x16x32_bf16 v[20:23],a[244:247],v[172:175],v[20:23]
v_exp_f32 v129,v129
v_mfma_f32_16x16x32_bf16 v[24:27],a[248:251],v[172:175],v[24:27]
v_exp_f32 v130,v130
v_mfma_f32_16x16x32_bf16 v[24:27],a[168:171],v[168:171],v[24:27]
v_exp_f32 v131,v131
v_mfma_f32_16x16x32_bf16 v[28:31],a[172:175],v[168:171],v[28:31]
v_cvt_pk_bf16_f32 v180,v128,v129
v_cvt_pk_bf16_f32 v181,v130,v131
v_mfma_f32_16x16x32_bf16 v[28:31],a[252:255],v[172:175],v[28:31]
v_exp_f32 v132,v132
v_mfma_f32_16x16x32_bf16 v[136:139],a[192:195],a[96:99],v[204:207]
v_exp_f32 v133,v133
v_mfma_f32_16x16x32_bf16 v[136:139],a[196:199],a[100:103],v[136:139]
P25:
s_cbranch_execz P153
v_mfma_f32_16x16x32_bf16 v[136:139],a[200:203],a[104:107],v[136:139]
buffer_load_dwordx4 v227,s[20:23],s34 offen offset:2048 nt lds
v_mfma_f32_16x16x32_bf16 v[136:139],a[204:207],a[108:111],v[136:139]
v_exp_f32 v134,v134
v_mfma_f32_16x16x32_bf16 v[140:143],a[208:211],a[108:111],v[204:207]
v_exp_f32 v135,v135
v_mfma_f32_16x16x32_bf16 v[140:143],a[212:215],a[104:107],v[140:143]
v_cvt_pk_bf16_f32 v182,v132,v133
v_cvt_pk_bf16_f32 v183,v134,v135
v_mfma_f32_16x16x32_bf16 v[140:143],a[216:219],a[100:103],v[140:143]
v_xor_b32 v225,0xc800,v225
v_xor_b32 v226,0xc800,v226
v_mfma_f32_16x16x32_bf16 v[140:143],a[220:223],a[96:99],v[140:143]
v_exp_f32 v136,v136
v_mfma_f32_16x16x32_bf16 v[208:211],a[180:183],v[176:179],v[208:211]
v_exp_f32 v137,v137
v_mfma_f32_16x16x32_bf16 v[208:211],a[180:183],v[180:183],v[208:211]
v_exp_f32 v138,v138
v_mfma_f32_16x16x32_bf16 v[32:35],a[224:227],v[180:183],v[32:35]
v_exp_f32 v139,v139
v_mfma_f32_16x16x32_bf16 v[32:35],a[144:147],v[176:179],v[32:35]
v_cvt_pk_bf16_f32 v184,v136,v137
v_cvt_pk_bf16_f32 v185,v138,v139
v_mfma_f32_16x16x32_bf16 v[36:39],a[148:151],v[176:179],v[36:39]
v_exp_f32 v140,v140
v_mfma_f32_16x16x32_bf16 v[36:39],a[228:231],v[180:183],v[36:39]
v_exp_f32 v141,v141
v_mfma_f32_16x16x32_bf16 v[40:43],a[232:235],v[180:183],v[40:43]
v_exp_f32 v142,v142
v_mfma_f32_16x16x32_bf16 v[40:43],a[152:155],v[176:179],v[40:43]
v_exp_f32 v143,v143
v_mfma_f32_16x16x32_bf16 v[44:47],a[156:159],v[176:179],v[44:47]
v_cvt_pk_bf16_f32 v186,v140,v141
v_cvt_pk_bf16_f32 v187,v142,v143
v_mfma_f32_16x16x32_bf16 v[44:47],a[236:239],v[180:183],v[44:47]
v_mfma_f32_16x16x32_bf16 v[48:51],a[240:243],v[180:183],v[48:51]
P26:
s_cbranch_execz P154
v_mfma_f32_16x16x32_bf16 v[48:51],a[160:163],v[176:179],v[48:51]
buffer_load_dwordx4 v227,s[20:23],s34 offen offset:3072 nt lds
v_mfma_f32_16x16x32_bf16 v[52:55],a[164:167],v[176:179],v[52:55]
v_mfma_f32_16x16x32_bf16 v[52:55],a[244:247],v[180:183],v[52:55]
v_mfma_f32_16x16x32_bf16 v[56:59],a[248:251],v[180:183],v[56:59]
v_mfma_f32_16x16x32_bf16 v[56:59],a[168:171],v[176:179],v[56:59]
v_mfma_f32_16x16x32_bf16 v[60:63],a[172:175],v[176:179],v[60:63]
v_mfma_f32_16x16x32_bf16 v[60:63],a[252:255],v[180:183],v[60:63]
v_mfma_f32_16x16x32_bf16 v[144:147],a[112:115],v[96:99],v[196:199]
v_mfma_f32_16x16x32_bf16 v[144:147],a[116:119],v[100:103],v[144:147]
v_mfma_f32_16x16x32_bf16 v[144:147],a[120:123],v[104:107],v[144:147]
v_mfma_f32_16x16x32_bf16 v[144:147],a[124:127],v[108:111],v[144:147]
v_mfma_f32_16x16x32_bf16 v[148:151],a[128:131],v[108:111],v[196:199]
v_mfma_f32_16x16x32_bf16 v[148:151],a[132:135],v[104:107],v[148:151]
v_mfma_f32_16x16x32_bf16 v[148:151],a[136:139],v[100:103],v[148:151]
v_mfma_f32_16x16x32_bf16 v[148:151],a[140:143],v[96:99],v[148:151]
v_mfma_f32_16x16x32_bf16 v[128:131],a[192:195],v[96:99],v[196:199]
v_mfma_f32_16x16x32_bf16 v[128:131],a[196:199],v[100:103],v[128:131]
v_mfma_f32_16x16x32_bf16 v[128:131],a[200:203],v[104:107],v[128:131]
v_mfma_f32_16x16x32_bf16 v[128:131],a[204:207],v[108:111],v[128:131]
v_exp_f32 v144,v144
v_mfma_f32_16x16x32_bf16 v[132:135],a[208:211],v[108:111],v[196:199]
v_exp_f32 v145,v145
v_mfma_f32_16x16x32_bf16 v[132:135],a[212:215],v[104:107],v[132:135]
v_exp_f32 v146,v146
v_mfma_f32_16x16x32_bf16 v[132:135],a[216:219],v[100:103],v[132:135]
v_exp_f32 v147,v147
v_mfma_f32_16x16x32_bf16 v[132:135],a[220:223],v[96:99],v[132:135]
v_cvt_pk_bf16_f32 v168,v144,v145
v_cvt_pk_bf16_f32 v169,v146,v147
v_mfma_f32_16x16x32_bf16 v[212:215],a[176:179],v[184:187],v[212:215]
v_exp_f32 v148,v148
v_mfma_f32_16x16x32_bf16 a[0:3],a[224:227],v[184:187],a[0:3]
v_exp_f32 v149,v149
v_mfma_f32_16x16x32_bf16 a[4:7],a[228:231],v[184:187],a[4:7]
P27:
s_cbranch_execz P155
Z1:
s_cbranch_execz Z5
v_mfma_f32_16x16x32_bf16 a[8:11],a[232:235],v[184:187],a[8:11]
s_add_u32 m0,s30,16384
v_exp_f32 v150,v150
v_mfma_f32_16x16x32_bf16 a[12:15],a[236:239],v[184:187],a[12:15]
s_mov_b32 s34,81920
v_exp_f32 v151,v151
v_mfma_f32_16x16x32_bf16 a[16:19],a[240:243],v[184:187],a[16:19]
v_cvt_pk_bf16_f32 v170,v148,v149
v_cvt_pk_bf16_f32 v171,v150,v151
v_mfma_f32_16x16x32_bf16 a[20:23],a[244:247],v[184:187],a[20:23]
v_exp_f32 v128,v128
v_mfma_f32_16x16x32_bf16 a[24:27],a[248:251],v[184:187],a[24:27]
s_waitcnt vmcnt(8) lgkmcnt(0)
s_barrier
v_mfma_f32_16x16x32_bf16 a[28:31],a[252:255],v[184:187],a[28:31]
v_exp_f32 v129,v129
v_mfma_f32_16x16x32_bf16 v[136:139],a[112:115],v[112:115],v[200:203]
v_exp_f32 v130,v130
v_mfma_f32_16x16x32_bf16 v[136:139],a[116:119],v[116:119],v[136:139]
v_exp_f32 v131,v131
v_mfma_f32_16x16x32_bf16 v[136:139],a[120:123],v[120:123],v[136:139]
buffer_load_dwordx4 v227,s[16:19],s34 offen nt lds
v_mfma_f32_16x16x32_bf16 v[136:139],a[124:127],v[124:127],v[136:139]
ds_read_b128 a[112:115],v224
v_cvt_pk_bf16_f32 v172,v128,v129
v_mfma_f32_16x16x32_bf16 v[140:143],a[128:131],v[124:127],v[200:203]
ds_read_b128 a[116:119],v224 offset:256
v_cvt_pk_bf16_f32 v173,v130,v131
v_mfma_f32_16x16x32_bf16 v[140:143],a[132:135],v[120:123],v[140:143]
v_exp_f32 v132,v132
v_mfma_f32_16x16x32_bf16 v[140:143],a[136:139],v[116:119],v[140:143]
v_exp_f32 v133,v133
v_mfma_f32_16x16x32_bf16 v[140:143],a[140:143],v[112:115],v[140:143]
v_exp_f32 v134,v134
v_mfma_f32_16x16x32_bf16 v[144:147],a[192:195],v[112:115],v[200:203]
v_exp_f32 v135,v135
v_mfma_f32_16x16x32_bf16 v[144:147],a[196:199],v[116:119],v[144:147]
P28:
s_cbranch_execz P156
v_mfma_f32_16x16x32_bf16 v[144:147],a[200:203],v[120:123],v[144:147]
ds_read_b128 a[120:123],v224 offset:512
v_cvt_pk_bf16_f32 v174,v132,v133
v_mfma_f32_16x16x32_bf16 v[144:147],a[204:207],v[124:127],v[144:147]
ds_read_b128 a[124:127],v224 offset:768
v_cvt_pk_bf16_f32 v175,v134,v135
v_mfma_f32_16x16x32_bf16 v[148:151],a[208:211],v[124:127],v[200:203]
v_exp_f32 v136,v136
v_mfma_f32_16x16x32_bf16 v[148:151],a[212:215],v[120:123],v[148:151]
ds_read_b128 a[128:131],v224 offset:1792
ds_read_b128 a[132:135],v224 offset:1536
v_mfma_f32_16x16x32_bf16 v[148:151],a[216:219],v[116:119],v[148:151]
v_exp_f32 v137,v137
v_mfma_f32_16x16x32_bf16 v[148:151],a[220:223],v[112:115],v[148:151]
ds_read_b128 a[136:139],v224 offset:1280
ds_read_b128 a[140:143],v224 offset:1024
v_mfma_f32_16x16x32_bf16 v[208:211],a[184:187],v[168:171],v[208:211]
v_exp_f32 v138,v138
v_mfma_f32_16x16x32_bf16 v[208:211],a[184:187],v[172:175],v[208:211]
v_exp_f32 v139,v139
v_mfma_f32_16x16x32_bf16 a[32:35],a[224:227],v[172:175],a[32:35]
v_xor_b32 v224,0x800,v224
v_cvt_pk_bf16_f32 v176,v136,v137
v_mfma_f32_16x16x32_bf16 a[32:35],a[144:147],v[168:171],a[32:35]
buffer_load_dwordx4 v227,s[16:19],s34 offen offset:1024 nt lds
v_mfma_f32_16x16x32_bf16 a[36:39],a[148:151],v[168:171],a[36:39]
ds_read_b128 a[192:195],v224
ds_read_b128 a[196:199],v224 offset:256
v_mfma_f32_16x16x32_bf16 a[36:39],a[228:231],v[172:175],a[36:39]
v_cvt_pk_bf16_f32 v177,v138,v139
v_mfma_f32_16x16x32_bf16 a[40:43],a[232:235],v[172:175],a[40:43]
ds_read_b128 a[200:203],v224 offset:512
ds_read_b128 a[204:207],v224 offset:768
v_mfma_f32_16x16x32_bf16 a[40:43],a[152:155],v[168:171],a[40:43]
P29:
s_cbranch_execz P157
v_mfma_f32_16x16x32_bf16 a[44:47],a[156:159],v[168:171],a[44:47]
v_exp_f32 v140,v140
v_mfma_f32_16x16x32_bf16 a[44:47],a[236:239],v[172:175],a[44:47]
ds_read_b128 a[208:211],v224 offset:1792
ds_read_b128 a[212:215],v224 offset:1536
v_mfma_f32_16x16x32_bf16 a[48:51],a[240:243],v[172:175],a[48:51]
v_exp_f32 v141,v141
v_mfma_f32_16x16x32_bf16 a[48:51],a[160:163],v[168:171],a[48:51]
v_exp_f32 v142,v142
v_mfma_f32_16x16x32_bf16 a[52:55],a[164:167],v[168:171],a[52:55]
ds_read_b128 a[216:219],v224 offset:1280
ds_read_b128 a[220:223],v224 offset:1024
v_mfma_f32_16x16x32_bf16 a[52:55],a[244:247],v[172:175],a[52:55]
v_exp_f32 v143,v143
v_mfma_f32_16x16x32_bf16 a[56:59],a[248:251],v[172:175],a[56:59]
v_cvt_pk_bf16_f32 v178,v140,v141
v_cvt_pk_bf16_f32 v179,v142,v143
v_mfma_f32_16x16x32_bf16 a[56:59],a[168:171],v[168:171],a[56:59]
v_exp_f32 v144,v144
v_mfma_f32_16x16x32_bf16 a[60:63],a[172:175],v[168:171],a[60:63]
v_exp_f32 v145,v145
v_mfma_f32_16x16x32_bf16 a[60:63],a[252:255],v[172:175],a[60:63]
s_waitcnt lgkmcnt(2)
v_exp_f32 v146,v146
v_mfma_f32_16x16x32_bf16 v[128:131],a[112:115],v[64:67],v[188:191]
v_exp_f32 v147,v147
v_mfma_f32_16x16x32_bf16 v[128:131],a[116:119],v[68:71],v[128:131]
v_cvt_pk_bf16_f32 v180,v144,v145
v_cvt_pk_bf16_f32 v181,v146,v147
v_mfma_f32_16x16x32_bf16 v[128:131],a[120:123],v[72:75],v[128:131]
buffer_load_dwordx4 v227,s[16:19],s34 offen offset:2048 nt lds
v_mfma_f32_16x16x32_bf16 v[128:131],a[124:127],v[76:79],v[128:131]
v_exp_f32 v148,v148
v_mfma_f32_16x16x32_bf16 v[132:135],a[128:131],v[76:79],v[188:191]
v_exp_f32 v149,v149
v_mfma_f32_16x16x32_bf16 v[132:135],a[132:135],v[72:75],v[132:135]
P30:
s_cbranch_execz P158
v_mfma_f32_16x16x32_bf16 v[132:135],a[136:139],v[68:71],v[132:135]
v_exp_f32 v150,v150
v_mfma_f32_16x16x32_bf16 v[132:135],a[140:143],v[64:67],v[132:135]
v_exp_f32 v151,v151
v_mfma_f32_16x16x32_bf16 v[136:139],a[192:195],v[64:67],v[188:191]
v_cvt_pk_bf16_f32 v182,v148,v149
v_cvt_pk_bf16_f32 v183,v150,v151
v_mfma_f32_16x16x32_bf16 v[136:139],a[196:199],v[68:71],v[136:139]
v_exp_f32 v128,v128
v_mfma_f32_16x16x32_bf16 v[136:139],a[200:203],v[72:75],v[136:139]
v_exp_f32 v129,v129
v_mfma_f32_16x16x32_bf16 v[136:139],a[204:207],v[76:79],v[136:139]
v_exp_f32 v130,v130
v_mfma_f32_16x16x32_bf16 v[140:143],a[208:211],v[76:79],v[188:191]
v_exp_f32 v131,v131
v_mfma_f32_16x16x32_bf16 v[140:143],a[212:215],v[72:75],v[140:143]
s_waitcnt lgkmcnt(0)
v_cvt_pk_bf16_f32 v168,v128,v129
v_cvt_pk_bf16_f32 v169,v130,v131
v_mfma_f32_16x16x32_bf16 v[140:143],a[216:219],v[68:71],v[140:143]
v_exp_f32 v132,v132
v_mfma_f32_16x16x32_bf16 v[140:143],a[220:223],v[64:67],v[140:143]
v_exp_f32 v133,v133
v_mfma_f32_16x16x32_bf16 v[208:211],a[188:191],v[176:179],v[208:211]
v_exp_f32 v134,v134
v_mfma_f32_16x16x32_bf16 v[208:211],a[188:191],v[180:183],v[208:211]
v_exp_f32 v135,v135
v_mfma_f32_16x16x32_bf16 a[64:67],a[224:227],v[180:183],a[64:67]
v_cvt_pk_bf16_f32 v170,v132,v133
v_cvt_pk_bf16_f32 v171,v134,v135
v_mfma_f32_16x16x32_bf16 a[64:67],a[144:147],v[176:179],a[64:67]
ds_read_b64_tr_b16 a[144:145],v225
ds_read_b64_tr_b16 a[146:147],v225 offset:1024
v_mfma_f32_16x16x32_bf16 a[68:71],a[148:151],v[176:179],a[68:71]
ds_read_b64_tr_b16 a[148:149],v226
ds_read_b64_tr_b16 a[150:151],v226 offset:1024
v_mfma_f32_16x16x32_bf16 a[68:71],a[228:231],v[180:183],a[68:71]
buffer_load_dwordx4 v227,s[16:19],s34 offen offset:3072 nt lds
v_mfma_f32_16x16x32_bf16 a[72:75],a[232:235],v[180:183],a[72:75]
P31:
s_cbranch_execz P159
v_mfma_f32_16x16x32_bf16 a[72:75],a[152:155],v[176:179],a[72:75]
ds_read_b64_tr_b16 a[152:153],v225 offset:256
ds_read_b64_tr_b16 a[154:155],v225 offset:1280
v_mfma_f32_16x16x32_bf16 a[76:79],a[156:159],v[176:179],a[76:79]
v_exp_f32 v136,v136
v_mfma_f32_16x16x32_bf16 a[76:79],a[236:239],v[180:183],a[76:79]
ds_read_b64_tr_b16 a[156:157],v226 offset:256
ds_read_b64_tr_b16 a[158:159],v226 offset:1280
v_mfma_f32_16x16x32_bf16 a[80:83],a[240:243],v[180:183],a[80:83]
v_exp_f32 v137,v137
v_mfma_f32_16x16x32_bf16 a[80:83],a[160:163],v[176:179],a[80:83]
ds_read_b64_tr_b16 a[160:161],v225 offset:512
ds_read_b64_tr_b16 a[162:163],v225 offset:1536
v_mfma_f32_16x16x32_bf16 a[84:87],a[164:167],v[176:179],a[84:87]
s_add_u32 m0,s30,32768
v_exp_f32 v138,v138
v_mfma_f32_16x16x32_bf16 a[84:87],a[244:247],v[180:183],a[84:87]
s_mov_b32 s34,81920
ds_read_b64_tr_b16 a[164:165],v226 offset:512
ds_read_b64_tr_b16 a[166:167],v226 offset:1536
v_mfma_f32_16x16x32_bf16 a[88:91],a[248:251],v[180:183],a[88:91]
v_exp_f32 v139,v139
v_mfma_f32_16x16x32_bf16 a[88:91],a[168:171],v[176:179],a[88:91]
ds_read_b64_tr_b16 a[168:169],v225 offset:768
ds_read_b64_tr_b16 a[170:171],v225 offset:1792
v_mfma_f32_16x16x32_bf16 a[92:95],a[172:175],v[176:179],a[92:95]
v_cvt_pk_bf16_f32 v172,v136,v137
v_cvt_pk_bf16_f32 v173,v138,v139
v_mfma_f32_16x16x32_bf16 a[92:95],a[252:255],v[180:183],a[92:95]
ds_read_b64_tr_b16 a[172:173],v226 offset:768
ds_read_b64_tr_b16 a[174:175],v226 offset:1792
v_mfma_f32_16x16x32_bf16 v[144:147],a[112:115],v[80:83],v[192:195]
P32:
s_cbranch_execz P160
v_mfma_f32_16x16x32_bf16 v[144:147],a[116:119],v[84:87],v[144:147]
v_xor_b32 v225,0x800,v225
v_xor_b32 v226,0x800,v226
v_mfma_f32_16x16x32_bf16 v[144:147],a[120:123],v[88:91],v[144:147]
ds_read_b64_tr_b16 a[224:225],v225
ds_read_b64_tr_b16 a[226:227],v225 offset:1024
v_mfma_f32_16x16x32_bf16 v[144:147],a[124:127],v[92:95],v[144:147]
buffer_load_dwordx4 v227,s[20:23],s34 offen nt lds
v_mfma_f32_16x16x32_bf16 v[148:151],a[128:131],v[92:95],v[192:195]
ds_read_b64_tr_b16 a[228:229],v226
ds_read_b64_tr_b16 a[230:231],v226 offset:1024
v_mfma_f32_16x16x32_bf16 v[148:151],a[132:135],v[88:91],v[148:151]
v_exp_f32 v140,v140
v_mfma_f32_16x16x32_bf16 v[148:151],a[136:139],v[84:87],v[148:151]
ds_read_b64_tr_b16 a[232:233],v225 offset:256
ds_read_b64_tr_b16 a[234:235],v225 offset:1280
v_mfma_f32_16x16x32_bf16 v[148:151],a[140:143],v[80:83],v[148:151]
v_exp_f32 v141,v141
v_mfma_f32_16x16x32_bf16 v[128:131],a[192:195],v[80:83],v[192:195]
ds_read_b64_tr_b16 a[236:237],v226 offset:256
ds_read_b64_tr_b16 a[238:239],v226 offset:1280
v_mfma_f32_16x16x32_bf16 v[128:131],a[196:199],v[84:87],v[128:131]
v_exp_f32 v142,v142
v_mfma_f32_16x16x32_bf16 v[128:131],a[200:203],v[88:91],v[128:131]
ds_read_b64_tr_b16 a[240:241],v225 offset:512
ds_read_b64_tr_b16 a[242:243],v225 offset:1536
v_mfma_f32_16x16x32_bf16 v[128:131],a[204:207],v[92:95],v[128:131]
v_exp_f32 v143,v143
v_mfma_f32_16x16x32_bf16 v[132:135],a[208:211],v[92:95],v[192:195]
ds_read_b64_tr_b16 a[244:245],v226 offset:512
v_cvt_pk_bf16_f32 v174,v140,v141
v_mfma_f32_16x16x32_bf16 v[132:135],a[212:215],v[88:91],v[132:135]
ds_read_b64_tr_b16 a[246:247],v226 offset:1536
v_cvt_pk_bf16_f32 v175,v142,v143
v_mfma_f32_16x16x32_bf16 v[132:135],a[216:219],v[84:87],v[132:135]
P33:
s_cbranch_execz P161
v_mfma_f32_16x16x32_bf16 v[132:135],a[220:223],v[80:83],v[132:135]
ds_read_b64_tr_b16 a[248:249],v225 offset:768
ds_read_b64_tr_b16 a[250:251],v225 offset:1792
v_mfma_f32_16x16x32_bf16 v[208:211],a[176:179],v[168:171],v[208:211]
v_exp_f32 v144,v144
v_mfma_f32_16x16x32_bf16 v[208:211],a[176:179],v[172:175],v[208:211]
s_waitcnt lgkmcnt(4)
ds_read_b64_tr_b16 a[252:253],v226 offset:768
ds_read_b64_tr_b16 a[254:255],v226 offset:1792
v_mfma_f32_16x16x32_bf16 v[0:3],a[224:227],v[172:175],v[0:3]
v_exp_f32 v145,v145
v_mfma_f32_16x16x32_bf16 v[0:3],a[144:147],v[168:171],v[0:3]
buffer_load_dwordx4 v227,s[20:23],s34 offen offset:1024 nt lds
v_mfma_f32_16x16x32_bf16 v[4:7],a[148:151],v[168:171],v[4:7]
v_exp_f32 v146,v146
v_mfma_f32_16x16x32_bf16 v[4:7],a[228:231],v[172:175],v[4:7]
v_exp_f32 v147,v147
v_mfma_f32_16x16x32_bf16 v[8:11],a[232:235],v[172:175],v[8:11]
v_cvt_pk_bf16_f32 v176,v144,v145
v_cvt_pk_bf16_f32 v177,v146,v147
v_mfma_f32_16x16x32_bf16 v[8:11],a[152:155],v[168:171],v[8:11]
v_exp_f32 v148,v148
v_mfma_f32_16x16x32_bf16 v[12:15],a[156:159],v[168:171],v[12:15]
v_exp_f32 v149,v149
v_mfma_f32_16x16x32_bf16 v[12:15],a[236:239],v[172:175],v[12:15]
v_exp_f32 v150,v150
v_mfma_f32_16x16x32_bf16 v[16:19],a[240:243],v[172:175],v[16:19]
v_exp_f32 v151,v151
v_mfma_f32_16x16x32_bf16 v[16:19],a[160:163],v[168:171],v[16:19]
v_cvt_pk_bf16_f32 v178,v148,v149
v_cvt_pk_bf16_f32 v179,v150,v151
v_mfma_f32_16x16x32_bf16 v[20:23],a[164:167],v[168:171],v[20:23]
s_waitcnt lgkmcnt(0)
v_exp_f32 v128,v128
v_mfma_f32_16x16x32_bf16 v[20:23],a[244:247],v[172:175],v[20:23]
P34:
s_cbranch_execz P162
v_mfma_f32_16x16x32_bf16 v[24:27],a[248:251],v[172:175],v[24:27]
v_exp_f32 v129,v129
v_mfma_f32_16x16x32_bf16 v[24:27],a[168:171],v[168:171],v[24:27]
v_exp_f32 v130,v130
v_mfma_f32_16x16x32_bf16 v[28:31],a[172:175],v[168:171],v[28:31]
v_exp_f32 v131,v131
v_mfma_f32_16x16x32_bf16 v[28:31],a[252:255],v[172:175],v[28:31]
v_cvt_pk_bf16_f32 v180,v128,v129
v_cvt_pk_bf16_f32 v181,v130,v131
v_mfma_f32_16x16x32_bf16 v[136:139],a[192:195],a[96:99],v[204:207]
v_exp_f32 v132,v132
v_mfma_f32_16x16x32_bf16 v[136:139],a[196:199],a[100:103],v[136:139]
v_exp_f32 v133,v133
v_mfma_f32_16x16x32_bf16 v[136:139],a[200:203],a[104:107],v[136:139]
buffer_load_dwordx4 v227,s[20:23],s34 offen offset:2048 nt lds
v_mfma_f32_16x16x32_bf16 v[136:139],a[204:207],a[108:111],v[136:139]
v_exp_f32 v134,v134
v_mfma_f32_16x16x32_bf16 v[140:143],a[208:211],a[108:111],v[204:207]
v_exp_f32 v135,v135
v_mfma_f32_16x16x32_bf16 v[140:143],a[212:215],a[104:107],v[140:143]
v_cvt_pk_bf16_f32 v182,v132,v133
v_cvt_pk_bf16_f32 v183,v134,v135
v_mfma_f32_16x16x32_bf16 v[140:143],a[216:219],a[100:103],v[140:143]
buffer_load_dwordx4 v[240:243],v228,s[12:15],s64 offen nt
v_mfma_f32_16x16x32_bf16 v[140:143],a[220:223],a[96:99],v[140:143]
v_exp_f32 v136,v136
v_mfma_f32_16x16x32_bf16 v[208:211],a[180:183],v[176:179],v[208:211]
v_exp_f32 v137,v137
v_mfma_f32_16x16x32_bf16 v[208:211],a[180:183],v[180:183],v[208:211]
v_exp_f32 v138,v138
v_mfma_f32_16x16x32_bf16 v[32:35],a[224:227],v[180:183],v[32:35]
v_exp_f32 v139,v139
v_mfma_f32_16x16x32_bf16 v[32:35],a[144:147],v[176:179],v[32:35]
v_cvt_pk_bf16_f32 v184,v136,v137
v_cvt_pk_bf16_f32 v185,v138,v139
v_mfma_f32_16x16x32_bf16 v[36:39],a[148:151],v[176:179],v[36:39]
v_exp_f32 v140,v140
v_mfma_f32_16x16x32_bf16 v[36:39],a[228:231],v[180:183],v[36:39]
P35:
s_cbranch_execz P163
v_mfma_f32_16x16x32_bf16 v[40:43],a[232:235],v[180:183],v[40:43]
v_exp_f32 v141,v141
v_mfma_f32_16x16x32_bf16 v[40:43],a[152:155],v[176:179],v[40:43]
v_exp_f32 v142,v142
v_mfma_f32_16x16x32_bf16 v[44:47],a[156:159],v[176:179],v[44:47]
v_exp_f32 v143,v143
v_mfma_f32_16x16x32_bf16 v[44:47],a[236:239],v[180:183],v[44:47]
v_cvt_pk_bf16_f32 v186,v140,v141
v_cvt_pk_bf16_f32 v187,v142,v143
v_mfma_f32_16x16x32_bf16 v[48:51],a[240:243],v[180:183],v[48:51]
v_xor_b32 v224,0xc800,v224
v_xor_b32 v225,0x10800,v225
v_mfma_f32_16x16x32_bf16 v[48:51],a[160:163],v[176:179],v[48:51]
buffer_load_dwordx4 v227,s[20:23],s34 offen offset:3072 nt lds
v_mfma_f32_16x16x32_bf16 v[52:55],a[164:167],v[176:179],v[52:55]
v_xor_b32 v226,0x10800,v226
v_mfma_f32_16x16x32_bf16 v[52:55],a[244:247],v[180:183],v[52:55]
v_mfma_f32_16x16x32_bf16 v[56:59],a[248:251],v[180:183],v[56:59]
v_mfma_f32_16x16x32_bf16 v[56:59],a[168:171],v[176:179],v[56:59]
v_mfma_f32_16x16x32_bf16 v[60:63],a[172:175],v[176:179],v[60:63]
v_mfma_f32_16x16x32_bf16 v[60:63],a[252:255],v[180:183],v[60:63]
v_mfma_f32_16x16x32_bf16 v[144:147],a[112:115],v[96:99],v[196:199]
v_mfma_f32_16x16x32_bf16 v[144:147],a[116:119],v[100:103],v[144:147]
v_mfma_f32_16x16x32_bf16 v[144:147],a[120:123],v[104:107],v[144:147]
v_mfma_f32_16x16x32_bf16 v[144:147],a[124:127],v[108:111],v[144:147]
v_mfma_f32_16x16x32_bf16 v[148:151],a[128:131],v[108:111],v[196:199]
v_mfma_f32_16x16x32_bf16 v[148:151],a[132:135],v[104:107],v[148:151]
v_mfma_f32_16x16x32_bf16 v[148:151],a[136:139],v[100:103],v[148:151]
buffer_load_dwordx4 v[244:247],v228,s[12:15],s64 offen offset:1024 nt
v_mfma_f32_16x16x32_bf16 v[148:151],a[140:143],v[96:99],v[148:151]
v_mfma_f32_16x16x32_bf16 v[128:131],a[192:195],v[96:99],v[196:199]
v_mfma_f32_16x16x32_bf16 v[128:131],a[196:199],v[100:103],v[128:131]
v_mfma_f32_16x16x32_bf16 v[128:131],a[200:203],v[104:107],v[128:131]
P36:
s_cbranch_execz P164
v_mfma_f32_16x16x32_bf16 v[128:131],a[204:207],v[108:111],v[128:131]
v_exp_f32 v144,v144
v_mfma_f32_16x16x32_bf16 v[132:135],a[208:211],v[108:111],v[196:199]
v_exp_f32 v145,v145
v_mfma_f32_16x16x32_bf16 v[132:135],a[212:215],v[104:107],v[132:135]
v_exp_f32 v146,v146
v_mfma_f32_16x16x32_bf16 v[132:135],a[216:219],v[100:103],v[132:135]
v_exp_f32 v147,v147
v_mfma_f32_16x16x32_bf16 v[132:135],a[220:223],v[96:99],v[132:135]
v_cvt_pk_bf16_f32 v168,v144,v145
v_cvt_pk_bf16_f32 v169,v146,v147
v_mfma_f32_16x16x32_bf16 v[212:215],a[176:179],v[184:187],v[212:215]
v_exp_f32 v148,v148
v_mfma_f32_16x16x32_bf16 a[0:3],a[224:227],v[184:187],a[0:3]
v_exp_f32 v149,v149
v_mfma_f32_16x16x32_bf16 a[4:7],a[228:231],v[184:187],a[4:7]
v_exp_f32 v150,v150
v_mfma_f32_16x16x32_bf16 a[8:11],a[232:235],v[184:187],a[8:11]
s_add_u32 m0,s30,49152
v_exp_f32 v151,v151
v_mfma_f32_16x16x32_bf16 a[12:15],a[236:239],v[184:187],a[12:15]
s_mov_b32 s34,98304
v_cvt_pk_bf16_f32 v170,v148,v149
v_cvt_pk_bf16_f32 v171,v150,v151
v_mfma_f32_16x16x32_bf16 a[16:19],a[240:243],v[184:187],a[16:19]
v_exp_f32 v128,v128
v_mfma_f32_16x16x32_bf16 a[20:23],a[244:247],v[184:187],a[20:23]
v_exp_f32 v129,v129
v_mfma_f32_16x16x32_bf16 a[24:27],a[248:251],v[184:187],a[24:27]
s_waitcnt vmcnt(10) lgkmcnt(0)
s_barrier
v_mfma_f32_16x16x32_bf16 a[28:31],a[252:255],v[184:187],a[28:31]
v_exp_f32 v130,v130
v_mfma_f32_16x16x32_bf16 v[136:139],a[112:115],v[112:115],v[200:203]
v_exp_f32 v131,v131
v_mfma_f32_16x16x32_bf16 v[136:139],a[116:119],v[116:119],v[136:139]
ds_read_b128 a[112:115],v224
v_cvt_pk_bf16_f32 v172,v128,v129
v_mfma_f32_16x16x32_bf16 v[136:139],a[120:123],v[120:123],v[136:139]
P37:
s_cbranch_execz P165
v_mfma_f32_16x16x32_bf16 v[136:139],a[124:127],v[124:127],v[136:139]
buffer_load_dwordx4 v227,s[16:19],s34 offen nt lds
v_mfma_f32_16x16x32_bf16 v[140:143],a[128:131],v[124:127],v[200:203]
ds_read_b128 a[116:119],v224 offset:256
v_cvt_pk_bf16_f32 v173,v130,v131
v_mfma_f32_16x16x32_bf16 v[140:143],a[132:135],v[120:123],v[140:143]
v_exp_f32 v132,v132
v_mfma_f32_16x16x32_bf16 v[140:143],a[136:139],v[116:119],v[140:143]
v_exp_f32 v133,v133
v_mfma_f32_16x16x32_bf16 v[140:143],a[140:143],v[112:115],v[140:143]
v_exp_f32 v134,v134
v_mfma_f32_16x16x32_bf16 v[144:147],a[192:195],v[112:115],v[200:203]
v_exp_f32 v135,v135
v_mfma_f32_16x16x32_bf16 v[144:147],a[196:199],v[116:119],v[144:147]
ds_read_b128 a[120:123],v224 offset:512
v_cvt_pk_bf16_f32 v174,v132,v133
v_mfma_f32_16x16x32_bf16 v[144:147],a[200:203],v[120:123],v[144:147]
ds_read_b128 a[124:127],v224 offset:768
v_cvt_pk_bf16_f32 v175,v134,v135
v_mfma_f32_16x16x32_bf16 v[144:147],a[204:207],v[124:127],v[144:147]
v_exp_f32 v136,v136
v_mfma_f32_16x16x32_bf16 v[148:151],a[208:211],v[124:127],v[200:203]
ds_read_b128 a[128:131],v224 offset:1792
ds_read_b128 a[132:135],v224 offset:1536
v_mfma_f32_16x16x32_bf16 v[148:151],a[212:215],v[120:123],v[148:151]
v_exp_f32 v137,v137
v_mfma_f32_16x16x32_bf16 v[148:151],a[216:219],v[116:119],v[148:151]
ds_read_b128 a[136:139],v224 offset:1280
ds_read_b128 a[140:143],v224 offset:1024
v_mfma_f32_16x16x32_bf16 v[148:151],a[220:223],v[112:115],v[148:151]
v_exp_f32 v138,v138
v_mfma_f32_16x16x32_bf16 v[208:211],a[184:187],v[168:171],v[208:211]
v_exp_f32 v139,v139
v_mfma_f32_16x16x32_bf16 v[208:211],a[184:187],v[172:175],v[208:211]
v_xor_b32 v224,0x800,v224
v_cvt_pk_bf16_f32 v176,v136,v137
v_mfma_f32_16x16x32_bf16 a[32:35],a[224:227],v[172:175],a[32:35]
P38:
s_cbranch_execz P166
v_mfma_f32_16x16x32_bf16 a[32:35],a[144:147],v[168:171],a[32:35]
buffer_load_dwordx4 v227,s[16:19],s34 offen offset:1024 nt lds
v_mfma_f32_16x16x32_bf16 a[36:39],a[148:151],v[168:171],a[36:39]
ds_read_b128 a[192:195],v224
ds_read_b128 a[196:199],v224 offset:256
v_mfma_f32_16x16x32_bf16 a[36:39],a[228:231],v[172:175],a[36:39]
v_cvt_pk_bf16_f32 v177,v138,v139
v_mfma_f32_16x16x32_bf16 a[40:43],a[232:235],v[172:175],a[40:43]
ds_read_b128 a[200:203],v224 offset:512
ds_read_b128 a[204:207],v224 offset:768
v_mfma_f32_16x16x32_bf16 a[40:43],a[152:155],v[168:171],a[40:43]
v_exp_f32 v140,v140
v_mfma_f32_16x16x32_bf16 a[44:47],a[156:159],v[168:171],a[44:47]
ds_read_b128 a[208:211],v224 offset:1792
ds_read_b128 a[212:215],v224 offset:1536
v_mfma_f32_16x16x32_bf16 a[44:47],a[236:239],v[172:175],a[44:47]
v_exp_f32 v141,v141
v_mfma_f32_16x16x32_bf16 a[48:51],a[240:243],v[172:175],a[48:51]
v_exp_f32 v142,v142
v_mfma_f32_16x16x32_bf16 a[48:51],a[160:163],v[168:171],a[48:51]
ds_read_b128 a[216:219],v224 offset:1280
ds_read_b128 a[220:223],v224 offset:1024
v_mfma_f32_16x16x32_bf16 a[52:55],a[164:167],v[168:171],a[52:55]
v_exp_f32 v143,v143
v_mfma_f32_16x16x32_bf16 a[52:55],a[244:247],v[172:175],a[52:55]
v_cvt_pk_bf16_f32 v178,v140,v141
v_cvt_pk_bf16_f32 v179,v142,v143
v_mfma_f32_16x16x32_bf16 a[56:59],a[248:251],v[172:175],a[56:59]
v_exp_f32 v144,v144
v_mfma_f32_16x16x32_bf16 a[56:59],a[168:171],v[168:171],a[56:59]
v_exp_f32 v145,v145
v_mfma_f32_16x16x32_bf16 a[60:63],a[172:175],v[168:171],a[60:63]
P39:
s_cbranch_execz P167
v_mfma_f32_16x16x32_bf16 a[60:63],a[252:255],v[172:175],a[60:63]
s_waitcnt lgkmcnt(0)
v_exp_f32 v146,v146
v_mfma_f32_16x16x32_bf16 v[128:131],a[112:115],v[64:67],v[188:191]
v_exp_f32 v147,v147
v_mfma_f32_16x16x32_bf16 v[128:131],a[116:119],v[68:71],v[128:131]
v_cvt_pk_bf16_f32 v180,v144,v145
v_cvt_pk_bf16_f32 v181,v146,v147
v_mfma_f32_16x16x32_bf16 v[128:131],a[120:123],v[72:75],v[128:131]
buffer_load_dwordx4 v227,s[16:19],s34 offen offset:2048 nt lds
v_mfma_f32_16x16x32_bf16 v[128:131],a[124:127],v[76:79],v[128:131]
v_exp_f32 v148,v148
v_mfma_f32_16x16x32_bf16 v[132:135],a[128:131],v[76:79],v[188:191]
v_exp_f32 v149,v149
v_mfma_f32_16x16x32_bf16 v[132:135],a[132:135],v[72:75],v[132:135]
v_exp_f32 v150,v150
v_mfma_f32_16x16x32_bf16 v[132:135],a[136:139],v[68:71],v[132:135]
v_exp_f32 v151,v151
v_mfma_f32_16x16x32_bf16 v[132:135],a[140:143],v[64:67],v[132:135]
v_cvt_pk_bf16_f32 v182,v148,v149
v_cvt_pk_bf16_f32 v183,v150,v151
v_mfma_f32_16x16x32_bf16 v[136:139],a[192:195],v[64:67],v[188:191]
v_exp_f32 v128,v128
v_mfma_f32_16x16x32_bf16 v[136:139],a[196:199],v[68:71],v[136:139]
v_exp_f32 v129,v129
v_mfma_f32_16x16x32_bf16 v[136:139],a[200:203],v[72:75],v[136:139]
v_exp_f32 v130,v130
v_mfma_f32_16x16x32_bf16 v[136:139],a[204:207],v[76:79],v[136:139]
v_exp_f32 v131,v131
v_mfma_f32_16x16x32_bf16 v[140:143],a[208:211],v[76:79],v[188:191]
v_cvt_pk_bf16_f32 v168,v128,v129
v_cvt_pk_bf16_f32 v169,v130,v131
v_mfma_f32_16x16x32_bf16 v[140:143],a[212:215],v[72:75],v[140:143]
v_exp_f32 v132,v132
v_mfma_f32_16x16x32_bf16 v[140:143],a[216:219],v[68:71],v[140:143]
v_exp_f32 v133,v133
v_mfma_f32_16x16x32_bf16 v[140:143],a[220:223],v[64:67],v[140:143]
v_exp_f32 v134,v134
v_mfma_f32_16x16x32_bf16 v[208:211],a[188:191],v[176:179],v[208:211]
P40:
s_cbranch_execz P168
v_mfma_f32_16x16x32_bf16 v[208:211],a[188:191],v[180:183],v[208:211]
v_exp_f32 v135,v135
v_mfma_f32_16x16x32_bf16 a[64:67],a[224:227],v[180:183],a[64:67]
v_cvt_pk_bf16_f32 v170,v132,v133
v_cvt_pk_bf16_f32 v171,v134,v135
v_mfma_f32_16x16x32_bf16 a[64:67],a[144:147],v[176:179],a[64:67]
ds_read_b64_tr_b16 a[144:145],v225
ds_read_b64_tr_b16 a[146:147],v225 offset:1024
v_mfma_f32_16x16x32_bf16 a[68:71],a[148:151],v[176:179],a[68:71]
ds_read_b64_tr_b16 a[148:149],v226
ds_read_b64_tr_b16 a[150:151],v226 offset:1024
v_mfma_f32_16x16x32_bf16 a[68:71],a[228:231],v[180:183],a[68:71]
buffer_load_dwordx4 v227,s[16:19],s34 offen offset:3072 nt lds
v_mfma_f32_16x16x32_bf16 a[72:75],a[232:235],v[180:183],a[72:75]
v_exp_f32 v136,v136
v_mfma_f32_16x16x32_bf16 a[72:75],a[152:155],v[176:179],a[72:75]
ds_read_b64_tr_b16 a[152:153],v225 offset:256
ds_read_b64_tr_b16 a[154:155],v225 offset:1280
v_mfma_f32_16x16x32_bf16 a[76:79],a[156:159],v[176:179],a[76:79]
v_exp_f32 v137,v137
v_mfma_f32_16x16x32_bf16 a[76:79],a[236:239],v[180:183],a[76:79]
ds_read_b64_tr_b16 a[156:157],v226 offset:256
ds_read_b64_tr_b16 a[158:159],v226 offset:1280
v_mfma_f32_16x16x32_bf16 a[80:83],a[240:243],v[180:183],a[80:83]
v_exp_f32 v138,v138
v_mfma_f32_16x16x32_bf16 a[80:83],a[160:163],v[176:179],a[80:83]
ds_read_b64_tr_b16 a[160:161],v225 offset:512
ds_read_b64_tr_b16 a[162:163],v225 offset:1536
v_mfma_f32_16x16x32_bf16 a[84:87],a[164:167],v[176:179],a[84:87]
s_add_u32 m0,s30,65536
v_exp_f32 v139,v139
v_mfma_f32_16x16x32_bf16 a[84:87],a[244:247],v[180:183],a[84:87]
s_mov_b32 s34,98304
ds_read_b64_tr_b16 a[164:165],v226 offset:512
ds_read_b64_tr_b16 a[166:167],v226 offset:1536
v_mfma_f32_16x16x32_bf16 a[88:91],a[248:251],v[180:183],a[88:91]
P41:
s_cbranch_execz P169
v_mfma_f32_16x16x32_bf16 a[88:91],a[168:171],v[176:179],a[88:91]
ds_read_b64_tr_b16 a[168:169],v225 offset:768
ds_read_b64_tr_b16 a[170:171],v225 offset:1792
v_mfma_f32_16x16x32_bf16 a[92:95],a[172:175],v[176:179],a[92:95]
v_cvt_pk_bf16_f32 v172,v136,v137
v_cvt_pk_bf16_f32 v173,v138,v139
v_mfma_f32_16x16x32_bf16 a[92:95],a[252:255],v[180:183],a[92:95]
ds_read_b64_tr_b16 a[172:173],v226 offset:768
ds_read_b64_tr_b16 a[174:175],v226 offset:1792
v_mfma_f32_16x16x32_bf16 v[144:147],a[112:115],v[80:83],v[192:195]
v_xor_b32 v225,0x800,v225
v_xor_b32 v226,0x800,v226
v_mfma_f32_16x16x32_bf16 v[144:147],a[116:119],v[84:87],v[144:147]
ds_read_b64_tr_b16 a[224:225],v225
ds_read_b64_tr_b16 a[226:227],v225 offset:1024
v_mfma_f32_16x16x32_bf16 v[144:147],a[120:123],v[88:91],v[144:147]
buffer_load_dwordx4 v227,s[20:23],s34 offen nt lds
v_mfma_f32_16x16x32_bf16 v[144:147],a[124:127],v[92:95],v[144:147]
ds_read_b64_tr_b16 a[228:229],v226
ds_read_b64_tr_b16 a[230:231],v226 offset:1024
v_mfma_f32_16x16x32_bf16 v[148:151],a[128:131],v[92:95],v[192:195]
v_exp_f32 v140,v140
v_mfma_f32_16x16x32_bf16 v[148:151],a[132:135],v[88:91],v[148:151]
ds_read_b64_tr_b16 a[232:233],v225 offset:256
ds_read_b64_tr_b16 a[234:235],v225 offset:1280
v_mfma_f32_16x16x32_bf16 v[148:151],a[136:139],v[84:87],v[148:151]
v_exp_f32 v141,v141
v_mfma_f32_16x16x32_bf16 v[148:151],a[140:143],v[80:83],v[148:151]
ds_read_b64_tr_b16 a[236:237],v226 offset:256
ds_read_b64_tr_b16 a[238:239],v226 offset:1280
v_mfma_f32_16x16x32_bf16 v[128:131],a[192:195],v[80:83],v[192:195]
P42:
s_cbranch_execz P170
v_mfma_f32_16x16x32_bf16 v[128:131],a[196:199],v[84:87],v[128:131]
v_exp_f32 v142,v142
v_mfma_f32_16x16x32_bf16 v[128:131],a[200:203],v[88:91],v[128:131]
ds_read_b64_tr_b16 a[240:241],v225 offset:512
ds_read_b64_tr_b16 a[242:243],v225 offset:1536
v_mfma_f32_16x16x32_bf16 v[128:131],a[204:207],v[92:95],v[128:131]
v_exp_f32 v143,v143
v_mfma_f32_16x16x32_bf16 v[132:135],a[208:211],v[92:95],v[192:195]
ds_read_b64_tr_b16 a[244:245],v226 offset:512
v_cvt_pk_bf16_f32 v174,v140,v141
v_mfma_f32_16x16x32_bf16 v[132:135],a[212:215],v[88:91],v[132:135]
ds_read_b64_tr_b16 a[246:247],v226 offset:1536
v_cvt_pk_bf16_f32 v175,v142,v143
v_mfma_f32_16x16x32_bf16 v[132:135],a[216:219],v[84:87],v[132:135]
v_exp_f32 v144,v144
v_mfma_f32_16x16x32_bf16 v[132:135],a[220:223],v[80:83],v[132:135]
ds_read_b64_tr_b16 a[248:249],v225 offset:768
ds_read_b64_tr_b16 a[250:251],v225 offset:1792
v_mfma_f32_16x16x32_bf16 v[208:211],a[176:179],v[168:171],v[208:211]
v_exp_f32 v145,v145
v_mfma_f32_16x16x32_bf16 v[208:211],a[176:179],v[172:175],v[208:211]
s_waitcnt lgkmcnt(4)
ds_read_b64_tr_b16 a[252:253],v226 offset:768
ds_read_b64_tr_b16 a[254:255],v226 offset:1792
v_mfma_f32_16x16x32_bf16 v[0:3],a[224:227],v[172:175],v[0:3]
v_exp_f32 v146,v146
v_mfma_f32_16x16x32_bf16 v[0:3],a[144:147],v[168:171],v[0:3]
buffer_load_dwordx4 v227,s[20:23],s34 offen offset:1024 nt lds
v_mfma_f32_16x16x32_bf16 v[4:7],a[148:151],v[168:171],v[4:7]
v_exp_f32 v147,v147
v_mfma_f32_16x16x32_bf16 v[4:7],a[228:231],v[172:175],v[4:7]
v_cvt_pk_bf16_f32 v176,v144,v145
v_cvt_pk_bf16_f32 v177,v146,v147
v_mfma_f32_16x16x32_bf16 v[8:11],a[232:235],v[172:175],v[8:11]
P43:
s_cbranch_execz P171
Z2:
s_cbranch_execz Z6
v_mfma_f32_16x16x32_bf16 v[8:11],a[152:155],v[168:171],v[8:11]
v_exp_f32 v148,v148
v_mfma_f32_16x16x32_bf16 v[12:15],a[156:159],v[168:171],v[12:15]
v_exp_f32 v149,v149
v_mfma_f32_16x16x32_bf16 v[12:15],a[236:239],v[172:175],v[12:15]
v_exp_f32 v150,v150
v_mfma_f32_16x16x32_bf16 v[16:19],a[240:243],v[172:175],v[16:19]
v_exp_f32 v151,v151
v_mfma_f32_16x16x32_bf16 v[16:19],a[160:163],v[168:171],v[16:19]
v_cvt_pk_bf16_f32 v178,v148,v149
v_cvt_pk_bf16_f32 v179,v150,v151
v_mfma_f32_16x16x32_bf16 v[20:23],a[164:167],v[168:171],v[20:23]
s_waitcnt lgkmcnt(0)
v_exp_f32 v128,v128
v_mfma_f32_16x16x32_bf16 v[20:23],a[244:247],v[172:175],v[20:23]
v_exp_f32 v129,v129
v_mfma_f32_16x16x32_bf16 v[24:27],a[248:251],v[172:175],v[24:27]
v_exp_f32 v130,v130
v_mfma_f32_16x16x32_bf16 v[24:27],a[168:171],v[168:171],v[24:27]
v_exp_f32 v131,v131
v_mfma_f32_16x16x32_bf16 v[28:31],a[172:175],v[168:171],v[28:31]
v_cvt_pk_bf16_f32 v180,v128,v129
v_cvt_pk_bf16_f32 v181,v130,v131
v_mfma_f32_16x16x32_bf16 v[28:31],a[252:255],v[172:175],v[28:31]
v_exp_f32 v132,v132
v_mfma_f32_16x16x32_bf16 v[136:139],a[192:195],a[96:99],v[204:207]
v_exp_f32 v133,v133
v_mfma_f32_16x16x32_bf16 v[136:139],a[196:199],a[100:103],v[136:139]
v_exp_f32 v134,v134
v_mfma_f32_16x16x32_bf16 v[136:139],a[200:203],a[104:107],v[136:139]
buffer_load_dwordx4 v227,s[20:23],s34 offen offset:2048 nt lds
v_mfma_f32_16x16x32_bf16 v[136:139],a[204:207],a[108:111],v[136:139]
v_exp_f32 v135,v135
v_mfma_f32_16x16x32_bf16 v[140:143],a[208:211],a[108:111],v[204:207]
v_cvt_pk_bf16_f32 v182,v132,v133
v_cvt_pk_bf16_f32 v183,v134,v135
v_mfma_f32_16x16x32_bf16 v[140:143],a[212:215],a[104:107],v[140:143]
buffer_load_dwordx4 v[248:251],v228,s[12:15],s64 offen offset:2048 nt
v_mfma_f32_16x16x32_bf16 v[140:143],a[216:219],a[100:103],v[140:143]
P44:
s_cbranch_execz P172
v_mfma_f32_16x16x32_bf16 v[140:143],a[220:223],a[96:99],v[140:143]
v_exp_f32 v136,v136
v_mfma_f32_16x16x32_bf16 v[208:211],a[180:183],v[176:179],v[208:211]
v_exp_f32 v137,v137
v_mfma_f32_16x16x32_bf16 v[208:211],a[180:183],v[180:183],v[208:211]
v_exp_f32 v138,v138
v_mfma_f32_16x16x32_bf16 v[32:35],a[224:227],v[180:183],v[32:35]
v_exp_f32 v139,v139
v_mfma_f32_16x16x32_bf16 v[32:35],a[144:147],v[176:179],v[32:35]
v_cvt_pk_bf16_f32 v184,v136,v137
v_cvt_pk_bf16_f32 v185,v138,v139
v_mfma_f32_16x16x32_bf16 v[36:39],a[148:151],v[176:179],v[36:39]
v_exp_f32 v140,v140
v_mfma_f32_16x16x32_bf16 v[36:39],a[228:231],v[180:183],v[36:39]
v_exp_f32 v141,v141
v_mfma_f32_16x16x32_bf16 v[40:43],a[232:235],v[180:183],v[40:43]
v_exp_f32 v142,v142
v_mfma_f32_16x16x32_bf16 v[40:43],a[152:155],v[176:179],v[40:43]
v_exp_f32 v143,v143
v_mfma_f32_16x16x32_bf16 v[44:47],a[156:159],v[176:179],v[44:47]
v_cvt_pk_bf16_f32 v186,v140,v141
v_cvt_pk_bf16_f32 v187,v142,v143
v_mfma_f32_16x16x32_bf16 v[44:47],a[236:239],v[180:183],v[44:47]
v_xor_b32 v224,0x10800,v224
v_xor_b32 v225,0x8800,v225
v_mfma_f32_16x16x32_bf16 v[48:51],a[240:243],v[180:183],v[48:51]
v_xor_b32 v226,0x8800,v226
v_mfma_f32_16x16x32_bf16 v[48:51],a[160:163],v[176:179],v[48:51]
buffer_load_dwordx4 v227,s[20:23],s34 offen offset:3072 nt lds
v_mfma_f32_16x16x32_bf16 v[52:55],a[164:167],v[176:179],v[52:55]
v_mfma_f32_16x16x32_bf16 v[52:55],a[244:247],v[180:183],v[52:55]
v_mfma_f32_16x16x32_bf16 v[56:59],a[248:251],v[180:183],v[56:59]
v_mfma_f32_16x16x32_bf16 v[56:59],a[168:171],v[176:179],v[56:59]
v_mfma_f32_16x16x32_bf16 v[60:63],a[172:175],v[176:179],v[60:63]
P45:
s_cbranch_execz P173
v_mfma_f32_16x16x32_bf16 v[60:63],a[252:255],v[180:183],v[60:63]
v_mfma_f32_16x16x32_bf16 v[144:147],a[112:115],v[96:99],v[196:199]
v_mfma_f32_16x16x32_bf16 v[144:147],a[116:119],v[100:103],v[144:147]
v_mfma_f32_16x16x32_bf16 v[144:147],a[120:123],v[104:107],v[144:147]
v_mfma_f32_16x16x32_bf16 v[144:147],a[124:127],v[108:111],v[144:147]
v_mfma_f32_16x16x32_bf16 v[148:151],a[128:131],v[108:111],v[196:199]
buffer_load_dwordx4 v[252:255],v228,s[12:15],s64 offen offset:3072 nt
v_mfma_f32_16x16x32_bf16 v[148:151],a[132:135],v[104:107],v[148:151]
v_mfma_f32_16x16x32_bf16 v[148:151],a[136:139],v[100:103],v[148:151]
v_mfma_f32_16x16x32_bf16 v[148:151],a[140:143],v[96:99],v[148:151]
v_mfma_f32_16x16x32_bf16 v[128:131],a[192:195],v[96:99],v[196:199]
v_mfma_f32_16x16x32_bf16 v[128:131],a[196:199],v[100:103],v[128:131]
v_mfma_f32_16x16x32_bf16 v[128:131],a[200:203],v[104:107],v[128:131]
v_exp_f32 v144,v144
v_mfma_f32_16x16x32_bf16 v[128:131],a[204:207],v[108:111],v[128:131]
v_exp_f32 v145,v145
v_mfma_f32_16x16x32_bf16 v[132:135],a[208:211],v[108:111],v[196:199]
v_exp_f32 v146,v146
v_mfma_f32_16x16x32_bf16 v[132:135],a[212:215],v[104:107],v[132:135]
v_exp_f32 v147,v147
v_mfma_f32_16x16x32_bf16 v[132:135],a[216:219],v[100:103],v[132:135]
v_cvt_pk_bf16_f32 v168,v144,v145
v_cvt_pk_bf16_f32 v169,v146,v147
v_mfma_f32_16x16x32_bf16 v[132:135],a[220:223],v[96:99],v[132:135]
v_exp_f32 v148,v148
v_mfma_f32_16x16x32_bf16 v[212:215],a[176:179],v[184:187],v[212:215]
v_exp_f32 v149,v149
v_mfma_f32_16x16x32_bf16 a[0:3],a[224:227],v[184:187],a[0:3]
v_exp_f32 v150,v150
v_mfma_f32_16x16x32_bf16 a[4:7],a[228:231],v[184:187],a[4:7]
v_exp_f32 v151,v151
v_mfma_f32_16x16x32_bf16 a[8:11],a[232:235],v[184:187],a[8:11]
s_add_u32 m0,s30,81920
v_cvt_pk_bf16_f32 v170,v148,v149
v_cvt_pk_bf16_f32 v171,v150,v151
v_mfma_f32_16x16x32_bf16 a[12:15],a[236:239],v[184:187],a[12:15]
P46:
s_cbranch_execz P174
v_mfma_f32_16x16x32_bf16 a[16:19],a[240:243],v[184:187],a[16:19]
s_mov_b32 s34,114688
v_exp_f32 v128,v128
v_mfma_f32_16x16x32_bf16 a[20:23],a[244:247],v[184:187],a[20:23]
v_exp_f32 v129,v129
v_mfma_f32_16x16x32_bf16 a[24:27],a[248:251],v[184:187],a[24:27]
s_waitcnt vmcnt(11) lgkmcnt(0)
s_barrier
v_mfma_f32_16x16x32_bf16 a[28:31],a[252:255],v[184:187],a[28:31]
v_exp_f32 v130,v130
v_mfma_f32_16x16x32_bf16 v[136:139],a[112:115],v[112:115],v[200:203]
v_exp_f32 v131,v131
v_mfma_f32_16x16x32_bf16 v[136:139],a[116:119],v[116:119],v[136:139]
ds_read_b128 a[112:115],v224
v_cvt_pk_bf16_f32 v172,v128,v129
v_mfma_f32_16x16x32_bf16 v[136:139],a[120:123],v[120:123],v[136:139]
buffer_load_dwordx4 v227,s[16:19],s34 offen nt lds
v_mfma_f32_16x16x32_bf16 v[136:139],a[124:127],v[124:127],v[136:139]
ds_read_b128 a[116:119],v224 offset:256
v_cvt_pk_bf16_f32 v173,v130,v131
v_mfma_f32_16x16x32_bf16 v[140:143],a[128:131],v[124:127],v[200:203]
v_exp_f32 v132,v132
v_mfma_f32_16x16x32_bf16 v[140:143],a[132:135],v[120:123],v[140:143]
v_exp_f32 v133,v133
v_mfma_f32_16x16x32_bf16 v[140:143],a[136:139],v[116:119],v[140:143]
v_exp_f32 v134,v134
v_mfma_f32_16x16x32_bf16 v[140:143],a[140:143],v[112:115],v[140:143]
v_exp_f32 v135,v135
v_mfma_f32_16x16x32_bf16 v[144:147],a[192:195],v[112:115],v[200:203]
ds_read_b128 a[120:123],v224 offset:512
v_cvt_pk_bf16_f32 v174,v132,v133
v_mfma_f32_16x16x32_bf16 v[144:147],a[196:199],v[116:119],v[144:147]
ds_read_b128 a[124:127],v224 offset:768
v_cvt_pk_bf16_f32 v175,v134,v135
v_mfma_f32_16x16x32_bf16 v[144:147],a[200:203],v[120:123],v[144:147]
v_exp_f32 v136,v136
v_mfma_f32_16x16x32_bf16 v[144:147],a[204:207],v[124:127],v[144:147]
P47:
s_cbranch_execz P175
v_mfma_f32_16x16x32_bf16 v[148:151],a[208:211],v[124:127],v[200:203]
ds_read_b128 a[128:131],v224 offset:1792
ds_read_b128 a[132:135],v224 offset:1536
v_mfma_f32_16x16x32_bf16 v[148:151],a[212:215],v[120:123],v[148:151]
v_exp_f32 v137,v137
v_mfma_f32_16x16x32_bf16 v[148:151],a[216:219],v[116:119],v[148:151]
ds_read_b128 a[136:139],v224 offset:1280
ds_read_b128 a[140:143],v224 offset:1024
v_mfma_f32_16x16x32_bf16 v[148:151],a[220:223],v[112:115],v[148:151]
v_exp_f32 v138,v138
v_mfma_f32_16x16x32_bf16 v[208:211],a[184:187],v[168:171],v[208:211]
v_exp_f32 v139,v139
v_mfma_f32_16x16x32_bf16 v[208:211],a[184:187],v[172:175],v[208:211]
v_xor_b32 v224,0x800,v224
v_cvt_pk_bf16_f32 v176,v136,v137
v_mfma_f32_16x16x32_bf16 a[32:35],a[224:227],v[172:175],a[32:35]
ds_read_b128 a[192:195],v224
ds_read_b128 a[196:199],v224 offset:256
v_mfma_f32_16x16x32_bf16 a[32:35],a[144:147],v[168:171],a[32:35]
buffer_load_dwordx4 v227,s[16:19],s34 offen offset:1024 nt lds
v_mfma_f32_16x16x32_bf16 a[36:39],a[148:151],v[168:171],a[36:39]
ds_read_b128 a[200:203],v224 offset:512
ds_read_b128 a[204:207],v224 offset:768
v_mfma_f32_16x16x32_bf16 a[36:39],a[228:231],v[172:175],a[36:39]
v_cvt_pk_bf16_f32 v177,v138,v139
v_mfma_f32_16x16x32_bf16 a[40:43],a[232:235],v[172:175],a[40:43]
v_exp_f32 v140,v140
v_mfma_f32_16x16x32_bf16 a[40:43],a[152:155],v[168:171],a[40:43]
ds_read_b128 a[208:211],v224 offset:1792
ds_read_b128 a[212:215],v224 offset:1536
v_mfma_f32_16x16x32_bf16 a[44:47],a[156:159],v[168:171],a[44:47]
v_exp_f32 v141,v141
v_mfma_f32_16x16x32_bf16 a[44:47],a[236:239],v[172:175],a[44:47]
v_exp_f32 v142,v142
v_mfma_f32_16x16x32_bf16 a[48:51],a[240:243],v[172:175],a[48:51]
P48:
s_cbranch_execz P176
v_mfma_f32_16x16x32_bf16 a[48:51],a[160:163],v[168:171],a[48:51]
ds_read_b128 a[216:219],v224 offset:1280
ds_read_b128 a[220:223],v224 offset:1024
v_mfma_f32_16x16x32_bf16 a[52:55],a[164:167],v[168:171],a[52:55]
v_exp_f32 v143,v143
v_mfma_f32_16x16x32_bf16 a[52:55],a[244:247],v[172:175],a[52:55]
v_cvt_pk_bf16_f32 v178,v140,v141
v_cvt_pk_bf16_f32 v179,v142,v143
v_mfma_f32_16x16x32_bf16 a[56:59],a[248:251],v[172:175],a[56:59]
v_exp_f32 v144,v144
v_mfma_f32_16x16x32_bf16 a[56:59],a[168:171],v[168:171],a[56:59]
v_exp_f32 v145,v145
v_mfma_f32_16x16x32_bf16 a[60:63],a[172:175],v[168:171],a[60:63]
v_exp_f32 v146,v146
v_mfma_f32_16x16x32_bf16 a[60:63],a[252:255],v[172:175],a[60:63]
s_waitcnt lgkmcnt(0)
v_exp_f32 v147,v147
v_mfma_f32_16x16x32_bf16 v[128:131],a[112:115],v[64:67],v[188:191]
v_cvt_pk_bf16_f32 v180,v144,v145
v_cvt_pk_bf16_f32 v181,v146,v147
v_mfma_f32_16x16x32_bf16 v[128:131],a[116:119],v[68:71],v[128:131]
v_exp_f32 v148,v148
v_mfma_f32_16x16x32_bf16 v[128:131],a[120:123],v[72:75],v[128:131]
buffer_load_dwordx4 v227,s[16:19],s34 offen offset:2048 nt lds
v_mfma_f32_16x16x32_bf16 v[128:131],a[124:127],v[76:79],v[128:131]
v_exp_f32 v149,v149
v_mfma_f32_16x16x32_bf16 v[132:135],a[128:131],v[76:79],v[188:191]
v_exp_f32 v150,v150
v_mfma_f32_16x16x32_bf16 v[132:135],a[132:135],v[72:75],v[132:135]
v_exp_f32 v151,v151
v_mfma_f32_16x16x32_bf16 v[132:135],a[136:139],v[68:71],v[132:135]
v_cvt_pk_bf16_f32 v182,v148,v149
v_cvt_pk_bf16_f32 v183,v150,v151
v_mfma_f32_16x16x32_bf16 v[132:135],a[140:143],v[64:67],v[132:135]
v_exp_f32 v128,v128
v_mfma_f32_16x16x32_bf16 v[136:139],a[192:195],v[64:67],v[188:191]
P49:
s_cbranch_execz P177
v_mfma_f32_16x16x32_bf16 v[136:139],a[196:199],v[68:71],v[136:139]
v_exp_f32 v129,v129
v_mfma_f32_16x16x32_bf16 v[136:139],a[200:203],v[72:75],v[136:139]
v_exp_f32 v130,v130
v_mfma_f32_16x16x32_bf16 v[136:139],a[204:207],v[76:79],v[136:139]
v_exp_f32 v131,v131
v_mfma_f32_16x16x32_bf16 v[140:143],a[208:211],v[76:79],v[188:191]
v_cvt_pk_bf16_f32 v168,v128,v129
v_cvt_pk_bf16_f32 v169,v130,v131
v_mfma_f32_16x16x32_bf16 v[140:143],a[212:215],v[72:75],v[140:143]
v_exp_f32 v132,v132
v_mfma_f32_16x16x32_bf16 v[140:143],a[216:219],v[68:71],v[140:143]
v_exp_f32 v133,v133
v_mfma_f32_16x16x32_bf16 v[140:143],a[220:223],v[64:67],v[140:143]
v_exp_f32 v134,v134
v_mfma_f32_16x16x32_bf16 v[208:211],a[188:191],v[176:179],v[208:211]
v_exp_f32 v135,v135
v_mfma_f32_16x16x32_bf16 v[208:211],a[188:191],v[180:183],v[208:211]
v_cvt_pk_bf16_f32 v170,v132,v133
v_cvt_pk_bf16_f32 v171,v134,v135
v_mfma_f32_16x16x32_bf16 a[64:67],a[224:227],v[180:183],a[64:67]
v_exp_f32 v136,v136
v_mfma_f32_16x16x32_bf16 a[64:67],a[144:147],v[176:179],a[64:67]
ds_read_b64_tr_b16 a[144:145],v225
ds_read_b64_tr_b16 a[146:147],v225 offset:1024
v_mfma_f32_16x16x32_bf16 a[68:71],a[148:151],v[176:179],a[68:71]
ds_read_b64_tr_b16 a[148:149],v226
ds_read_b64_tr_b16 a[150:151],v226 offset:1024
v_mfma_f32_16x16x32_bf16 a[68:71],a[228:231],v[180:183],a[68:71]
buffer_load_dwordx4 v227,s[16:19],s34 offen offset:3072 nt lds
v_mfma_f32_16x16x32_bf16 a[72:75],a[232:235],v[180:183],a[72:75]
v_exp_f32 v137,v137
v_mfma_f32_16x16x32_bf16 a[72:75],a[152:155],v[176:179],a[72:75]
ds_read_b64_tr_b16 a[152:153],v225 offset:256
ds_read_b64_tr_b16 a[154:155],v225 offset:1280
v_mfma_f32_16x16x32_bf16 a[76:79],a[156:159],v[176:179],a[76:79]
P50:
s_cbranch_execz P178
v_mfma_f32_16x16x32_bf16 a[76:79],a[236:239],v[180:183],a[76:79]
ds_read_b64_tr_b16 a[156:157],v226 offset:256
ds_read_b64_tr_b16 a[158:159],v226 offset:1280
v_mfma_f32_16x16x32_bf16 a[80:83],a[240:243],v[180:183],a[80:83]
v_exp_f32 v138,v138
v_mfma_f32_16x16x32_bf16 a[80:83],a[160:163],v[176:179],a[80:83]
ds_read_b64_tr_b16 a[160:161],v225 offset:512
ds_read_b64_tr_b16 a[162:163],v225 offset:1536
v_mfma_f32_16x16x32_bf16 a[84:87],a[164:167],v[176:179],a[84:87]
s_add_u32 m0,s30,0
v_exp_f32 v139,v139
v_mfma_f32_16x16x32_bf16 a[84:87],a[244:247],v[180:183],a[84:87]
s_mov_b32 s34,114688
ds_read_b64_tr_b16 a[164:165],v226 offset:512
ds_read_b64_tr_b16 a[166:167],v226 offset:1536
v_mfma_f32_16x16x32_bf16 a[88:91],a[248:251],v[180:183],a[88:91]
v_cvt_pk_bf16_f32 v172,v136,v137
v_cvt_pk_bf16_f32 v173,v138,v139
v_mfma_f32_16x16x32_bf16 a[88:91],a[168:171],v[176:179],a[88:91]
ds_read_b64_tr_b16 a[168:169],v225 offset:768
ds_read_b64_tr_b16 a[170:171],v225 offset:1792
v_mfma_f32_16x16x32_bf16 a[92:95],a[172:175],v[176:179],a[92:95]
v_exp_f32 v140,v140
v_mfma_f32_16x16x32_bf16 a[92:95],a[252:255],v[180:183],a[92:95]
ds_read_b64_tr_b16 a[172:173],v226 offset:768
ds_read_b64_tr_b16 a[174:175],v226 offset:1792
v_mfma_f32_16x16x32_bf16 v[144:147],a[112:115],v[80:83],v[192:195]
v_xor_b32 v225,0x800,v225
v_xor_b32 v226,0x800,v226
v_mfma_f32_16x16x32_bf16 v[144:147],a[116:119],v[84:87],v[144:147]
ds_read_b64_tr_b16 a[224:225],v225
ds_read_b64_tr_b16 a[226:227],v225 offset:1024
v_mfma_f32_16x16x32_bf16 v[144:147],a[120:123],v[88:91],v[144:147]
buffer_load_dwordx4 v227,s[20:23],s34 offen nt lds
v_mfma_f32_16x16x32_bf16 v[144:147],a[124:127],v[92:95],v[144:147]
P51:
s_cbranch_execz P179
v_mfma_f32_16x16x32_bf16 v[148:151],a[128:131],v[92:95],v[192:195]
ds_read_b64_tr_b16 a[228:229],v226
ds_read_b64_tr_b16 a[230:231],v226 offset:1024
v_mfma_f32_16x16x32_bf16 v[148:151],a[132:135],v[88:91],v[148:151]
v_exp_f32 v141,v141
v_mfma_f32_16x16x32_bf16 v[148:151],a[136:139],v[84:87],v[148:151]
ds_read_b64_tr_b16 a[232:233],v225 offset:256
ds_read_b64_tr_b16 a[234:235],v225 offset:1280
v_mfma_f32_16x16x32_bf16 v[148:151],a[140:143],v[80:83],v[148:151]
v_exp_f32 v142,v142
v_mfma_f32_16x16x32_bf16 v[128:131],a[192:195],v[80:83],v[192:195]
ds_read_b64_tr_b16 a[236:237],v226 offset:256
ds_read_b64_tr_b16 a[238:239],v226 offset:1280
v_mfma_f32_16x16x32_bf16 v[128:131],a[196:199],v[84:87],v[128:131]
v_exp_f32 v143,v143
v_mfma_f32_16x16x32_bf16 v[128:131],a[200:203],v[88:91],v[128:131]
ds_read_b64_tr_b16 a[240:241],v225 offset:512
ds_read_b64_tr_b16 a[242:243],v225 offset:1536
v_mfma_f32_16x16x32_bf16 v[128:131],a[204:207],v[92:95],v[128:131]
v_cvt_pk_bf16_f32 v174,v140,v141
v_cvt_pk_bf16_f32 v175,v142,v143
v_mfma_f32_16x16x32_bf16 v[132:135],a[208:211],v[92:95],v[192:195]
ds_read_b64_tr_b16 a[244:245],v226 offset:512
ds_read_b64_tr_b16 a[246:247],v226 offset:1536
v_mfma_f32_16x16x32_bf16 v[132:135],a[212:215],v[88:91],v[132:135]
v_exp_f32 v144,v144
v_mfma_f32_16x16x32_bf16 v[132:135],a[216:219],v[84:87],v[132:135]
ds_read_b64_tr_b16 a[248:249],v225 offset:768
ds_read_b64_tr_b16 a[250:251],v225 offset:1792
v_mfma_f32_16x16x32_bf16 v[132:135],a[220:223],v[80:83],v[132:135]
v_exp_f32 v145,v145
v_mfma_f32_16x16x32_bf16 v[208:211],a[176:179],v[168:171],v[208:211]
ds_read_b64_tr_b16 a[252:253],v226 offset:768
ds_read_b64_tr_b16 a[254:255],v226 offset:1792
v_mfma_f32_16x16x32_bf16 v[208:211],a[176:179],v[172:175],v[208:211]
s_waitcnt lgkmcnt(6)
P52:
s_cbranch_execz P180
v_mfma_f32_16x16x32_bf16 v[0:3],a[224:227],v[172:175],v[0:3]
v_exp_f32 v146,v146
v_mfma_f32_16x16x32_bf16 v[0:3],a[144:147],v[168:171],v[0:3]
buffer_load_dwordx4 v227,s[20:23],s34 offen offset:1024 nt lds
v_mfma_f32_16x16x32_bf16 v[4:7],a[148:151],v[168:171],v[4:7]
v_exp_f32 v147,v147
v_mfma_f32_16x16x32_bf16 v[4:7],a[228:231],v[172:175],v[4:7]
v_cvt_pk_bf16_f32 v176,v144,v145
v_cvt_pk_bf16_f32 v177,v146,v147
v_mfma_f32_16x16x32_bf16 v[8:11],a[232:235],v[172:175],v[8:11]
v_exp_f32 v148,v148
v_mfma_f32_16x16x32_bf16 v[8:11],a[152:155],v[168:171],v[8:11]
v_exp_f32 v149,v149
v_mfma_f32_16x16x32_bf16 v[12:15],a[156:159],v[168:171],v[12:15]
v_exp_f32 v150,v150
v_mfma_f32_16x16x32_bf16 v[12:15],a[236:239],v[172:175],v[12:15]
v_exp_f32 v151,v151
v_mfma_f32_16x16x32_bf16 v[16:19],a[240:243],v[172:175],v[16:19]
v_cvt_pk_bf16_f32 v178,v148,v149
v_cvt_pk_bf16_f32 v179,v150,v151
v_mfma_f32_16x16x32_bf16 v[16:19],a[160:163],v[168:171],v[16:19]
v_exp_f32 v128,v128
v_mfma_f32_16x16x32_bf16 v[20:23],a[164:167],v[168:171],v[20:23]
s_waitcnt lgkmcnt(0)
v_exp_f32 v129,v129
v_mfma_f32_16x16x32_bf16 v[20:23],a[244:247],v[172:175],v[20:23]
v_exp_f32 v130,v130
v_mfma_f32_16x16x32_bf16 v[24:27],a[248:251],v[172:175],v[24:27]
v_exp_f32 v131,v131
v_mfma_f32_16x16x32_bf16 v[24:27],a[168:171],v[168:171],v[24:27]
v_cvt_pk_bf16_f32 v180,v128,v129
v_cvt_pk_bf16_f32 v181,v130,v131
v_mfma_f32_16x16x32_bf16 v[28:31],a[172:175],v[168:171],v[28:31]
v_exp_f32 v132,v132
v_mfma_f32_16x16x32_bf16 v[28:31],a[252:255],v[172:175],v[28:31]
P53:
s_cbranch_execz P181
v_mfma_f32_16x16x32_bf16 v[136:139],a[192:195],a[96:99],v[204:207]
v_exp_f32 v133,v133
v_mfma_f32_16x16x32_bf16 v[136:139],a[196:199],a[100:103],v[136:139]
v_exp_f32 v134,v134
v_mfma_f32_16x16x32_bf16 v[136:139],a[200:203],a[104:107],v[136:139]
buffer_load_dwordx4 v227,s[20:23],s34 offen offset:2048 nt lds
v_mfma_f32_16x16x32_bf16 v[136:139],a[204:207],a[108:111],v[136:139]
v_exp_f32 v135,v135
v_mfma_f32_16x16x32_bf16 v[140:143],a[208:211],a[108:111],v[204:207]
v_cvt_pk_bf16_f32 v182,v132,v133
v_cvt_pk_bf16_f32 v183,v134,v135
v_mfma_f32_16x16x32_bf16 v[140:143],a[212:215],a[104:107],v[140:143]
v_lshlrev_b32 v152,16,v240
v_and_b32 v153,0xffff0000,v240
v_mfma_f32_16x16x32_bf16 v[140:143],a[216:219],a[100:103],v[140:143]
v_mul_f32 v152,s80,v152
v_mul_f32 v153,s80,v153
v_mfma_f32_16x16x32_bf16 v[140:143],a[220:223],a[96:99],v[140:143]
v_cvt_pk_bf16_f32 v240,v152,v153
v_lshlrev_b32 v154,16,v241
v_mfma_f32_16x16x32_bf16 v[208:211],a[180:183],v[176:179],v[208:211]
v_and_b32 v155,0xffff0000,v241
v_mul_f32 v154,s80,v154
v_mfma_f32_16x16x32_bf16 v[208:211],a[180:183],v[180:183],v[208:211]
v_mul_f32 v155,s80,v155
v_cvt_pk_bf16_f32 v241,v154,v155
v_mfma_f32_16x16x32_bf16 v[32:35],a[224:227],v[180:183],v[32:35]
v_lshlrev_b32 v152,16,v242
v_and_b32 v153,0xffff0000,v242
v_mfma_f32_16x16x32_bf16 v[32:35],a[144:147],v[176:179],v[32:35]
v_mul_f32 v152,s80,v152
v_mul_f32 v153,s80,v153
v_mfma_f32_16x16x32_bf16 v[36:39],a[148:151],v[176:179],v[36:39]
v_cvt_pk_bf16_f32 v242,v152,v153
v_lshlrev_b32 v154,16,v243
v_mfma_f32_16x16x32_bf16 v[36:39],a[228:231],v[180:183],v[36:39]
v_and_b32 v155,0xffff0000,v243
v_mul_f32 v154,s80,v154
v_mfma_f32_16x16x32_bf16 v[40:43],a[232:235],v[180:183],v[40:43]
P54:
s_cbranch_execz P182
v_mfma_f32_16x16x32_bf16 v[40:43],a[152:155],v[176:179],v[40:43]
v_mul_f32 v155,s80,v155
v_cvt_pk_bf16_f32 v243,v154,v155
v_mfma_f32_16x16x32_bf16 v[44:47],a[156:159],v[176:179],v[44:47]
ds_write_b128 v229,v[240:243]
v_mfma_f32_16x16x32_bf16 v[44:47],a[236:239],v[180:183],v[44:47]
buffer_load_dwordx4 v[240:243],v228,s[12:15],s65 offen nt
v_mfma_f32_16x16x32_bf16 v[48:51],a[240:243],v[180:183],v[48:51]
v_exp_f32 v136,v136
v_mfma_f32_16x16x32_bf16 v[48:51],a[160:163],v[176:179],v[48:51]
buffer_load_dwordx4 v227,s[20:23],s34 offen offset:3072 nt lds
v_mfma_f32_16x16x32_bf16 v[52:55],a[164:167],v[176:179],v[52:55]
v_exp_f32 v137,v137
v_mfma_f32_16x16x32_bf16 v[52:55],a[244:247],v[180:183],v[52:55]
v_exp_f32 v138,v138
v_mfma_f32_16x16x32_bf16 v[56:59],a[248:251],v[180:183],v[56:59]
v_exp_f32 v139,v139
v_mfma_f32_16x16x32_bf16 v[56:59],a[168:171],v[176:179],v[56:59]
v_cvt_pk_bf16_f32 v184,v136,v137
v_cvt_pk_bf16_f32 v185,v138,v139
v_mfma_f32_16x16x32_bf16 v[60:63],a[172:175],v[176:179],v[60:63]
v_exp_f32 v140,v140
v_mfma_f32_16x16x32_bf16 v[60:63],a[252:255],v[180:183],v[60:63]
v_exp_f32 v141,v141
v_mfma_f32_16x16x32_bf16 v[144:147],a[112:115],v[96:99],v[196:199]
v_exp_f32 v142,v142
v_mfma_f32_16x16x32_bf16 v[144:147],a[116:119],v[100:103],v[144:147]
v_exp_f32 v143,v143
v_mfma_f32_16x16x32_bf16 v[144:147],a[120:123],v[104:107],v[144:147]
v_cvt_pk_bf16_f32 v186,v140,v141
v_cvt_pk_bf16_f32 v187,v142,v143
v_mfma_f32_16x16x32_bf16 v[144:147],a[124:127],v[108:111],v[144:147]
s_waitcnt vmcnt(19)
v_xor_b32 v224,0x8800,v224
v_lshlrev_b32 v152,16,v244
v_mfma_f32_16x16x32_bf16 v[148:151],a[128:131],v[108:111],v[196:199]
P55:
s_cbranch_execz P183
v_mfma_f32_16x16x32_bf16 v[148:151],a[132:135],v[104:107],v[148:151]
v_and_b32 v153,0xffff0000,v244
v_mul_f32 v152,s80,v152
v_mfma_f32_16x16x32_bf16 v[148:151],a[136:139],v[100:103],v[148:151]
v_exp_f32 v144,v144
v_mfma_f32_16x16x32_bf16 v[148:151],a[140:143],v[96:99],v[148:151]
v_exp_f32 v145,v145
v_mfma_f32_16x16x32_bf16 v[128:131],a[192:195],v[96:99],v[196:199]
v_exp_f32 v146,v146
v_mfma_f32_16x16x32_bf16 v[128:131],a[196:199],v[100:103],v[128:131]
v_exp_f32 v147,v147
v_mfma_f32_16x16x32_bf16 v[128:131],a[200:203],v[104:107],v[128:131]
v_cvt_pk_bf16_f32 v168,v144,v145
v_cvt_pk_bf16_f32 v169,v146,v147
v_mfma_f32_16x16x32_bf16 v[128:131],a[204:207],v[108:111],v[128:131]
v_exp_f32 v148,v148
v_mfma_f32_16x16x32_bf16 v[132:135],a[208:211],v[108:111],v[196:199]
v_exp_f32 v149,v149
v_mfma_f32_16x16x32_bf16 v[132:135],a[212:215],v[104:107],v[132:135]
v_exp_f32 v150,v150
v_mfma_f32_16x16x32_bf16 v[132:135],a[216:219],v[100:103],v[132:135]
v_exp_f32 v151,v151
v_mfma_f32_16x16x32_bf16 v[132:135],a[220:223],v[96:99],v[132:135]
v_cvt_pk_bf16_f32 v170,v148,v149
v_cvt_pk_bf16_f32 v171,v150,v151
v_mfma_f32_16x16x32_bf16 v[212:215],a[176:179],v[184:187],v[212:215]
v_exp_f32 v128,v128
v_mfma_f32_16x16x32_bf16 a[0:3],a[224:227],v[184:187],a[0:3]
v_exp_f32 v129,v129
v_mfma_f32_16x16x32_bf16 a[4:7],a[228:231],v[184:187],a[4:7]
v_exp_f32 v130,v130
v_mfma_f32_16x16x32_bf16 a[8:11],a[232:235],v[184:187],a[8:11]
s_add_u32 m0,s30,16384
v_exp_f32 v131,v131
v_mfma_f32_16x16x32_bf16 a[12:15],a[236:239],v[184:187],a[12:15]
s_mov_b32 s34,131072
v_cvt_pk_bf16_f32 v172,v128,v129
v_cvt_pk_bf16_f32 v173,v130,v131
v_mfma_f32_16x16x32_bf16 a[16:19],a[240:243],v[184:187],a[16:19]
P56:
s_cbranch_execz P184
v_mfma_f32_16x16x32_bf16 a[20:23],a[244:247],v[184:187],a[20:23]
v_exp_f32 v132,v132
v_mfma_f32_16x16x32_bf16 a[24:27],a[248:251],v[184:187],a[24:27]
s_waitcnt vmcnt(10) lgkmcnt(0)
s_barrier
v_mfma_f32_16x16x32_bf16 a[28:31],a[252:255],v[184:187],a[28:31]
v_exp_f32 v133,v133
v_mfma_f32_16x16x32_bf16 v[136:139],a[112:115],v[112:115],v[200:203]
v_exp_f32 v134,v134
v_mfma_f32_16x16x32_bf16 v[136:139],a[116:119],v[116:119],v[136:139]
v_exp_f32 v135,v135
v_mfma_f32_16x16x32_bf16 v[136:139],a[120:123],v[120:123],v[136:139]
buffer_load_dwordx4 v227,s[16:19],s34 offen nt lds
v_mfma_f32_16x16x32_bf16 v[136:139],a[124:127],v[124:127],v[136:139]
ds_read_b128 a[112:115],v224
v_cvt_pk_bf16_f32 v174,v132,v133
v_mfma_f32_16x16x32_bf16 v[140:143],a[128:131],v[124:127],v[200:203]
ds_read_b128 a[116:119],v224 offset:256
v_cvt_pk_bf16_f32 v175,v134,v135
v_mfma_f32_16x16x32_bf16 v[140:143],a[132:135],v[120:123],v[140:143]
v_mul_f32 v153,s80,v153
v_cvt_pk_bf16_f32 v244,v152,v153
v_mfma_f32_16x16x32_bf16 v[140:143],a[136:139],v[116:119],v[140:143]
ds_read_b128 a[120:123],v224 offset:512
ds_read_b128 a[124:127],v224 offset:768
v_mfma_f32_16x16x32_bf16 v[140:143],a[140:143],v[112:115],v[140:143]
v_exp_f32 v136,v136
v_mfma_f32_16x16x32_bf16 v[144:147],a[192:195],v[112:115],v[200:203]
ds_read_b128 a[128:131],v224 offset:1792
ds_read_b128 a[132:135],v224 offset:1536
v_mfma_f32_16x16x32_bf16 v[144:147],a[196:199],v[116:119],v[144:147]
v_exp_f32 v137,v137
v_mfma_f32_16x16x32_bf16 v[144:147],a[200:203],v[120:123],v[144:147]
ds_read_b128 a[136:139],v224 offset:1280
ds_read_b128 a[140:143],v224 offset:1024
v_mfma_f32_16x16x32_bf16 v[144:147],a[204:207],v[124:127],v[144:147]
P57:
s_cbranch_execz P185
v_mfma_f32_16x16x32_bf16 v[148:151],a[208:211],v[124:127],v[200:203]
v_xor_b32 v224,0x800,v224
v_lshlrev_b32 v154,16,v245
v_mfma_f32_16x16x32_bf16 v[148:151],a[212:215],v[120:123],v[148:151]
ds_read_b128 a[192:195],v224
ds_read_b128 a[196:199],v224 offset:256
v_mfma_f32_16x16x32_bf16 v[148:151],a[216:219],v[116:119],v[148:151]
v_and_b32 v155,0xffff0000,v245
v_mul_f32 v154,s80,v154
v_mfma_f32_16x16x32_bf16 v[148:151],a[220:223],v[112:115],v[148:151]
v_exp_f32 v138,v138
v_mfma_f32_16x16x32_bf16 v[208:211],a[184:187],v[168:171],v[208:211]
ds_read_b128 a[200:203],v224 offset:512
v_mul_f32 v155,s80,v155
v_mfma_f32_16x16x32_bf16 v[208:211],a[184:187],v[172:175],v[208:211]
v_exp_f32 v139,v139
v_mfma_f32_16x16x32_bf16 a[32:35],a[224:227],v[172:175],a[32:35]
ds_read_b128 a[204:207],v224 offset:768
v_cvt_pk_bf16_f32 v245,v154,v155
v_mfma_f32_16x16x32_bf16 a[32:35],a[144:147],v[168:171],a[32:35]
buffer_load_dwordx4 v227,s[16:19],s34 offen offset:1024 nt lds
v_mfma_f32_16x16x32_bf16 a[36:39],a[148:151],v[168:171],a[36:39]
ds_read_b128 a[208:211],v224 offset:1792
v_lshlrev_b32 v152,16,v246
v_mfma_f32_16x16x32_bf16 a[36:39],a[228:231],v[172:175],a[36:39]
ds_read_b128 a[212:215],v224 offset:1536
v_cvt_pk_bf16_f32 v176,v136,v137
v_mfma_f32_16x16x32_bf16 a[40:43],a[232:235],v[172:175],a[40:43]
v_and_b32 v153,0xffff0000,v246
v_cvt_pk_bf16_f32 v177,v138,v139
v_mfma_f32_16x16x32_bf16 a[40:43],a[152:155],v[168:171],a[40:43]
ds_read_b128 a[216:219],v224 offset:1280
v_mul_f32 v152,s80,v152
v_mfma_f32_16x16x32_bf16 a[44:47],a[156:159],v[168:171],a[44:47]
P58:
s_cbranch_execz P186
v_mfma_f32_16x16x32_bf16 a[44:47],a[236:239],v[172:175],a[44:47]
ds_read_b128 a[220:223],v224 offset:1024
v_mul_f32 v153,s80,v153
v_mfma_f32_16x16x32_bf16 a[48:51],a[240:243],v[172:175],a[48:51]
v_exp_f32 v140,v140
v_mfma_f32_16x16x32_bf16 a[48:51],a[160:163],v[168:171],a[48:51]
v_cvt_pk_bf16_f32 v246,v152,v153
v_lshlrev_b32 v154,16,v247
v_mfma_f32_16x16x32_bf16 a[52:55],a[164:167],v[168:171],a[52:55]
v_exp_f32 v141,v141
v_mfma_f32_16x16x32_bf16 a[52:55],a[244:247],v[172:175],a[52:55]
v_and_b32 v155,0xffff0000,v247
v_mul_f32 v154,s80,v154
v_mfma_f32_16x16x32_bf16 a[56:59],a[248:251],v[172:175],a[56:59]
v_exp_f32 v142,v142
v_mfma_f32_16x16x32_bf16 a[56:59],a[168:171],v[168:171],a[56:59]
v_mul_f32 v155,s80,v155
v_cvt_pk_bf16_f32 v247,v154,v155
v_mfma_f32_16x16x32_bf16 a[60:63],a[172:175],v[168:171],a[60:63]
v_exp_f32 v143,v143
v_mfma_f32_16x16x32_bf16 a[60:63],a[252:255],v[172:175],a[60:63]
s_waitcnt lgkmcnt(0)
ds_write_b128 v230,v[244:247] offset:1024
v_mfma_f32_16x16x32_bf16 v[128:131],a[112:115],v[64:67],v[188:191]
v_cvt_pk_bf16_f32 v178,v140,v141
v_cvt_pk_bf16_f32 v179,v142,v143
v_mfma_f32_16x16x32_bf16 v[128:131],a[116:119],v[68:71],v[128:131]
buffer_load_dwordx4 v[244:247],v228,s[12:15],s65 offen offset:1024 nt
v_mfma_f32_16x16x32_bf16 v[128:131],a[120:123],v[72:75],v[128:131]
buffer_load_dwordx4 v227,s[16:19],s34 offen offset:2048 nt lds
v_mfma_f32_16x16x32_bf16 v[128:131],a[124:127],v[76:79],v[128:131]
v_exp_f32 v144,v144
v_mfma_f32_16x16x32_bf16 v[132:135],a[128:131],v[76:79],v[188:191]
v_exp_f32 v145,v145
v_mfma_f32_16x16x32_bf16 v[132:135],a[132:135],v[72:75],v[132:135]
v_exp_f32 v146,v146
v_mfma_f32_16x16x32_bf16 v[132:135],a[136:139],v[68:71],v[132:135]
v_exp_f32 v147,v147
v_mfma_f32_16x16x32_bf16 v[132:135],a[140:143],v[64:67],v[132:135]
P59:
s_cbranch_execz P187
Z3:
s_cbranch_execz Z7
v_mfma_f32_16x16x32_bf16 v[136:139],a[192:195],v[64:67],v[188:191]
v_cvt_pk_bf16_f32 v180,v144,v145
v_cvt_pk_bf16_f32 v181,v146,v147
v_mfma_f32_16x16x32_bf16 v[136:139],a[196:199],v[68:71],v[136:139]
v_exp_f32 v148,v148
v_mfma_f32_16x16x32_bf16 v[136:139],a[200:203],v[72:75],v[136:139]
v_exp_f32 v149,v149
v_mfma_f32_16x16x32_bf16 v[136:139],a[204:207],v[76:79],v[136:139]
v_exp_f32 v150,v150
v_mfma_f32_16x16x32_bf16 v[140:143],a[208:211],v[76:79],v[188:191]
v_exp_f32 v151,v151
v_mfma_f32_16x16x32_bf16 v[140:143],a[212:215],v[72:75],v[140:143]
v_cvt_pk_bf16_f32 v182,v148,v149
v_cvt_pk_bf16_f32 v183,v150,v151
v_mfma_f32_16x16x32_bf16 v[140:143],a[216:219],v[68:71],v[140:143]
v_xor_b32 v225,0x18800,v225
v_xor_b32 v226,0x18800,v226
v_mfma_f32_16x16x32_bf16 v[140:143],a[220:223],v[64:67],v[140:143]
v_exp_f32 v128,v128
v_mfma_f32_16x16x32_bf16 v[208:211],a[188:191],v[176:179],v[208:211]
v_exp_f32 v129,v129
v_mfma_f32_16x16x32_bf16 v[208:211],a[188:191],v[180:183],v[208:211]
v_exp_f32 v130,v130
v_mfma_f32_16x16x32_bf16 a[64:67],a[224:227],v[180:183],a[64:67]
v_exp_f32 v131,v131
v_mfma_f32_16x16x32_bf16 a[64:67],a[144:147],v[176:179],a[64:67]
ds_read_b64_tr_b16 a[144:145],v225
ds_read_b64_tr_b16 a[146:147],v225 offset:1024
v_mfma_f32_16x16x32_bf16 a[68:71],a[148:151],v[176:179],a[68:71]
ds_read_b64_tr_b16 a[148:149],v226
ds_read_b64_tr_b16 a[150:151],v226 offset:1024
v_mfma_f32_16x16x32_bf16 a[68:71],a[228:231],v[180:183],a[68:71]
buffer_load_dwordx4 v227,s[16:19],s34 offen offset:3072 nt lds
v_mfma_f32_16x16x32_bf16 a[72:75],a[232:235],v[180:183],a[72:75]
P60:
s_cbranch_execz P188
v_mfma_f32_16x16x32_bf16 a[72:75],a[152:155],v[176:179],a[72:75]
ds_read_b64_tr_b16 a[152:153],v225 offset:256
ds_read_b64_tr_b16 a[154:155],v225 offset:1280
v_mfma_f32_16x16x32_bf16 a[76:79],a[156:159],v[176:179],a[76:79]
v_cvt_pk_bf16_f32 v168,v128,v129
v_cvt_pk_bf16_f32 v169,v130,v131
v_mfma_f32_16x16x32_bf16 a[76:79],a[236:239],v[180:183],a[76:79]
ds_read_b64_tr_b16 a[156:157],v226 offset:256
ds_read_b64_tr_b16 a[158:159],v226 offset:1280
v_mfma_f32_16x16x32_bf16 a[80:83],a[240:243],v[180:183],a[80:83]
v_exp_f32 v132,v132
v_mfma_f32_16x16x32_bf16 a[80:83],a[160:163],v[176:179],a[80:83]
ds_read_b64_tr_b16 a[160:161],v225 offset:512
ds_read_b64_tr_b16 a[162:163],v225 offset:1536
v_mfma_f32_16x16x32_bf16 a[84:87],a[164:167],v[176:179],a[84:87]
s_add_u32 m0,s30,32768
v_exp_f32 v133,v133
v_mfma_f32_16x16x32_bf16 a[84:87],a[244:247],v[180:183],a[84:87]
s_mov_b32 s34,131072
ds_read_b64_tr_b16 a[164:165],v226 offset:512
ds_read_b64_tr_b16 a[166:167],v226 offset:1536
v_mfma_f32_16x16x32_bf16 a[88:91],a[248:251],v[180:183],a[88:91]
v_exp_f32 v134,v134
v_mfma_f32_16x16x32_bf16 a[88:91],a[168:171],v[176:179],a[88:91]
ds_read_b64_tr_b16 a[168:169],v225 offset:768
ds_read_b64_tr_b16 a[170:171],v225 offset:1792
v_mfma_f32_16x16x32_bf16 a[92:95],a[172:175],v[176:179],a[92:95]
v_exp_f32 v135,v135
v_mfma_f32_16x16x32_bf16 a[92:95],a[252:255],v[180:183],a[92:95]
ds_read_b64_tr_b16 a[172:173],v226 offset:768
ds_read_b64_tr_b16 a[174:175],v226 offset:1792
v_mfma_f32_16x16x32_bf16 v[144:147],a[112:115],v[80:83],v[192:195]
v_xor_b32 v225,0x800,v225
v_xor_b32 v226,0x800,v226
v_mfma_f32_16x16x32_bf16 v[144:147],a[116:119],v[84:87],v[144:147]
P61:
s_cbranch_execz P189
v_mfma_f32_16x16x32_bf16 v[144:147],a[120:123],v[88:91],v[144:147]
ds_read_b64_tr_b16 a[224:225],v225
ds_read_b64_tr_b16 a[226:227],v225 offset:1024
v_mfma_f32_16x16x32_bf16 v[144:147],a[124:127],v[92:95],v[144:147]
buffer_load_dwordx4 v227,s[20:23],s34 offen nt lds
v_mfma_f32_16x16x32_bf16 v[148:151],a[128:131],v[92:95],v[192:195]
ds_read_b64_tr_b16 a[228:229],v226
v_cvt_pk_bf16_f32 v170,v132,v133
v_mfma_f32_16x16x32_bf16 v[148:151],a[132:135],v[88:91],v[148:151]
ds_read_b64_tr_b16 a[230:231],v226 offset:1024
v_cvt_pk_bf16_f32 v171,v134,v135
v_mfma_f32_16x16x32_bf16 v[148:151],a[136:139],v[84:87],v[148:151]
v_exp_f32 v136,v136
v_mfma_f32_16x16x32_bf16 v[148:151],a[140:143],v[80:83],v[148:151]
v_exp_f32 v137,v137
v_mfma_f32_16x16x32_bf16 v[128:131],a[192:195],v[80:83],v[192:195]
ds_read_b64_tr_b16 a[232:233],v225 offset:256
v_exp_f32 v138,v138
v_mfma_f32_16x16x32_bf16 v[128:131],a[196:199],v[84:87],v[128:131]
ds_read_b64_tr_b16 a[234:235],v225 offset:1280
v_exp_f32 v139,v139
v_mfma_f32_16x16x32_bf16 v[128:131],a[200:203],v[88:91],v[128:131]
v_cvt_pk_bf16_f32 v172,v136,v137
v_cvt_pk_bf16_f32 v173,v138,v139
v_mfma_f32_16x16x32_bf16 v[128:131],a[204:207],v[92:95],v[128:131]
ds_read_b64_tr_b16 a[236:237],v226 offset:256
ds_read_b64_tr_b16 a[238:239],v226 offset:1280
v_exp_f32 v140,v140
v_mfma_f32_16x16x32_bf16 v[132:135],a[208:211],v[92:95],v[192:195]
v_exp_f32 v141,v141
v_mfma_f32_16x16x32_bf16 v[132:135],a[212:215],v[88:91],v[132:135]
ds_read_b64_tr_b16 a[240:241],v225 offset:512
v_exp_f32 v142,v142
v_mfma_f32_16x16x32_bf16 v[132:135],a[216:219],v[84:87],v[132:135]
ds_read_b64_tr_b16 a[242:243],v225 offset:1536
v_exp_f32 v143,v143
v_mfma_f32_16x16x32_bf16 v[132:135],a[220:223],v[80:83],v[132:135]
v_cvt_pk_bf16_f32 v174,v140,v141
v_cvt_pk_bf16_f32 v175,v142,v143
v_mfma_f32_16x16x32_bf16 v[208:211],a[176:179],v[168:171],v[208:211]
P62:
s_cbranch_execz P190
ds_read_b64_tr_b16 a[244:245],v226 offset:512
ds_read_b64_tr_b16 a[246:247],v226 offset:1536
v_mfma_f32_16x16x32_bf16 v[208:211],a[176:179],v[172:175],v[208:211]
s_waitcnt lgkmcnt(4)
v_exp_f32 v144,v144
v_mfma_f32_16x16x32_bf16 v[0:3],a[224:227],v[172:175],v[0:3]
ds_read_b64_tr_b16 a[248:249],v225 offset:768
ds_read_b64_tr_b16 a[250:251],v225 offset:1792
v_mfma_f32_16x16x32_bf16 v[0:3],a[144:147],v[168:171],v[0:3]
buffer_load_dwordx4 v227,s[20:23],s34 offen offset:1024 nt lds
v_mfma_f32_16x16x32_bf16 v[4:7],a[148:151],v[168:171],v[4:7]
ds_read_b64_tr_b16 a[252:253],v226 offset:768
ds_read_b64_tr_b16 a[254:255],v226 offset:1792
v_mfma_f32_16x16x32_bf16 v[4:7],a[228:231],v[172:175],v[4:7]
v_exp_f32 v145,v145
v_mfma_f32_16x16x32_bf16 v[8:11],a[232:235],v[172:175],v[8:11]
v_exp_f32 v146,v146
v_mfma_f32_16x16x32_bf16 v[8:11],a[152:155],v[168:171],v[8:11]
v_exp_f32 v147,v147
v_mfma_f32_16x16x32_bf16 v[12:15],a[156:159],v[168:171],v[12:15]
v_cvt_pk_bf16_f32 v176,v144,v145
v_cvt_pk_bf16_f32 v177,v146,v147
v_mfma_f32_16x16x32_bf16 v[12:15],a[236:239],v[172:175],v[12:15]
s_waitcnt lgkmcnt(2)
v_exp_f32 v148,v148
v_mfma_f32_16x16x32_bf16 v[16:19],a[240:243],v[172:175],v[16:19]
v_exp_f32 v149,v149
v_mfma_f32_16x16x32_bf16 v[16:19],a[160:163],v[168:171],v[16:19]
v_exp_f32 v150,v150
v_mfma_f32_16x16x32_bf16 v[20:23],a[164:167],v[168:171],v[20:23]
P63:
s_cbranch_execz P191
v_mfma_f32_16x16x32_bf16 v[20:23],a[244:247],v[172:175],v[20:23]
v_exp_f32 v151,v151
v_mfma_f32_16x16x32_bf16 v[24:27],a[248:251],v[172:175],v[24:27]
v_cvt_pk_bf16_f32 v178,v148,v149
v_cvt_pk_bf16_f32 v179,v150,v151
v_mfma_f32_16x16x32_bf16 v[24:27],a[168:171],v[168:171],v[24:27]
v_exp_f32 v128,v128
v_mfma_f32_16x16x32_bf16 v[28:31],a[172:175],v[168:171],v[28:31]
s_waitcnt lgkmcnt(0)
v_exp_f32 v129,v129
v_mfma_f32_16x16x32_bf16 v[28:31],a[252:255],v[172:175],v[28:31]
v_exp_f32 v130,v130
v_mfma_f32_16x16x32_bf16 v[136:139],a[192:195],a[96:99],v[204:207]
v_exp_f32 v131,v131
v_mfma_f32_16x16x32_bf16 v[136:139],a[196:199],a[100:103],v[136:139]
v_cvt_pk_bf16_f32 v180,v128,v129
v_cvt_pk_bf16_f32 v181,v130,v131
v_mfma_f32_16x16x32_bf16 v[136:139],a[200:203],a[104:107],v[136:139]
v_exp_f32 v132,v132
v_mfma_f32_16x16x32_bf16 v[136:139],a[204:207],a[108:111],v[136:139]
buffer_load_dwordx4 v227,s[20:23],s34 offen offset:2048 nt lds
v_mfma_f32_16x16x32_bf16 v[140:143],a[208:211],a[108:111],v[204:207]
v_exp_f32 v133,v133
v_mfma_f32_16x16x32_bf16 v[140:143],a[212:215],a[104:107],v[140:143]
v_exp_f32 v134,v134
v_mfma_f32_16x16x32_bf16 v[140:143],a[216:219],a[100:103],v[140:143]
v_exp_f32 v135,v135
v_mfma_f32_16x16x32_bf16 v[140:143],a[220:223],a[96:99],v[140:143]
v_cvt_pk_bf16_f32 v182,v132,v133
v_cvt_pk_bf16_f32 v183,v134,v135
v_mfma_f32_16x16x32_bf16 v[208:211],a[180:183],v[176:179],v[208:211]
v_lshlrev_b32 v152,16,v248
v_and_b32 v153,0xffff0000,v248
v_mfma_f32_16x16x32_bf16 v[208:211],a[180:183],v[180:183],v[208:211]
v_mul_f32 v152,s80,v152
v_mul_f32 v153,s80,v153
v_mfma_f32_16x16x32_bf16 v[32:35],a[224:227],v[180:183],v[32:35]
v_cvt_pk_bf16_f32 v248,v152,v153
v_lshlrev_b32 v154,16,v249
v_mfma_f32_16x16x32_bf16 v[32:35],a[144:147],v[176:179],v[32:35]
P64:
s_cbranch_execz P192
v_mfma_f32_16x16x32_bf16 v[36:39],a[148:151],v[176:179],v[36:39]
v_and_b32 v155,0xffff0000,v249
v_mul_f32 v154,s80,v154
v_mfma_f32_16x16x32_bf16 v[36:39],a[228:231],v[180:183],v[36:39]
v_mul_f32 v155,s80,v155
v_cvt_pk_bf16_f32 v249,v154,v155
v_mfma_f32_16x16x32_bf16 v[40:43],a[232:235],v[180:183],v[40:43]
v_lshlrev_b32 v152,16,v250
v_and_b32 v153,0xffff0000,v250
v_mfma_f32_16x16x32_bf16 v[40:43],a[152:155],v[176:179],v[40:43]
v_mul_f32 v152,s80,v152
v_mul_f32 v153,s80,v153
v_mfma_f32_16x16x32_bf16 v[44:47],a[156:159],v[176:179],v[44:47]
v_cvt_pk_bf16_f32 v250,v152,v153
v_lshlrev_b32 v154,16,v251
v_mfma_f32_16x16x32_bf16 v[44:47],a[236:239],v[180:183],v[44:47]
v_and_b32 v155,0xffff0000,v251
v_mul_f32 v154,s80,v154
v_mfma_f32_16x16x32_bf16 v[48:51],a[240:243],v[180:183],v[48:51]
v_mul_f32 v155,s80,v155
v_cvt_pk_bf16_f32 v251,v154,v155
v_mfma_f32_16x16x32_bf16 v[48:51],a[160:163],v[176:179],v[48:51]
buffer_load_dwordx4 v227,s[20:23],s34 offen offset:3072 nt lds
v_mfma_f32_16x16x32_bf16 v[52:55],a[164:167],v[176:179],v[52:55]
ds_write_b128 v229,v[248:251] offset:2048
v_mfma_f32_16x16x32_bf16 v[52:55],a[244:247],v[180:183],v[52:55]
buffer_load_dwordx4 v[248:251],v228,s[12:15],s65 offen offset:2048 nt
v_mfma_f32_16x16x32_bf16 v[56:59],a[248:251],v[180:183],v[56:59]
v_exp_f32 v136,v136
v_mfma_f32_16x16x32_bf16 v[56:59],a[168:171],v[176:179],v[56:59]
v_exp_f32 v137,v137
v_mfma_f32_16x16x32_bf16 v[60:63],a[172:175],v[176:179],v[60:63]
v_exp_f32 v138,v138
v_mfma_f32_16x16x32_bf16 v[60:63],a[252:255],v[180:183],v[60:63]
v_exp_f32 v139,v139
v_mfma_f32_16x16x32_bf16 v[144:147],a[112:115],v[96:99],v[196:199]
P65:
s_cbranch_execz P193
v_mfma_f32_16x16x32_bf16 v[144:147],a[116:119],v[100:103],v[144:147]
s_waitcnt vmcnt(19)
v_cvt_pk_bf16_f32 v184,v136,v137
v_cvt_pk_bf16_f32 v185,v138,v139
v_mfma_f32_16x16x32_bf16 v[144:147],a[120:123],v[104:107],v[144:147]
v_exp_f32 v140,v140
v_mfma_f32_16x16x32_bf16 v[144:147],a[124:127],v[108:111],v[144:147]
v_exp_f32 v141,v141
v_mfma_f32_16x16x32_bf16 v[148:151],a[128:131],v[108:111],v[196:199]
v_exp_f32 v142,v142
v_mfma_f32_16x16x32_bf16 v[148:151],a[132:135],v[104:107],v[148:151]
v_exp_f32 v143,v143
v_mfma_f32_16x16x32_bf16 v[148:151],a[136:139],v[100:103],v[148:151]
v_cvt_pk_bf16_f32 v186,v140,v141
v_cvt_pk_bf16_f32 v187,v142,v143
v_mfma_f32_16x16x32_bf16 v[148:151],a[140:143],v[96:99],v[148:151]
v_exp_f32 v144,v144
v_mfma_f32_16x16x32_bf16 v[128:131],a[192:195],v[96:99],v[196:199]
v_exp_f32 v145,v145
v_mfma_f32_16x16x32_bf16 v[128:131],a[196:199],v[100:103],v[128:131]
v_exp_f32 v146,v146
v_mfma_f32_16x16x32_bf16 v[128:131],a[200:203],v[104:107],v[128:131]
v_exp_f32 v147,v147
v_mfma_f32_16x16x32_bf16 v[128:131],a[204:207],v[108:111],v[128:131]
v_cvt_pk_bf16_f32 v168,v144,v145
v_cvt_pk_bf16_f32 v169,v146,v147
v_mfma_f32_16x16x32_bf16 v[132:135],a[208:211],v[108:111],v[196:199]
v_exp_f32 v148,v148
v_mfma_f32_16x16x32_bf16 v[132:135],a[212:215],v[104:107],v[132:135]
v_exp_f32 v149,v149
v_mfma_f32_16x16x32_bf16 v[132:135],a[216:219],v[100:103],v[132:135]
v_exp_f32 v150,v150
v_mfma_f32_16x16x32_bf16 v[132:135],a[220:223],v[96:99],v[132:135]
v_exp_f32 v151,v151
v_mfma_f32_16x16x32_bf16 v[212:215],a[176:179],v[184:187],v[212:215]
v_cvt_pk_bf16_f32 v170,v148,v149
v_cvt_pk_bf16_f32 v171,v150,v151
v_mfma_f32_16x16x32_bf16 a[0:3],a[224:227],v[184:187],a[0:3]
P66:
s_cbranch_execz P194
v_mfma_f32_16x16x32_bf16 a[4:7],a[228:231],v[184:187],a[4:7]
v_exp_f32 v128,v128
v_mfma_f32_16x16x32_bf16 a[8:11],a[232:235],v[184:187],a[8:11]
s_add_u32 m0,s30,49152
v_exp_f32 v129,v129
v_mfma_f32_16x16x32_bf16 a[12:15],a[236:239],v[184:187],a[12:15]
s_mov_b32 s34,147456
v_xor_b32 v224,0x18800,v224
v_lshlrev_b32 v152,16,v252
v_mfma_f32_16x16x32_bf16 a[16:19],a[240:243],v[184:187],a[16:19]
v_exp_f32 v130,v130
v_mfma_f32_16x16x32_bf16 a[20:23],a[244:247],v[184:187],a[20:23]
v_exp_f32 v131,v131
v_mfma_f32_16x16x32_bf16 a[24:27],a[248:251],v[184:187],a[24:27]
s_waitcnt vmcnt(10) lgkmcnt(0)
s_barrier
v_mfma_f32_16x16x32_bf16 a[28:31],a[252:255],v[184:187],a[28:31]
v_cvt_pk_bf16_f32 v172,v128,v129
v_cvt_pk_bf16_f32 v173,v130,v131
v_mfma_f32_16x16x32_bf16 v[136:139],a[112:115],v[112:115],v[200:203]
v_exp_f32 v132,v132
v_mfma_f32_16x16x32_bf16 v[136:139],a[116:119],v[116:119],v[136:139]
v_exp_f32 v133,v133
v_mfma_f32_16x16x32_bf16 v[136:139],a[120:123],v[120:123],v[136:139]
buffer_load_dwordx4 v227,s[16:19],s34 offen nt lds
v_mfma_f32_16x16x32_bf16 v[136:139],a[124:127],v[124:127],v[136:139]
v_exp_f32 v134,v134
v_mfma_f32_16x16x32_bf16 v[140:143],a[128:131],v[124:127],v[200:203]
v_exp_f32 v135,v135
v_mfma_f32_16x16x32_bf16 v[140:143],a[132:135],v[120:123],v[140:143]
ds_read_b128 a[112:115],v224
v_cvt_pk_bf16_f32 v174,v132,v133
v_mfma_f32_16x16x32_bf16 v[140:143],a[136:139],v[116:119],v[140:143]
ds_read_b128 a[116:119],v224 offset:256
v_cvt_pk_bf16_f32 v175,v134,v135
v_mfma_f32_16x16x32_bf16 v[140:143],a[140:143],v[112:115],v[140:143]
v_and_b32 v153,0xffff0000,v252
v_mul_f32 v152,s80,v152
v_mfma_f32_16x16x32_bf16 v[144:147],a[192:195],v[112:115],v[200:203]
P67:
s_cbranch_execz P195
v_mfma_f32_16x16x32_bf16 v[144:147],a[196:199],v[116:119],v[144:147]
ds_read_b128 a[120:123],v224 offset:512
ds_read_b128 a[124:127],v224 offset:768
v_mfma_f32_16x16x32_bf16 v[144:147],a[200:203],v[120:123],v[144:147]
v_mul_f32 v153,s80,v153
v_cvt_pk_bf16_f32 v252,v152,v153
v_mfma_f32_16x16x32_bf16 v[144:147],a[204:207],v[124:127],v[144:147]
ds_read_b128 a[128:131],v224 offset:1792
ds_read_b128 a[132:135],v224 offset:1536
v_mfma_f32_16x16x32_bf16 v[148:151],a[208:211],v[124:127],v[200:203]
v_lshlrev_b32 v154,16,v253
v_and_b32 v155,0xffff0000,v253
v_mfma_f32_16x16x32_bf16 v[148:151],a[212:215],v[120:123],v[148:151]
ds_read_b128 a[136:139],v224 offset:1280
ds_read_b128 a[140:143],v224 offset:1024
v_mfma_f32_16x16x32_bf16 v[148:151],a[216:219],v[116:119],v[148:151]
v_exp_f32 v136,v136
v_mfma_f32_16x16x32_bf16 v[148:151],a[220:223],v[112:115],v[148:151]
v_xor_b32 v224,0x800,v224
v_mul_f32 v154,s80,v154
v_mfma_f32_16x16x32_bf16 v[208:211],a[184:187],v[168:171],v[208:211]
ds_read_b128 a[192:195],v224
v_mul_f32 v155,s80,v155
v_mfma_f32_16x16x32_bf16 v[208:211],a[184:187],v[172:175],v[208:211]
v_exp_f32 v137,v137
v_mfma_f32_16x16x32_bf16 a[32:35],a[224:227],v[172:175],a[32:35]
ds_read_b128 a[196:199],v224 offset:256
v_cvt_pk_bf16_f32 v253,v154,v155
v_mfma_f32_16x16x32_bf16 a[32:35],a[144:147],v[168:171],a[32:35]
buffer_load_dwordx4 v227,s[16:19],s34 offen offset:1024 nt lds
v_mfma_f32_16x16x32_bf16 a[36:39],a[148:151],v[168:171],a[36:39]
ds_read_b128 a[200:203],v224 offset:512
v_lshlrev_b32 v152,16,v254
v_mfma_f32_16x16x32_bf16 a[36:39],a[228:231],v[172:175],a[36:39]
P68:
s_cbranch_execz P196
v_mfma_f32_16x16x32_bf16 a[40:43],a[232:235],v[172:175],a[40:43]
v_exp_f32 v138,v138
v_mfma_f32_16x16x32_bf16 a[40:43],a[152:155],v[168:171],a[40:43]
ds_read_b128 a[204:207],v224 offset:768
v_and_b32 v153,0xffff0000,v254
v_mfma_f32_16x16x32_bf16 a[44:47],a[156:159],v[168:171],a[44:47]
v_mul_f32 v152,s80,v152
v_mul_f32 v153,s80,v153
v_mfma_f32_16x16x32_bf16 a[44:47],a[236:239],v[172:175],a[44:47]
v_exp_f32 v139,v139
v_mfma_f32_16x16x32_bf16 a[48:51],a[240:243],v[172:175],a[48:51]
ds_read_b128 a[208:211],v224 offset:1792
v_cvt_pk_bf16_f32 v254,v152,v153
v_mfma_f32_16x16x32_bf16 a[48:51],a[160:163],v[168:171],a[48:51]
ds_read_b128 a[212:215],v224 offset:1536
v_cvt_pk_bf16_f32 v176,v136,v137
v_mfma_f32_16x16x32_bf16 a[52:55],a[164:167],v[168:171],a[52:55]
v_lshlrev_b32 v154,16,v255
v_cvt_pk_bf16_f32 v177,v138,v139
v_mfma_f32_16x16x32_bf16 a[52:55],a[244:247],v[172:175],a[52:55]
ds_read_b128 a[216:219],v224 offset:1280
v_and_b32 v155,0xffff0000,v255
v_mfma_f32_16x16x32_bf16 a[56:59],a[248:251],v[172:175],a[56:59]
ds_read_b128 a[220:223],v224 offset:1024
v_mul_f32 v154,s80,v154
v_mfma_f32_16x16x32_bf16 a[56:59],a[168:171],v[168:171],a[56:59]
v_exp_f32 v140,v140
v_mfma_f32_16x16x32_bf16 a[60:63],a[172:175],v[168:171],a[60:63]
v_mul_f32 v155,s80,v155
v_cvt_pk_bf16_f32 v255,v154,v155
v_mfma_f32_16x16x32_bf16 a[60:63],a[252:255],v[172:175],a[60:63]
s_waitcnt lgkmcnt(2)
v_exp_f32 v141,v141
v_mfma_f32_16x16x32_bf16 v[128:131],a[112:115],v[64:67],v[188:191]
ds_write_b128 v230,v[252:255] offset:3072
v_mfma_f32_16x16x32_bf16 v[128:131],a[116:119],v[68:71],v[128:131]
P69:
s_cbranch_execz P197
v_mfma_f32_16x16x32_bf16 v[128:131],a[120:123],v[72:75],v[128:131]
v_exp_f32 v142,v142
v_mfma_f32_16x16x32_bf16 v[128:131],a[124:127],v[76:79],v[128:131]
buffer_load_dwordx4 v[252:255],v228,s[12:15],s65 offen offset:3072 nt
v_exp_f32 v143,v143
v_mfma_f32_16x16x32_bf16 v[132:135],a[128:131],v[76:79],v[188:191]
buffer_load_dwordx4 v227,s[16:19],s34 offen offset:2048 nt lds
v_cvt_pk_bf16_f32 v178,v140,v141
v_mfma_f32_16x16x32_bf16 v[132:135],a[132:135],v[72:75],v[132:135]
v_cvt_pk_bf16_f32 v179,v142,v143
v_xor_b32 v225,0x10800,v225
v_mfma_f32_16x16x32_bf16 v[132:135],a[136:139],v[68:71],v[132:135]
v_exp_f32 v144,v144
v_mfma_f32_16x16x32_bf16 v[132:135],a[140:143],v[64:67],v[132:135]
v_exp_f32 v145,v145
v_mfma_f32_16x16x32_bf16 v[136:139],a[192:195],v[64:67],v[188:191]
v_exp_f32 v146,v146
v_mfma_f32_16x16x32_bf16 v[136:139],a[196:199],v[68:71],v[136:139]
v_exp_f32 v147,v147
v_mfma_f32_16x16x32_bf16 v[136:139],a[200:203],v[72:75],v[136:139]
v_cvt_pk_bf16_f32 v180,v144,v145
v_cvt_pk_bf16_f32 v181,v146,v147
v_mfma_f32_16x16x32_bf16 v[136:139],a[204:207],v[76:79],v[136:139]
v_exp_f32 v148,v148
v_mfma_f32_16x16x32_bf16 v[140:143],a[208:211],v[76:79],v[188:191]
v_exp_f32 v149,v149
v_mfma_f32_16x16x32_bf16 v[140:143],a[212:215],v[72:75],v[140:143]
s_waitcnt lgkmcnt(0)
v_exp_f32 v150,v150
v_mfma_f32_16x16x32_bf16 v[140:143],a[216:219],v[68:71],v[140:143]
v_exp_f32 v151,v151
v_mfma_f32_16x16x32_bf16 v[140:143],a[220:223],v[64:67],v[140:143]
v_cvt_pk_bf16_f32 v182,v148,v149
v_cvt_pk_bf16_f32 v183,v150,v151
v_mfma_f32_16x16x32_bf16 v[208:211],a[188:191],v[176:179],v[208:211]
v_xor_b32 v226,0x10800,v226
v_lshlrev_b32 v152,16,v240
v_mfma_f32_16x16x32_bf16 v[208:211],a[188:191],v[180:183],v[208:211]
P70:
s_cbranch_execz P198
v_mfma_f32_16x16x32_bf16 a[64:67],a[224:227],v[180:183],a[64:67]
v_exp_f32 v128,v128
v_mfma_f32_16x16x32_bf16 a[64:67],a[144:147],v[176:179],a[64:67]
ds_read_b64_tr_b16 a[144:145],v225
ds_read_b64_tr_b16 a[146:147],v225 offset:1024
v_mfma_f32_16x16x32_bf16 a[68:71],a[148:151],v[176:179],a[68:71]
ds_read_b64_tr_b16 a[148:149],v226
ds_read_b64_tr_b16 a[150:151],v226 offset:1024
v_mfma_f32_16x16x32_bf16 a[68:71],a[228:231],v[180:183],a[68:71]
buffer_load_dwordx4 v227,s[16:19],s34 offen offset:3072 nt lds
v_mfma_f32_16x16x32_bf16 a[72:75],a[232:235],v[180:183],a[72:75]
v_exp_f32 v129,v129
v_mfma_f32_16x16x32_bf16 a[72:75],a[152:155],v[176:179],a[72:75]
ds_read_b64_tr_b16 a[152:153],v225 offset:256
ds_read_b64_tr_b16 a[154:155],v225 offset:1280
v_mfma_f32_16x16x32_bf16 a[76:79],a[156:159],v[176:179],a[76:79]
v_exp_f32 v130,v130
v_mfma_f32_16x16x32_bf16 a[76:79],a[236:239],v[180:183],a[76:79]
ds_read_b64_tr_b16 a[156:157],v226 offset:256
ds_read_b64_tr_b16 a[158:159],v226 offset:1280
v_mfma_f32_16x16x32_bf16 a[80:83],a[240:243],v[180:183],a[80:83]
v_exp_f32 v131,v131
v_mfma_f32_16x16x32_bf16 a[80:83],a[160:163],v[176:179],a[80:83]
ds_read_b64_tr_b16 a[160:161],v225 offset:512
ds_read_b64_tr_b16 a[162:163],v225 offset:1536
v_mfma_f32_16x16x32_bf16 a[84:87],a[164:167],v[176:179],a[84:87]
s_add_u32 m0,s30,65536
v_cvt_pk_bf16_f32 v168,v128,v129
v_cvt_pk_bf16_f32 v169,v130,v131
v_mfma_f32_16x16x32_bf16 a[84:87],a[244:247],v[180:183],a[84:87]
s_mov_b32 s34,147456
ds_read_b64_tr_b16 a[164:165],v226 offset:512
ds_read_b64_tr_b16 a[166:167],v226 offset:1536
v_mfma_f32_16x16x32_bf16 a[88:91],a[248:251],v[180:183],a[88:91]
P71:
s_cbranch_execz P199
v_mfma_f32_16x16x32_bf16 a[88:91],a[168:171],v[176:179],a[88:91]
ds_read_b64_tr_b16 a[168:169],v225 offset:768
ds_read_b64_tr_b16 a[170:171],v225 offset:1792
v_mfma_f32_16x16x32_bf16 a[92:95],a[172:175],v[176:179],a[92:95]
v_exp_f32 v132,v132
v_mfma_f32_16x16x32_bf16 a[92:95],a[252:255],v[180:183],a[92:95]
v_exp_f32 v133,v133
v_mfma_f32_16x16x32_bf16 v[144:147],a[112:115],v[80:83],v[192:195]
ds_read_b64_tr_b16 a[172:173],v226 offset:768
ds_read_b64_tr_b16 a[174:175],v226 offset:1792
v_mfma_f32_16x16x32_bf16 v[144:147],a[116:119],v[84:87],v[144:147]
v_exp_f32 v134,v134
v_mfma_f32_16x16x32_bf16 v[144:147],a[120:123],v[88:91],v[144:147]
v_xor_b32 v225,0x800,v225
v_xor_b32 v226,0x800,v226
v_mfma_f32_16x16x32_bf16 v[144:147],a[124:127],v[92:95],v[144:147]
ds_read_b64_tr_b16 a[224:225],v225
v_exp_f32 v135,v135
v_mfma_f32_16x16x32_bf16 v[148:151],a[128:131],v[92:95],v[192:195]
ds_read_b64_tr_b16 a[226:227],v225 offset:1024
buffer_load_dwordx4 v227,s[20:23],s34 offen nt lds
v_cvt_pk_bf16_f32 v170,v132,v133
v_mfma_f32_16x16x32_bf16 v[148:151],a[132:135],v[88:91],v[148:151]
v_cvt_pk_bf16_f32 v171,v134,v135
v_and_b32 v153,0xffff0000,v240
v_mfma_f32_16x16x32_bf16 v[148:151],a[136:139],v[84:87],v[148:151]
ds_read_b64_tr_b16 a[228:229],v226
ds_read_b64_tr_b16 a[230:231],v226 offset:1024
v_exp_f32 v136,v136
v_mfma_f32_16x16x32_bf16 v[148:151],a[140:143],v[80:83],v[148:151]
v_exp_f32 v137,v137
v_mfma_f32_16x16x32_bf16 v[128:131],a[192:195],v[80:83],v[192:195]
ds_read_b64_tr_b16 a[232:233],v225 offset:256
v_exp_f32 v138,v138
v_mfma_f32_16x16x32_bf16 v[128:131],a[196:199],v[84:87],v[128:131]
ds_read_b64_tr_b16 a[234:235],v225 offset:1280
v_exp_f32 v139,v139
v_mfma_f32_16x16x32_bf16 v[128:131],a[200:203],v[88:91],v[128:131]
v_cvt_pk_bf16_f32 v172,v136,v137
v_cvt_pk_bf16_f32 v173,v138,v139
v_mfma_f32_16x16x32_bf16 v[128:131],a[204:207],v[92:95],v[128:131]
P72:
s_cbranch_execz P200
ds_read_b64_tr_b16 a[236:237],v226 offset:256
ds_read_b64_tr_b16 a[238:239],v226 offset:1280
v_exp_f32 v140,v140
v_mfma_f32_16x16x32_bf16 v[132:135],a[208:211],v[92:95],v[192:195]
v_exp_f32 v141,v141
v_mfma_f32_16x16x32_bf16 v[132:135],a[212:215],v[88:91],v[132:135]
ds_read_b64_tr_b16 a[240:241],v225 offset:512
v_exp_f32 v142,v142
v_mfma_f32_16x16x32_bf16 v[132:135],a[216:219],v[84:87],v[132:135]
ds_read_b64_tr_b16 a[242:243],v225 offset:1536
v_exp_f32 v143,v143
v_mfma_f32_16x16x32_bf16 v[132:135],a[220:223],v[80:83],v[132:135]
v_cvt_pk_bf16_f32 v174,v140,v141
v_cvt_pk_bf16_f32 v175,v142,v143
v_mfma_f32_16x16x32_bf16 v[208:211],a[176:179],v[168:171],v[208:211]
ds_read_b64_tr_b16 a[244:245],v226 offset:512
ds_read_b64_tr_b16 a[246:247],v226 offset:1536
v_mfma_f32_16x16x32_bf16 v[208:211],a[176:179],v[172:175],v[208:211]
s_waitcnt lgkmcnt(4)
v_exp_f32 v144,v144
v_mfma_f32_16x16x32_bf16 v[0:3],a[224:227],v[172:175],v[0:3]
ds_read_b64_tr_b16 a[248:249],v225 offset:768
ds_read_b64_tr_b16 a[250:251],v225 offset:1792
v_mfma_f32_16x16x32_bf16 v[0:3],a[144:147],v[168:171],v[0:3]
buffer_load_dwordx4 v227,s[20:23],s34 offen offset:1024 nt lds
v_mfma_f32_16x16x32_bf16 v[4:7],a[148:151],v[168:171],v[4:7]
ds_read_b64_tr_b16 a[252:253],v226 offset:768
ds_read_b64_tr_b16 a[254:255],v226 offset:1792
v_mfma_f32_16x16x32_bf16 v[4:7],a[228:231],v[172:175],v[4:7]
P73:
s_cbranch_execz P201
v_mfma_f32_16x16x32_bf16 v[8:11],a[232:235],v[172:175],v[8:11]
v_exp_f32 v145,v145
v_mfma_f32_16x16x32_bf16 v[8:11],a[152:155],v[168:171],v[8:11]
v_exp_f32 v146,v146
v_mfma_f32_16x16x32_bf16 v[12:15],a[156:159],v[168:171],v[12:15]
v_exp_f32 v147,v147
v_mfma_f32_16x16x32_bf16 v[12:15],a[236:239],v[172:175],v[12:15]
s_waitcnt lgkmcnt(2)
v_cvt_pk_bf16_f32 v176,v144,v145
v_cvt_pk_bf16_f32 v177,v146,v147
v_mfma_f32_16x16x32_bf16 v[16:19],a[240:243],v[172:175],v[16:19]
v_exp_f32 v148,v148
v_mfma_f32_16x16x32_bf16 v[16:19],a[160:163],v[168:171],v[16:19]
v_exp_f32 v149,v149
v_mfma_f32_16x16x32_bf16 v[20:23],a[164:167],v[168:171],v[20:23]
v_exp_f32 v150,v150
v_mfma_f32_16x16x32_bf16 v[20:23],a[244:247],v[172:175],v[20:23]
v_exp_f32 v151,v151
v_mfma_f32_16x16x32_bf16 v[24:27],a[248:251],v[172:175],v[24:27]
v_cvt_pk_bf16_f32 v178,v148,v149
v_cvt_pk_bf16_f32 v179,v150,v151
v_mfma_f32_16x16x32_bf16 v[24:27],a[168:171],v[168:171],v[24:27]
v_exp_f32 v128,v128
v_mfma_f32_16x16x32_bf16 v[28:31],a[172:175],v[168:171],v[28:31]
s_waitcnt lgkmcnt(0)
v_exp_f32 v129,v129
v_mfma_f32_16x16x32_bf16 v[28:31],a[252:255],v[172:175],v[28:31]
v_exp_f32 v130,v130
v_mfma_f32_16x16x32_bf16 v[136:139],a[192:195],a[96:99],v[204:207]
v_exp_f32 v131,v131
v_mfma_f32_16x16x32_bf16 v[136:139],a[196:199],a[100:103],v[136:139]
v_cvt_pk_bf16_f32 v180,v128,v129
v_cvt_pk_bf16_f32 v181,v130,v131
v_mfma_f32_16x16x32_bf16 v[136:139],a[200:203],a[104:107],v[136:139]
v_exp_f32 v132,v132
v_mfma_f32_16x16x32_bf16 v[136:139],a[204:207],a[108:111],v[136:139]
buffer_load_dwordx4 v227,s[20:23],s34 offen offset:2048 nt lds
v_mfma_f32_16x16x32_bf16 v[140:143],a[208:211],a[108:111],v[204:207]
v_exp_f32 v133,v133
v_mfma_f32_16x16x32_bf16 v[140:143],a[212:215],a[104:107],v[140:143]
v_exp_f32 v134,v134
v_mfma_f32_16x16x32_bf16 v[140:143],a[216:219],a[100:103],v[140:143]
v_exp_f32 v135,v135
v_mfma_f32_16x16x32_bf16 v[140:143],a[220:223],a[96:99],v[140:143]
P74:
s_cbranch_execz P202
v_cvt_pk_bf16_f32 v182,v132,v133
v_mfma_f32_16x16x32_bf16 v[208:211],a[180:183],v[176:179],v[208:211]
v_cvt_pk_bf16_f32 v183,v134,v135
v_mul_f32 v152,s80,v152
s_nop 0
v_mfma_f32_16x16x32_bf16 v[208:211],a[180:183],v[180:183],v[208:211]
v_mul_f32 v153,s80,v153
v_cvt_pk_bf16_f32 v240,v152,v153
v_mfma_f32_16x16x32_bf16 v[32:35],a[224:227],v[180:183],v[32:35]
v_lshlrev_b32 v154,16,v241
v_and_b32 v155,0xffff0000,v241
v_mfma_f32_16x16x32_bf16 v[32:35],a[144:147],v[176:179],v[32:35]
v_mul_f32 v154,s80,v154
v_mul_f32 v155,s80,v155
v_mfma_f32_16x16x32_bf16 v[36:39],a[148:151],v[176:179],v[36:39]
v_cvt_pk_bf16_f32 v241,v154,v155
v_lshlrev_b32 v152,16,v242
v_mfma_f32_16x16x32_bf16 v[36:39],a[228:231],v[180:183],v[36:39]
v_and_b32 v153,0xffff0000,v242
v_mul_f32 v152,s80,v152
v_mfma_f32_16x16x32_bf16 v[40:43],a[232:235],v[180:183],v[40:43]
v_mul_f32 v153,s80,v153
v_cvt_pk_bf16_f32 v242,v152,v153
v_mfma_f32_16x16x32_bf16 v[40:43],a[152:155],v[176:179],v[40:43]
v_lshlrev_b32 v154,16,v243
v_and_b32 v155,0xffff0000,v243
v_mfma_f32_16x16x32_bf16 v[44:47],a[156:159],v[176:179],v[44:47]
v_mul_f32 v154,s80,v154
v_mul_f32 v155,s80,v155
v_mfma_f32_16x16x32_bf16 v[44:47],a[236:239],v[180:183],v[44:47]
v_cvt_pk_bf16_f32 v243,v154,v155
v_xor_b32 v224,0x10800,v224
v_mfma_f32_16x16x32_bf16 v[48:51],a[240:243],v[180:183],v[48:51]
P75:
s_cbranch_execz P203
Z4:
s_cbranch_execz Z8
v_mfma_f32_16x16x32_bf16 v[48:51],a[160:163],v[176:179],v[48:51]
buffer_load_dwordx4 v227,s[20:23],s34 offen offset:3072 nt lds
v_mfma_f32_16x16x32_bf16 v[52:55],a[164:167],v[176:179],v[52:55]
ds_write_b128 v229,v[240:243] offset:16384
v_mfma_f32_16x16x32_bf16 v[52:55],a[244:247],v[180:183],v[52:55]
buffer_load_dwordx4 v[240:243],v228,s[12:15],s66 offen nt
v_mfma_f32_16x16x32_bf16 v[56:59],a[248:251],v[180:183],v[56:59]
v_exp_f32 v136,v136
v_mfma_f32_16x16x32_bf16 v[56:59],a[168:171],v[176:179],v[56:59]
v_exp_f32 v137,v137
v_mfma_f32_16x16x32_bf16 v[60:63],a[172:175],v[176:179],v[60:63]
v_exp_f32 v138,v138
v_mfma_f32_16x16x32_bf16 v[60:63],a[252:255],v[180:183],v[60:63]
v_exp_f32 v139,v139
v_mfma_f32_16x16x32_bf16 v[144:147],a[112:115],v[96:99],v[196:199]
s_waitcnt vmcnt(17)
v_cvt_pk_bf16_f32 v184,v136,v137
v_cvt_pk_bf16_f32 v185,v138,v139
v_mfma_f32_16x16x32_bf16 v[144:147],a[116:119],v[100:103],v[144:147]
v_exp_f32 v140,v140
v_mfma_f32_16x16x32_bf16 v[144:147],a[120:123],v[104:107],v[144:147]
v_exp_f32 v141,v141
v_mfma_f32_16x16x32_bf16 v[144:147],a[124:127],v[108:111],v[144:147]
v_exp_f32 v142,v142
v_mfma_f32_16x16x32_bf16 v[148:151],a[128:131],v[108:111],v[196:199]
v_exp_f32 v143,v143
v_mfma_f32_16x16x32_bf16 v[148:151],a[132:135],v[104:107],v[148:151]
v_cvt_pk_bf16_f32 v186,v140,v141
v_cvt_pk_bf16_f32 v187,v142,v143
v_mfma_f32_16x16x32_bf16 v[148:151],a[136:139],v[100:103],v[148:151]
v_lshlrev_b32 v152,16,v244
v_and_b32 v153,0xffff0000,v244
v_mfma_f32_16x16x32_bf16 v[148:151],a[140:143],v[96:99],v[148:151]
v_exp_f32 v144,v144
v_mfma_f32_16x16x32_bf16 v[128:131],a[192:195],v[96:99],v[196:199]
v_exp_f32 v145,v145
v_mfma_f32_16x16x32_bf16 v[128:131],a[196:199],v[100:103],v[128:131]
P76:
s_cbranch_execz P204
v_mfma_f32_16x16x32_bf16 v[128:131],a[200:203],v[104:107],v[128:131]
v_exp_f32 v146,v146
v_mfma_f32_16x16x32_bf16 v[128:131],a[204:207],v[108:111],v[128:131]
v_exp_f32 v147,v147
v_mfma_f32_16x16x32_bf16 v[132:135],a[208:211],v[108:111],v[196:199]
v_cvt_pk_bf16_f32 v168,v144,v145
v_cvt_pk_bf16_f32 v169,v146,v147
v_mfma_f32_16x16x32_bf16 v[132:135],a[212:215],v[104:107],v[132:135]
v_exp_f32 v148,v148
v_mfma_f32_16x16x32_bf16 v[132:135],a[216:219],v[100:103],v[132:135]
v_exp_f32 v149,v149
v_mfma_f32_16x16x32_bf16 v[132:135],a[220:223],v[96:99],v[132:135]
v_exp_f32 v150,v150
v_mfma_f32_16x16x32_bf16 v[212:215],a[176:179],v[184:187],v[212:215]
v_exp_f32 v151,v151
v_mfma_f32_16x16x32_bf16 a[0:3],a[224:227],v[184:187],a[0:3]
v_cvt_pk_bf16_f32 v170,v148,v149
v_cvt_pk_bf16_f32 v171,v150,v151
v_mfma_f32_16x16x32_bf16 a[4:7],a[228:231],v[184:187],a[4:7]
v_exp_f32 v128,v128
v_mfma_f32_16x16x32_bf16 a[8:11],a[232:235],v[184:187],a[8:11]
s_add_u32 m0,s30,81920
v_exp_f32 v129,v129
v_mfma_f32_16x16x32_bf16 a[12:15],a[236:239],v[184:187],a[12:15]
s_mov_b32 s34,163840
v_exp_f32 v130,v130
v_mfma_f32_16x16x32_bf16 a[16:19],a[240:243],v[184:187],a[16:19]
v_exp_f32 v131,v131
v_mfma_f32_16x16x32_bf16 a[20:23],a[244:247],v[184:187],a[20:23]
v_cvt_pk_bf16_f32 v172,v128,v129
v_cvt_pk_bf16_f32 v173,v130,v131
v_mfma_f32_16x16x32_bf16 a[24:27],a[248:251],v[184:187],a[24:27]
s_waitcnt vmcnt(11) lgkmcnt(0)
s_barrier
v_mfma_f32_16x16x32_bf16 a[28:31],a[252:255],v[184:187],a[28:31]
v_exp_f32 v132,v132
v_mfma_f32_16x16x32_bf16 v[136:139],a[112:115],v[112:115],v[200:203]
v_exp_f32 v133,v133
v_mfma_f32_16x16x32_bf16 v[136:139],a[116:119],v[116:119],v[136:139]
P77:
s_cbranch_execz P205
v_mfma_f32_16x16x32_bf16 v[136:139],a[120:123],v[120:123],v[136:139]
buffer_load_dwordx4 v227,s[16:19],s34 offen nt lds
v_mfma_f32_16x16x32_bf16 v[136:139],a[124:127],v[124:127],v[136:139]
v_exp_f32 v134,v134
v_mfma_f32_16x16x32_bf16 v[140:143],a[128:131],v[124:127],v[200:203]
v_exp_f32 v135,v135
v_mfma_f32_16x16x32_bf16 v[140:143],a[132:135],v[120:123],v[140:143]
ds_read_b128 a[112:115],v224
v_cvt_pk_bf16_f32 v174,v132,v133
v_mfma_f32_16x16x32_bf16 v[140:143],a[136:139],v[116:119],v[140:143]
ds_read_b128 a[116:119],v224 offset:256
v_cvt_pk_bf16_f32 v175,v134,v135
v_mfma_f32_16x16x32_bf16 v[140:143],a[140:143],v[112:115],v[140:143]
v_mul_f32 v152,s80,v152
v_mul_f32 v153,s80,v153
v_mfma_f32_16x16x32_bf16 v[144:147],a[192:195],v[112:115],v[200:203]
ds_read_b128 a[120:123],v224 offset:512
ds_read_b128 a[124:127],v224 offset:768
v_mfma_f32_16x16x32_bf16 v[144:147],a[196:199],v[116:119],v[144:147]
v_cvt_pk_bf16_f32 v244,v152,v153
v_lshlrev_b32 v154,16,v245
v_mfma_f32_16x16x32_bf16 v[144:147],a[200:203],v[120:123],v[144:147]
ds_read_b128 a[128:131],v224 offset:1792
ds_read_b128 a[132:135],v224 offset:1536
v_mfma_f32_16x16x32_bf16 v[144:147],a[204:207],v[124:127],v[144:147]
v_and_b32 v155,0xffff0000,v245
v_mul_f32 v154,s80,v154
v_mfma_f32_16x16x32_bf16 v[148:151],a[208:211],v[124:127],v[200:203]
ds_read_b128 a[136:139],v224 offset:1280
ds_read_b128 a[140:143],v224 offset:1024
v_mfma_f32_16x16x32_bf16 v[148:151],a[212:215],v[120:123],v[148:151]
v_mul_f32 v155,s80,v155
v_xor_b32 v224,0x800,v224
v_mfma_f32_16x16x32_bf16 v[148:151],a[216:219],v[116:119],v[148:151]
P78:
s_cbranch_execz P206
v_mfma_f32_16x16x32_bf16 v[148:151],a[220:223],v[112:115],v[148:151]
v_exp_f32 v136,v136
v_mfma_f32_16x16x32_bf16 v[208:211],a[184:187],v[168:171],v[208:211]
ds_read_b128 a[192:195],v224
v_cvt_pk_bf16_f32 v245,v154,v155
v_mfma_f32_16x16x32_bf16 v[208:211],a[184:187],v[172:175],v[208:211]
ds_read_b128 a[196:199],v224 offset:256
v_lshlrev_b32 v152,16,v246
v_mfma_f32_16x16x32_bf16 a[32:35],a[224:227],v[172:175],a[32:35]
v_exp_f32 v137,v137
v_mfma_f32_16x16x32_bf16 a[32:35],a[144:147],v[168:171],a[32:35]
buffer_load_dwordx4 v227,s[16:19],s34 offen offset:1024 nt lds
v_mfma_f32_16x16x32_bf16 a[36:39],a[148:151],v[168:171],a[36:39]
ds_read_b128 a[200:203],v224 offset:512
v_and_b32 v153,0xffff0000,v246
v_mfma_f32_16x16x32_bf16 a[36:39],a[228:231],v[172:175],a[36:39]
ds_read_b128 a[204:207],v224 offset:768
v_mul_f32 v152,s80,v152
v_mfma_f32_16x16x32_bf16 a[40:43],a[232:235],v[172:175],a[40:43]
v_exp_f32 v138,v138
v_mfma_f32_16x16x32_bf16 a[40:43],a[152:155],v[168:171],a[40:43]
ds_read_b128 a[208:211],v224 offset:1792
v_mul_f32 v153,s80,v153
v_mfma_f32_16x16x32_bf16 a[44:47],a[156:159],v[168:171],a[44:47]
ds_read_b128 a[212:215],v224 offset:1536
v_cvt_pk_bf16_f32 v246,v152,v153
v_mfma_f32_16x16x32_bf16 a[44:47],a[236:239],v[172:175],a[44:47]
v_exp_f32 v139,v139
v_mfma_f32_16x16x32_bf16 a[48:51],a[240:243],v[172:175],a[48:51]
ds_read_b128 a[216:219],v224 offset:1280
v_lshlrev_b32 v154,16,v247
v_mfma_f32_16x16x32_bf16 a[48:51],a[160:163],v[168:171],a[48:51]
ds_read_b128 a[220:223],v224 offset:1024
v_and_b32 v155,0xffff0000,v247
v_mfma_f32_16x16x32_bf16 a[52:55],a[164:167],v[168:171],a[52:55]
v_cvt_pk_bf16_f32 v176,v136,v137
v_mul_f32 v154,s80,v154
v_mfma_f32_16x16x32_bf16 a[52:55],a[244:247],v[172:175],a[52:55]
P79:
s_cbranch_execz P207
v_mfma_f32_16x16x32_bf16 a[56:59],a[248:251],v[172:175],a[56:59]
v_cvt_pk_bf16_f32 v177,v138,v139
v_mul_f32 v155,s80,v155
v_mfma_f32_16x16x32_bf16 a[56:59],a[168:171],v[168:171],a[56:59]
v_cvt_pk_bf16_f32 v247,v154,v155
v_xor_b32 v225,0x8800,v225
v_mfma_f32_16x16x32_bf16 a[60:63],a[172:175],v[168:171],a[60:63]
v_exp_f32 v140,v140
v_mfma_f32_16x16x32_bf16 a[60:63],a[252:255],v[172:175],a[60:63]
s_waitcnt lgkmcnt(0)
ds_write_b128 v230,v[244:247] offset:17408
v_mfma_f32_16x16x32_bf16 v[128:131],a[112:115],v[64:67],v[188:191]
v_exp_f32 v141,v141
v_mfma_f32_16x16x32_bf16 v[128:131],a[116:119],v[68:71],v[128:131]
buffer_load_dwordx4 v[244:247],v228,s[12:15],s66 offen offset:1024 nt
v_mfma_f32_16x16x32_bf16 v[128:131],a[120:123],v[72:75],v[128:131]
v_exp_f32 v142,v142
v_mfma_f32_16x16x32_bf16 v[128:131],a[124:127],v[76:79],v[128:131]
v_exp_f32 v143,v143
v_mfma_f32_16x16x32_bf16 v[132:135],a[128:131],v[76:79],v[188:191]
buffer_load_dwordx4 v227,s[16:19],s34 offen offset:2048 nt lds
v_cvt_pk_bf16_f32 v178,v140,v141
v_mfma_f32_16x16x32_bf16 v[132:135],a[132:135],v[72:75],v[132:135]
s_waitcnt vmcnt(14)
v_cvt_pk_bf16_f32 v179,v142,v143
v_xor_b32 v226,0x8800,v226
v_mfma_f32_16x16x32_bf16 v[132:135],a[136:139],v[68:71],v[132:135]
v_exp_f32 v144,v144
v_mfma_f32_16x16x32_bf16 v[132:135],a[140:143],v[64:67],v[132:135]
v_exp_f32 v145,v145
v_mfma_f32_16x16x32_bf16 v[136:139],a[192:195],v[64:67],v[188:191]
v_exp_f32 v146,v146
v_mfma_f32_16x16x32_bf16 v[136:139],a[196:199],v[68:71],v[136:139]
v_exp_f32 v147,v147
v_mfma_f32_16x16x32_bf16 v[136:139],a[200:203],v[72:75],v[136:139]
v_cvt_pk_bf16_f32 v180,v144,v145
v_cvt_pk_bf16_f32 v181,v146,v147
v_mfma_f32_16x16x32_bf16 v[136:139],a[204:207],v[76:79],v[136:139]
v_exp_f32 v148,v148
v_mfma_f32_16x16x32_bf16 v[140:143],a[208:211],v[76:79],v[188:191]
P80:
s_cbranch_execz P208
v_exp_f32 v149,v149
v_mfma_f32_16x16x32_bf16 v[140:143],a[212:215],v[72:75],v[140:143]
v_exp_f32 v150,v150
v_mfma_f32_16x16x32_bf16 v[140:143],a[216:219],v[68:71],v[140:143]
v_exp_f32 v151,v151
v_mfma_f32_16x16x32_bf16 v[140:143],a[220:223],v[64:67],v[140:143]
v_cvt_pk_bf16_f32 v182,v148,v149
v_cvt_pk_bf16_f32 v183,v150,v151
v_mfma_f32_16x16x32_bf16 v[208:211],a[188:191],v[176:179],v[208:211]
v_exp_f32 v128,v128
v_mfma_f32_16x16x32_bf16 v[208:211],a[188:191],v[180:183],v[208:211]
v_exp_f32 v129,v129
v_mfma_f32_16x16x32_bf16 a[64:67],a[224:227],v[180:183],a[64:67]
v_exp_f32 v130,v130
v_mfma_f32_16x16x32_bf16 a[64:67],a[144:147],v[176:179],a[64:67]
ds_read_b64_tr_b16 a[144:145],v225
ds_read_b64_tr_b16 a[146:147],v225 offset:1024
v_mfma_f32_16x16x32_bf16 a[68:71],a[148:151],v[176:179],a[68:71]
ds_read_b64_tr_b16 a[148:149],v226
ds_read_b64_tr_b16 a[150:151],v226 offset:1024
v_mfma_f32_16x16x32_bf16 a[68:71],a[228:231],v[180:183],a[68:71]
buffer_load_dwordx4 v227,s[16:19],s34 offen offset:3072 nt lds
v_mfma_f32_16x16x32_bf16 a[72:75],a[232:235],v[180:183],a[72:75]
v_exp_f32 v131,v131
v_mfma_f32_16x16x32_bf16 a[72:75],a[152:155],v[176:179],a[72:75]
ds_read_b64_tr_b16 a[152:153],v225 offset:256
ds_read_b64_tr_b16 a[154:155],v225 offset:1280
v_mfma_f32_16x16x32_bf16 a[76:79],a[156:159],v[176:179],a[76:79]
v_cvt_pk_bf16_f32 v168,v128,v129
v_cvt_pk_bf16_f32 v169,v130,v131
v_mfma_f32_16x16x32_bf16 a[76:79],a[236:239],v[180:183],a[76:79]
ds_read_b64_tr_b16 a[156:157],v226 offset:256
ds_read_b64_tr_b16 a[158:159],v226 offset:1280
v_mfma_f32_16x16x32_bf16 a[80:83],a[240:243],v[180:183],a[80:83]
P81:
s_cbranch_execz P209
v_mfma_f32_16x16x32_bf16 a[80:83],a[160:163],v[176:179],a[80:83]
ds_read_b64_tr_b16 a[160:161],v225 offset:512
ds_read_b64_tr_b16 a[162:163],v225 offset:1536
v_mfma_f32_16x16x32_bf16 a[84:87],a[164:167],v[176:179],a[84:87]
s_add_u32 m0,s30,0
v_exp_f32 v132,v132
v_mfma_f32_16x16x32_bf16 a[84:87],a[244:247],v[180:183],a[84:87]
s_mov_b32 s34,163840
ds_read_b64_tr_b16 a[164:165],v226 offset:512
ds_read_b64_tr_b16 a[166:167],v226 offset:1536
v_mfma_f32_16x16x32_bf16 a[88:91],a[248:251],v[180:183],a[88:91]
v_exp_f32 v133,v133
v_mfma_f32_16x16x32_bf16 a[88:91],a[168:171],v[176:179],a[88:91]
ds_read_b64_tr_b16 a[168:169],v225 offset:768
ds_read_b64_tr_b16 a[170:171],v225 offset:1792
v_mfma_f32_16x16x32_bf16 a[92:95],a[172:175],v[176:179],a[92:95]
v_exp_f32 v134,v134
v_mfma_f32_16x16x32_bf16 a[92:95],a[252:255],v[180:183],a[92:95]
ds_read_b64_tr_b16 a[172:173],v226 offset:768
ds_read_b64_tr_b16 a[174:175],v226 offset:1792
v_mfma_f32_16x16x32_bf16 v[144:147],a[112:115],v[80:83],v[192:195]
v_xor_b32 v225,0x800,v225
v_xor_b32 v226,0x800,v226
v_mfma_f32_16x16x32_bf16 v[144:147],a[116:119],v[84:87],v[144:147]
v_exp_f32 v135,v135
v_mfma_f32_16x16x32_bf16 v[144:147],a[120:123],v[88:91],v[144:147]
ds_read_b64_tr_b16 a[224:225],v225
ds_read_b64_tr_b16 a[226:227],v225 offset:1024
v_mfma_f32_16x16x32_bf16 v[144:147],a[124:127],v[92:95],v[144:147]
buffer_load_dwordx4 v227,s[20:23],s34 offen nt lds
v_mfma_f32_16x16x32_bf16 v[148:151],a[128:131],v[92:95],v[192:195]
ds_read_b64_tr_b16 a[228:229],v226
v_cvt_pk_bf16_f32 v170,v132,v133
v_mfma_f32_16x16x32_bf16 v[148:151],a[132:135],v[88:91],v[148:151]
ds_read_b64_tr_b16 a[230:231],v226 offset:1024
v_cvt_pk_bf16_f32 v171,v134,v135
v_mfma_f32_16x16x32_bf16 v[148:151],a[136:139],v[84:87],v[148:151]
P82:
s_cbranch_execz P210
v_exp_f32 v136,v136
v_mfma_f32_16x16x32_bf16 v[148:151],a[140:143],v[80:83],v[148:151]
v_exp_f32 v137,v137
v_mfma_f32_16x16x32_bf16 v[128:131],a[192:195],v[80:83],v[192:195]
ds_read_b64_tr_b16 a[232:233],v225 offset:256
v_exp_f32 v138,v138
v_mfma_f32_16x16x32_bf16 v[128:131],a[196:199],v[84:87],v[128:131]
ds_read_b64_tr_b16 a[234:235],v225 offset:1280
v_exp_f32 v139,v139
v_mfma_f32_16x16x32_bf16 v[128:131],a[200:203],v[88:91],v[128:131]
v_cvt_pk_bf16_f32 v172,v136,v137
v_cvt_pk_bf16_f32 v173,v138,v139
v_mfma_f32_16x16x32_bf16 v[128:131],a[204:207],v[92:95],v[128:131]
ds_read_b64_tr_b16 a[236:237],v226 offset:256
ds_read_b64_tr_b16 a[238:239],v226 offset:1280
v_exp_f32 v140,v140
v_mfma_f32_16x16x32_bf16 v[132:135],a[208:211],v[92:95],v[192:195]
v_exp_f32 v141,v141
v_mfma_f32_16x16x32_bf16 v[132:135],a[212:215],v[88:91],v[132:135]
ds_read_b64_tr_b16 a[240:241],v225 offset:512
v_exp_f32 v142,v142
v_mfma_f32_16x16x32_bf16 v[132:135],a[216:219],v[84:87],v[132:135]
ds_read_b64_tr_b16 a[242:243],v225 offset:1536
v_exp_f32 v143,v143
v_mfma_f32_16x16x32_bf16 v[132:135],a[220:223],v[80:83],v[132:135]
v_cvt_pk_bf16_f32 v174,v140,v141
v_cvt_pk_bf16_f32 v175,v142,v143
v_mfma_f32_16x16x32_bf16 v[208:211],a[176:179],v[168:171],v[208:211]
ds_read_b64_tr_b16 a[244:245],v226 offset:512
ds_read_b64_tr_b16 a[246:247],v226 offset:1536
v_mfma_f32_16x16x32_bf16 v[208:211],a[176:179],v[172:175],v[208:211]
s_waitcnt lgkmcnt(4)
P83:
s_cbranch_execz P211
v_mfma_f32_16x16x32_bf16 v[0:3],a[224:227],v[172:175],v[0:3]
ds_read_b64_tr_b16 a[248:249],v225 offset:768
ds_read_b64_tr_b16 a[250:251],v225 offset:1792
v_mfma_f32_16x16x32_bf16 v[0:3],a[144:147],v[168:171],v[0:3]
v_exp_f32 v144,v144
v_mfma_f32_16x16x32_bf16 v[4:7],a[148:151],v[168:171],v[4:7]
buffer_load_dwordx4 v227,s[20:23],s34 offen offset:1024 nt lds
v_mfma_f32_16x16x32_bf16 v[4:7],a[228:231],v[172:175],v[4:7]
ds_read_b64_tr_b16 a[252:253],v226 offset:768
ds_read_b64_tr_b16 a[254:255],v226 offset:1792
v_mfma_f32_16x16x32_bf16 v[8:11],a[232:235],v[172:175],v[8:11]
v_exp_f32 v145,v145
v_mfma_f32_16x16x32_bf16 v[8:11],a[152:155],v[168:171],v[8:11]
v_exp_f32 v146,v146
v_mfma_f32_16x16x32_bf16 v[12:15],a[156:159],v[168:171],v[12:15]
v_exp_f32 v147,v147
v_mfma_f32_16x16x32_bf16 v[12:15],a[236:239],v[172:175],v[12:15]
s_waitcnt lgkmcnt(2)
v_cvt_pk_bf16_f32 v176,v144,v145
v_cvt_pk_bf16_f32 v177,v146,v147
v_mfma_f32_16x16x32_bf16 v[16:19],a[240:243],v[172:175],v[16:19]
v_exp_f32 v148,v148
v_mfma_f32_16x16x32_bf16 v[16:19],a[160:163],v[168:171],v[16:19]
v_exp_f32 v149,v149
v_mfma_f32_16x16x32_bf16 v[20:23],a[164:167],v[168:171],v[20:23]
v_exp_f32 v150,v150
v_mfma_f32_16x16x32_bf16 v[20:23],a[244:247],v[172:175],v[20:23]
v_exp_f32 v151,v151
v_mfma_f32_16x16x32_bf16 v[24:27],a[248:251],v[172:175],v[24:27]
v_cvt_pk_bf16_f32 v178,v148,v149
v_cvt_pk_bf16_f32 v179,v150,v151
v_mfma_f32_16x16x32_bf16 v[24:27],a[168:171],v[168:171],v[24:27]
v_exp_f32 v128,v128
v_mfma_f32_16x16x32_bf16 v[28:31],a[172:175],v[168:171],v[28:31]
s_waitcnt lgkmcnt(0)
P84:
s_cbranch_execz P212
v_mfma_f32_16x16x32_bf16 v[28:31],a[252:255],v[172:175],v[28:31]
v_exp_f32 v129,v129
v_mfma_f32_16x16x32_bf16 v[136:139],a[192:195],a[96:99],v[204:207]
v_exp_f32 v130,v130
v_mfma_f32_16x16x32_bf16 v[136:139],a[196:199],a[100:103],v[136:139]
v_exp_f32 v131,v131
v_mfma_f32_16x16x32_bf16 v[136:139],a[200:203],a[104:107],v[136:139]
v_cvt_pk_bf16_f32 v180,v128,v129
v_cvt_pk_bf16_f32 v181,v130,v131
v_mfma_f32_16x16x32_bf16 v[136:139],a[204:207],a[108:111],v[136:139]
v_exp_f32 v132,v132
v_mfma_f32_16x16x32_bf16 v[140:143],a[208:211],a[108:111],v[204:207]
buffer_load_dwordx4 v227,s[20:23],s34 offen offset:2048 nt lds
v_exp_f32 v133,v133
v_mfma_f32_16x16x32_bf16 v[140:143],a[212:215],a[104:107],v[140:143]
v_exp_f32 v134,v134
v_mfma_f32_16x16x32_bf16 v[140:143],a[216:219],a[100:103],v[140:143]
v_exp_f32 v135,v135
v_mfma_f32_16x16x32_bf16 v[140:143],a[220:223],a[96:99],v[140:143]
v_cvt_pk_bf16_f32 v182,v132,v133
v_lshlrev_b32 v152,16,v248
v_mfma_f32_16x16x32_bf16 v[208:211],a[180:183],v[176:179],v[208:211]
v_cvt_pk_bf16_f32 v183,v134,v135
v_and_b32 v153,0xffff0000,v248
v_mul_f32 v152,s80,v152
v_mfma_f32_16x16x32_bf16 v[208:211],a[180:183],v[180:183],v[208:211]
v_mul_f32 v153,s80,v153
v_cvt_pk_bf16_f32 v248,v152,v153
v_mfma_f32_16x16x32_bf16 v[32:35],a[224:227],v[180:183],v[32:35]
v_lshlrev_b32 v154,16,v249
v_and_b32 v155,0xffff0000,v249
v_mfma_f32_16x16x32_bf16 v[32:35],a[144:147],v[176:179],v[32:35]
v_mul_f32 v154,s80,v154
v_mul_f32 v155,s80,v155
v_mfma_f32_16x16x32_bf16 v[36:39],a[148:151],v[176:179],v[36:39]
v_cvt_pk_bf16_f32 v249,v154,v155
v_lshlrev_b32 v152,16,v250
v_mfma_f32_16x16x32_bf16 v[36:39],a[228:231],v[180:183],v[36:39]
v_and_b32 v153,0xffff0000,v250
v_mul_f32 v152,s80,v152
v_mfma_f32_16x16x32_bf16 v[40:43],a[232:235],v[180:183],v[40:43]
v_mul_f32 v153,s80,v153
v_cvt_pk_bf16_f32 v250,v152,v153
v_mfma_f32_16x16x32_bf16 v[40:43],a[152:155],v[176:179],v[40:43]
P85:
s_cbranch_execz P213
v_lshlrev_b32 v154,16,v251
v_and_b32 v155,0xffff0000,v251
v_mfma_f32_16x16x32_bf16 v[44:47],a[156:159],v[176:179],v[44:47]
v_mul_f32 v154,s80,v154
v_mul_f32 v155,s80,v155
v_mfma_f32_16x16x32_bf16 v[44:47],a[236:239],v[180:183],v[44:47]
v_cvt_pk_bf16_f32 v251,v154,v155
v_xor_b32 v224,0x8800,v224
v_mfma_f32_16x16x32_bf16 v[48:51],a[240:243],v[180:183],v[48:51]
ds_write_b128 v229,v[248:251] offset:18432
v_mfma_f32_16x16x32_bf16 v[48:51],a[160:163],v[176:179],v[48:51]
buffer_load_dwordx4 v[248:251],v228,s[12:15],s66 offen offset:2048 nt
v_mfma_f32_16x16x32_bf16 v[52:55],a[164:167],v[176:179],v[52:55]
s_waitcnt vmcnt(16)
buffer_load_dwordx4 v227,s[20:23],s34 offen offset:3072 nt lds
v_mfma_f32_16x16x32_bf16 v[52:55],a[244:247],v[180:183],v[52:55]
v_exp_f32 v136,v136
v_mfma_f32_16x16x32_bf16 v[56:59],a[248:251],v[180:183],v[56:59]
v_exp_f32 v137,v137
v_mfma_f32_16x16x32_bf16 v[56:59],a[168:171],v[176:179],v[56:59]
v_exp_f32 v138,v138
v_mfma_f32_16x16x32_bf16 v[60:63],a[172:175],v[176:179],v[60:63]
v_exp_f32 v139,v139
v_mfma_f32_16x16x32_bf16 v[60:63],a[252:255],v[180:183],v[60:63]
v_cvt_pk_bf16_f32 v184,v136,v137
v_cvt_pk_bf16_f32 v185,v138,v139
v_mfma_f32_16x16x32_bf16 v[144:147],a[112:115],v[96:99],v[196:199]
v_exp_f32 v140,v140
v_mfma_f32_16x16x32_bf16 v[144:147],a[116:119],v[100:103],v[144:147]
v_exp_f32 v141,v141
v_mfma_f32_16x16x32_bf16 v[144:147],a[120:123],v[104:107],v[144:147]
v_exp_f32 v142,v142
v_mfma_f32_16x16x32_bf16 v[144:147],a[124:127],v[108:111],v[144:147]
P86:
s_cbranch_execz P214
v_mfma_f32_16x16x32_bf16 v[148:151],a[128:131],v[108:111],v[196:199]
v_exp_f32 v143,v143
v_mfma_f32_16x16x32_bf16 v[148:151],a[132:135],v[104:107],v[148:151]
v_cvt_pk_bf16_f32 v186,v140,v141
v_cvt_pk_bf16_f32 v187,v142,v143
v_mfma_f32_16x16x32_bf16 v[148:151],a[136:139],v[100:103],v[148:151]
v_lshlrev_b32 v152,16,v252
v_and_b32 v153,0xffff0000,v252
v_mfma_f32_16x16x32_bf16 v[148:151],a[140:143],v[96:99],v[148:151]
v_exp_f32 v144,v144
v_mfma_f32_16x16x32_bf16 v[128:131],a[192:195],v[96:99],v[196:199]
v_exp_f32 v145,v145
v_mfma_f32_16x16x32_bf16 v[128:131],a[196:199],v[100:103],v[128:131]
v_exp_f32 v146,v146
v_mfma_f32_16x16x32_bf16 v[128:131],a[200:203],v[104:107],v[128:131]
v_exp_f32 v147,v147
v_mfma_f32_16x16x32_bf16 v[128:131],a[204:207],v[108:111],v[128:131]
v_cvt_pk_bf16_f32 v168,v144,v145
v_cvt_pk_bf16_f32 v169,v146,v147
v_mfma_f32_16x16x32_bf16 v[132:135],a[208:211],v[108:111],v[196:199]
v_exp_f32 v148,v148
v_mfma_f32_16x16x32_bf16 v[132:135],a[212:215],v[104:107],v[132:135]
v_exp_f32 v149,v149
v_mfma_f32_16x16x32_bf16 v[132:135],a[216:219],v[100:103],v[132:135]
v_exp_f32 v150,v150
v_mfma_f32_16x16x32_bf16 v[132:135],a[220:223],v[96:99],v[132:135]
v_exp_f32 v151,v151
v_mfma_f32_16x16x32_bf16 v[212:215],a[176:179],v[184:187],v[212:215]
v_cvt_pk_bf16_f32 v170,v148,v149
v_cvt_pk_bf16_f32 v171,v150,v151
v_mfma_f32_16x16x32_bf16 a[0:3],a[224:227],v[184:187],a[0:3]
v_exp_f32 v128,v128
v_mfma_f32_16x16x32_bf16 a[4:7],a[228:231],v[184:187],a[4:7]
v_exp_f32 v129,v129
v_mfma_f32_16x16x32_bf16 a[8:11],a[232:235],v[184:187],a[8:11]
s_add_u32 m0,s30,16384
v_exp_f32 v130,v130
v_mfma_f32_16x16x32_bf16 a[12:15],a[236:239],v[184:187],a[12:15]
P87:
s_cbranch_execz P215
v_mfma_f32_16x16x32_bf16 a[16:19],a[240:243],v[184:187],a[16:19]
s_mov_b32 s34,180224
v_exp_f32 v131,v131
v_mfma_f32_16x16x32_bf16 a[20:23],a[244:247],v[184:187],a[20:23]
v_cvt_pk_bf16_f32 v172,v128,v129
v_cvt_pk_bf16_f32 v173,v130,v131
v_mfma_f32_16x16x32_bf16 a[24:27],a[248:251],v[184:187],a[24:27]
s_waitcnt vmcnt(11) lgkmcnt(0)
s_barrier
v_mfma_f32_16x16x32_bf16 a[28:31],a[252:255],v[184:187],a[28:31]
v_exp_f32 v132,v132
v_mfma_f32_16x16x32_bf16 v[136:139],a[112:115],v[112:115],v[200:203]
v_exp_f32 v133,v133
v_mfma_f32_16x16x32_bf16 v[136:139],a[116:119],v[116:119],v[136:139]
v_exp_f32 v134,v134
v_mfma_f32_16x16x32_bf16 v[136:139],a[120:123],v[120:123],v[136:139]
buffer_load_dwordx4 v227,s[16:19],s34 offen nt lds
v_mfma_f32_16x16x32_bf16 v[136:139],a[124:127],v[124:127],v[136:139]
v_exp_f32 v135,v135
v_mfma_f32_16x16x32_bf16 v[140:143],a[128:131],v[124:127],v[200:203]
ds_read_b128 a[112:115],v224
v_cvt_pk_bf16_f32 v174,v132,v133
v_mfma_f32_16x16x32_bf16 v[140:143],a[132:135],v[120:123],v[140:143]
ds_read_b128 a[116:119],v224 offset:256
v_cvt_pk_bf16_f32 v175,v134,v135
v_mfma_f32_16x16x32_bf16 v[140:143],a[136:139],v[116:119],v[140:143]
v_mul_f32 v152,s80,v152
v_mul_f32 v153,s80,v153
v_mfma_f32_16x16x32_bf16 v[140:143],a[140:143],v[112:115],v[140:143]
ds_read_b128 a[120:123],v224 offset:512
ds_read_b128 a[124:127],v224 offset:768
v_mfma_f32_16x16x32_bf16 v[144:147],a[192:195],v[112:115],v[200:203]
v_cvt_pk_bf16_f32 v252,v152,v153
v_lshlrev_b32 v154,16,v253
v_mfma_f32_16x16x32_bf16 v[144:147],a[196:199],v[116:119],v[144:147]
ds_read_b128 a[128:131],v224 offset:1792
v_and_b32 v155,0xffff0000,v253
v_mfma_f32_16x16x32_bf16 v[144:147],a[200:203],v[120:123],v[144:147]
P88:
s_cbranch_execz P216
v_mfma_f32_16x16x32_bf16 v[144:147],a[204:207],v[124:127],v[144:147]
ds_read_b128 a[132:135],v224 offset:1536
v_mul_f32 v154,s80,v154
v_mfma_f32_16x16x32_bf16 v[148:151],a[208:211],v[124:127],v[200:203]
v_mul_f32 v155,s80,v155
v_cvt_pk_bf16_f32 v253,v154,v155
v_mfma_f32_16x16x32_bf16 v[148:151],a[212:215],v[120:123],v[148:151]
ds_read_b128 a[136:139],v224 offset:1280
v_lshlrev_b32 v152,16,v254
v_mfma_f32_16x16x32_bf16 v[148:151],a[216:219],v[116:119],v[148:151]
ds_read_b128 a[140:143],v224 offset:1024
v_and_b32 v153,0xffff0000,v254
v_mfma_f32_16x16x32_bf16 v[148:151],a[220:223],v[112:115],v[148:151]
v_mul_f32 v152,s80,v152
v_xor_b32 v224,0x800,v224
v_mfma_f32_16x16x32_bf16 v[208:211],a[184:187],v[168:171],v[208:211]
v_exp_f32 v136,v136
v_mfma_f32_16x16x32_bf16 v[208:211],a[184:187],v[172:175],v[208:211]
ds_read_b128 a[192:195],v224
v_mul_f32 v153,s80,v153
v_mfma_f32_16x16x32_bf16 a[32:35],a[224:227],v[172:175],a[32:35]
ds_read_b128 a[196:199],v224 offset:256
v_cvt_pk_bf16_f32 v254,v152,v153
v_mfma_f32_16x16x32_bf16 a[32:35],a[144:147],v[168:171],a[32:35]
buffer_load_dwordx4 v227,s[16:19],s34 offen offset:1024 nt lds
v_mfma_f32_16x16x32_bf16 a[36:39],a[148:151],v[168:171],a[36:39]
v_exp_f32 v137,v137
v_mfma_f32_16x16x32_bf16 a[36:39],a[228:231],v[172:175],a[36:39]
ds_read_b128 a[200:203],v224 offset:512
v_lshlrev_b32 v154,16,v255
v_mfma_f32_16x16x32_bf16 a[40:43],a[232:235],v[172:175],a[40:43]
ds_read_b128 a[204:207],v224 offset:768
v_and_b32 v155,0xffff0000,v255
v_mfma_f32_16x16x32_bf16 a[40:43],a[152:155],v[168:171],a[40:43]
P89:
s_cbranch_execz P217
v_mfma_f32_16x16x32_bf16 a[44:47],a[156:159],v[168:171],a[44:47]
v_exp_f32 v138,v138
v_mfma_f32_16x16x32_bf16 a[44:47],a[236:239],v[172:175],a[44:47]
ds_read_b128 a[208:211],v224 offset:1792
v_mul_f32 v154,s80,v154
v_mfma_f32_16x16x32_bf16 a[48:51],a[240:243],v[172:175],a[48:51]
ds_read_b128 a[212:215],v224 offset:1536
v_mul_f32 v155,s80,v155
v_mfma_f32_16x16x32_bf16 a[48:51],a[160:163],v[168:171],a[48:51]
v_exp_f32 v139,v139
v_mfma_f32_16x16x32_bf16 a[52:55],a[164:167],v[168:171],a[52:55]
ds_read_b128 a[216:219],v224 offset:1280
v_cvt_pk_bf16_f32 v255,v154,v155
v_mfma_f32_16x16x32_bf16 a[52:55],a[244:247],v[172:175],a[52:55]
ds_read_b128 a[220:223],v224 offset:1024
v_cvt_pk_bf16_f32 v176,v136,v137
v_mfma_f32_16x16x32_bf16 a[56:59],a[248:251],v[172:175],a[56:59]
ds_write_b128 v230,v[252:255] offset:19456
v_mfma_f32_16x16x32_bf16 a[56:59],a[168:171],v[168:171],a[56:59]
v_cvt_pk_bf16_f32 v177,v138,v139
v_xor_b32 v225,0x18800,v225
v_mfma_f32_16x16x32_bf16 a[60:63],a[172:175],v[168:171],a[60:63]
buffer_load_dwordx4 v[252:255],v228,s[12:15],s66 offen offset:3072 nt
v_mfma_f32_16x16x32_bf16 a[60:63],a[252:255],v[172:175],a[60:63]
s_waitcnt lgkmcnt(3)
v_exp_f32 v140,v140
v_mfma_f32_16x16x32_bf16 v[128:131],a[112:115],v[64:67],v[188:191]
v_exp_f32 v141,v141
v_mfma_f32_16x16x32_bf16 v[128:131],a[116:119],v[68:71],v[128:131]
s_waitcnt vmcnt(13)
v_exp_f32 v142,v142
v_mfma_f32_16x16x32_bf16 v[128:131],a[120:123],v[72:75],v[128:131]
v_exp_f32 v143,v143
v_mfma_f32_16x16x32_bf16 v[128:131],a[124:127],v[76:79],v[128:131]
buffer_load_dwordx4 v227,s[16:19],s34 offen offset:2048 nt lds
v_mfma_f32_16x16x32_bf16 v[132:135],a[128:131],v[76:79],v[188:191]
v_cvt_pk_bf16_f32 v178,v140,v141
v_cvt_pk_bf16_f32 v179,v142,v143
v_mfma_f32_16x16x32_bf16 v[132:135],a[132:135],v[72:75],v[132:135]
P90:
s_cbranch_execz P218
v_mfma_f32_16x16x32_bf16 v[132:135],a[136:139],v[68:71],v[132:135]
v_exp_f32 v144,v144
v_mfma_f32_16x16x32_bf16 v[132:135],a[140:143],v[64:67],v[132:135]
v_exp_f32 v145,v145
v_mfma_f32_16x16x32_bf16 v[136:139],a[192:195],v[64:67],v[188:191]
v_exp_f32 v146,v146
v_mfma_f32_16x16x32_bf16 v[136:139],a[196:199],v[68:71],v[136:139]
v_exp_f32 v147,v147
v_mfma_f32_16x16x32_bf16 v[136:139],a[200:203],v[72:75],v[136:139]
v_cvt_pk_bf16_f32 v180,v144,v145
v_cvt_pk_bf16_f32 v181,v146,v147
v_mfma_f32_16x16x32_bf16 v[136:139],a[204:207],v[76:79],v[136:139]
v_exp_f32 v148,v148
v_mfma_f32_16x16x32_bf16 v[140:143],a[208:211],v[76:79],v[188:191]
v_exp_f32 v149,v149
v_mfma_f32_16x16x32_bf16 v[140:143],a[212:215],v[72:75],v[140:143]
s_waitcnt lgkmcnt(0)
v_exp_f32 v150,v150
v_mfma_f32_16x16x32_bf16 v[140:143],a[216:219],v[68:71],v[140:143]
v_exp_f32 v151,v151
v_mfma_f32_16x16x32_bf16 v[140:143],a[220:223],v[64:67],v[140:143]
v_cvt_pk_bf16_f32 v182,v148,v149
v_cvt_pk_bf16_f32 v183,v150,v151
v_mfma_f32_16x16x32_bf16 v[208:211],a[188:191],v[176:179],v[208:211]
v_xor_b32 v226,0x18800,v226
v_lshlrev_b32 v152,16,v240
v_mfma_f32_16x16x32_bf16 v[208:211],a[188:191],v[180:183],v[208:211]
v_exp_f32 v128,v128
v_mfma_f32_16x16x32_bf16 a[64:67],a[224:227],v[180:183],a[64:67]
v_exp_f32 v129,v129
v_mfma_f32_16x16x32_bf16 a[64:67],a[144:147],v[176:179],a[64:67]
ds_read_b64_tr_b16 a[144:145],v225
ds_read_b64_tr_b16 a[146:147],v225 offset:1024
v_mfma_f32_16x16x32_bf16 a[68:71],a[148:151],v[176:179],a[68:71]
ds_read_b64_tr_b16 a[148:149],v226
ds_read_b64_tr_b16 a[150:151],v226 offset:1024
v_mfma_f32_16x16x32_bf16 a[68:71],a[228:231],v[180:183],a[68:71]
buffer_load_dwordx4 v227,s[16:19],s34 offen offset:3072 nt lds
v_mfma_f32_16x16x32_bf16 a[72:75],a[232:235],v[180:183],a[72:75]
P91:
s_cbranch_execz P219
Z5:
s_cbranch_execz Z9
v_mfma_f32_16x16x32_bf16 a[72:75],a[152:155],v[176:179],a[72:75]
ds_read_b64_tr_b16 a[152:153],v225 offset:256
ds_read_b64_tr_b16 a[154:155],v225 offset:1280
v_mfma_f32_16x16x32_bf16 a[76:79],a[156:159],v[176:179],a[76:79]
v_exp_f32 v130,v130
v_mfma_f32_16x16x32_bf16 a[76:79],a[236:239],v[180:183],a[76:79]
ds_read_b64_tr_b16 a[156:157],v226 offset:256
ds_read_b64_tr_b16 a[158:159],v226 offset:1280
v_mfma_f32_16x16x32_bf16 a[80:83],a[240:243],v[180:183],a[80:83]
v_exp_f32 v131,v131
v_mfma_f32_16x16x32_bf16 a[80:83],a[160:163],v[176:179],a[80:83]
ds_read_b64_tr_b16 a[160:161],v225 offset:512
ds_read_b64_tr_b16 a[162:163],v225 offset:1536
v_mfma_f32_16x16x32_bf16 a[84:87],a[164:167],v[176:179],a[84:87]
s_add_u32 m0,s30,32768
v_cvt_pk_bf16_f32 v168,v128,v129
v_cvt_pk_bf16_f32 v169,v130,v131
v_mfma_f32_16x16x32_bf16 a[84:87],a[244:247],v[180:183],a[84:87]
s_mov_b32 s34,180224
ds_read_b64_tr_b16 a[164:165],v226 offset:512
ds_read_b64_tr_b16 a[166:167],v226 offset:1536
v_mfma_f32_16x16x32_bf16 a[88:91],a[248:251],v[180:183],a[88:91]
v_exp_f32 v132,v132
v_mfma_f32_16x16x32_bf16 a[88:91],a[168:171],v[176:179],a[88:91]
ds_read_b64_tr_b16 a[168:169],v225 offset:768
ds_read_b64_tr_b16 a[170:171],v225 offset:1792
v_mfma_f32_16x16x32_bf16 a[92:95],a[172:175],v[176:179],a[92:95]
v_exp_f32 v133,v133
v_mfma_f32_16x16x32_bf16 a[92:95],a[252:255],v[180:183],a[92:95]
P92:
s_cbranch_execz P220
v_mfma_f32_16x16x32_bf16 v[144:147],a[112:115],v[80:83],v[192:195]
ds_read_b64_tr_b16 a[172:173],v226 offset:768
ds_read_b64_tr_b16 a[174:175],v226 offset:1792
v_mfma_f32_16x16x32_bf16 v[144:147],a[116:119],v[84:87],v[144:147]
v_exp_f32 v134,v134
v_mfma_f32_16x16x32_bf16 v[144:147],a[120:123],v[88:91],v[144:147]
v_xor_b32 v225,0x800,v225
v_xor_b32 v226,0x800,v226
v_mfma_f32_16x16x32_bf16 v[144:147],a[124:127],v[92:95],v[144:147]
ds_read_b64_tr_b16 a[224:225],v225
v_exp_f32 v135,v135
v_mfma_f32_16x16x32_bf16 v[148:151],a[128:131],v[92:95],v[192:195]
ds_read_b64_tr_b16 a[226:227],v225 offset:1024
buffer_load_dwordx4 v227,s[20:23],s34 offen nt lds
v_cvt_pk_bf16_f32 v170,v132,v133
v_mfma_f32_16x16x32_bf16 v[148:151],a[132:135],v[88:91],v[148:151]
v_cvt_pk_bf16_f32 v171,v134,v135
v_and_b32 v153,0xffff0000,v240
v_mfma_f32_16x16x32_bf16 v[148:151],a[136:139],v[84:87],v[148:151]
ds_read_b64_tr_b16 a[228:229],v226
ds_read_b64_tr_b16 a[230:231],v226 offset:1024
v_exp_f32 v136,v136
v_mfma_f32_16x16x32_bf16 v[148:151],a[140:143],v[80:83],v[148:151]
v_exp_f32 v137,v137
v_mfma_f32_16x16x32_bf16 v[128:131],a[192:195],v[80:83],v[192:195]
ds_read_b64_tr_b16 a[232:233],v225 offset:256
v_exp_f32 v138,v138
v_mfma_f32_16x16x32_bf16 v[128:131],a[196:199],v[84:87],v[128:131]
ds_read_b64_tr_b16 a[234:235],v225 offset:1280
v_exp_f32 v139,v139
v_mfma_f32_16x16x32_bf16 v[128:131],a[200:203],v[88:91],v[128:131]
v_cvt_pk_bf16_f32 v172,v136,v137
v_cvt_pk_bf16_f32 v173,v138,v139
v_mfma_f32_16x16x32_bf16 v[128:131],a[204:207],v[92:95],v[128:131]
ds_read_b64_tr_b16 a[236:237],v226 offset:256
ds_read_b64_tr_b16 a[238:239],v226 offset:1280
v_exp_f32 v140,v140
v_mfma_f32_16x16x32_bf16 v[132:135],a[208:211],v[92:95],v[192:195]
v_exp_f32 v141,v141
v_mfma_f32_16x16x32_bf16 v[132:135],a[212:215],v[88:91],v[132:135]
P93:
s_cbranch_execz P221
ds_read_b64_tr_b16 a[240:241],v225 offset:512
v_exp_f32 v142,v142
v_mfma_f32_16x16x32_bf16 v[132:135],a[216:219],v[84:87],v[132:135]
ds_read_b64_tr_b16 a[242:243],v225 offset:1536
v_exp_f32 v143,v143
v_mfma_f32_16x16x32_bf16 v[132:135],a[220:223],v[80:83],v[132:135]
v_cvt_pk_bf16_f32 v174,v140,v141
v_cvt_pk_bf16_f32 v175,v142,v143
v_mfma_f32_16x16x32_bf16 v[208:211],a[176:179],v[168:171],v[208:211]
ds_read_b64_tr_b16 a[244:245],v226 offset:512
ds_read_b64_tr_b16 a[246:247],v226 offset:1536
v_mfma_f32_16x16x32_bf16 v[208:211],a[176:179],v[172:175],v[208:211]
s_waitcnt lgkmcnt(4)
v_exp_f32 v144,v144
v_mfma_f32_16x16x32_bf16 v[0:3],a[224:227],v[172:175],v[0:3]
ds_read_b64_tr_b16 a[248:249],v225 offset:768
ds_read_b64_tr_b16 a[250:251],v225 offset:1792
v_mfma_f32_16x16x32_bf16 v[0:3],a[144:147],v[168:171],v[0:3]
buffer_load_dwordx4 v227,s[20:23],s34 offen offset:1024 nt lds
v_mfma_f32_16x16x32_bf16 v[4:7],a[148:151],v[168:171],v[4:7]
ds_read_b64_tr_b16 a[252:253],v226 offset:768
ds_read_b64_tr_b16 a[254:255],v226 offset:1792
v_mfma_f32_16x16x32_bf16 v[4:7],a[228:231],v[172:175],v[4:7]
v_exp_f32 v145,v145
v_mfma_f32_16x16x32_bf16 v[8:11],a[232:235],v[172:175],v[8:11]
v_exp_f32 v146,v146
v_mfma_f32_16x16x32_bf16 v[8:11],a[152:155],v[168:171],v[8:11]
v_exp_f32 v147,v147
v_mfma_f32_16x16x32_bf16 v[12:15],a[156:159],v[168:171],v[12:15]
v_cvt_pk_bf16_f32 v176,v144,v145
v_cvt_pk_bf16_f32 v177,v146,v147
v_mfma_f32_16x16x32_bf16 v[12:15],a[236:239],v[172:175],v[12:15]
s_waitcnt lgkmcnt(2)
P94:
s_cbranch_execz P222
v_mfma_f32_16x16x32_bf16 v[16:19],a[240:243],v[172:175],v[16:19]
v_exp_f32 v148,v148
v_mfma_f32_16x16x32_bf16 v[16:19],a[160:163],v[168:171],v[16:19]
v_exp_f32 v149,v149
v_mfma_f32_16x16x32_bf16 v[20:23],a[164:167],v[168:171],v[20:23]
v_exp_f32 v150,v150
v_mfma_f32_16x16x32_bf16 v[20:23],a[244:247],v[172:175],v[20:23]
v_exp_f32 v151,v151
v_mfma_f32_16x16x32_bf16 v[24:27],a[248:251],v[172:175],v[24:27]
v_cvt_pk_bf16_f32 v178,v148,v149
v_cvt_pk_bf16_f32 v179,v150,v151
v_mfma_f32_16x16x32_bf16 v[24:27],a[168:171],v[168:171],v[24:27]
v_exp_f32 v128,v128
v_mfma_f32_16x16x32_bf16 v[28:31],a[172:175],v[168:171],v[28:31]
s_waitcnt lgkmcnt(0)
v_exp_f32 v129,v129
v_mfma_f32_16x16x32_bf16 v[28:31],a[252:255],v[172:175],v[28:31]
v_exp_f32 v130,v130
v_mfma_f32_16x16x32_bf16 v[136:139],a[192:195],a[96:99],v[204:207]
v_exp_f32 v131,v131
v_mfma_f32_16x16x32_bf16 v[136:139],a[196:199],a[100:103],v[136:139]
v_cvt_pk_bf16_f32 v180,v128,v129
v_cvt_pk_bf16_f32 v181,v130,v131
v_mfma_f32_16x16x32_bf16 v[136:139],a[200:203],a[104:107],v[136:139]
v_exp_f32 v132,v132
v_mfma_f32_16x16x32_bf16 v[136:139],a[204:207],a[108:111],v[136:139]
v_mul_f32 v152,s80,v152
v_mul_f32 v153,s80,v153
v_mfma_f32_16x16x32_bf16 v[140:143],a[208:211],a[108:111],v[204:207]
buffer_load_dwordx4 v227,s[20:23],s34 offen offset:2048 nt lds
v_exp_f32 v133,v133
v_cvt_pk_bf16_f32 v240,v152,v153
v_mfma_f32_16x16x32_bf16 v[140:143],a[212:215],a[104:107],v[140:143]
v_lshlrev_b32 v154,16,v241
v_exp_f32 v134,v134
v_and_b32 v155,0xffff0000,v241
v_mfma_f32_16x16x32_bf16 v[140:143],a[216:219],a[100:103],v[140:143]
v_mul_f32 v154,s80,v154
v_exp_f32 v135,v135
v_mul_f32 v155,s80,v155
v_mfma_f32_16x16x32_bf16 v[140:143],a[220:223],a[96:99],v[140:143]
v_cvt_pk_bf16_f32 v241,v154,v155
v_cvt_pk_bf16_f32 v182,v132,v133
P95:
s_cbranch_execz P223
v_lshlrev_b32 v152,16,v242
v_mfma_f32_16x16x32_bf16 v[208:211],a[180:183],v[176:179],v[208:211]
v_cvt_pk_bf16_f32 v183,v134,v135
v_and_b32 v153,0xffff0000,v242
v_mul_f32 v152,s80,v152
v_mfma_f32_16x16x32_bf16 v[208:211],a[180:183],v[180:183],v[208:211]
v_mul_f32 v153,s80,v153
v_cvt_pk_bf16_f32 v242,v152,v153
v_mfma_f32_16x16x32_bf16 v[32:35],a[224:227],v[180:183],v[32:35]
v_lshlrev_b32 v154,16,v243
v_and_b32 v155,0xffff0000,v243
v_mfma_f32_16x16x32_bf16 v[32:35],a[144:147],v[176:179],v[32:35]
v_mul_f32 v154,s80,v154
v_mul_f32 v155,s80,v155
v_mfma_f32_16x16x32_bf16 v[36:39],a[148:151],v[176:179],v[36:39]
v_cvt_pk_bf16_f32 v243,v154,v155
v_xor_b32 v224,0x18800,v224
v_mfma_f32_16x16x32_bf16 v[36:39],a[228:231],v[180:183],v[36:39]
ds_write_b128 v229,v[240:243] offset:49152
v_mfma_f32_16x16x32_bf16 v[40:43],a[232:235],v[180:183],v[40:43]
buffer_load_dwordx4 v[240:243],v228,s[12:15],s67 offen nt
v_mfma_f32_16x16x32_bf16 v[40:43],a[152:155],v[176:179],v[40:43]
s_waitcnt vmcnt(16)
v_exp_f32 v136,v136
v_mfma_f32_16x16x32_bf16 v[44:47],a[156:159],v[176:179],v[44:47]
v_exp_f32 v137,v137
v_mfma_f32_16x16x32_bf16 v[44:47],a[236:239],v[180:183],v[44:47]
v_exp_f32 v138,v138
v_mfma_f32_16x16x32_bf16 v[48:51],a[240:243],v[180:183],v[48:51]
v_exp_f32 v139,v139
v_mfma_f32_16x16x32_bf16 v[48:51],a[160:163],v[176:179],v[48:51]
buffer_load_dwordx4 v227,s[20:23],s34 offen offset:3072 nt lds
v_mfma_f32_16x16x32_bf16 v[52:55],a[164:167],v[176:179],v[52:55]
P96:
s_cbranch_execz P224
v_mfma_f32_16x16x32_bf16 v[52:55],a[244:247],v[180:183],v[52:55]
v_cvt_pk_bf16_f32 v184,v136,v137
v_cvt_pk_bf16_f32 v185,v138,v139
v_mfma_f32_16x16x32_bf16 v[56:59],a[248:251],v[180:183],v[56:59]
v_exp_f32 v140,v140
v_mfma_f32_16x16x32_bf16 v[56:59],a[168:171],v[176:179],v[56:59]
v_exp_f32 v141,v141
v_mfma_f32_16x16x32_bf16 v[60:63],a[172:175],v[176:179],v[60:63]
v_exp_f32 v142,v142
v_mfma_f32_16x16x32_bf16 v[60:63],a[252:255],v[180:183],v[60:63]
v_exp_f32 v143,v143
v_mfma_f32_16x16x32_bf16 v[144:147],a[112:115],v[96:99],v[196:199]
v_cvt_pk_bf16_f32 v186,v140,v141
v_cvt_pk_bf16_f32 v187,v142,v143
v_mfma_f32_16x16x32_bf16 v[144:147],a[116:119],v[100:103],v[144:147]
v_lshlrev_b32 v152,16,v244
v_and_b32 v153,0xffff0000,v244
v_mfma_f32_16x16x32_bf16 v[144:147],a[120:123],v[104:107],v[144:147]
v_mul_f32 v152,s80,v152
v_mul_f32 v153,s80,v153
v_mfma_f32_16x16x32_bf16 v[144:147],a[124:127],v[108:111],v[144:147]
v_cvt_pk_bf16_f32 v244,v152,v153
v_lshlrev_b32 v154,16,v245
v_mfma_f32_16x16x32_bf16 v[148:151],a[128:131],v[108:111],v[196:199]
v_and_b32 v155,0xffff0000,v245
v_mul_f32 v154,s80,v154
v_mfma_f32_16x16x32_bf16 v[148:151],a[132:135],v[104:107],v[148:151]
v_mul_f32 v155,s80,v155
v_cvt_pk_bf16_f32 v245,v154,v155
v_mfma_f32_16x16x32_bf16 v[148:151],a[136:139],v[100:103],v[148:151]
v_exp_f32 v144,v144
v_mfma_f32_16x16x32_bf16 v[148:151],a[140:143],v[96:99],v[148:151]
v_exp_f32 v145,v145
v_mfma_f32_16x16x32_bf16 v[128:131],a[192:195],v[96:99],v[196:199]
v_exp_f32 v146,v146
v_mfma_f32_16x16x32_bf16 v[128:131],a[196:199],v[100:103],v[128:131]
v_exp_f32 v147,v147
v_mfma_f32_16x16x32_bf16 v[128:131],a[200:203],v[104:107],v[128:131]
P97:
s_cbranch_execz P225
v_mfma_f32_16x16x32_bf16 v[128:131],a[204:207],v[108:111],v[128:131]
v_cvt_pk_bf16_f32 v168,v144,v145
v_cvt_pk_bf16_f32 v169,v146,v147
v_mfma_f32_16x16x32_bf16 v[132:135],a[208:211],v[108:111],v[196:199]
v_exp_f32 v148,v148
v_mfma_f32_16x16x32_bf16 v[132:135],a[212:215],v[104:107],v[132:135]
v_exp_f32 v149,v149
v_mfma_f32_16x16x32_bf16 v[132:135],a[216:219],v[100:103],v[132:135]
v_exp_f32 v150,v150
v_mfma_f32_16x16x32_bf16 v[132:135],a[220:223],v[96:99],v[132:135]
v_exp_f32 v151,v151
v_mfma_f32_16x16x32_bf16 v[212:215],a[176:179],v[184:187],v[212:215]
v_cvt_pk_bf16_f32 v170,v148,v149
v_cvt_pk_bf16_f32 v171,v150,v151
v_mfma_f32_16x16x32_bf16 a[0:3],a[224:227],v[184:187],a[0:3]
v_exp_f32 v128,v128
v_mfma_f32_16x16x32_bf16 a[4:7],a[228:231],v[184:187],a[4:7]
v_exp_f32 v129,v129
v_mfma_f32_16x16x32_bf16 a[8:11],a[232:235],v[184:187],a[8:11]
s_add_u32 m0,s30,49152
v_exp_f32 v130,v130
v_mfma_f32_16x16x32_bf16 a[12:15],a[236:239],v[184:187],a[12:15]
s_mov_b32 s34,196608
v_exp_f32 v131,v131
v_mfma_f32_16x16x32_bf16 a[16:19],a[240:243],v[184:187],a[16:19]
v_cvt_pk_bf16_f32 v172,v128,v129
v_cvt_pk_bf16_f32 v173,v130,v131
v_mfma_f32_16x16x32_bf16 a[20:23],a[244:247],v[184:187],a[20:23]
v_exp_f32 v132,v132
v_mfma_f32_16x16x32_bf16 a[24:27],a[248:251],v[184:187],a[24:27]
s_waitcnt vmcnt(10) lgkmcnt(0)
s_barrier
v_mfma_f32_16x16x32_bf16 a[28:31],a[252:255],v[184:187],a[28:31]
v_exp_f32 v133,v133
v_mfma_f32_16x16x32_bf16 v[136:139],a[112:115],v[112:115],v[200:203]
v_exp_f32 v134,v134
v_mfma_f32_16x16x32_bf16 v[136:139],a[116:119],v[116:119],v[136:139]
P98:
s_cbranch_execz P226
v_mfma_f32_16x16x32_bf16 v[136:139],a[120:123],v[120:123],v[136:139]
buffer_load_dwordx4 v227,s[16:19],s34 offen nt lds
v_mfma_f32_16x16x32_bf16 v[136:139],a[124:127],v[124:127],v[136:139]
v_exp_f32 v135,v135
v_mfma_f32_16x16x32_bf16 v[140:143],a[128:131],v[124:127],v[200:203]
ds_read_b128 a[112:115],v224
v_cvt_pk_bf16_f32 v174,v132,v133
v_mfma_f32_16x16x32_bf16 v[140:143],a[132:135],v[120:123],v[140:143]
ds_read_b128 a[116:119],v224 offset:256
v_cvt_pk_bf16_f32 v175,v134,v135
v_mfma_f32_16x16x32_bf16 v[140:143],a[136:139],v[116:119],v[140:143]
v_lshlrev_b32 v152,16,v246
v_and_b32 v153,0xffff0000,v246
v_mfma_f32_16x16x32_bf16 v[140:143],a[140:143],v[112:115],v[140:143]
ds_read_b128 a[120:123],v224 offset:512
ds_read_b128 a[124:127],v224 offset:768
v_mfma_f32_16x16x32_bf16 v[144:147],a[192:195],v[112:115],v[200:203]
v_mul_f32 v152,s80,v152
v_mul_f32 v153,s80,v153
v_mfma_f32_16x16x32_bf16 v[144:147],a[196:199],v[116:119],v[144:147]
ds_read_b128 a[128:131],v224 offset:1792
ds_read_b128 a[132:135],v224 offset:1536
v_mfma_f32_16x16x32_bf16 v[144:147],a[200:203],v[120:123],v[144:147]
v_cvt_pk_bf16_f32 v246,v152,v153
v_lshlrev_b32 v154,16,v247
v_mfma_f32_16x16x32_bf16 v[144:147],a[204:207],v[124:127],v[144:147]
ds_read_b128 a[136:139],v224 offset:1280
ds_read_b128 a[140:143],v224 offset:1024
v_mfma_f32_16x16x32_bf16 v[148:151],a[208:211],v[124:127],v[200:203]
v_exp_f32 v136,v136
v_mfma_f32_16x16x32_bf16 v[148:151],a[212:215],v[120:123],v[148:151]
v_xor_b32 v224,0x800,v224
v_and_b32 v155,0xffff0000,v247
v_mfma_f32_16x16x32_bf16 v[148:151],a[216:219],v[116:119],v[148:151]
ds_read_b128 a[192:195],v224
ds_read_b128 a[196:199],v224 offset:256
v_mfma_f32_16x16x32_bf16 v[148:151],a[220:223],v[112:115],v[148:151]
P99:
s_cbranch_execz P227
v_mfma_f32_16x16x32_bf16 v[208:211],a[184:187],v[168:171],v[208:211]
v_exp_f32 v137,v137
v_mfma_f32_16x16x32_bf16 v[208:211],a[184:187],v[172:175],v[208:211]
ds_read_b128 a[200:203],v224 offset:512
v_mul_f32 v154,s80,v154
v_mfma_f32_16x16x32_bf16 a[32:35],a[224:227],v[172:175],a[32:35]
ds_read_b128 a[204:207],v224 offset:768
v_mul_f32 v155,s80,v155
v_mfma_f32_16x16x32_bf16 a[32:35],a[144:147],v[168:171],a[32:35]
buffer_load_dwordx4 v227,s[16:19],s34 offen offset:1024 nt lds
v_mfma_f32_16x16x32_bf16 a[36:39],a[148:151],v[168:171],a[36:39]
v_exp_f32 v138,v138
v_mfma_f32_16x16x32_bf16 a[36:39],a[228:231],v[172:175],a[36:39]
ds_read_b128 a[208:211],v224 offset:1792
v_cvt_pk_bf16_f32 v247,v154,v155
v_mfma_f32_16x16x32_bf16 a[40:43],a[232:235],v[172:175],a[40:43]
v_exp_f32 v139,v139
v_mfma_f32_16x16x32_bf16 a[40:43],a[152:155],v[168:171],a[40:43]
ds_write_b128 v230,v[244:247] offset:50176
v_mfma_f32_16x16x32_bf16 a[44:47],a[156:159],v[168:171],a[44:47]
ds_read_b128 a[212:215],v224 offset:1536
v_cvt_pk_bf16_f32 v176,v136,v137
v_mfma_f32_16x16x32_bf16 a[44:47],a[236:239],v[172:175],a[44:47]
buffer_load_dwordx4 v[244:247],v228,s[12:15],s67 offen offset:1024 nt
v_mfma_f32_16x16x32_bf16 a[48:51],a[240:243],v[172:175],a[48:51]
ds_read_b128 a[216:219],v224 offset:1280
v_cvt_pk_bf16_f32 v177,v138,v139
v_mfma_f32_16x16x32_bf16 a[48:51],a[160:163],v[168:171],a[48:51]
v_exp_f32 v140,v140
v_mfma_f32_16x16x32_bf16 a[52:55],a[164:167],v[168:171],a[52:55]
v_exp_f32 v141,v141
v_mfma_f32_16x16x32_bf16 a[52:55],a[244:247],v[172:175],a[52:55]
v_exp_f32 v142,v142
v_mfma_f32_16x16x32_bf16 a[56:59],a[248:251],v[172:175],a[56:59]
P100:
s_cbranch_execz P228
v_mfma_f32_16x16x32_bf16 a[56:59],a[168:171],v[168:171],a[56:59]
v_exp_f32 v143,v143
v_mfma_f32_16x16x32_bf16 a[60:63],a[172:175],v[168:171],a[60:63]
ds_read_b128 a[220:223],v224 offset:1024
v_cvt_pk_bf16_f32 v178,v140,v141
v_mfma_f32_16x16x32_bf16 a[60:63],a[252:255],v[172:175],a[60:63]
s_waitcnt lgkmcnt(1)
v_cvt_pk_bf16_f32 v179,v142,v143
v_xor_b32 v225,0x10800,v225
v_mfma_f32_16x16x32_bf16 v[128:131],a[112:115],v[64:67],v[188:191]
v_exp_f32 v144,v144
v_mfma_f32_16x16x32_bf16 v[128:131],a[116:119],v[68:71],v[128:131]
v_exp_f32 v145,v145
v_mfma_f32_16x16x32_bf16 v[128:131],a[120:123],v[72:75],v[128:131]
buffer_load_dwordx4 v227,s[16:19],s34 offen offset:2048 nt lds
v_mfma_f32_16x16x32_bf16 v[128:131],a[124:127],v[76:79],v[128:131]
v_exp_f32 v146,v146
v_mfma_f32_16x16x32_bf16 v[132:135],a[128:131],v[76:79],v[188:191]
v_exp_f32 v147,v147
v_mfma_f32_16x16x32_bf16 v[132:135],a[132:135],v[72:75],v[132:135]
v_cvt_pk_bf16_f32 v180,v144,v145
v_cvt_pk_bf16_f32 v181,v146,v147
v_mfma_f32_16x16x32_bf16 v[132:135],a[136:139],v[68:71],v[132:135]
v_exp_f32 v148,v148
v_mfma_f32_16x16x32_bf16 v[132:135],a[140:143],v[64:67],v[132:135]
v_exp_f32 v149,v149
v_mfma_f32_16x16x32_bf16 v[136:139],a[192:195],v[64:67],v[188:191]
v_exp_f32 v150,v150
v_mfma_f32_16x16x32_bf16 v[136:139],a[196:199],v[68:71],v[136:139]
v_exp_f32 v151,v151
v_mfma_f32_16x16x32_bf16 v[136:139],a[200:203],v[72:75],v[136:139]
v_cvt_pk_bf16_f32 v182,v148,v149
v_cvt_pk_bf16_f32 v183,v150,v151
v_mfma_f32_16x16x32_bf16 v[136:139],a[204:207],v[76:79],v[136:139]
v_xor_b32 v226,0x10800,v226
v_lshlrev_b32 v152,16,v248
v_mfma_f32_16x16x32_bf16 v[140:143],a[208:211],v[76:79],v[188:191]
P101:
s_cbranch_execz P229
v_mfma_f32_16x16x32_bf16 v[140:143],a[212:215],v[72:75],v[140:143]
v_exp_f32 v128,v128
v_mfma_f32_16x16x32_bf16 v[140:143],a[216:219],v[68:71],v[140:143]
s_waitcnt lgkmcnt(0)
v_exp_f32 v129,v129
v_mfma_f32_16x16x32_bf16 v[140:143],a[220:223],v[64:67],v[140:143]
v_exp_f32 v130,v130
v_mfma_f32_16x16x32_bf16 v[208:211],a[188:191],v[176:179],v[208:211]
v_exp_f32 v131,v131
v_mfma_f32_16x16x32_bf16 v[208:211],a[188:191],v[180:183],v[208:211]
v_cvt_pk_bf16_f32 v168,v128,v129
v_cvt_pk_bf16_f32 v169,v130,v131
v_mfma_f32_16x16x32_bf16 a[64:67],a[224:227],v[180:183],a[64:67]
v_exp_f32 v132,v132
v_mfma_f32_16x16x32_bf16 a[64:67],a[144:147],v[176:179],a[64:67]
ds_read_b64_tr_b16 a[144:145],v225
ds_read_b64_tr_b16 a[146:147],v225 offset:1024
v_mfma_f32_16x16x32_bf16 a[68:71],a[148:151],v[176:179],a[68:71]
ds_read_b64_tr_b16 a[148:149],v226
ds_read_b64_tr_b16 a[150:151],v226 offset:1024
v_mfma_f32_16x16x32_bf16 a[68:71],a[228:231],v[180:183],a[68:71]
buffer_load_dwordx4 v227,s[16:19],s34 offen offset:3072 nt lds
v_mfma_f32_16x16x32_bf16 a[72:75],a[232:235],v[180:183],a[72:75]
v_exp_f32 v133,v133
v_mfma_f32_16x16x32_bf16 a[72:75],a[152:155],v[176:179],a[72:75]
ds_read_b64_tr_b16 a[152:153],v225 offset:256
ds_read_b64_tr_b16 a[154:155],v225 offset:1280
v_mfma_f32_16x16x32_bf16 a[76:79],a[156:159],v[176:179],a[76:79]
v_exp_f32 v134,v134
v_mfma_f32_16x16x32_bf16 a[76:79],a[236:239],v[180:183],a[76:79]
ds_read_b64_tr_b16 a[156:157],v226 offset:256
ds_read_b64_tr_b16 a[158:159],v226 offset:1280
v_mfma_f32_16x16x32_bf16 a[80:83],a[240:243],v[180:183],a[80:83]
v_exp_f32 v135,v135
v_mfma_f32_16x16x32_bf16 a[80:83],a[160:163],v[176:179],a[80:83]
P102:
s_cbranch_execz P230
v_mfma_f32_16x16x32_bf16 a[84:87],a[164:167],v[176:179],a[84:87]
ds_read_b64_tr_b16 a[160:161],v225 offset:512
ds_read_b64_tr_b16 a[162:163],v225 offset:1536
v_mfma_f32_16x16x32_bf16 a[84:87],a[244:247],v[180:183],a[84:87]
s_add_u32 m0,s30,65536
v_cvt_pk_bf16_f32 v170,v132,v133
v_cvt_pk_bf16_f32 v171,v134,v135
v_mfma_f32_16x16x32_bf16 a[88:91],a[248:251],v[180:183],a[88:91]
ds_read_b64_tr_b16 a[164:165],v226 offset:512
ds_read_b64_tr_b16 a[166:167],v226 offset:1536
v_mfma_f32_16x16x32_bf16 a[88:91],a[168:171],v[176:179],a[88:91]
s_mov_b32 s34,196608
v_exp_f32 v136,v136
v_mfma_f32_16x16x32_bf16 a[92:95],a[172:175],v[176:179],a[92:95]
ds_read_b64_tr_b16 a[168:169],v225 offset:768
ds_read_b64_tr_b16 a[170:171],v225 offset:1792
v_mfma_f32_16x16x32_bf16 a[92:95],a[252:255],v[180:183],a[92:95]
v_exp_f32 v137,v137
v_mfma_f32_16x16x32_bf16 v[144:147],a[112:115],v[80:83],v[192:195]
ds_read_b64_tr_b16 a[172:173],v226 offset:768
ds_read_b64_tr_b16 a[174:175],v226 offset:1792
v_mfma_f32_16x16x32_bf16 v[144:147],a[116:119],v[84:87],v[144:147]
v_xor_b32 v225,0x800,v225
v_xor_b32 v226,0x800,v226
v_mfma_f32_16x16x32_bf16 v[144:147],a[120:123],v[88:91],v[144:147]
ds_read_b64_tr_b16 a[224:225],v225
ds_read_b64_tr_b16 a[226:227],v225 offset:1024
v_mfma_f32_16x16x32_bf16 v[144:147],a[124:127],v[92:95],v[144:147]
buffer_load_dwordx4 v227,s[20:23],s34 offen nt lds
v_mfma_f32_16x16x32_bf16 v[148:151],a[128:131],v[92:95],v[192:195]
ds_read_b64_tr_b16 a[228:229],v226
ds_read_b64_tr_b16 a[230:231],v226 offset:1024
v_mfma_f32_16x16x32_bf16 v[148:151],a[132:135],v[88:91],v[148:151]
P103:
s_cbranch_execz P231
v_mfma_f32_16x16x32_bf16 v[148:151],a[136:139],v[84:87],v[148:151]
v_exp_f32 v138,v138
v_mfma_f32_16x16x32_bf16 v[148:151],a[140:143],v[80:83],v[148:151]
ds_read_b64_tr_b16 a[232:233],v225 offset:256
ds_read_b64_tr_b16 a[234:235],v225 offset:1280
v_mfma_f32_16x16x32_bf16 v[128:131],a[192:195],v[80:83],v[192:195]
v_exp_f32 v139,v139
v_mfma_f32_16x16x32_bf16 v[128:131],a[196:199],v[84:87],v[128:131]
ds_read_b64_tr_b16 a[236:237],v226 offset:256
v_cvt_pk_bf16_f32 v172,v136,v137
v_mfma_f32_16x16x32_bf16 v[128:131],a[200:203],v[88:91],v[128:131]
ds_read_b64_tr_b16 a[238:239],v226 offset:1280
v_cvt_pk_bf16_f32 v173,v138,v139
v_mfma_f32_16x16x32_bf16 v[128:131],a[204:207],v[92:95],v[128:131]
v_exp_f32 v140,v140
v_mfma_f32_16x16x32_bf16 v[132:135],a[208:211],v[92:95],v[192:195]
v_exp_f32 v141,v141
v_mfma_f32_16x16x32_bf16 v[132:135],a[212:215],v[88:91],v[132:135]
ds_read_b64_tr_b16 a[240:241],v225 offset:512
v_exp_f32 v142,v142
v_mfma_f32_16x16x32_bf16 v[132:135],a[216:219],v[84:87],v[132:135]
ds_read_b64_tr_b16 a[242:243],v225 offset:1536
v_exp_f32 v143,v143
v_mfma_f32_16x16x32_bf16 v[132:135],a[220:223],v[80:83],v[132:135]
v_cvt_pk_bf16_f32 v174,v140,v141
v_cvt_pk_bf16_f32 v175,v142,v143
v_mfma_f32_16x16x32_bf16 v[208:211],a[176:179],v[168:171],v[208:211]
ds_read_b64_tr_b16 a[244:245],v226 offset:512
ds_read_b64_tr_b16 a[246:247],v226 offset:1536
v_mfma_f32_16x16x32_bf16 v[208:211],a[176:179],v[172:175],v[208:211]
s_waitcnt lgkmcnt(4)
v_exp_f32 v144,v144
v_mfma_f32_16x16x32_bf16 v[0:3],a[224:227],v[172:175],v[0:3]
ds_read_b64_tr_b16 a[248:249],v225 offset:768
ds_read_b64_tr_b16 a[250:251],v225 offset:1792
v_mfma_f32_16x16x32_bf16 v[0:3],a[144:147],v[168:171],v[0:3]
P104:
s_cbranch_execz P232
v_mfma_f32_16x16x32_bf16 v[4:7],a[148:151],v[168:171],v[4:7]
buffer_load_dwordx4 v227,s[20:23],s34 offen offset:1024 nt lds
v_mfma_f32_16x16x32_bf16 v[4:7],a[228:231],v[172:175],v[4:7]
ds_read_b64_tr_b16 a[252:253],v226 offset:768
ds_read_b64_tr_b16 a[254:255],v226 offset:1792
v_mfma_f32_16x16x32_bf16 v[8:11],a[232:235],v[172:175],v[8:11]
v_exp_f32 v145,v145
v_mfma_f32_16x16x32_bf16 v[8:11],a[152:155],v[168:171],v[8:11]
v_exp_f32 v146,v146
v_mfma_f32_16x16x32_bf16 v[12:15],a[156:159],v[168:171],v[12:15]
v_exp_f32 v147,v147
v_mfma_f32_16x16x32_bf16 v[12:15],a[236:239],v[172:175],v[12:15]
s_waitcnt lgkmcnt(2)
v_cvt_pk_bf16_f32 v176,v144,v145
v_cvt_pk_bf16_f32 v177,v146,v147
v_mfma_f32_16x16x32_bf16 v[16:19],a[240:243],v[172:175],v[16:19]
v_exp_f32 v148,v148
v_mfma_f32_16x16x32_bf16 v[16:19],a[160:163],v[168:171],v[16:19]
v_exp_f32 v149,v149
v_mfma_f32_16x16x32_bf16 v[20:23],a[164:167],v[168:171],v[20:23]
v_exp_f32 v150,v150
v_mfma_f32_16x16x32_bf16 v[20:23],a[244:247],v[172:175],v[20:23]
v_exp_f32 v151,v151
v_mfma_f32_16x16x32_bf16 v[24:27],a[248:251],v[172:175],v[24:27]
v_cvt_pk_bf16_f32 v178,v148,v149
v_cvt_pk_bf16_f32 v179,v150,v151
v_mfma_f32_16x16x32_bf16 v[24:27],a[168:171],v[168:171],v[24:27]
v_exp_f32 v128,v128
v_mfma_f32_16x16x32_bf16 v[28:31],a[172:175],v[168:171],v[28:31]
s_waitcnt lgkmcnt(0)
v_and_b32 v153,0xffff0000,v248
v_mul_f32 v152,s80,v152
v_mfma_f32_16x16x32_bf16 v[28:31],a[252:255],v[172:175],v[28:31]
v_exp_f32 v129,v129
v_mul_f32 v153,s80,v153
v_cvt_pk_bf16_f32 v248,v152,v153
v_mfma_f32_16x16x32_bf16 v[136:139],a[192:195],a[96:99],v[204:207]
v_exp_f32 v130,v130
v_lshlrev_b32 v154,16,v249
v_and_b32 v155,0xffff0000,v249
v_mfma_f32_16x16x32_bf16 v[136:139],a[196:199],a[100:103],v[136:139]
v_exp_f32 v131,v131
v_mul_f32 v154,s80,v154
v_mul_f32 v155,s80,v155
v_mfma_f32_16x16x32_bf16 v[136:139],a[200:203],a[104:107],v[136:139]
P105:
s_cbranch_execz P233
v_cvt_pk_bf16_f32 v180,v128,v129
v_cvt_pk_bf16_f32 v249,v154,v155
v_cvt_pk_bf16_f32 v181,v130,v131
v_lshlrev_b32 v152,16,v250
v_mfma_f32_16x16x32_bf16 v[136:139],a[204:207],a[108:111],v[136:139]
v_and_b32 v153,0xffff0000,v250
v_exp_f32 v132,v132
v_mul_f32 v152,s80,v152
v_mfma_f32_16x16x32_bf16 v[140:143],a[208:211],a[108:111],v[204:207]
buffer_load_dwordx4 v227,s[20:23],s34 offen offset:2048 nt lds
v_mul_f32 v153,s80,v153
v_exp_f32 v133,v133
v_cvt_pk_bf16_f32 v250,v152,v153
v_mfma_f32_16x16x32_bf16 v[140:143],a[212:215],a[104:107],v[140:143]
v_lshlrev_b32 v154,16,v251
v_exp_f32 v134,v134
v_and_b32 v155,0xffff0000,v251
v_mfma_f32_16x16x32_bf16 v[140:143],a[216:219],a[100:103],v[140:143]
v_mul_f32 v154,s80,v154
v_exp_f32 v135,v135
v_mul_f32 v155,s80,v155
v_mfma_f32_16x16x32_bf16 v[140:143],a[220:223],a[96:99],v[140:143]
v_cvt_pk_bf16_f32 v251,v154,v155
v_cvt_pk_bf16_f32 v182,v132,v133
v_mfma_f32_16x16x32_bf16 v[208:211],a[180:183],v[176:179],v[208:211]
ds_write_b128 v229,v[248:251] offset:51200
v_cvt_pk_bf16_f32 v183,v134,v135
s_nop 1
v_mfma_f32_16x16x32_bf16 v[208:211],a[180:183],v[180:183],v[208:211]
buffer_load_dwordx4 v[248:251],v228,s[12:15],s67 offen offset:2048 nt
v_mfma_f32_16x16x32_bf16 v[32:35],a[224:227],v[180:183],v[32:35]
s_waitcnt vmcnt(16)
v_exp_f32 v136,v136
v_mfma_f32_16x16x32_bf16 v[32:35],a[144:147],v[176:179],v[32:35]
P106:
s_cbranch_execz P234
v_mfma_f32_16x16x32_bf16 v[36:39],a[148:151],v[176:179],v[36:39]
v_exp_f32 v137,v137
v_mfma_f32_16x16x32_bf16 v[36:39],a[228:231],v[180:183],v[36:39]
v_exp_f32 v138,v138
v_mfma_f32_16x16x32_bf16 v[40:43],a[232:235],v[180:183],v[40:43]
v_exp_f32 v139,v139
v_mfma_f32_16x16x32_bf16 v[40:43],a[152:155],v[176:179],v[40:43]
v_cvt_pk_bf16_f32 v184,v136,v137
v_cvt_pk_bf16_f32 v185,v138,v139
v_mfma_f32_16x16x32_bf16 v[44:47],a[156:159],v[176:179],v[44:47]
v_exp_f32 v140,v140
v_mfma_f32_16x16x32_bf16 v[44:47],a[236:239],v[180:183],v[44:47]
v_exp_f32 v141,v141
v_mfma_f32_16x16x32_bf16 v[48:51],a[240:243],v[180:183],v[48:51]
v_exp_f32 v142,v142
v_mfma_f32_16x16x32_bf16 v[48:51],a[160:163],v[176:179],v[48:51]
buffer_load_dwordx4 v227,s[20:23],s34 offen offset:3072 nt lds
v_mfma_f32_16x16x32_bf16 v[52:55],a[164:167],v[176:179],v[52:55]
v_exp_f32 v143,v143
v_mfma_f32_16x16x32_bf16 v[52:55],a[244:247],v[180:183],v[52:55]
v_cvt_pk_bf16_f32 v186,v140,v141
v_cvt_pk_bf16_f32 v187,v142,v143
v_mfma_f32_16x16x32_bf16 v[56:59],a[248:251],v[180:183],v[56:59]
v_xor_b32 v224,0x10800,v224
v_lshlrev_b32 v152,16,v252
v_mfma_f32_16x16x32_bf16 v[56:59],a[168:171],v[176:179],v[56:59]
v_and_b32 v153,0xffff0000,v252
v_mul_f32 v152,s80,v152
v_mfma_f32_16x16x32_bf16 v[60:63],a[172:175],v[176:179],v[60:63]
v_mul_f32 v153,s80,v153
v_cvt_pk_bf16_f32 v252,v152,v153
v_mfma_f32_16x16x32_bf16 v[60:63],a[252:255],v[180:183],v[60:63]
v_lshlrev_b32 v154,16,v253
v_and_b32 v155,0xffff0000,v253
v_mfma_f32_16x16x32_bf16 v[144:147],a[112:115],v[96:99],v[196:199]
v_mul_f32 v154,s80,v154
v_mul_f32 v155,s80,v155
v_mfma_f32_16x16x32_bf16 v[144:147],a[116:119],v[100:103],v[144:147]
P107:
s_cbranch_execz P235
Z6:
s_cbranch_execz Z10
v_mfma_f32_16x16x32_bf16 v[144:147],a[120:123],v[104:107],v[144:147]
v_cvt_pk_bf16_f32 v253,v154,v155
v_lshlrev_b32 v152,16,v254
v_mfma_f32_16x16x32_bf16 v[144:147],a[124:127],v[108:111],v[144:147]
v_and_b32 v153,0xffff0000,v254
v_mul_f32 v152,s80,v152
v_mfma_f32_16x16x32_bf16 v[148:151],a[128:131],v[108:111],v[196:199]
v_mul_f32 v153,s80,v153
v_cvt_pk_bf16_f32 v254,v152,v153
v_mfma_f32_16x16x32_bf16 v[148:151],a[132:135],v[104:107],v[148:151]
v_lshlrev_b32 v154,16,v255
v_and_b32 v155,0xffff0000,v255
v_mfma_f32_16x16x32_bf16 v[148:151],a[136:139],v[100:103],v[148:151]
v_exp_f32 v144,v144
v_mfma_f32_16x16x32_bf16 v[148:151],a[140:143],v[96:99],v[148:151]
v_exp_f32 v145,v145
v_mfma_f32_16x16x32_bf16 v[128:131],a[192:195],v[96:99],v[196:199]
v_exp_f32 v146,v146
v_mfma_f32_16x16x32_bf16 v[128:131],a[196:199],v[100:103],v[128:131]
v_exp_f32 v147,v147
v_mfma_f32_16x16x32_bf16 v[128:131],a[200:203],v[104:107],v[128:131]
v_cvt_pk_bf16_f32 v168,v144,v145
v_cvt_pk_bf16_f32 v169,v146,v147
v_mfma_f32_16x16x32_bf16 v[128:131],a[204:207],v[108:111],v[128:131]
v_exp_f32 v148,v148
v_mfma_f32_16x16x32_bf16 v[132:135],a[208:211],v[108:111],v[196:199]
v_exp_f32 v149,v149
v_mfma_f32_16x16x32_bf16 v[132:135],a[212:215],v[104:107],v[132:135]
v_exp_f32 v150,v150
v_mfma_f32_16x16x32_bf16 v[132:135],a[216:219],v[100:103],v[132:135]
v_exp_f32 v151,v151
v_mfma_f32_16x16x32_bf16 v[132:135],a[220:223],v[96:99],v[132:135]
v_cvt_pk_bf16_f32 v170,v148,v149
v_cvt_pk_bf16_f32 v171,v150,v151
v_mfma_f32_16x16x32_bf16 v[212:215],a[176:179],v[184:187],v[212:215]
v_exp_f32 v128,v128
v_mfma_f32_16x16x32_bf16 a[0:3],a[224:227],v[184:187],a[0:3]
P108:
s_cbranch_execz P236
v_mfma_f32_16x16x32_bf16 a[4:7],a[228:231],v[184:187],a[4:7]
v_exp_f32 v129,v129
v_mfma_f32_16x16x32_bf16 a[8:11],a[232:235],v[184:187],a[8:11]
s_add_u32 m0,s30,81920
v_exp_f32 v130,v130
v_mfma_f32_16x16x32_bf16 a[12:15],a[236:239],v[184:187],a[12:15]
s_mov_b32 s34,212992
v_exp_f32 v131,v131
v_mfma_f32_16x16x32_bf16 a[16:19],a[240:243],v[184:187],a[16:19]
v_cvt_pk_bf16_f32 v172,v128,v129
v_cvt_pk_bf16_f32 v173,v130,v131
v_mfma_f32_16x16x32_bf16 a[20:23],a[244:247],v[184:187],a[20:23]
v_exp_f32 v132,v132
v_mfma_f32_16x16x32_bf16 a[24:27],a[248:251],v[184:187],a[24:27]
s_waitcnt vmcnt(10) lgkmcnt(0)
s_barrier
v_mfma_f32_16x16x32_bf16 a[28:31],a[252:255],v[184:187],a[28:31]
v_exp_f32 v133,v133
v_mfma_f32_16x16x32_bf16 v[136:139],a[112:115],v[112:115],v[200:203]
v_exp_f32 v134,v134
v_mfma_f32_16x16x32_bf16 v[136:139],a[116:119],v[116:119],v[136:139]
v_exp_f32 v135,v135
v_mfma_f32_16x16x32_bf16 v[136:139],a[120:123],v[120:123],v[136:139]
buffer_load_dwordx4 v227,s[16:19],s34 offen nt lds
v_mfma_f32_16x16x32_bf16 v[136:139],a[124:127],v[124:127],v[136:139]
ds_read_b128 a[112:115],v224
v_cvt_pk_bf16_f32 v174,v132,v133
v_mfma_f32_16x16x32_bf16 v[140:143],a[128:131],v[124:127],v[200:203]
ds_read_b128 a[116:119],v224 offset:256
v_cvt_pk_bf16_f32 v175,v134,v135
v_mfma_f32_16x16x32_bf16 v[140:143],a[132:135],v[120:123],v[140:143]
v_mul_f32 v154,s80,v154
v_mul_f32 v155,s80,v155
v_mfma_f32_16x16x32_bf16 v[140:143],a[136:139],v[116:119],v[140:143]
ds_read_b128 a[120:123],v224 offset:512
ds_read_b128 a[124:127],v224 offset:768
v_mfma_f32_16x16x32_bf16 v[140:143],a[140:143],v[112:115],v[140:143]
P109:
s_cbranch_execz P237
v_mfma_f32_16x16x32_bf16 v[144:147],a[192:195],v[112:115],v[200:203]
ds_read_b128 a[128:131],v224 offset:1792
v_cvt_pk_bf16_f32 v255,v154,v155
v_mfma_f32_16x16x32_bf16 v[144:147],a[196:199],v[116:119],v[144:147]
ds_read_b128 a[132:135],v224 offset:1536
v_xor_b32 v225,0x8800,v225
v_mfma_f32_16x16x32_bf16 v[144:147],a[200:203],v[120:123],v[144:147]
ds_write_b128 v230,v[252:255] offset:52224
v_mfma_f32_16x16x32_bf16 v[144:147],a[204:207],v[124:127],v[144:147]
buffer_load_dwordx4 v[252:255],v228,s[12:15],s67 offen offset:3072 nt
v_mfma_f32_16x16x32_bf16 v[148:151],a[208:211],v[124:127],v[200:203]
ds_read_b128 a[136:139],v224 offset:1280
ds_read_b128 a[140:143],v224 offset:1024
v_mfma_f32_16x16x32_bf16 v[148:151],a[212:215],v[120:123],v[148:151]
v_exp_f32 v136,v136
v_mfma_f32_16x16x32_bf16 v[148:151],a[216:219],v[116:119],v[148:151]
v_xor_b32 v224,0x800,v224
v_xor_b32 v226,0x8800,v226
v_mfma_f32_16x16x32_bf16 v[148:151],a[220:223],v[112:115],v[148:151]
ds_read_b128 a[192:195],v224
ds_read_b128 a[196:199],v224 offset:256
v_mfma_f32_16x16x32_bf16 v[208:211],a[184:187],v[168:171],v[208:211]
v_exp_f32 v137,v137
v_mfma_f32_16x16x32_bf16 v[208:211],a[184:187],v[172:175],v[208:211]
v_exp_f32 v138,v138
v_mfma_f32_16x16x32_bf16 a[32:35],a[224:227],v[172:175],a[32:35]
v_exp_f32 v139,v139
v_mfma_f32_16x16x32_bf16 a[32:35],a[144:147],v[168:171],a[32:35]
buffer_load_dwordx4 v227,s[16:19],s34 offen offset:1024 nt lds
v_mfma_f32_16x16x32_bf16 a[36:39],a[148:151],v[168:171],a[36:39]
ds_read_b128 a[200:203],v224 offset:512
ds_read_b128 a[204:207],v224 offset:768
v_mfma_f32_16x16x32_bf16 a[36:39],a[228:231],v[172:175],a[36:39]
P110:
s_cbranch_execz P238
v_mfma_f32_16x16x32_bf16 a[40:43],a[232:235],v[172:175],a[40:43]
ds_read_b128 a[208:211],v224 offset:1792
v_cvt_pk_bf16_f32 v176,v136,v137
v_mfma_f32_16x16x32_bf16 a[40:43],a[152:155],v[168:171],a[40:43]
ds_read_b128 a[212:215],v224 offset:1536
v_cvt_pk_bf16_f32 v177,v138,v139
v_mfma_f32_16x16x32_bf16 a[44:47],a[156:159],v[168:171],a[44:47]
v_exp_f32 v140,v140
v_mfma_f32_16x16x32_bf16 a[44:47],a[236:239],v[172:175],a[44:47]
v_exp_f32 v141,v141
v_mfma_f32_16x16x32_bf16 a[48:51],a[240:243],v[172:175],a[48:51]
v_exp_f32 v142,v142
v_mfma_f32_16x16x32_bf16 a[48:51],a[160:163],v[168:171],a[48:51]
ds_read_b128 a[216:219],v224 offset:1280
ds_read_b128 a[220:223],v224 offset:1024
v_mfma_f32_16x16x32_bf16 a[52:55],a[164:167],v[168:171],a[52:55]
v_exp_f32 v143,v143
v_mfma_f32_16x16x32_bf16 a[52:55],a[244:247],v[172:175],a[52:55]
v_cvt_pk_bf16_f32 v178,v140,v141
v_cvt_pk_bf16_f32 v179,v142,v143
v_mfma_f32_16x16x32_bf16 a[56:59],a[248:251],v[172:175],a[56:59]
v_exp_f32 v144,v144
v_mfma_f32_16x16x32_bf16 a[56:59],a[168:171],v[168:171],a[56:59]
v_exp_f32 v145,v145
v_mfma_f32_16x16x32_bf16 a[60:63],a[172:175],v[168:171],a[60:63]
v_exp_f32 v146,v146
v_mfma_f32_16x16x32_bf16 a[60:63],a[252:255],v[172:175],a[60:63]
s_waitcnt lgkmcnt(0)
v_exp_f32 v147,v147
v_mfma_f32_16x16x32_bf16 v[128:131],a[112:115],v[64:67],v[188:191]
v_cvt_pk_bf16_f32 v180,v144,v145
v_cvt_pk_bf16_f32 v181,v146,v147
v_mfma_f32_16x16x32_bf16 v[128:131],a[116:119],v[68:71],v[128:131]
v_exp_f32 v148,v148
v_mfma_f32_16x16x32_bf16 v[128:131],a[120:123],v[72:75],v[128:131]
buffer_load_dwordx4 v227,s[16:19],s34 offen offset:2048 nt lds
v_mfma_f32_16x16x32_bf16 v[128:131],a[124:127],v[76:79],v[128:131]
P111:
s_cbranch_execz P239
v_mfma_f32_16x16x32_bf16 v[132:135],a[128:131],v[76:79],v[188:191]
v_exp_f32 v149,v149
v_mfma_f32_16x16x32_bf16 v[132:135],a[132:135],v[72:75],v[132:135]
v_exp_f32 v150,v150
v_mfma_f32_16x16x32_bf16 v[132:135],a[136:139],v[68:71],v[132:135]
v_exp_f32 v151,v151
v_mfma_f32_16x16x32_bf16 v[132:135],a[140:143],v[64:67],v[132:135]
v_cvt_pk_bf16_f32 v182,v148,v149
v_cvt_pk_bf16_f32 v183,v150,v151
v_mfma_f32_16x16x32_bf16 v[136:139],a[192:195],v[64:67],v[188:191]
v_exp_f32 v128,v128
v_mfma_f32_16x16x32_bf16 v[136:139],a[196:199],v[68:71],v[136:139]
v_exp_f32 v129,v129
v_mfma_f32_16x16x32_bf16 v[136:139],a[200:203],v[72:75],v[136:139]
v_exp_f32 v130,v130
v_mfma_f32_16x16x32_bf16 v[136:139],a[204:207],v[76:79],v[136:139]
v_exp_f32 v131,v131
v_mfma_f32_16x16x32_bf16 v[140:143],a[208:211],v[76:79],v[188:191]
v_cvt_pk_bf16_f32 v168,v128,v129
v_cvt_pk_bf16_f32 v169,v130,v131
v_mfma_f32_16x16x32_bf16 v[140:143],a[212:215],v[72:75],v[140:143]
v_exp_f32 v132,v132
v_mfma_f32_16x16x32_bf16 v[140:143],a[216:219],v[68:71],v[140:143]
v_exp_f32 v133,v133
v_mfma_f32_16x16x32_bf16 v[140:143],a[220:223],v[64:67],v[140:143]
v_exp_f32 v134,v134
v_mfma_f32_16x16x32_bf16 v[208:211],a[188:191],v[176:179],v[208:211]
v_exp_f32 v135,v135
v_mfma_f32_16x16x32_bf16 v[208:211],a[188:191],v[180:183],v[208:211]
v_cvt_pk_bf16_f32 v170,v132,v133
v_cvt_pk_bf16_f32 v171,v134,v135
v_mfma_f32_16x16x32_bf16 a[64:67],a[224:227],v[180:183],a[64:67]
v_exp_f32 v136,v136
v_mfma_f32_16x16x32_bf16 a[64:67],a[144:147],v[176:179],a[64:67]
ds_read_b64_tr_b16 a[144:145],v225
ds_read_b64_tr_b16 a[146:147],v225 offset:1024
v_mfma_f32_16x16x32_bf16 a[68:71],a[148:151],v[176:179],a[68:71]
ds_read_b64_tr_b16 a[148:149],v226
ds_read_b64_tr_b16 a[150:151],v226 offset:1024
v_mfma_f32_16x16x32_bf16 a[68:71],a[228:231],v[180:183],a[68:71]
buffer_load_dwordx4 v227,s[16:19],s34 offen offset:3072 nt lds
v_mfma_f32_16x16x32_bf16 a[72:75],a[232:235],v[180:183],a[72:75]
P112:
s_cbranch_execz P240
v_mfma_f32_16x16x32_bf16 a[72:75],a[152:155],v[176:179],a[72:75]
ds_read_b64_tr_b16 a[152:153],v225 offset:256
ds_read_b64_tr_b16 a[154:155],v225 offset:1280
v_mfma_f32_16x16x32_bf16 a[76:79],a[156:159],v[176:179],a[76:79]
v_exp_f32 v137,v137
v_mfma_f32_16x16x32_bf16 a[76:79],a[236:239],v[180:183],a[76:79]
ds_read_b64_tr_b16 a[156:157],v226 offset:256
ds_read_b64_tr_b16 a[158:159],v226 offset:1280
v_mfma_f32_16x16x32_bf16 a[80:83],a[240:243],v[180:183],a[80:83]
v_exp_f32 v138,v138
v_mfma_f32_16x16x32_bf16 a[80:83],a[160:163],v[176:179],a[80:83]
ds_read_b64_tr_b16 a[160:161],v225 offset:512
ds_read_b64_tr_b16 a[162:163],v225 offset:1536
v_mfma_f32_16x16x32_bf16 a[84:87],a[164:167],v[176:179],a[84:87]
s_add_u32 m0,s30,0
v_exp_f32 v139,v139
v_mfma_f32_16x16x32_bf16 a[84:87],a[244:247],v[180:183],a[84:87]
s_mov_b32 s34,212992
ds_read_b64_tr_b16 a[164:165],v226 offset:512
ds_read_b64_tr_b16 a[166:167],v226 offset:1536
v_mfma_f32_16x16x32_bf16 a[88:91],a[248:251],v[180:183],a[88:91]
v_cvt_pk_bf16_f32 v172,v136,v137
v_cvt_pk_bf16_f32 v173,v138,v139
v_mfma_f32_16x16x32_bf16 a[88:91],a[168:171],v[176:179],a[88:91]
ds_read_b64_tr_b16 a[168:169],v225 offset:768
ds_read_b64_tr_b16 a[170:171],v225 offset:1792
v_mfma_f32_16x16x32_bf16 a[92:95],a[172:175],v[176:179],a[92:95]
v_exp_f32 v140,v140
v_mfma_f32_16x16x32_bf16 a[92:95],a[252:255],v[180:183],a[92:95]
P113:
s_cbranch_execz P241
v_mfma_f32_16x16x32_bf16 v[144:147],a[112:115],v[80:83],v[192:195]
ds_read_b64_tr_b16 a[172:173],v226 offset:768
ds_read_b64_tr_b16 a[174:175],v226 offset:1792
v_mfma_f32_16x16x32_bf16 v[144:147],a[116:119],v[84:87],v[144:147]
v_xor_b32 v225,0x800,v225
v_xor_b32 v226,0x800,v226
v_mfma_f32_16x16x32_bf16 v[144:147],a[120:123],v[88:91],v[144:147]
ds_read_b64_tr_b16 a[224:225],v225
ds_read_b64_tr_b16 a[226:227],v225 offset:1024
v_mfma_f32_16x16x32_bf16 v[144:147],a[124:127],v[92:95],v[144:147]
buffer_load_dwordx4 v227,s[20:23],s34 offen nt lds
v_mfma_f32_16x16x32_bf16 v[148:151],a[128:131],v[92:95],v[192:195]
ds_read_b64_tr_b16 a[228:229],v226
ds_read_b64_tr_b16 a[230:231],v226 offset:1024
v_mfma_f32_16x16x32_bf16 v[148:151],a[132:135],v[88:91],v[148:151]
v_exp_f32 v141,v141
v_mfma_f32_16x16x32_bf16 v[148:151],a[136:139],v[84:87],v[148:151]
ds_read_b64_tr_b16 a[232:233],v225 offset:256
ds_read_b64_tr_b16 a[234:235],v225 offset:1280
v_mfma_f32_16x16x32_bf16 v[148:151],a[140:143],v[80:83],v[148:151]
v_exp_f32 v142,v142
v_mfma_f32_16x16x32_bf16 v[128:131],a[192:195],v[80:83],v[192:195]
ds_read_b64_tr_b16 a[236:237],v226 offset:256
ds_read_b64_tr_b16 a[238:239],v226 offset:1280
v_mfma_f32_16x16x32_bf16 v[128:131],a[196:199],v[84:87],v[128:131]
v_exp_f32 v143,v143
v_mfma_f32_16x16x32_bf16 v[128:131],a[200:203],v[88:91],v[128:131]
ds_read_b64_tr_b16 a[240:241],v225 offset:512
ds_read_b64_tr_b16 a[242:243],v225 offset:1536
v_mfma_f32_16x16x32_bf16 v[128:131],a[204:207],v[92:95],v[128:131]
v_cvt_pk_bf16_f32 v174,v140,v141
v_cvt_pk_bf16_f32 v175,v142,v143
v_mfma_f32_16x16x32_bf16 v[132:135],a[208:211],v[92:95],v[192:195]
P114:
s_cbranch_execz P242
v_mfma_f32_16x16x32_bf16 v[132:135],a[212:215],v[88:91],v[132:135]
ds_read_b64_tr_b16 a[244:245],v226 offset:512
ds_read_b64_tr_b16 a[246:247],v226 offset:1536
v_mfma_f32_16x16x32_bf16 v[132:135],a[216:219],v[84:87],v[132:135]
v_exp_f32 v144,v144
v_mfma_f32_16x16x32_bf16 v[132:135],a[220:223],v[80:83],v[132:135]
ds_read_b64_tr_b16 a[248:249],v225 offset:768
ds_read_b64_tr_b16 a[250:251],v225 offset:1792
v_mfma_f32_16x16x32_bf16 v[208:211],a[176:179],v[168:171],v[208:211]
v_exp_f32 v145,v145
v_mfma_f32_16x16x32_bf16 v[208:211],a[176:179],v[172:175],v[208:211]
s_waitcnt lgkmcnt(4)
ds_read_b64_tr_b16 a[252:253],v226 offset:768
ds_read_b64_tr_b16 a[254:255],v226 offset:1792
v_mfma_f32_16x16x32_bf16 v[0:3],a[224:227],v[172:175],v[0:3]
v_exp_f32 v146,v146
v_mfma_f32_16x16x32_bf16 v[0:3],a[144:147],v[168:171],v[0:3]
buffer_load_dwordx4 v227,s[20:23],s34 offen offset:1024 nt lds
v_mfma_f32_16x16x32_bf16 v[4:7],a[148:151],v[168:171],v[4:7]
v_exp_f32 v147,v147
v_mfma_f32_16x16x32_bf16 v[4:7],a[228:231],v[172:175],v[4:7]
v_cvt_pk_bf16_f32 v176,v144,v145
v_cvt_pk_bf16_f32 v177,v146,v147
v_mfma_f32_16x16x32_bf16 v[8:11],a[232:235],v[172:175],v[8:11]
v_exp_f32 v148,v148
v_mfma_f32_16x16x32_bf16 v[8:11],a[152:155],v[168:171],v[8:11]
v_lshlrev_b32 v152,16,v240
v_and_b32 v153,0xffff0000,v240
v_mfma_f32_16x16x32_bf16 v[12:15],a[156:159],v[168:171],v[12:15]
v_exp_f32 v149,v149
v_mfma_f32_16x16x32_bf16 v[12:15],a[236:239],v[172:175],v[12:15]
v_mul_f32 v152,s80,v152
v_mul_f32 v153,s80,v153
v_mfma_f32_16x16x32_bf16 v[16:19],a[240:243],v[172:175],v[16:19]
v_exp_f32 v150,v150
v_mfma_f32_16x16x32_bf16 v[16:19],a[160:163],v[168:171],v[16:19]
v_cvt_pk_bf16_f32 v240,v152,v153
v_lshlrev_b32 v154,16,v241
v_mfma_f32_16x16x32_bf16 v[20:23],a[164:167],v[168:171],v[20:23]
s_waitcnt lgkmcnt(0)
P115:
s_cbranch_execz P243
v_mfma_f32_16x16x32_bf16 v[20:23],a[244:247],v[172:175],v[20:23]
v_exp_f32 v151,v151
v_and_b32 v155,0xffff0000,v241
v_mfma_f32_16x16x32_bf16 v[24:27],a[248:251],v[172:175],v[24:27]
v_mul_f32 v154,s80,v154
v_cvt_pk_bf16_f32 v178,v148,v149
v_mul_f32 v155,s80,v155
v_mfma_f32_16x16x32_bf16 v[24:27],a[168:171],v[168:171],v[24:27]
v_cvt_pk_bf16_f32 v179,v150,v151
v_cvt_pk_bf16_f32 v241,v154,v155
v_lshlrev_b32 v152,16,v242
v_mfma_f32_16x16x32_bf16 v[28:31],a[172:175],v[168:171],v[28:31]
v_exp_f32 v128,v128
v_and_b32 v153,0xffff0000,v242
v_mul_f32 v152,s80,v152
v_mfma_f32_16x16x32_bf16 v[28:31],a[252:255],v[172:175],v[28:31]
v_exp_f32 v129,v129
v_mul_f32 v153,s80,v153
v_cvt_pk_bf16_f32 v242,v152,v153
v_mfma_f32_16x16x32_bf16 v[136:139],a[192:195],a[96:99],v[204:207]
v_exp_f32 v130,v130
v_lshlrev_b32 v154,16,v243
v_and_b32 v155,0xffff0000,v243
v_mfma_f32_16x16x32_bf16 v[136:139],a[196:199],a[100:103],v[136:139]
v_exp_f32 v131,v131
v_mul_f32 v154,s80,v154
v_mul_f32 v155,s80,v155
v_mfma_f32_16x16x32_bf16 v[136:139],a[200:203],a[104:107],v[136:139]
v_cvt_pk_bf16_f32 v180,v128,v129
v_cvt_pk_bf16_f32 v243,v154,v155
v_cvt_pk_bf16_f32 v181,v130,v131
v_mfma_f32_16x16x32_bf16 v[136:139],a[204:207],a[108:111],v[136:139]
ds_write_b128 v229,v[240:243] offset:32768
v_exp_f32 v132,v132
v_mfma_f32_16x16x32_bf16 v[140:143],a[208:211],a[108:111],v[204:207]
buffer_load_dwordx4 v227,s[20:23],s34 offen offset:2048 nt lds
buffer_load_dwordx4 v[240:243],v228,s[12:15],s68 offen nt
v_exp_f32 v133,v133
v_mfma_f32_16x16x32_bf16 v[140:143],a[212:215],a[104:107],v[140:143]
v_exp_f32 v134,v134
v_mfma_f32_16x16x32_bf16 v[140:143],a[216:219],a[100:103],v[140:143]
v_exp_f32 v135,v135
v_mfma_f32_16x16x32_bf16 v[140:143],a[220:223],a[96:99],v[140:143]
P116:
s_cbranch_execz P244
v_cvt_pk_bf16_f32 v182,v132,v133
v_mfma_f32_16x16x32_bf16 v[208:211],a[180:183],v[176:179],v[208:211]
s_waitcnt vmcnt(16)
v_cvt_pk_bf16_f32 v183,v134,v135
v_xor_b32 v224,0x8800,v224
s_nop 0
v_mfma_f32_16x16x32_bf16 v[208:211],a[180:183],v[180:183],v[208:211]
v_exp_f32 v136,v136
v_mfma_f32_16x16x32_bf16 v[32:35],a[224:227],v[180:183],v[32:35]
v_exp_f32 v137,v137
v_mfma_f32_16x16x32_bf16 v[32:35],a[144:147],v[176:179],v[32:35]
v_exp_f32 v138,v138
v_mfma_f32_16x16x32_bf16 v[36:39],a[148:151],v[176:179],v[36:39]
v_exp_f32 v139,v139
v_mfma_f32_16x16x32_bf16 v[36:39],a[228:231],v[180:183],v[36:39]
v_cvt_pk_bf16_f32 v184,v136,v137
v_cvt_pk_bf16_f32 v185,v138,v139
v_mfma_f32_16x16x32_bf16 v[40:43],a[232:235],v[180:183],v[40:43]
v_exp_f32 v140,v140
v_mfma_f32_16x16x32_bf16 v[40:43],a[152:155],v[176:179],v[40:43]
v_exp_f32 v141,v141
v_mfma_f32_16x16x32_bf16 v[44:47],a[156:159],v[176:179],v[44:47]
v_exp_f32 v142,v142
v_mfma_f32_16x16x32_bf16 v[44:47],a[236:239],v[180:183],v[44:47]
v_exp_f32 v143,v143
v_mfma_f32_16x16x32_bf16 v[48:51],a[240:243],v[180:183],v[48:51]
v_cvt_pk_bf16_f32 v186,v140,v141
v_cvt_pk_bf16_f32 v187,v142,v143
v_mfma_f32_16x16x32_bf16 v[48:51],a[160:163],v[176:179],v[48:51]
buffer_load_dwordx4 v227,s[20:23],s34 offen offset:3072 nt lds
v_mfma_f32_16x16x32_bf16 v[52:55],a[164:167],v[176:179],v[52:55]
P117:
s_cbranch_execz P245
v_mfma_f32_16x16x32_bf16 v[52:55],a[244:247],v[180:183],v[52:55]
v_lshlrev_b32 v152,16,v244
v_and_b32 v153,0xffff0000,v244
v_mfma_f32_16x16x32_bf16 v[56:59],a[248:251],v[180:183],v[56:59]
v_mul_f32 v152,s80,v152
v_mul_f32 v153,s80,v153
v_mfma_f32_16x16x32_bf16 v[56:59],a[168:171],v[176:179],v[56:59]
v_cvt_pk_bf16_f32 v244,v152,v153
v_lshlrev_b32 v154,16,v245
v_mfma_f32_16x16x32_bf16 v[60:63],a[172:175],v[176:179],v[60:63]
v_and_b32 v155,0xffff0000,v245
v_mul_f32 v154,s80,v154
v_mfma_f32_16x16x32_bf16 v[60:63],a[252:255],v[180:183],v[60:63]
v_mul_f32 v155,s80,v155
v_cvt_pk_bf16_f32 v245,v154,v155
v_mfma_f32_16x16x32_bf16 v[144:147],a[112:115],v[96:99],v[196:199]
v_lshlrev_b32 v152,16,v246
v_and_b32 v153,0xffff0000,v246
v_mfma_f32_16x16x32_bf16 v[144:147],a[116:119],v[100:103],v[144:147]
v_mul_f32 v152,s80,v152
v_mul_f32 v153,s80,v153
v_mfma_f32_16x16x32_bf16 v[144:147],a[120:123],v[104:107],v[144:147]
v_cvt_pk_bf16_f32 v246,v152,v153
v_lshlrev_b32 v154,16,v247
v_mfma_f32_16x16x32_bf16 v[144:147],a[124:127],v[108:111],v[144:147]
v_and_b32 v155,0xffff0000,v247
v_mul_f32 v154,s80,v154
v_mfma_f32_16x16x32_bf16 v[148:151],a[128:131],v[108:111],v[196:199]
v_mul_f32 v155,s80,v155
v_cvt_pk_bf16_f32 v247,v154,v155
v_mfma_f32_16x16x32_bf16 v[148:151],a[132:135],v[104:107],v[148:151]
ds_write_b128 v230,v[244:247] offset:33792
v_mfma_f32_16x16x32_bf16 v[148:151],a[136:139],v[100:103],v[148:151]
v_exp_f32 v144,v144
v_mfma_f32_16x16x32_bf16 v[148:151],a[140:143],v[96:99],v[148:151]
v_exp_f32 v145,v145
v_mfma_f32_16x16x32_bf16 v[128:131],a[192:195],v[96:99],v[196:199]
v_exp_f32 v146,v146
v_mfma_f32_16x16x32_bf16 v[128:131],a[196:199],v[100:103],v[128:131]
P118:
s_cbranch_execz P246
v_mfma_f32_16x16x32_bf16 v[128:131],a[200:203],v[104:107],v[128:131]
v_exp_f32 v147,v147
v_mfma_f32_16x16x32_bf16 v[128:131],a[204:207],v[108:111],v[128:131]
v_cvt_pk_bf16_f32 v168,v144,v145
v_cvt_pk_bf16_f32 v169,v146,v147
v_mfma_f32_16x16x32_bf16 v[132:135],a[208:211],v[108:111],v[196:199]
v_exp_f32 v148,v148
v_mfma_f32_16x16x32_bf16 v[132:135],a[212:215],v[104:107],v[132:135]
v_exp_f32 v149,v149
v_mfma_f32_16x16x32_bf16 v[132:135],a[216:219],v[100:103],v[132:135]
v_exp_f32 v150,v150
v_mfma_f32_16x16x32_bf16 v[132:135],a[220:223],v[96:99],v[132:135]
v_exp_f32 v151,v151
v_mfma_f32_16x16x32_bf16 v[212:215],a[176:179],v[184:187],v[212:215]
v_cvt_pk_bf16_f32 v170,v148,v149
v_cvt_pk_bf16_f32 v171,v150,v151
v_mfma_f32_16x16x32_bf16 a[0:3],a[224:227],v[184:187],a[0:3]
v_exp_f32 v128,v128
v_mfma_f32_16x16x32_bf16 a[4:7],a[228:231],v[184:187],a[4:7]
v_exp_f32 v129,v129
v_mfma_f32_16x16x32_bf16 a[8:11],a[232:235],v[184:187],a[8:11]
s_add_u32 m0,s30,16384
v_exp_f32 v130,v130
v_mfma_f32_16x16x32_bf16 a[12:15],a[236:239],v[184:187],a[12:15]
s_mov_b32 s34,229376
v_exp_f32 v131,v131
v_mfma_f32_16x16x32_bf16 a[16:19],a[240:243],v[184:187],a[16:19]
v_cvt_pk_bf16_f32 v172,v128,v129
v_cvt_pk_bf16_f32 v173,v130,v131
v_mfma_f32_16x16x32_bf16 a[20:23],a[244:247],v[184:187],a[20:23]
v_exp_f32 v132,v132
v_mfma_f32_16x16x32_bf16 a[24:27],a[248:251],v[184:187],a[24:27]
s_waitcnt vmcnt(10) lgkmcnt(0)
s_barrier
v_mfma_f32_16x16x32_bf16 a[28:31],a[252:255],v[184:187],a[28:31]
v_exp_f32 v133,v133
v_mfma_f32_16x16x32_bf16 v[136:139],a[112:115],v[112:115],v[200:203]
v_exp_f32 v134,v134
v_mfma_f32_16x16x32_bf16 v[136:139],a[116:119],v[116:119],v[136:139]
P119:
s_cbranch_execz P247
v_mfma_f32_16x16x32_bf16 v[136:139],a[120:123],v[120:123],v[136:139]
buffer_load_dwordx4 v227,s[16:19],s34 offen nt lds
v_mfma_f32_16x16x32_bf16 v[136:139],a[124:127],v[124:127],v[136:139]
v_exp_f32 v135,v135
v_mfma_f32_16x16x32_bf16 v[140:143],a[128:131],v[124:127],v[200:203]
ds_read_b128 a[112:115],v224
v_cvt_pk_bf16_f32 v174,v132,v133
v_mfma_f32_16x16x32_bf16 v[140:143],a[132:135],v[120:123],v[140:143]
ds_read_b128 a[116:119],v224 offset:256
v_cvt_pk_bf16_f32 v175,v134,v135
v_mfma_f32_16x16x32_bf16 v[140:143],a[136:139],v[116:119],v[140:143]
buffer_load_dwordx4 v[244:247],v228,s[12:15],s68 offen offset:1024 nt
v_mfma_f32_16x16x32_bf16 v[140:143],a[140:143],v[112:115],v[140:143]
ds_read_b128 a[120:123],v224 offset:512
ds_read_b128 a[124:127],v224 offset:768
v_mfma_f32_16x16x32_bf16 v[144:147],a[192:195],v[112:115],v[200:203]
v_exp_f32 v136,v136
v_mfma_f32_16x16x32_bf16 v[144:147],a[196:199],v[116:119],v[144:147]
ds_read_b128 a[128:131],v224 offset:1792
ds_read_b128 a[132:135],v224 offset:1536
v_mfma_f32_16x16x32_bf16 v[144:147],a[200:203],v[120:123],v[144:147]
v_exp_f32 v137,v137
v_mfma_f32_16x16x32_bf16 v[144:147],a[204:207],v[124:127],v[144:147]
ds_read_b128 a[136:139],v224 offset:1280
ds_read_b128 a[140:143],v224 offset:1024
v_mfma_f32_16x16x32_bf16 v[148:151],a[208:211],v[124:127],v[200:203]
v_xor_b32 v224,0x800,v224
v_xor_b32 v225,0x18800,v225
v_mfma_f32_16x16x32_bf16 v[148:151],a[212:215],v[120:123],v[148:151]
ds_read_b128 a[192:195],v224
ds_read_b128 a[196:199],v224 offset:256
v_mfma_f32_16x16x32_bf16 v[148:151],a[216:219],v[116:119],v[148:151]
v_exp_f32 v138,v138
v_mfma_f32_16x16x32_bf16 v[148:151],a[220:223],v[112:115],v[148:151]
P120:
s_cbranch_execz P248
v_mfma_f32_16x16x32_bf16 v[208:211],a[184:187],v[168:171],v[208:211]
v_exp_f32 v139,v139
v_mfma_f32_16x16x32_bf16 v[208:211],a[184:187],v[172:175],v[208:211]
ds_read_b128 a[200:203],v224 offset:512
ds_read_b128 a[204:207],v224 offset:768
v_mfma_f32_16x16x32_bf16 a[32:35],a[224:227],v[172:175],a[32:35]
v_cvt_pk_bf16_f32 v176,v136,v137
v_cvt_pk_bf16_f32 v177,v138,v139
v_mfma_f32_16x16x32_bf16 a[32:35],a[144:147],v[168:171],a[32:35]
buffer_load_dwordx4 v227,s[16:19],s34 offen offset:1024 nt lds
v_mfma_f32_16x16x32_bf16 a[36:39],a[148:151],v[168:171],a[36:39]
v_exp_f32 v140,v140
v_mfma_f32_16x16x32_bf16 a[36:39],a[228:231],v[172:175],a[36:39]
ds_read_b128 a[208:211],v224 offset:1792
ds_read_b128 a[212:215],v224 offset:1536
v_mfma_f32_16x16x32_bf16 a[40:43],a[232:235],v[172:175],a[40:43]
v_exp_f32 v141,v141
v_mfma_f32_16x16x32_bf16 a[40:43],a[152:155],v[168:171],a[40:43]
v_exp_f32 v142,v142
v_mfma_f32_16x16x32_bf16 a[44:47],a[156:159],v[168:171],a[44:47]
ds_read_b128 a[216:219],v224 offset:1280
ds_read_b128 a[220:223],v224 offset:1024
v_mfma_f32_16x16x32_bf16 a[44:47],a[236:239],v[172:175],a[44:47]
v_exp_f32 v143,v143
v_mfma_f32_16x16x32_bf16 a[48:51],a[240:243],v[172:175],a[48:51]
v_cvt_pk_bf16_f32 v178,v140,v141
v_cvt_pk_bf16_f32 v179,v142,v143
v_mfma_f32_16x16x32_bf16 a[48:51],a[160:163],v[168:171],a[48:51]
v_exp_f32 v144,v144
v_mfma_f32_16x16x32_bf16 a[52:55],a[164:167],v[168:171],a[52:55]
v_exp_f32 v145,v145
v_mfma_f32_16x16x32_bf16 a[52:55],a[244:247],v[172:175],a[52:55]
v_exp_f32 v146,v146
v_mfma_f32_16x16x32_bf16 a[56:59],a[248:251],v[172:175],a[56:59]
v_exp_f32 v147,v147
v_mfma_f32_16x16x32_bf16 a[56:59],a[168:171],v[168:171],a[56:59]
P121:
s_cbranch_execz P249
v_mfma_f32_16x16x32_bf16 a[60:63],a[172:175],v[168:171],a[60:63]
v_cvt_pk_bf16_f32 v180,v144,v145
v_cvt_pk_bf16_f32 v181,v146,v147
v_mfma_f32_16x16x32_bf16 a[60:63],a[252:255],v[172:175],a[60:63]
s_waitcnt lgkmcnt(0)
v_exp_f32 v148,v148
v_mfma_f32_16x16x32_bf16 v[128:131],a[112:115],v[64:67],v[188:191]
v_exp_f32 v149,v149
v_mfma_f32_16x16x32_bf16 v[128:131],a[116:119],v[68:71],v[128:131]
v_exp_f32 v150,v150
v_mfma_f32_16x16x32_bf16 v[128:131],a[120:123],v[72:75],v[128:131]
buffer_load_dwordx4 v227,s[16:19],s34 offen offset:2048 nt lds
v_mfma_f32_16x16x32_bf16 v[128:131],a[124:127],v[76:79],v[128:131]
v_exp_f32 v151,v151
v_mfma_f32_16x16x32_bf16 v[132:135],a[128:131],v[76:79],v[188:191]
v_cvt_pk_bf16_f32 v182,v148,v149
v_cvt_pk_bf16_f32 v183,v150,v151
v_mfma_f32_16x16x32_bf16 v[132:135],a[132:135],v[72:75],v[132:135]
v_xor_b32 v226,0x18800,v226
v_lshlrev_b32 v152,16,v248
v_mfma_f32_16x16x32_bf16 v[132:135],a[136:139],v[68:71],v[132:135]
v_exp_f32 v128,v128
v_mfma_f32_16x16x32_bf16 v[132:135],a[140:143],v[64:67],v[132:135]
v_exp_f32 v129,v129
v_mfma_f32_16x16x32_bf16 v[136:139],a[192:195],v[64:67],v[188:191]
v_exp_f32 v130,v130
v_mfma_f32_16x16x32_bf16 v[136:139],a[196:199],v[68:71],v[136:139]
v_exp_f32 v131,v131
v_mfma_f32_16x16x32_bf16 v[136:139],a[200:203],v[72:75],v[136:139]
v_cvt_pk_bf16_f32 v168,v128,v129
v_cvt_pk_bf16_f32 v169,v130,v131
v_mfma_f32_16x16x32_bf16 v[136:139],a[204:207],v[76:79],v[136:139]
v_exp_f32 v132,v132
v_mfma_f32_16x16x32_bf16 v[140:143],a[208:211],v[76:79],v[188:191]
v_exp_f32 v133,v133
v_mfma_f32_16x16x32_bf16 v[140:143],a[212:215],v[72:75],v[140:143]
v_exp_f32 v134,v134
v_mfma_f32_16x16x32_bf16 v[140:143],a[216:219],v[68:71],v[140:143]
P122:
s_cbranch_execz P250
v_mfma_f32_16x16x32_bf16 v[140:143],a[220:223],v[64:67],v[140:143]
v_exp_f32 v135,v135
v_mfma_f32_16x16x32_bf16 v[208:211],a[188:191],v[176:179],v[208:211]
v_cvt_pk_bf16_f32 v170,v132,v133
v_cvt_pk_bf16_f32 v171,v134,v135
v_mfma_f32_16x16x32_bf16 v[208:211],a[188:191],v[180:183],v[208:211]
v_exp_f32 v136,v136
v_mfma_f32_16x16x32_bf16 a[64:67],a[224:227],v[180:183],a[64:67]
v_exp_f32 v137,v137
v_mfma_f32_16x16x32_bf16 a[64:67],a[144:147],v[176:179],a[64:67]
ds_read_b64_tr_b16 a[144:145],v225
ds_read_b64_tr_b16 a[146:147],v225 offset:1024
v_mfma_f32_16x16x32_bf16 a[68:71],a[148:151],v[176:179],a[68:71]
ds_read_b64_tr_b16 a[148:149],v226
ds_read_b64_tr_b16 a[150:151],v226 offset:1024
v_mfma_f32_16x16x32_bf16 a[68:71],a[228:231],v[180:183],a[68:71]
buffer_load_dwordx4 v227,s[16:19],s34 offen offset:3072 nt lds
v_mfma_f32_16x16x32_bf16 a[72:75],a[232:235],v[180:183],a[72:75]
v_exp_f32 v138,v138
v_mfma_f32_16x16x32_bf16 a[72:75],a[152:155],v[176:179],a[72:75]
ds_read_b64_tr_b16 a[152:153],v225 offset:256
ds_read_b64_tr_b16 a[154:155],v225 offset:1280
v_mfma_f32_16x16x32_bf16 a[76:79],a[156:159],v[176:179],a[76:79]
v_exp_f32 v139,v139
v_mfma_f32_16x16x32_bf16 a[76:79],a[236:239],v[180:183],a[76:79]
ds_read_b64_tr_b16 a[156:157],v226 offset:256
ds_read_b64_tr_b16 a[158:159],v226 offset:1280
v_mfma_f32_16x16x32_bf16 a[80:83],a[240:243],v[180:183],a[80:83]
v_cvt_pk_bf16_f32 v172,v136,v137
v_cvt_pk_bf16_f32 v173,v138,v139
v_mfma_f32_16x16x32_bf16 a[80:83],a[160:163],v[176:179],a[80:83]
ds_read_b64_tr_b16 a[160:161],v225 offset:512
ds_read_b64_tr_b16 a[162:163],v225 offset:1536
v_mfma_f32_16x16x32_bf16 a[84:87],a[164:167],v[176:179],a[84:87]
P123:
s_cbranch_execz P251
Z7:
s_cbranch_execz Z11
v_mfma_f32_16x16x32_bf16 a[84:87],a[244:247],v[180:183],a[84:87]
s_add_u32 m0,s30,32768
ds_read_b64_tr_b16 a[164:165],v226 offset:512
ds_read_b64_tr_b16 a[166:167],v226 offset:1536
v_mfma_f32_16x16x32_bf16 a[88:91],a[248:251],v[180:183],a[88:91]
s_mov_b32 s34,229376
v_exp_f32 v140,v140
v_mfma_f32_16x16x32_bf16 a[88:91],a[168:171],v[176:179],a[88:91]
ds_read_b64_tr_b16 a[168:169],v225 offset:768
ds_read_b64_tr_b16 a[170:171],v225 offset:1792
v_mfma_f32_16x16x32_bf16 a[92:95],a[172:175],v[176:179],a[92:95]
v_exp_f32 v141,v141
v_mfma_f32_16x16x32_bf16 a[92:95],a[252:255],v[180:183],a[92:95]
ds_read_b64_tr_b16 a[172:173],v226 offset:768
ds_read_b64_tr_b16 a[174:175],v226 offset:1792
v_mfma_f32_16x16x32_bf16 v[144:147],a[112:115],v[80:83],v[192:195]
v_xor_b32 v225,0x800,v225
v_xor_b32 v226,0x800,v226
v_mfma_f32_16x16x32_bf16 v[144:147],a[116:119],v[84:87],v[144:147]
ds_read_b64_tr_b16 a[224:225],v225
ds_read_b64_tr_b16 a[226:227],v225 offset:1024
v_mfma_f32_16x16x32_bf16 v[144:147],a[120:123],v[88:91],v[144:147]
buffer_load_dwordx4 v227,s[20:23],s34 offen nt lds
v_mfma_f32_16x16x32_bf16 v[144:147],a[124:127],v[92:95],v[144:147]
ds_read_b64_tr_b16 a[228:229],v226
ds_read_b64_tr_b16 a[230:231],v226 offset:1024
v_mfma_f32_16x16x32_bf16 v[148:151],a[128:131],v[92:95],v[192:195]
v_exp_f32 v142,v142
v_mfma_f32_16x16x32_bf16 v[148:151],a[132:135],v[88:91],v[148:151]
ds_read_b64_tr_b16 a[232:233],v225 offset:256
ds_read_b64_tr_b16 a[234:235],v225 offset:1280
v_mfma_f32_16x16x32_bf16 v[148:151],a[136:139],v[84:87],v[148:151]
P124:
s_cbranch_execz P252
v_mfma_f32_16x16x32_bf16 v[148:151],a[140:143],v[80:83],v[148:151]
ds_read_b64_tr_b16 a[236:237],v226 offset:256
ds_read_b64_tr_b16 a[238:239],v226 offset:1280
v_mfma_f32_16x16x32_bf16 v[128:131],a[192:195],v[80:83],v[192:195]
v_exp_f32 v143,v143
v_mfma_f32_16x16x32_bf16 v[128:131],a[196:199],v[84:87],v[128:131]
ds_read_b64_tr_b16 a[240:241],v225 offset:512
ds_read_b64_tr_b16 a[242:243],v225 offset:1536
v_mfma_f32_16x16x32_bf16 v[128:131],a[200:203],v[88:91],v[128:131]
v_cvt_pk_bf16_f32 v174,v140,v141
v_cvt_pk_bf16_f32 v175,v142,v143
v_mfma_f32_16x16x32_bf16 v[128:131],a[204:207],v[92:95],v[128:131]
ds_read_b64_tr_b16 a[244:245],v226 offset:512
ds_read_b64_tr_b16 a[246:247],v226 offset:1536
v_mfma_f32_16x16x32_bf16 v[132:135],a[208:211],v[92:95],v[192:195]
v_exp_f32 v144,v144
v_mfma_f32_16x16x32_bf16 v[132:135],a[212:215],v[88:91],v[132:135]
ds_read_b64_tr_b16 a[248:249],v225 offset:768
ds_read_b64_tr_b16 a[250:251],v225 offset:1792
v_mfma_f32_16x16x32_bf16 v[132:135],a[216:219],v[84:87],v[132:135]
v_exp_f32 v145,v145
v_mfma_f32_16x16x32_bf16 v[132:135],a[220:223],v[80:83],v[132:135]
ds_read_b64_tr_b16 a[252:253],v226 offset:768
ds_read_b64_tr_b16 a[254:255],v226 offset:1792
v_mfma_f32_16x16x32_bf16 v[208:211],a[176:179],v[168:171],v[208:211]
v_and_b32 v153,0xffff0000,v248
v_mul_f32 v152,s80,v152
v_mfma_f32_16x16x32_bf16 v[208:211],a[176:179],v[172:175],v[208:211]
s_waitcnt lgkmcnt(4)
v_exp_f32 v146,v146
v_mfma_f32_16x16x32_bf16 v[0:3],a[224:227],v[172:175],v[0:3]
v_mul_f32 v153,s80,v153
v_cvt_pk_bf16_f32 v248,v152,v153
v_mfma_f32_16x16x32_bf16 v[0:3],a[144:147],v[168:171],v[0:3]
buffer_load_dwordx4 v227,s[20:23],s34 offen offset:1024 nt lds
v_mfma_f32_16x16x32_bf16 v[4:7],a[148:151],v[168:171],v[4:7]
P125:
s_cbranch_execz P253
v_mfma_f32_16x16x32_bf16 v[4:7],a[228:231],v[172:175],v[4:7]
v_exp_f32 v147,v147
v_mfma_f32_16x16x32_bf16 v[8:11],a[232:235],v[172:175],v[8:11]
v_lshlrev_b32 v154,16,v249
v_and_b32 v155,0xffff0000,v249
v_mfma_f32_16x16x32_bf16 v[8:11],a[152:155],v[168:171],v[8:11]
v_cvt_pk_bf16_f32 v176,v144,v145
v_mul_f32 v154,s80,v154
v_mfma_f32_16x16x32_bf16 v[12:15],a[156:159],v[168:171],v[12:15]
v_cvt_pk_bf16_f32 v177,v146,v147
v_mul_f32 v155,s80,v155
v_mfma_f32_16x16x32_bf16 v[12:15],a[236:239],v[172:175],v[12:15]
v_cvt_pk_bf16_f32 v249,v154,v155
v_lshlrev_b32 v152,16,v250
v_mfma_f32_16x16x32_bf16 v[16:19],a[240:243],v[172:175],v[16:19]
v_exp_f32 v148,v148
v_mfma_f32_16x16x32_bf16 v[16:19],a[160:163],v[168:171],v[16:19]
v_and_b32 v153,0xffff0000,v250
v_exp_f32 v149,v149
v_mul_f32 v152,s80,v152
v_mfma_f32_16x16x32_bf16 v[20:23],a[164:167],v[168:171],v[20:23]
v_mul_f32 v153,s80,v153
v_exp_f32 v150,v150
v_cvt_pk_bf16_f32 v250,v152,v153
v_mfma_f32_16x16x32_bf16 v[20:23],a[244:247],v[172:175],v[20:23]
s_waitcnt lgkmcnt(0)
v_lshlrev_b32 v154,16,v251
v_exp_f32 v151,v151
v_and_b32 v155,0xffff0000,v251
v_mfma_f32_16x16x32_bf16 v[24:27],a[248:251],v[172:175],v[24:27]
v_mul_f32 v154,s80,v154
v_cvt_pk_bf16_f32 v178,v148,v149
v_mul_f32 v155,s80,v155
v_mfma_f32_16x16x32_bf16 v[24:27],a[168:171],v[168:171],v[24:27]
v_cvt_pk_bf16_f32 v179,v150,v151
v_cvt_pk_bf16_f32 v251,v154,v155
v_mfma_f32_16x16x32_bf16 v[28:31],a[172:175],v[168:171],v[28:31]
ds_write_b128 v229,v[248:251] offset:34816
v_exp_f32 v128,v128
v_mfma_f32_16x16x32_bf16 v[28:31],a[252:255],v[172:175],v[28:31]
buffer_load_dwordx4 v[248:251],v228,s[12:15],s68 offen offset:2048 nt
v_exp_f32 v129,v129
v_mfma_f32_16x16x32_bf16 v[136:139],a[192:195],a[96:99],v[204:207]
P126:
s_cbranch_execz P254
v_exp_f32 v130,v130
v_mfma_f32_16x16x32_bf16 v[136:139],a[196:199],a[100:103],v[136:139]
v_exp_f32 v131,v131
v_mfma_f32_16x16x32_bf16 v[136:139],a[200:203],a[104:107],v[136:139]
s_waitcnt vmcnt(16)
v_cvt_pk_bf16_f32 v180,v128,v129
v_cvt_pk_bf16_f32 v181,v130,v131
v_mfma_f32_16x16x32_bf16 v[136:139],a[204:207],a[108:111],v[136:139]
v_exp_f32 v132,v132
v_mfma_f32_16x16x32_bf16 v[140:143],a[208:211],a[108:111],v[204:207]
buffer_load_dwordx4 v227,s[20:23],s34 offen offset:2048 nt lds
v_exp_f32 v133,v133
v_mfma_f32_16x16x32_bf16 v[140:143],a[212:215],a[104:107],v[140:143]
v_exp_f32 v134,v134
v_mfma_f32_16x16x32_bf16 v[140:143],a[216:219],a[100:103],v[140:143]
v_exp_f32 v135,v135
v_mfma_f32_16x16x32_bf16 v[140:143],a[220:223],a[96:99],v[140:143]
v_cvt_pk_bf16_f32 v182,v132,v133
v_cvt_pk_bf16_f32 v183,v134,v135
v_mfma_f32_16x16x32_bf16 v[208:211],a[180:183],v[176:179],v[208:211]
v_exp_f32 v136,v136
v_mfma_f32_16x16x32_bf16 v[208:211],a[180:183],v[180:183],v[208:211]
v_exp_f32 v137,v137
v_mfma_f32_16x16x32_bf16 v[32:35],a[224:227],v[180:183],v[32:35]
v_exp_f32 v138,v138
v_mfma_f32_16x16x32_bf16 v[32:35],a[144:147],v[176:179],v[32:35]
v_exp_f32 v139,v139
v_mfma_f32_16x16x32_bf16 v[36:39],a[148:151],v[176:179],v[36:39]
v_cvt_pk_bf16_f32 v184,v136,v137
v_cvt_pk_bf16_f32 v185,v138,v139
v_mfma_f32_16x16x32_bf16 v[36:39],a[228:231],v[180:183],v[36:39]
v_exp_f32 v140,v140
v_mfma_f32_16x16x32_bf16 v[40:43],a[232:235],v[180:183],v[40:43]
P127:
s_cbranch_execz P255
v_mfma_f32_16x16x32_bf16 v[40:43],a[152:155],v[176:179],v[40:43]
v_exp_f32 v141,v141
v_mfma_f32_16x16x32_bf16 v[44:47],a[156:159],v[176:179],v[44:47]
v_exp_f32 v142,v142
v_mfma_f32_16x16x32_bf16 v[44:47],a[236:239],v[180:183],v[44:47]
v_exp_f32 v143,v143
v_mfma_f32_16x16x32_bf16 v[48:51],a[240:243],v[180:183],v[48:51]
v_cvt_pk_bf16_f32 v186,v140,v141
v_cvt_pk_bf16_f32 v187,v142,v143
v_mfma_f32_16x16x32_bf16 v[48:51],a[160:163],v[176:179],v[48:51]
buffer_load_dwordx4 v227,s[20:23],s34 offen offset:3072 nt lds
v_mfma_f32_16x16x32_bf16 v[52:55],a[164:167],v[176:179],v[52:55]
v_lshlrev_b32 v152,16,v252
v_and_b32 v153,0xffff0000,v252
v_mfma_f32_16x16x32_bf16 v[52:55],a[244:247],v[180:183],v[52:55]
v_mul_f32 v152,s80,v152
v_xor_b32 v224,0x18800,v224
v_mfma_f32_16x16x32_bf16 v[56:59],a[248:251],v[180:183],v[56:59]
v_mul_f32 v153,s80,v153
v_cvt_pk_bf16_f32 v252,v152,v153
v_mfma_f32_16x16x32_bf16 v[56:59],a[168:171],v[176:179],v[56:59]
v_lshlrev_b32 v154,16,v253
v_and_b32 v155,0xffff0000,v253
v_mfma_f32_16x16x32_bf16 v[60:63],a[172:175],v[176:179],v[60:63]
v_mul_f32 v154,s80,v154
v_mul_f32 v155,s80,v155
v_mfma_f32_16x16x32_bf16 v[60:63],a[252:255],v[180:183],v[60:63]
v_cvt_pk_bf16_f32 v253,v154,v155
v_lshlrev_b32 v152,16,v254
v_mfma_f32_16x16x32_bf16 v[144:147],a[112:115],v[96:99],v[196:199]
v_and_b32 v153,0xffff0000,v254
v_mul_f32 v152,s80,v152
v_mfma_f32_16x16x32_bf16 v[144:147],a[116:119],v[100:103],v[144:147]
v_mul_f32 v153,s80,v153
v_cvt_pk_bf16_f32 v254,v152,v153
v_mfma_f32_16x16x32_bf16 v[144:147],a[120:123],v[104:107],v[144:147]
v_lshlrev_b32 v154,16,v255
v_and_b32 v155,0xffff0000,v255
v_mfma_f32_16x16x32_bf16 v[144:147],a[124:127],v[108:111],v[144:147]
P128:
s_cbranch_execz P256
v_mfma_f32_16x16x32_bf16 v[148:151],a[128:131],v[108:111],v[196:199]
v_mul_f32 v154,s80,v154
v_mul_f32 v155,s80,v155
v_mfma_f32_16x16x32_bf16 v[148:151],a[132:135],v[104:107],v[148:151]
v_cvt_pk_bf16_f32 v255,v154,v155
v_xor_b32 v225,0x10800,v225
v_mfma_f32_16x16x32_bf16 v[148:151],a[136:139],v[100:103],v[148:151]
v_exp_f32 v144,v144
v_mfma_f32_16x16x32_bf16 v[148:151],a[140:143],v[96:99],v[148:151]
v_exp_f32 v145,v145
v_mfma_f32_16x16x32_bf16 v[128:131],a[192:195],v[96:99],v[196:199]
v_exp_f32 v146,v146
v_mfma_f32_16x16x32_bf16 v[128:131],a[196:199],v[100:103],v[128:131]
v_exp_f32 v147,v147
v_mfma_f32_16x16x32_bf16 v[128:131],a[200:203],v[104:107],v[128:131]
v_cvt_pk_bf16_f32 v168,v144,v145
v_cvt_pk_bf16_f32 v169,v146,v147
v_mfma_f32_16x16x32_bf16 v[128:131],a[204:207],v[108:111],v[128:131]
v_exp_f32 v148,v148
v_mfma_f32_16x16x32_bf16 v[132:135],a[208:211],v[108:111],v[196:199]
v_exp_f32 v149,v149
v_mfma_f32_16x16x32_bf16 v[132:135],a[212:215],v[104:107],v[132:135]
v_exp_f32 v150,v150
v_mfma_f32_16x16x32_bf16 v[132:135],a[216:219],v[100:103],v[132:135]
v_exp_f32 v151,v151
v_mfma_f32_16x16x32_bf16 v[132:135],a[220:223],v[96:99],v[132:135]
v_cvt_pk_bf16_f32 v170,v148,v149
v_cvt_pk_bf16_f32 v171,v150,v151
v_mfma_f32_16x16x32_bf16 v[212:215],a[176:179],v[184:187],v[212:215]
v_exp_f32 v128,v128
v_mfma_f32_16x16x32_bf16 a[0:3],a[224:227],v[184:187],a[0:3]
v_exp_f32 v129,v129
v_mfma_f32_16x16x32_bf16 a[4:7],a[228:231],v[184:187],a[4:7]
v_exp_f32 v130,v130
v_mfma_f32_16x16x32_bf16 a[8:11],a[232:235],v[184:187],a[8:11]
s_add_u32 m0,s30,49152
v_exp_f32 v131,v131
v_mfma_f32_16x16x32_bf16 a[12:15],a[236:239],v[184:187],a[12:15]
P129:
s_cbranch_execz P257
v_mfma_f32_16x16x32_bf16 a[16:19],a[240:243],v[184:187],a[16:19]
s_mov_b32 s34,245760
v_cvt_pk_bf16_f32 v172,v128,v129
v_cvt_pk_bf16_f32 v173,v130,v131
v_mfma_f32_16x16x32_bf16 a[20:23],a[244:247],v[184:187],a[20:23]
v_exp_f32 v132,v132
v_mfma_f32_16x16x32_bf16 a[24:27],a[248:251],v[184:187],a[24:27]
s_waitcnt vmcnt(10) lgkmcnt(0)
s_barrier
v_mfma_f32_16x16x32_bf16 a[28:31],a[252:255],v[184:187],a[28:31]
v_exp_f32 v133,v133
v_mfma_f32_16x16x32_bf16 v[136:139],a[112:115],v[112:115],v[200:203]
v_exp_f32 v134,v134
v_mfma_f32_16x16x32_bf16 v[136:139],a[116:119],v[116:119],v[136:139]
v_exp_f32 v135,v135
v_mfma_f32_16x16x32_bf16 v[136:139],a[120:123],v[120:123],v[136:139]
buffer_load_dwordx4 v227,s[16:19],s34 offen nt lds
v_mfma_f32_16x16x32_bf16 v[136:139],a[124:127],v[124:127],v[136:139]
ds_read_b128 a[112:115],v224
v_cvt_pk_bf16_f32 v174,v132,v133
v_mfma_f32_16x16x32_bf16 v[140:143],a[128:131],v[124:127],v[200:203]
ds_read_b128 a[116:119],v224 offset:256
v_cvt_pk_bf16_f32 v175,v134,v135
v_mfma_f32_16x16x32_bf16 v[140:143],a[132:135],v[120:123],v[140:143]
ds_write_b128 v230,v[252:255] offset:35840
v_mfma_f32_16x16x32_bf16 v[140:143],a[136:139],v[116:119],v[140:143]
buffer_load_dwordx4 v[252:255],v228,s[12:15],s68 offen offset:3072 nt
v_mfma_f32_16x16x32_bf16 v[140:143],a[140:143],v[112:115],v[140:143]
ds_read_b128 a[120:123],v224 offset:512
ds_read_b128 a[124:127],v224 offset:768
v_mfma_f32_16x16x32_bf16 v[144:147],a[192:195],v[112:115],v[200:203]
v_exp_f32 v136,v136
v_mfma_f32_16x16x32_bf16 v[144:147],a[196:199],v[116:119],v[144:147]
ds_read_b128 a[128:131],v224 offset:1792
ds_read_b128 a[132:135],v224 offset:1536
v_mfma_f32_16x16x32_bf16 v[144:147],a[200:203],v[120:123],v[144:147]
P130:
s_cbranch_execz P258
v_mfma_f32_16x16x32_bf16 v[144:147],a[204:207],v[124:127],v[144:147]
ds_read_b128 a[136:139],v224 offset:1280
ds_read_b128 a[140:143],v224 offset:1024
v_mfma_f32_16x16x32_bf16 v[148:151],a[208:211],v[124:127],v[200:203]
v_xor_b32 v224,0x800,v224
v_xor_b32 v226,0x10800,v226
v_mfma_f32_16x16x32_bf16 v[148:151],a[212:215],v[120:123],v[148:151]
ds_read_b128 a[192:195],v224
ds_read_b128 a[196:199],v224 offset:256
v_mfma_f32_16x16x32_bf16 v[148:151],a[216:219],v[116:119],v[148:151]
v_exp_f32 v137,v137
v_mfma_f32_16x16x32_bf16 v[148:151],a[220:223],v[112:115],v[148:151]
v_exp_f32 v138,v138
v_mfma_f32_16x16x32_bf16 v[208:211],a[184:187],v[168:171],v[208:211]
v_exp_f32 v139,v139
v_mfma_f32_16x16x32_bf16 v[208:211],a[184:187],v[172:175],v[208:211]
ds_read_b128 a[200:203],v224 offset:512
ds_read_b128 a[204:207],v224 offset:768
v_mfma_f32_16x16x32_bf16 a[32:35],a[224:227],v[172:175],a[32:35]
v_cvt_pk_bf16_f32 v176,v136,v137
v_cvt_pk_bf16_f32 v177,v138,v139
v_mfma_f32_16x16x32_bf16 a[32:35],a[144:147],v[168:171],a[32:35]
buffer_load_dwordx4 v227,s[16:19],s34 offen offset:1024 nt lds
v_mfma_f32_16x16x32_bf16 a[36:39],a[148:151],v[168:171],a[36:39]
v_exp_f32 v140,v140
v_mfma_f32_16x16x32_bf16 a[36:39],a[228:231],v[172:175],a[36:39]
ds_read_b128 a[208:211],v224 offset:1792
ds_read_b128 a[212:215],v224 offset:1536
v_mfma_f32_16x16x32_bf16 a[40:43],a[232:235],v[172:175],a[40:43]
v_exp_f32 v141,v141
v_mfma_f32_16x16x32_bf16 a[40:43],a[152:155],v[168:171],a[40:43]
v_exp_f32 v142,v142
v_mfma_f32_16x16x32_bf16 a[44:47],a[156:159],v[168:171],a[44:47]
P131:
s_cbranch_execz P259
v_mfma_f32_16x16x32_bf16 a[44:47],a[236:239],v[172:175],a[44:47]
ds_read_b128 a[216:219],v224 offset:1280
ds_read_b128 a[220:223],v224 offset:1024
v_mfma_f32_16x16x32_bf16 a[48:51],a[240:243],v[172:175],a[48:51]
v_exp_f32 v143,v143
v_mfma_f32_16x16x32_bf16 a[48:51],a[160:163],v[168:171],a[48:51]
v_cvt_pk_bf16_f32 v178,v140,v141
v_cvt_pk_bf16_f32 v179,v142,v143
v_mfma_f32_16x16x32_bf16 a[52:55],a[164:167],v[168:171],a[52:55]
v_exp_f32 v144,v144
v_mfma_f32_16x16x32_bf16 a[52:55],a[244:247],v[172:175],a[52:55]
v_exp_f32 v145,v145
v_mfma_f32_16x16x32_bf16 a[56:59],a[248:251],v[172:175],a[56:59]
v_exp_f32 v146,v146
v_mfma_f32_16x16x32_bf16 a[56:59],a[168:171],v[168:171],a[56:59]
v_exp_f32 v147,v147
v_mfma_f32_16x16x32_bf16 a[60:63],a[172:175],v[168:171],a[60:63]
v_cvt_pk_bf16_f32 v180,v144,v145
v_cvt_pk_bf16_f32 v181,v146,v147
v_mfma_f32_16x16x32_bf16 a[60:63],a[252:255],v[172:175],a[60:63]
s_waitcnt lgkmcnt(0)
v_exp_f32 v148,v148
v_mfma_f32_16x16x32_bf16 v[128:131],a[112:115],v[64:67],v[188:191]
v_exp_f32 v149,v149
v_mfma_f32_16x16x32_bf16 v[128:131],a[116:119],v[68:71],v[128:131]
v_exp_f32 v150,v150
v_mfma_f32_16x16x32_bf16 v[128:131],a[120:123],v[72:75],v[128:131]
buffer_load_dwordx4 v227,s[16:19],s34 offen offset:2048 nt lds
v_mfma_f32_16x16x32_bf16 v[128:131],a[124:127],v[76:79],v[128:131]
v_exp_f32 v151,v151
v_mfma_f32_16x16x32_bf16 v[132:135],a[128:131],v[76:79],v[188:191]
v_cvt_pk_bf16_f32 v182,v148,v149
v_cvt_pk_bf16_f32 v183,v150,v151
v_mfma_f32_16x16x32_bf16 v[132:135],a[132:135],v[72:75],v[132:135]
v_lshlrev_b32 v152,16,v240
v_and_b32 v153,0xffff0000,v240
v_mfma_f32_16x16x32_bf16 v[132:135],a[136:139],v[68:71],v[132:135]
P132:
s_cbranch_execz P260
v_mfma_f32_16x16x32_bf16 v[132:135],a[140:143],v[64:67],v[132:135]
v_exp_f32 v128,v128
v_mfma_f32_16x16x32_bf16 v[136:139],a[192:195],v[64:67],v[188:191]
v_exp_f32 v129,v129
v_mfma_f32_16x16x32_bf16 v[136:139],a[196:199],v[68:71],v[136:139]
v_exp_f32 v130,v130
v_mfma_f32_16x16x32_bf16 v[136:139],a[200:203],v[72:75],v[136:139]
v_exp_f32 v131,v131
v_mfma_f32_16x16x32_bf16 v[136:139],a[204:207],v[76:79],v[136:139]
v_cvt_pk_bf16_f32 v168,v128,v129
v_cvt_pk_bf16_f32 v169,v130,v131
v_mfma_f32_16x16x32_bf16 v[140:143],a[208:211],v[76:79],v[188:191]
v_exp_f32 v132,v132
v_mfma_f32_16x16x32_bf16 v[140:143],a[212:215],v[72:75],v[140:143]
v_exp_f32 v133,v133
v_mfma_f32_16x16x32_bf16 v[140:143],a[216:219],v[68:71],v[140:143]
v_exp_f32 v134,v134
v_mfma_f32_16x16x32_bf16 v[140:143],a[220:223],v[64:67],v[140:143]
v_exp_f32 v135,v135
v_mfma_f32_16x16x32_bf16 v[208:211],a[188:191],v[176:179],v[208:211]
v_cvt_pk_bf16_f32 v170,v132,v133
v_cvt_pk_bf16_f32 v171,v134,v135
v_mfma_f32_16x16x32_bf16 v[208:211],a[188:191],v[180:183],v[208:211]
v_exp_f32 v136,v136
v_mfma_f32_16x16x32_bf16 a[64:67],a[224:227],v[180:183],a[64:67]
v_exp_f32 v137,v137
v_mfma_f32_16x16x32_bf16 a[64:67],a[144:147],v[176:179],a[64:67]
ds_read_b64_tr_b16 a[144:145],v225
ds_read_b64_tr_b16 a[146:147],v225 offset:1024
v_mfma_f32_16x16x32_bf16 a[68:71],a[148:151],v[176:179],a[68:71]
ds_read_b64_tr_b16 a[148:149],v226
ds_read_b64_tr_b16 a[150:151],v226 offset:1024
v_mfma_f32_16x16x32_bf16 a[68:71],a[228:231],v[180:183],a[68:71]
buffer_load_dwordx4 v227,s[16:19],s34 offen offset:3072 nt lds
v_mfma_f32_16x16x32_bf16 a[72:75],a[232:235],v[180:183],a[72:75]
v_exp_f32 v138,v138
v_mfma_f32_16x16x32_bf16 a[72:75],a[152:155],v[176:179],a[72:75]
ds_read_b64_tr_b16 a[152:153],v225 offset:256
ds_read_b64_tr_b16 a[154:155],v225 offset:1280
v_mfma_f32_16x16x32_bf16 a[76:79],a[156:159],v[176:179],a[76:79]
P133:
s_cbranch_execz P261
v_mfma_f32_16x16x32_bf16 a[76:79],a[236:239],v[180:183],a[76:79]
ds_read_b64_tr_b16 a[156:157],v226 offset:256
ds_read_b64_tr_b16 a[158:159],v226 offset:1280
v_mfma_f32_16x16x32_bf16 a[80:83],a[240:243],v[180:183],a[80:83]
v_exp_f32 v139,v139
v_mfma_f32_16x16x32_bf16 a[80:83],a[160:163],v[176:179],a[80:83]
ds_read_b64_tr_b16 a[160:161],v225 offset:512
ds_read_b64_tr_b16 a[162:163],v225 offset:1536
v_mfma_f32_16x16x32_bf16 a[84:87],a[164:167],v[176:179],a[84:87]
s_add_u32 m0,s30,65536
v_cvt_pk_bf16_f32 v172,v136,v137
v_cvt_pk_bf16_f32 v173,v138,v139
v_mfma_f32_16x16x32_bf16 a[84:87],a[244:247],v[180:183],a[84:87]
s_mov_b32 s34,245760
ds_read_b64_tr_b16 a[164:165],v226 offset:512
ds_read_b64_tr_b16 a[166:167],v226 offset:1536
v_mfma_f32_16x16x32_bf16 a[88:91],a[248:251],v[180:183],a[88:91]
v_exp_f32 v140,v140
v_mfma_f32_16x16x32_bf16 a[88:91],a[168:171],v[176:179],a[88:91]
ds_read_b64_tr_b16 a[168:169],v225 offset:768
ds_read_b64_tr_b16 a[170:171],v225 offset:1792
v_mfma_f32_16x16x32_bf16 a[92:95],a[172:175],v[176:179],a[92:95]
v_exp_f32 v141,v141
v_mfma_f32_16x16x32_bf16 a[92:95],a[252:255],v[180:183],a[92:95]
ds_read_b64_tr_b16 a[172:173],v226 offset:768
ds_read_b64_tr_b16 a[174:175],v226 offset:1792
v_mfma_f32_16x16x32_bf16 v[144:147],a[112:115],v[80:83],v[192:195]
v_xor_b32 v225,0x800,v225
v_xor_b32 v226,0x800,v226
v_mfma_f32_16x16x32_bf16 v[144:147],a[116:119],v[84:87],v[144:147]
P134:
s_cbranch_execz P262
v_mfma_f32_16x16x32_bf16 v[144:147],a[120:123],v[88:91],v[144:147]
ds_read_b64_tr_b16 a[224:225],v225
ds_read_b64_tr_b16 a[226:227],v225 offset:1024
v_mfma_f32_16x16x32_bf16 v[144:147],a[124:127],v[92:95],v[144:147]
buffer_load_dwordx4 v227,s[20:23],s34 offen nt lds
v_mfma_f32_16x16x32_bf16 v[148:151],a[128:131],v[92:95],v[192:195]
ds_read_b64_tr_b16 a[228:229],v226
ds_read_b64_tr_b16 a[230:231],v226 offset:1024
v_mfma_f32_16x16x32_bf16 v[148:151],a[132:135],v[88:91],v[148:151]
v_exp_f32 v142,v142
v_mfma_f32_16x16x32_bf16 v[148:151],a[136:139],v[84:87],v[148:151]
ds_read_b64_tr_b16 a[232:233],v225 offset:256
ds_read_b64_tr_b16 a[234:235],v225 offset:1280
v_mfma_f32_16x16x32_bf16 v[148:151],a[140:143],v[80:83],v[148:151]
v_exp_f32 v143,v143
v_mfma_f32_16x16x32_bf16 v[128:131],a[192:195],v[80:83],v[192:195]
ds_read_b64_tr_b16 a[236:237],v226 offset:256
ds_read_b64_tr_b16 a[238:239],v226 offset:1280
v_mfma_f32_16x16x32_bf16 v[128:131],a[196:199],v[84:87],v[128:131]
v_cvt_pk_bf16_f32 v174,v140,v141
v_cvt_pk_bf16_f32 v175,v142,v143
v_mfma_f32_16x16x32_bf16 v[128:131],a[200:203],v[88:91],v[128:131]
ds_read_b64_tr_b16 a[240:241],v225 offset:512
ds_read_b64_tr_b16 a[242:243],v225 offset:1536
v_mfma_f32_16x16x32_bf16 v[128:131],a[204:207],v[92:95],v[128:131]
v_mul_f32 v152,s80,v152
v_mul_f32 v153,s80,v153
v_mfma_f32_16x16x32_bf16 v[132:135],a[208:211],v[92:95],v[192:195]
ds_read_b64_tr_b16 a[244:245],v226 offset:512
ds_read_b64_tr_b16 a[246:247],v226 offset:1536
v_mfma_f32_16x16x32_bf16 v[132:135],a[212:215],v[88:91],v[132:135]
v_cvt_pk_bf16_f32 v240,v152,v153
v_lshlrev_b32 v154,16,v241
v_mfma_f32_16x16x32_bf16 v[132:135],a[216:219],v[84:87],v[132:135]
P135:
s_cbranch_execz P263
v_mfma_f32_16x16x32_bf16 v[132:135],a[220:223],v[80:83],v[132:135]
ds_read_b64_tr_b16 a[248:249],v225 offset:768
ds_read_b64_tr_b16 a[250:251],v225 offset:1792
v_mfma_f32_16x16x32_bf16 v[208:211],a[176:179],v[168:171],v[208:211]
v_and_b32 v155,0xffff0000,v241
v_mul_f32 v154,s80,v154
v_mfma_f32_16x16x32_bf16 v[208:211],a[176:179],v[172:175],v[208:211]
s_waitcnt lgkmcnt(4)
v_exp_f32 v144,v144
v_mfma_f32_16x16x32_bf16 v[0:3],a[224:227],v[172:175],v[0:3]
ds_read_b64_tr_b16 a[252:253],v226 offset:768
v_mul_f32 v155,s80,v155
v_mfma_f32_16x16x32_bf16 v[0:3],a[144:147],v[168:171],v[0:3]
buffer_load_dwordx4 v227,s[20:23],s34 offen offset:1024 nt lds
v_mfma_f32_16x16x32_bf16 v[4:7],a[148:151],v[168:171],v[4:7]
v_exp_f32 v145,v145
v_mfma_f32_16x16x32_bf16 v[4:7],a[228:231],v[172:175],v[4:7]
ds_read_b64_tr_b16 a[254:255],v226 offset:1792
v_cvt_pk_bf16_f32 v241,v154,v155
v_mfma_f32_16x16x32_bf16 v[8:11],a[232:235],v[172:175],v[8:11]
v_lshlrev_b32 v152,16,v242
v_and_b32 v153,0xffff0000,v242
v_mfma_f32_16x16x32_bf16 v[8:11],a[152:155],v[168:171],v[8:11]
v_exp_f32 v146,v146
v_mul_f32 v152,s80,v152
v_mfma_f32_16x16x32_bf16 v[12:15],a[156:159],v[168:171],v[12:15]
v_exp_f32 v147,v147
v_mul_f32 v153,s80,v153
v_cvt_pk_bf16_f32 v242,v152,v153
v_mfma_f32_16x16x32_bf16 v[12:15],a[236:239],v[172:175],v[12:15]
v_cvt_pk_bf16_f32 v176,v144,v145
v_lshlrev_b32 v154,16,v243
v_cvt_pk_bf16_f32 v177,v146,v147
v_and_b32 v155,0xffff0000,v243
v_mfma_f32_16x16x32_bf16 v[16:19],a[240:243],v[172:175],v[16:19]
v_mul_f32 v154,s80,v154
v_exp_f32 v148,v148
v_mul_f32 v155,s80,v155
v_mfma_f32_16x16x32_bf16 v[16:19],a[160:163],v[168:171],v[16:19]
v_cvt_pk_bf16_f32 v243,v154,v155
v_exp_f32 v149,v149
v_mfma_f32_16x16x32_bf16 v[20:23],a[164:167],v[168:171],v[20:23]
s_waitcnt lgkmcnt(0)
v_exp_f32 v150,v150
v_mfma_f32_16x16x32_bf16 v[20:23],a[244:247],v[172:175],v[20:23]
P136:
s_cbranch_execz P264
v_exp_f32 v151,v151
v_mfma_f32_16x16x32_bf16 v[24:27],a[248:251],v[172:175],v[24:27]
s_waitcnt vmcnt(15)
v_cvt_pk_bf16_f32 v178,v148,v149
v_cvt_pk_bf16_f32 v179,v150,v151
v_mfma_f32_16x16x32_bf16 v[24:27],a[168:171],v[168:171],v[24:27]
v_exp_f32 v128,v128
v_mfma_f32_16x16x32_bf16 v[28:31],a[172:175],v[168:171],v[28:31]
v_exp_f32 v129,v129
v_mfma_f32_16x16x32_bf16 v[28:31],a[252:255],v[172:175],v[28:31]
v_exp_f32 v130,v130
v_mfma_f32_16x16x32_bf16 v[136:139],a[192:195],a[96:99],v[204:207]
v_exp_f32 v131,v131
v_mfma_f32_16x16x32_bf16 v[136:139],a[196:199],a[100:103],v[136:139]
v_cvt_pk_bf16_f32 v180,v128,v129
v_cvt_pk_bf16_f32 v181,v130,v131
v_mfma_f32_16x16x32_bf16 v[136:139],a[200:203],a[104:107],v[136:139]
v_exp_f32 v132,v132
v_mfma_f32_16x16x32_bf16 v[136:139],a[204:207],a[108:111],v[136:139]
buffer_load_dwordx4 v227,s[20:23],s34 offen offset:2048 nt lds
v_mfma_f32_16x16x32_bf16 v[140:143],a[208:211],a[108:111],v[204:207]
v_exp_f32 v133,v133
v_mfma_f32_16x16x32_bf16 v[140:143],a[212:215],a[104:107],v[140:143]
v_exp_f32 v134,v134
v_mfma_f32_16x16x32_bf16 v[140:143],a[216:219],a[100:103],v[140:143]
v_exp_f32 v135,v135
v_mfma_f32_16x16x32_bf16 v[140:143],a[220:223],a[96:99],v[140:143]
v_cvt_pk_bf16_f32 v182,v132,v133
v_cvt_pk_bf16_f32 v183,v134,v135
v_mfma_f32_16x16x32_bf16 v[208:211],a[180:183],v[176:179],v[208:211]
v_exp_f32 v136,v136
v_mfma_f32_16x16x32_bf16 v[208:211],a[180:183],v[180:183],v[208:211]
P137:
s_cbranch_execz P265
v_mfma_f32_16x16x32_bf16 v[32:35],a[224:227],v[180:183],v[32:35]
v_exp_f32 v137,v137
v_mfma_f32_16x16x32_bf16 v[32:35],a[144:147],v[176:179],v[32:35]
v_exp_f32 v138,v138
v_mfma_f32_16x16x32_bf16 v[36:39],a[148:151],v[176:179],v[36:39]
v_exp_f32 v139,v139
v_mfma_f32_16x16x32_bf16 v[36:39],a[228:231],v[180:183],v[36:39]
v_cvt_pk_bf16_f32 v184,v136,v137
v_cvt_pk_bf16_f32 v185,v138,v139
v_mfma_f32_16x16x32_bf16 v[40:43],a[232:235],v[180:183],v[40:43]
v_exp_f32 v140,v140
v_mfma_f32_16x16x32_bf16 v[40:43],a[152:155],v[176:179],v[40:43]
v_exp_f32 v141,v141
v_mfma_f32_16x16x32_bf16 v[44:47],a[156:159],v[176:179],v[44:47]
v_exp_f32 v142,v142
v_mfma_f32_16x16x32_bf16 v[44:47],a[236:239],v[180:183],v[44:47]
v_exp_f32 v143,v143
v_mfma_f32_16x16x32_bf16 v[48:51],a[240:243],v[180:183],v[48:51]
v_cvt_pk_bf16_f32 v186,v140,v141
v_cvt_pk_bf16_f32 v187,v142,v143
v_mfma_f32_16x16x32_bf16 v[48:51],a[160:163],v[176:179],v[48:51]
buffer_load_dwordx4 v227,s[20:23],s34 offen offset:3072 nt lds
v_mfma_f32_16x16x32_bf16 v[52:55],a[164:167],v[176:179],v[52:55]
v_lshlrev_b32 v152,16,v244
v_and_b32 v153,0xffff0000,v244
v_mfma_f32_16x16x32_bf16 v[52:55],a[244:247],v[180:183],v[52:55]
v_mul_f32 v152,s80,v152
v_mul_f32 v153,s80,v153
v_mfma_f32_16x16x32_bf16 v[56:59],a[248:251],v[180:183],v[56:59]
v_cvt_pk_bf16_f32 v244,v152,v153
v_lshlrev_b32 v154,16,v245
v_mfma_f32_16x16x32_bf16 v[56:59],a[168:171],v[176:179],v[56:59]
v_and_b32 v155,0xffff0000,v245
v_mul_f32 v154,s80,v154
v_mfma_f32_16x16x32_bf16 v[60:63],a[172:175],v[176:179],v[60:63]
v_mul_f32 v155,s80,v155
v_xor_b32 v224,0x10800,v224
v_mfma_f32_16x16x32_bf16 v[60:63],a[252:255],v[180:183],v[60:63]
P138:
s_cbranch_execz P266
v_mfma_f32_16x16x32_bf16 v[144:147],a[112:115],v[96:99],v[196:199]
v_cvt_pk_bf16_f32 v245,v154,v155
v_lshlrev_b32 v152,16,v246
v_mfma_f32_16x16x32_bf16 v[144:147],a[116:119],v[100:103],v[144:147]
v_and_b32 v153,0xffff0000,v246
v_mul_f32 v152,s80,v152
v_mfma_f32_16x16x32_bf16 v[144:147],a[120:123],v[104:107],v[144:147]
v_mul_f32 v153,s80,v153
v_cvt_pk_bf16_f32 v246,v152,v153
v_mfma_f32_16x16x32_bf16 v[144:147],a[124:127],v[108:111],v[144:147]
v_lshlrev_b32 v154,16,v247
v_and_b32 v155,0xffff0000,v247
v_mfma_f32_16x16x32_bf16 v[148:151],a[128:131],v[108:111],v[196:199]
v_mul_f32 v154,s80,v154
v_mul_f32 v155,s80,v155
v_mfma_f32_16x16x32_bf16 v[148:151],a[132:135],v[104:107],v[148:151]
v_cvt_pk_bf16_f32 v247,v154,v155
v_xor_b32 v225,0x8800,v225
v_mfma_f32_16x16x32_bf16 v[148:151],a[136:139],v[100:103],v[148:151]
v_exp_f32 v144,v144
v_mfma_f32_16x16x32_bf16 v[148:151],a[140:143],v[96:99],v[148:151]
v_exp_f32 v145,v145
v_mfma_f32_16x16x32_bf16 v[128:131],a[192:195],v[96:99],v[196:199]
v_exp_f32 v146,v146
v_mfma_f32_16x16x32_bf16 v[128:131],a[196:199],v[100:103],v[128:131]
v_exp_f32 v147,v147
v_mfma_f32_16x16x32_bf16 v[128:131],a[200:203],v[104:107],v[128:131]
v_cvt_pk_bf16_f32 v168,v144,v145
v_cvt_pk_bf16_f32 v169,v146,v147
v_mfma_f32_16x16x32_bf16 v[128:131],a[204:207],v[108:111],v[128:131]
v_exp_f32 v148,v148
v_mfma_f32_16x16x32_bf16 v[132:135],a[208:211],v[108:111],v[196:199]
v_exp_f32 v149,v149
v_mfma_f32_16x16x32_bf16 v[132:135],a[212:215],v[104:107],v[132:135]
v_exp_f32 v150,v150
v_mfma_f32_16x16x32_bf16 v[132:135],a[216:219],v[100:103],v[132:135]
v_exp_f32 v151,v151
v_mfma_f32_16x16x32_bf16 v[132:135],a[220:223],v[96:99],v[132:135]
v_cvt_pk_bf16_f32 v170,v148,v149
v_cvt_pk_bf16_f32 v171,v150,v151
v_mfma_f32_16x16x32_bf16 v[212:215],a[176:179],v[184:187],v[212:215]
P139:
s_cbranch_execz P267
Z8:
s_cbranch_execz ZB0
v_mfma_f32_16x16x32_bf16 a[0:3],a[224:227],v[184:187],a[0:3]
v_exp_f32 v128,v128
v_mfma_f32_16x16x32_bf16 a[4:7],a[228:231],v[184:187],a[4:7]
v_exp_f32 v129,v129
v_mfma_f32_16x16x32_bf16 a[8:11],a[232:235],v[184:187],a[8:11]
s_add_u32 m0,s30,81920
v_exp_f32 v130,v130
v_mfma_f32_16x16x32_bf16 a[12:15],a[236:239],v[184:187],a[12:15]
s_mov_b32 s34,262144
v_exp_f32 v131,v131
v_mfma_f32_16x16x32_bf16 a[16:19],a[240:243],v[184:187],a[16:19]
v_cvt_pk_bf16_f32 v172,v128,v129
v_cvt_pk_bf16_f32 v173,v130,v131
v_mfma_f32_16x16x32_bf16 a[20:23],a[244:247],v[184:187],a[20:23]
v_exp_f32 v132,v132
v_mfma_f32_16x16x32_bf16 a[24:27],a[248:251],v[184:187],a[24:27]
s_waitcnt vmcnt(9) lgkmcnt(0)
s_barrier
v_mfma_f32_16x16x32_bf16 a[28:31],a[252:255],v[184:187],a[28:31]
v_exp_f32 v133,v133
v_mfma_f32_16x16x32_bf16 v[136:139],a[112:115],v[112:115],v[200:203]
v_exp_f32 v134,v134
v_mfma_f32_16x16x32_bf16 v[136:139],a[116:119],v[116:119],v[136:139]
v_exp_f32 v135,v135
v_mfma_f32_16x16x32_bf16 v[136:139],a[120:123],v[120:123],v[136:139]
buffer_load_dwordx4 v227,s[16:19],s34 offen nt lds
v_mfma_f32_16x16x32_bf16 v[136:139],a[124:127],v[124:127],v[136:139]
ds_read_b128 a[112:115],v224
v_cvt_pk_bf16_f32 v174,v132,v133
v_mfma_f32_16x16x32_bf16 v[140:143],a[128:131],v[124:127],v[200:203]
ds_read_b128 a[116:119],v224 offset:256
v_cvt_pk_bf16_f32 v175,v134,v135
v_mfma_f32_16x16x32_bf16 v[140:143],a[132:135],v[120:123],v[140:143]
v_xor_b32 v226,0x8800,v226
v_mfma_f32_16x16x32_bf16 v[140:143],a[136:139],v[116:119],v[140:143]
P140:
s_cbranch_execz P268
v_mfma_f32_16x16x32_bf16 v[140:143],a[140:143],v[112:115],v[140:143]
ds_read_b128 a[120:123],v224 offset:512
ds_read_b128 a[124:127],v224 offset:768
v_mfma_f32_16x16x32_bf16 v[144:147],a[192:195],v[112:115],v[200:203]
v_exp_f32 v136,v136
v_mfma_f32_16x16x32_bf16 v[144:147],a[196:199],v[116:119],v[144:147]
ds_read_b128 a[128:131],v224 offset:1792
ds_read_b128 a[132:135],v224 offset:1536
v_mfma_f32_16x16x32_bf16 v[144:147],a[200:203],v[120:123],v[144:147]
v_exp_f32 v137,v137
v_mfma_f32_16x16x32_bf16 v[144:147],a[204:207],v[124:127],v[144:147]
ds_read_b128 a[136:139],v224 offset:1280
ds_read_b128 a[140:143],v224 offset:1024
v_mfma_f32_16x16x32_bf16 v[148:151],a[208:211],v[124:127],v[200:203]
v_exp_f32 v138,v138
v_mfma_f32_16x16x32_bf16 v[148:151],a[212:215],v[120:123],v[148:151]
v_xor_b32 v224,0x800,v224
v_lshlrev_b32 v152,16,v248
v_mfma_f32_16x16x32_bf16 v[148:151],a[216:219],v[116:119],v[148:151]
ds_read_b128 a[192:195],v224
ds_read_b128 a[196:199],v224 offset:256
v_mfma_f32_16x16x32_bf16 v[148:151],a[220:223],v[112:115],v[148:151]
v_exp_f32 v139,v139
v_mfma_f32_16x16x32_bf16 v[208:211],a[184:187],v[168:171],v[208:211]
ds_read_b128 a[200:203],v224 offset:512
ds_read_b128 a[204:207],v224 offset:768
v_mfma_f32_16x16x32_bf16 v[208:211],a[184:187],v[172:175],v[208:211]
v_cvt_pk_bf16_f32 v176,v136,v137
v_cvt_pk_bf16_f32 v177,v138,v139
v_mfma_f32_16x16x32_bf16 a[32:35],a[224:227],v[172:175],a[32:35]
v_exp_f32 v140,v140
v_mfma_f32_16x16x32_bf16 a[32:35],a[144:147],v[168:171],a[32:35]
buffer_load_dwordx4 v227,s[16:19],s34 offen offset:1024 nt lds
v_mfma_f32_16x16x32_bf16 a[36:39],a[148:151],v[168:171],a[36:39]
P141:
s_cbranch_execz P269
v_mfma_f32_16x16x32_bf16 a[36:39],a[228:231],v[172:175],a[36:39]
ds_read_b128 a[208:211],v224 offset:1792
ds_read_b128 a[212:215],v224 offset:1536
v_mfma_f32_16x16x32_bf16 a[40:43],a[232:235],v[172:175],a[40:43]
v_exp_f32 v141,v141
v_mfma_f32_16x16x32_bf16 a[40:43],a[152:155],v[168:171],a[40:43]
v_exp_f32 v142,v142
v_mfma_f32_16x16x32_bf16 a[44:47],a[156:159],v[168:171],a[44:47]
ds_read_b128 a[216:219],v224 offset:1280
ds_read_b128 a[220:223],v224 offset:1024
v_mfma_f32_16x16x32_bf16 a[44:47],a[236:239],v[172:175],a[44:47]
v_exp_f32 v143,v143
v_mfma_f32_16x16x32_bf16 a[48:51],a[240:243],v[172:175],a[48:51]
v_cvt_pk_bf16_f32 v178,v140,v141
v_cvt_pk_bf16_f32 v179,v142,v143
v_mfma_f32_16x16x32_bf16 a[48:51],a[160:163],v[168:171],a[48:51]
v_exp_f32 v144,v144
v_mfma_f32_16x16x32_bf16 a[52:55],a[164:167],v[168:171],a[52:55]
v_exp_f32 v145,v145
v_mfma_f32_16x16x32_bf16 a[52:55],a[244:247],v[172:175],a[52:55]
v_exp_f32 v146,v146
v_mfma_f32_16x16x32_bf16 a[56:59],a[248:251],v[172:175],a[56:59]
v_exp_f32 v147,v147
v_mfma_f32_16x16x32_bf16 a[56:59],a[168:171],v[168:171],a[56:59]
v_cvt_pk_bf16_f32 v180,v144,v145
v_cvt_pk_bf16_f32 v181,v146,v147
v_mfma_f32_16x16x32_bf16 a[60:63],a[172:175],v[168:171],a[60:63]
v_exp_f32 v148,v148
v_mfma_f32_16x16x32_bf16 a[60:63],a[252:255],v[172:175],a[60:63]
s_waitcnt lgkmcnt(0)
v_exp_f32 v149,v149
v_mfma_f32_16x16x32_bf16 v[128:131],a[112:115],v[64:67],v[188:191]
v_exp_f32 v150,v150
v_mfma_f32_16x16x32_bf16 v[128:131],a[116:119],v[68:71],v[128:131]
v_exp_f32 v151,v151
v_mfma_f32_16x16x32_bf16 v[128:131],a[120:123],v[72:75],v[128:131]
buffer_load_dwordx4 v227,s[16:19],s34 offen offset:2048 nt lds
v_mfma_f32_16x16x32_bf16 v[128:131],a[124:127],v[76:79],v[128:131]
P142:
s_cbranch_execz P270
v_mfma_f32_16x16x32_bf16 v[132:135],a[128:131],v[76:79],v[188:191]
v_cvt_pk_bf16_f32 v182,v148,v149
v_cvt_pk_bf16_f32 v183,v150,v151
v_mfma_f32_16x16x32_bf16 v[132:135],a[132:135],v[72:75],v[132:135]
v_and_b32 v153,0xffff0000,v248
v_mul_f32 v152,s80,v152
v_mfma_f32_16x16x32_bf16 v[132:135],a[136:139],v[68:71],v[132:135]
v_exp_f32 v128,v128
v_mfma_f32_16x16x32_bf16 v[132:135],a[140:143],v[64:67],v[132:135]
v_exp_f32 v129,v129
v_mfma_f32_16x16x32_bf16 v[136:139],a[192:195],v[64:67],v[188:191]
v_exp_f32 v130,v130
v_mfma_f32_16x16x32_bf16 v[136:139],a[196:199],v[68:71],v[136:139]
v_exp_f32 v131,v131
v_mfma_f32_16x16x32_bf16 v[136:139],a[200:203],v[72:75],v[136:139]
v_cvt_pk_bf16_f32 v168,v128,v129
v_cvt_pk_bf16_f32 v169,v130,v131
v_mfma_f32_16x16x32_bf16 v[136:139],a[204:207],v[76:79],v[136:139]
v_exp_f32 v132,v132
v_mfma_f32_16x16x32_bf16 v[140:143],a[208:211],v[76:79],v[188:191]
v_exp_f32 v133,v133
v_mfma_f32_16x16x32_bf16 v[140:143],a[212:215],v[72:75],v[140:143]
v_exp_f32 v134,v134
v_mfma_f32_16x16x32_bf16 v[140:143],a[216:219],v[68:71],v[140:143]
v_exp_f32 v135,v135
v_mfma_f32_16x16x32_bf16 v[140:143],a[220:223],v[64:67],v[140:143]
v_cvt_pk_bf16_f32 v170,v132,v133
v_cvt_pk_bf16_f32 v171,v134,v135
v_mfma_f32_16x16x32_bf16 v[208:211],a[188:191],v[176:179],v[208:211]
v_exp_f32 v136,v136
v_mfma_f32_16x16x32_bf16 v[208:211],a[188:191],v[180:183],v[208:211]
v_exp_f32 v137,v137
v_mfma_f32_16x16x32_bf16 a[64:67],a[224:227],v[180:183],a[64:67]
v_exp_f32 v138,v138
v_mfma_f32_16x16x32_bf16 a[64:67],a[144:147],v[176:179],a[64:67]
ds_read_b64_tr_b16 a[144:145],v225
ds_read_b64_tr_b16 a[146:147],v225 offset:1024
v_mfma_f32_16x16x32_bf16 a[68:71],a[148:151],v[176:179],a[68:71]
ds_read_b64_tr_b16 a[148:149],v226
ds_read_b64_tr_b16 a[150:151],v226 offset:1024
v_mfma_f32_16x16x32_bf16 a[68:71],a[228:231],v[180:183],a[68:71]
P143:
s_cbranch_execz P271
buffer_load_dwordx4 v227,s[16:19],s34 offen offset:3072 nt lds
v_mfma_f32_16x16x32_bf16 a[72:75],a[232:235],v[180:183],a[72:75]
v_exp_f32 v139,v139
v_mfma_f32_16x16x32_bf16 a[72:75],a[152:155],v[176:179],a[72:75]
ds_read_b64_tr_b16 a[152:153],v225 offset:256
ds_read_b64_tr_b16 a[154:155],v225 offset:1280
v_mfma_f32_16x16x32_bf16 a[76:79],a[156:159],v[176:179],a[76:79]
v_cvt_pk_bf16_f32 v172,v136,v137
v_cvt_pk_bf16_f32 v173,v138,v139
v_mfma_f32_16x16x32_bf16 a[76:79],a[236:239],v[180:183],a[76:79]
ds_read_b64_tr_b16 a[156:157],v226 offset:256
ds_read_b64_tr_b16 a[158:159],v226 offset:1280
v_mfma_f32_16x16x32_bf16 a[80:83],a[240:243],v[180:183],a[80:83]
v_exp_f32 v140,v140
v_mfma_f32_16x16x32_bf16 a[80:83],a[160:163],v[176:179],a[80:83]
ds_read_b64_tr_b16 a[160:161],v225 offset:512
ds_read_b64_tr_b16 a[162:163],v225 offset:1536
v_mfma_f32_16x16x32_bf16 a[84:87],a[164:167],v[176:179],a[84:87]
s_add_u32 m0,s30,0
v_exp_f32 v141,v141
v_mfma_f32_16x16x32_bf16 a[84:87],a[244:247],v[180:183],a[84:87]
s_mov_b32 s34,262144
ds_read_b64_tr_b16 a[164:165],v226 offset:512
ds_read_b64_tr_b16 a[166:167],v226 offset:1536
v_mfma_f32_16x16x32_bf16 a[88:91],a[248:251],v[180:183],a[88:91]
v_exp_f32 v142,v142
v_mfma_f32_16x16x32_bf16 a[88:91],a[168:171],v[176:179],a[88:91]
ds_read_b64_tr_b16 a[168:169],v225 offset:768
ds_read_b64_tr_b16 a[170:171],v225 offset:1792
v_mfma_f32_16x16x32_bf16 a[92:95],a[172:175],v[176:179],a[92:95]
P144:
s_cbranch_execz P272
v_mfma_f32_16x16x32_bf16 a[92:95],a[252:255],v[180:183],a[92:95]
ds_read_b64_tr_b16 a[172:173],v226 offset:768
ds_read_b64_tr_b16 a[174:175],v226 offset:1792
v_mfma_f32_16x16x32_bf16 v[144:147],a[112:115],v[80:83],v[192:195]
v_xor_b32 v225,0x800,v225
v_xor_b32 v226,0x800,v226
v_mfma_f32_16x16x32_bf16 v[144:147],a[116:119],v[84:87],v[144:147]
ds_read_b64_tr_b16 a[224:225],v225
ds_read_b64_tr_b16 a[226:227],v225 offset:1024
v_mfma_f32_16x16x32_bf16 v[144:147],a[120:123],v[88:91],v[144:147]
buffer_load_dwordx4 v227,s[20:23],s34 offen nt lds
v_mfma_f32_16x16x32_bf16 v[144:147],a[124:127],v[92:95],v[144:147]
ds_read_b64_tr_b16 a[228:229],v226
ds_read_b64_tr_b16 a[230:231],v226 offset:1024
v_mfma_f32_16x16x32_bf16 v[148:151],a[128:131],v[92:95],v[192:195]
v_mul_f32 v153,s80,v153
v_cvt_pk_bf16_f32 v248,v152,v153
v_mfma_f32_16x16x32_bf16 v[148:151],a[132:135],v[88:91],v[148:151]
ds_read_b64_tr_b16 a[232:233],v225 offset:256
ds_read_b64_tr_b16 a[234:235],v225 offset:1280
v_mfma_f32_16x16x32_bf16 v[148:151],a[136:139],v[84:87],v[148:151]
v_exp_f32 v143,v143
v_mfma_f32_16x16x32_bf16 v[148:151],a[140:143],v[80:83],v[148:151]
ds_read_b64_tr_b16 a[236:237],v226 offset:256
ds_read_b64_tr_b16 a[238:239],v226 offset:1280
v_mfma_f32_16x16x32_bf16 v[128:131],a[192:195],v[80:83],v[192:195]
v_lshlrev_b32 v154,16,v249
v_cvt_pk_bf16_f32 v174,v140,v141
v_mfma_f32_16x16x32_bf16 v[128:131],a[196:199],v[84:87],v[128:131]
ds_read_b64_tr_b16 a[240:241],v225 offset:512
ds_read_b64_tr_b16 a[242:243],v225 offset:1536
v_mfma_f32_16x16x32_bf16 v[128:131],a[200:203],v[88:91],v[128:131]
P145:
s_cbranch_execz P273
v_mfma_f32_16x16x32_bf16 v[128:131],a[204:207],v[92:95],v[128:131]
ds_read_b64_tr_b16 a[244:245],v226 offset:512
v_and_b32 v155,0xffff0000,v249
v_mfma_f32_16x16x32_bf16 v[132:135],a[208:211],v[92:95],v[192:195]
ds_read_b64_tr_b16 a[246:247],v226 offset:1536
v_cvt_pk_bf16_f32 v175,v142,v143
v_mfma_f32_16x16x32_bf16 v[132:135],a[212:215],v[88:91],v[132:135]
v_mul_f32 v154,s80,v154
v_mul_f32 v155,s80,v155
v_mfma_f32_16x16x32_bf16 v[132:135],a[216:219],v[84:87],v[132:135]
ds_read_b64_tr_b16 a[248:249],v225 offset:768
v_cvt_pk_bf16_f32 v249,v154,v155
v_mfma_f32_16x16x32_bf16 v[132:135],a[220:223],v[80:83],v[132:135]
ds_read_b64_tr_b16 a[250:251],v225 offset:1792
v_lshlrev_b32 v152,16,v250
v_mfma_f32_16x16x32_bf16 v[208:211],a[176:179],v[168:171],v[208:211]
v_and_b32 v153,0xffff0000,v250
v_mul_f32 v152,s80,v152
v_mfma_f32_16x16x32_bf16 v[208:211],a[176:179],v[172:175],v[208:211]
s_waitcnt lgkmcnt(3)
ds_read_b64_tr_b16 a[252:253],v226 offset:768
v_mul_f32 v153,s80,v153
v_mfma_f32_16x16x32_bf16 v[0:3],a[224:227],v[172:175],v[0:3]
ds_read_b64_tr_b16 a[254:255],v226 offset:1792
v_cvt_pk_bf16_f32 v250,v152,v153
v_mfma_f32_16x16x32_bf16 v[0:3],a[144:147],v[168:171],v[0:3]
v_lshlrev_b32 v154,16,v251
v_and_b32 v155,0xffff0000,v251
v_mfma_f32_16x16x32_bf16 v[4:7],a[148:151],v[168:171],v[4:7]
v_exp_f32 v144,v144
v_mfma_f32_16x16x32_bf16 v[4:7],a[228:231],v[172:175],v[4:7]
buffer_load_dwordx4 v227,s[20:23],s34 offen offset:1024 nt lds
v_mul_f32 v154,s80,v154
v_mul_f32 v155,s80,v155
v_mfma_f32_16x16x32_bf16 v[8:11],a[232:235],v[172:175],v[8:11]
v_exp_f32 v145,v145
v_cvt_pk_bf16_f32 v251,v154,v155
v_mfma_f32_16x16x32_bf16 v[8:11],a[152:155],v[168:171],v[8:11]
v_exp_f32 v146,v146
v_mfma_f32_16x16x32_bf16 v[12:15],a[156:159],v[168:171],v[12:15]
v_exp_f32 v147,v147
v_mfma_f32_16x16x32_bf16 v[12:15],a[236:239],v[172:175],v[12:15]
s_waitcnt vmcnt(13)
v_cvt_pk_bf16_f32 v176,v144,v145
P146:
s_cbranch_execz P274
v_cvt_pk_bf16_f32 v177,v146,v147
v_mfma_f32_16x16x32_bf16 v[16:19],a[240:243],v[172:175],v[16:19]
v_exp_f32 v148,v148
v_mfma_f32_16x16x32_bf16 v[16:19],a[160:163],v[168:171],v[16:19]
v_exp_f32 v149,v149
v_mfma_f32_16x16x32_bf16 v[20:23],a[164:167],v[168:171],v[20:23]
s_waitcnt lgkmcnt(0)
v_exp_f32 v150,v150
v_mfma_f32_16x16x32_bf16 v[20:23],a[244:247],v[172:175],v[20:23]
v_exp_f32 v151,v151
v_mfma_f32_16x16x32_bf16 v[24:27],a[248:251],v[172:175],v[24:27]
v_cvt_pk_bf16_f32 v178,v148,v149
v_cvt_pk_bf16_f32 v179,v150,v151
v_mfma_f32_16x16x32_bf16 v[24:27],a[168:171],v[168:171],v[24:27]
v_exp_f32 v128,v128
v_mfma_f32_16x16x32_bf16 v[28:31],a[172:175],v[168:171],v[28:31]
v_exp_f32 v129,v129
v_mfma_f32_16x16x32_bf16 v[28:31],a[252:255],v[172:175],v[28:31]
v_exp_f32 v130,v130
v_mfma_f32_16x16x32_bf16 v[136:139],a[192:195],a[96:99],v[204:207]
v_exp_f32 v131,v131
v_mfma_f32_16x16x32_bf16 v[136:139],a[196:199],a[100:103],v[136:139]
v_cvt_pk_bf16_f32 v180,v128,v129
v_cvt_pk_bf16_f32 v181,v130,v131
v_mfma_f32_16x16x32_bf16 v[136:139],a[200:203],a[104:107],v[136:139]
v_exp_f32 v132,v132
v_mfma_f32_16x16x32_bf16 v[136:139],a[204:207],a[108:111],v[136:139]
buffer_load_dwordx4 v227,s[20:23],s34 offen offset:2048 nt lds
v_mfma_f32_16x16x32_bf16 v[140:143],a[208:211],a[108:111],v[204:207]
v_exp_f32 v133,v133
v_mfma_f32_16x16x32_bf16 v[140:143],a[212:215],a[104:107],v[140:143]
v_exp_f32 v134,v134
v_mfma_f32_16x16x32_bf16 v[140:143],a[216:219],a[100:103],v[140:143]
v_exp_f32 v135,v135
v_mfma_f32_16x16x32_bf16 v[140:143],a[220:223],a[96:99],v[140:143]
v_cvt_pk_bf16_f32 v182,v132,v133
v_cvt_pk_bf16_f32 v183,v134,v135
v_mfma_f32_16x16x32_bf16 v[208:211],a[180:183],v[176:179],v[208:211]
P147:
s_cbranch_execz P275
v_mfma_f32_16x16x32_bf16 v[208:211],a[180:183],v[180:183],v[208:211]
v_exp_f32 v136,v136
v_mfma_f32_16x16x32_bf16 v[32:35],a[224:227],v[180:183],v[32:35]
v_exp_f32 v137,v137
v_mfma_f32_16x16x32_bf16 v[32:35],a[144:147],v[176:179],v[32:35]
v_exp_f32 v138,v138
v_mfma_f32_16x16x32_bf16 v[36:39],a[148:151],v[176:179],v[36:39]
v_exp_f32 v139,v139
v_mfma_f32_16x16x32_bf16 v[36:39],a[228:231],v[180:183],v[36:39]
v_cvt_pk_bf16_f32 v184,v136,v137
v_cvt_pk_bf16_f32 v185,v138,v139
v_mfma_f32_16x16x32_bf16 v[40:43],a[232:235],v[180:183],v[40:43]
v_exp_f32 v140,v140
v_mfma_f32_16x16x32_bf16 v[40:43],a[152:155],v[176:179],v[40:43]
v_exp_f32 v141,v141
v_mfma_f32_16x16x32_bf16 v[44:47],a[156:159],v[176:179],v[44:47]
v_exp_f32 v142,v142
v_mfma_f32_16x16x32_bf16 v[44:47],a[236:239],v[180:183],v[44:47]
v_exp_f32 v143,v143
v_mfma_f32_16x16x32_bf16 v[48:51],a[240:243],v[180:183],v[48:51]
v_cvt_pk_bf16_f32 v186,v140,v141
v_cvt_pk_bf16_f32 v187,v142,v143
v_mfma_f32_16x16x32_bf16 v[48:51],a[160:163],v[176:179],v[48:51]
buffer_load_dwordx4 v227,s[20:23],s34 offen offset:3072 nt lds
v_mfma_f32_16x16x32_bf16 v[52:55],a[164:167],v[176:179],v[52:55]
v_lshlrev_b32 v152,16,v252
v_and_b32 v153,0xffff0000,v252
v_mfma_f32_16x16x32_bf16 v[52:55],a[244:247],v[180:183],v[52:55]
v_mul_f32 v152,s80,v152
v_mul_f32 v153,s80,v153
v_mfma_f32_16x16x32_bf16 v[56:59],a[248:251],v[180:183],v[56:59]
v_cvt_pk_bf16_f32 v252,v152,v153
v_lshlrev_b32 v154,16,v253
v_mfma_f32_16x16x32_bf16 v[56:59],a[168:171],v[176:179],v[56:59]
P148:
s_cbranch_execz P276
v_mfma_f32_16x16x32_bf16 v[60:63],a[172:175],v[176:179],v[60:63]
v_and_b32 v155,0xffff0000,v253
v_mul_f32 v154,s80,v154
v_mfma_f32_16x16x32_bf16 v[60:63],a[252:255],v[180:183],v[60:63]
v_mul_f32 v155,s80,v155
v_cvt_pk_bf16_f32 v253,v154,v155
v_mfma_f32_16x16x32_bf16 v[144:147],a[112:115],v[96:99],v[196:199]
v_lshlrev_b32 v152,16,v254
v_and_b32 v153,0xffff0000,v254
v_mfma_f32_16x16x32_bf16 v[144:147],a[116:119],v[100:103],v[144:147]
v_mul_f32 v152,s80,v152
v_mul_f32 v153,s80,v153
v_mfma_f32_16x16x32_bf16 v[144:147],a[120:123],v[104:107],v[144:147]
v_cvt_pk_bf16_f32 v254,v152,v153
v_lshlrev_b32 v154,16,v255
v_mfma_f32_16x16x32_bf16 v[144:147],a[124:127],v[108:111],v[144:147]
v_and_b32 v155,0xffff0000,v255
v_mul_f32 v154,s80,v154
v_mfma_f32_16x16x32_bf16 v[148:151],a[128:131],v[108:111],v[196:199]
v_mul_f32 v155,s80,v155
v_xor_b32 v224,0x8800,v224
v_mfma_f32_16x16x32_bf16 v[148:151],a[132:135],v[104:107],v[148:151]
v_cvt_pk_bf16_f32 v255,v154,v155
v_xor_b32 v225,0x18800,v225
v_mfma_f32_16x16x32_bf16 v[148:151],a[136:139],v[100:103],v[148:151]
v_exp_f32 v144,v144
v_mfma_f32_16x16x32_bf16 v[148:151],a[140:143],v[96:99],v[148:151]
v_exp_f32 v145,v145
v_mfma_f32_16x16x32_bf16 v[128:131],a[192:195],v[96:99],v[196:199]
v_exp_f32 v146,v146
v_mfma_f32_16x16x32_bf16 v[128:131],a[196:199],v[100:103],v[128:131]
v_exp_f32 v147,v147
v_mfma_f32_16x16x32_bf16 v[128:131],a[200:203],v[104:107],v[128:131]
v_cvt_pk_bf16_f32 v168,v144,v145
v_cvt_pk_bf16_f32 v169,v146,v147
v_mfma_f32_16x16x32_bf16 v[128:131],a[204:207],v[108:111],v[128:131]
P149:
s_cbranch_execz P277
v_mfma_f32_16x16x32_bf16 v[132:135],a[208:211],v[108:111],v[196:199]
v_exp_f32 v148,v148
v_mfma_f32_16x16x32_bf16 v[132:135],a[212:215],v[104:107],v[132:135]
v_exp_f32 v149,v149
v_mfma_f32_16x16x32_bf16 v[132:135],a[216:219],v[100:103],v[132:135]
v_exp_f32 v150,v150
v_mfma_f32_16x16x32_bf16 v[132:135],a[220:223],v[96:99],v[132:135]
v_exp_f32 v151,v151
v_mfma_f32_16x16x32_bf16 v[212:215],a[176:179],v[184:187],v[212:215]
v_cvt_pk_bf16_f32 v170,v148,v149
v_cvt_pk_bf16_f32 v171,v150,v151
v_mfma_f32_16x16x32_bf16 a[0:3],a[224:227],v[184:187],a[0:3]
v_exp_f32 v128,v128
v_mfma_f32_16x16x32_bf16 a[4:7],a[228:231],v[184:187],a[4:7]
v_exp_f32 v129,v129
v_mfma_f32_16x16x32_bf16 a[8:11],a[232:235],v[184:187],a[8:11]
s_add_u32 m0,s30,16384
v_exp_f32 v130,v130
v_mfma_f32_16x16x32_bf16 a[12:15],a[236:239],v[184:187],a[12:15]
s_mov_b32 s34,278528
v_exp_f32 v131,v131
v_mfma_f32_16x16x32_bf16 a[16:19],a[240:243],v[184:187],a[16:19]
v_cvt_pk_bf16_f32 v172,v128,v129
v_cvt_pk_bf16_f32 v173,v130,v131
v_mfma_f32_16x16x32_bf16 a[20:23],a[244:247],v[184:187],a[20:23]
v_exp_f32 v132,v132
v_mfma_f32_16x16x32_bf16 a[24:27],a[248:251],v[184:187],a[24:27]
s_waitcnt vmcnt(8) lgkmcnt(0)
s_barrier
v_mfma_f32_16x16x32_bf16 a[28:31],a[252:255],v[184:187],a[28:31]
v_exp_f32 v133,v133
v_mfma_f32_16x16x32_bf16 v[136:139],a[112:115],v[112:115],v[200:203]
v_exp_f32 v134,v134
v_mfma_f32_16x16x32_bf16 v[136:139],a[116:119],v[116:119],v[136:139]
v_exp_f32 v135,v135
v_mfma_f32_16x16x32_bf16 v[136:139],a[120:123],v[120:123],v[136:139]
buffer_load_dwordx4 v227,s[16:19],s34 offen nt lds
v_mfma_f32_16x16x32_bf16 v[136:139],a[124:127],v[124:127],v[136:139]
P150:
s_cbranch_execz P278
v_mfma_f32_16x16x32_bf16 v[140:143],a[128:131],v[124:127],v[200:203]
ds_read_b128 a[112:115],v224
v_cvt_pk_bf16_f32 v174,v132,v133
v_mfma_f32_16x16x32_bf16 v[140:143],a[132:135],v[120:123],v[140:143]
ds_read_b128 a[116:119],v224 offset:256
v_cvt_pk_bf16_f32 v175,v134,v135
v_mfma_f32_16x16x32_bf16 v[140:143],a[136:139],v[116:119],v[140:143]
v_exp_f32 v136,v136
v_mfma_f32_16x16x32_bf16 v[140:143],a[140:143],v[112:115],v[140:143]
ds_read_b128 a[120:123],v224 offset:512
ds_read_b128 a[124:127],v224 offset:768
v_mfma_f32_16x16x32_bf16 v[144:147],a[192:195],v[112:115],v[200:203]
v_exp_f32 v137,v137
v_mfma_f32_16x16x32_bf16 v[144:147],a[196:199],v[116:119],v[144:147]
ds_read_b128 a[128:131],v224 offset:1792
ds_read_b128 a[132:135],v224 offset:1536
v_mfma_f32_16x16x32_bf16 v[144:147],a[200:203],v[120:123],v[144:147]
v_exp_f32 v138,v138
v_mfma_f32_16x16x32_bf16 v[144:147],a[204:207],v[124:127],v[144:147]
ds_read_b128 a[136:139],v224 offset:1280
ds_read_b128 a[140:143],v224 offset:1024
v_mfma_f32_16x16x32_bf16 v[148:151],a[208:211],v[124:127],v[200:203]
v_exp_f32 v139,v139
v_mfma_f32_16x16x32_bf16 v[148:151],a[212:215],v[120:123],v[148:151]
v_cvt_pk_bf16_f32 v176,v136,v137
v_cvt_pk_bf16_f32 v177,v138,v139
v_mfma_f32_16x16x32_bf16 v[148:151],a[216:219],v[116:119],v[148:151]
v_exp_f32 v140,v140
v_mfma_f32_16x16x32_bf16 v[148:151],a[220:223],v[112:115],v[148:151]
v_exp_f32 v141,v141
v_mfma_f32_16x16x32_bf16 v[208:211],a[184:187],v[168:171],v[208:211]
v_exp_f32 v142,v142
v_mfma_f32_16x16x32_bf16 v[208:211],a[184:187],v[172:175],v[208:211]
v_exp_f32 v143,v143
v_mfma_f32_16x16x32_bf16 a[32:35],a[224:227],v[172:175],a[32:35]
ds_read_b128 a[192:195],v231
v_cvt_pk_bf16_f32 v178,v140,v141
v_mfma_f32_16x16x32_bf16 a[32:35],a[144:147],v[168:171],a[32:35]
P151:
s_cbranch_execz P279
v_mfma_f32_16x16x32_bf16 a[36:39],a[148:151],v[168:171],a[36:39]
buffer_load_dwordx4 v227,s[16:19],s34 offen offset:1024 nt lds
v_mfma_f32_16x16x32_bf16 a[36:39],a[228:231],v[172:175],a[36:39]
ds_read_b128 a[196:199],v232
v_cvt_pk_bf16_f32 v179,v142,v143
v_mfma_f32_16x16x32_bf16 a[40:43],a[232:235],v[172:175],a[40:43]
v_exp_f32 v144,v144
v_mfma_f32_16x16x32_bf16 a[40:43],a[152:155],v[168:171],a[40:43]
v_exp_f32 v145,v145
v_mfma_f32_16x16x32_bf16 a[44:47],a[156:159],v[168:171],a[44:47]
v_exp_f32 v146,v146
v_mfma_f32_16x16x32_bf16 a[44:47],a[236:239],v[172:175],a[44:47]
v_exp_f32 v147,v147
v_mfma_f32_16x16x32_bf16 a[48:51],a[240:243],v[172:175],a[48:51]
ds_read_b128 a[200:203],v231 offset:128
v_cvt_pk_bf16_f32 v180,v144,v145
v_mfma_f32_16x16x32_bf16 a[48:51],a[160:163],v[168:171],a[48:51]
ds_read_b128 a[204:207],v232 offset:128
v_cvt_pk_bf16_f32 v181,v146,v147
v_mfma_f32_16x16x32_bf16 a[52:55],a[164:167],v[168:171],a[52:55]
v_exp_f32 v148,v148
v_mfma_f32_16x16x32_bf16 a[52:55],a[244:247],v[172:175],a[52:55]
v_exp_f32 v149,v149
v_mfma_f32_16x16x32_bf16 a[56:59],a[248:251],v[172:175],a[56:59]
v_exp_f32 v150,v150
v_mfma_f32_16x16x32_bf16 a[56:59],a[168:171],v[168:171],a[56:59]
v_exp_f32 v151,v151
v_mfma_f32_16x16x32_bf16 a[60:63],a[172:175],v[168:171],a[60:63]
ds_read_b128 a[208:211],v231 offset:16384
v_cvt_pk_bf16_f32 v182,v148,v149
v_mfma_f32_16x16x32_bf16 a[60:63],a[252:255],v[172:175],a[60:63]
s_waitcnt lgkmcnt(1)
ds_read_b128 a[212:215],v232 offset:16384
v_cvt_pk_bf16_f32 v183,v150,v151
v_mfma_f32_16x16x32_bf16 v[128:131],a[112:115],v[64:67],v[188:191]
P152:
s_cbranch_execz P280
v_mfma_f32_16x16x32_bf16 v[128:131],a[116:119],v[68:71],v[128:131]
ds_read_b128 a[216:219],v231 offset:16512
v_xor_b32 v226,0x18800,v226
v_mfma_f32_16x16x32_bf16 v[128:131],a[120:123],v[72:75],v[128:131]
buffer_load_dwordx4 v227,s[16:19],s34 offen offset:2048 nt lds
v_mfma_f32_16x16x32_bf16 v[128:131],a[124:127],v[76:79],v[128:131]
ds_read_b128 a[220:223],v232 offset:16512
v_xor_b32 v224,0x800,v224
v_mfma_f32_16x16x32_bf16 v[132:135],a[128:131],v[76:79],v[188:191]
v_mfma_f32_16x16x32_bf16 v[132:135],a[132:135],v[72:75],v[132:135]
v_mfma_f32_16x16x32_bf16 v[132:135],a[136:139],v[68:71],v[132:135]
v_mfma_f32_16x16x32_bf16 v[132:135],a[140:143],v[64:67],v[132:135]
v_mfma_f32_16x16x32_bf16 v[140:143],a[140:143],v[80:83],v[192:195]
v_mfma_f32_16x16x32_bf16 v[140:143],a[136:139],v[84:87],v[140:143]
v_exp_f32 v128,v128
v_mfma_f32_16x16x32_bf16 v[140:143],a[132:135],v[88:91],v[140:143]
v_exp_f32 v129,v129
v_mfma_f32_16x16x32_bf16 v[140:143],a[128:131],v[92:95],v[140:143]
v_exp_f32 v130,v130
v_mfma_f32_16x16x32_bf16 v[136:139],a[124:127],v[92:95],v[192:195]
v_exp_f32 v131,v131
v_mfma_f32_16x16x32_bf16 v[136:139],a[120:123],v[88:91],v[136:139]
v_cvt_pk_bf16_f32 v168,v128,v129
v_cvt_pk_bf16_f32 v169,v130,v131
v_mfma_f32_16x16x32_bf16 v[136:139],a[116:119],v[84:87],v[136:139]
v_exp_f32 v132,v132
v_mfma_f32_16x16x32_bf16 v[136:139],a[112:115],v[80:83],v[136:139]
v_exp_f32 v133,v133
v_mfma_f32_16x16x32_bf16 v[208:211],a[188:191],v[176:179],v[208:211]
v_exp_f32 v134,v134
v_mfma_f32_16x16x32_bf16 v[208:211],a[188:191],v[180:183],v[208:211]
v_exp_f32 v135,v135
v_mfma_f32_16x16x32_bf16 a[64:67],a[224:227],v[180:183],a[64:67]
v_cvt_pk_bf16_f32 v170,v132,v133
v_cvt_pk_bf16_f32 v171,v134,v135
v_mfma_f32_16x16x32_bf16 a[64:67],a[144:147],v[176:179],a[64:67]
P153:
s_cbranch_execz P281
v_mfma_f32_16x16x32_bf16 a[68:71],a[148:151],v[176:179],a[68:71]
buffer_load_dwordx4 v227,s[16:19],s34 offen offset:3072 nt lds
v_mfma_f32_16x16x32_bf16 a[68:71],a[228:231],v[180:183],a[68:71]
ds_read_b64_tr_b16 a[144:145],v225
ds_read_b64_tr_b16 a[146:147],v225 offset:1024
v_mfma_f32_16x16x32_bf16 a[72:75],a[232:235],v[180:183],a[72:75]
v_exp_f32 v140,v140
v_mfma_f32_16x16x32_bf16 a[72:75],a[152:155],v[176:179],a[72:75]
ds_read_b64_tr_b16 a[148:149],v226
ds_read_b64_tr_b16 a[150:151],v226 offset:1024
v_mfma_f32_16x16x32_bf16 a[76:79],a[156:159],v[176:179],a[76:79]
v_exp_f32 v141,v141
v_mfma_f32_16x16x32_bf16 a[76:79],a[236:239],v[180:183],a[76:79]
ds_read_b64_tr_b16 a[152:153],v225 offset:256
ds_read_b64_tr_b16 a[154:155],v225 offset:1280
v_mfma_f32_16x16x32_bf16 a[80:83],a[240:243],v[180:183],a[80:83]
v_exp_f32 v142,v142
v_mfma_f32_16x16x32_bf16 a[80:83],a[160:163],v[176:179],a[80:83]
ds_read_b64_tr_b16 a[156:157],v226 offset:256
ds_read_b64_tr_b16 a[158:159],v226 offset:1280
v_mfma_f32_16x16x32_bf16 a[84:87],a[164:167],v[176:179],a[84:87]
s_add_u32 m0,s30,32768
v_exp_f32 v143,v143
v_mfma_f32_16x16x32_bf16 a[84:87],a[244:247],v[180:183],a[84:87]
s_mov_b32 s34,278528
ds_read_b64_tr_b16 a[160:161],v225 offset:512
ds_read_b64_tr_b16 a[162:163],v225 offset:1536
v_mfma_f32_16x16x32_bf16 a[88:91],a[248:251],v[180:183],a[88:91]
v_cvt_pk_bf16_f32 v174,v140,v141
v_cvt_pk_bf16_f32 v175,v142,v143
v_mfma_f32_16x16x32_bf16 a[88:91],a[168:171],v[176:179],a[88:91]
ds_read_b64_tr_b16 a[164:165],v226 offset:512
ds_read_b64_tr_b16 a[166:167],v226 offset:1536
v_mfma_f32_16x16x32_bf16 a[92:95],a[172:175],v[176:179],a[92:95]
P154:
s_cbranch_execz P282
v_mfma_f32_16x16x32_bf16 a[92:95],a[252:255],v[180:183],a[92:95]
ds_read_b64_tr_b16 a[168:169],v225 offset:768
ds_read_b64_tr_b16 a[170:171],v225 offset:1792
v_mfma_f32_16x16x32_bf16 v[144:147],a[112:115],v[96:99],v[196:199]
v_exp_f32 v136,v136
v_mfma_f32_16x16x32_bf16 v[144:147],a[116:119],v[100:103],v[144:147]
ds_read_b64_tr_b16 a[172:173],v226 offset:768
ds_read_b64_tr_b16 a[174:175],v226 offset:1792
v_mfma_f32_16x16x32_bf16 v[144:147],a[120:123],v[104:107],v[144:147]
buffer_load_dwordx4 v227,s[20:23],s34 offen nt lds
v_mfma_f32_16x16x32_bf16 v[144:147],a[124:127],v[108:111],v[144:147]
v_exp_f32 v137,v137
v_mfma_f32_16x16x32_bf16 v[148:151],a[128:131],v[108:111],v[196:199]
v_exp_f32 v138,v138
v_mfma_f32_16x16x32_bf16 v[148:151],a[132:135],v[104:107],v[148:151]
v_exp_f32 v139,v139
v_mfma_f32_16x16x32_bf16 v[148:151],a[136:139],v[100:103],v[148:151]
ds_read_b128 a[240:243],v231 offset:32768
v_cvt_pk_bf16_f32 v172,v136,v137
v_mfma_f32_16x16x32_bf16 v[148:151],a[140:143],v[96:99],v[148:151]
ds_read_b128 a[244:247],v232 offset:32768
v_cvt_pk_bf16_f32 v173,v138,v139
v_mfma_f32_16x16x32_bf16 v[132:135],a[140:143],v[112:115],v[200:203]
v_exp_f32 v144,v144
v_mfma_f32_16x16x32_bf16 v[132:135],a[136:139],v[116:119],v[132:135]
v_exp_f32 v145,v145
v_mfma_f32_16x16x32_bf16 v[132:135],a[132:135],v[120:123],v[132:135]
v_exp_f32 v146,v146
v_mfma_f32_16x16x32_bf16 v[132:135],a[128:131],v[124:127],v[132:135]
v_exp_f32 v147,v147
v_mfma_f32_16x16x32_bf16 v[128:131],a[124:127],v[124:127],v[200:203]
ds_read_b128 a[248:251],v231 offset:32896
v_cvt_pk_bf16_f32 v176,v144,v145
v_mfma_f32_16x16x32_bf16 v[128:131],a[120:123],v[120:123],v[128:131]
P155:
s_cbranch_execz P283
Z9:
s_cbranch_execz ZB0
v_mfma_f32_16x16x32_bf16 v[128:131],a[116:119],v[116:119],v[128:131]
ds_read_b128 a[252:255],v232 offset:32896
v_cvt_pk_bf16_f32 v177,v146,v147
v_mfma_f32_16x16x32_bf16 v[128:131],a[112:115],v[112:115],v[128:131]
s_waitcnt lgkmcnt(2)
ds_read_b128 a[112:115],v224
ds_read_b128 a[116:119],v224 offset:256
v_mfma_f32_16x16x32_bf16 v[0:3],a[144:147],v[168:171],v[0:3]
v_exp_f32 v148,v148
v_mfma_f32_16x16x32_bf16 v[4:7],a[148:151],v[168:171],v[4:7]
ds_read_b128 a[120:123],v224 offset:512
ds_read_b128 a[124:127],v224 offset:768
v_mfma_f32_16x16x32_bf16 v[8:11],a[152:155],v[168:171],v[8:11]
v_exp_f32 v149,v149
v_mfma_f32_16x16x32_bf16 v[12:15],a[156:159],v[168:171],v[12:15]
buffer_load_dwordx4 v227,s[20:23],s34 offen offset:1024 nt lds
v_mfma_f32_16x16x32_bf16 v[16:19],a[160:163],v[168:171],v[16:19]
ds_read_b128 a[128:131],v224 offset:1792
ds_read_b128 a[132:135],v224 offset:1536
v_mfma_f32_16x16x32_bf16 v[20:23],a[164:167],v[168:171],v[20:23]
v_exp_f32 v150,v150
v_mfma_f32_16x16x32_bf16 v[24:27],a[168:171],v[168:171],v[24:27]
ds_read_b128 a[136:139],v224 offset:1280
ds_read_b128 a[140:143],v224 offset:1024
v_mfma_f32_16x16x32_bf16 v[28:31],a[172:175],v[168:171],v[28:31]
v_exp_f32 v151,v151
v_mfma_f32_16x16x32_bf16 v[208:211],a[176:179],v[168:171],v[208:211]
v_cvt_pk_bf16_f32 v178,v148,v149
v_cvt_pk_bf16_f32 v179,v150,v151
v_mfma_f32_16x16x32_bf16 v[208:211],a[180:183],v[172:175],v[208:211]
v_exp_f32 v132,v132
v_mfma_f32_16x16x32_bf16 v[32:35],a[144:147],v[172:175],v[32:35]
v_exp_f32 v133,v133
v_mfma_f32_16x16x32_bf16 v[36:39],a[148:151],v[172:175],v[36:39]
P156:
s_cbranch_execz P284
v_mfma_f32_16x16x32_bf16 v[40:43],a[152:155],v[172:175],v[40:43]
v_exp_f32 v134,v134
v_mfma_f32_16x16x32_bf16 v[44:47],a[156:159],v[172:175],v[44:47]
v_exp_f32 v135,v135
v_mfma_f32_16x16x32_bf16 v[48:51],a[160:163],v[172:175],v[48:51]
v_cvt_pk_bf16_f32 v182,v132,v133
v_cvt_pk_bf16_f32 v183,v134,v135
v_mfma_f32_16x16x32_bf16 v[52:55],a[164:167],v[172:175],v[52:55]
v_exp_f32 v128,v128
v_mfma_f32_16x16x32_bf16 v[56:59],a[168:171],v[172:175],v[56:59]
v_exp_f32 v129,v129
v_mfma_f32_16x16x32_bf16 v[60:63],a[172:175],v[172:175],v[60:63]
s_waitcnt lgkmcnt(0)
v_exp_f32 v130,v130
v_mfma_f32_16x16x32_bf16 v[136:139],a[112:115],a[96:99],v[204:207]
v_exp_f32 v131,v131
v_mfma_f32_16x16x32_bf16 v[136:139],a[116:119],a[100:103],v[136:139]
v_cvt_pk_bf16_f32 v180,v128,v129
v_cvt_pk_bf16_f32 v181,v130,v131
v_mfma_f32_16x16x32_bf16 v[136:139],a[120:123],a[104:107],v[136:139]
buffer_load_dwordx4 v227,s[20:23],s34 offen offset:2048 nt lds
v_mfma_f32_16x16x32_bf16 v[136:139],a[124:127],a[108:111],v[136:139]
v_xor_b32 v225,0x800,v225
v_xor_b32 v226,0x800,v226
v_mfma_f32_16x16x32_bf16 v[140:143],a[128:131],a[108:111],v[204:207]
ds_write_b128 v229,v[240:243] offset:32768
v_mfma_f32_16x16x32_bf16 v[140:143],a[132:135],a[104:107],v[140:143]
ds_write_b128 v230,v[244:247] offset:33792
v_mfma_f32_16x16x32_bf16 v[140:143],a[136:139],a[100:103],v[140:143]
ds_write_b128 v229,v[248:251] offset:34816
v_mfma_f32_16x16x32_bf16 v[140:143],a[140:143],a[96:99],v[140:143]
v_exp_f32 v136,v136
v_mfma_f32_16x16x32_bf16 v[148:151],a[140:143],v[64:67],v[188:191]
v_exp_f32 v137,v137
v_mfma_f32_16x16x32_bf16 v[148:151],a[136:139],v[68:71],v[148:151]
v_exp_f32 v138,v138
v_mfma_f32_16x16x32_bf16 v[148:151],a[132:135],v[72:75],v[148:151]
P157:
s_cbranch_execz P285
v_mfma_f32_16x16x32_bf16 v[148:151],a[128:131],v[76:79],v[148:151]
v_exp_f32 v139,v139
v_mfma_f32_16x16x32_bf16 v[144:147],a[124:127],v[76:79],v[188:191]
v_cvt_pk_bf16_f32 v184,v136,v137
v_cvt_pk_bf16_f32 v185,v138,v139
v_mfma_f32_16x16x32_bf16 v[144:147],a[120:123],v[72:75],v[144:147]
v_exp_f32 v140,v140
v_mfma_f32_16x16x32_bf16 v[144:147],a[116:119],v[68:71],v[144:147]
v_exp_f32 v141,v141
v_mfma_f32_16x16x32_bf16 v[144:147],a[112:115],v[64:67],v[144:147]
v_exp_f32 v142,v142
v_mfma_f32_16x16x32_bf16 a[32:35],a[144:147],v[176:179],a[32:35]
v_exp_f32 v143,v143
v_mfma_f32_16x16x32_bf16 a[36:39],a[148:151],v[176:179],a[36:39]
v_cvt_pk_bf16_f32 v186,v140,v141
v_cvt_pk_bf16_f32 v187,v142,v143
v_mfma_f32_16x16x32_bf16 a[40:43],a[152:155],v[176:179],a[40:43]
ds_write_b128 v230,v[252:255] offset:35840
v_mfma_f32_16x16x32_bf16 a[44:47],a[156:159],v[176:179],a[44:47]
buffer_load_dwordx4 v227,s[20:23],s34 offen offset:3072 nt lds
v_mfma_f32_16x16x32_bf16 a[48:51],a[160:163],v[176:179],a[48:51]
ds_read_b128 a[224:227],v231 offset:49152
v_xor_b32 v224,0x18800,v224
v_mfma_f32_16x16x32_bf16 a[52:55],a[164:167],v[176:179],a[52:55]
v_exp_f32 v148,v148
v_mfma_f32_16x16x32_bf16 a[56:59],a[168:171],v[176:179],a[56:59]
v_exp_f32 v149,v149
v_mfma_f32_16x16x32_bf16 a[60:63],a[172:175],v[176:179],a[60:63]
v_exp_f32 v150,v150
v_mfma_f32_16x16x32_bf16 v[208:211],a[184:187],v[176:179],v[208:211]
v_exp_f32 v151,v151
v_mfma_f32_16x16x32_bf16 v[208:211],a[188:191],v[180:183],v[208:211]
ds_read_b128 a[228:231],v232 offset:49152
v_cvt_pk_bf16_f32 v170,v148,v149
v_mfma_f32_16x16x32_bf16 a[64:67],a[144:147],v[180:183],a[64:67]
P158:
s_cbranch_execz P286
v_mfma_f32_16x16x32_bf16 a[68:71],a[148:151],v[180:183],a[68:71]
ds_read_b64_tr_b16 a[144:145],v225
ds_read_b64_tr_b16 a[146:147],v225 offset:1024
v_mfma_f32_16x16x32_bf16 a[72:75],a[152:155],v[180:183],a[72:75]
ds_read_b128 a[232:235],v231 offset:49280
v_cvt_pk_bf16_f32 v171,v150,v151
v_mfma_f32_16x16x32_bf16 a[76:79],a[156:159],v[180:183],a[76:79]
ds_read_b64_tr_b16 a[148:149],v226
ds_read_b64_tr_b16 a[150:151],v226 offset:1024
v_mfma_f32_16x16x32_bf16 a[80:83],a[160:163],v[180:183],a[80:83]
v_exp_f32 v144,v144
v_mfma_f32_16x16x32_bf16 a[84:87],a[164:167],v[180:183],a[84:87]
ds_read_b64_tr_b16 a[152:153],v225 offset:256
ds_read_b64_tr_b16 a[154:155],v225 offset:1280
v_mfma_f32_16x16x32_bf16 a[88:91],a[168:171],v[180:183],a[88:91]
v_exp_f32 v145,v145
v_mfma_f32_16x16x32_bf16 a[92:95],a[172:175],v[180:183],a[92:95]
ds_read_b64_tr_b16 a[156:157],v226 offset:256
ds_read_b64_tr_b16 a[158:159],v226 offset:1280
v_mfma_f32_16x16x32_bf16 v[128:131],a[112:115],v[80:83],v[192:195]
v_exp_f32 v146,v146
v_mfma_f32_16x16x32_bf16 v[128:131],a[116:119],v[84:87],v[128:131]
ds_read_b64_tr_b16 a[160:161],v225 offset:512
ds_read_b64_tr_b16 a[162:163],v225 offset:1536
v_mfma_f32_16x16x32_bf16 v[128:131],a[120:123],v[88:91],v[128:131]
v_exp_f32 v147,v147
v_mfma_f32_16x16x32_bf16 v[128:131],a[124:127],v[92:95],v[128:131]
ds_read_b64_tr_b16 a[164:165],v226 offset:512
ds_read_b64_tr_b16 a[166:167],v226 offset:1536
v_mfma_f32_16x16x32_bf16 v[132:135],a[128:131],v[92:95],v[192:195]
ds_read_b128 a[236:239],v232 offset:49280
v_cvt_pk_bf16_f32 v168,v144,v145
v_mfma_f32_16x16x32_bf16 v[132:135],a[132:135],v[88:91],v[132:135]
ds_read_b64_tr_b16 a[168:169],v225 offset:768
ds_read_b64_tr_b16 a[170:171],v225 offset:1792
v_mfma_f32_16x16x32_bf16 v[132:135],a[136:139],v[84:87],v[132:135]
P159:
s_cbranch_execz P287
v_mfma_f32_16x16x32_bf16 v[132:135],a[140:143],v[80:83],v[132:135]
ds_read_b64_tr_b16 a[172:173],v226 offset:768
ds_read_b64_tr_b16 a[174:175],v226 offset:1792
v_mfma_f32_16x16x32_bf16 v[140:143],a[140:143],v[96:99],v[196:199]
ds_read_b128 a[96:99],v231 offset:32768
v_cvt_pk_bf16_f32 v169,v146,v147
v_mfma_f32_16x16x32_bf16 v[140:143],a[136:139],v[100:103],v[140:143]
ds_read_b128 a[100:103],v232 offset:32768
v_xor_b32 v225,0x10800,v225
v_mfma_f32_16x16x32_bf16 v[140:143],a[132:135],v[104:107],v[140:143]
ds_read_b128 a[104:107],v231 offset:32896
v_xor_b32 v226,0x10800,v226
v_mfma_f32_16x16x32_bf16 v[140:143],a[128:131],v[108:111],v[140:143]
v_exp_f32 v128,v128
v_mfma_f32_16x16x32_bf16 v[136:139],a[124:127],v[108:111],v[196:199]
v_exp_f32 v129,v129
v_mfma_f32_16x16x32_bf16 v[136:139],a[120:123],v[104:107],v[136:139]
v_exp_f32 v130,v130
v_mfma_f32_16x16x32_bf16 v[136:139],a[116:119],v[100:103],v[136:139]
v_exp_f32 v131,v131
v_mfma_f32_16x16x32_bf16 v[136:139],a[112:115],v[96:99],v[136:139]
s_waitcnt lgkmcnt(1)
ds_read_b128 a[108:111],v232 offset:32896
v_cvt_pk_bf16_f32 v172,v128,v129
v_mfma_f32_16x16x32_bf16 a[0:3],a[144:147],v[184:187],a[0:3]
v_cvt_pk_bf16_f32 v173,v130,v131
v_mfma_f32_16x16x32_bf16 a[4:7],a[148:151],v[184:187],a[4:7]
v_exp_f32 v132,v132
v_mfma_f32_16x16x32_bf16 a[8:11],a[152:155],v[184:187],a[8:11]
s_add_u32 m0,s30,49152
v_exp_f32 v133,v133
v_mfma_f32_16x16x32_bf16 a[12:15],a[156:159],v[184:187],a[12:15]
s_mov_b32 s34,294912
v_exp_f32 v134,v134
v_mfma_f32_16x16x32_bf16 a[16:19],a[160:163],v[184:187],a[16:19]
P160:
s_cbranch_execz P288
v_mfma_f32_16x16x32_bf16 a[20:23],a[164:167],v[184:187],a[20:23]
v_exp_f32 v135,v135
v_mfma_f32_16x16x32_bf16 a[24:27],a[168:171],v[184:187],a[24:27]
s_waitcnt vmcnt(8) lgkmcnt(0)
s_barrier
v_mfma_f32_16x16x32_bf16 a[28:31],a[172:175],v[184:187],a[28:31]
v_cvt_pk_bf16_f32 v174,v132,v133
v_cvt_pk_bf16_f32 v175,v134,v135
v_mfma_f32_16x16x32_bf16 v[212:215],a[176:179],v[184:187],v[212:215]
v_exp_f32 v140,v140
v_mfma_f32_16x16x32_bf16 v[208:211],a[176:179],v[168:171],v[208:211]
v_exp_f32 v141,v141
v_mfma_f32_16x16x32_bf16 v[0:3],a[144:147],v[168:171],v[0:3]
buffer_load_dwordx4 v227,s[16:19],s34 offen nt lds
s_nop 2
v_mov_b32 v205,v212
ds_write_b64 v237,v[204:205]
ds_write_b128 v235,a[0:3]
ds_write_b128 v159,a[4:7]
v_mfma_f32_16x16x32_bf16 v[4:7],a[148:151],v[168:171],v[4:7]
v_exp_f32 v142,v142
v_mfma_f32_16x16x32_bf16 v[8:11],a[152:155],v[168:171],v[8:11]
v_exp_f32 v143,v143
v_cvt_pk_bf16_f32 v178,v140,v141
v_mfma_f32_16x16x32_bf16 v[12:15],a[156:159],v[168:171],v[12:15]
v_cvt_pk_bf16_f32 v179,v142,v143
v_exp_f32 v136,v136
v_mfma_f32_16x16x32_bf16 v[16:19],a[160:163],v[168:171],v[16:19]
v_exp_f32 v137,v137
v_mfma_f32_16x16x32_bf16 v[20:23],a[164:167],v[168:171],v[20:23]
ds_write_b128 v235,a[8:11] offset:128
v_mfma_f32_16x16x32_bf16 v[24:27],a[168:171],v[168:171],v[24:27]
v_exp_f32 v138,v138
v_mfma_f32_16x16x32_bf16 v[28:31],a[172:175],v[168:171],v[28:31]
v_exp_f32 v139,v139
v_cvt_pk_bf16_f32 v176,v136,v137
v_mfma_f32_16x16x32_bf16 v[144:147],a[112:115],v[112:115],v[200:203]
P161:
s_cbranch_execz P289
v_cvt_pk_bf16_f32 v177,v138,v139
v_mfma_f32_16x16x32_bf16 v[144:147],a[116:119],v[116:119],v[144:147]
ds_read_b128 a[112:115],v224
v_rcp_f32 v160,v208
v_mfma_f32_16x16x32_bf16 v[144:147],a[120:123],v[120:123],v[144:147]
ds_read_b128 a[116:119],v224 offset:256
v_mul_f32 v0,v0,v160
v_mul_f32 v1,v1,v160
v_mfma_f32_16x16x32_bf16 v[144:147],a[124:127],v[124:127],v[144:147]
v_mul_f32 v2,v2,v160
v_mul_f32 v3,v3,v160
v_mul_f32 v4,v4,v160
v_mfma_f32_16x16x32_bf16 v[148:151],a[128:131],v[124:127],v[200:203]
ds_read_b128 a[120:123],v224 offset:512
ds_read_b128 a[124:127],v224 offset:768
v_mul_f32 v5,v5,v160
v_mfma_f32_16x16x32_bf16 v[148:151],a[132:135],v[120:123],v[148:151]
v_exp_f32 v144,v144
v_mul_f32 v6,v6,v160
v_mfma_f32_16x16x32_bf16 v[148:151],a[136:139],v[116:119],v[148:151]
ds_read_b128 a[128:131],v224 offset:1792
ds_read_b128 a[132:135],v224 offset:1536
v_mul_f32 v7,v7,v160
v_mfma_f32_16x16x32_bf16 v[148:151],a[140:143],v[112:115],v[148:151]
v_exp_f32 v145,v145
v_cvt_pk_bf16_f32 v240,v0,v1
v_mfma_f32_16x16x32_bf16 v[32:35],a[144:147],v[172:175],v[32:35]
ds_read_b128 a[136:139],v224 offset:1280
ds_read_b128 a[140:143],v224 offset:1024
v_xor_b32 v224,0x800,v224
v_mfma_f32_16x16x32_bf16 v[36:39],a[148:151],v[172:175],v[36:39]
buffer_load_dwordx4 v227,s[16:19],s34 offen offset:1024 nt lds
v_cvt_pk_bf16_f32 v241,v2,v3
v_mfma_f32_16x16x32_bf16 v[40:43],a[152:155],v[172:175],v[40:43]
v_exp_f32 v146,v146
v_cvt_pk_bf16_f32 v242,v4,v5
v_mfma_f32_16x16x32_bf16 v[44:47],a[156:159],v[172:175],v[44:47]
P162:
s_cbranch_execz P290
v_cvt_pk_bf16_f32 v243,v6,v7
v_mfma_f32_16x16x32_bf16 v[48:51],a[160:163],v[172:175],v[48:51]
v_exp_f32 v147,v147
v_cvt_pk_bf16_f32 v180,v144,v145
v_mfma_f32_16x16x32_bf16 v[52:55],a[164:167],v[172:175],v[52:55]
v_cvt_pk_bf16_f32 v181,v146,v147
v_exp_f32 v148,v148
v_mfma_f32_16x16x32_bf16 v[56:59],a[168:171],v[172:175],v[56:59]
ds_write_b128 v159,a[12:15] offset:128
v_mul_f32 v8,v8,v160
v_mfma_f32_16x16x32_bf16 v[60:63],a[172:175],v[172:175],v[60:63]
v_exp_f32 v149,v149
v_mul_f32 v9,v9,v160
v_mfma_f32_16x16x32_bf16 v[208:211],a[180:183],v[172:175],v[208:211]
v_exp_f32 v150,v150
v_mul_f32 v10,v10,v160
v_mfma_f32_16x16x32_bf16 v[208:211],a[184:187],v[176:179],v[208:211]
v_exp_f32 v151,v151
v_cvt_pk_bf16_f32 v182,v148,v149
v_mfma_f32_16x16x32_bf16 a[32:35],a[144:147],v[176:179],a[32:35]
v_cvt_pk_bf16_f32 v183,v150,v151
v_mul_f32 v11,v11,v160
v_mul_f32 v12,v12,v160
v_mfma_f32_16x16x32_bf16 a[36:39],a[148:151],v[176:179],a[36:39]
v_mul_f32 v13,v13,v160
v_mul_f32 v14,v14,v160
v_mul_f32 v15,v15,v160
v_mfma_f32_16x16x32_bf16 a[40:43],a[152:155],v[176:179],a[40:43]
v_cvt_pk_bf16_f32 v244,v8,v9
v_cvt_pk_bf16_f32 v245,v10,v11
v_cvt_pk_bf16_f32 v246,v12,v13
v_mfma_f32_16x16x32_bf16 a[44:47],a[156:159],v[176:179],a[44:47]
v_cvt_pk_bf16_f32 v247,v14,v15
v_mul_f32 v16,v16,v160
v_mul_f32 v17,v17,v160
v_mfma_f32_16x16x32_bf16 a[48:51],a[160:163],v[176:179],a[48:51]
v_mul_f32 v18,v18,v160
v_mul_f32 v19,v19,v160
v_mul_f32 v20,v20,v160
v_mfma_f32_16x16x32_bf16 a[52:55],a[164:167],v[176:179],a[52:55]
P163:
s_cbranch_execz P291
v_mul_f32 v21,v21,v160
v_mfma_f32_16x16x32_bf16 a[56:59],a[168:171],v[176:179],a[56:59]
v_mul_f32 v22,v22,v160
v_mul_f32 v23,v23,v160
v_cvt_pk_bf16_f32 v248,v16,v17
v_mfma_f32_16x16x32_bf16 a[60:63],a[172:175],v[176:179],a[60:63]
s_waitcnt lgkmcnt(0)
v_cvt_pk_bf16_f32 v249,v18,v19
v_cvt_pk_bf16_f32 v250,v20,v21
v_cvt_pk_bf16_f32 v251,v22,v23
v_mfma_f32_16x16x32_bf16 v[128:131],a[112:115],a[192:195],0
buffer_load_dwordx4 v227,s[16:19],s34 offen offset:2048 nt lds
v_mul_f32 v24,v24,v160
v_mfma_f32_16x16x32_bf16 v[128:131],a[116:119],a[196:199],v[128:131]
v_mul_f32 v25,v25,v160
v_mul_f32 v26,v26,v160
v_mul_f32 v27,v27,v160
v_mfma_f32_16x16x32_bf16 v[128:131],a[120:123],a[200:203],v[128:131]
v_mul_f32 v28,v28,v160
v_mul_f32 v29,v29,v160
v_mul_f32 v30,v30,v160
v_mfma_f32_16x16x32_bf16 v[128:131],a[124:127],a[204:207],v[128:131]
v_mul_f32 v31,v31,v160
v_cvt_pk_bf16_f32 v252,v24,v25
v_cvt_pk_bf16_f32 v253,v26,v27
v_mfma_f32_16x16x32_bf16 v[132:135],a[128:131],a[204:207],0
v_cvt_pk_bf16_f32 v254,v28,v29
v_rcp_f32 v162,v210
v_mfma_f32_16x16x32_bf16 v[132:135],a[132:135],a[200:203],v[132:135]
ds_write_b128 v235,a[16:19] offset:256
v_cvt_pk_bf16_f32 v255,v30,v31
v_mfma_f32_16x16x32_bf16 v[132:135],a[136:139],a[196:199],v[132:135]
v_rcp_f32 v161,v209
v_mfma_f32_16x16x32_bf16 v[132:135],a[140:143],a[192:195],v[132:135]
v_max3_f32 v156,v128,v129,v130
s_nop 6
v_max3_f32 v157,v131,v132,v133
v_max3_f32 v156,v156,v134,v135
v_max_f32 v156,v156,v157
v_mov_b32 v157,v156
s_nop 1
v_permlane32_swap_b32 v156,v157
v_max_f32 v156,v156,v157
v_mov_b32 v157,v156
s_nop 1
v_permlane16_swap_b32 v156,v157
v_max_f32 v156,v156,v157
v_sub_f32 v128,v128,v156
v_sub_f32 v129,v129,v156
P164:
s_cbranch_execz P292
v_sub_f32 v130,v130,v156
v_sub_f32 v131,v131,v156
v_sub_f32 v132,v132,v156
v_sub_f32 v133,v133,v156
v_sub_f32 v134,v134,v156
v_sub_f32 v135,v135,v156
v_sub_f32 v188,0,v156
v_sub_f32 v189,0,v156
v_sub_f32 v190,0,v156
v_sub_f32 v191,0,v156
v_exp_f32 v128,v128
v_exp_f32 v129,v129
v_exp_f32 v130,v130
v_exp_f32 v131,v131
v_mfma_f32_16x16x32_bf16 v[136:139],a[112:115],a[208:211],0
v_cvt_pk_bf16_f32 v168,v128,v129
v_cvt_pk_bf16_f32 v169,v130,v131
v_mul_f32 v32,v32,v161
v_mfma_f32_16x16x32_bf16 v[136:139],a[116:119],a[212:215],v[136:139]
v_exp_f32 v132,v132
v_mul_f32 v33,v33,v161
v_mfma_f32_16x16x32_bf16 v[136:139],a[120:123],a[216:219],v[136:139]
v_exp_f32 v133,v133
v_mul_f32 v34,v34,v161
v_mfma_f32_16x16x32_bf16 v[136:139],a[124:127],a[220:223],v[136:139]
v_exp_f32 v134,v134
v_mul_f32 v35,v35,v161
v_mfma_f32_16x16x32_bf16 v[140:143],a[128:131],a[220:223],0
v_exp_f32 v135,v135
v_cvt_pk_bf16_f32 v170,v132,v133
v_mfma_f32_16x16x32_bf16 v[140:143],a[132:135],a[216:219],v[140:143]
v_cvt_pk_bf16_f32 v171,v134,v135
v_mul_f32 v36,v36,v161
v_mul_f32 v37,v37,v161
v_mfma_f32_16x16x32_bf16 v[140:143],a[136:139],a[212:215],v[140:143]
v_mul_f32 v38,v38,v161
v_mul_f32 v39,v39,v161
v_cvt_pk_bf16_f32 v32,v32,v33
v_mfma_f32_16x16x32_bf16 v[140:143],a[140:143],a[208:211],v[140:143]
v_max3_f32 v156,v136,v137,v138
s_nop 6
v_max3_f32 v157,v139,v140,v141
v_max3_f32 v156,v156,v142,v143
v_max_f32 v156,v156,v157
v_mov_b32 v157,v156
s_nop 1
v_permlane32_swap_b32 v156,v157
P165:
s_cbranch_execz P293
v_max_f32 v156,v156,v157
v_mov_b32 v157,v156
s_nop 1
v_permlane16_swap_b32 v156,v157
v_max_f32 v156,v156,v157
v_sub_f32 v136,v136,v156
v_mfma_f32_16x16x32_bf16 v[144:147],a[112:115],a[224:227],0
v_sub_f32 v137,v137,v156
v_sub_f32 v138,v138,v156
v_sub_f32 v139,v139,v156
v_mfma_f32_16x16x32_bf16 v[144:147],a[116:119],a[228:231],v[144:147]
buffer_load_dwordx4 v227,s[16:19],s34 offen offset:3072 nt lds
v_sub_f32 v140,v140,v156
v_mfma_f32_16x16x32_bf16 v[144:147],a[120:123],a[232:235],v[144:147]
v_sub_f32 v141,v141,v156
v_sub_f32 v142,v142,v156
v_sub_f32 v143,v143,v156
v_mfma_f32_16x16x32_bf16 v[144:147],a[124:127],a[236:239],v[144:147]
v_sub_f32 v192,0,v156
v_sub_f32 v193,0,v156
v_sub_f32 v194,0,v156
v_mfma_f32_16x16x32_bf16 v[148:151],a[128:131],a[236:239],0
v_sub_f32 v195,0,v156
v_exp_f32 v136,v136
v_mfma_f32_16x16x32_bf16 v[148:151],a[132:135],a[232:235],v[148:151]
v_exp_f32 v137,v137
v_cvt_pk_bf16_f32 v33,v34,v35
v_mfma_f32_16x16x32_bf16 v[148:151],a[136:139],a[228:231],v[148:151]
ds_write_b128 v159,a[20:23] offset:256
v_cvt_pk_bf16_f32 v34,v36,v37
v_mfma_f32_16x16x32_bf16 v[148:151],a[140:143],a[224:227],v[148:151]
v_exp_f32 v138,v138
v_cvt_pk_bf16_f32 v35,v38,v39
v_mfma_f32_16x16x32_bf16 v[208:211],a[188:191],v[180:183],v[208:211]
v_exp_f32 v139,v139
v_cvt_pk_bf16_f32 v172,v136,v137
v_mfma_f32_16x16x32_bf16 a[64:67],a[144:147],v[180:183],a[64:67]
ds_read_b64_tr_b16 a[144:145],v225
ds_read_b64_tr_b16 a[146:147],v225 offset:1024
v_cvt_pk_bf16_f32 v173,v138,v139
v_mfma_f32_16x16x32_bf16 a[68:71],a[148:151],v[180:183],a[68:71]
ds_read_b64_tr_b16 a[148:149],v226
ds_read_b64_tr_b16 a[150:151],v226 offset:1024
P166:
s_cbranch_execz P294
v_mul_f32 v40,v40,v161
v_mfma_f32_16x16x32_bf16 a[72:75],a[152:155],v[180:183],a[72:75]
ds_read_b64_tr_b16 a[152:153],v225 offset:256
ds_read_b64_tr_b16 a[154:155],v225 offset:1280
v_exp_f32 v140,v140
v_mfma_f32_16x16x32_bf16 a[76:79],a[156:159],v[180:183],a[76:79]
ds_read_b64_tr_b16 a[156:157],v226 offset:256
ds_read_b64_tr_b16 a[158:159],v226 offset:1280
v_exp_f32 v141,v141
v_mfma_f32_16x16x32_bf16 a[80:83],a[160:163],v[180:183],a[80:83]
s_add_u32 m0,s30,65536
s_mov_b32 s34,294912
v_exp_f32 v142,v142
v_mfma_f32_16x16x32_bf16 a[84:87],a[164:167],v[180:183],a[84:87]
ds_read_b64_tr_b16 a[160:161],v225 offset:512
ds_read_b64_tr_b16 a[162:163],v225 offset:1536
v_exp_f32 v143,v143
v_mfma_f32_16x16x32_bf16 a[88:91],a[168:171],v[180:183],a[88:91]
v_cvt_pk_bf16_f32 v174,v140,v141
v_cvt_pk_bf16_f32 v175,v142,v143
v_max3_f32 v156,v144,v145,v146
v_mfma_f32_16x16x32_bf16 a[92:95],a[172:175],v[180:183],a[92:95]
ds_read_b64_tr_b16 a[164:165],v226 offset:512
ds_read_b64_tr_b16 a[166:167],v226 offset:1536
v_max3_f32 v157,v147,v148,v149
v_mfma_f32_16x16x32_bf16 v[128:131],a[112:115],a[240:243],0
v_max3_f32 v156,v156,v150,v151
v_max_f32 v156,v156,v157
v_mov_b32 v157,v156
v_mfma_f32_16x16x32_bf16 v[128:131],a[116:119],a[244:247],v[128:131]
P167:
s_cbranch_execz P295
ds_read_b64_tr_b16 a[168:169],v225 offset:768
v_mfma_f32_16x16x32_bf16 v[128:131],a[120:123],a[248:251],v[128:131]
ds_read_b64_tr_b16 a[170:171],v225 offset:1792
v_permlane32_swap_b32 v156,v157
v_mfma_f32_16x16x32_bf16 v[128:131],a[124:127],a[252:255],v[128:131]
buffer_load_dwordx4 v227,s[20:23],s34 offen nt lds
v_max_f32 v156,v156,v157
v_mfma_f32_16x16x32_bf16 v[132:135],a[128:131],a[252:255],0
ds_read_b128 a[112:115],v224
ds_read_b64_tr_b16 a[172:173],v226 offset:768
v_mov_b32 v157,v156
v_mfma_f32_16x16x32_bf16 v[132:135],a[132:135],a[248:251],v[132:135]
ds_read_b128 a[116:119],v224 offset:256
ds_read_b64_tr_b16 a[174:175],v226 offset:1792
v_permlane16_swap_b32 v156,v157
v_mfma_f32_16x16x32_bf16 v[132:135],a[136:139],a[244:247],v[132:135]
ds_write_b128 v235,a[24:27] offset:384
v_max_f32 v156,v156,v157
v_sub_f32 v144,v144,v156
v_mfma_f32_16x16x32_bf16 v[132:135],a[140:143],a[240:243],v[132:135]
ds_read_b128 a[120:123],v224 offset:512
ds_read_b128 a[124:127],v224 offset:768
v_sub_f32 v145,v145,v156
v_sub_f32 v146,v146,v156
v_mfma_f32_16x16x32_bf16 v[216:219],a[176:179],v[168:171],0
s_waitcnt lgkmcnt(7)
v_sub_f32 v147,v147,v156
v_sub_f32 v148,v148,v156
v_sub_f32 v149,v149,v156
v_mfma_f32_16x16x32_bf16 v[64:67],a[144:147],v[168:171],0
ds_read_b128 a[128:131],v224 offset:1792
ds_read_b128 a[132:135],v224 offset:1536
v_sub_f32 v150,v150,v156
v_mfma_f32_16x16x32_bf16 v[68:71],a[148:151],v[168:171],0
v_sub_f32 v151,v151,v156
v_sub_f32 v196,0,v156
v_sub_f32 v197,0,v156
v_mfma_f32_16x16x32_bf16 v[72:75],a[152:155],v[168:171],0
ds_read_b128 a[136:139],v224 offset:1280
ds_read_b128 a[140:143],v224 offset:1024
v_sub_f32 v198,0,v156
v_mfma_f32_16x16x32_bf16 v[76:79],a[156:159],v[168:171],0
v_sub_f32 v199,0,v156
v_exp_f32 v144,v144
v_mfma_f32_16x16x32_bf16 v[80:83],a[160:163],v[168:171],0
P168:
s_cbranch_execz P296
v_mul_f32 v41,v41,v161
v_mfma_f32_16x16x32_bf16 v[84:87],a[164:167],v[168:171],0
v_exp_f32 v145,v145
v_mul_f32 v42,v42,v161
v_mfma_f32_16x16x32_bf16 v[88:91],a[168:171],v[168:171],0
s_waitcnt lgkmcnt(2)
v_exp_f32 v146,v146
v_mul_f32 v43,v43,v161
v_mfma_f32_16x16x32_bf16 v[92:95],a[172:175],v[168:171],0
v_exp_f32 v147,v147
v_cvt_pk_bf16_f32 v176,v144,v145
v_mfma_f32_16x16x32_bf16 v[136:139],a[112:115],a[96:99],0
v_cvt_pk_bf16_f32 v177,v146,v147
v_exp_f32 v148,v148
v_mfma_f32_16x16x32_bf16 v[136:139],a[116:119],a[100:103],v[136:139]
v_exp_f32 v149,v149
v_mul_f32 v44,v44,v161
v_mfma_f32_16x16x32_bf16 v[136:139],a[120:123],a[104:107],v[136:139]
buffer_load_dwordx4 v227,s[20:23],s34 offen offset:1024 nt lds
v_mul_f32 v45,v45,v161
v_mfma_f32_16x16x32_bf16 v[136:139],a[124:127],a[108:111],v[136:139]
v_exp_f32 v150,v150
v_mul_f32 v46,v46,v161
v_mfma_f32_16x16x32_bf16 v[140:143],a[128:131],a[108:111],0
v_exp_f32 v151,v151
v_cvt_pk_bf16_f32 v178,v148,v149
v_mfma_f32_16x16x32_bf16 v[140:143],a[132:135],a[104:107],v[140:143]
s_waitcnt lgkmcnt(0)
v_cvt_pk_bf16_f32 v179,v150,v151
v_max3_f32 v156,v128,v129,v130
v_max3_f32 v157,v131,v132,v133
v_mfma_f32_16x16x32_bf16 v[140:143],a[136:139],a[100:103],v[140:143]
ds_write_b128 v159,a[28:31] offset:384
v_max3_f32 v156,v156,v134,v135
v_mfma_f32_16x16x32_bf16 v[140:143],a[140:143],a[96:99],v[140:143]
P169:
s_cbranch_execz P297
v_max_f32 v156,v156,v157
v_mfma_f32_16x16x32_bf16 v[216:219],a[180:183],v[172:175],v[216:219]
v_mov_b32 v157,v156
v_mul_f32 v47,v47,v161
v_xor_b32 v225,0x800,v225
v_mfma_f32_16x16x32_bf16 v[96:99],a[144:147],v[172:175],0
v_permlane32_swap_b32 v156,v157
v_max_f32 v156,v156,v157
v_mfma_f32_16x16x32_bf16 v[100:103],a[148:151],v[172:175],0
v_mov_b32 v157,v156
v_permlane16_swap_b32 v32,v34
v_mfma_f32_16x16x32_bf16 v[104:107],a[152:155],v[172:175],0
v_permlane16_swap_b32 v156,v157
v_max_f32 v156,v156,v157
v_mfma_f32_16x16x32_bf16 v[108:111],a[156:159],v[172:175],0
v_sub_f32 v128,v128,v156
v_sub_f32 v129,v129,v156
v_sub_f32 v130,v130,v156
v_mfma_f32_16x16x32_bf16 v[112:115],a[160:163],v[172:175],0
v_sub_f32 v131,v131,v156
v_sub_f32 v132,v132,v156
v_sub_f32 v133,v133,v156
v_mfma_f32_16x16x32_bf16 v[116:119],a[164:167],v[172:175],0
v_sub_f32 v134,v134,v156
v_permlane16_swap_b32 v33,v35
v_mfma_f32_16x16x32_bf16 v[120:123],a[168:171],v[172:175],0
ds_write_b128 v233,v[32:35] offset:32768
v_sub_f32 v135,v135,v156
v_mfma_f32_16x16x32_bf16 v[124:127],a[172:175],v[172:175],0
v_sub_f32 v200,0,v156
v_sub_f32 v201,0,v156
v_sub_f32 v202,0,v156
v_mfma_f32_16x16x32_bf16 v[144:147],a[112:115],a[192:195],v[188:191]
v_cvt_pk_bf16_f32 v40,v40,v41
v_sub_f32 v203,0,v156
v_cvt_pk_bf16_f32 v41,v42,v43
v_mfma_f32_16x16x32_bf16 v[144:147],a[116:119],a[196:199],v[144:147]
buffer_load_dwordx4 v227,s[20:23],s34 offen offset:2048 nt lds
v_cvt_pk_bf16_f32 v42,v44,v45
v_mfma_f32_16x16x32_bf16 v[144:147],a[120:123],a[200:203],v[144:147]
v_exp_f32 v128,v128
v_cvt_pk_bf16_f32 v43,v46,v47
v_mfma_f32_16x16x32_bf16 v[144:147],a[124:127],a[204:207],v[144:147]
v_mul_f32 v48,v48,v161
v_exp_f32 v129,v129
v_mfma_f32_16x16x32_bf16 v[148:151],a[128:131],a[204:207],v[188:191]
v_mul_f32 v49,v49,v161
v_mul_f32 v50,v50,v161
v_mul_f32 v51,v51,v161
v_mfma_f32_16x16x32_bf16 v[148:151],a[132:135],a[200:203],v[148:151]
P170:
s_cbranch_execz P298
v_exp_f32 v130,v130
v_mul_f32 v52,v52,v161
v_mfma_f32_16x16x32_bf16 v[148:151],a[136:139],a[196:199],v[148:151]
v_exp_f32 v131,v131
v_mul_f32 v53,v53,v161
v_mul_f32 v54,v54,v161
v_mfma_f32_16x16x32_bf16 v[148:151],a[140:143],a[192:195],v[148:151]
v_cvt_pk_bf16_f32 v180,v128,v129
v_mul_f32 v55,v55,v161
v_cvt_pk_bf16_f32 v181,v130,v131
v_mfma_f32_16x16x32_bf16 v[216:219],a[184:187],v[176:179],v[216:219]
v_permlane16_swap_b32 v40,v42
v_exp_f32 v132,v132
v_mfma_f32_16x16x32_bf16 v[0:3],a[144:147],v[176:179],0
v_permlane16_swap_b32 v41,v43
v_exp_f32 v133,v133
v_mfma_f32_16x16x32_bf16 v[4:7],a[148:151],v[176:179],0
ds_write_b128 v234,v[40:43] offset:32768
v_exp_f32 v134,v134
v_mfma_f32_16x16x32_bf16 v[8:11],a[152:155],v[176:179],0
v_cvt_pk_bf16_f32 v48,v48,v49
v_exp_f32 v135,v135
v_cvt_pk_bf16_f32 v49,v50,v51
v_mfma_f32_16x16x32_bf16 v[12:15],a[156:159],v[176:179],0
v_cvt_pk_bf16_f32 v50,v52,v53
v_cvt_pk_bf16_f32 v182,v132,v133
v_cvt_pk_bf16_f32 v51,v54,v55
v_mfma_f32_16x16x32_bf16 v[16:19],a[160:163],v[176:179],0
v_cvt_pk_bf16_f32 v183,v134,v135
v_mul_f32 v56,v56,v161
v_max3_f32 v156,v136,v137,v138
v_mul_f32 v57,v57,v161
v_mfma_f32_16x16x32_bf16 v[20:23],a[164:167],v[176:179],0
v_max3_f32 v157,v139,v140,v141
v_mul_f32 v58,v58,v161
v_max3_f32 v156,v156,v142,v143
v_mul_f32 v59,v59,v161
v_mfma_f32_16x16x32_bf16 v[24:27],a[168:171],v[176:179],0
P171:
s_cbranch_execz P299
Z10:
s_cbranch_execz ZB0
v_max_f32 v156,v156,v157
v_mul_f32 v60,v60,v161
v_mov_b32 v157,v156
v_mul_f32 v61,v61,v161
v_mfma_f32_16x16x32_bf16 v[28:31],a[172:175],v[176:179],0
v_mul_f32 v62,v62,v161
v_permlane32_swap_b32 v156,v157
v_mul_f32 v63,v63,v161
v_mfma_f32_16x16x32_bf16 v[128:131],a[112:115],a[208:211],v[192:195]
v_max_f32 v156,v156,v157
v_permlane16_swap_b32 v48,v50
v_mfma_f32_16x16x32_bf16 v[128:131],a[116:119],a[212:215],v[128:131]
v_mov_b32 v157,v156
v_permlane16_swap_b32 v49,v51
v_mfma_f32_16x16x32_bf16 v[128:131],a[120:123],a[216:219],v[128:131]
ds_write_b128 v233,v[48:51] offset:32896
v_permlane16_swap_b32 v156,v157
v_mfma_f32_16x16x32_bf16 v[128:131],a[124:127],a[220:223],v[128:131]
buffer_load_dwordx4 v227,s[20:23],s34 offen offset:3072 nt lds
v_max_f32 v156,v156,v157
v_sub_f32 v136,v136,v156
v_cvt_pk_bf16_f32 v56,v56,v57
v_mfma_f32_16x16x32_bf16 v[132:135],a[128:131],a[220:223],v[192:195]
v_sub_f32 v137,v137,v156
v_cvt_pk_bf16_f32 v57,v58,v59
v_sub_f32 v138,v138,v156
v_cvt_pk_bf16_f32 v58,v60,v61
v_mfma_f32_16x16x32_bf16 v[132:135],a[132:135],a[216:219],v[132:135]
v_sub_f32 v139,v139,v156
v_cvt_pk_bf16_f32 v59,v62,v63
v_sub_f32 v140,v140,v156
v_mfma_f32_16x16x32_bf16 v[132:135],a[136:139],a[212:215],v[132:135]
v_sub_f32 v141,v141,v156
v_permlane16_swap_b32 v56,v58
v_sub_f32 v142,v142,v156
v_mfma_f32_16x16x32_bf16 v[132:135],a[140:143],a[208:211],v[132:135]
v_sub_f32 v143,v143,v156
v_permlane16_swap_b32 v57,v59
v_sub_f32 v204,0,v156
v_mfma_f32_16x16x32_bf16 v[216:219],a[188:191],v[180:183],v[216:219]
ds_write_b128 v234,v[56:59] offset:32896
v_sub_f32 v205,0,v156
v_xor_b32 v226,0x800,v226
v_sub_f32 v206,0,v156
v_mfma_f32_16x16x32_bf16 v[32:35],a[144:147],v[180:183],0
P172:
s_cbranch_execz P300
ds_read_b64_tr_b16 a[144:145],v225
ds_read_b64_tr_b16 a[146:147],v225 offset:1024
v_sub_f32 v207,0,v156
v_mfma_f32_16x16x32_bf16 v[36:39],a[148:151],v[180:183],0
ds_read_b64_tr_b16 a[148:149],v226
ds_read_b64_tr_b16 a[150:151],v226 offset:1024
v_exp_f32 v136,v136
v_mfma_f32_16x16x32_bf16 v[40:43],a[152:155],v[180:183],0
ds_read_b64_tr_b16 a[152:153],v225 offset:256
ds_read_b64_tr_b16 a[154:155],v225 offset:1280
v_exp_f32 v137,v137
v_mfma_f32_16x16x32_bf16 v[44:47],a[156:159],v[180:183],0
ds_read_b64_tr_b16 a[156:157],v226 offset:256
ds_read_b64_tr_b16 a[158:159],v226 offset:1280
v_exp_f32 v138,v138
v_mfma_f32_16x16x32_bf16 v[48:51],a[160:163],v[180:183],0
v_exp_f32 v139,v139
v_cvt_pk_bf16_f32 v184,v136,v137
v_mfma_f32_16x16x32_bf16 v[52:55],a[164:167],v[180:183],0
ds_read_b64_tr_b16 a[160:161],v225 offset:512
ds_read_b64_tr_b16 a[162:163],v225 offset:1536
v_cvt_pk_bf16_f32 v185,v138,v139
v_mfma_f32_16x16x32_bf16 v[56:59],a[168:171],v[180:183],0
v_exp_f32 v140,v140
v_xor_b32 v224,0x10800,v224
v_mfma_f32_16x16x32_bf16 v[60:63],a[172:175],v[180:183],0
ds_read_b64_tr_b16 a[164:165],v226 offset:512
v_exp_f32 v141,v141
v_mfma_f32_16x16x32_bf16 v[136:139],a[112:115],a[224:227],v[196:199]
ds_read_b64_tr_b16 a[166:167],v226 offset:1536
v_exp_f32 v142,v142
v_mfma_f32_16x16x32_bf16 v[136:139],a[116:119],a[228:231],v[136:139]
v_exp_f32 v143,v143
v_cvt_pk_bf16_f32 v186,v140,v141
v_mfma_f32_16x16x32_bf16 v[136:139],a[120:123],a[232:235],v[136:139]
ds_read_b64_tr_b16 a[168:169],v225 offset:768
ds_read_b64_tr_b16 a[170:171],v225 offset:1792
P173:
s_cbranch_execz P301
v_cvt_pk_bf16_f32 v187,v142,v143
v_mfma_f32_16x16x32_bf16 v[136:139],a[124:127],a[236:239],v[136:139]
v_exp_f32 v144,v144
v_mfma_f32_16x16x32_bf16 v[140:143],a[128:131],a[236:239],v[196:199]
ds_read_b64_tr_b16 a[172:173],v226 offset:768
ds_read_b64_tr_b16 a[174:175],v226 offset:1792
v_xor_b32 v225,0x8800,v225
v_mfma_f32_16x16x32_bf16 v[140:143],a[132:135],a[232:235],v[140:143]
v_exp_f32 v145,v145
v_xor_b32 v226,0x8800,v226
v_mfma_f32_16x16x32_bf16 v[140:143],a[136:139],a[228:231],v[140:143]
v_exp_f32 v146,v146
v_mfma_f32_16x16x32_bf16 v[140:143],a[140:143],a[224:227],v[140:143]
v_rcp_f32 v163,v211
v_max3_u32 v239,v208,v209,v210
v_mfma_f32_16x16x32_bf16 v[220:223],a[176:179],v[184:187],0
s_waitcnt lgkmcnt(2)
v_exp_f32 v147,v147
v_cvt_pk_bf16_f32 v168,v144,v145
v_mfma_f32_16x16x32_bf16 a[0:3],a[144:147],v[184:187],0
v_max3_u32 v239,v239,v211,v212
v_cvt_pk_bf16_f32 v169,v146,v147
v_mfma_f32_16x16x32_bf16 a[4:7],a[148:151],v[184:187],0
v_exp_f32 v148,v148
v_mfma_f32_16x16x32_bf16 a[8:11],a[152:155],v[184:187],0
s_add_u32 m0,s30,81920
v_exp_f32 v149,v149
v_mfma_f32_16x16x32_bf16 a[12:15],a[156:159],v[184:187],0
s_mov_b32 s34,311296
v_exp_f32 v150,v150
v_mfma_f32_16x16x32_bf16 a[16:19],a[160:163],v[184:187],0
P174:
s_cbranch_execz P302
v_mfma_f32_16x16x32_bf16 a[20:23],a[164:167],v[184:187],0
v_exp_f32 v151,v151
v_cvt_pk_bf16_f32 v170,v148,v149
v_mfma_f32_16x16x32_bf16 a[24:27],a[168:171],v[184:187],0
s_waitcnt vmcnt(8) lgkmcnt(0)
s_barrier
v_cvt_pk_bf16_f32 v171,v150,v151
v_mfma_f32_16x16x32_bf16 a[28:31],a[172:175],v[184:187],0
ds_read_b128 v[208:211],v238
v_exp_f32 v128,v128
v_mfma_f32_16x16x32_bf16 v[144:147],a[112:115],a[240:243],v[200:203]
ds_read_b128 v[212:215],v238 offset:64
v_exp_f32 v129,v129
v_mfma_f32_16x16x32_bf16 v[144:147],a[116:119],a[244:247],v[144:147]
ds_read_b128 a[112:115],v224
v_exp_f32 v130,v130
v_mfma_f32_16x16x32_bf16 v[144:147],a[120:123],a[248:251],v[144:147]
buffer_load_dwordx4 v227,s[16:19],s34 offen nt lds
ds_read_b128 a[116:119],v224 offset:256
v_mfma_f32_16x16x32_bf16 v[144:147],a[124:127],a[252:255],v[144:147]
v_exp_f32 v131,v131
v_cvt_pk_bf16_f32 v172,v128,v129
v_mfma_f32_16x16x32_bf16 v[148:151],a[128:131],a[252:255],v[200:203]
ds_read_b128 a[120:123],v224 offset:512
ds_read_b128 a[124:127],v224 offset:768
v_cvt_pk_bf16_f32 v173,v130,v131
v_mfma_f32_16x16x32_bf16 v[148:151],a[132:135],a[248:251],v[148:151]
v_exp_f32 v132,v132
v_mfma_f32_16x16x32_bf16 v[148:151],a[136:139],a[244:247],v[148:151]
ds_read_b128 a[128:131],v224 offset:1792
v_exp_f32 v133,v133
v_mfma_f32_16x16x32_bf16 v[148:151],a[140:143],a[240:243],v[148:151]
ds_read_b128 a[132:135],v224 offset:1536
v_exp_f32 v134,v134
v_mfma_f32_16x16x32_bf16 v[216:219],a[176:179],v[168:171],v[216:219]
v_exp_f32 v135,v135
v_cvt_pk_bf16_f32 v174,v132,v133
v_mfma_f32_16x16x32_bf16 v[64:67],a[144:147],v[168:171],v[64:67]
P175:
s_cbranch_execz P303
v_mfma_f32_16x16x32_bf16 v[68:71],a[148:151],v[168:171],v[68:71]
ds_read_b128 a[136:139],v224 offset:1280
ds_read_b128 a[140:143],v224 offset:1024
v_mfma_f32_16x16x32_bf16 v[72:75],a[152:155],v[168:171],v[72:75]
v_cvt_pk_bf16_f32 v175,v134,v135
v_xor_b32 v224,0x800,v224
v_mfma_f32_16x16x32_bf16 v[76:79],a[156:159],v[168:171],v[76:79]
v_exp_f32 v136,v136
v_mfma_f32_16x16x32_bf16 v[80:83],a[160:163],v[168:171],v[80:83]
v_exp_f32 v137,v137
v_mfma_f32_16x16x32_bf16 v[84:87],a[164:167],v[168:171],v[84:87]
v_exp_f32 v138,v138
v_mfma_f32_16x16x32_bf16 v[88:91],a[168:171],v[168:171],v[88:91]
v_exp_f32 v139,v139
v_mfma_f32_16x16x32_bf16 v[92:95],a[172:175],v[168:171],v[92:95]
s_waitcnt lgkmcnt(0)
v_cvt_pk_bf16_f32 v176,v136,v137
v_cvt_pk_bf16_f32 v177,v138,v139
v_mfma_f32_16x16x32_bf16 v[128:131],a[112:115],a[192:195],v[188:191]
v_exp_f32 v140,v140
v_mfma_f32_16x16x32_bf16 v[128:131],a[116:119],a[196:199],v[128:131]
buffer_load_dwordx4 v227,s[16:19],s34 offen offset:1024 nt lds
v_mfma_f32_16x16x32_bf16 v[128:131],a[120:123],a[200:203],v[128:131]
v_exp_f32 v141,v141
v_mfma_f32_16x16x32_bf16 v[128:131],a[124:127],a[204:207],v[128:131]
v_exp_f32 v142,v142
v_mfma_f32_16x16x32_bf16 v[132:135],a[128:131],a[204:207],v[188:191]
v_exp_f32 v143,v143
v_mfma_f32_16x16x32_bf16 v[132:135],a[132:135],a[200:203],v[132:135]
v_cvt_pk_bf16_f32 v178,v140,v141
v_cvt_pk_bf16_f32 v179,v142,v143
v_mfma_f32_16x16x32_bf16 v[132:135],a[136:139],a[196:199],v[132:135]
v_exp_f32 v144,v144
v_mfma_f32_16x16x32_bf16 v[132:135],a[140:143],a[192:195],v[132:135]
v_exp_f32 v145,v145
v_mfma_f32_16x16x32_bf16 v[96:99],a[144:147],v[172:175],v[96:99]
P176:
s_cbranch_execz P304
v_mfma_f32_16x16x32_bf16 v[100:103],a[148:151],v[172:175],v[100:103]
v_exp_f32 v146,v146
v_mfma_f32_16x16x32_bf16 v[104:107],a[152:155],v[172:175],v[104:107]
v_exp_f32 v147,v147
v_mfma_f32_16x16x32_bf16 v[108:111],a[156:159],v[172:175],v[108:111]
v_cvt_pk_bf16_f32 v180,v144,v145
v_cvt_pk_bf16_f32 v181,v146,v147
v_mfma_f32_16x16x32_bf16 v[112:115],a[160:163],v[172:175],v[112:115]
v_exp_f32 v148,v148
v_mfma_f32_16x16x32_bf16 v[116:119],a[164:167],v[172:175],v[116:119]
v_exp_f32 v149,v149
v_mfma_f32_16x16x32_bf16 v[120:123],a[168:171],v[172:175],v[120:123]
v_exp_f32 v150,v150
v_mfma_f32_16x16x32_bf16 v[124:127],a[172:175],v[172:175],v[124:127]
v_exp_f32 v151,v151
v_mfma_f32_16x16x32_bf16 v[216:219],a[180:183],v[172:175],v[216:219]
v_cvt_pk_bf16_f32 v182,v148,v149
v_cvt_pk_bf16_f32 v183,v150,v151
v_mfma_f32_16x16x32_bf16 v[216:219],a[184:187],v[176:179],v[216:219]
v_exp_f32 v128,v128
v_mfma_f32_16x16x32_bf16 v[0:3],a[144:147],v[176:179],v[0:3]
buffer_load_dwordx4 v227,s[16:19],s34 offen offset:2048 nt lds
v_mfma_f32_16x16x32_bf16 v[4:7],a[148:151],v[176:179],v[4:7]
v_exp_f32 v129,v129
v_mfma_f32_16x16x32_bf16 v[8:11],a[152:155],v[176:179],v[8:11]
v_exp_f32 v130,v130
v_mfma_f32_16x16x32_bf16 v[12:15],a[156:159],v[176:179],v[12:15]
v_exp_f32 v131,v131
v_mfma_f32_16x16x32_bf16 v[16:19],a[160:163],v[176:179],v[16:19]
v_cvt_pk_bf16_f32 v168,v128,v129
v_cvt_pk_bf16_f32 v169,v130,v131
v_mfma_f32_16x16x32_bf16 v[20:23],a[164:167],v[176:179],v[20:23]
v_exp_f32 v132,v132
v_mfma_f32_16x16x32_bf16 v[24:27],a[168:171],v[176:179],v[24:27]
v_exp_f32 v133,v133
v_mfma_f32_16x16x32_bf16 v[28:31],a[172:175],v[176:179],v[28:31]
v_exp_f32 v134,v134
v_mfma_f32_16x16x32_bf16 v[136:139],a[112:115],a[208:211],v[192:195]
P177:
s_cbranch_execz P305
v_mfma_f32_16x16x32_bf16 v[136:139],a[116:119],a[212:215],v[136:139]
v_exp_f32 v135,v135
v_mfma_f32_16x16x32_bf16 v[136:139],a[120:123],a[216:219],v[136:139]
v_cvt_pk_bf16_f32 v170,v132,v133
v_cvt_pk_bf16_f32 v171,v134,v135
v_mfma_f32_16x16x32_bf16 v[136:139],a[124:127],a[220:223],v[136:139]
v_permlane16_swap_b32 v240,v242
v_mfma_f32_16x16x32_bf16 v[140:143],a[128:131],a[220:223],v[192:195]
v_permlane16_swap_b32 v241,v243
v_mfma_f32_16x16x32_bf16 v[140:143],a[132:135],a[216:219],v[140:143]
ds_write_b128 v233,v[240:243] offset:49152
v_mfma_f32_16x16x32_bf16 v[140:143],a[136:139],a[212:215],v[140:143]
v_permlane16_swap_b32 v244,v246
v_mfma_f32_16x16x32_bf16 v[140:143],a[140:143],a[208:211],v[140:143]
v_exp_f32 v136,v136
v_mfma_f32_16x16x32_bf16 v[216:219],a[188:191],v[180:183],v[216:219]
v_exp_f32 v137,v137
v_mfma_f32_16x16x32_bf16 v[32:35],a[144:147],v[180:183],v[32:35]
ds_read_b64_tr_b16 a[144:145],v225
ds_read_b64_tr_b16 a[146:147],v225 offset:1024
v_mfma_f32_16x16x32_bf16 v[36:39],a[148:151],v[180:183],v[36:39]
buffer_load_dwordx4 v227,s[16:19],s34 offen offset:3072 nt lds
v_mfma_f32_16x16x32_bf16 v[40:43],a[152:155],v[180:183],v[40:43]
ds_read_b64_tr_b16 a[148:149],v226
ds_read_b64_tr_b16 a[150:151],v226 offset:1024
v_mfma_f32_16x16x32_bf16 v[44:47],a[156:159],v[180:183],v[44:47]
v_exp_f32 v138,v138
v_mfma_f32_16x16x32_bf16 v[48:51],a[160:163],v[180:183],v[48:51]
ds_read_b64_tr_b16 a[152:153],v225 offset:256
ds_read_b64_tr_b16 a[154:155],v225 offset:1280
v_mfma_f32_16x16x32_bf16 v[52:55],a[164:167],v[180:183],v[52:55]
v_exp_f32 v139,v139
v_mfma_f32_16x16x32_bf16 v[56:59],a[168:171],v[180:183],v[56:59]
ds_read_b64_tr_b16 a[156:157],v226 offset:256
ds_read_b64_tr_b16 a[158:159],v226 offset:1280
v_mfma_f32_16x16x32_bf16 v[60:63],a[172:175],v[180:183],v[60:63]
P178:
s_cbranch_execz P306
v_mfma_f32_16x16x32_bf16 v[144:147],a[112:115],a[224:227],v[196:199]
ds_read_b64_tr_b16 a[160:161],v225 offset:512
ds_read_b64_tr_b16 a[162:163],v225 offset:1536
v_mfma_f32_16x16x32_bf16 v[144:147],a[116:119],a[228:231],v[144:147]
s_add_u32 m0,s30,0
v_cvt_pk_bf16_f32 v172,v136,v137
v_cvt_pk_bf16_f32 v173,v138,v139
v_mfma_f32_16x16x32_bf16 v[144:147],a[120:123],a[232:235],v[144:147]
s_mov_b32 s34,311296
ds_read_b64_tr_b16 a[164:165],v226 offset:512
ds_read_b64_tr_b16 a[166:167],v226 offset:1536
v_mfma_f32_16x16x32_bf16 v[144:147],a[124:127],a[236:239],v[144:147]
v_exp_f32 v140,v140
v_mfma_f32_16x16x32_bf16 v[148:151],a[128:131],a[236:239],v[196:199]
ds_read_b64_tr_b16 a[168:169],v225 offset:768
ds_read_b64_tr_b16 a[170:171],v225 offset:1792
v_mfma_f32_16x16x32_bf16 v[148:151],a[132:135],a[232:235],v[148:151]
v_exp_f32 v141,v141
v_mfma_f32_16x16x32_bf16 v[148:151],a[136:139],a[228:231],v[148:151]
ds_read_b64_tr_b16 a[172:173],v226 offset:768
ds_read_b64_tr_b16 a[174:175],v226 offset:1792
v_mfma_f32_16x16x32_bf16 v[148:151],a[140:143],a[224:227],v[148:151]
v_exp_f32 v142,v142
v_mfma_f32_16x16x32_bf16 v[132:135],a[140:143],a[240:243],v[200:203]
v_exp_f32 v143,v143
v_mfma_f32_16x16x32_bf16 v[132:135],a[136:139],a[244:247],v[132:135]
buffer_load_dwordx4 v227,s[20:23],s34 offen nt lds
v_mfma_f32_16x16x32_bf16 v[132:135],a[132:135],a[248:251],v[132:135]
v_cvt_pk_bf16_f32 v174,v140,v141
v_cvt_pk_bf16_f32 v175,v142,v143
v_mfma_f32_16x16x32_bf16 v[132:135],a[128:131],a[252:255],v[132:135]
v_exp_f32 v144,v144
v_mfma_f32_16x16x32_bf16 v[128:131],a[124:127],a[252:255],v[200:203]
v_exp_f32 v145,v145
v_mfma_f32_16x16x32_bf16 v[128:131],a[120:123],a[248:251],v[128:131]
P179:
s_cbranch_execz P307
v_mfma_f32_16x16x32_bf16 v[128:131],a[116:119],a[244:247],v[128:131]
v_exp_f32 v146,v146
v_mfma_f32_16x16x32_bf16 v[128:131],a[112:115],a[240:243],v[128:131]
s_waitcnt lgkmcnt(0)
ds_read_b128 a[112:115],v224
ds_read_b128 a[116:119],v224 offset:256
v_mfma_f32_16x16x32_bf16 v[64:67],a[144:147],v[168:171],v[64:67]
v_exp_f32 v147,v147
v_mfma_f32_16x16x32_bf16 v[68:71],a[148:151],v[168:171],v[68:71]
ds_read_b128 a[120:123],v224 offset:512
ds_read_b128 a[124:127],v224 offset:768
v_mfma_f32_16x16x32_bf16 v[72:75],a[152:155],v[168:171],v[72:75]
v_cvt_pk_bf16_f32 v176,v144,v145
v_cvt_pk_bf16_f32 v177,v146,v147
v_mfma_f32_16x16x32_bf16 v[76:79],a[156:159],v[168:171],v[76:79]
ds_read_b128 a[128:131],v224 offset:1792
ds_read_b128 a[132:135],v224 offset:1536
v_mfma_f32_16x16x32_bf16 v[80:83],a[160:163],v[168:171],v[80:83]
v_exp_f32 v148,v148
v_mfma_f32_16x16x32_bf16 v[84:87],a[164:167],v[168:171],v[84:87]
ds_read_b128 a[136:139],v224 offset:1280
ds_read_b128 a[140:143],v224 offset:1024
v_mfma_f32_16x16x32_bf16 v[88:91],a[168:171],v[168:171],v[88:91]
v_exp_f32 v149,v149
v_mfma_f32_16x16x32_bf16 v[92:95],a[172:175],v[168:171],v[92:95]
v_exp_f32 v150,v150
v_mfma_f32_16x16x32_bf16 v[216:219],a[176:179],v[168:171],v[216:219]
v_exp_f32 v151,v151
v_mfma_f32_16x16x32_bf16 v[216:219],a[180:183],v[172:175],v[216:219]
v_cvt_pk_bf16_f32 v178,v148,v149
v_cvt_pk_bf16_f32 v179,v150,v151
v_mfma_f32_16x16x32_bf16 v[96:99],a[144:147],v[172:175],v[96:99]
buffer_load_dwordx4 v227,s[20:23],s34 offen offset:1024 nt lds
v_mfma_f32_16x16x32_bf16 v[100:103],a[148:151],v[172:175],v[100:103]
P180:
s_cbranch_execz P308
v_mfma_f32_16x16x32_bf16 v[104:107],a[152:155],v[172:175],v[104:107]
v_exp_f32 v132,v132
v_mfma_f32_16x16x32_bf16 v[108:111],a[156:159],v[172:175],v[108:111]
v_exp_f32 v133,v133
v_mfma_f32_16x16x32_bf16 v[112:115],a[160:163],v[172:175],v[112:115]
v_exp_f32 v134,v134
v_mfma_f32_16x16x32_bf16 v[116:119],a[164:167],v[172:175],v[116:119]
v_exp_f32 v135,v135
v_mfma_f32_16x16x32_bf16 v[120:123],a[168:171],v[172:175],v[120:123]
v_cvt_pk_bf16_f32 v182,v132,v133
v_cvt_pk_bf16_f32 v183,v134,v135
v_mfma_f32_16x16x32_bf16 v[124:127],a[172:175],v[172:175],v[124:127]
s_waitcnt lgkmcnt(0)
v_exp_f32 v128,v128
v_mfma_f32_16x16x32_bf16 v[136:139],a[112:115],a[96:99],v[204:207]
v_exp_f32 v129,v129
v_mfma_f32_16x16x32_bf16 v[136:139],a[116:119],a[100:103],v[136:139]
v_exp_f32 v130,v130
v_mfma_f32_16x16x32_bf16 v[136:139],a[120:123],a[104:107],v[136:139]
v_exp_f32 v131,v131
v_mfma_f32_16x16x32_bf16 v[136:139],a[124:127],a[108:111],v[136:139]
v_cvt_pk_bf16_f32 v180,v128,v129
v_cvt_pk_bf16_f32 v181,v130,v131
v_mfma_f32_16x16x32_bf16 v[140:143],a[128:131],a[108:111],v[204:207]
v_xor_b32 v225,0x800,v225
v_xor_b32 v226,0x800,v226
v_mfma_f32_16x16x32_bf16 v[140:143],a[132:135],a[104:107],v[140:143]
v_permlane16_swap_b32 v245,v247
v_mfma_f32_16x16x32_bf16 v[140:143],a[136:139],a[100:103],v[140:143]
v_exp_f32 v136,v136
v_mfma_f32_16x16x32_bf16 v[140:143],a[140:143],a[96:99],v[140:143]
v_exp_f32 v137,v137
v_mfma_f32_16x16x32_bf16 v[148:151],a[140:143],a[192:195],v[188:191]
v_exp_f32 v138,v138
v_mfma_f32_16x16x32_bf16 v[148:151],a[136:139],a[196:199],v[148:151]
buffer_load_dwordx4 v227,s[20:23],s34 offen offset:2048 nt lds
v_mfma_f32_16x16x32_bf16 v[148:151],a[132:135],a[200:203],v[148:151]
v_exp_f32 v139,v139
v_mfma_f32_16x16x32_bf16 v[148:151],a[128:131],a[204:207],v[148:151]
P181:
s_cbranch_execz P309
v_mfma_f32_16x16x32_bf16 v[144:147],a[124:127],a[204:207],v[188:191]
v_cvt_pk_bf16_f32 v184,v136,v137
v_cvt_pk_bf16_f32 v185,v138,v139
v_mfma_f32_16x16x32_bf16 v[144:147],a[120:123],a[200:203],v[144:147]
v_exp_f32 v140,v140
v_mfma_f32_16x16x32_bf16 v[144:147],a[116:119],a[196:199],v[144:147]
v_exp_f32 v141,v141
v_mfma_f32_16x16x32_bf16 v[144:147],a[112:115],a[192:195],v[144:147]
v_exp_f32 v142,v142
v_mfma_f32_16x16x32_bf16 v[0:3],a[144:147],v[176:179],v[0:3]
v_exp_f32 v143,v143
v_mfma_f32_16x16x32_bf16 v[4:7],a[148:151],v[176:179],v[4:7]
v_cvt_pk_bf16_f32 v186,v140,v141
v_cvt_pk_bf16_f32 v187,v142,v143
v_mfma_f32_16x16x32_bf16 v[8:11],a[152:155],v[176:179],v[8:11]
v_exp_f32 v148,v148
v_mfma_f32_16x16x32_bf16 v[12:15],a[156:159],v[176:179],v[12:15]
v_exp_f32 v149,v149
v_mfma_f32_16x16x32_bf16 v[16:19],a[160:163],v[176:179],v[16:19]
v_exp_f32 v150,v150
v_mfma_f32_16x16x32_bf16 v[20:23],a[164:167],v[176:179],v[20:23]
v_exp_f32 v151,v151
v_mfma_f32_16x16x32_bf16 v[24:27],a[168:171],v[176:179],v[24:27]
v_cvt_pk_bf16_f32 v170,v148,v149
v_cvt_pk_bf16_f32 v171,v150,v151
v_mfma_f32_16x16x32_bf16 v[28:31],a[172:175],v[176:179],v[28:31]
v_exp_f32 v144,v144
v_mfma_f32_16x16x32_bf16 v[216:219],a[184:187],v[176:179],v[216:219]
v_exp_f32 v145,v145
v_mfma_f32_16x16x32_bf16 v[216:219],a[188:191],v[180:183],v[216:219]
v_exp_f32 v146,v146
v_mfma_f32_16x16x32_bf16 v[32:35],a[144:147],v[180:183],v[32:35]
ds_read_b64_tr_b16 a[144:145],v225
ds_read_b64_tr_b16 a[146:147],v225 offset:1024
v_mfma_f32_16x16x32_bf16 v[36:39],a[148:151],v[180:183],v[36:39]
buffer_load_dwordx4 v227,s[20:23],s34 offen offset:3072 nt lds
v_mfma_f32_16x16x32_bf16 v[40:43],a[152:155],v[180:183],v[40:43]
P182:
s_cbranch_execz P310
v_mfma_f32_16x16x32_bf16 v[44:47],a[156:159],v[180:183],v[44:47]
ds_read_b64_tr_b16 a[148:149],v226
ds_read_b64_tr_b16 a[150:151],v226 offset:1024
v_mfma_f32_16x16x32_bf16 v[48:51],a[160:163],v[180:183],v[48:51]
v_exp_f32 v147,v147
v_mfma_f32_16x16x32_bf16 v[52:55],a[164:167],v[180:183],v[52:55]
ds_read_b64_tr_b16 a[152:153],v225 offset:256
ds_read_b64_tr_b16 a[154:155],v225 offset:1280
v_mfma_f32_16x16x32_bf16 v[56:59],a[168:171],v[180:183],v[56:59]
v_cvt_pk_bf16_f32 v168,v144,v145
v_cvt_pk_bf16_f32 v169,v146,v147
v_mfma_f32_16x16x32_bf16 v[60:63],a[172:175],v[180:183],v[60:63]
ds_read_b64_tr_b16 a[156:157],v226 offset:256
ds_read_b64_tr_b16 a[158:159],v226 offset:1280
v_mfma_f32_16x16x32_bf16 v[128:131],a[112:115],a[208:211],v[192:195]
ds_write_b128 v234,v[244:247] offset:49152
v_mfma_f32_16x16x32_bf16 v[128:131],a[116:119],a[212:215],v[128:131]
ds_read_b64_tr_b16 a[160:161],v225 offset:512
ds_read_b64_tr_b16 a[162:163],v225 offset:1536
v_mfma_f32_16x16x32_bf16 v[128:131],a[120:123],a[216:219],v[128:131]
v_permlane16_swap_b32 v248,v250
v_mfma_f32_16x16x32_bf16 v[128:131],a[124:127],a[220:223],v[128:131]
ds_read_b64_tr_b16 a[164:165],v226 offset:512
ds_read_b64_tr_b16 a[166:167],v226 offset:1536
v_mfma_f32_16x16x32_bf16 v[132:135],a[128:131],a[220:223],v[192:195]
v_permlane16_swap_b32 v249,v251
v_mfma_f32_16x16x32_bf16 v[132:135],a[132:135],a[216:219],v[132:135]
ds_read_b64_tr_b16 a[168:169],v225 offset:768
ds_read_b64_tr_b16 a[170:171],v225 offset:1792
v_mfma_f32_16x16x32_bf16 v[132:135],a[136:139],a[212:215],v[132:135]
v_exp_f32 v128,v128
v_mfma_f32_16x16x32_bf16 v[132:135],a[140:143],a[208:211],v[132:135]
ds_read_b64_tr_b16 a[172:173],v226 offset:768
ds_read_b64_tr_b16 a[174:175],v226 offset:1792
v_mfma_f32_16x16x32_bf16 v[140:143],a[140:143],a[224:227],v[196:199]
P183:
s_cbranch_execz P311
v_mfma_f32_16x16x32_bf16 v[140:143],a[136:139],a[228:231],v[140:143]
v_exp_f32 v129,v129
v_mfma_f32_16x16x32_bf16 v[140:143],a[132:135],a[232:235],v[140:143]
v_exp_f32 v130,v130
v_mfma_f32_16x16x32_bf16 v[140:143],a[128:131],a[236:239],v[140:143]
v_exp_f32 v131,v131
v_mfma_f32_16x16x32_bf16 v[136:139],a[124:127],a[236:239],v[196:199]
v_cvt_pk_bf16_f32 v172,v128,v129
v_xor_b32 v224,0x8800,v224
v_mfma_f32_16x16x32_bf16 v[136:139],a[120:123],a[232:235],v[136:139]
v_cvt_pk_bf16_f32 v173,v130,v131
v_xor_b32 v225,0x18800,v225
v_mfma_f32_16x16x32_bf16 v[136:139],a[116:119],a[228:231],v[136:139]
v_exp_f32 v132,v132
v_mfma_f32_16x16x32_bf16 v[136:139],a[112:115],a[224:227],v[136:139]
s_waitcnt lgkmcnt(0)
s_mov_b64 exec,0
s_bitcmp1_b32 s3,1
s_cbranch_scc1 ZT1
s_bitcmp1_b32 s3,0
s_cbranch_scc1 Z13
s_branch Z12
ZT1:
s_bitcmp1_b32 s3,0
s_cbranch_scc1 Z15
s_branch Z14
ZB1:
s_mov_b64 exec,-1
v_mfma_f32_16x16x32_bf16 a[0:3],a[144:147],v[184:187],a[0:3]
v_exp_f32 v133,v133
v_mfma_f32_16x16x32_bf16 a[4:7],a[148:151],v[184:187],a[4:7]
v_exp_f32 v134,v134
v_mfma_f32_16x16x32_bf16 a[8:11],a[152:155],v[184:187],a[8:11]
s_add_u32 m0,s30,16384
v_exp_f32 v135,v135
v_mfma_f32_16x16x32_bf16 a[12:15],a[156:159],v[184:187],a[12:15]
s_mov_b32 s34,327680
v_cvt_pk_bf16_f32 v174,v132,v133
v_cvt_pk_bf16_f32 v175,v134,v135
v_mfma_f32_16x16x32_bf16 a[16:19],a[160:163],v[184:187],a[16:19]
v_exp_f32 v140,v140
v_mfma_f32_16x16x32_bf16 a[20:23],a[164:167],v[184:187],a[20:23]
P184:
s_cbranch_execz P312
v_mfma_f32_16x16x32_bf16 a[24:27],a[168:171],v[184:187],a[24:27]
s_waitcnt vmcnt(8) lgkmcnt(0)
s_barrier
v_mfma_f32_16x16x32_bf16 a[28:31],a[172:175],v[184:187],a[28:31]
v_exp_f32 v141,v141
v_mfma_f32_16x16x32_bf16 v[220:223],a[176:179],v[184:187],v[220:223]
v_exp_f32 v142,v142
v_mfma_f32_16x16x32_bf16 v[216:219],a[176:179],v[168:171],v[216:219]
v_exp_f32 v143,v143
v_mfma_f32_16x16x32_bf16 v[64:67],a[144:147],v[168:171],v[64:67]
buffer_load_dwordx4 v227,s[16:19],s34 offen nt lds
v_mfma_f32_16x16x32_bf16 v[68:71],a[148:151],v[168:171],v[68:71]
v_cvt_pk_bf16_f32 v178,v140,v141
v_cvt_pk_bf16_f32 v179,v142,v143
v_mfma_f32_16x16x32_bf16 v[72:75],a[152:155],v[168:171],v[72:75]
v_exp_f32 v136,v136
v_mfma_f32_16x16x32_bf16 v[76:79],a[156:159],v[168:171],v[76:79]
v_exp_f32 v137,v137
v_mfma_f32_16x16x32_bf16 v[80:83],a[160:163],v[168:171],v[80:83]
v_exp_f32 v138,v138
v_mfma_f32_16x16x32_bf16 v[84:87],a[164:167],v[168:171],v[84:87]
v_exp_f32 v139,v139
v_mfma_f32_16x16x32_bf16 v[88:91],a[168:171],v[168:171],v[88:91]
v_cvt_pk_bf16_f32 v176,v136,v137
v_cvt_pk_bf16_f32 v177,v138,v139
v_mfma_f32_16x16x32_bf16 v[92:95],a[172:175],v[168:171],v[92:95]
ds_write_b128 v233,v[248:251] offset:49280
v_mfma_f32_16x16x32_bf16 v[144:147],a[112:115],a[240:243],v[200:203]
v_permlane16_swap_b32 v252,v254
v_mfma_f32_16x16x32_bf16 v[144:147],a[116:119],a[244:247],v[144:147]
ds_read_b128 a[112:115],v224
ds_read_b128 a[116:119],v224 offset:256
v_mfma_f32_16x16x32_bf16 v[144:147],a[120:123],a[248:251],v[144:147]
v_permlane16_swap_b32 v253,v255
v_mfma_f32_16x16x32_bf16 v[144:147],a[124:127],a[252:255],v[144:147]
ds_read_b128 a[120:123],v224 offset:512
ds_read_b128 a[124:127],v224 offset:768
v_mfma_f32_16x16x32_bf16 v[148:151],a[128:131],a[252:255],v[200:203]
P185:
s_cbranch_execz P313
v_mfma_f32_16x16x32_bf16 v[148:151],a[132:135],a[248:251],v[148:151]
ds_read_b128 a[128:131],v224 offset:1792
ds_read_b128 a[132:135],v224 offset:1536
v_mfma_f32_16x16x32_bf16 v[148:151],a[136:139],a[244:247],v[148:151]
v_exp_f32 v144,v144
v_mfma_f32_16x16x32_bf16 v[148:151],a[140:143],a[240:243],v[148:151]
ds_read_b128 a[136:139],v224 offset:1280
ds_read_b128 a[140:143],v224 offset:1024
v_mfma_f32_16x16x32_bf16 v[96:99],a[144:147],v[172:175],v[96:99]
v_exp_f32 v145,v145
v_mfma_f32_16x16x32_bf16 v[100:103],a[148:151],v[172:175],v[100:103]
buffer_load_dwordx4 v227,s[16:19],s34 offen offset:1024 nt lds
v_mfma_f32_16x16x32_bf16 v[104:107],a[152:155],v[172:175],v[104:107]
v_exp_f32 v146,v146
v_mfma_f32_16x16x32_bf16 v[108:111],a[156:159],v[172:175],v[108:111]
v_exp_f32 v147,v147
v_mfma_f32_16x16x32_bf16 v[112:115],a[160:163],v[172:175],v[112:115]
v_cvt_pk_bf16_f32 v180,v144,v145
v_cvt_pk_bf16_f32 v181,v146,v147
v_mfma_f32_16x16x32_bf16 v[116:119],a[164:167],v[172:175],v[116:119]
v_exp_f32 v148,v148
v_mfma_f32_16x16x32_bf16 v[120:123],a[168:171],v[172:175],v[120:123]
v_exp_f32 v149,v149
v_mfma_f32_16x16x32_bf16 v[124:127],a[172:175],v[172:175],v[124:127]
v_exp_f32 v150,v150
v_mfma_f32_16x16x32_bf16 v[216:219],a[180:183],v[172:175],v[216:219]
v_exp_f32 v151,v151
v_mfma_f32_16x16x32_bf16 v[216:219],a[184:187],v[176:179],v[216:219]
v_cvt_pk_bf16_f32 v182,v148,v149
v_cvt_pk_bf16_f32 v183,v150,v151
v_mfma_f32_16x16x32_bf16 v[0:3],a[144:147],v[176:179],v[0:3]
v_xor_b32 v226,0x18800,v226
v_xor_b32 v224,0x800,v224
v_mfma_f32_16x16x32_bf16 v[4:7],a[148:151],v[176:179],v[4:7]
P186:
s_cbranch_execz P314
v_mfma_f32_16x16x32_bf16 v[8:11],a[152:155],v[176:179],v[8:11]
ds_write_b128 v234,v[252:255] offset:49280
v_mfma_f32_16x16x32_bf16 v[12:15],a[156:159],v[176:179],v[12:15]
v_xor_b32 v153,16,v236
v_mfma_f32_16x16x32_bf16 v[16:19],a[160:163],v[176:179],v[16:19]
ds_read_b128 v[240:243],v236
ds_read_b128 v[244:247],v153
v_mfma_f32_16x16x32_bf16 v[20:23],a[164:167],v[176:179],v[20:23]
ds_read_b128 v[248:251],v236 offset:16384
ds_read_b128 v[252:255],v153 offset:16384
v_mfma_f32_16x16x32_bf16 v[24:27],a[168:171],v[176:179],v[24:27]
v_xor_b32 v152,64,v236
v_xor_b32 v153,64,v153
v_mfma_f32_16x16x32_bf16 v[28:31],a[172:175],v[176:179],v[28:31]
s_waitcnt lgkmcnt(5)
v_min_f32 v154,v208,v212
v_min_f32 v155,v210,v214
v_mfma_f32_16x16x32_bf16 v[128:131],a[112:115],a[192:195],v[188:191]
buffer_load_dwordx4 v227,s[16:19],s34 offen offset:2048 nt lds
v_mfma_f32_16x16x32_bf16 v[128:131],a[116:119],a[196:199],v[128:131]
v_sub_f32 v208,v154,v208
v_sub_f32 v210,v155,v210
v_mfma_f32_16x16x32_bf16 v[128:131],a[120:123],a[200:203],v[128:131]
v_sub_f32 v212,v154,v212
v_sub_f32 v214,v155,v214
v_mfma_f32_16x16x32_bf16 v[128:131],a[124:127],a[204:207],v[128:131]
v_exp_f32 v208,v208
v_mfma_f32_16x16x32_bf16 v[132:135],a[128:131],a[204:207],v[188:191]
v_exp_f32 v210,v210
v_mfma_f32_16x16x32_bf16 v[132:135],a[132:135],a[200:203],v[132:135]
v_exp_f32 v212,v212
v_mfma_f32_16x16x32_bf16 v[132:135],a[136:139],a[196:199],v[132:135]
v_exp_f32 v214,v214
v_mfma_f32_16x16x32_bf16 v[132:135],a[140:143],a[192:195],v[132:135]
v_exp_f32 v128,v128
v_mfma_f32_16x16x32_bf16 v[140:143],a[140:143],a[208:211],v[192:195]
v_exp_f32 v129,v129
v_mfma_f32_16x16x32_bf16 v[140:143],a[136:139],a[212:215],v[140:143]
v_exp_f32 v130,v130
v_mfma_f32_16x16x32_bf16 v[140:143],a[132:135],a[216:219],v[140:143]
P187:
s_cbranch_execz P315
Z11:
s_cbranch_execz ZB0
v_mfma_f32_16x16x32_bf16 v[140:143],a[128:131],a[220:223],v[140:143]
v_exp_f32 v131,v131
v_mfma_f32_16x16x32_bf16 v[136:139],a[124:127],a[220:223],v[192:195]
v_cvt_pk_bf16_f32 v168,v128,v129
v_cvt_pk_bf16_f32 v169,v130,v131
v_mfma_f32_16x16x32_bf16 v[136:139],a[120:123],a[216:219],v[136:139]
v_exp_f32 v132,v132
v_mfma_f32_16x16x32_bf16 v[136:139],a[116:119],a[212:215],v[136:139]
v_exp_f32 v133,v133
v_mfma_f32_16x16x32_bf16 v[136:139],a[112:115],a[208:211],v[136:139]
v_exp_f32 v134,v134
v_mfma_f32_16x16x32_bf16 v[216:219],a[188:191],v[180:183],v[216:219]
v_exp_f32 v135,v135
v_mfma_f32_16x16x32_bf16 v[32:35],a[144:147],v[180:183],v[32:35]
ds_read_b64_tr_b16 a[144:145],v225
ds_read_b64_tr_b16 a[146:147],v225 offset:1024
v_mfma_f32_16x16x32_bf16 v[36:39],a[148:151],v[180:183],v[36:39]
buffer_load_dwordx4 v227,s[16:19],s34 offen offset:3072 nt lds
v_mfma_f32_16x16x32_bf16 v[40:43],a[152:155],v[180:183],v[40:43]
ds_read_b64_tr_b16 a[148:149],v226
ds_read_b64_tr_b16 a[150:151],v226 offset:1024
v_mfma_f32_16x16x32_bf16 v[44:47],a[156:159],v[180:183],v[44:47]
v_cvt_pk_bf16_f32 v170,v132,v133
v_cvt_pk_bf16_f32 v171,v134,v135
v_mfma_f32_16x16x32_bf16 v[48:51],a[160:163],v[180:183],v[48:51]
ds_read_b64_tr_b16 a[152:153],v225 offset:256
ds_read_b64_tr_b16 a[154:155],v225 offset:1280
v_mfma_f32_16x16x32_bf16 v[52:55],a[164:167],v[180:183],v[52:55]
v_exp_f32 v140,v140
v_mfma_f32_16x16x32_bf16 v[56:59],a[168:171],v[180:183],v[56:59]
ds_read_b64_tr_b16 a[156:157],v226 offset:256
ds_read_b64_tr_b16 a[158:159],v226 offset:1280
v_mfma_f32_16x16x32_bf16 v[60:63],a[172:175],v[180:183],v[60:63]
v_exp_f32 v141,v141
v_mfma_f32_16x16x32_bf16 v[144:147],a[112:115],a[224:227],v[196:199]
P188:
s_cbranch_execz P316
v_mfma_f32_16x16x32_bf16 v[144:147],a[116:119],a[228:231],v[144:147]
s_add_u32 m0,s30,32768
ds_read_b64_tr_b16 a[160:161],v225 offset:512
ds_read_b64_tr_b16 a[162:163],v225 offset:1536
v_mfma_f32_16x16x32_bf16 v[144:147],a[120:123],a[232:235],v[144:147]
s_mov_b32 s34,327680
v_exp_f32 v142,v142
v_mfma_f32_16x16x32_bf16 v[144:147],a[124:127],a[236:239],v[144:147]
ds_read_b64_tr_b16 a[164:165],v226 offset:512
ds_read_b64_tr_b16 a[166:167],v226 offset:1536
v_mfma_f32_16x16x32_bf16 v[148:151],a[128:131],a[236:239],v[196:199]
v_exp_f32 v143,v143
v_mfma_f32_16x16x32_bf16 v[148:151],a[132:135],a[232:235],v[148:151]
ds_read_b64_tr_b16 a[168:169],v225 offset:768
ds_read_b64_tr_b16 a[170:171],v225 offset:1792
v_mfma_f32_16x16x32_bf16 v[148:151],a[136:139],a[228:231],v[148:151]
v_cvt_pk_bf16_f32 v174,v140,v141
v_cvt_pk_bf16_f32 v175,v142,v143
v_mfma_f32_16x16x32_bf16 v[148:151],a[140:143],a[224:227],v[148:151]
ds_read_b64_tr_b16 a[172:173],v226 offset:768
ds_read_b64_tr_b16 a[174:175],v226 offset:1792
v_mfma_f32_16x16x32_bf16 v[132:135],a[140:143],a[240:243],v[200:203]
v_exp_f32 v136,v136
v_mfma_f32_16x16x32_bf16 v[132:135],a[136:139],a[244:247],v[132:135]
buffer_load_dwordx4 v227,s[20:23],s34 offen nt lds
v_mfma_f32_16x16x32_bf16 v[132:135],a[132:135],a[248:251],v[132:135]
v_exp_f32 v137,v137
v_mfma_f32_16x16x32_bf16 v[132:135],a[128:131],a[252:255],v[132:135]
v_exp_f32 v138,v138
v_mfma_f32_16x16x32_bf16 v[128:131],a[124:127],a[252:255],v[200:203]
v_exp_f32 v139,v139
v_mfma_f32_16x16x32_bf16 v[128:131],a[120:123],a[248:251],v[128:131]
v_cvt_pk_bf16_f32 v172,v136,v137
v_cvt_pk_bf16_f32 v173,v138,v139
v_mfma_f32_16x16x32_bf16 v[128:131],a[116:119],a[244:247],v[128:131]
P189:
s_cbranch_execz P317
v_mfma_f32_16x16x32_bf16 v[128:131],a[112:115],a[240:243],v[128:131]
s_waitcnt lgkmcnt(0)
ds_read_b128 a[112:115],v224
ds_read_b128 a[116:119],v224 offset:256
v_mfma_f32_16x16x32_bf16 v[64:67],a[144:147],v[168:171],v[64:67]
v_exp_f32 v144,v144
v_mfma_f32_16x16x32_bf16 v[68:71],a[148:151],v[168:171],v[68:71]
ds_read_b128 a[120:123],v224 offset:512
ds_read_b128 a[124:127],v224 offset:768
v_mfma_f32_16x16x32_bf16 v[72:75],a[152:155],v[168:171],v[72:75]
v_exp_f32 v145,v145
v_mfma_f32_16x16x32_bf16 v[76:79],a[156:159],v[168:171],v[76:79]
ds_read_b128 a[128:131],v224 offset:1792
ds_read_b128 a[132:135],v224 offset:1536
v_mfma_f32_16x16x32_bf16 v[80:83],a[160:163],v[168:171],v[80:83]
v_exp_f32 v146,v146
v_mfma_f32_16x16x32_bf16 v[84:87],a[164:167],v[168:171],v[84:87]
ds_read_b128 a[136:139],v224 offset:1280
ds_read_b128 a[140:143],v224 offset:1024
v_mfma_f32_16x16x32_bf16 v[88:91],a[168:171],v[168:171],v[88:91]
v_exp_f32 v147,v147
v_mfma_f32_16x16x32_bf16 v[92:95],a[172:175],v[168:171],v[92:95]
v_cvt_pk_bf16_f32 v176,v144,v145
v_cvt_pk_bf16_f32 v177,v146,v147
v_mfma_f32_16x16x32_bf16 v[216:219],a[176:179],v[168:171],v[216:219]
v_exp_f32 v148,v148
v_mfma_f32_16x16x32_bf16 v[216:219],a[180:183],v[172:175],v[216:219]
v_exp_f32 v149,v149
v_mfma_f32_16x16x32_bf16 v[96:99],a[144:147],v[172:175],v[96:99]
buffer_load_dwordx4 v227,s[20:23],s34 offen offset:1024 nt lds
v_mfma_f32_16x16x32_bf16 v[100:103],a[148:151],v[172:175],v[100:103]
v_exp_f32 v150,v150
v_mfma_f32_16x16x32_bf16 v[104:107],a[152:155],v[172:175],v[104:107]
v_exp_f32 v151,v151
v_mfma_f32_16x16x32_bf16 v[108:111],a[156:159],v[172:175],v[108:111]
P190:
s_cbranch_execz P318
v_mfma_f32_16x16x32_bf16 v[112:115],a[160:163],v[172:175],v[112:115]
v_cvt_pk_bf16_f32 v178,v148,v149
v_mul_f32 v154,v208,v209
v_mfma_f32_16x16x32_bf16 v[116:119],a[164:167],v[172:175],v[116:119]
v_cvt_pk_bf16_f32 v179,v150,v151
v_mul_f32 v155,v210,v211
v_mfma_f32_16x16x32_bf16 v[120:123],a[168:171],v[172:175],v[120:123]
v_fmac_f32 v154,v212,v213
v_fmac_f32 v155,v214,v215
v_mfma_f32_16x16x32_bf16 v[124:127],a[172:175],v[172:175],v[124:127]
s_waitcnt lgkmcnt(0)
v_rcp_f32 v154,v154
v_mfma_f32_16x16x32_bf16 v[136:139],a[112:115],a[96:99],v[204:207]
v_rcp_f32 v155,v155
v_mfma_f32_16x16x32_bf16 v[136:139],a[116:119],a[100:103],v[136:139]
v_mul_f32 v208,v208,v154
v_mul_f32 v210,v210,v155
v_mfma_f32_16x16x32_bf16 v[136:139],a[120:123],a[104:107],v[136:139]
v_mul_f32 v212,v212,v154
v_mul_f32 v214,v214,v155
v_mfma_f32_16x16x32_bf16 v[136:139],a[124:127],a[108:111],v[136:139]
v_mul_f32 v240,v240,v208
v_mul_f32 v241,v241,v208
v_mfma_f32_16x16x32_bf16 v[140:143],a[128:131],a[108:111],v[204:207]
v_exp_f32 v132,v132
v_mfma_f32_16x16x32_bf16 v[140:143],a[132:135],a[104:107],v[140:143]
v_mul_f32 v242,v242,v208
v_mul_f32 v243,v243,v208
v_mfma_f32_16x16x32_bf16 v[140:143],a[136:139],a[100:103],v[140:143]
v_exp_f32 v133,v133
v_mfma_f32_16x16x32_bf16 v[140:143],a[140:143],a[96:99],v[140:143]
v_mul_f32 v244,v244,v208
v_mul_f32 v245,v245,v208
v_mfma_f32_16x16x32_bf16 v[148:151],a[140:143],a[192:195],v[188:191]
v_exp_f32 v134,v134
v_mfma_f32_16x16x32_bf16 v[148:151],a[136:139],a[196:199],v[148:151]
buffer_load_dwordx4 v227,s[20:23],s34 offen offset:2048 nt lds
v_mfma_f32_16x16x32_bf16 v[148:151],a[132:135],a[200:203],v[148:151]
v_mul_f32 v246,v246,v208
v_mul_f32 v247,v247,v208
v_mfma_f32_16x16x32_bf16 v[148:151],a[128:131],a[204:207],v[148:151]
v_exp_f32 v135,v135
v_mfma_f32_16x16x32_bf16 v[144:147],a[124:127],a[204:207],v[188:191]
P191:
s_cbranch_execz P319
v_mfma_f32_16x16x32_bf16 v[144:147],a[120:123],a[200:203],v[144:147]
v_fmac_f32 v240,v248,v212
v_fmac_f32 v241,v249,v212
v_mfma_f32_16x16x32_bf16 v[144:147],a[116:119],a[196:199],v[144:147]
v_cvt_pk_bf16_f32 v182,v132,v133
v_fmac_f32 v242,v250,v212
v_mfma_f32_16x16x32_bf16 v[144:147],a[112:115],a[192:195],v[144:147]
v_cvt_pk_bf16_f32 v183,v134,v135
v_fmac_f32 v243,v251,v212
v_mfma_f32_16x16x32_bf16 v[0:3],a[144:147],v[176:179],v[0:3]
v_fmac_f32 v244,v252,v212
v_fmac_f32 v245,v253,v212
v_mfma_f32_16x16x32_bf16 v[4:7],a[148:151],v[176:179],v[4:7]
v_exp_f32 v128,v128
v_mfma_f32_16x16x32_bf16 v[8:11],a[152:155],v[176:179],v[8:11]
v_fmac_f32 v246,v254,v212
v_fmac_f32 v247,v255,v212
v_mfma_f32_16x16x32_bf16 v[12:15],a[156:159],v[176:179],v[12:15]
v_exp_f32 v129,v129
v_mfma_f32_16x16x32_bf16 v[16:19],a[160:163],v[176:179],v[16:19]
ds_read_b128 v[248:251],v152 offset:18432
ds_read_b128 v[252:255],v153 offset:18432
v_mfma_f32_16x16x32_bf16 v[20:23],a[164:167],v[176:179],v[20:23]
v_exp_f32 v130,v130
v_mfma_f32_16x16x32_bf16 v[24:27],a[168:171],v[176:179],v[24:27]
v_cvt_pk_bf16_f32 v240,v240,v241
v_exp_f32 v131,v131
v_cvt_pk_bf16_f32 v241,v242,v243
v_mfma_f32_16x16x32_bf16 v[28:31],a[172:175],v[176:179],v[28:31]
v_cvt_pk_bf16_f32 v242,v244,v245
v_cvt_pk_bf16_f32 v180,v128,v129
v_cvt_pk_bf16_f32 v243,v246,v247
v_mfma_f32_16x16x32_bf16 v[216:219],a[184:187],v[176:179],v[216:219]
v_cvt_pk_bf16_f32 v181,v130,v131
v_xor_b32 v225,0x800,v225
s_nop 0
v_mfma_f32_16x16x32_bf16 v[216:219],a[188:191],v[180:183],v[216:219]
v_xor_b32 v226,0x800,v226
v_xor_b32 v224,0x18800,v224
v_mfma_f32_16x16x32_bf16 v[32:35],a[144:147],v[180:183],v[32:35]
P192:
s_cbranch_execz P320
v_mfma_f32_16x16x32_bf16 v[36:39],a[148:151],v[180:183],v[36:39]
ds_read_b64_tr_b16 a[144:145],v225
ds_read_b64_tr_b16 a[146:147],v225 offset:1024
v_mfma_f32_16x16x32_bf16 v[40:43],a[152:155],v[180:183],v[40:43]
buffer_load_dwordx4 v227,s[20:23],s34 offen offset:3072 nt lds
v_mfma_f32_16x16x32_bf16 v[44:47],a[156:159],v[180:183],v[44:47]
ds_read_b64_tr_b16 a[148:149],v226
ds_read_b64_tr_b16 a[150:151],v226 offset:1024
v_mfma_f32_16x16x32_bf16 v[48:51],a[160:163],v[180:183],v[48:51]
v_exp_f32 v136,v136
v_mfma_f32_16x16x32_bf16 v[52:55],a[164:167],v[180:183],v[52:55]
v_exp_f32 v137,v137
v_mfma_f32_16x16x32_bf16 v[56:59],a[168:171],v[180:183],v[56:59]
v_exp_f32 v138,v138
v_mfma_f32_16x16x32_bf16 v[60:63],a[172:175],v[180:183],v[60:63]
ds_read_b64_tr_b16 a[152:153],v225 offset:256
ds_read_b64_tr_b16 a[154:155],v225 offset:1280
buffer_store_dwordx4 v[240:243],v228,s[24:27],s76 offen nt
v_mfma_f32_16x16x32_bf16 v[128:131],a[112:115],a[208:211],v[192:195]
ds_read_b128 v[244:247],v153 offset:2048
v_exp_f32 v139,v139
v_mfma_f32_16x16x32_bf16 v[128:131],a[116:119],a[212:215],v[128:131]
ds_read_b128 v[240:243],v152 offset:2048
ds_read_b64_tr_b16 a[156:157],v226 offset:256
v_cvt_pk_bf16_f32 v184,v136,v137
v_cvt_pk_bf16_f32 v185,v138,v139
s_waitcnt lgkmcnt(5)
v_mul_f32 v248,v248,v214
v_mfma_f32_16x16x32_bf16 v[128:131],a[120:123],a[216:219],v[128:131]
ds_read_b64_tr_b16 a[158:159],v226 offset:1280
v_mul_f32 v249,v249,v214
v_exp_f32 v140,v140
v_mul_f32 v250,v250,v214
v_mfma_f32_16x16x32_bf16 v[128:131],a[124:127],a[220:223],v[128:131]
v_mul_f32 v251,v251,v214
v_exp_f32 v141,v141
v_mul_f32 v252,v252,v214
v_mfma_f32_16x16x32_bf16 v[132:135],a[128:131],a[220:223],v[192:195]
ds_read_b64_tr_b16 a[160:161],v225 offset:512
ds_read_b64_tr_b16 a[162:163],v225 offset:1536
P193:
s_cbranch_execz P321
v_mul_f32 v253,v253,v214
v_exp_f32 v142,v142
v_mul_f32 v254,v254,v214
v_mfma_f32_16x16x32_bf16 v[132:135],a[132:135],a[216:219],v[132:135]
v_mul_f32 v255,v255,v214
v_exp_f32 v143,v143
s_waitcnt lgkmcnt(5)
v_fmac_f32 v252,v244,v210
v_mfma_f32_16x16x32_bf16 v[132:135],a[136:139],a[212:215],v[132:135]
ds_read_b64_tr_b16 a[164:165],v226 offset:512
v_fmac_f32 v253,v245,v210
v_cvt_pk_bf16_f32 v186,v140,v141
v_fmac_f32 v254,v246,v210
v_mfma_f32_16x16x32_bf16 v[132:135],a[140:143],a[208:211],v[132:135]
ds_read_b64_tr_b16 a[166:167],v226 offset:1536
v_cvt_pk_bf16_f32 v187,v142,v143
v_fmac_f32 v255,v247,v210
s_waitcnt lgkmcnt(5)
v_fmac_f32 v248,v240,v210
v_mfma_f32_16x16x32_bf16 v[140:143],a[140:143],a[224:227],v[196:199]
v_fmac_f32 v249,v241,v210
v_fmac_f32 v250,v242,v210
v_mfma_f32_16x16x32_bf16 v[140:143],a[136:139],a[228:231],v[140:143]
ds_read_b64_tr_b16 a[168:169],v225 offset:768
ds_read_b64_tr_b16 a[170:171],v225 offset:1792
v_fmac_f32 v251,v243,v210
v_cvt_pk_bf16_f32 v240,v248,v249
v_mfma_f32_16x16x32_bf16 v[140:143],a[132:135],a[232:235],v[140:143]
v_cvt_pk_bf16_f32 v241,v250,v251
v_cvt_pk_bf16_f32 v242,v252,v253
v_mfma_f32_16x16x32_bf16 v[140:143],a[128:131],a[236:239],v[140:143]
ds_read_b64_tr_b16 a[172:173],v226 offset:768
v_cvt_pk_bf16_f32 v243,v254,v255
v_mfma_f32_16x16x32_bf16 v[136:139],a[124:127],a[236:239],v[196:199]
ds_read_b64_tr_b16 a[174:175],v226 offset:1792
v_xor_b32 v225,0x10800,v225
v_mfma_f32_16x16x32_bf16 v[136:139],a[120:123],a[232:235],v[136:139]
P194:
s_cbranch_execz P322
v_mfma_f32_16x16x32_bf16 v[136:139],a[116:119],a[228:231],v[136:139]
v_exp_f32 v148,v148
v_mfma_f32_16x16x32_bf16 v[136:139],a[112:115],a[224:227],v[136:139]
v_exp_f32 v149,v149
v_mfma_f32_16x16x32_bf16 a[0:3],a[144:147],v[184:187],a[0:3]
v_exp_f32 v150,v150
v_mfma_f32_16x16x32_bf16 a[4:7],a[148:151],v[184:187],a[4:7]
v_exp_f32 v151,v151
v_mfma_f32_16x16x32_bf16 a[8:11],a[152:155],v[184:187],a[8:11]
s_waitcnt lgkmcnt(0)
s_add_u32 m0,s30,49152
v_cvt_pk_bf16_f32 v170,v148,v149
v_cvt_pk_bf16_f32 v171,v150,v151
v_mfma_f32_16x16x32_bf16 a[12:15],a[156:159],v[184:187],a[12:15]
v_exp_f32 v144,v144
v_mfma_f32_16x16x32_bf16 a[16:19],a[160:163],v[184:187],a[16:19]
v_exp_f32 v145,v145
v_mfma_f32_16x16x32_bf16 a[20:23],a[164:167],v[184:187],a[20:23]
buffer_store_dwordx4 v[240:243],v228,s[24:27],s76 offen offset:1024 nt
v_exp_f32 v146,v146
v_mfma_f32_16x16x32_bf16 a[24:27],a[168:171],v[184:187],a[24:27]
s_waitcnt vmcnt(10) lgkmcnt(0)
s_barrier
v_exp_f32 v147,v147
v_mfma_f32_16x16x32_bf16 a[28:31],a[172:175],v[184:187],a[28:31]
v_accvgpr_read_b32 v240,a32
v_cvt_pk_bf16_f32 v168,v144,v145
v_mfma_f32_16x16x32_bf16 v[220:223],a[176:179],v[184:187],v[220:223]
v_cvt_pk_bf16_f32 v169,v146,v147
v_accvgpr_read_b32 v241,a33
s_nop 0
v_mfma_f32_16x16x32_bf16 v[216:219],a[176:179],v[168:171],v[216:219]
s_mov_b32 s34,344064
s_add_u32 s76,s76,73728
v_accvgpr_read_b32 v242,a34
v_mfma_f32_16x16x32_bf16 v[64:67],a[144:147],v[168:171],v[64:67]
v_accvgpr_read_b32 v243,a35
v_accvgpr_read_b32 v244,a36
v_mfma_f32_16x16x32_bf16 v[68:71],a[148:151],v[168:171],v[68:71]
P195:
s_cbranch_execz P323
v_accvgpr_read_b32 v245,a37
v_mfma_f32_16x16x32_bf16 v[72:75],a[152:155],v[168:171],v[72:75]
buffer_load_dwordx4 v227,s[16:19],s34 offen nt lds
v_accvgpr_read_b32 v246,a38
v_mfma_f32_16x16x32_bf16 v[76:79],a[156:159],v[168:171],v[76:79]
v_exp_f32 v128,v128
v_accvgpr_read_b32 v247,a39
v_mfma_f32_16x16x32_bf16 v[80:83],a[160:163],v[168:171],v[80:83]
v_exp_f32 v129,v129
v_mul_f32 v240,v240,v162
v_mfma_f32_16x16x32_bf16 v[84:87],a[164:167],v[168:171],v[84:87]
v_exp_f32 v130,v130
v_mul_f32 v241,v241,v162
v_mul_f32 v242,v242,v162
v_mfma_f32_16x16x32_bf16 v[88:91],a[168:171],v[168:171],v[88:91]
v_exp_f32 v131,v131
v_mul_f32 v243,v243,v162
v_mfma_f32_16x16x32_bf16 v[92:95],a[172:175],v[168:171],v[92:95]
v_cvt_pk_bf16_f32 v172,v128,v129
v_mul_f32 v244,v244,v162
v_cvt_pk_bf16_f32 v173,v130,v131
v_mfma_f32_16x16x32_bf16 v[144:147],a[112:115],a[240:243],v[200:203]
v_mul_f32 v245,v245,v162
v_exp_f32 v132,v132
v_mfma_f32_16x16x32_bf16 v[144:147],a[116:119],a[244:247],v[144:147]
v_mul_f32 v246,v246,v162
v_exp_f32 v133,v133
v_mul_f32 v247,v247,v162
v_mfma_f32_16x16x32_bf16 v[144:147],a[120:123],a[248:251],v[144:147]
v_cvt_pk_bf16_f32 v240,v240,v241
v_exp_f32 v134,v134
v_mfma_f32_16x16x32_bf16 v[144:147],a[124:127],a[252:255],v[144:147]
v_cvt_pk_bf16_f32 v241,v242,v243
v_exp_f32 v135,v135
v_mfma_f32_16x16x32_bf16 v[148:151],a[128:131],a[252:255],v[200:203]
v_cvt_pk_bf16_f32 v242,v244,v245
v_cvt_pk_bf16_f32 v174,v132,v133
v_mfma_f32_16x16x32_bf16 v[148:151],a[132:135],a[248:251],v[148:151]
v_cvt_pk_bf16_f32 v175,v134,v135
v_cvt_pk_bf16_f32 v243,v246,v247
v_mfma_f32_16x16x32_bf16 v[148:151],a[136:139],a[244:247],v[148:151]
P196:
s_cbranch_execz P324
v_exp_f32 v140,v140
v_accvgpr_read_b32 v248,a40
v_accvgpr_read_b32 v249,a41
v_mfma_f32_16x16x32_bf16 v[148:151],a[140:143],a[240:243],v[148:151]
v_exp_f32 v141,v141
v_accvgpr_read_b32 v250,a42
v_mfma_f32_16x16x32_bf16 v[96:99],a[144:147],v[172:175],v[96:99]
v_exp_f32 v142,v142
v_accvgpr_read_b32 v251,a43
v_mfma_f32_16x16x32_bf16 v[100:103],a[148:151],v[172:175],v[100:103]
v_exp_f32 v143,v143
v_accvgpr_read_b32 v252,a44
v_mfma_f32_16x16x32_bf16 v[104:107],a[152:155],v[172:175],v[104:107]
v_cvt_pk_bf16_f32 v178,v140,v141
v_accvgpr_read_b32 v253,a45
v_cvt_pk_bf16_f32 v179,v142,v143
v_accvgpr_read_b32 v254,a46
v_mfma_f32_16x16x32_bf16 v[108:111],a[156:159],v[172:175],v[108:111]
buffer_load_dwordx4 v227,s[16:19],s34 offen offset:1024 nt lds
v_accvgpr_read_b32 v255,a47
v_exp_f32 v136,v136
v_mfma_f32_16x16x32_bf16 v[112:115],a[160:163],v[172:175],v[112:115]
v_mul_f32 v248,v248,v162
v_exp_f32 v137,v137
v_mfma_f32_16x16x32_bf16 v[116:119],a[164:167],v[172:175],v[116:119]
ds_read_b128 a[112:115],v224
v_mul_f32 v249,v249,v162
v_exp_f32 v138,v138
v_mfma_f32_16x16x32_bf16 v[120:123],a[168:171],v[172:175],v[120:123]
ds_read_b128 a[116:119],v224 offset:256
v_mul_f32 v250,v250,v162
v_exp_f32 v139,v139
v_mfma_f32_16x16x32_bf16 v[124:127],a[172:175],v[172:175],v[124:127]
v_mul_f32 v251,v251,v162
v_cvt_pk_bf16_f32 v176,v136,v137
v_mul_f32 v252,v252,v162
v_mfma_f32_16x16x32_bf16 v[216:219],a[180:183],v[172:175],v[216:219]
P197:
s_cbranch_execz P325
ds_read_b128 a[120:123],v224 offset:512
ds_read_b128 a[124:127],v224 offset:768
v_cvt_pk_bf16_f32 v177,v138,v139
v_mul_f32 v253,v253,v162
v_mul_f32 v254,v254,v162
v_mfma_f32_16x16x32_bf16 v[216:219],a[184:187],v[176:179],v[216:219]
v_mul_f32 v255,v255,v162
v_xor_b32 v226,0x10800,v226
v_mfma_f32_16x16x32_bf16 v[0:3],a[144:147],v[176:179],v[0:3]
ds_read_b128 a[128:131],v224 offset:1792
v_permlane16_swap_b32 v240,v242
v_mfma_f32_16x16x32_bf16 v[4:7],a[148:151],v[176:179],v[4:7]
ds_read_b128 a[132:135],v224 offset:1536
v_permlane16_swap_b32 v241,v243
v_mfma_f32_16x16x32_bf16 v[8:11],a[152:155],v[176:179],v[8:11]
ds_write_b128 v233,v[240:243]
v_mfma_f32_16x16x32_bf16 v[12:15],a[156:159],v[176:179],v[12:15]
ds_read_b128 a[136:139],v224 offset:1280
v_cvt_pk_bf16_f32 v248,v248,v249
v_mfma_f32_16x16x32_bf16 v[16:19],a[160:163],v[176:179],v[16:19]
ds_read_b128 a[140:143],v224 offset:1024
v_cvt_pk_bf16_f32 v249,v250,v251
v_mfma_f32_16x16x32_bf16 v[20:23],a[164:167],v[176:179],v[20:23]
v_cvt_pk_bf16_f32 v250,v252,v253
v_cvt_pk_bf16_f32 v251,v254,v255
v_mfma_f32_16x16x32_bf16 v[24:27],a[168:171],v[176:179],v[24:27]
v_accvgpr_read_b32 v240,a48
v_accvgpr_read_b32 v241,a49
v_mfma_f32_16x16x32_bf16 v[28:31],a[172:175],v[176:179],v[28:31]
s_waitcnt lgkmcnt(3)
P198:
s_cbranch_execz P326
v_mfma_f32_16x16x32_bf16 v[128:131],a[112:115],a[192:195],v[188:191]
v_accvgpr_read_b32 v242,a50
v_accvgpr_read_b32 v243,a51
v_mfma_f32_16x16x32_bf16 v[128:131],a[116:119],a[196:199],v[128:131]
v_accvgpr_read_b32 v244,a52
v_accvgpr_read_b32 v245,a53
v_mfma_f32_16x16x32_bf16 v[128:131],a[120:123],a[200:203],v[128:131]
buffer_load_dwordx4 v227,s[16:19],s34 offen offset:2048 nt lds
v_mfma_f32_16x16x32_bf16 v[128:131],a[124:127],a[204:207],v[128:131]
v_accvgpr_read_b32 v246,a54
v_accvgpr_read_b32 v247,a55
v_mfma_f32_16x16x32_bf16 v[132:135],a[128:131],a[204:207],v[188:191]
v_exp_f32 v144,v144
v_mfma_f32_16x16x32_bf16 v[132:135],a[132:135],a[200:203],v[132:135]
s_waitcnt lgkmcnt(0)
v_mul_f32 v240,v240,v162
v_mul_f32 v241,v241,v162
v_mfma_f32_16x16x32_bf16 v[132:135],a[136:139],a[196:199],v[132:135]
v_exp_f32 v145,v145
v_mfma_f32_16x16x32_bf16 v[132:135],a[140:143],a[192:195],v[132:135]
v_exp_f32 v146,v146
v_mul_f32 v242,v242,v162
v_mul_f32 v243,v243,v162
v_mfma_f32_16x16x32_bf16 v[140:143],a[140:143],a[208:211],v[192:195]
v_exp_f32 v147,v147
v_mul_f32 v244,v244,v162
v_mfma_f32_16x16x32_bf16 v[140:143],a[136:139],a[212:215],v[140:143]
v_cvt_pk_bf16_f32 v180,v144,v145
v_mul_f32 v245,v245,v162
v_cvt_pk_bf16_f32 v181,v146,v147
v_mul_f32 v246,v246,v162
v_mfma_f32_16x16x32_bf16 v[140:143],a[132:135],a[216:219],v[140:143]
v_mul_f32 v247,v247,v162
v_exp_f32 v148,v148
v_mfma_f32_16x16x32_bf16 v[140:143],a[128:131],a[220:223],v[140:143]
v_permlane16_swap_b32 v248,v250
v_exp_f32 v149,v149
v_mfma_f32_16x16x32_bf16 v[136:139],a[124:127],a[220:223],v[192:195]
v_permlane16_swap_b32 v249,v251
v_exp_f32 v150,v150
v_mfma_f32_16x16x32_bf16 v[136:139],a[120:123],a[216:219],v[136:139]
ds_write_b128 v234,v[248:251]
v_exp_f32 v151,v151
v_mfma_f32_16x16x32_bf16 v[136:139],a[116:119],a[212:215],v[136:139]
v_cvt_pk_bf16_f32 v240,v240,v241
v_cvt_pk_bf16_f32 v182,v148,v149
v_mfma_f32_16x16x32_bf16 v[136:139],a[112:115],a[208:211],v[136:139]
P199:
s_cbranch_execz P327
v_cvt_pk_bf16_f32 v183,v150,v151
v_cvt_pk_bf16_f32 v241,v242,v243
s_nop 0
v_mfma_f32_16x16x32_bf16 v[216:219],a[188:191],v[180:183],v[216:219]
v_cvt_pk_bf16_f32 v242,v244,v245
v_cvt_pk_bf16_f32 v243,v246,v247
v_mfma_f32_16x16x32_bf16 v[32:35],a[144:147],v[180:183],v[32:35]
ds_read_b64_tr_b16 a[144:145],v225
v_accvgpr_read_b32 v248,a56
v_mfma_f32_16x16x32_bf16 v[36:39],a[148:151],v[180:183],v[36:39]
ds_read_b64_tr_b16 a[146:147],v225 offset:1024
v_accvgpr_read_b32 v249,a57
v_mfma_f32_16x16x32_bf16 v[40:43],a[152:155],v[180:183],v[40:43]
buffer_load_dwordx4 v227,s[16:19],s34 offen offset:3072 nt lds
v_accvgpr_read_b32 v250,a58
v_mfma_f32_16x16x32_bf16 v[44:47],a[156:159],v[180:183],v[44:47]
ds_read_b64_tr_b16 a[148:149],v226
v_accvgpr_read_b32 v251,a59
v_mfma_f32_16x16x32_bf16 v[48:51],a[160:163],v[180:183],v[48:51]
ds_read_b64_tr_b16 a[150:151],v226 offset:1024
v_accvgpr_read_b32 v252,a60
v_accvgpr_read_b32 v253,a61
v_mfma_f32_16x16x32_bf16 v[52:55],a[164:167],v[180:183],v[52:55]
v_exp_f32 v128,v128
v_accvgpr_read_b32 v254,a62
v_mfma_f32_16x16x32_bf16 v[56:59],a[168:171],v[180:183],v[56:59]
v_exp_f32 v129,v129
v_accvgpr_read_b32 v255,a63
v_mfma_f32_16x16x32_bf16 v[60:63],a[172:175],v[180:183],v[60:63]
ds_read_b64_tr_b16 a[152:153],v225 offset:256
ds_read_b64_tr_b16 a[154:155],v225 offset:1280
P200:
s_cbranch_execz P328
v_exp_f32 v130,v130
v_mul_f32 v248,v248,v162
v_mfma_f32_16x16x32_bf16 v[144:147],a[112:115],a[224:227],v[196:199]
v_exp_f32 v131,v131
v_mul_f32 v249,v249,v162
v_mfma_f32_16x16x32_bf16 v[144:147],a[116:119],a[228:231],v[144:147]
ds_read_b64_tr_b16 a[156:157],v226 offset:256
v_cvt_pk_bf16_f32 v168,v128,v129
v_mul_f32 v250,v250,v162
v_cvt_pk_bf16_f32 v169,v130,v131
v_mul_f32 v251,v251,v162
v_mfma_f32_16x16x32_bf16 v[144:147],a[120:123],a[232:235],v[144:147]
ds_read_b64_tr_b16 a[158:159],v226 offset:1280
v_mul_f32 v252,v252,v162
v_exp_f32 v132,v132
v_mfma_f32_16x16x32_bf16 v[144:147],a[124:127],a[236:239],v[144:147]
v_mul_f32 v253,v253,v162
v_exp_f32 v133,v133
v_mul_f32 v254,v254,v162
v_mfma_f32_16x16x32_bf16 v[148:151],a[128:131],a[236:239],v[196:199]
ds_read_b64_tr_b16 a[160:161],v225 offset:512
ds_read_b64_tr_b16 a[162:163],v225 offset:1536
v_mul_f32 v255,v255,v162
v_exp_f32 v134,v134
v_mfma_f32_16x16x32_bf16 v[148:151],a[132:135],a[232:235],v[148:151]
v_permlane16_swap_b32 v240,v242
v_exp_f32 v135,v135
v_mfma_f32_16x16x32_bf16 v[148:151],a[136:139],a[228:231],v[148:151]
ds_read_b64_tr_b16 a[164:165],v226 offset:512
v_permlane16_swap_b32 v241,v243
v_cvt_pk_bf16_f32 v170,v132,v133
v_mfma_f32_16x16x32_bf16 v[148:151],a[140:143],a[224:227],v[148:151]
ds_read_b64_tr_b16 a[166:167],v226 offset:1536
ds_write_b128 v233,v[240:243] offset:128
v_cvt_pk_bf16_f32 v171,v134,v135
v_xor_b32 v224,0x800,v224
v_mfma_f32_16x16x32_bf16 v[132:135],a[140:143],a[240:243],v[200:203]
s_add_u32 m0,s30,65536
s_mov_b32 s34,344064
v_cvt_pk_bf16_f32 v248,v248,v249
v_mfma_f32_16x16x32_bf16 v[132:135],a[136:139],a[244:247],v[132:135]
P201:
s_cbranch_execz P329
ds_read_b64_tr_b16 a[168:169],v225 offset:768
ds_read_b64_tr_b16 a[170:171],v225 offset:1792
v_cvt_pk_bf16_f32 v249,v250,v251
v_cvt_pk_bf16_f32 v250,v252,v253
v_mfma_f32_16x16x32_bf16 v[132:135],a[132:135],a[248:251],v[132:135]
v_cvt_pk_bf16_f32 v251,v254,v255
v_mfma_f32_16x16x32_bf16 v[132:135],a[128:131],a[252:255],v[132:135]
buffer_load_dwordx4 v227,s[20:23],s34 offen nt lds
ds_read_b64_tr_b16 a[172:173],v226 offset:768
v_permlane16_swap_b32 v248,v250
v_mfma_f32_16x16x32_bf16 v[128:131],a[124:127],a[252:255],v[200:203]
ds_read_b64_tr_b16 a[174:175],v226 offset:1792
v_permlane16_swap_b32 v249,v251
v_mfma_f32_16x16x32_bf16 v[128:131],a[120:123],a[248:251],v[128:131]
ds_write_b128 v234,v[248:251] offset:128
v_mfma_f32_16x16x32_bf16 v[128:131],a[116:119],a[244:247],v[128:131]
v_exp_f32 v140,v140
v_accvgpr_read_b32 v240,a64
v_accvgpr_read_b32 v241,a65
v_mfma_f32_16x16x32_bf16 v[128:131],a[112:115],a[240:243],v[128:131]
s_waitcnt lgkmcnt(3)
v_exp_f32 v141,v141
v_accvgpr_read_b32 v242,a66
v_mfma_f32_16x16x32_bf16 v[64:67],a[144:147],v[168:171],v[64:67]
v_exp_f32 v142,v142
v_accvgpr_read_b32 v243,a67
v_mfma_f32_16x16x32_bf16 v[68:71],a[148:151],v[168:171],v[68:71]
v_exp_f32 v143,v143
v_accvgpr_read_b32 v244,a68
v_mfma_f32_16x16x32_bf16 v[72:75],a[152:155],v[168:171],v[72:75]
v_cvt_pk_bf16_f32 v174,v140,v141
v_accvgpr_read_b32 v245,a69
v_cvt_pk_bf16_f32 v175,v142,v143
v_mfma_f32_16x16x32_bf16 v[76:79],a[156:159],v[168:171],v[76:79]
P202:
s_cbranch_execz P330
v_accvgpr_read_b32 v246,a70
v_exp_f32 v136,v136
v_accvgpr_read_b32 v247,a71
v_mfma_f32_16x16x32_bf16 v[80:83],a[160:163],v[168:171],v[80:83]
v_mul_f32 v240,v240,v163
v_exp_f32 v137,v137
v_mfma_f32_16x16x32_bf16 v[84:87],a[164:167],v[168:171],v[84:87]
ds_read_b128 a[112:115],v224
v_mul_f32 v241,v241,v163
v_exp_f32 v138,v138
v_mfma_f32_16x16x32_bf16 v[88:91],a[168:171],v[168:171],v[88:91]
s_waitcnt lgkmcnt(1)
ds_read_b128 a[116:119],v224 offset:256
v_mul_f32 v242,v242,v163
v_exp_f32 v139,v139
v_mfma_f32_16x16x32_bf16 v[92:95],a[172:175],v[168:171],v[92:95]
v_mul_f32 v243,v243,v163
v_cvt_pk_bf16_f32 v172,v136,v137
v_mul_f32 v244,v244,v163
v_mfma_f32_16x16x32_bf16 v[216:219],a[176:179],v[168:171],v[216:219]
ds_read_b128 a[120:123],v224 offset:512
ds_read_b128 a[124:127],v224 offset:768
v_cvt_pk_bf16_f32 v173,v138,v139
v_mul_f32 v245,v245,v163
s_nop 0
v_mfma_f32_16x16x32_bf16 v[216:219],a[180:183],v[172:175],v[216:219]
v_mul_f32 v246,v246,v163
v_mul_f32 v247,v247,v163
v_mfma_f32_16x16x32_bf16 v[96:99],a[144:147],v[172:175],v[96:99]
ds_read_b128 a[128:131],v224 offset:1792
ds_read_b128 a[132:135],v224 offset:1536
v_mfma_f32_16x16x32_bf16 v[100:103],a[148:151],v[172:175],v[100:103]
v_cvt_pk_bf16_f32 v240,v240,v241
v_cvt_pk_bf16_f32 v241,v242,v243
v_mfma_f32_16x16x32_bf16 v[104:107],a[152:155],v[172:175],v[104:107]
buffer_load_dwordx4 v227,s[20:23],s34 offen offset:1024 nt lds
v_cvt_pk_bf16_f32 v242,v244,v245
v_mfma_f32_16x16x32_bf16 v[108:111],a[156:159],v[172:175],v[108:111]
P203:
s_cbranch_execz P331
Z12:
s_cbranch_execz Z16
ds_read_b128 a[136:139],v224 offset:1280
v_cvt_pk_bf16_f32 v243,v246,v247
v_mfma_f32_16x16x32_bf16 v[112:115],a[160:163],v[172:175],v[112:115]
ds_read_b128 a[140:143],v224 offset:1024
v_accvgpr_read_b32 v248,a72
v_mfma_f32_16x16x32_bf16 v[116:119],a[164:167],v[172:175],v[116:119]
v_exp_f32 v144,v144
v_accvgpr_read_b32 v249,a73
v_mfma_f32_16x16x32_bf16 v[120:123],a[168:171],v[172:175],v[120:123]
v_exp_f32 v145,v145
v_accvgpr_read_b32 v250,a74
v_mfma_f32_16x16x32_bf16 v[124:127],a[172:175],v[172:175],v[124:127]
s_waitcnt lgkmcnt(2)
v_exp_f32 v146,v146
v_accvgpr_read_b32 v251,a75
v_accvgpr_read_b32 v252,a76
v_mfma_f32_16x16x32_bf16 v[136:139],a[112:115],a[96:99],v[204:207]
v_exp_f32 v147,v147
v_accvgpr_read_b32 v253,a77
v_mfma_f32_16x16x32_bf16 v[136:139],a[116:119],a[100:103],v[136:139]
v_cvt_pk_bf16_f32 v176,v144,v145
v_accvgpr_read_b32 v254,a78
v_cvt_pk_bf16_f32 v177,v146,v147
v_mfma_f32_16x16x32_bf16 v[136:139],a[120:123],a[104:107],v[136:139]
v_accvgpr_read_b32 v255,a79
v_exp_f32 v148,v148
v_mfma_f32_16x16x32_bf16 v[136:139],a[124:127],a[108:111],v[136:139]
v_mul_f32 v248,v248,v163
v_exp_f32 v149,v149
v_mul_f32 v249,v249,v163
v_mfma_f32_16x16x32_bf16 v[140:143],a[128:131],a[108:111],v[204:207]
v_mul_f32 v250,v250,v163
v_exp_f32 v150,v150
v_mfma_f32_16x16x32_bf16 v[140:143],a[132:135],a[104:107],v[140:143]
s_waitcnt lgkmcnt(0)
v_mul_f32 v251,v251,v163
v_exp_f32 v151,v151
v_mfma_f32_16x16x32_bf16 v[140:143],a[136:139],a[100:103],v[140:143]
P204:
s_cbranch_execz L_back
v_mul_f32 v252,v252,v163
v_cvt_pk_bf16_f32 v178,v148,v149
v_mfma_f32_16x16x32_bf16 v[140:143],a[140:143],a[96:99],v[140:143]
v_cvt_pk_bf16_f32 v179,v150,v151
v_mul_f32 v253,v253,v163
v_mul_f32 v254,v254,v163
v_mfma_f32_16x16x32_bf16 v[148:151],a[140:143],a[192:195],v[188:191]
v_mul_f32 v255,v255,v163
v_xor_b32 v225,0x800,v225
v_mfma_f32_16x16x32_bf16 v[148:151],a[136:139],a[196:199],v[148:151]
v_permlane16_swap_b32 v240,v242
v_mfma_f32_16x16x32_bf16 v[148:151],a[132:135],a[200:203],v[148:151]
v_permlane16_swap_b32 v241,v243
v_mfma_f32_16x16x32_bf16 v[148:151],a[128:131],a[204:207],v[148:151]
ds_write_b128 v233,v[240:243] offset:16384
buffer_load_dwordx4 v227,s[20:23],s34 offen offset:2048 nt lds
v_mfma_f32_16x16x32_bf16 v[144:147],a[124:127],a[204:207],v[188:191]
v_cvt_pk_bf16_f32 v248,v248,v249
v_cvt_pk_bf16_f32 v249,v250,v251
v_mfma_f32_16x16x32_bf16 v[144:147],a[120:123],a[200:203],v[144:147]
v_cvt_pk_bf16_f32 v250,v252,v253
v_cvt_pk_bf16_f32 v251,v254,v255
v_mfma_f32_16x16x32_bf16 v[144:147],a[116:119],a[196:199],v[144:147]
v_exp_f32 v132,v132
v_mfma_f32_16x16x32_bf16 v[144:147],a[112:115],a[192:195],v[144:147]
v_exp_f32 v133,v133
v_accvgpr_read_b32 v240,a80
v_mfma_f32_16x16x32_bf16 v[0:3],a[144:147],v[176:179],v[0:3]
v_exp_f32 v134,v134
v_accvgpr_read_b32 v241,a81
v_mfma_f32_16x16x32_bf16 v[4:7],a[148:151],v[176:179],v[4:7]
v_exp_f32 v135,v135
v_accvgpr_read_b32 v242,a82
v_accvgpr_read_b32 v243,a83
v_mfma_f32_16x16x32_bf16 v[8:11],a[152:155],v[176:179],v[8:11]
v_cvt_pk_bf16_f32 v182,v132,v133
v_accvgpr_read_b32 v244,a84
P205:
s_cbranch_execz L_back
v_cvt_pk_bf16_f32 v183,v134,v135
v_mfma_f32_16x16x32_bf16 v[12:15],a[156:159],v[176:179],v[12:15]
v_accvgpr_read_b32 v245,a85
v_exp_f32 v128,v128
v_mfma_f32_16x16x32_bf16 v[16:19],a[160:163],v[176:179],v[16:19]
v_accvgpr_read_b32 v246,a86
v_exp_f32 v129,v129
v_mfma_f32_16x16x32_bf16 v[20:23],a[164:167],v[176:179],v[20:23]
v_accvgpr_read_b32 v247,a87
v_exp_f32 v130,v130
v_mul_f32 v240,v240,v163
v_mfma_f32_16x16x32_bf16 v[24:27],a[168:171],v[176:179],v[24:27]
v_mul_f32 v241,v241,v163
v_exp_f32 v131,v131
v_mfma_f32_16x16x32_bf16 v[28:31],a[172:175],v[176:179],v[28:31]
v_mul_f32 v242,v242,v163
v_cvt_pk_bf16_f32 v180,v128,v129
v_mfma_f32_16x16x32_bf16 v[216:219],a[184:187],v[176:179],v[216:219]
v_cvt_pk_bf16_f32 v181,v130,v131
v_mul_f32 v243,v243,v163
s_nop 0
v_mfma_f32_16x16x32_bf16 v[216:219],a[188:191],v[180:183],v[216:219]
v_xor_b32 v226,0x800,v226
v_mul_f32 v244,v244,v163
v_mfma_f32_16x16x32_bf16 v[32:35],a[144:147],v[180:183],v[32:35]
ds_read_b64_tr_b16 a[144:145],v225
v_mul_f32 v245,v245,v163
v_mul_f32 v246,v246,v163
v_mfma_f32_16x16x32_bf16 v[36:39],a[148:151],v[180:183],v[36:39]
ds_read_b64_tr_b16 a[146:147],v225 offset:1024
v_mul_f32 v247,v247,v163
v_mfma_f32_16x16x32_bf16 v[40:43],a[152:155],v[180:183],v[40:43]
buffer_load_dwordx4 v227,s[20:23],s34 offen offset:3072 nt lds
v_permlane16_swap_b32 v248,v250
v_mfma_f32_16x16x32_bf16 v[44:47],a[156:159],v[180:183],v[44:47]
v_permlane16_swap_b32 v249,v251
v_mfma_f32_16x16x32_bf16 v[48:51],a[160:163],v[180:183],v[48:51]
ds_write_b128 v234,v[248:251] offset:16384
ds_read_b64_tr_b16 a[148:149],v226
v_mfma_f32_16x16x32_bf16 v[52:55],a[164:167],v[180:183],v[52:55]
P206:
s_cbranch_execz L_back
ds_read_b64_tr_b16 a[150:151],v226 offset:1024
v_exp_f32 v136,v136
v_cvt_pk_bf16_f32 v240,v240,v241
v_cvt_pk_bf16_f32 v241,v242,v243
v_mfma_f32_16x16x32_bf16 v[56:59],a[168:171],v[180:183],v[56:59]
v_exp_f32 v137,v137
v_cvt_pk_bf16_f32 v242,v244,v245
v_mfma_f32_16x16x32_bf16 v[60:63],a[172:175],v[180:183],v[60:63]
ds_read_b64_tr_b16 a[152:153],v225 offset:256
ds_read_b64_tr_b16 a[154:155],v225 offset:1280
v_exp_f32 v138,v138
v_cvt_pk_bf16_f32 v243,v246,v247
v_mfma_f32_16x16x32_bf16 v[128:131],a[112:115],a[208:211],v[192:195]
v_exp_f32 v139,v139
v_accvgpr_read_b32 v248,a88
v_mfma_f32_16x16x32_bf16 v[128:131],a[116:119],a[212:215],v[128:131]
ds_read_b64_tr_b16 a[156:157],v226 offset:256
v_cvt_pk_bf16_f32 v184,v136,v137
v_accvgpr_read_b32 v249,a89
v_cvt_pk_bf16_f32 v185,v138,v139
v_accvgpr_read_b32 v250,a90
v_mfma_f32_16x16x32_bf16 v[128:131],a[120:123],a[216:219],v[128:131]
ds_read_b64_tr_b16 a[158:159],v226 offset:1280
v_accvgpr_read_b32 v251,a91
v_exp_f32 v140,v140
v_mfma_f32_16x16x32_bf16 v[128:131],a[124:127],a[220:223],v[128:131]
v_accvgpr_read_b32 v252,a92
v_exp_f32 v141,v141
v_mfma_f32_16x16x32_bf16 v[132:135],a[128:131],a[220:223],v[192:195]
ds_read_b64_tr_b16 a[160:161],v225 offset:512
ds_read_b64_tr_b16 a[162:163],v225 offset:1536
v_accvgpr_read_b32 v253,a93
v_exp_f32 v142,v142
v_mfma_f32_16x16x32_bf16 v[132:135],a[132:135],a[216:219],v[132:135]
P207:
s_cbranch_execz L_back
v_accvgpr_read_b32 v254,a94
v_exp_f32 v143,v143
v_mfma_f32_16x16x32_bf16 v[132:135],a[136:139],a[212:215],v[132:135]
ds_read_b64_tr_b16 a[164:165],v226 offset:512
v_accvgpr_read_b32 v255,a95
v_cvt_pk_bf16_f32 v186,v140,v141
v_mul_f32 v248,v248,v163
v_mfma_f32_16x16x32_bf16 v[132:135],a[140:143],a[208:211],v[132:135]
ds_read_b64_tr_b16 a[166:167],v226 offset:1536
v_cvt_pk_bf16_f32 v187,v142,v143
v_mul_f32 v249,v249,v163
v_mfma_f32_16x16x32_bf16 v[140:143],a[140:143],a[224:227],v[196:199]
v_mul_f32 v250,v250,v163
v_mul_f32 v251,v251,v163
v_mfma_f32_16x16x32_bf16 v[140:143],a[136:139],a[228:231],v[140:143]
ds_read_b64_tr_b16 a[168:169],v225 offset:768
ds_read_b64_tr_b16 a[170:171],v225 offset:1792
v_mfma_f32_16x16x32_bf16 v[140:143],a[132:135],a[232:235],v[140:143]
v_mul_f32 v252,v252,v163
v_mul_f32 v253,v253,v163
v_mfma_f32_16x16x32_bf16 v[140:143],a[128:131],a[236:239],v[140:143]
ds_read_b64_tr_b16 a[172:173],v226 offset:768
v_mul_f32 v254,v254,v163
v_mul_f32 v255,v255,v163
v_mfma_f32_16x16x32_bf16 v[136:139],a[124:127],a[236:239],v[196:199]
ds_read_b64_tr_b16 a[174:175],v226 offset:1792
v_permlane16_swap_b32 v240,v242
v_mfma_f32_16x16x32_bf16 v[136:139],a[120:123],a[232:235],v[136:139]
v_permlane16_swap_b32 v241,v243
v_mfma_f32_16x16x32_bf16 v[136:139],a[116:119],a[228:231],v[136:139]
ds_write_b128 v233,v[240:243] offset:16512
v_exp_f32 v148,v148
v_mfma_f32_16x16x32_bf16 v[136:139],a[112:115],a[224:227],v[136:139]
s_waitcnt lgkmcnt(3)
v_exp_f32 v149,v149
v_cvt_pk_bf16_f32 v248,v248,v249
v_mfma_f32_16x16x32_bf16 a[0:3],a[144:147],v[184:187],a[0:3]
v_exp_f32 v150,v150
v_cvt_pk_bf16_f32 v249,v250,v251
v_mfma_f32_16x16x32_bf16 a[4:7],a[148:151],v[184:187],a[4:7]
P208:
s_cbranch_execz L_back
v_exp_f32 v151,v151
v_cvt_pk_bf16_f32 v250,v252,v253
v_mfma_f32_16x16x32_bf16 a[8:11],a[152:155],v[184:187],a[8:11]
v_cvt_pk_bf16_f32 v170,v148,v149
v_cvt_pk_bf16_f32 v251,v254,v255
v_cvt_pk_bf16_f32 v171,v150,v151
v_mfma_f32_16x16x32_bf16 a[12:15],a[156:159],v[184:187],a[12:15]
v_permlane16_swap_b32 v248,v250
v_exp_f32 v144,v144
v_mfma_f32_16x16x32_bf16 a[16:19],a[160:163],v[184:187],a[16:19]
v_permlane16_swap_b32 v249,v251
v_exp_f32 v145,v145
v_mfma_f32_16x16x32_bf16 a[20:23],a[164:167],v[184:187],a[20:23]
ds_write_b128 v234,v[248:251] offset:16512
v_exp_f32 v146,v146
v_mfma_f32_16x16x32_bf16 a[24:27],a[168:171],v[184:187],a[24:27]
s_waitcnt vmcnt(10) lgkmcnt(0)
s_barrier
v_exp_f32 v147,v147
v_mfma_f32_16x16x32_bf16 a[28:31],a[172:175],v[184:187],a[28:31]
s_add_u32 m0,s30,81920
s_mov_b32 s34,360448
v_cvt_pk_bf16_f32 v168,v144,v145
v_mfma_f32_16x16x32_bf16 v[220:223],a[176:179],v[184:187],v[220:223]
v_cvt_pk_bf16_f32 v169,v146,v147
v_xor_b32 v224,0x10800,v224
s_nop 0
v_mfma_f32_16x16x32_bf16 v[216:219],a[176:179],v[168:171],v[216:219]
v_exp_f32 v128,v128
v_mfma_f32_16x16x32_bf16 v[64:67],a[144:147],v[168:171],v[64:67]
buffer_load_dwordx4 v227,s[16:19],s34 offen nt lds
v_mfma_f32_16x16x32_bf16 v[68:71],a[148:151],v[168:171],v[68:71]
P209:
s_cbranch_execz L_back
v_mfma_f32_16x16x32_bf16 v[72:75],a[152:155],v[168:171],v[72:75]
v_exp_f32 v129,v129
v_mfma_f32_16x16x32_bf16 v[76:79],a[156:159],v[168:171],v[76:79]
v_exp_f32 v130,v130
v_mfma_f32_16x16x32_bf16 v[80:83],a[160:163],v[168:171],v[80:83]
v_exp_f32 v131,v131
v_mfma_f32_16x16x32_bf16 v[84:87],a[164:167],v[168:171],v[84:87]
v_cvt_pk_bf16_f32 v172,v128,v129
v_cvt_pk_bf16_f32 v173,v130,v131
v_mfma_f32_16x16x32_bf16 v[88:91],a[168:171],v[168:171],v[88:91]
v_exp_f32 v132,v132
v_mfma_f32_16x16x32_bf16 v[92:95],a[172:175],v[168:171],v[92:95]
v_exp_f32 v133,v133
v_mfma_f32_16x16x32_bf16 v[144:147],a[112:115],a[240:243],v[200:203]
v_exp_f32 v134,v134
v_mfma_f32_16x16x32_bf16 v[144:147],a[116:119],a[244:247],v[144:147]
v_exp_f32 v135,v135
v_mfma_f32_16x16x32_bf16 v[144:147],a[120:123],a[248:251],v[144:147]
ds_read_b128 a[112:115],v224
v_cvt_pk_bf16_f32 v174,v132,v133
v_mfma_f32_16x16x32_bf16 v[144:147],a[124:127],a[252:255],v[144:147]
ds_read_b128 a[116:119],v224 offset:256
v_cvt_pk_bf16_f32 v175,v134,v135
v_mfma_f32_16x16x32_bf16 v[148:151],a[128:131],a[252:255],v[200:203]
v_exp_f32 v140,v140
v_mfma_f32_16x16x32_bf16 v[148:151],a[132:135],a[248:251],v[148:151]
v_exp_f32 v141,v141
v_mfma_f32_16x16x32_bf16 v[148:151],a[136:139],a[244:247],v[148:151]
v_exp_f32 v142,v142
v_mfma_f32_16x16x32_bf16 v[148:151],a[140:143],a[240:243],v[148:151]
v_exp_f32 v143,v143
v_mfma_f32_16x16x32_bf16 v[96:99],a[144:147],v[172:175],v[96:99]
ds_read_b128 a[120:123],v224 offset:512
v_cvt_pk_bf16_f32 v178,v140,v141
v_mfma_f32_16x16x32_bf16 v[100:103],a[148:151],v[172:175],v[100:103]
buffer_load_dwordx4 v227,s[16:19],s34 offen offset:1024 nt lds
v_mfma_f32_16x16x32_bf16 v[104:107],a[152:155],v[172:175],v[104:107]
ds_read_b128 a[124:127],v224 offset:768
v_cvt_pk_bf16_f32 v179,v142,v143
v_mfma_f32_16x16x32_bf16 v[108:111],a[156:159],v[172:175],v[108:111]
v_exp_f32 v136,v136
v_mfma_f32_16x16x32_bf16 v[112:115],a[160:163],v[172:175],v[112:115]
P210:
s_cbranch_execz L_back
v_exp_f32 v137,v137
v_mfma_f32_16x16x32_bf16 v[116:119],a[164:167],v[172:175],v[116:119]
v_exp_f32 v138,v138
v_mfma_f32_16x16x32_bf16 v[120:123],a[168:171],v[172:175],v[120:123]
v_exp_f32 v139,v139
v_mfma_f32_16x16x32_bf16 v[124:127],a[172:175],v[172:175],v[124:127]
ds_read_b128 a[128:131],v224 offset:1792
v_cvt_pk_bf16_f32 v176,v136,v137
v_mfma_f32_16x16x32_bf16 v[216:219],a[180:183],v[172:175],v[216:219]
ds_read_b128 a[132:135],v224 offset:1536
v_cvt_pk_bf16_f32 v177,v138,v139
s_nop 1
v_mfma_f32_16x16x32_bf16 v[216:219],a[184:187],v[176:179],v[216:219]
v_exp_f32 v144,v144
v_mfma_f32_16x16x32_bf16 v[0:3],a[144:147],v[176:179],v[0:3]
ds_read_b128 a[136:139],v224 offset:1280
ds_read_b128 a[140:143],v224 offset:1024
v_mfma_f32_16x16x32_bf16 v[4:7],a[148:151],v[176:179],v[4:7]
v_xor_b32 v224,0x800,v224
v_xor_b32 v225,0x8800,v225
v_mfma_f32_16x16x32_bf16 v[8:11],a[152:155],v[176:179],v[8:11]
ds_read_b128 a[32:35],v224
ds_read_b128 a[36:39],v224 offset:256
v_mfma_f32_16x16x32_bf16 v[12:15],a[156:159],v[176:179],v[12:15]
v_exp_f32 v145,v145
v_mfma_f32_16x16x32_bf16 v[16:19],a[160:163],v[176:179],v[16:19]
ds_read_b128 a[40:43],v224 offset:512
ds_read_b128 a[44:47],v224 offset:768
v_mfma_f32_16x16x32_bf16 v[20:23],a[164:167],v[176:179],v[20:23]
P211:
s_cbranch_execz L_back
v_mfma_f32_16x16x32_bf16 v[24:27],a[168:171],v[176:179],v[24:27]
buffer_load_dwordx4 v227,s[16:19],s34 offen offset:2048 nt lds
v_mfma_f32_16x16x32_bf16 v[28:31],a[172:175],v[176:179],v[28:31]
s_waitcnt lgkmcnt(4)
ds_read_b128 a[48:51],v224 offset:1792
ds_read_b128 a[52:55],v224 offset:1536
v_mfma_f32_16x16x32_bf16 v[128:131],a[112:115],a[192:195],v[188:191]
v_exp_f32 v146,v146
v_mfma_f32_16x16x32_bf16 v[128:131],a[116:119],a[196:199],v[128:131]
ds_read_b128 a[56:59],v224 offset:1280
ds_read_b128 a[60:63],v224 offset:1024
v_mfma_f32_16x16x32_bf16 v[128:131],a[120:123],a[200:203],v[128:131]
v_exp_f32 v147,v147
v_mfma_f32_16x16x32_bf16 v[128:131],a[124:127],a[204:207],v[128:131]
v_cvt_pk_bf16_f32 v180,v144,v145
v_cvt_pk_bf16_f32 v181,v146,v147
v_mfma_f32_16x16x32_bf16 v[132:135],a[128:131],a[204:207],v[188:191]
v_exp_f32 v148,v148
v_mfma_f32_16x16x32_bf16 v[132:135],a[132:135],a[200:203],v[132:135]
v_exp_f32 v149,v149
v_mfma_f32_16x16x32_bf16 v[132:135],a[136:139],a[196:199],v[132:135]
v_exp_f32 v150,v150
v_mfma_f32_16x16x32_bf16 v[132:135],a[140:143],a[192:195],v[132:135]
s_waitcnt lgkmcnt(0)
v_exp_f32 v151,v151
v_mfma_f32_16x16x32_bf16 v[136:139],a[32:35],a[192:195],v[188:191]
v_cvt_pk_bf16_f32 v182,v148,v149
v_cvt_pk_bf16_f32 v183,v150,v151
v_mfma_f32_16x16x32_bf16 v[136:139],a[36:39],a[196:199],v[136:139]
v_xor_b32 v226,0x8800,v226
v_xor_b32 v224,0x8800,v224
v_mfma_f32_16x16x32_bf16 v[136:139],a[40:43],a[200:203],v[136:139]
v_exp_f32 v128,v128
v_mfma_f32_16x16x32_bf16 v[136:139],a[44:47],a[204:207],v[136:139]
v_exp_f32 v129,v129
v_mfma_f32_16x16x32_bf16 v[140:143],a[48:51],a[204:207],v[188:191]
v_exp_f32 v130,v130
v_mfma_f32_16x16x32_bf16 v[140:143],a[52:55],a[200:203],v[140:143]
P212:
s_cbranch_execz L_back
v_mfma_f32_16x16x32_bf16 v[140:143],a[56:59],a[196:199],v[140:143]
buffer_load_dwordx4 v227,s[16:19],s34 offen offset:3072 nt lds
v_mfma_f32_16x16x32_bf16 v[140:143],a[60:63],a[192:195],v[140:143]
v_exp_f32 v131,v131
v_mfma_f32_16x16x32_bf16 v[216:219],a[188:191],v[180:183],v[216:219]
v_cvt_pk_bf16_f32 v168,v128,v129
v_cvt_pk_bf16_f32 v169,v130,v131
v_mfma_f32_16x16x32_bf16 v[32:35],a[144:147],v[180:183],v[32:35]
ds_read_b64_tr_b16 a[144:145],v225
ds_read_b64_tr_b16 a[146:147],v225 offset:1024
v_mfma_f32_16x16x32_bf16 v[36:39],a[148:151],v[180:183],v[36:39]
ds_read_b64_tr_b16 a[148:149],v226
ds_read_b64_tr_b16 a[150:151],v226 offset:1024
v_mfma_f32_16x16x32_bf16 v[40:43],a[152:155],v[180:183],v[40:43]
ds_read_b64_tr_b16 a[152:153],v225 offset:256
ds_read_b64_tr_b16 a[154:155],v225 offset:1280
v_mfma_f32_16x16x32_bf16 v[44:47],a[156:159],v[180:183],v[44:47]
ds_read_b64_tr_b16 a[156:157],v226 offset:256
ds_read_b64_tr_b16 a[158:159],v226 offset:1280
v_mfma_f32_16x16x32_bf16 v[48:51],a[160:163],v[180:183],v[48:51]
ds_read_b64_tr_b16 a[160:161],v225 offset:512
ds_read_b64_tr_b16 a[162:163],v225 offset:1536
v_mfma_f32_16x16x32_bf16 v[52:55],a[164:167],v[180:183],v[52:55]
ds_read_b64_tr_b16 a[164:165],v226 offset:512
ds_read_b64_tr_b16 a[166:167],v226 offset:1536
v_mfma_f32_16x16x32_bf16 v[56:59],a[168:171],v[180:183],v[56:59]
s_add_u32 m0,s30,0
v_exp_f32 v132,v132
v_mfma_f32_16x16x32_bf16 v[60:63],a[172:175],v[180:183],v[60:63]
ds_read_b64_tr_b16 a[168:169],v225 offset:768
ds_read_b64_tr_b16 a[170:171],v225 offset:1792
v_mfma_f32_16x16x32_bf16 v[144:147],a[112:115],a[208:211],v[192:195]
P213:
s_cbranch_execz L_back
v_mfma_f32_16x16x32_bf16 v[144:147],a[116:119],a[212:215],v[144:147]
ds_read_b64_tr_b16 a[172:173],v226 offset:768
v_exp_f32 v133,v133
v_mfma_f32_16x16x32_bf16 v[144:147],a[120:123],a[216:219],v[144:147]
ds_read_b64_tr_b16 a[174:175],v226 offset:1792
v_exp_f32 v134,v134
v_xor_b32 v225,0x800,v225
v_mfma_f32_16x16x32_bf16 v[144:147],a[124:127],a[220:223],v[144:147]
v_xor_b32 v226,0x800,v226
ds_read_b64_tr_b16 a[64:65],v225
v_exp_f32 v135,v135
v_mfma_f32_16x16x32_bf16 v[148:151],a[128:131],a[220:223],v[192:195]
ds_read_b64_tr_b16 a[66:67],v225 offset:1024
v_cvt_pk_bf16_f32 v170,v132,v133
v_mfma_f32_16x16x32_bf16 v[148:151],a[132:135],a[216:219],v[148:151]
s_mov_b32 s34,360448
v_cvt_pk_bf16_f32 v171,v134,v135
v_mfma_f32_16x16x32_bf16 v[148:151],a[136:139],a[212:215],v[148:151]
ds_read_b64_tr_b16 a[68:69],v226
ds_read_b64_tr_b16 a[70:71],v226 offset:1024
v_exp_f32 v136,v136
v_mfma_f32_16x16x32_bf16 v[148:151],a[140:143],a[208:211],v[148:151]
buffer_load_dwordx4 v227,s[20:23],s34 offen nt lds
v_exp_f32 v137,v137
v_mfma_f32_16x16x32_bf16 v[128:131],a[32:35],a[208:211],v[192:195]
ds_read_b64_tr_b16 a[72:73],v225 offset:256
v_exp_f32 v138,v138
v_mfma_f32_16x16x32_bf16 v[128:131],a[36:39],a[212:215],v[128:131]
ds_read_b64_tr_b16 a[74:75],v225 offset:1280
v_exp_f32 v139,v139
v_mfma_f32_16x16x32_bf16 v[128:131],a[40:43],a[216:219],v[128:131]
v_cvt_pk_bf16_f32 v172,v136,v137
v_cvt_pk_bf16_f32 v173,v138,v139
v_mfma_f32_16x16x32_bf16 v[128:131],a[44:47],a[220:223],v[128:131]
ds_read_b64_tr_b16 a[76:77],v226 offset:256
ds_read_b64_tr_b16 a[78:79],v226 offset:1280
v_exp_f32 v140,v140
v_mfma_f32_16x16x32_bf16 v[132:135],a[48:51],a[220:223],v[192:195]
v_exp_f32 v141,v141
v_mfma_f32_16x16x32_bf16 v[132:135],a[52:55],a[216:219],v[132:135]
ds_read_b64_tr_b16 a[80:81],v225 offset:512
v_exp_f32 v142,v142
v_mfma_f32_16x16x32_bf16 v[132:135],a[56:59],a[212:215],v[132:135]
P214:
s_cbranch_execz L_back
ds_read_b64_tr_b16 a[82:83],v225 offset:1536
v_exp_f32 v143,v143
v_mfma_f32_16x16x32_bf16 v[132:135],a[60:63],a[208:211],v[132:135]
v_cvt_pk_bf16_f32 v174,v140,v141
v_cvt_pk_bf16_f32 v175,v142,v143
v_mfma_f32_16x16x32_bf16 v[216:219],a[176:179],v[168:171],v[216:219]
ds_read_b64_tr_b16 a[84:85],v226 offset:512
ds_read_b64_tr_b16 a[86:87],v226 offset:1536
v_mfma_f32_16x16x32_bf16 v[216:219],a[176:179],v[172:175],v[216:219]
s_waitcnt lgkmcnt(4)
v_exp_f32 v144,v144
v_mfma_f32_16x16x32_bf16 v[64:67],a[64:67],v[172:175],v[64:67]
ds_read_b64_tr_b16 a[88:89],v225 offset:768
ds_read_b64_tr_b16 a[90:91],v225 offset:1792
v_mfma_f32_16x16x32_bf16 v[64:67],a[144:147],v[168:171],v[64:67]
v_exp_f32 v145,v145
v_mfma_f32_16x16x32_bf16 v[68:71],a[148:151],v[168:171],v[68:71]
ds_read_b64_tr_b16 a[92:93],v226 offset:768
ds_read_b64_tr_b16 a[94:95],v226 offset:1792
v_mfma_f32_16x16x32_bf16 v[68:71],a[68:71],v[172:175],v[68:71]
v_exp_f32 v146,v146
v_mfma_f32_16x16x32_bf16 v[72:75],a[72:75],v[172:175],v[72:75]
v_exp_f32 v147,v147
v_mfma_f32_16x16x32_bf16 v[72:75],a[152:155],v[168:171],v[72:75]
buffer_load_dwordx4 v227,s[20:23],s34 offen offset:1024 nt lds
v_mfma_f32_16x16x32_bf16 v[76:79],a[156:159],v[168:171],v[76:79]
v_cvt_pk_bf16_f32 v176,v144,v145
v_cvt_pk_bf16_f32 v177,v146,v147
v_mfma_f32_16x16x32_bf16 v[76:79],a[76:79],v[172:175],v[76:79]
s_waitcnt lgkmcnt(2)
P215:
s_cbranch_execz L_back
v_mfma_f32_16x16x32_bf16 v[80:83],a[80:83],v[172:175],v[80:83]
v_exp_f32 v148,v148
v_mfma_f32_16x16x32_bf16 v[80:83],a[160:163],v[168:171],v[80:83]
v_exp_f32 v149,v149
v_mfma_f32_16x16x32_bf16 v[84:87],a[164:167],v[168:171],v[84:87]
v_exp_f32 v150,v150
v_mfma_f32_16x16x32_bf16 v[84:87],a[84:87],v[172:175],v[84:87]
v_exp_f32 v151,v151
v_mfma_f32_16x16x32_bf16 v[88:91],a[88:91],v[172:175],v[88:91]
v_cvt_pk_bf16_f32 v178,v148,v149
v_cvt_pk_bf16_f32 v179,v150,v151
v_mfma_f32_16x16x32_bf16 v[88:91],a[168:171],v[168:171],v[88:91]
v_exp_f32 v128,v128
v_mfma_f32_16x16x32_bf16 v[92:95],a[172:175],v[168:171],v[92:95]
s_waitcnt lgkmcnt(0)
v_exp_f32 v129,v129
v_mfma_f32_16x16x32_bf16 v[92:95],a[92:95],v[172:175],v[92:95]
v_exp_f32 v130,v130
v_mfma_f32_16x16x32_bf16 v[136:139],a[32:35],a[96:99],v[204:207]
v_exp_f32 v131,v131
v_mfma_f32_16x16x32_bf16 v[136:139],a[36:39],a[100:103],v[136:139]
v_cvt_pk_bf16_f32 v180,v128,v129
v_cvt_pk_bf16_f32 v181,v130,v131
v_mfma_f32_16x16x32_bf16 v[136:139],a[40:43],a[104:107],v[136:139]
v_exp_f32 v132,v132
v_mfma_f32_16x16x32_bf16 v[136:139],a[44:47],a[108:111],v[136:139]
v_exp_f32 v133,v133
v_mfma_f32_16x16x32_bf16 v[140:143],a[48:51],a[108:111],v[204:207]
v_exp_f32 v134,v134
v_mfma_f32_16x16x32_bf16 v[140:143],a[52:55],a[104:107],v[140:143]
buffer_load_dwordx4 v227,s[20:23],s34 offen offset:2048 nt lds
v_mfma_f32_16x16x32_bf16 v[140:143],a[56:59],a[100:103],v[140:143]
v_exp_f32 v135,v135
v_mfma_f32_16x16x32_bf16 v[140:143],a[60:63],a[96:99],v[140:143]
v_cvt_pk_bf16_f32 v182,v132,v133
v_cvt_pk_bf16_f32 v183,v134,v135
v_mfma_f32_16x16x32_bf16 v[216:219],a[180:183],v[176:179],v[216:219]
P216:
s_cbranch_execz L_back
v_mfma_f32_16x16x32_bf16 v[216:219],a[180:183],v[180:183],v[216:219]
v_exp_f32 v136,v136
v_mfma_f32_16x16x32_bf16 v[96:99],a[64:67],v[180:183],v[96:99]
v_exp_f32 v137,v137
v_mfma_f32_16x16x32_bf16 v[96:99],a[144:147],v[176:179],v[96:99]
v_exp_f32 v138,v138
v_mfma_f32_16x16x32_bf16 v[100:103],a[148:151],v[176:179],v[100:103]
v_exp_f32 v139,v139
v_mfma_f32_16x16x32_bf16 v[100:103],a[68:71],v[180:183],v[100:103]
v_cvt_pk_bf16_f32 v184,v136,v137
v_cvt_pk_bf16_f32 v185,v138,v139
v_mfma_f32_16x16x32_bf16 v[104:107],a[72:75],v[180:183],v[104:107]
v_exp_f32 v140,v140
v_mfma_f32_16x16x32_bf16 v[104:107],a[152:155],v[176:179],v[104:107]
v_exp_f32 v141,v141
v_mfma_f32_16x16x32_bf16 v[108:111],a[156:159],v[176:179],v[108:111]
v_exp_f32 v142,v142
v_mfma_f32_16x16x32_bf16 v[108:111],a[76:79],v[180:183],v[108:111]
v_exp_f32 v143,v143
v_mfma_f32_16x16x32_bf16 v[112:115],a[80:83],v[180:183],v[112:115]
v_cvt_pk_bf16_f32 v186,v140,v141
v_cvt_pk_bf16_f32 v187,v142,v143
v_mfma_f32_16x16x32_bf16 v[112:115],a[160:163],v[176:179],v[112:115]
v_xor_b32 v225,0x18800,v225
v_xor_b32 v226,0x18800,v226
v_mfma_f32_16x16x32_bf16 v[116:119],a[164:167],v[176:179],v[116:119]
buffer_load_dwordx4 v227,s[20:23],s34 offen offset:3072 nt lds
v_mfma_f32_16x16x32_bf16 v[116:119],a[84:87],v[180:183],v[116:119]
v_mfma_f32_16x16x32_bf16 v[120:123],a[88:91],v[180:183],v[120:123]
v_mfma_f32_16x16x32_bf16 v[120:123],a[168:171],v[176:179],v[120:123]
v_mfma_f32_16x16x32_bf16 v[124:127],a[172:175],v[176:179],v[124:127]
v_mfma_f32_16x16x32_bf16 v[124:127],a[92:95],v[180:183],v[124:127]
v_mfma_f32_16x16x32_bf16 v[144:147],a[112:115],a[224:227],v[196:199]
v_mfma_f32_16x16x32_bf16 v[144:147],a[116:119],a[228:231],v[144:147]
v_mfma_f32_16x16x32_bf16 v[144:147],a[120:123],a[232:235],v[144:147]
P217:
s_cbranch_execz L_back
v_mfma_f32_16x16x32_bf16 v[144:147],a[124:127],a[236:239],v[144:147]
v_mfma_f32_16x16x32_bf16 v[148:151],a[128:131],a[236:239],v[196:199]
v_mfma_f32_16x16x32_bf16 v[148:151],a[132:135],a[232:235],v[148:151]
v_mfma_f32_16x16x32_bf16 v[148:151],a[136:139],a[228:231],v[148:151]
v_mfma_f32_16x16x32_bf16 v[148:151],a[140:143],a[224:227],v[148:151]
v_mfma_f32_16x16x32_bf16 v[128:131],a[32:35],a[224:227],v[196:199]
v_mfma_f32_16x16x32_bf16 v[128:131],a[36:39],a[228:231],v[128:131]
v_mfma_f32_16x16x32_bf16 v[128:131],a[40:43],a[232:235],v[128:131]
v_mfma_f32_16x16x32_bf16 v[128:131],a[44:47],a[236:239],v[128:131]
v_exp_f32 v144,v144
v_mfma_f32_16x16x32_bf16 v[132:135],a[48:51],a[236:239],v[196:199]
v_exp_f32 v145,v145
v_mfma_f32_16x16x32_bf16 v[132:135],a[52:55],a[232:235],v[132:135]
v_exp_f32 v146,v146
v_mfma_f32_16x16x32_bf16 v[132:135],a[56:59],a[228:231],v[132:135]
v_exp_f32 v147,v147
v_mfma_f32_16x16x32_bf16 v[132:135],a[60:63],a[224:227],v[132:135]
v_cvt_pk_bf16_f32 v168,v144,v145
v_cvt_pk_bf16_f32 v169,v146,v147
v_mfma_f32_16x16x32_bf16 v[220:223],a[176:179],v[184:187],v[220:223]
v_exp_f32 v148,v148
v_mfma_f32_16x16x32_bf16 a[0:3],a[64:67],v[184:187],a[0:3]
v_exp_f32 v149,v149
v_mfma_f32_16x16x32_bf16 a[4:7],a[68:71],v[184:187],a[4:7]
v_exp_f32 v150,v150
v_mfma_f32_16x16x32_bf16 a[8:11],a[72:75],v[184:187],a[8:11]
s_add_u32 m0,s30,16384
v_exp_f32 v151,v151
v_mfma_f32_16x16x32_bf16 a[12:15],a[76:79],v[184:187],a[12:15]
s_mov_b32 s34,376832
v_cvt_pk_bf16_f32 v170,v148,v149
v_cvt_pk_bf16_f32 v171,v150,v151
v_mfma_f32_16x16x32_bf16 a[16:19],a[80:83],v[184:187],a[16:19]
v_exp_f32 v128,v128
v_mfma_f32_16x16x32_bf16 a[20:23],a[84:87],v[184:187],a[20:23]
v_exp_f32 v129,v129
v_mfma_f32_16x16x32_bf16 a[24:27],a[88:91],v[184:187],a[24:27]
s_waitcnt vmcnt(8) lgkmcnt(0)
s_barrier
v_mfma_f32_16x16x32_bf16 a[28:31],a[92:95],v[184:187],a[28:31]
P218:
s_cbranch_execz L_back
v_mfma_f32_16x16x32_bf16 v[136:139],a[112:115],a[240:243],v[200:203]
v_exp_f32 v130,v130
v_mfma_f32_16x16x32_bf16 v[136:139],a[116:119],a[244:247],v[136:139]
v_exp_f32 v131,v131
v_mfma_f32_16x16x32_bf16 v[136:139],a[120:123],a[248:251],v[136:139]
buffer_load_dwordx4 v227,s[16:19],s34 offen nt lds
v_mfma_f32_16x16x32_bf16 v[136:139],a[124:127],a[252:255],v[136:139]
ds_read_b128 a[112:115],v224
v_cvt_pk_bf16_f32 v172,v128,v129
v_mfma_f32_16x16x32_bf16 v[140:143],a[128:131],a[252:255],v[200:203]
ds_read_b128 a[116:119],v224 offset:256
v_cvt_pk_bf16_f32 v173,v130,v131
v_mfma_f32_16x16x32_bf16 v[140:143],a[132:135],a[248:251],v[140:143]
v_exp_f32 v132,v132
v_mfma_f32_16x16x32_bf16 v[140:143],a[136:139],a[244:247],v[140:143]
v_exp_f32 v133,v133
v_mfma_f32_16x16x32_bf16 v[140:143],a[140:143],a[240:243],v[140:143]
v_exp_f32 v134,v134
v_mfma_f32_16x16x32_bf16 v[144:147],a[32:35],a[240:243],v[200:203]
v_exp_f32 v135,v135
v_mfma_f32_16x16x32_bf16 v[144:147],a[36:39],a[244:247],v[144:147]
ds_read_b128 a[120:123],v224 offset:512
v_cvt_pk_bf16_f32 v174,v132,v133
v_mfma_f32_16x16x32_bf16 v[144:147],a[40:43],a[248:251],v[144:147]
ds_read_b128 a[124:127],v224 offset:768
v_cvt_pk_bf16_f32 v175,v134,v135
v_mfma_f32_16x16x32_bf16 v[144:147],a[44:47],a[252:255],v[144:147]
v_exp_f32 v136,v136
v_mfma_f32_16x16x32_bf16 v[148:151],a[48:51],a[252:255],v[200:203]
ds_read_b128 a[128:131],v224 offset:1792
ds_read_b128 a[132:135],v224 offset:1536
v_mfma_f32_16x16x32_bf16 v[148:151],a[52:55],a[248:251],v[148:151]
v_exp_f32 v137,v137
v_mfma_f32_16x16x32_bf16 v[148:151],a[56:59],a[244:247],v[148:151]
P219:
s_cbranch_execz L_back
Z13:
s_cbranch_execz Z17
v_mfma_f32_16x16x32_bf16 v[148:151],a[60:63],a[240:243],v[148:151]
ds_read_b128 a[136:139],v224 offset:1280
ds_read_b128 a[140:143],v224 offset:1024
v_mfma_f32_16x16x32_bf16 v[216:219],a[184:187],v[168:171],v[216:219]
v_xor_b32 v224,0x800,v224
v_and_b32 v231,0xf0,v228
v_mfma_f32_16x16x32_bf16 v[216:219],a[184:187],v[172:175],v[216:219]
ds_read_b128 a[32:35],v224
ds_read_b128 a[36:39],v224 offset:256
v_mfma_f32_16x16x32_bf16 v[0:3],a[64:67],v[172:175],v[0:3]
v_exp_f32 v138,v138
v_mfma_f32_16x16x32_bf16 v[0:3],a[144:147],v[168:171],v[0:3]
buffer_load_dwordx4 v227,s[16:19],s34 offen offset:1024 nt lds
v_mfma_f32_16x16x32_bf16 v[4:7],a[148:151],v[168:171],v[4:7]
v_exp_f32 v139,v139
v_mfma_f32_16x16x32_bf16 v[4:7],a[68:71],v[172:175],v[4:7]
ds_read_b128 a[40:43],v224 offset:512
ds_read_b128 a[44:47],v224 offset:768
v_mfma_f32_16x16x32_bf16 v[8:11],a[72:75],v[172:175],v[8:11]
v_cvt_pk_bf16_f32 v176,v136,v137
v_cvt_pk_bf16_f32 v177,v138,v139
v_mfma_f32_16x16x32_bf16 v[8:11],a[152:155],v[168:171],v[8:11]
v_exp_f32 v140,v140
v_mfma_f32_16x16x32_bf16 v[12:15],a[156:159],v[168:171],v[12:15]
ds_read_b128 a[48:51],v224 offset:1792
ds_read_b128 a[52:55],v224 offset:1536
v_mfma_f32_16x16x32_bf16 v[12:15],a[76:79],v[172:175],v[12:15]
v_exp_f32 v141,v141
v_mfma_f32_16x16x32_bf16 v[16:19],a[80:83],v[172:175],v[16:19]
v_exp_f32 v142,v142
v_mfma_f32_16x16x32_bf16 v[16:19],a[160:163],v[168:171],v[16:19]
ds_read_b128 a[56:59],v224 offset:1280
ds_read_b128 a[60:63],v224 offset:1024
v_mfma_f32_16x16x32_bf16 v[20:23],a[164:167],v[168:171],v[20:23]
P220:
s_cbranch_execz L_back
v_mfma_f32_16x16x32_bf16 v[20:23],a[84:87],v[172:175],v[20:23]
v_exp_f32 v143,v143
v_mfma_f32_16x16x32_bf16 v[24:27],a[88:91],v[172:175],v[24:27]
v_cvt_pk_bf16_f32 v178,v140,v141
v_cvt_pk_bf16_f32 v179,v142,v143
v_mfma_f32_16x16x32_bf16 v[24:27],a[168:171],v[168:171],v[24:27]
v_exp_f32 v144,v144
v_mfma_f32_16x16x32_bf16 v[28:31],a[172:175],v[168:171],v[28:31]
v_exp_f32 v145,v145
v_mfma_f32_16x16x32_bf16 v[28:31],a[92:95],v[172:175],v[28:31]
s_waitcnt lgkmcnt(0)
v_exp_f32 v146,v146
v_mfma_f32_16x16x32_bf16 v[128:131],a[112:115],a[192:195],v[188:191]
v_exp_f32 v147,v147
v_mfma_f32_16x16x32_bf16 v[128:131],a[116:119],a[196:199],v[128:131]
v_cvt_pk_bf16_f32 v180,v144,v145
v_cvt_pk_bf16_f32 v181,v146,v147
v_mfma_f32_16x16x32_bf16 v[128:131],a[120:123],a[200:203],v[128:131]
buffer_load_dwordx4 v227,s[16:19],s34 offen offset:2048 nt lds
v_mfma_f32_16x16x32_bf16 v[128:131],a[124:127],a[204:207],v[128:131]
v_exp_f32 v148,v148
v_mfma_f32_16x16x32_bf16 v[132:135],a[128:131],a[204:207],v[188:191]
v_exp_f32 v149,v149
v_mfma_f32_16x16x32_bf16 v[132:135],a[132:135],a[200:203],v[132:135]
v_exp_f32 v150,v150
v_mfma_f32_16x16x32_bf16 v[132:135],a[136:139],a[196:199],v[132:135]
v_exp_f32 v151,v151
v_mfma_f32_16x16x32_bf16 v[132:135],a[140:143],a[192:195],v[132:135]
v_cvt_pk_bf16_f32 v182,v148,v149
v_cvt_pk_bf16_f32 v183,v150,v151
v_mfma_f32_16x16x32_bf16 v[136:139],a[32:35],a[192:195],v[188:191]
v_exp_f32 v128,v128
v_mfma_f32_16x16x32_bf16 v[136:139],a[36:39],a[196:199],v[136:139]
v_exp_f32 v129,v129
v_mfma_f32_16x16x32_bf16 v[136:139],a[40:43],a[200:203],v[136:139]
v_exp_f32 v130,v130
v_mfma_f32_16x16x32_bf16 v[136:139],a[44:47],a[204:207],v[136:139]
P221:
s_cbranch_execz L_back
v_mfma_f32_16x16x32_bf16 v[140:143],a[48:51],a[204:207],v[188:191]
v_exp_f32 v131,v131
v_mfma_f32_16x16x32_bf16 v[140:143],a[52:55],a[200:203],v[140:143]
v_cvt_pk_bf16_f32 v168,v128,v129
v_cvt_pk_bf16_f32 v169,v130,v131
v_mfma_f32_16x16x32_bf16 v[140:143],a[56:59],a[196:199],v[140:143]
v_exp_f32 v132,v132
v_mfma_f32_16x16x32_bf16 v[140:143],a[60:63],a[192:195],v[140:143]
v_exp_f32 v133,v133
v_mfma_f32_16x16x32_bf16 v[216:219],a[188:191],v[176:179],v[216:219]
v_exp_f32 v134,v134
v_mfma_f32_16x16x32_bf16 v[216:219],a[188:191],v[180:183],v[216:219]
v_exp_f32 v135,v135
v_mfma_f32_16x16x32_bf16 v[32:35],a[64:67],v[180:183],v[32:35]
v_cvt_pk_bf16_f32 v170,v132,v133
v_cvt_pk_bf16_f32 v171,v134,v135
v_mfma_f32_16x16x32_bf16 v[32:35],a[144:147],v[176:179],v[32:35]
ds_read_b64_tr_b16 a[144:145],v225
ds_read_b64_tr_b16 a[146:147],v225 offset:1024
v_mfma_f32_16x16x32_bf16 v[36:39],a[148:151],v[176:179],v[36:39]
ds_read_b64_tr_b16 a[148:149],v226
ds_read_b64_tr_b16 a[150:151],v226 offset:1024
v_mfma_f32_16x16x32_bf16 v[36:39],a[68:71],v[180:183],v[36:39]
buffer_load_dwordx4 v227,s[16:19],s34 offen offset:3072 nt lds
v_mfma_f32_16x16x32_bf16 v[40:43],a[72:75],v[180:183],v[40:43]
v_exp_f32 v136,v136
v_mfma_f32_16x16x32_bf16 v[40:43],a[152:155],v[176:179],v[40:43]
ds_read_b64_tr_b16 a[152:153],v225 offset:256
ds_read_b64_tr_b16 a[154:155],v225 offset:1280
v_mfma_f32_16x16x32_bf16 v[44:47],a[156:159],v[176:179],v[44:47]
v_exp_f32 v137,v137
v_mfma_f32_16x16x32_bf16 v[44:47],a[76:79],v[180:183],v[44:47]
ds_read_b64_tr_b16 a[156:157],v226 offset:256
ds_read_b64_tr_b16 a[158:159],v226 offset:1280
v_mfma_f32_16x16x32_bf16 v[48:51],a[80:83],v[180:183],v[48:51]
P222:
s_cbranch_execz L_back
v_mfma_f32_16x16x32_bf16 v[48:51],a[160:163],v[176:179],v[48:51]
ds_read_b64_tr_b16 a[160:161],v225 offset:512
ds_read_b64_tr_b16 a[162:163],v225 offset:1536
v_mfma_f32_16x16x32_bf16 v[52:55],a[164:167],v[176:179],v[52:55]
s_add_u32 m0,s30,32768
v_exp_f32 v138,v138
v_mfma_f32_16x16x32_bf16 v[52:55],a[84:87],v[180:183],v[52:55]
s_mov_b32 s34,376832
ds_read_b64_tr_b16 a[164:165],v226 offset:512
ds_read_b64_tr_b16 a[166:167],v226 offset:1536
v_mfma_f32_16x16x32_bf16 v[56:59],a[88:91],v[180:183],v[56:59]
v_exp_f32 v139,v139
v_mfma_f32_16x16x32_bf16 v[56:59],a[168:171],v[176:179],v[56:59]
ds_read_b64_tr_b16 a[168:169],v225 offset:768
ds_read_b64_tr_b16 a[170:171],v225 offset:1792
v_mfma_f32_16x16x32_bf16 v[60:63],a[172:175],v[176:179],v[60:63]
v_cvt_pk_bf16_f32 v172,v136,v137
v_cvt_pk_bf16_f32 v173,v138,v139
v_mfma_f32_16x16x32_bf16 v[60:63],a[92:95],v[180:183],v[60:63]
ds_read_b64_tr_b16 a[172:173],v226 offset:768
ds_read_b64_tr_b16 a[174:175],v226 offset:1792
v_mfma_f32_16x16x32_bf16 v[144:147],a[112:115],a[208:211],v[192:195]
v_xor_b32 v225,0x800,v225
v_xor_b32 v226,0x800,v226
v_mfma_f32_16x16x32_bf16 v[144:147],a[116:119],a[212:215],v[144:147]
ds_read_b64_tr_b16 a[64:65],v225
ds_read_b64_tr_b16 a[66:67],v225 offset:1024
v_mfma_f32_16x16x32_bf16 v[144:147],a[120:123],a[216:219],v[144:147]
buffer_load_dwordx4 v227,s[20:23],s34 offen nt lds
v_mfma_f32_16x16x32_bf16 v[144:147],a[124:127],a[220:223],v[144:147]
ds_read_b64_tr_b16 a[68:69],v226
ds_read_b64_tr_b16 a[70:71],v226 offset:1024
v_mfma_f32_16x16x32_bf16 v[148:151],a[128:131],a[220:223],v[192:195]
P223:
s_cbranch_execz L_back
v_mfma_f32_16x16x32_bf16 v[148:151],a[132:135],a[216:219],v[148:151]
ds_read_b64_tr_b16 a[72:73],v225 offset:256
ds_read_b64_tr_b16 a[74:75],v225 offset:1280
v_mfma_f32_16x16x32_bf16 v[148:151],a[136:139],a[212:215],v[148:151]
v_exp_f32 v140,v140
v_mfma_f32_16x16x32_bf16 v[148:151],a[140:143],a[208:211],v[148:151]
ds_read_b64_tr_b16 a[76:77],v226 offset:256
ds_read_b64_tr_b16 a[78:79],v226 offset:1280
v_mfma_f32_16x16x32_bf16 v[128:131],a[32:35],a[208:211],v[192:195]
v_exp_f32 v141,v141
v_mfma_f32_16x16x32_bf16 v[128:131],a[36:39],a[212:215],v[128:131]
v_exp_f32 v142,v142
v_mfma_f32_16x16x32_bf16 v[128:131],a[40:43],a[216:219],v[128:131]
ds_read_b64_tr_b16 a[80:81],v225 offset:512
ds_read_b64_tr_b16 a[82:83],v225 offset:1536
v_mfma_f32_16x16x32_bf16 v[128:131],a[44:47],a[220:223],v[128:131]
v_exp_f32 v143,v143
v_mfma_f32_16x16x32_bf16 v[132:135],a[48:51],a[220:223],v[192:195]
ds_read_b64_tr_b16 a[84:85],v226 offset:512
v_cvt_pk_bf16_f32 v174,v140,v141
v_mfma_f32_16x16x32_bf16 v[132:135],a[52:55],a[216:219],v[132:135]
ds_read_b64_tr_b16 a[86:87],v226 offset:1536
v_cvt_pk_bf16_f32 v175,v142,v143
v_mfma_f32_16x16x32_bf16 v[132:135],a[56:59],a[212:215],v[132:135]
v_exp_f32 v144,v144
v_mfma_f32_16x16x32_bf16 v[132:135],a[60:63],a[208:211],v[132:135]
ds_read_b64_tr_b16 a[88:89],v225 offset:768
ds_read_b64_tr_b16 a[90:91],v225 offset:1792
v_mfma_f32_16x16x32_bf16 v[216:219],a[176:179],v[168:171],v[216:219]
v_exp_f32 v145,v145
v_mfma_f32_16x16x32_bf16 v[216:219],a[176:179],v[172:175],v[216:219]
s_waitcnt lgkmcnt(4)
ds_read_b64_tr_b16 a[92:93],v226 offset:768
ds_read_b64_tr_b16 a[94:95],v226 offset:1792
v_mfma_f32_16x16x32_bf16 v[64:67],a[64:67],v[172:175],v[64:67]
P224:
s_cbranch_execz L_back
v_mfma_f32_16x16x32_bf16 v[64:67],a[144:147],v[168:171],v[64:67]
buffer_load_dwordx4 v227,s[20:23],s34 offen offset:1024 nt lds
v_mfma_f32_16x16x32_bf16 v[68:71],a[148:151],v[168:171],v[68:71]
v_exp_f32 v146,v146
v_mfma_f32_16x16x32_bf16 v[68:71],a[68:71],v[172:175],v[68:71]
v_exp_f32 v147,v147
v_mfma_f32_16x16x32_bf16 v[72:75],a[72:75],v[172:175],v[72:75]
v_cvt_pk_bf16_f32 v176,v144,v145
v_cvt_pk_bf16_f32 v177,v146,v147
v_mfma_f32_16x16x32_bf16 v[72:75],a[152:155],v[168:171],v[72:75]
v_exp_f32 v148,v148
v_mfma_f32_16x16x32_bf16 v[76:79],a[156:159],v[168:171],v[76:79]
v_exp_f32 v149,v149
v_mfma_f32_16x16x32_bf16 v[76:79],a[76:79],v[172:175],v[76:79]
v_exp_f32 v150,v150
v_mfma_f32_16x16x32_bf16 v[80:83],a[80:83],v[172:175],v[80:83]
v_exp_f32 v151,v151
v_mfma_f32_16x16x32_bf16 v[80:83],a[160:163],v[168:171],v[80:83]
v_cvt_pk_bf16_f32 v178,v148,v149
v_cvt_pk_bf16_f32 v179,v150,v151
v_mfma_f32_16x16x32_bf16 v[84:87],a[164:167],v[168:171],v[84:87]
s_waitcnt lgkmcnt(0)
v_exp_f32 v128,v128
v_mfma_f32_16x16x32_bf16 v[84:87],a[84:87],v[172:175],v[84:87]
v_exp_f32 v129,v129
v_mfma_f32_16x16x32_bf16 v[88:91],a[88:91],v[172:175],v[88:91]
v_exp_f32 v130,v130
v_mfma_f32_16x16x32_bf16 v[88:91],a[168:171],v[168:171],v[88:91]
v_exp_f32 v131,v131
v_mfma_f32_16x16x32_bf16 v[92:95],a[172:175],v[168:171],v[92:95]
v_cvt_pk_bf16_f32 v180,v128,v129
v_cvt_pk_bf16_f32 v181,v130,v131
v_mfma_f32_16x16x32_bf16 v[92:95],a[92:95],v[172:175],v[92:95]
v_exp_f32 v132,v132
v_mfma_f32_16x16x32_bf16 v[136:139],a[32:35],a[96:99],v[204:207]
v_exp_f32 v133,v133
v_mfma_f32_16x16x32_bf16 v[136:139],a[36:39],a[100:103],v[136:139]
P225:
s_cbranch_execz L_back
v_mfma_f32_16x16x32_bf16 v[136:139],a[40:43],a[104:107],v[136:139]
buffer_load_dwordx4 v227,s[20:23],s34 offen offset:2048 nt lds
v_mfma_f32_16x16x32_bf16 v[136:139],a[44:47],a[108:111],v[136:139]
v_exp_f32 v134,v134
v_mfma_f32_16x16x32_bf16 v[140:143],a[48:51],a[108:111],v[204:207]
v_exp_f32 v135,v135
v_mfma_f32_16x16x32_bf16 v[140:143],a[52:55],a[104:107],v[140:143]
v_cvt_pk_bf16_f32 v182,v132,v133
v_cvt_pk_bf16_f32 v183,v134,v135
v_mfma_f32_16x16x32_bf16 v[140:143],a[56:59],a[100:103],v[140:143]
v_xor_b32 v224,0x18800,v224
v_xor_b32 v225,0x10800,v225
v_mfma_f32_16x16x32_bf16 v[140:143],a[60:63],a[96:99],v[140:143]
v_exp_f32 v136,v136
v_mfma_f32_16x16x32_bf16 v[216:219],a[180:183],v[176:179],v[216:219]
v_exp_f32 v137,v137
v_mfma_f32_16x16x32_bf16 v[216:219],a[180:183],v[180:183],v[216:219]
v_exp_f32 v138,v138
v_mfma_f32_16x16x32_bf16 v[96:99],a[64:67],v[180:183],v[96:99]
v_exp_f32 v139,v139
v_mfma_f32_16x16x32_bf16 v[96:99],a[144:147],v[176:179],v[96:99]
v_cvt_pk_bf16_f32 v184,v136,v137
v_cvt_pk_bf16_f32 v185,v138,v139
v_mfma_f32_16x16x32_bf16 v[100:103],a[148:151],v[176:179],v[100:103]
v_exp_f32 v140,v140
v_mfma_f32_16x16x32_bf16 v[100:103],a[68:71],v[180:183],v[100:103]
v_exp_f32 v141,v141
v_mfma_f32_16x16x32_bf16 v[104:107],a[72:75],v[180:183],v[104:107]
v_exp_f32 v142,v142
v_mfma_f32_16x16x32_bf16 v[104:107],a[152:155],v[176:179],v[104:107]
v_exp_f32 v143,v143
v_mfma_f32_16x16x32_bf16 v[108:111],a[156:159],v[176:179],v[108:111]
v_cvt_pk_bf16_f32 v186,v140,v141
v_cvt_pk_bf16_f32 v187,v142,v143
v_mfma_f32_16x16x32_bf16 v[108:111],a[76:79],v[180:183],v[108:111]
v_xor_b32 v226,0x10800,v226
v_lshrrev_b32 v232,8,v228
v_mfma_f32_16x16x32_bf16 v[112:115],a[80:83],v[180:183],v[112:115]
P226:
s_cbranch_execz L_back
v_mfma_f32_16x16x32_bf16 v[112:115],a[160:163],v[176:179],v[112:115]
s_mul_i32 s35,s3,8704
buffer_load_dwordx4 v227,s[20:23],s34 offen offset:3072 nt lds
v_mfma_f32_16x16x32_bf16 v[116:119],a[164:167],v[176:179],v[116:119]
s_add_u32 s35,s35,16384
v_mul_u32_u24 v164,0x110,v232
v_lshlrev_b32 v232,3,v232
v_mfma_f32_16x16x32_bf16 v[116:119],a[84:87],v[180:183],v[116:119]
v_add_u32 v164,v164,v231
v_mul_u32_u24 v231,17,v231
v_mfma_f32_16x16x32_bf16 v[120:123],a[88:91],v[180:183],v[120:123]
v_add_u32 v231,v231,v232
v_add_u32 v231,s35,v231
v_mfma_f32_16x16x32_bf16 v[120:123],a[168:171],v[176:179],v[120:123]
v_add_u32 v232,s35,v164
v_mfma_f32_16x16x32_bf16 v[124:127],a[172:175],v[176:179],v[124:127]
v_mfma_f32_16x16x32_bf16 v[124:127],a[92:95],v[180:183],v[124:127]
v_mfma_f32_16x16x32_bf16 v[144:147],a[112:115],a[224:227],v[196:199]
v_mfma_f32_16x16x32_bf16 v[144:147],a[116:119],a[228:231],v[144:147]
v_mfma_f32_16x16x32_bf16 v[144:147],a[120:123],a[232:235],v[144:147]
v_mfma_f32_16x16x32_bf16 v[144:147],a[124:127],a[236:239],v[144:147]
v_mfma_f32_16x16x32_bf16 v[148:151],a[128:131],a[236:239],v[196:199]
v_mfma_f32_16x16x32_bf16 v[148:151],a[132:135],a[232:235],v[148:151]
v_mfma_f32_16x16x32_bf16 v[148:151],a[136:139],a[228:231],v[148:151]
v_mfma_f32_16x16x32_bf16 v[148:151],a[140:143],a[224:227],v[148:151]
v_mfma_f32_16x16x32_bf16 v[128:131],a[32:35],a[224:227],v[196:199]
v_mfma_f32_16x16x32_bf16 v[128:131],a[36:39],a[228:231],v[128:131]
v_mfma_f32_16x16x32_bf16 v[128:131],a[40:43],a[232:235],v[128:131]
v_mfma_f32_16x16x32_bf16 v[128:131],a[44:47],a[236:239],v[128:131]
v_exp_f32 v144,v144
v_mfma_f32_16x16x32_bf16 v[132:135],a[48:51],a[236:239],v[196:199]
v_exp_f32 v145,v145
v_mfma_f32_16x16x32_bf16 v[132:135],a[52:55],a[232:235],v[132:135]
v_exp_f32 v146,v146
v_mfma_f32_16x16x32_bf16 v[132:135],a[56:59],a[228:231],v[132:135]
P227:
s_cbranch_execz L_back
v_mfma_f32_16x16x32_bf16 v[132:135],a[60:63],a[224:227],v[132:135]
v_exp_f32 v147,v147
v_mfma_f32_16x16x32_bf16 v[220:223],a[176:179],v[184:187],v[220:223]
v_cvt_pk_bf16_f32 v168,v144,v145
v_cvt_pk_bf16_f32 v169,v146,v147
v_mfma_f32_16x16x32_bf16 a[0:3],a[64:67],v[184:187],a[0:3]
v_exp_f32 v148,v148
v_mfma_f32_16x16x32_bf16 a[4:7],a[68:71],v[184:187],a[4:7]
v_exp_f32 v149,v149
v_mfma_f32_16x16x32_bf16 a[8:11],a[72:75],v[184:187],a[8:11]
s_add_u32 m0,s30,49152
v_exp_f32 v150,v150
v_mfma_f32_16x16x32_bf16 a[12:15],a[76:79],v[184:187],a[12:15]
s_mov_b32 s34,393216
v_exp_f32 v151,v151
v_mfma_f32_16x16x32_bf16 a[16:19],a[80:83],v[184:187],a[16:19]
v_cvt_pk_bf16_f32 v170,v148,v149
v_cvt_pk_bf16_f32 v171,v150,v151
v_mfma_f32_16x16x32_bf16 a[20:23],a[84:87],v[184:187],a[20:23]
v_exp_f32 v128,v128
v_mfma_f32_16x16x32_bf16 a[24:27],a[88:91],v[184:187],a[24:27]
s_waitcnt vmcnt(8) lgkmcnt(0)
s_barrier
v_mfma_f32_16x16x32_bf16 a[28:31],a[92:95],v[184:187],a[28:31]
v_exp_f32 v129,v129
v_mfma_f32_16x16x32_bf16 v[136:139],a[112:115],a[240:243],v[200:203]
v_exp_f32 v130,v130
v_mfma_f32_16x16x32_bf16 v[136:139],a[116:119],a[244:247],v[136:139]
v_exp_f32 v131,v131
v_mfma_f32_16x16x32_bf16 v[136:139],a[120:123],a[248:251],v[136:139]
buffer_load_dwordx4 v227,s[16:19],s34 offen nt lds
v_mfma_f32_16x16x32_bf16 v[136:139],a[124:127],a[252:255],v[136:139]
ds_read_b128 a[112:115],v224
v_cvt_pk_bf16_f32 v172,v128,v129
v_mfma_f32_16x16x32_bf16 v[140:143],a[128:131],a[252:255],v[200:203]
ds_read_b128 a[116:119],v224 offset:256
v_cvt_pk_bf16_f32 v173,v130,v131
v_mfma_f32_16x16x32_bf16 v[140:143],a[132:135],a[248:251],v[140:143]
P228:
s_cbranch_execz L_back
v_mfma_f32_16x16x32_bf16 v[140:143],a[136:139],a[244:247],v[140:143]
v_exp_f32 v132,v132
v_mfma_f32_16x16x32_bf16 v[140:143],a[140:143],a[240:243],v[140:143]
v_exp_f32 v133,v133
v_mfma_f32_16x16x32_bf16 v[144:147],a[32:35],a[240:243],v[200:203]
v_exp_f32 v134,v134
v_mfma_f32_16x16x32_bf16 v[144:147],a[36:39],a[244:247],v[144:147]
v_exp_f32 v135,v135
v_mfma_f32_16x16x32_bf16 v[144:147],a[40:43],a[248:251],v[144:147]
ds_read_b128 a[120:123],v224 offset:512
v_cvt_pk_bf16_f32 v174,v132,v133
v_mfma_f32_16x16x32_bf16 v[144:147],a[44:47],a[252:255],v[144:147]
ds_read_b128 a[124:127],v224 offset:768
v_cvt_pk_bf16_f32 v175,v134,v135
v_mfma_f32_16x16x32_bf16 v[148:151],a[48:51],a[252:255],v[200:203]
v_exp_f32 v136,v136
v_mfma_f32_16x16x32_bf16 v[148:151],a[52:55],a[248:251],v[148:151]
ds_read_b128 a[128:131],v224 offset:1792
ds_read_b128 a[132:135],v224 offset:1536
v_mfma_f32_16x16x32_bf16 v[148:151],a[56:59],a[244:247],v[148:151]
v_exp_f32 v137,v137
v_mfma_f32_16x16x32_bf16 v[148:151],a[60:63],a[240:243],v[148:151]
ds_read_b128 a[136:139],v224 offset:1280
ds_read_b128 a[140:143],v224 offset:1024
v_mfma_f32_16x16x32_bf16 v[216:219],a[184:187],v[168:171],v[216:219]
v_exp_f32 v138,v138
v_mfma_f32_16x16x32_bf16 v[216:219],a[184:187],v[172:175],v[216:219]
v_exp_f32 v139,v139
v_mfma_f32_16x16x32_bf16 v[0:3],a[64:67],v[172:175],v[0:3]
v_xor_b32 v224,0x800,v224
v_cvt_pk_bf16_f32 v176,v136,v137
v_mfma_f32_16x16x32_bf16 v[0:3],a[144:147],v[168:171],v[0:3]
buffer_load_dwordx4 v227,s[16:19],s34 offen offset:1024 nt lds
v_mfma_f32_16x16x32_bf16 v[4:7],a[148:151],v[168:171],v[4:7]
ds_read_b128 a[32:35],v224
ds_read_b128 a[36:39],v224 offset:256
v_mfma_f32_16x16x32_bf16 v[4:7],a[68:71],v[172:175],v[4:7]
P229:
s_cbranch_execz L_back
v_mfma_f32_16x16x32_bf16 v[8:11],a[72:75],v[172:175],v[8:11]
ds_read_b128 a[40:43],v224 offset:512
ds_read_b128 a[44:47],v224 offset:768
v_mfma_f32_16x16x32_bf16 v[8:11],a[152:155],v[168:171],v[8:11]
v_cvt_pk_bf16_f32 v177,v138,v139
v_mfma_f32_16x16x32_bf16 v[12:15],a[156:159],v[168:171],v[12:15]
v_exp_f32 v140,v140
v_mfma_f32_16x16x32_bf16 v[12:15],a[76:79],v[172:175],v[12:15]
ds_read_b128 a[48:51],v224 offset:1792
ds_read_b128 a[52:55],v224 offset:1536
v_mfma_f32_16x16x32_bf16 v[16:19],a[80:83],v[172:175],v[16:19]
v_exp_f32 v141,v141
v_mfma_f32_16x16x32_bf16 v[16:19],a[160:163],v[168:171],v[16:19]
v_exp_f32 v142,v142
v_mfma_f32_16x16x32_bf16 v[20:23],a[164:167],v[168:171],v[20:23]
ds_read_b128 a[56:59],v224 offset:1280
ds_read_b128 a[60:63],v224 offset:1024
v_mfma_f32_16x16x32_bf16 v[20:23],a[84:87],v[172:175],v[20:23]
v_exp_f32 v143,v143
v_mfma_f32_16x16x32_bf16 v[24:27],a[88:91],v[172:175],v[24:27]
v_cvt_pk_bf16_f32 v178,v140,v141
v_cvt_pk_bf16_f32 v179,v142,v143
v_mfma_f32_16x16x32_bf16 v[24:27],a[168:171],v[168:171],v[24:27]
v_exp_f32 v144,v144
v_mfma_f32_16x16x32_bf16 v[28:31],a[172:175],v[168:171],v[28:31]
v_exp_f32 v145,v145
v_mfma_f32_16x16x32_bf16 v[28:31],a[92:95],v[172:175],v[28:31]
s_waitcnt lgkmcnt(2)
v_exp_f32 v146,v146
v_mfma_f32_16x16x32_bf16 v[128:131],a[112:115],a[192:195],v[188:191]
v_exp_f32 v147,v147
v_mfma_f32_16x16x32_bf16 v[128:131],a[116:119],a[196:199],v[128:131]
v_cvt_pk_bf16_f32 v180,v144,v145
v_cvt_pk_bf16_f32 v181,v146,v147
v_mfma_f32_16x16x32_bf16 v[128:131],a[120:123],a[200:203],v[128:131]
P230:
s_cbranch_execz L_back
v_mfma_f32_16x16x32_bf16 v[128:131],a[124:127],a[204:207],v[128:131]
buffer_load_dwordx4 v227,s[16:19],s34 offen offset:2048 nt lds
v_mfma_f32_16x16x32_bf16 v[132:135],a[128:131],a[204:207],v[188:191]
v_exp_f32 v148,v148
v_mfma_f32_16x16x32_bf16 v[132:135],a[132:135],a[200:203],v[132:135]
v_exp_f32 v149,v149
v_mfma_f32_16x16x32_bf16 v[132:135],a[136:139],a[196:199],v[132:135]
v_exp_f32 v150,v150
v_mfma_f32_16x16x32_bf16 v[132:135],a[140:143],a[192:195],v[132:135]
v_exp_f32 v151,v151
v_mfma_f32_16x16x32_bf16 v[136:139],a[32:35],a[192:195],v[188:191]
v_cvt_pk_bf16_f32 v182,v148,v149
v_cvt_pk_bf16_f32 v183,v150,v151
v_mfma_f32_16x16x32_bf16 v[136:139],a[36:39],a[196:199],v[136:139]
v_exp_f32 v128,v128
v_mfma_f32_16x16x32_bf16 v[136:139],a[40:43],a[200:203],v[136:139]
v_exp_f32 v129,v129
v_mfma_f32_16x16x32_bf16 v[136:139],a[44:47],a[204:207],v[136:139]
v_exp_f32 v130,v130
v_mfma_f32_16x16x32_bf16 v[140:143],a[48:51],a[204:207],v[188:191]
v_exp_f32 v131,v131
v_mfma_f32_16x16x32_bf16 v[140:143],a[52:55],a[200:203],v[140:143]
s_waitcnt lgkmcnt(0)
v_cvt_pk_bf16_f32 v168,v128,v129
v_cvt_pk_bf16_f32 v169,v130,v131
v_mfma_f32_16x16x32_bf16 v[140:143],a[56:59],a[196:199],v[140:143]
v_exp_f32 v132,v132
v_mfma_f32_16x16x32_bf16 v[140:143],a[60:63],a[192:195],v[140:143]
v_exp_f32 v133,v133
v_mfma_f32_16x16x32_bf16 v[216:219],a[188:191],v[176:179],v[216:219]
v_exp_f32 v134,v134
v_mfma_f32_16x16x32_bf16 v[216:219],a[188:191],v[180:183],v[216:219]
v_exp_f32 v135,v135
v_mfma_f32_16x16x32_bf16 v[32:35],a[64:67],v[180:183],v[32:35]
v_cvt_pk_bf16_f32 v170,v132,v133
v_cvt_pk_bf16_f32 v171,v134,v135
v_mfma_f32_16x16x32_bf16 v[32:35],a[144:147],v[176:179],v[32:35]
ds_read_b64_tr_b16 a[144:145],v225
ds_read_b64_tr_b16 a[146:147],v225 offset:1024
v_mfma_f32_16x16x32_bf16 v[36:39],a[148:151],v[176:179],v[36:39]
ds_read_b64_tr_b16 a[148:149],v226
ds_read_b64_tr_b16 a[150:151],v226 offset:1024
v_mfma_f32_16x16x32_bf16 v[36:39],a[68:71],v[180:183],v[36:39]
P231:
s_cbranch_execz L_back
buffer_load_dwordx4 v227,s[16:19],s34 offen offset:3072 nt lds
v_mfma_f32_16x16x32_bf16 v[40:43],a[72:75],v[180:183],v[40:43]
v_exp_f32 v136,v136
v_mfma_f32_16x16x32_bf16 v[40:43],a[152:155],v[176:179],v[40:43]
ds_read_b64_tr_b16 a[152:153],v225 offset:256
ds_read_b64_tr_b16 a[154:155],v225 offset:1280
v_mfma_f32_16x16x32_bf16 v[44:47],a[156:159],v[176:179],v[44:47]
v_exp_f32 v137,v137
v_mfma_f32_16x16x32_bf16 v[44:47],a[76:79],v[180:183],v[44:47]
ds_read_b64_tr_b16 a[156:157],v226 offset:256
ds_read_b64_tr_b16 a[158:159],v226 offset:1280
v_mfma_f32_16x16x32_bf16 v[48:51],a[80:83],v[180:183],v[48:51]
v_exp_f32 v138,v138
v_mfma_f32_16x16x32_bf16 v[48:51],a[160:163],v[176:179],v[48:51]
ds_read_b64_tr_b16 a[160:161],v225 offset:512
ds_read_b64_tr_b16 a[162:163],v225 offset:1536
v_mfma_f32_16x16x32_bf16 v[52:55],a[164:167],v[176:179],v[52:55]
s_add_u32 m0,s30,65536
v_exp_f32 v139,v139
v_mfma_f32_16x16x32_bf16 v[52:55],a[84:87],v[180:183],v[52:55]
s_mov_b32 s34,393216
ds_read_b64_tr_b16 a[164:165],v226 offset:512
ds_read_b64_tr_b16 a[166:167],v226 offset:1536
v_mfma_f32_16x16x32_bf16 v[56:59],a[88:91],v[180:183],v[56:59]
v_cvt_pk_bf16_f32 v172,v136,v137
v_cvt_pk_bf16_f32 v173,v138,v139
v_mfma_f32_16x16x32_bf16 v[56:59],a[168:171],v[176:179],v[56:59]
P232:
s_cbranch_execz L_back
v_mfma_f32_16x16x32_bf16 v[60:63],a[172:175],v[176:179],v[60:63]
ds_read_b64_tr_b16 a[168:169],v225 offset:768
ds_read_b64_tr_b16 a[170:171],v225 offset:1792
v_mfma_f32_16x16x32_bf16 v[60:63],a[92:95],v[180:183],v[60:63]
v_exp_f32 v140,v140
v_mfma_f32_16x16x32_bf16 v[144:147],a[112:115],a[208:211],v[192:195]
ds_read_b64_tr_b16 a[172:173],v226 offset:768
ds_read_b64_tr_b16 a[174:175],v226 offset:1792
v_mfma_f32_16x16x32_bf16 v[144:147],a[116:119],a[212:215],v[144:147]
v_xor_b32 v225,0x800,v225
v_xor_b32 v226,0x800,v226
v_mfma_f32_16x16x32_bf16 v[144:147],a[120:123],a[216:219],v[144:147]
ds_read_b64_tr_b16 a[64:65],v225
ds_read_b64_tr_b16 a[66:67],v225 offset:1024
v_mfma_f32_16x16x32_bf16 v[144:147],a[124:127],a[220:223],v[144:147]
buffer_load_dwordx4 v227,s[20:23],s34 offen nt lds
v_mfma_f32_16x16x32_bf16 v[148:151],a[128:131],a[220:223],v[192:195]
ds_read_b64_tr_b16 a[68:69],v226
ds_read_b64_tr_b16 a[70:71],v226 offset:1024
v_mfma_f32_16x16x32_bf16 v[148:151],a[132:135],a[216:219],v[148:151]
v_exp_f32 v141,v141
v_mfma_f32_16x16x32_bf16 v[148:151],a[136:139],a[212:215],v[148:151]
ds_read_b64_tr_b16 a[72:73],v225 offset:256
ds_read_b64_tr_b16 a[74:75],v225 offset:1280
v_mfma_f32_16x16x32_bf16 v[148:151],a[140:143],a[208:211],v[148:151]
v_exp_f32 v142,v142
v_mfma_f32_16x16x32_bf16 v[128:131],a[32:35],a[208:211],v[192:195]
ds_read_b64_tr_b16 a[76:77],v226 offset:256
ds_read_b64_tr_b16 a[78:79],v226 offset:1280
v_mfma_f32_16x16x32_bf16 v[128:131],a[36:39],a[212:215],v[128:131]
v_exp_f32 v143,v143
v_mfma_f32_16x16x32_bf16 v[128:131],a[40:43],a[216:219],v[128:131]
ds_read_b64_tr_b16 a[80:81],v225 offset:512
ds_read_b64_tr_b16 a[82:83],v225 offset:1536
v_mfma_f32_16x16x32_bf16 v[128:131],a[44:47],a[220:223],v[128:131]
P233:
s_cbranch_execz L_back
v_mfma_f32_16x16x32_bf16 v[132:135],a[48:51],a[220:223],v[192:195]
ds_read_b64_tr_b16 a[84:85],v226 offset:512
v_cvt_pk_bf16_f32 v174,v140,v141
v_mfma_f32_16x16x32_bf16 v[132:135],a[52:55],a[216:219],v[132:135]
ds_read_b64_tr_b16 a[86:87],v226 offset:1536
v_cvt_pk_bf16_f32 v175,v142,v143
v_mfma_f32_16x16x32_bf16 v[132:135],a[56:59],a[212:215],v[132:135]
v_exp_f32 v144,v144
v_mfma_f32_16x16x32_bf16 v[132:135],a[60:63],a[208:211],v[132:135]
ds_read_b64_tr_b16 a[88:89],v225 offset:768
ds_read_b64_tr_b16 a[90:91],v225 offset:1792
v_mfma_f32_16x16x32_bf16 v[216:219],a[176:179],v[168:171],v[216:219]
v_exp_f32 v145,v145
v_mfma_f32_16x16x32_bf16 v[216:219],a[176:179],v[172:175],v[216:219]
s_waitcnt lgkmcnt(4)
ds_read_b64_tr_b16 a[92:93],v226 offset:768
ds_read_b64_tr_b16 a[94:95],v226 offset:1792
v_mfma_f32_16x16x32_bf16 v[64:67],a[64:67],v[172:175],v[64:67]
v_exp_f32 v146,v146
v_mfma_f32_16x16x32_bf16 v[64:67],a[144:147],v[168:171],v[64:67]
buffer_load_dwordx4 v227,s[20:23],s34 offen offset:1024 nt lds
v_mfma_f32_16x16x32_bf16 v[68:71],a[148:151],v[168:171],v[68:71]
v_exp_f32 v147,v147
v_mfma_f32_16x16x32_bf16 v[68:71],a[68:71],v[172:175],v[68:71]
v_cvt_pk_bf16_f32 v176,v144,v145
v_cvt_pk_bf16_f32 v177,v146,v147
v_mfma_f32_16x16x32_bf16 v[72:75],a[72:75],v[172:175],v[72:75]
v_exp_f32 v148,v148
v_mfma_f32_16x16x32_bf16 v[72:75],a[152:155],v[168:171],v[72:75]
v_exp_f32 v149,v149
v_mfma_f32_16x16x32_bf16 v[76:79],a[156:159],v[168:171],v[76:79]
v_exp_f32 v150,v150
v_mfma_f32_16x16x32_bf16 v[76:79],a[76:79],v[172:175],v[76:79]
v_exp_f32 v151,v151
v_mfma_f32_16x16x32_bf16 v[80:83],a[80:83],v[172:175],v[80:83]
P234:
s_cbranch_execz L_back
v_mfma_f32_16x16x32_bf16 v[80:83],a[160:163],v[168:171],v[80:83]
v_cvt_pk_bf16_f32 v178,v148,v149
v_cvt_pk_bf16_f32 v179,v150,v151
v_mfma_f32_16x16x32_bf16 v[84:87],a[164:167],v[168:171],v[84:87]
s_waitcnt lgkmcnt(0)
v_exp_f32 v128,v128
v_mfma_f32_16x16x32_bf16 v[84:87],a[84:87],v[172:175],v[84:87]
v_exp_f32 v129,v129
v_mfma_f32_16x16x32_bf16 v[88:91],a[88:91],v[172:175],v[88:91]
v_exp_f32 v130,v130
v_mfma_f32_16x16x32_bf16 v[88:91],a[168:171],v[168:171],v[88:91]
v_exp_f32 v131,v131
v_mfma_f32_16x16x32_bf16 v[92:95],a[172:175],v[168:171],v[92:95]
v_cvt_pk_bf16_f32 v180,v128,v129
v_cvt_pk_bf16_f32 v181,v130,v131
v_mfma_f32_16x16x32_bf16 v[92:95],a[92:95],v[172:175],v[92:95]
v_exp_f32 v132,v132
v_mfma_f32_16x16x32_bf16 v[136:139],a[32:35],a[96:99],v[204:207]
v_exp_f32 v133,v133
v_mfma_f32_16x16x32_bf16 v[136:139],a[36:39],a[100:103],v[136:139]
v_exp_f32 v134,v134
v_mfma_f32_16x16x32_bf16 v[136:139],a[40:43],a[104:107],v[136:139]
buffer_load_dwordx4 v227,s[20:23],s34 offen offset:2048 nt lds
v_mfma_f32_16x16x32_bf16 v[136:139],a[44:47],a[108:111],v[136:139]
v_exp_f32 v135,v135
v_mfma_f32_16x16x32_bf16 v[140:143],a[48:51],a[108:111],v[204:207]
v_cvt_pk_bf16_f32 v182,v132,v133
v_cvt_pk_bf16_f32 v183,v134,v135
v_mfma_f32_16x16x32_bf16 v[140:143],a[52:55],a[104:107],v[140:143]
v_xor_b32 v224,0x10800,v224
v_xor_b32 v225,0x8800,v225
v_mfma_f32_16x16x32_bf16 v[140:143],a[56:59],a[100:103],v[140:143]
v_exp_f32 v136,v136
v_mfma_f32_16x16x32_bf16 v[140:143],a[60:63],a[96:99],v[140:143]
v_exp_f32 v137,v137
v_mfma_f32_16x16x32_bf16 v[216:219],a[180:183],v[176:179],v[216:219]
v_exp_f32 v138,v138
v_mfma_f32_16x16x32_bf16 v[216:219],a[180:183],v[180:183],v[216:219]
P235:
s_cbranch_execz L_back
Z14:
s_cbranch_execz Z18
v_mfma_f32_16x16x32_bf16 v[96:99],a[64:67],v[180:183],v[96:99]
v_exp_f32 v139,v139
v_mfma_f32_16x16x32_bf16 v[96:99],a[144:147],v[176:179],v[96:99]
v_cvt_pk_bf16_f32 v184,v136,v137
v_cvt_pk_bf16_f32 v185,v138,v139
v_mfma_f32_16x16x32_bf16 v[100:103],a[148:151],v[176:179],v[100:103]
v_exp_f32 v140,v140
v_mfma_f32_16x16x32_bf16 v[100:103],a[68:71],v[180:183],v[100:103]
v_exp_f32 v141,v141
v_mfma_f32_16x16x32_bf16 v[104:107],a[72:75],v[180:183],v[104:107]
v_exp_f32 v142,v142
v_mfma_f32_16x16x32_bf16 v[104:107],a[152:155],v[176:179],v[104:107]
v_exp_f32 v143,v143
v_mfma_f32_16x16x32_bf16 v[108:111],a[156:159],v[176:179],v[108:111]
v_cvt_pk_bf16_f32 v186,v140,v141
v_cvt_pk_bf16_f32 v187,v142,v143
v_mfma_f32_16x16x32_bf16 v[108:111],a[76:79],v[180:183],v[108:111]
v_xor_b32 v226,0x8800,v226
v_mfma_f32_16x16x32_bf16 v[112:115],a[80:83],v[180:183],v[112:115]
v_mfma_f32_16x16x32_bf16 v[112:115],a[160:163],v[176:179],v[112:115]
buffer_load_dwordx4 v227,s[20:23],s34 offen offset:3072 nt lds
v_mfma_f32_16x16x32_bf16 v[116:119],a[164:167],v[176:179],v[116:119]
v_mfma_f32_16x16x32_bf16 v[116:119],a[84:87],v[180:183],v[116:119]
v_mfma_f32_16x16x32_bf16 v[120:123],a[88:91],v[180:183],v[120:123]
v_mfma_f32_16x16x32_bf16 v[120:123],a[168:171],v[176:179],v[120:123]
v_mfma_f32_16x16x32_bf16 v[124:127],a[172:175],v[176:179],v[124:127]
v_mfma_f32_16x16x32_bf16 v[124:127],a[92:95],v[180:183],v[124:127]
v_mfma_f32_16x16x32_bf16 v[144:147],a[112:115],a[224:227],v[196:199]
v_mfma_f32_16x16x32_bf16 v[144:147],a[116:119],a[228:231],v[144:147]
v_mfma_f32_16x16x32_bf16 v[144:147],a[120:123],a[232:235],v[144:147]
v_mfma_f32_16x16x32_bf16 v[144:147],a[124:127],a[236:239],v[144:147]
v_mfma_f32_16x16x32_bf16 v[148:151],a[128:131],a[236:239],v[196:199]
v_mfma_f32_16x16x32_bf16 v[148:151],a[132:135],a[232:235],v[148:151]
P236:
s_cbranch_execz L_back
v_mfma_f32_16x16x32_bf16 v[148:151],a[136:139],a[228:231],v[148:151]
v_mfma_f32_16x16x32_bf16 v[148:151],a[140:143],a[224:227],v[148:151]
v_mfma_f32_16x16x32_bf16 v[128:131],a[32:35],a[224:227],v[196:199]
v_mfma_f32_16x16x32_bf16 v[128:131],a[36:39],a[228:231],v[128:131]
v_mfma_f32_16x16x32_bf16 v[128:131],a[40:43],a[232:235],v[128:131]
v_exp_f32 v144,v144
v_mfma_f32_16x16x32_bf16 v[128:131],a[44:47],a[236:239],v[128:131]
v_exp_f32 v145,v145
v_mfma_f32_16x16x32_bf16 v[132:135],a[48:51],a[236:239],v[196:199]
v_exp_f32 v146,v146
v_mfma_f32_16x16x32_bf16 v[132:135],a[52:55],a[232:235],v[132:135]
v_exp_f32 v147,v147
v_mfma_f32_16x16x32_bf16 v[132:135],a[56:59],a[228:231],v[132:135]
v_cvt_pk_bf16_f32 v168,v144,v145
v_cvt_pk_bf16_f32 v169,v146,v147
v_mfma_f32_16x16x32_bf16 v[132:135],a[60:63],a[224:227],v[132:135]
v_exp_f32 v148,v148
v_mfma_f32_16x16x32_bf16 v[220:223],a[176:179],v[184:187],v[220:223]
v_exp_f32 v149,v149
v_mfma_f32_16x16x32_bf16 a[0:3],a[64:67],v[184:187],a[0:3]
v_exp_f32 v150,v150
v_mfma_f32_16x16x32_bf16 a[4:7],a[68:71],v[184:187],a[4:7]
v_exp_f32 v151,v151
v_mfma_f32_16x16x32_bf16 a[8:11],a[72:75],v[184:187],a[8:11]
s_add_u32 m0,s30,81920
v_cvt_pk_bf16_f32 v170,v148,v149
v_cvt_pk_bf16_f32 v171,v150,v151
v_mfma_f32_16x16x32_bf16 a[12:15],a[76:79],v[184:187],a[12:15]
s_mov_b32 s34,409600
v_exp_f32 v128,v128
v_mfma_f32_16x16x32_bf16 a[16:19],a[80:83],v[184:187],a[16:19]
v_exp_f32 v129,v129
v_mfma_f32_16x16x32_bf16 a[20:23],a[84:87],v[184:187],a[20:23]
v_exp_f32 v130,v130
v_mfma_f32_16x16x32_bf16 a[24:27],a[88:91],v[184:187],a[24:27]
s_waitcnt vmcnt(8) lgkmcnt(0)
s_barrier
v_mfma_f32_16x16x32_bf16 a[28:31],a[92:95],v[184:187],a[28:31]
P237:
s_cbranch_execz L_back
v_mfma_f32_16x16x32_bf16 v[136:139],a[112:115],a[240:243],v[200:203]
v_exp_f32 v131,v131
v_mfma_f32_16x16x32_bf16 v[136:139],a[116:119],a[244:247],v[136:139]
ds_read_b128 a[112:115],v224
v_cvt_pk_bf16_f32 v172,v128,v129
v_mfma_f32_16x16x32_bf16 v[136:139],a[120:123],a[248:251],v[136:139]
buffer_load_dwordx4 v227,s[16:19],s34 offen nt lds
v_mfma_f32_16x16x32_bf16 v[136:139],a[124:127],a[252:255],v[136:139]
ds_read_b128 a[116:119],v224 offset:256
v_cvt_pk_bf16_f32 v173,v130,v131
v_mfma_f32_16x16x32_bf16 v[140:143],a[128:131],a[252:255],v[200:203]
v_exp_f32 v132,v132
v_mfma_f32_16x16x32_bf16 v[140:143],a[132:135],a[248:251],v[140:143]
v_exp_f32 v133,v133
v_mfma_f32_16x16x32_bf16 v[140:143],a[136:139],a[244:247],v[140:143]
v_exp_f32 v134,v134
v_mfma_f32_16x16x32_bf16 v[140:143],a[140:143],a[240:243],v[140:143]
v_exp_f32 v135,v135
v_mfma_f32_16x16x32_bf16 v[144:147],a[32:35],a[240:243],v[200:203]
ds_read_b128 a[120:123],v224 offset:512
v_cvt_pk_bf16_f32 v174,v132,v133
v_mfma_f32_16x16x32_bf16 v[144:147],a[36:39],a[244:247],v[144:147]
ds_read_b128 a[124:127],v224 offset:768
v_cvt_pk_bf16_f32 v175,v134,v135
v_mfma_f32_16x16x32_bf16 v[144:147],a[40:43],a[248:251],v[144:147]
v_exp_f32 v136,v136
v_mfma_f32_16x16x32_bf16 v[144:147],a[44:47],a[252:255],v[144:147]
ds_read_b128 a[128:131],v224 offset:1792
ds_read_b128 a[132:135],v224 offset:1536
v_mfma_f32_16x16x32_bf16 v[148:151],a[48:51],a[252:255],v[200:203]
v_exp_f32 v137,v137
v_mfma_f32_16x16x32_bf16 v[148:151],a[52:55],a[248:251],v[148:151]
ds_read_b128 a[136:139],v224 offset:1280
ds_read_b128 a[140:143],v224 offset:1024
v_mfma_f32_16x16x32_bf16 v[148:151],a[56:59],a[244:247],v[148:151]
P238:
s_cbranch_execz L_back
v_mfma_f32_16x16x32_bf16 v[148:151],a[60:63],a[240:243],v[148:151]
v_exp_f32 v138,v138
v_mfma_f32_16x16x32_bf16 v[216:219],a[184:187],v[168:171],v[216:219]
v_exp_f32 v139,v139
v_mfma_f32_16x16x32_bf16 v[216:219],a[184:187],v[172:175],v[216:219]
v_xor_b32 v224,0x800,v224
v_cvt_pk_bf16_f32 v176,v136,v137
v_mfma_f32_16x16x32_bf16 v[0:3],a[64:67],v[172:175],v[0:3]
ds_read_b128 a[32:35],v224
ds_read_b128 a[36:39],v224 offset:256
v_mfma_f32_16x16x32_bf16 v[0:3],a[144:147],v[168:171],v[0:3]
buffer_load_dwordx4 v227,s[16:19],s34 offen offset:1024 nt lds
v_mfma_f32_16x16x32_bf16 v[4:7],a[148:151],v[168:171],v[4:7]
ds_read_b128 a[40:43],v224 offset:512
ds_read_b128 a[44:47],v224 offset:768
v_mfma_f32_16x16x32_bf16 v[4:7],a[68:71],v[172:175],v[4:7]
v_cvt_pk_bf16_f32 v177,v138,v139
v_mfma_f32_16x16x32_bf16 v[8:11],a[72:75],v[172:175],v[8:11]
v_exp_f32 v140,v140
v_mfma_f32_16x16x32_bf16 v[8:11],a[152:155],v[168:171],v[8:11]
ds_read_b128 a[48:51],v224 offset:1792
ds_read_b128 a[52:55],v224 offset:1536
v_mfma_f32_16x16x32_bf16 v[12:15],a[156:159],v[168:171],v[12:15]
v_exp_f32 v141,v141
v_mfma_f32_16x16x32_bf16 v[12:15],a[76:79],v[172:175],v[12:15]
v_exp_f32 v142,v142
v_mfma_f32_16x16x32_bf16 v[16:19],a[80:83],v[172:175],v[16:19]
ds_read_b128 a[56:59],v224 offset:1280
ds_read_b128 a[60:63],v224 offset:1024
v_mfma_f32_16x16x32_bf16 v[16:19],a[160:163],v[168:171],v[16:19]
v_exp_f32 v143,v143
v_mfma_f32_16x16x32_bf16 v[20:23],a[164:167],v[168:171],v[20:23]
v_cvt_pk_bf16_f32 v178,v140,v141
v_cvt_pk_bf16_f32 v179,v142,v143
v_mfma_f32_16x16x32_bf16 v[20:23],a[84:87],v[172:175],v[20:23]
P239:
s_cbranch_execz L_back
v_mfma_f32_16x16x32_bf16 v[24:27],a[88:91],v[172:175],v[24:27]
v_exp_f32 v144,v144
v_mfma_f32_16x16x32_bf16 v[24:27],a[168:171],v[168:171],v[24:27]
v_exp_f32 v145,v145
v_mfma_f32_16x16x32_bf16 v[28:31],a[172:175],v[168:171],v[28:31]
v_exp_f32 v146,v146
v_mfma_f32_16x16x32_bf16 v[28:31],a[92:95],v[172:175],v[28:31]
s_waitcnt lgkmcnt(0)
v_exp_f32 v147,v147
v_mfma_f32_16x16x32_bf16 v[128:131],a[112:115],a[192:195],v[188:191]
v_cvt_pk_bf16_f32 v180,v144,v145
v_cvt_pk_bf16_f32 v181,v146,v147
v_mfma_f32_16x16x32_bf16 v[128:131],a[116:119],a[196:199],v[128:131]
v_exp_f32 v148,v148
v_mfma_f32_16x16x32_bf16 v[128:131],a[120:123],a[200:203],v[128:131]
buffer_load_dwordx4 v227,s[16:19],s34 offen offset:2048 nt lds
v_mfma_f32_16x16x32_bf16 v[128:131],a[124:127],a[204:207],v[128:131]
v_exp_f32 v149,v149
v_mfma_f32_16x16x32_bf16 v[132:135],a[128:131],a[204:207],v[188:191]
v_exp_f32 v150,v150
v_mfma_f32_16x16x32_bf16 v[132:135],a[132:135],a[200:203],v[132:135]
v_exp_f32 v151,v151
v_mfma_f32_16x16x32_bf16 v[132:135],a[136:139],a[196:199],v[132:135]
v_cvt_pk_bf16_f32 v182,v148,v149
v_cvt_pk_bf16_f32 v183,v150,v151
v_mfma_f32_16x16x32_bf16 v[132:135],a[140:143],a[192:195],v[132:135]
v_exp_f32 v128,v128
v_mfma_f32_16x16x32_bf16 v[136:139],a[32:35],a[192:195],v[188:191]
v_exp_f32 v129,v129
v_mfma_f32_16x16x32_bf16 v[136:139],a[36:39],a[196:199],v[136:139]
v_exp_f32 v130,v130
v_mfma_f32_16x16x32_bf16 v[136:139],a[40:43],a[200:203],v[136:139]
v_exp_f32 v131,v131
v_mfma_f32_16x16x32_bf16 v[136:139],a[44:47],a[204:207],v[136:139]
v_cvt_pk_bf16_f32 v168,v128,v129
v_cvt_pk_bf16_f32 v169,v130,v131
v_mfma_f32_16x16x32_bf16 v[140:143],a[48:51],a[204:207],v[188:191]
P240:
s_cbranch_execz L_back
v_mfma_f32_16x16x32_bf16 v[140:143],a[52:55],a[200:203],v[140:143]
v_exp_f32 v132,v132
v_mfma_f32_16x16x32_bf16 v[140:143],a[56:59],a[196:199],v[140:143]
v_exp_f32 v133,v133
v_mfma_f32_16x16x32_bf16 v[140:143],a[60:63],a[192:195],v[140:143]
v_exp_f32 v134,v134
v_mfma_f32_16x16x32_bf16 v[216:219],a[188:191],v[176:179],v[216:219]
v_exp_f32 v135,v135
v_mfma_f32_16x16x32_bf16 v[216:219],a[188:191],v[180:183],v[216:219]
v_cvt_pk_bf16_f32 v170,v132,v133
v_cvt_pk_bf16_f32 v171,v134,v135
v_mfma_f32_16x16x32_bf16 v[32:35],a[64:67],v[180:183],v[32:35]
v_exp_f32 v136,v136
v_mfma_f32_16x16x32_bf16 v[32:35],a[144:147],v[176:179],v[32:35]
ds_read_b64_tr_b16 a[144:145],v225
ds_read_b64_tr_b16 a[146:147],v225 offset:1024
v_mfma_f32_16x16x32_bf16 v[36:39],a[148:151],v[176:179],v[36:39]
ds_read_b64_tr_b16 a[148:149],v226
ds_read_b64_tr_b16 a[150:151],v226 offset:1024
v_mfma_f32_16x16x32_bf16 v[36:39],a[68:71],v[180:183],v[36:39]
buffer_load_dwordx4 v227,s[16:19],s34 offen offset:3072 nt lds
v_mfma_f32_16x16x32_bf16 v[40:43],a[72:75],v[180:183],v[40:43]
v_exp_f32 v137,v137
v_mfma_f32_16x16x32_bf16 v[40:43],a[152:155],v[176:179],v[40:43]
ds_read_b64_tr_b16 a[152:153],v225 offset:256
ds_read_b64_tr_b16 a[154:155],v225 offset:1280
v_mfma_f32_16x16x32_bf16 v[44:47],a[156:159],v[176:179],v[44:47]
v_exp_f32 v138,v138
v_mfma_f32_16x16x32_bf16 v[44:47],a[76:79],v[180:183],v[44:47]
ds_read_b64_tr_b16 a[156:157],v226 offset:256
ds_read_b64_tr_b16 a[158:159],v226 offset:1280
v_mfma_f32_16x16x32_bf16 v[48:51],a[80:83],v[180:183],v[48:51]
v_exp_f32 v139,v139
v_mfma_f32_16x16x32_bf16 v[48:51],a[160:163],v[176:179],v[48:51]
ds_read_b64_tr_b16 a[160:161],v225 offset:512
ds_read_b64_tr_b16 a[162:163],v225 offset:1536
v_mfma_f32_16x16x32_bf16 v[52:55],a[164:167],v[176:179],v[52:55]
P241:
s_cbranch_execz L_back
v_mfma_f32_16x16x32_bf16 v[52:55],a[84:87],v[180:183],v[52:55]
s_add_u32 m0,s30,0
ds_read_b64_tr_b16 a[164:165],v226 offset:512
ds_read_b64_tr_b16 a[166:167],v226 offset:1536
v_mfma_f32_16x16x32_bf16 v[56:59],a[88:91],v[180:183],v[56:59]
s_mov_b32 s34,409600
v_cvt_pk_bf16_f32 v172,v136,v137
v_cvt_pk_bf16_f32 v173,v138,v139
v_mfma_f32_16x16x32_bf16 v[56:59],a[168:171],v[176:179],v[56:59]
ds_read_b64_tr_b16 a[168:169],v225 offset:768
ds_read_b64_tr_b16 a[170:171],v225 offset:1792
v_mfma_f32_16x16x32_bf16 v[60:63],a[172:175],v[176:179],v[60:63]
v_exp_f32 v140,v140
v_mfma_f32_16x16x32_bf16 v[60:63],a[92:95],v[180:183],v[60:63]
ds_read_b64_tr_b16 a[172:173],v226 offset:768
ds_read_b64_tr_b16 a[174:175],v226 offset:1792
v_mfma_f32_16x16x32_bf16 v[144:147],a[112:115],a[208:211],v[192:195]
v_xor_b32 v225,0x800,v225
v_xor_b32 v226,0x800,v226
v_mfma_f32_16x16x32_bf16 v[144:147],a[116:119],a[212:215],v[144:147]
ds_read_b64_tr_b16 a[64:65],v225
ds_read_b64_tr_b16 a[66:67],v225 offset:1024
v_mfma_f32_16x16x32_bf16 v[144:147],a[120:123],a[216:219],v[144:147]
buffer_load_dwordx4 v227,s[20:23],s34 offen nt lds
v_mfma_f32_16x16x32_bf16 v[144:147],a[124:127],a[220:223],v[144:147]
ds_read_b64_tr_b16 a[68:69],v226
ds_read_b64_tr_b16 a[70:71],v226 offset:1024
v_mfma_f32_16x16x32_bf16 v[148:151],a[128:131],a[220:223],v[192:195]
v_exp_f32 v141,v141
v_mfma_f32_16x16x32_bf16 v[148:151],a[132:135],a[216:219],v[148:151]
ds_read_b64_tr_b16 a[72:73],v225 offset:256
ds_read_b64_tr_b16 a[74:75],v225 offset:1280
v_mfma_f32_16x16x32_bf16 v[148:151],a[136:139],a[212:215],v[148:151]
P242:
s_cbranch_execz L_back
v_mfma_f32_16x16x32_bf16 v[148:151],a[140:143],a[208:211],v[148:151]
ds_read_b64_tr_b16 a[76:77],v226 offset:256
ds_read_b64_tr_b16 a[78:79],v226 offset:1280
v_mfma_f32_16x16x32_bf16 v[128:131],a[32:35],a[208:211],v[192:195]
v_exp_f32 v142,v142
v_mfma_f32_16x16x32_bf16 v[128:131],a[36:39],a[212:215],v[128:131]
ds_read_b64_tr_b16 a[80:81],v225 offset:512
ds_read_b64_tr_b16 a[82:83],v225 offset:1536
v_mfma_f32_16x16x32_bf16 v[128:131],a[40:43],a[216:219],v[128:131]
v_exp_f32 v143,v143
v_mfma_f32_16x16x32_bf16 v[128:131],a[44:47],a[220:223],v[128:131]
ds_read_b64_tr_b16 a[84:85],v226 offset:512
v_cvt_pk_bf16_f32 v174,v140,v141
v_mfma_f32_16x16x32_bf16 v[132:135],a[48:51],a[220:223],v[192:195]
ds_read_b64_tr_b16 a[86:87],v226 offset:1536
v_cvt_pk_bf16_f32 v175,v142,v143
v_mfma_f32_16x16x32_bf16 v[132:135],a[52:55],a[216:219],v[132:135]
v_exp_f32 v144,v144
v_mfma_f32_16x16x32_bf16 v[132:135],a[56:59],a[212:215],v[132:135]
ds_read_b64_tr_b16 a[88:89],v225 offset:768
ds_read_b64_tr_b16 a[90:91],v225 offset:1792
v_mfma_f32_16x16x32_bf16 v[132:135],a[60:63],a[208:211],v[132:135]
v_exp_f32 v145,v145
v_mfma_f32_16x16x32_bf16 v[216:219],a[176:179],v[168:171],v[216:219]
ds_read_b64_tr_b16 a[92:93],v226 offset:768
ds_read_b64_tr_b16 a[94:95],v226 offset:1792
v_mfma_f32_16x16x32_bf16 v[216:219],a[176:179],v[172:175],v[216:219]
s_waitcnt lgkmcnt(5)
v_exp_f32 v146,v146
v_mfma_f32_16x16x32_bf16 v[64:67],a[64:67],v[172:175],v[64:67]
v_exp_f32 v147,v147
v_mfma_f32_16x16x32_bf16 v[64:67],a[144:147],v[168:171],v[64:67]
buffer_load_dwordx4 v227,s[20:23],s34 offen offset:1024 nt lds
v_mfma_f32_16x16x32_bf16 v[68:71],a[148:151],v[168:171],v[68:71]
P243:
s_cbranch_execz L_back
v_mfma_f32_16x16x32_bf16 v[68:71],a[68:71],v[172:175],v[68:71]
v_cvt_pk_bf16_f32 v176,v144,v145
v_cvt_pk_bf16_f32 v177,v146,v147
v_mfma_f32_16x16x32_bf16 v[72:75],a[72:75],v[172:175],v[72:75]
v_exp_f32 v148,v148
v_mfma_f32_16x16x32_bf16 v[72:75],a[152:155],v[168:171],v[72:75]
v_exp_f32 v149,v149
v_mfma_f32_16x16x32_bf16 v[76:79],a[156:159],v[168:171],v[76:79]
v_exp_f32 v150,v150
v_mfma_f32_16x16x32_bf16 v[76:79],a[76:79],v[172:175],v[76:79]
v_exp_f32 v151,v151
v_mfma_f32_16x16x32_bf16 v[80:83],a[80:83],v[172:175],v[80:83]
v_cvt_pk_bf16_f32 v178,v148,v149
v_cvt_pk_bf16_f32 v179,v150,v151
v_mfma_f32_16x16x32_bf16 v[80:83],a[160:163],v[168:171],v[80:83]
v_exp_f32 v128,v128
v_mfma_f32_16x16x32_bf16 v[84:87],a[164:167],v[168:171],v[84:87]
s_waitcnt lgkmcnt(0)
v_exp_f32 v129,v129
v_mfma_f32_16x16x32_bf16 v[84:87],a[84:87],v[172:175],v[84:87]
v_exp_f32 v130,v130
v_mfma_f32_16x16x32_bf16 v[88:91],a[88:91],v[172:175],v[88:91]
v_exp_f32 v131,v131
v_mfma_f32_16x16x32_bf16 v[88:91],a[168:171],v[168:171],v[88:91]
v_cvt_pk_bf16_f32 v180,v128,v129
v_cvt_pk_bf16_f32 v181,v130,v131
v_mfma_f32_16x16x32_bf16 v[92:95],a[172:175],v[168:171],v[92:95]
v_exp_f32 v132,v132
v_mfma_f32_16x16x32_bf16 v[92:95],a[92:95],v[172:175],v[92:95]
v_exp_f32 v133,v133
v_mfma_f32_16x16x32_bf16 v[136:139],a[32:35],a[96:99],v[204:207]
v_exp_f32 v134,v134
v_mfma_f32_16x16x32_bf16 v[136:139],a[36:39],a[100:103],v[136:139]
v_exp_f32 v135,v135
v_mfma_f32_16x16x32_bf16 v[136:139],a[40:43],a[104:107],v[136:139]
buffer_load_dwordx4 v227,s[20:23],s34 offen offset:2048 nt lds
v_mfma_f32_16x16x32_bf16 v[136:139],a[44:47],a[108:111],v[136:139]
v_cvt_pk_bf16_f32 v182,v132,v133
v_cvt_pk_bf16_f32 v183,v134,v135
v_mfma_f32_16x16x32_bf16 v[140:143],a[48:51],a[108:111],v[204:207]
P244:
s_cbranch_execz L_back
v_mfma_f32_16x16x32_bf16 v[140:143],a[52:55],a[104:107],v[140:143]
v_xor_b32 v224,0x8800,v224
v_xor_b32 v225,0x18800,v225
v_mfma_f32_16x16x32_bf16 v[140:143],a[56:59],a[100:103],v[140:143]
v_exp_f32 v136,v136
v_mfma_f32_16x16x32_bf16 v[140:143],a[60:63],a[96:99],v[140:143]
v_exp_f32 v137,v137
v_mfma_f32_16x16x32_bf16 v[216:219],a[180:183],v[176:179],v[216:219]
v_exp_f32 v138,v138
v_mfma_f32_16x16x32_bf16 v[216:219],a[180:183],v[180:183],v[216:219]
v_exp_f32 v139,v139
v_mfma_f32_16x16x32_bf16 v[96:99],a[64:67],v[180:183],v[96:99]
v_cvt_pk_bf16_f32 v184,v136,v137
v_cvt_pk_bf16_f32 v185,v138,v139
v_mfma_f32_16x16x32_bf16 v[96:99],a[144:147],v[176:179],v[96:99]
v_exp_f32 v140,v140
v_mfma_f32_16x16x32_bf16 v[100:103],a[148:151],v[176:179],v[100:103]
v_exp_f32 v141,v141
v_mfma_f32_16x16x32_bf16 v[100:103],a[68:71],v[180:183],v[100:103]
v_exp_f32 v142,v142
v_mfma_f32_16x16x32_bf16 v[104:107],a[72:75],v[180:183],v[104:107]
v_exp_f32 v143,v143
v_mfma_f32_16x16x32_bf16 v[104:107],a[152:155],v[176:179],v[104:107]
v_cvt_pk_bf16_f32 v186,v140,v141
v_cvt_pk_bf16_f32 v187,v142,v143
v_mfma_f32_16x16x32_bf16 v[108:111],a[156:159],v[176:179],v[108:111]
v_xor_b32 v226,0x18800,v226
v_mfma_f32_16x16x32_bf16 v[108:111],a[76:79],v[180:183],v[108:111]
v_mfma_f32_16x16x32_bf16 v[112:115],a[80:83],v[180:183],v[112:115]
v_mfma_f32_16x16x32_bf16 v[112:115],a[160:163],v[176:179],v[112:115]
buffer_load_dwordx4 v227,s[20:23],s34 offen offset:3072 nt lds
v_mfma_f32_16x16x32_bf16 v[116:119],a[164:167],v[176:179],v[116:119]
v_mfma_f32_16x16x32_bf16 v[116:119],a[84:87],v[180:183],v[116:119]
P245:
s_cbranch_execz L_back
v_mfma_f32_16x16x32_bf16 v[120:123],a[88:91],v[180:183],v[120:123]
v_mfma_f32_16x16x32_bf16 v[120:123],a[168:171],v[176:179],v[120:123]
v_mfma_f32_16x16x32_bf16 v[124:127],a[172:175],v[176:179],v[124:127]
v_mfma_f32_16x16x32_bf16 v[124:127],a[92:95],v[180:183],v[124:127]
v_mfma_f32_16x16x32_bf16 v[144:147],a[112:115],a[224:227],v[196:199]
v_mfma_f32_16x16x32_bf16 v[144:147],a[116:119],a[228:231],v[144:147]
v_mfma_f32_16x16x32_bf16 v[144:147],a[120:123],a[232:235],v[144:147]
v_mfma_f32_16x16x32_bf16 v[144:147],a[124:127],a[236:239],v[144:147]
v_mfma_f32_16x16x32_bf16 v[148:151],a[128:131],a[236:239],v[196:199]
v_mfma_f32_16x16x32_bf16 v[148:151],a[132:135],a[232:235],v[148:151]
v_mfma_f32_16x16x32_bf16 v[148:151],a[136:139],a[228:231],v[148:151]
v_mfma_f32_16x16x32_bf16 v[148:151],a[140:143],a[224:227],v[148:151]
v_mfma_f32_16x16x32_bf16 v[128:131],a[32:35],a[224:227],v[196:199]
v_mfma_f32_16x16x32_bf16 v[128:131],a[36:39],a[228:231],v[128:131]
v_mfma_f32_16x16x32_bf16 v[128:131],a[40:43],a[232:235],v[128:131]
v_mfma_f32_16x16x32_bf16 v[128:131],a[44:47],a[236:239],v[128:131]
v_exp_f32 v144,v144
v_mfma_f32_16x16x32_bf16 v[132:135],a[48:51],a[236:239],v[196:199]
v_exp_f32 v145,v145
v_mfma_f32_16x16x32_bf16 v[132:135],a[52:55],a[232:235],v[132:135]
v_exp_f32 v146,v146
v_mfma_f32_16x16x32_bf16 v[132:135],a[56:59],a[228:231],v[132:135]
v_exp_f32 v147,v147
v_mfma_f32_16x16x32_bf16 v[132:135],a[60:63],a[224:227],v[132:135]
v_cvt_pk_bf16_f32 v168,v144,v145
v_cvt_pk_bf16_f32 v169,v146,v147
v_mfma_f32_16x16x32_bf16 v[220:223],a[176:179],v[184:187],v[220:223]
v_exp_f32 v148,v148
v_mfma_f32_16x16x32_bf16 a[0:3],a[64:67],v[184:187],a[0:3]
v_exp_f32 v149,v149
v_mfma_f32_16x16x32_bf16 a[4:7],a[68:71],v[184:187],a[4:7]
v_exp_f32 v150,v150
v_mfma_f32_16x16x32_bf16 a[8:11],a[72:75],v[184:187],a[8:11]
s_add_u32 m0,s30,16384
v_exp_f32 v151,v151
v_mfma_f32_16x16x32_bf16 a[12:15],a[76:79],v[184:187],a[12:15]
P246:
s_cbranch_execz L_back
v_mfma_f32_16x16x32_bf16 a[16:19],a[80:83],v[184:187],a[16:19]
s_mov_b32 s34,425984
v_cvt_pk_bf16_f32 v170,v148,v149
v_cvt_pk_bf16_f32 v171,v150,v151
v_mfma_f32_16x16x32_bf16 a[20:23],a[84:87],v[184:187],a[20:23]
v_exp_f32 v128,v128
v_mfma_f32_16x16x32_bf16 a[24:27],a[88:91],v[184:187],a[24:27]
s_waitcnt vmcnt(8) lgkmcnt(0)
s_barrier
v_mfma_f32_16x16x32_bf16 a[28:31],a[92:95],v[184:187],a[28:31]
v_exp_f32 v129,v129
v_mfma_f32_16x16x32_bf16 v[136:139],a[112:115],a[240:243],v[200:203]
v_exp_f32 v130,v130
v_mfma_f32_16x16x32_bf16 v[136:139],a[116:119],a[244:247],v[136:139]
v_exp_f32 v131,v131
v_mfma_f32_16x16x32_bf16 v[136:139],a[120:123],a[248:251],v[136:139]
buffer_load_dwordx4 v227,s[16:19],s34 offen nt lds
v_mfma_f32_16x16x32_bf16 v[136:139],a[124:127],a[252:255],v[136:139]
ds_read_b128 a[112:115],v224
v_cvt_pk_bf16_f32 v172,v128,v129
v_mfma_f32_16x16x32_bf16 v[140:143],a[128:131],a[252:255],v[200:203]
ds_read_b128 a[116:119],v224 offset:256
v_cvt_pk_bf16_f32 v173,v130,v131
v_mfma_f32_16x16x32_bf16 v[140:143],a[132:135],a[248:251],v[140:143]
v_exp_f32 v132,v132
v_mfma_f32_16x16x32_bf16 v[140:143],a[136:139],a[244:247],v[140:143]
v_exp_f32 v133,v133
v_mfma_f32_16x16x32_bf16 v[140:143],a[140:143],a[240:243],v[140:143]
v_exp_f32 v134,v134
v_mfma_f32_16x16x32_bf16 v[144:147],a[32:35],a[240:243],v[200:203]
v_exp_f32 v135,v135
v_mfma_f32_16x16x32_bf16 v[144:147],a[36:39],a[244:247],v[144:147]
ds_read_b128 a[120:123],v224 offset:512
v_cvt_pk_bf16_f32 v174,v132,v133
v_mfma_f32_16x16x32_bf16 v[144:147],a[40:43],a[248:251],v[144:147]
ds_read_b128 a[124:127],v224 offset:768
v_cvt_pk_bf16_f32 v175,v134,v135
v_mfma_f32_16x16x32_bf16 v[144:147],a[44:47],a[252:255],v[144:147]
P247:
s_cbranch_execz L_back
v_mfma_f32_16x16x32_bf16 v[148:151],a[48:51],a[252:255],v[200:203]
ds_read_b128 a[128:131],v224 offset:1792
ds_read_b128 a[132:135],v224 offset:1536
v_mfma_f32_16x16x32_bf16 v[148:151],a[52:55],a[248:251],v[148:151]
v_exp_f32 v136,v136
v_mfma_f32_16x16x32_bf16 v[148:151],a[56:59],a[244:247],v[148:151]
ds_read_b128 a[136:139],v224 offset:1280
ds_read_b128 a[140:143],v224 offset:1024
v_mfma_f32_16x16x32_bf16 v[148:151],a[60:63],a[240:243],v[148:151]
v_exp_f32 v137,v137
v_mfma_f32_16x16x32_bf16 v[216:219],a[184:187],v[168:171],v[216:219]
v_exp_f32 v138,v138
v_mfma_f32_16x16x32_bf16 v[216:219],a[184:187],v[172:175],v[216:219]
v_exp_f32 v139,v139
v_mfma_f32_16x16x32_bf16 v[0:3],a[64:67],v[172:175],v[0:3]
v_xor_b32 v224,0x800,v224
v_cvt_pk_bf16_f32 v176,v136,v137
v_mfma_f32_16x16x32_bf16 v[0:3],a[144:147],v[168:171],v[0:3]
buffer_load_dwordx4 v227,s[16:19],s34 offen offset:1024 nt lds
v_mfma_f32_16x16x32_bf16 v[4:7],a[148:151],v[168:171],v[4:7]
ds_read_b128 a[32:35],v224
ds_read_b128 a[36:39],v224 offset:256
v_mfma_f32_16x16x32_bf16 v[4:7],a[68:71],v[172:175],v[4:7]
v_cvt_pk_bf16_f32 v177,v138,v139
v_mfma_f32_16x16x32_bf16 v[8:11],a[72:75],v[172:175],v[8:11]
ds_read_b128 a[40:43],v224 offset:512
ds_read_b128 a[44:47],v224 offset:768
v_mfma_f32_16x16x32_bf16 v[8:11],a[152:155],v[168:171],v[8:11]
v_exp_f32 v140,v140
v_mfma_f32_16x16x32_bf16 v[12:15],a[156:159],v[168:171],v[12:15]
ds_read_b128 a[48:51],v224 offset:1792
ds_read_b128 a[52:55],v224 offset:1536
v_mfma_f32_16x16x32_bf16 v[12:15],a[76:79],v[172:175],v[12:15]
P248:
s_cbranch_execz L_back
v_mfma_f32_16x16x32_bf16 v[16:19],a[80:83],v[172:175],v[16:19]
v_exp_f32 v141,v141
v_mfma_f32_16x16x32_bf16 v[16:19],a[160:163],v[168:171],v[16:19]
v_exp_f32 v142,v142
v_mfma_f32_16x16x32_bf16 v[20:23],a[164:167],v[168:171],v[20:23]
ds_read_b128 a[56:59],v224 offset:1280
ds_read_b128 a[60:63],v224 offset:1024
v_mfma_f32_16x16x32_bf16 v[20:23],a[84:87],v[172:175],v[20:23]
v_exp_f32 v143,v143
v_mfma_f32_16x16x32_bf16 v[24:27],a[88:91],v[172:175],v[24:27]
v_cvt_pk_bf16_f32 v178,v140,v141
v_cvt_pk_bf16_f32 v179,v142,v143
v_mfma_f32_16x16x32_bf16 v[24:27],a[168:171],v[168:171],v[24:27]
v_exp_f32 v144,v144
v_mfma_f32_16x16x32_bf16 v[28:31],a[172:175],v[168:171],v[28:31]
v_exp_f32 v145,v145
v_mfma_f32_16x16x32_bf16 v[28:31],a[92:95],v[172:175],v[28:31]
s_waitcnt lgkmcnt(2)
v_exp_f32 v146,v146
v_mfma_f32_16x16x32_bf16 v[128:131],a[112:115],a[192:195],v[188:191]
v_exp_f32 v147,v147
v_mfma_f32_16x16x32_bf16 v[128:131],a[116:119],a[196:199],v[128:131]
v_cvt_pk_bf16_f32 v180,v144,v145
v_cvt_pk_bf16_f32 v181,v146,v147
v_mfma_f32_16x16x32_bf16 v[128:131],a[120:123],a[200:203],v[128:131]
buffer_load_dwordx4 v227,s[16:19],s34 offen offset:2048 nt lds
v_mfma_f32_16x16x32_bf16 v[128:131],a[124:127],a[204:207],v[128:131]
v_exp_f32 v148,v148
v_mfma_f32_16x16x32_bf16 v[132:135],a[128:131],a[204:207],v[188:191]
v_exp_f32 v149,v149
v_mfma_f32_16x16x32_bf16 v[132:135],a[132:135],a[200:203],v[132:135]
v_exp_f32 v150,v150
v_mfma_f32_16x16x32_bf16 v[132:135],a[136:139],a[196:199],v[132:135]
v_exp_f32 v151,v151
v_mfma_f32_16x16x32_bf16 v[132:135],a[140:143],a[192:195],v[132:135]
v_cvt_pk_bf16_f32 v182,v148,v149
v_cvt_pk_bf16_f32 v183,v150,v151
v_mfma_f32_16x16x32_bf16 v[136:139],a[32:35],a[192:195],v[188:191]
P249:
s_cbranch_execz L_back
v_mfma_f32_16x16x32_bf16 v[136:139],a[36:39],a[196:199],v[136:139]
v_exp_f32 v128,v128
v_mfma_f32_16x16x32_bf16 v[136:139],a[40:43],a[200:203],v[136:139]
v_exp_f32 v129,v129
v_mfma_f32_16x16x32_bf16 v[136:139],a[44:47],a[204:207],v[136:139]
v_exp_f32 v130,v130
v_mfma_f32_16x16x32_bf16 v[140:143],a[48:51],a[204:207],v[188:191]
v_exp_f32 v131,v131
v_mfma_f32_16x16x32_bf16 v[140:143],a[52:55],a[200:203],v[140:143]
s_waitcnt lgkmcnt(0)
v_cvt_pk_bf16_f32 v168,v128,v129
v_cvt_pk_bf16_f32 v169,v130,v131
v_mfma_f32_16x16x32_bf16 v[140:143],a[56:59],a[196:199],v[140:143]
v_exp_f32 v132,v132
v_mfma_f32_16x16x32_bf16 v[140:143],a[60:63],a[192:195],v[140:143]
v_exp_f32 v133,v133
v_mfma_f32_16x16x32_bf16 v[216:219],a[188:191],v[176:179],v[216:219]
v_exp_f32 v134,v134
v_mfma_f32_16x16x32_bf16 v[216:219],a[188:191],v[180:183],v[216:219]
v_exp_f32 v135,v135
v_mfma_f32_16x16x32_bf16 v[32:35],a[64:67],v[180:183],v[32:35]
v_cvt_pk_bf16_f32 v170,v132,v133
v_cvt_pk_bf16_f32 v171,v134,v135
v_mfma_f32_16x16x32_bf16 v[32:35],a[144:147],v[176:179],v[32:35]
ds_read_b64_tr_b16 a[144:145],v225
ds_read_b64_tr_b16 a[146:147],v225 offset:1024
v_mfma_f32_16x16x32_bf16 v[36:39],a[148:151],v[176:179],v[36:39]
ds_read_b64_tr_b16 a[148:149],v226
ds_read_b64_tr_b16 a[150:151],v226 offset:1024
v_mfma_f32_16x16x32_bf16 v[36:39],a[68:71],v[180:183],v[36:39]
buffer_load_dwordx4 v227,s[16:19],s34 offen offset:3072 nt lds
v_mfma_f32_16x16x32_bf16 v[40:43],a[72:75],v[180:183],v[40:43]
v_exp_f32 v136,v136
v_mfma_f32_16x16x32_bf16 v[40:43],a[152:155],v[176:179],v[40:43]
ds_read_b64_tr_b16 a[152:153],v225 offset:256
ds_read_b64_tr_b16 a[154:155],v225 offset:1280
v_mfma_f32_16x16x32_bf16 v[44:47],a[156:159],v[176:179],v[44:47]
P250:
s_cbranch_execz L_back
v_mfma_f32_16x16x32_bf16 v[44:47],a[76:79],v[180:183],v[44:47]
ds_read_b64_tr_b16 a[156:157],v226 offset:256
ds_read_b64_tr_b16 a[158:159],v226 offset:1280
v_mfma_f32_16x16x32_bf16 v[48:51],a[80:83],v[180:183],v[48:51]
v_exp_f32 v137,v137
v_mfma_f32_16x16x32_bf16 v[48:51],a[160:163],v[176:179],v[48:51]
ds_read_b64_tr_b16 a[160:161],v225 offset:512
ds_read_b64_tr_b16 a[162:163],v225 offset:1536
v_mfma_f32_16x16x32_bf16 v[52:55],a[164:167],v[176:179],v[52:55]
s_add_u32 m0,s30,32768
v_exp_f32 v138,v138
v_mfma_f32_16x16x32_bf16 v[52:55],a[84:87],v[180:183],v[52:55]
s_mov_b32 s34,425984
ds_read_b64_tr_b16 a[164:165],v226 offset:512
ds_read_b64_tr_b16 a[166:167],v226 offset:1536
v_mfma_f32_16x16x32_bf16 v[56:59],a[88:91],v[180:183],v[56:59]
v_exp_f32 v139,v139
v_mfma_f32_16x16x32_bf16 v[56:59],a[168:171],v[176:179],v[56:59]
ds_read_b64_tr_b16 a[168:169],v225 offset:768
ds_read_b64_tr_b16 a[170:171],v225 offset:1792
v_mfma_f32_16x16x32_bf16 v[60:63],a[172:175],v[176:179],v[60:63]
v_cvt_pk_bf16_f32 v172,v136,v137
v_cvt_pk_bf16_f32 v173,v138,v139
v_mfma_f32_16x16x32_bf16 v[60:63],a[92:95],v[180:183],v[60:63]
ds_read_b64_tr_b16 a[172:173],v226 offset:768
ds_read_b64_tr_b16 a[174:175],v226 offset:1792
v_mfma_f32_16x16x32_bf16 v[144:147],a[112:115],a[208:211],v[192:195]
v_xor_b32 v225,0x800,v225
v_xor_b32 v226,0x800,v226
v_mfma_f32_16x16x32_bf16 v[144:147],a[116:119],a[212:215],v[144:147]
ds_read_b64_tr_b16 a[64:65],v225
ds_read_b64_tr_b16 a[66:67],v225 offset:1024
v_mfma_f32_16x16x32_bf16 v[144:147],a[120:123],a[216:219],v[144:147]
P251:
s_cbranch_execz L_back
Z15:
s_cbranch_execz Z19
v_mfma_f32_16x16x32_bf16 v[144:147],a[124:127],a[220:223],v[144:147]
buffer_load_dwordx4 v227,s[20:23],s34 offen nt lds
v_mfma_f32_16x16x32_bf16 v[148:151],a[128:131],a[220:223],v[192:195]
ds_read_b64_tr_b16 a[68:69],v226
ds_read_b64_tr_b16 a[70:71],v226 offset:1024
v_mfma_f32_16x16x32_bf16 v[148:151],a[132:135],a[216:219],v[148:151]
v_exp_f32 v140,v140
v_mfma_f32_16x16x32_bf16 v[148:151],a[136:139],a[212:215],v[148:151]
ds_read_b64_tr_b16 a[72:73],v225 offset:256
ds_read_b64_tr_b16 a[74:75],v225 offset:1280
v_mfma_f32_16x16x32_bf16 v[148:151],a[140:143],a[208:211],v[148:151]
v_exp_f32 v141,v141
v_mfma_f32_16x16x32_bf16 v[128:131],a[32:35],a[208:211],v[192:195]
ds_read_b64_tr_b16 a[76:77],v226 offset:256
ds_read_b64_tr_b16 a[78:79],v226 offset:1280
v_mfma_f32_16x16x32_bf16 v[128:131],a[36:39],a[212:215],v[128:131]
v_exp_f32 v142,v142
v_mfma_f32_16x16x32_bf16 v[128:131],a[40:43],a[216:219],v[128:131]
ds_read_b64_tr_b16 a[80:81],v225 offset:512
ds_read_b64_tr_b16 a[82:83],v225 offset:1536
v_mfma_f32_16x16x32_bf16 v[128:131],a[44:47],a[220:223],v[128:131]
v_exp_f32 v143,v143
v_mfma_f32_16x16x32_bf16 v[132:135],a[48:51],a[220:223],v[192:195]
ds_read_b64_tr_b16 a[84:85],v226 offset:512
v_cvt_pk_bf16_f32 v174,v140,v141
v_mfma_f32_16x16x32_bf16 v[132:135],a[52:55],a[216:219],v[132:135]
ds_read_b64_tr_b16 a[86:87],v226 offset:1536
v_cvt_pk_bf16_f32 v175,v142,v143
v_mfma_f32_16x16x32_bf16 v[132:135],a[56:59],a[212:215],v[132:135]
v_exp_f32 v144,v144
v_mfma_f32_16x16x32_bf16 v[132:135],a[60:63],a[208:211],v[132:135]
ds_read_b64_tr_b16 a[88:89],v225 offset:768
ds_read_b64_tr_b16 a[90:91],v225 offset:1792
v_mfma_f32_16x16x32_bf16 v[216:219],a[176:179],v[168:171],v[216:219]
P252:
s_cbranch_execz L_back
v_mfma_f32_16x16x32_bf16 v[216:219],a[176:179],v[172:175],v[216:219]
s_waitcnt lgkmcnt(4)
ds_read_b64_tr_b16 a[92:93],v226 offset:768
ds_read_b64_tr_b16 a[94:95],v226 offset:1792
v_mfma_f32_16x16x32_bf16 v[64:67],a[64:67],v[172:175],v[64:67]
v_exp_f32 v145,v145
v_mfma_f32_16x16x32_bf16 v[64:67],a[144:147],v[168:171],v[64:67]
buffer_load_dwordx4 v227,s[20:23],s34 offen offset:1024 nt lds
v_mfma_f32_16x16x32_bf16 v[68:71],a[148:151],v[168:171],v[68:71]
v_exp_f32 v146,v146
v_mfma_f32_16x16x32_bf16 v[68:71],a[68:71],v[172:175],v[68:71]
v_exp_f32 v147,v147
v_mfma_f32_16x16x32_bf16 v[72:75],a[72:75],v[172:175],v[72:75]
v_cvt_pk_bf16_f32 v176,v144,v145
v_cvt_pk_bf16_f32 v177,v146,v147
v_mfma_f32_16x16x32_bf16 v[72:75],a[152:155],v[168:171],v[72:75]
v_exp_f32 v148,v148
v_mfma_f32_16x16x32_bf16 v[76:79],a[156:159],v[168:171],v[76:79]
v_exp_f32 v149,v149
v_mfma_f32_16x16x32_bf16 v[76:79],a[76:79],v[172:175],v[76:79]
v_exp_f32 v150,v150
v_mfma_f32_16x16x32_bf16 v[80:83],a[80:83],v[172:175],v[80:83]
v_exp_f32 v151,v151
v_mfma_f32_16x16x32_bf16 v[80:83],a[160:163],v[168:171],v[80:83]
v_cvt_pk_bf16_f32 v178,v148,v149
v_cvt_pk_bf16_f32 v179,v150,v151
v_mfma_f32_16x16x32_bf16 v[84:87],a[164:167],v[168:171],v[84:87]
s_waitcnt lgkmcnt(0)
v_exp_f32 v128,v128
v_mfma_f32_16x16x32_bf16 v[84:87],a[84:87],v[172:175],v[84:87]
v_exp_f32 v129,v129
v_mfma_f32_16x16x32_bf16 v[88:91],a[88:91],v[172:175],v[88:91]
v_exp_f32 v130,v130
v_mfma_f32_16x16x32_bf16 v[88:91],a[168:171],v[168:171],v[88:91]
v_exp_f32 v131,v131
v_mfma_f32_16x16x32_bf16 v[92:95],a[172:175],v[168:171],v[92:95]
P253:
s_cbranch_execz L_back
v_mfma_f32_16x16x32_bf16 v[92:95],a[92:95],v[172:175],v[92:95]
v_cvt_pk_bf16_f32 v180,v128,v129
v_cvt_pk_bf16_f32 v181,v130,v131
v_mfma_f32_16x16x32_bf16 v[136:139],a[32:35],a[96:99],v[204:207]
v_exp_f32 v132,v132
v_mfma_f32_16x16x32_bf16 v[136:139],a[36:39],a[100:103],v[136:139]
v_exp_f32 v133,v133
v_mfma_f32_16x16x32_bf16 v[136:139],a[40:43],a[104:107],v[136:139]
buffer_load_dwordx4 v227,s[20:23],s34 offen offset:2048 nt lds
v_mfma_f32_16x16x32_bf16 v[136:139],a[44:47],a[108:111],v[136:139]
v_exp_f32 v134,v134
v_mfma_f32_16x16x32_bf16 v[140:143],a[48:51],a[108:111],v[204:207]
v_exp_f32 v135,v135
v_mfma_f32_16x16x32_bf16 v[140:143],a[52:55],a[104:107],v[140:143]
v_cvt_pk_bf16_f32 v182,v132,v133
v_cvt_pk_bf16_f32 v183,v134,v135
v_mfma_f32_16x16x32_bf16 v[140:143],a[56:59],a[100:103],v[140:143]
v_xor_b32 v224,0x18800,v224
v_xor_b32 v225,0x10800,v225
v_mfma_f32_16x16x32_bf16 v[140:143],a[60:63],a[96:99],v[140:143]
v_exp_f32 v136,v136
v_mfma_f32_16x16x32_bf16 v[216:219],a[180:183],v[176:179],v[216:219]
v_exp_f32 v137,v137
v_mfma_f32_16x16x32_bf16 v[216:219],a[180:183],v[180:183],v[216:219]
v_exp_f32 v138,v138
v_mfma_f32_16x16x32_bf16 v[96:99],a[64:67],v[180:183],v[96:99]
v_exp_f32 v139,v139
v_mfma_f32_16x16x32_bf16 v[96:99],a[144:147],v[176:179],v[96:99]
v_cvt_pk_bf16_f32 v184,v136,v137
v_cvt_pk_bf16_f32 v185,v138,v139
v_mfma_f32_16x16x32_bf16 v[100:103],a[148:151],v[176:179],v[100:103]
v_exp_f32 v140,v140
v_mfma_f32_16x16x32_bf16 v[100:103],a[68:71],v[180:183],v[100:103]
v_exp_f32 v141,v141
v_mfma_f32_16x16x32_bf16 v[104:107],a[72:75],v[180:183],v[104:107]
v_exp_f32 v142,v142
v_mfma_f32_16x16x32_bf16 v[104:107],a[152:155],v[176:179],v[104:107]
P254:
s_cbranch_execz L_back
v_mfma_f32_16x16x32_bf16 v[108:111],a[156:159],v[176:179],v[108:111]
v_exp_f32 v143,v143
v_mfma_f32_16x16x32_bf16 v[108:111],a[76:79],v[180:183],v[108:111]
v_cvt_pk_bf16_f32 v186,v140,v141
v_cvt_pk_bf16_f32 v187,v142,v143
v_mfma_f32_16x16x32_bf16 v[112:115],a[80:83],v[180:183],v[112:115]
v_xor_b32 v226,0x10800,v226
v_mfma_f32_16x16x32_bf16 v[112:115],a[160:163],v[176:179],v[112:115]
buffer_load_dwordx4 v227,s[20:23],s34 offen offset:3072 nt lds
v_mfma_f32_16x16x32_bf16 v[116:119],a[164:167],v[176:179],v[116:119]
v_mfma_f32_16x16x32_bf16 v[116:119],a[84:87],v[180:183],v[116:119]
v_mfma_f32_16x16x32_bf16 v[120:123],a[88:91],v[180:183],v[120:123]
v_mfma_f32_16x16x32_bf16 v[120:123],a[168:171],v[176:179],v[120:123]
v_mfma_f32_16x16x32_bf16 v[124:127],a[172:175],v[176:179],v[124:127]
v_mfma_f32_16x16x32_bf16 v[124:127],a[92:95],v[180:183],v[124:127]
v_mfma_f32_16x16x32_bf16 v[144:147],a[112:115],a[224:227],v[196:199]
v_mfma_f32_16x16x32_bf16 v[144:147],a[116:119],a[228:231],v[144:147]
v_mfma_f32_16x16x32_bf16 v[144:147],a[120:123],a[232:235],v[144:147]
v_mfma_f32_16x16x32_bf16 v[144:147],a[124:127],a[236:239],v[144:147]
v_mfma_f32_16x16x32_bf16 v[148:151],a[128:131],a[236:239],v[196:199]
v_mfma_f32_16x16x32_bf16 v[148:151],a[132:135],a[232:235],v[148:151]
v_mfma_f32_16x16x32_bf16 v[148:151],a[136:139],a[228:231],v[148:151]
v_mfma_f32_16x16x32_bf16 v[148:151],a[140:143],a[224:227],v[148:151]
v_mfma_f32_16x16x32_bf16 v[128:131],a[32:35],a[224:227],v[196:199]
v_mfma_f32_16x16x32_bf16 v[128:131],a[36:39],a[228:231],v[128:131]
v_mfma_f32_16x16x32_bf16 v[128:131],a[40:43],a[232:235],v[128:131]
v_mfma_f32_16x16x32_bf16 v[128:131],a[44:47],a[236:239],v[128:131]
v_exp_f32 v144,v144
v_mfma_f32_16x16x32_bf16 v[132:135],a[48:51],a[236:239],v[196:199]
v_exp_f32 v145,v145
v_mfma_f32_16x16x32_bf16 v[132:135],a[52:55],a[232:235],v[132:135]
v_exp_f32 v146,v146
v_mfma_f32_16x16x32_bf16 v[132:135],a[56:59],a[228:231],v[132:135]
P255:
s_cbranch_execz L_back
v_mfma_f32_16x16x32_bf16 v[132:135],a[60:63],a[224:227],v[132:135]
v_exp_f32 v147,v147
v_mfma_f32_16x16x32_bf16 v[220:223],a[176:179],v[184:187],v[220:223]
v_cvt_pk_bf16_f32 v168,v144,v145
v_cvt_pk_bf16_f32 v169,v146,v147
v_mfma_f32_16x16x32_bf16 a[0:3],a[64:67],v[184:187],a[0:3]
v_exp_f32 v148,v148
v_mfma_f32_16x16x32_bf16 a[4:7],a[68:71],v[184:187],a[4:7]
v_exp_f32 v149,v149
v_mfma_f32_16x16x32_bf16 a[8:11],a[72:75],v[184:187],a[8:11]
s_add_u32 m0,s30,49152
v_exp_f32 v150,v150
v_mfma_f32_16x16x32_bf16 a[12:15],a[76:79],v[184:187],a[12:15]
s_mov_b32 s34,442368
v_exp_f32 v151,v151
v_mfma_f32_16x16x32_bf16 a[16:19],a[80:83],v[184:187],a[16:19]
v_cvt_pk_bf16_f32 v170,v148,v149
v_cvt_pk_bf16_f32 v171,v150,v151
v_mfma_f32_16x16x32_bf16 a[20:23],a[84:87],v[184:187],a[20:23]
v_exp_f32 v128,v128
v_mfma_f32_16x16x32_bf16 a[24:27],a[88:91],v[184:187],a[24:27]
s_waitcnt vmcnt(8) lgkmcnt(0)
s_barrier
v_mfma_f32_16x16x32_bf16 a[28:31],a[92:95],v[184:187],a[28:31]
v_exp_f32 v129,v129
v_mfma_f32_16x16x32_bf16 v[136:139],a[112:115],a[240:243],v[200:203]
v_exp_f32 v130,v130
v_mfma_f32_16x16x32_bf16 v[136:139],a[116:119],a[244:247],v[136:139]
v_exp_f32 v131,v131
v_mfma_f32_16x16x32_bf16 v[136:139],a[120:123],a[248:251],v[136:139]
buffer_load_dwordx4 v227,s[16:19],s34 offen nt lds
v_mfma_f32_16x16x32_bf16 v[136:139],a[124:127],a[252:255],v[136:139]
ds_read_b128 a[112:115],v224
v_cvt_pk_bf16_f32 v172,v128,v129
v_mfma_f32_16x16x32_bf16 v[140:143],a[128:131],a[252:255],v[200:203]
ds_read_b128 a[116:119],v224 offset:256
v_cvt_pk_bf16_f32 v173,v130,v131
v_mfma_f32_16x16x32_bf16 v[140:143],a[132:135],a[248:251],v[140:143]
P256:
s_cbranch_execz L_back
v_mfma_f32_16x16x32_bf16 v[140:143],a[136:139],a[244:247],v[140:143]
v_exp_f32 v132,v132
v_mfma_f32_16x16x32_bf16 v[140:143],a[140:143],a[240:243],v[140:143]
v_exp_f32 v133,v133
v_mfma_f32_16x16x32_bf16 v[144:147],a[32:35],a[240:243],v[200:203]
v_exp_f32 v134,v134
v_mfma_f32_16x16x32_bf16 v[144:147],a[36:39],a[244:247],v[144:147]
v_exp_f32 v135,v135
v_mfma_f32_16x16x32_bf16 v[144:147],a[40:43],a[248:251],v[144:147]
ds_read_b128 a[120:123],v224 offset:512
v_cvt_pk_bf16_f32 v174,v132,v133
v_mfma_f32_16x16x32_bf16 v[144:147],a[44:47],a[252:255],v[144:147]
ds_read_b128 a[124:127],v224 offset:768
v_cvt_pk_bf16_f32 v175,v134,v135
v_mfma_f32_16x16x32_bf16 v[148:151],a[48:51],a[252:255],v[200:203]
v_exp_f32 v136,v136
v_mfma_f32_16x16x32_bf16 v[148:151],a[52:55],a[248:251],v[148:151]
ds_read_b128 a[128:131],v224 offset:1792
ds_read_b128 a[132:135],v224 offset:1536
v_mfma_f32_16x16x32_bf16 v[148:151],a[56:59],a[244:247],v[148:151]
v_exp_f32 v137,v137
v_mfma_f32_16x16x32_bf16 v[148:151],a[60:63],a[240:243],v[148:151]
ds_read_b128 a[136:139],v224 offset:1280
ds_read_b128 a[140:143],v224 offset:1024
v_mfma_f32_16x16x32_bf16 v[216:219],a[184:187],v[168:171],v[216:219]
v_exp_f32 v138,v138
v_mfma_f32_16x16x32_bf16 v[216:219],a[184:187],v[172:175],v[216:219]
v_exp_f32 v139,v139
v_mfma_f32_16x16x32_bf16 v[0:3],a[64:67],v[172:175],v[0:3]
v_xor_b32 v224,0x800,v224
v_cvt_pk_bf16_f32 v176,v136,v137
v_mfma_f32_16x16x32_bf16 v[0:3],a[144:147],v[168:171],v[0:3]
buffer_load_dwordx4 v227,s[16:19],s34 offen offset:1024 nt lds
v_mfma_f32_16x16x32_bf16 v[4:7],a[148:151],v[168:171],v[4:7]
ds_read_b128 a[32:35],v224
ds_read_b128 a[36:39],v224 offset:256
v_mfma_f32_16x16x32_bf16 v[4:7],a[68:71],v[172:175],v[4:7]
P257:
s_cbranch_execz L_back
v_mfma_f32_16x16x32_bf16 v[8:11],a[72:75],v[172:175],v[8:11]
ds_read_b128 a[40:43],v224 offset:512
ds_read_b128 a[44:47],v224 offset:768
v_mfma_f32_16x16x32_bf16 v[8:11],a[152:155],v[168:171],v[8:11]
v_cvt_pk_bf16_f32 v177,v138,v139
v_mfma_f32_16x16x32_bf16 v[12:15],a[156:159],v[168:171],v[12:15]
v_exp_f32 v140,v140
v_mfma_f32_16x16x32_bf16 v[12:15],a[76:79],v[172:175],v[12:15]
ds_read_b128 a[48:51],v224 offset:1792
ds_read_b128 a[52:55],v224 offset:1536
v_mfma_f32_16x16x32_bf16 v[16:19],a[80:83],v[172:175],v[16:19]
v_exp_f32 v141,v141
v_mfma_f32_16x16x32_bf16 v[16:19],a[160:163],v[168:171],v[16:19]
v_exp_f32 v142,v142
v_mfma_f32_16x16x32_bf16 v[20:23],a[164:167],v[168:171],v[20:23]
ds_read_b128 a[56:59],v224 offset:1280
ds_read_b128 a[60:63],v224 offset:1024
v_mfma_f32_16x16x32_bf16 v[20:23],a[84:87],v[172:175],v[20:23]
v_exp_f32 v143,v143
v_mfma_f32_16x16x32_bf16 v[24:27],a[88:91],v[172:175],v[24:27]
v_cvt_pk_bf16_f32 v178,v140,v141
v_cvt_pk_bf16_f32 v179,v142,v143
v_mfma_f32_16x16x32_bf16 v[24:27],a[168:171],v[168:171],v[24:27]
v_exp_f32 v144,v144
v_mfma_f32_16x16x32_bf16 v[28:31],a[172:175],v[168:171],v[28:31]
v_exp_f32 v145,v145
v_mfma_f32_16x16x32_bf16 v[28:31],a[92:95],v[172:175],v[28:31]
s_waitcnt lgkmcnt(2)
v_exp_f32 v146,v146
v_mfma_f32_16x16x32_bf16 v[128:131],a[112:115],a[192:195],v[188:191]
v_exp_f32 v147,v147
v_mfma_f32_16x16x32_bf16 v[128:131],a[116:119],a[196:199],v[128:131]
v_cvt_pk_bf16_f32 v180,v144,v145
v_cvt_pk_bf16_f32 v181,v146,v147
v_mfma_f32_16x16x32_bf16 v[128:131],a[120:123],a[200:203],v[128:131]
P258:
s_cbranch_execz L_back
v_mfma_f32_16x16x32_bf16 v[128:131],a[124:127],a[204:207],v[128:131]
buffer_load_dwordx4 v227,s[16:19],s34 offen offset:2048 nt lds
v_mfma_f32_16x16x32_bf16 v[132:135],a[128:131],a[204:207],v[188:191]
v_exp_f32 v148,v148
v_mfma_f32_16x16x32_bf16 v[132:135],a[132:135],a[200:203],v[132:135]
v_exp_f32 v149,v149
v_mfma_f32_16x16x32_bf16 v[132:135],a[136:139],a[196:199],v[132:135]
v_exp_f32 v150,v150
v_mfma_f32_16x16x32_bf16 v[132:135],a[140:143],a[192:195],v[132:135]
v_exp_f32 v151,v151
v_mfma_f32_16x16x32_bf16 v[136:139],a[32:35],a[192:195],v[188:191]
v_cvt_pk_bf16_f32 v182,v148,v149
v_cvt_pk_bf16_f32 v183,v150,v151
v_mfma_f32_16x16x32_bf16 v[136:139],a[36:39],a[196:199],v[136:139]
v_exp_f32 v128,v128
v_mfma_f32_16x16x32_bf16 v[136:139],a[40:43],a[200:203],v[136:139]
v_exp_f32 v129,v129
v_mfma_f32_16x16x32_bf16 v[136:139],a[44:47],a[204:207],v[136:139]
v_exp_f32 v130,v130
v_mfma_f32_16x16x32_bf16 v[140:143],a[48:51],a[204:207],v[188:191]
v_exp_f32 v131,v131
v_mfma_f32_16x16x32_bf16 v[140:143],a[52:55],a[200:203],v[140:143]
s_waitcnt lgkmcnt(0)
v_cvt_pk_bf16_f32 v168,v128,v129
v_cvt_pk_bf16_f32 v169,v130,v131
v_mfma_f32_16x16x32_bf16 v[140:143],a[56:59],a[196:199],v[140:143]
v_exp_f32 v132,v132
v_mfma_f32_16x16x32_bf16 v[140:143],a[60:63],a[192:195],v[140:143]
v_exp_f32 v133,v133
v_mfma_f32_16x16x32_bf16 v[216:219],a[188:191],v[176:179],v[216:219]
v_exp_f32 v134,v134
v_mfma_f32_16x16x32_bf16 v[216:219],a[188:191],v[180:183],v[216:219]
v_exp_f32 v135,v135
v_mfma_f32_16x16x32_bf16 v[32:35],a[64:67],v[180:183],v[32:35]
v_cvt_pk_bf16_f32 v170,v132,v133
v_cvt_pk_bf16_f32 v171,v134,v135
v_mfma_f32_16x16x32_bf16 v[32:35],a[144:147],v[176:179],v[32:35]
ds_read_b64_tr_b16 a[144:145],v225
ds_read_b64_tr_b16 a[146:147],v225 offset:1024
v_mfma_f32_16x16x32_bf16 v[36:39],a[148:151],v[176:179],v[36:39]
ds_read_b64_tr_b16 a[148:149],v226
ds_read_b64_tr_b16 a[150:151],v226 offset:1024
v_mfma_f32_16x16x32_bf16 v[36:39],a[68:71],v[180:183],v[36:39]
P259:
s_cbranch_execz L_back
buffer_load_dwordx4 v227,s[16:19],s34 offen offset:3072 nt lds
v_mfma_f32_16x16x32_bf16 v[40:43],a[72:75],v[180:183],v[40:43]
v_exp_f32 v136,v136
v_mfma_f32_16x16x32_bf16 v[40:43],a[152:155],v[176:179],v[40:43]
ds_read_b64_tr_b16 a[152:153],v225 offset:256
ds_read_b64_tr_b16 a[154:155],v225 offset:1280
v_mfma_f32_16x16x32_bf16 v[44:47],a[156:159],v[176:179],v[44:47]
v_exp_f32 v137,v137
v_mfma_f32_16x16x32_bf16 v[44:47],a[76:79],v[180:183],v[44:47]
ds_read_b64_tr_b16 a[156:157],v226 offset:256
ds_read_b64_tr_b16 a[158:159],v226 offset:1280
v_mfma_f32_16x16x32_bf16 v[48:51],a[80:83],v[180:183],v[48:51]
v_exp_f32 v138,v138
v_mfma_f32_16x16x32_bf16 v[48:51],a[160:163],v[176:179],v[48:51]
ds_read_b64_tr_b16 a[160:161],v225 offset:512
ds_read_b64_tr_b16 a[162:163],v225 offset:1536
v_mfma_f32_16x16x32_bf16 v[52:55],a[164:167],v[176:179],v[52:55]
s_add_u32 m0,s30,65536
v_exp_f32 v139,v139
v_mfma_f32_16x16x32_bf16 v[52:55],a[84:87],v[180:183],v[52:55]
s_mov_b32 s34,442368
ds_read_b64_tr_b16 a[164:165],v226 offset:512
ds_read_b64_tr_b16 a[166:167],v226 offset:1536
v_mfma_f32_16x16x32_bf16 v[56:59],a[88:91],v[180:183],v[56:59]
v_cvt_pk_bf16_f32 v172,v136,v137
v_cvt_pk_bf16_f32 v173,v138,v139
v_mfma_f32_16x16x32_bf16 v[56:59],a[168:171],v[176:179],v[56:59]
P260:
s_cbranch_execz L_back
v_mfma_f32_16x16x32_bf16 v[60:63],a[172:175],v[176:179],v[60:63]
ds_read_b64_tr_b16 a[168:169],v225 offset:768
ds_read_b64_tr_b16 a[170:171],v225 offset:1792
v_mfma_f32_16x16x32_bf16 v[60:63],a[92:95],v[180:183],v[60:63]
v_exp_f32 v140,v140
v_mfma_f32_16x16x32_bf16 v[144:147],a[112:115],a[208:211],v[192:195]
ds_read_b64_tr_b16 a[172:173],v226 offset:768
ds_read_b64_tr_b16 a[174:175],v226 offset:1792
v_mfma_f32_16x16x32_bf16 v[144:147],a[116:119],a[212:215],v[144:147]
v_xor_b32 v225,0x800,v225
v_xor_b32 v226,0x800,v226
v_mfma_f32_16x16x32_bf16 v[144:147],a[120:123],a[216:219],v[144:147]
ds_read_b64_tr_b16 a[64:65],v225
ds_read_b64_tr_b16 a[66:67],v225 offset:1024
v_mfma_f32_16x16x32_bf16 v[144:147],a[124:127],a[220:223],v[144:147]
buffer_load_dwordx4 v227,s[20:23],s34 offen nt lds
v_mfma_f32_16x16x32_bf16 v[148:151],a[128:131],a[220:223],v[192:195]
ds_read_b64_tr_b16 a[68:69],v226
ds_read_b64_tr_b16 a[70:71],v226 offset:1024
v_mfma_f32_16x16x32_bf16 v[148:151],a[132:135],a[216:219],v[148:151]
v_exp_f32 v141,v141
v_mfma_f32_16x16x32_bf16 v[148:151],a[136:139],a[212:215],v[148:151]
ds_read_b64_tr_b16 a[72:73],v225 offset:256
ds_read_b64_tr_b16 a[74:75],v225 offset:1280
v_mfma_f32_16x16x32_bf16 v[148:151],a[140:143],a[208:211],v[148:151]
v_exp_f32 v142,v142
v_mfma_f32_16x16x32_bf16 v[128:131],a[32:35],a[208:211],v[192:195]
ds_read_b64_tr_b16 a[76:77],v226 offset:256
ds_read_b64_tr_b16 a[78:79],v226 offset:1280
v_mfma_f32_16x16x32_bf16 v[128:131],a[36:39],a[212:215],v[128:131]
v_exp_f32 v143,v143
v_mfma_f32_16x16x32_bf16 v[128:131],a[40:43],a[216:219],v[128:131]
ds_read_b64_tr_b16 a[80:81],v225 offset:512
ds_read_b64_tr_b16 a[82:83],v225 offset:1536
v_mfma_f32_16x16x32_bf16 v[128:131],a[44:47],a[220:223],v[128:131]
P261:
s_cbranch_execz L_back
v_mfma_f32_16x16x32_bf16 v[132:135],a[48:51],a[220:223],v[192:195]
ds_read_b64_tr_b16 a[84:85],v226 offset:512
v_cvt_pk_bf16_f32 v174,v140,v141
v_mfma_f32_16x16x32_bf16 v[132:135],a[52:55],a[216:219],v[132:135]
ds_read_b64_tr_b16 a[86:87],v226 offset:1536
v_cvt_pk_bf16_f32 v175,v142,v143
v_mfma_f32_16x16x32_bf16 v[132:135],a[56:59],a[212:215],v[132:135]
v_exp_f32 v144,v144
v_mfma_f32_16x16x32_bf16 v[132:135],a[60:63],a[208:211],v[132:135]
ds_read_b64_tr_b16 a[88:89],v225 offset:768
ds_read_b64_tr_b16 a[90:91],v225 offset:1792
v_mfma_f32_16x16x32_bf16 v[216:219],a[176:179],v[168:171],v[216:219]
v_exp_f32 v145,v145
v_mfma_f32_16x16x32_bf16 v[216:219],a[176:179],v[172:175],v[216:219]
s_waitcnt lgkmcnt(4)
ds_read_b64_tr_b16 a[92:93],v226 offset:768
ds_read_b64_tr_b16 a[94:95],v226 offset:1792
v_mfma_f32_16x16x32_bf16 v[64:67],a[64:67],v[172:175],v[64:67]
v_exp_f32 v146,v146
v_mfma_f32_16x16x32_bf16 v[64:67],a[144:147],v[168:171],v[64:67]
buffer_load_dwordx4 v227,s[20:23],s34 offen offset:1024 nt lds
v_mfma_f32_16x16x32_bf16 v[68:71],a[148:151],v[168:171],v[68:71]
v_exp_f32 v147,v147
v_mfma_f32_16x16x32_bf16 v[68:71],a[68:71],v[172:175],v[68:71]
v_cvt_pk_bf16_f32 v176,v144,v145
v_cvt_pk_bf16_f32 v177,v146,v147
v_mfma_f32_16x16x32_bf16 v[72:75],a[72:75],v[172:175],v[72:75]
v_exp_f32 v148,v148
v_mfma_f32_16x16x32_bf16 v[72:75],a[152:155],v[168:171],v[72:75]
v_exp_f32 v149,v149
v_mfma_f32_16x16x32_bf16 v[76:79],a[156:159],v[168:171],v[76:79]
v_exp_f32 v150,v150
v_mfma_f32_16x16x32_bf16 v[76:79],a[76:79],v[172:175],v[76:79]
v_exp_f32 v151,v151
v_mfma_f32_16x16x32_bf16 v[80:83],a[80:83],v[172:175],v[80:83]
P262:
s_cbranch_execz L_back
v_mfma_f32_16x16x32_bf16 v[80:83],a[160:163],v[168:171],v[80:83]
v_cvt_pk_bf16_f32 v178,v148,v149
v_cvt_pk_bf16_f32 v179,v150,v151
v_mfma_f32_16x16x32_bf16 v[84:87],a[164:167],v[168:171],v[84:87]
s_waitcnt lgkmcnt(0)
v_exp_f32 v128,v128
v_mfma_f32_16x16x32_bf16 v[84:87],a[84:87],v[172:175],v[84:87]
v_exp_f32 v129,v129
v_mfma_f32_16x16x32_bf16 v[88:91],a[88:91],v[172:175],v[88:91]
v_exp_f32 v130,v130
v_mfma_f32_16x16x32_bf16 v[88:91],a[168:171],v[168:171],v[88:91]
v_exp_f32 v131,v131
v_mfma_f32_16x16x32_bf16 v[92:95],a[172:175],v[168:171],v[92:95]
v_cvt_pk_bf16_f32 v180,v128,v129
v_cvt_pk_bf16_f32 v181,v130,v131
v_mfma_f32_16x16x32_bf16 v[92:95],a[92:95],v[172:175],v[92:95]
v_exp_f32 v132,v132
v_mfma_f32_16x16x32_bf16 v[136:139],a[32:35],a[96:99],v[204:207]
v_exp_f32 v133,v133
v_mfma_f32_16x16x32_bf16 v[136:139],a[36:39],a[100:103],v[136:139]
v_exp_f32 v134,v134
v_mfma_f32_16x16x32_bf16 v[136:139],a[40:43],a[104:107],v[136:139]
buffer_load_dwordx4 v227,s[20:23],s34 offen offset:2048 nt lds
v_mfma_f32_16x16x32_bf16 v[136:139],a[44:47],a[108:111],v[136:139]
v_exp_f32 v135,v135
v_mfma_f32_16x16x32_bf16 v[140:143],a[48:51],a[108:111],v[204:207]
v_cvt_pk_bf16_f32 v182,v132,v133
v_cvt_pk_bf16_f32 v183,v134,v135
v_mfma_f32_16x16x32_bf16 v[140:143],a[52:55],a[104:107],v[140:143]
v_xor_b32 v224,0x10800,v224
v_xor_b32 v225,0x8800,v225
v_mfma_f32_16x16x32_bf16 v[140:143],a[56:59],a[100:103],v[140:143]
v_exp_f32 v136,v136
v_mfma_f32_16x16x32_bf16 v[140:143],a[60:63],a[96:99],v[140:143]
v_exp_f32 v137,v137
v_mfma_f32_16x16x32_bf16 v[216:219],a[180:183],v[176:179],v[216:219]
v_exp_f32 v138,v138
v_mfma_f32_16x16x32_bf16 v[216:219],a[180:183],v[180:183],v[216:219]
P263:
s_cbranch_execz L_back
v_mfma_f32_16x16x32_bf16 v[96:99],a[64:67],v[180:183],v[96:99]
v_exp_f32 v139,v139
v_mfma_f32_16x16x32_bf16 v[96:99],a[144:147],v[176:179],v[96:99]
v_cvt_pk_bf16_f32 v184,v136,v137
v_cvt_pk_bf16_f32 v185,v138,v139
v_mfma_f32_16x16x32_bf16 v[100:103],a[148:151],v[176:179],v[100:103]
v_exp_f32 v140,v140
v_mfma_f32_16x16x32_bf16 v[100:103],a[68:71],v[180:183],v[100:103]
v_exp_f32 v141,v141
v_mfma_f32_16x16x32_bf16 v[104:107],a[72:75],v[180:183],v[104:107]
v_exp_f32 v142,v142
v_mfma_f32_16x16x32_bf16 v[104:107],a[152:155],v[176:179],v[104:107]
v_exp_f32 v143,v143
v_mfma_f32_16x16x32_bf16 v[108:111],a[156:159],v[176:179],v[108:111]
v_cvt_pk_bf16_f32 v186,v140,v141
v_cvt_pk_bf16_f32 v187,v142,v143
v_mfma_f32_16x16x32_bf16 v[108:111],a[76:79],v[180:183],v[108:111]
v_xor_b32 v226,0x8800,v226
v_mfma_f32_16x16x32_bf16 v[112:115],a[80:83],v[180:183],v[112:115]
v_mfma_f32_16x16x32_bf16 v[112:115],a[160:163],v[176:179],v[112:115]
buffer_load_dwordx4 v227,s[20:23],s34 offen offset:3072 nt lds
v_mfma_f32_16x16x32_bf16 v[116:119],a[164:167],v[176:179],v[116:119]
v_mfma_f32_16x16x32_bf16 v[116:119],a[84:87],v[180:183],v[116:119]
v_mfma_f32_16x16x32_bf16 v[120:123],a[88:91],v[180:183],v[120:123]
v_mfma_f32_16x16x32_bf16 v[120:123],a[168:171],v[176:179],v[120:123]
v_mfma_f32_16x16x32_bf16 v[124:127],a[172:175],v[176:179],v[124:127]
v_mfma_f32_16x16x32_bf16 v[124:127],a[92:95],v[180:183],v[124:127]
v_mfma_f32_16x16x32_bf16 v[144:147],a[112:115],a[224:227],v[196:199]
v_mfma_f32_16x16x32_bf16 v[144:147],a[116:119],a[228:231],v[144:147]
v_mfma_f32_16x16x32_bf16 v[144:147],a[120:123],a[232:235],v[144:147]
v_mfma_f32_16x16x32_bf16 v[144:147],a[124:127],a[236:239],v[144:147]
v_mfma_f32_16x16x32_bf16 v[148:151],a[128:131],a[236:239],v[196:199]
v_mfma_f32_16x16x32_bf16 v[148:151],a[132:135],a[232:235],v[148:151]
P264:
s_cbranch_execz L_back
v_mfma_f32_16x16x32_bf16 v[148:151],a[136:139],a[228:231],v[148:151]
v_mfma_f32_16x16x32_bf16 v[148:151],a[140:143],a[224:227],v[148:151]
v_mfma_f32_16x16x32_bf16 v[128:131],a[32:35],a[224:227],v[196:199]
v_mfma_f32_16x16x32_bf16 v[128:131],a[36:39],a[228:231],v[128:131]
v_mfma_f32_16x16x32_bf16 v[128:131],a[40:43],a[232:235],v[128:131]
v_exp_f32 v144,v144
v_mfma_f32_16x16x32_bf16 v[128:131],a[44:47],a[236:239],v[128:131]
v_exp_f32 v145,v145
v_mfma_f32_16x16x32_bf16 v[132:135],a[48:51],a[236:239],v[196:199]
v_exp_f32 v146,v146
v_mfma_f32_16x16x32_bf16 v[132:135],a[52:55],a[232:235],v[132:135]
v_exp_f32 v147,v147
v_mfma_f32_16x16x32_bf16 v[132:135],a[56:59],a[228:231],v[132:135]
v_cvt_pk_bf16_f32 v168,v144,v145
v_cvt_pk_bf16_f32 v169,v146,v147
v_mfma_f32_16x16x32_bf16 v[132:135],a[60:63],a[224:227],v[132:135]
v_exp_f32 v148,v148
v_mfma_f32_16x16x32_bf16 v[220:223],a[176:179],v[184:187],v[220:223]
v_exp_f32 v149,v149
v_mfma_f32_16x16x32_bf16 a[0:3],a[64:67],v[184:187],a[0:3]
v_exp_f32 v150,v150
v_mfma_f32_16x16x32_bf16 a[4:7],a[68:71],v[184:187],a[4:7]
v_exp_f32 v151,v151
v_mfma_f32_16x16x32_bf16 a[8:11],a[72:75],v[184:187],a[8:11]
s_add_u32 m0,s30,81920
v_cvt_pk_bf16_f32 v170,v148,v149
v_cvt_pk_bf16_f32 v171,v150,v151
v_mfma_f32_16x16x32_bf16 a[12:15],a[76:79],v[184:187],a[12:15]
s_mov_b32 s34,458752
v_exp_f32 v128,v128
v_mfma_f32_16x16x32_bf16 a[16:19],a[80:83],v[184:187],a[16:19]
v_exp_f32 v129,v129
v_mfma_f32_16x16x32_bf16 a[20:23],a[84:87],v[184:187],a[20:23]
v_exp_f32 v130,v130
v_mfma_f32_16x16x32_bf16 a[24:27],a[88:91],v[184:187],a[24:27]
s_waitcnt vmcnt(8) lgkmcnt(0)
s_barrier
v_mfma_f32_16x16x32_bf16 a[28:31],a[92:95],v[184:187],a[28:31]
P265:
s_cbranch_execz L_back
v_mfma_f32_16x16x32_bf16 v[136:139],a[112:115],a[240:243],v[200:203]
v_exp_f32 v131,v131
v_mfma_f32_16x16x32_bf16 v[136:139],a[116:119],a[244:247],v[136:139]
ds_read_b128 a[112:115],v224
v_cvt_pk_bf16_f32 v172,v128,v129
v_mfma_f32_16x16x32_bf16 v[136:139],a[120:123],a[248:251],v[136:139]
buffer_load_dwordx4 v227,s[16:19],s34 offen nt lds
v_mfma_f32_16x16x32_bf16 v[136:139],a[124:127],a[252:255],v[136:139]
ds_read_b128 a[116:119],v224 offset:256
v_cvt_pk_bf16_f32 v173,v130,v131
v_mfma_f32_16x16x32_bf16 v[140:143],a[128:131],a[252:255],v[200:203]
v_exp_f32 v132,v132
v_mfma_f32_16x16x32_bf16 v[140:143],a[132:135],a[248:251],v[140:143]
v_exp_f32 v133,v133
v_mfma_f32_16x16x32_bf16 v[140:143],a[136:139],a[244:247],v[140:143]
v_exp_f32 v134,v134
v_mfma_f32_16x16x32_bf16 v[140:143],a[140:143],a[240:243],v[140:143]
v_exp_f32 v135,v135
v_mfma_f32_16x16x32_bf16 v[144:147],a[32:35],a[240:243],v[200:203]
ds_read_b128 a[120:123],v224 offset:512
v_cvt_pk_bf16_f32 v174,v132,v133
v_mfma_f32_16x16x32_bf16 v[144:147],a[36:39],a[244:247],v[144:147]
ds_read_b128 a[124:127],v224 offset:768
v_cvt_pk_bf16_f32 v175,v134,v135
v_mfma_f32_16x16x32_bf16 v[144:147],a[40:43],a[248:251],v[144:147]
v_exp_f32 v136,v136
v_mfma_f32_16x16x32_bf16 v[144:147],a[44:47],a[252:255],v[144:147]
ds_read_b128 a[128:131],v224 offset:1792
ds_read_b128 a[132:135],v224 offset:1536
v_mfma_f32_16x16x32_bf16 v[148:151],a[48:51],a[252:255],v[200:203]
v_exp_f32 v137,v137
v_mfma_f32_16x16x32_bf16 v[148:151],a[52:55],a[248:251],v[148:151]
ds_read_b128 a[136:139],v224 offset:1280
ds_read_b128 a[140:143],v224 offset:1024
v_mfma_f32_16x16x32_bf16 v[148:151],a[56:59],a[244:247],v[148:151]
P266:
s_cbranch_execz L_back
v_mfma_f32_16x16x32_bf16 v[148:151],a[60:63],a[240:243],v[148:151]
v_exp_f32 v138,v138
v_mfma_f32_16x16x32_bf16 v[216:219],a[184:187],v[168:171],v[216:219]
v_exp_f32 v139,v139
v_mfma_f32_16x16x32_bf16 v[216:219],a[184:187],v[172:175],v[216:219]
v_xor_b32 v224,0x800,v224
v_cvt_pk_bf16_f32 v176,v136,v137
v_mfma_f32_16x16x32_bf16 v[0:3],a[64:67],v[172:175],v[0:3]
ds_read_b128 a[32:35],v224
ds_read_b128 a[36:39],v224 offset:256
v_mfma_f32_16x16x32_bf16 v[0:3],a[144:147],v[168:171],v[0:3]
buffer_load_dwordx4 v227,s[16:19],s34 offen offset:1024 nt lds
v_mfma_f32_16x16x32_bf16 v[4:7],a[148:151],v[168:171],v[4:7]
ds_read_b128 a[40:43],v224 offset:512
ds_read_b128 a[44:47],v224 offset:768
v_mfma_f32_16x16x32_bf16 v[4:7],a[68:71],v[172:175],v[4:7]
v_cvt_pk_bf16_f32 v177,v138,v139
v_mfma_f32_16x16x32_bf16 v[8:11],a[72:75],v[172:175],v[8:11]
v_exp_f32 v140,v140
v_mfma_f32_16x16x32_bf16 v[8:11],a[152:155],v[168:171],v[8:11]
ds_read_b128 a[48:51],v224 offset:1792
ds_read_b128 a[52:55],v224 offset:1536
v_mfma_f32_16x16x32_bf16 v[12:15],a[156:159],v[168:171],v[12:15]
v_exp_f32 v141,v141
v_mfma_f32_16x16x32_bf16 v[12:15],a[76:79],v[172:175],v[12:15]
v_exp_f32 v142,v142
v_mfma_f32_16x16x32_bf16 v[16:19],a[80:83],v[172:175],v[16:19]
ds_read_b128 a[56:59],v224 offset:1280
ds_read_b128 a[60:63],v224 offset:1024
v_mfma_f32_16x16x32_bf16 v[16:19],a[160:163],v[168:171],v[16:19]
v_exp_f32 v143,v143
v_mfma_f32_16x16x32_bf16 v[20:23],a[164:167],v[168:171],v[20:23]
v_cvt_pk_bf16_f32 v178,v140,v141
v_cvt_pk_bf16_f32 v179,v142,v143
v_mfma_f32_16x16x32_bf16 v[20:23],a[84:87],v[172:175],v[20:23]
P267:
s_cbranch_execz L_back
Z16:
s_cbranch_execz ZB1
v_mfma_f32_16x16x32_bf16 v[24:27],a[88:91],v[172:175],v[24:27]
v_exp_f32 v144,v144
v_mfma_f32_16x16x32_bf16 v[24:27],a[168:171],v[168:171],v[24:27]
v_exp_f32 v145,v145
v_mfma_f32_16x16x32_bf16 v[28:31],a[172:175],v[168:171],v[28:31]
v_exp_f32 v146,v146
v_mfma_f32_16x16x32_bf16 v[28:31],a[92:95],v[172:175],v[28:31]
s_waitcnt lgkmcnt(0)
v_exp_f32 v147,v147
v_mfma_f32_16x16x32_bf16 v[128:131],a[112:115],a[192:195],v[188:191]
v_cvt_pk_bf16_f32 v180,v144,v145
v_cvt_pk_bf16_f32 v181,v146,v147
v_mfma_f32_16x16x32_bf16 v[128:131],a[116:119],a[196:199],v[128:131]
v_exp_f32 v148,v148
v_mfma_f32_16x16x32_bf16 v[128:131],a[120:123],a[200:203],v[128:131]
buffer_load_dwordx4 v227,s[16:19],s34 offen offset:2048 nt lds
v_mfma_f32_16x16x32_bf16 v[128:131],a[124:127],a[204:207],v[128:131]
v_exp_f32 v149,v149
v_mfma_f32_16x16x32_bf16 v[132:135],a[128:131],a[204:207],v[188:191]
v_exp_f32 v150,v150
v_mfma_f32_16x16x32_bf16 v[132:135],a[132:135],a[200:203],v[132:135]
v_exp_f32 v151,v151
v_mfma_f32_16x16x32_bf16 v[132:135],a[136:139],a[196:199],v[132:135]
v_cvt_pk_bf16_f32 v182,v148,v149
v_cvt_pk_bf16_f32 v183,v150,v151
v_mfma_f32_16x16x32_bf16 v[132:135],a[140:143],a[192:195],v[132:135]
v_exp_f32 v128,v128
v_mfma_f32_16x16x32_bf16 v[136:139],a[32:35],a[192:195],v[188:191]
v_exp_f32 v129,v129
v_mfma_f32_16x16x32_bf16 v[136:139],a[36:39],a[196:199],v[136:139]
v_exp_f32 v130,v130
v_mfma_f32_16x16x32_bf16 v[136:139],a[40:43],a[200:203],v[136:139]
v_exp_f32 v131,v131
v_mfma_f32_16x16x32_bf16 v[136:139],a[44:47],a[204:207],v[136:139]
v_cvt_pk_bf16_f32 v168,v128,v129
v_cvt_pk_bf16_f32 v169,v130,v131
v_mfma_f32_16x16x32_bf16 v[140:143],a[48:51],a[204:207],v[188:191]
P268:
s_cbranch_execz L_back
v_mfma_f32_16x16x32_bf16 v[140:143],a[52:55],a[200:203],v[140:143]
v_exp_f32 v132,v132
v_mfma_f32_16x16x32_bf16 v[140:143],a[56:59],a[196:199],v[140:143]
v_exp_f32 v133,v133
v_mfma_f32_16x16x32_bf16 v[140:143],a[60:63],a[192:195],v[140:143]
v_exp_f32 v134,v134
v_mfma_f32_16x16x32_bf16 v[216:219],a[188:191],v[176:179],v[216:219]
v_exp_f32 v135,v135
v_mfma_f32_16x16x32_bf16 v[216:219],a[188:191],v[180:183],v[216:219]
v_cvt_pk_bf16_f32 v170,v132,v133
v_cvt_pk_bf16_f32 v171,v134,v135
v_mfma_f32_16x16x32_bf16 v[32:35],a[64:67],v[180:183],v[32:35]
v_exp_f32 v136,v136
v_mfma_f32_16x16x32_bf16 v[32:35],a[144:147],v[176:179],v[32:35]
ds_read_b64_tr_b16 a[144:145],v225
ds_read_b64_tr_b16 a[146:147],v225 offset:1024
v_mfma_f32_16x16x32_bf16 v[36:39],a[148:151],v[176:179],v[36:39]
ds_read_b64_tr_b16 a[148:149],v226
ds_read_b64_tr_b16 a[150:151],v226 offset:1024
v_mfma_f32_16x16x32_bf16 v[36:39],a[68:71],v[180:183],v[36:39]
buffer_load_dwordx4 v227,s[16:19],s34 offen offset:3072 nt lds
v_mfma_f32_16x16x32_bf16 v[40:43],a[72:75],v[180:183],v[40:43]
v_exp_f32 v137,v137
v_mfma_f32_16x16x32_bf16 v[40:43],a[152:155],v[176:179],v[40:43]
ds_read_b64_tr_b16 a[152:153],v225 offset:256
ds_read_b64_tr_b16 a[154:155],v225 offset:1280
v_mfma_f32_16x16x32_bf16 v[44:47],a[156:159],v[176:179],v[44:47]
v_exp_f32 v138,v138
v_mfma_f32_16x16x32_bf16 v[44:47],a[76:79],v[180:183],v[44:47]
ds_read_b64_tr_b16 a[156:157],v226 offset:256
ds_read_b64_tr_b16 a[158:159],v226 offset:1280
v_mfma_f32_16x16x32_bf16 v[48:51],a[80:83],v[180:183],v[48:51]
v_exp_f32 v139,v139
v_mfma_f32_16x16x32_bf16 v[48:51],a[160:163],v[176:179],v[48:51]
ds_read_b64_tr_b16 a[160:161],v225 offset:512
ds_read_b64_tr_b16 a[162:163],v225 offset:1536
v_mfma_f32_16x16x32_bf16 v[52:55],a[164:167],v[176:179],v[52:55]
P269:
s_cbranch_execz L_back
v_mfma_f32_16x16x32_bf16 v[52:55],a[84:87],v[180:183],v[52:55]
s_add_u32 m0,s30,0
ds_read_b64_tr_b16 a[164:165],v226 offset:512
ds_read_b64_tr_b16 a[166:167],v226 offset:1536
v_mfma_f32_16x16x32_bf16 v[56:59],a[88:91],v[180:183],v[56:59]
s_mov_b32 s34,458752
v_cvt_pk_bf16_f32 v172,v136,v137
v_cvt_pk_bf16_f32 v173,v138,v139
v_mfma_f32_16x16x32_bf16 v[56:59],a[168:171],v[176:179],v[56:59]
ds_read_b64_tr_b16 a[168:169],v225 offset:768
ds_read_b64_tr_b16 a[170:171],v225 offset:1792
v_mfma_f32_16x16x32_bf16 v[60:63],a[172:175],v[176:179],v[60:63]
v_exp_f32 v140,v140
v_mfma_f32_16x16x32_bf16 v[60:63],a[92:95],v[180:183],v[60:63]
ds_read_b64_tr_b16 a[172:173],v226 offset:768
ds_read_b64_tr_b16 a[174:175],v226 offset:1792
v_mfma_f32_16x16x32_bf16 v[144:147],a[112:115],a[208:211],v[192:195]
v_xor_b32 v225,0x800,v225
v_xor_b32 v226,0x800,v226
v_mfma_f32_16x16x32_bf16 v[144:147],a[116:119],a[212:215],v[144:147]
ds_read_b64_tr_b16 a[64:65],v225
ds_read_b64_tr_b16 a[66:67],v225 offset:1024
v_mfma_f32_16x16x32_bf16 v[144:147],a[120:123],a[216:219],v[144:147]
buffer_load_dwordx4 v227,s[20:23],s34 offen nt lds
v_mfma_f32_16x16x32_bf16 v[144:147],a[124:127],a[220:223],v[144:147]
ds_read_b64_tr_b16 a[68:69],v226
ds_read_b64_tr_b16 a[70:71],v226 offset:1024
v_mfma_f32_16x16x32_bf16 v[148:151],a[128:131],a[220:223],v[192:195]
v_exp_f32 v141,v141
v_mfma_f32_16x16x32_bf16 v[148:151],a[132:135],a[216:219],v[148:151]
ds_read_b64_tr_b16 a[72:73],v225 offset:256
ds_read_b64_tr_b16 a[74:75],v225 offset:1280
v_mfma_f32_16x16x32_bf16 v[148:151],a[136:139],a[212:215],v[148:151]
P270:
s_cbranch_execz L_back
v_mfma_f32_16x16x32_bf16 v[148:151],a[140:143],a[208:211],v[148:151]
ds_read_b64_tr_b16 a[76:77],v226 offset:256
ds_read_b64_tr_b16 a[78:79],v226 offset:1280
v_mfma_f32_16x16x32_bf16 v[128:131],a[32:35],a[208:211],v[192:195]
v_exp_f32 v142,v142
v_mfma_f32_16x16x32_bf16 v[128:131],a[36:39],a[212:215],v[128:131]
ds_read_b64_tr_b16 a[80:81],v225 offset:512
ds_read_b64_tr_b16 a[82:83],v225 offset:1536
v_mfma_f32_16x16x32_bf16 v[128:131],a[40:43],a[216:219],v[128:131]
v_exp_f32 v143,v143
v_mfma_f32_16x16x32_bf16 v[128:131],a[44:47],a[220:223],v[128:131]
ds_read_b64_tr_b16 a[84:85],v226 offset:512
v_cvt_pk_bf16_f32 v174,v140,v141
v_mfma_f32_16x16x32_bf16 v[132:135],a[48:51],a[220:223],v[192:195]
ds_read_b64_tr_b16 a[86:87],v226 offset:1536
v_cvt_pk_bf16_f32 v175,v142,v143
v_mfma_f32_16x16x32_bf16 v[132:135],a[52:55],a[216:219],v[132:135]
v_exp_f32 v144,v144
v_mfma_f32_16x16x32_bf16 v[132:135],a[56:59],a[212:215],v[132:135]
ds_read_b64_tr_b16 a[88:89],v225 offset:768
ds_read_b64_tr_b16 a[90:91],v225 offset:1792
v_mfma_f32_16x16x32_bf16 v[132:135],a[60:63],a[208:211],v[132:135]
v_exp_f32 v145,v145
v_mfma_f32_16x16x32_bf16 v[216:219],a[176:179],v[168:171],v[216:219]
ds_read_b64_tr_b16 a[92:93],v226 offset:768
ds_read_b64_tr_b16 a[94:95],v226 offset:1792
v_mfma_f32_16x16x32_bf16 v[216:219],a[176:179],v[172:175],v[216:219]
s_waitcnt lgkmcnt(5)
v_exp_f32 v146,v146
v_mfma_f32_16x16x32_bf16 v[64:67],a[64:67],v[172:175],v[64:67]
v_exp_f32 v147,v147
v_mfma_f32_16x16x32_bf16 v[64:67],a[144:147],v[168:171],v[64:67]
buffer_load_dwordx4 v227,s[20:23],s34 offen offset:1024 nt lds
v_mfma_f32_16x16x32_bf16 v[68:71],a[148:151],v[168:171],v[68:71]
P271:
s_cbranch_execz L_back
v_mfma_f32_16x16x32_bf16 v[68:71],a[68:71],v[172:175],v[68:71]
v_cvt_pk_bf16_f32 v176,v144,v145
v_cvt_pk_bf16_f32 v177,v146,v147
v_mfma_f32_16x16x32_bf16 v[72:75],a[72:75],v[172:175],v[72:75]
v_exp_f32 v148,v148
v_mfma_f32_16x16x32_bf16 v[72:75],a[152:155],v[168:171],v[72:75]
v_exp_f32 v149,v149
v_mfma_f32_16x16x32_bf16 v[76:79],a[156:159],v[168:171],v[76:79]
v_exp_f32 v150,v150
v_mfma_f32_16x16x32_bf16 v[76:79],a[76:79],v[172:175],v[76:79]
v_exp_f32 v151,v151
v_mfma_f32_16x16x32_bf16 v[80:83],a[80:83],v[172:175],v[80:83]
v_cvt_pk_bf16_f32 v178,v148,v149
v_cvt_pk_bf16_f32 v179,v150,v151
v_mfma_f32_16x16x32_bf16 v[80:83],a[160:163],v[168:171],v[80:83]
v_exp_f32 v128,v128
v_mfma_f32_16x16x32_bf16 v[84:87],a[164:167],v[168:171],v[84:87]
s_waitcnt lgkmcnt(0)
v_exp_f32 v129,v129
v_mfma_f32_16x16x32_bf16 v[84:87],a[84:87],v[172:175],v[84:87]
v_exp_f32 v130,v130
v_mfma_f32_16x16x32_bf16 v[88:91],a[88:91],v[172:175],v[88:91]
v_exp_f32 v131,v131
v_mfma_f32_16x16x32_bf16 v[88:91],a[168:171],v[168:171],v[88:91]
v_cvt_pk_bf16_f32 v180,v128,v129
v_cvt_pk_bf16_f32 v181,v130,v131
v_mfma_f32_16x16x32_bf16 v[92:95],a[172:175],v[168:171],v[92:95]
v_exp_f32 v132,v132
v_mfma_f32_16x16x32_bf16 v[92:95],a[92:95],v[172:175],v[92:95]
v_exp_f32 v133,v133
v_mfma_f32_16x16x32_bf16 v[136:139],a[32:35],a[96:99],v[204:207]
v_exp_f32 v134,v134
v_mfma_f32_16x16x32_bf16 v[136:139],a[36:39],a[100:103],v[136:139]
v_exp_f32 v135,v135
v_mfma_f32_16x16x32_bf16 v[136:139],a[40:43],a[104:107],v[136:139]
buffer_load_dwordx4 v227,s[20:23],s34 offen offset:2048 nt lds
v_mfma_f32_16x16x32_bf16 v[136:139],a[44:47],a[108:111],v[136:139]
v_cvt_pk_bf16_f32 v182,v132,v133
v_cvt_pk_bf16_f32 v183,v134,v135
v_mfma_f32_16x16x32_bf16 v[140:143],a[48:51],a[108:111],v[204:207]
P272:
s_cbranch_execz L_back
v_mfma_f32_16x16x32_bf16 v[140:143],a[52:55],a[104:107],v[140:143]
v_xor_b32 v224,0x8800,v224
v_xor_b32 v225,0x18800,v225
v_mfma_f32_16x16x32_bf16 v[140:143],a[56:59],a[100:103],v[140:143]
v_exp_f32 v136,v136
v_mfma_f32_16x16x32_bf16 v[140:143],a[60:63],a[96:99],v[140:143]
v_exp_f32 v137,v137
v_mfma_f32_16x16x32_bf16 v[216:219],a[180:183],v[176:179],v[216:219]
v_exp_f32 v138,v138
v_mfma_f32_16x16x32_bf16 v[216:219],a[180:183],v[180:183],v[216:219]
v_exp_f32 v139,v139
v_mfma_f32_16x16x32_bf16 v[96:99],a[64:67],v[180:183],v[96:99]
v_cvt_pk_bf16_f32 v184,v136,v137
v_cvt_pk_bf16_f32 v185,v138,v139
v_mfma_f32_16x16x32_bf16 v[96:99],a[144:147],v[176:179],v[96:99]
v_exp_f32 v140,v140
v_mfma_f32_16x16x32_bf16 v[100:103],a[148:151],v[176:179],v[100:103]
v_exp_f32 v141,v141
v_mfma_f32_16x16x32_bf16 v[100:103],a[68:71],v[180:183],v[100:103]
v_exp_f32 v142,v142
v_mfma_f32_16x16x32_bf16 v[104:107],a[72:75],v[180:183],v[104:107]
v_exp_f32 v143,v143
v_mfma_f32_16x16x32_bf16 v[104:107],a[152:155],v[176:179],v[104:107]
v_cvt_pk_bf16_f32 v186,v140,v141
v_cvt_pk_bf16_f32 v187,v142,v143
v_mfma_f32_16x16x32_bf16 v[108:111],a[156:159],v[176:179],v[108:111]
v_xor_b32 v226,0x18800,v226
v_mfma_f32_16x16x32_bf16 v[108:111],a[76:79],v[180:183],v[108:111]
v_mfma_f32_16x16x32_bf16 v[112:115],a[80:83],v[180:183],v[112:115]
v_mfma_f32_16x16x32_bf16 v[112:115],a[160:163],v[176:179],v[112:115]
buffer_load_dwordx4 v227,s[20:23],s34 offen offset:3072 nt lds
v_mfma_f32_16x16x32_bf16 v[116:119],a[164:167],v[176:179],v[116:119]
v_mfma_f32_16x16x32_bf16 v[116:119],a[84:87],v[180:183],v[116:119]
P273:
s_cbranch_execz L_back
v_mfma_f32_16x16x32_bf16 v[120:123],a[88:91],v[180:183],v[120:123]
v_mfma_f32_16x16x32_bf16 v[120:123],a[168:171],v[176:179],v[120:123]
v_mfma_f32_16x16x32_bf16 v[124:127],a[172:175],v[176:179],v[124:127]
v_mfma_f32_16x16x32_bf16 v[124:127],a[92:95],v[180:183],v[124:127]
v_mfma_f32_16x16x32_bf16 v[144:147],a[112:115],a[224:227],v[196:199]
v_mfma_f32_16x16x32_bf16 v[144:147],a[116:119],a[228:231],v[144:147]
v_mfma_f32_16x16x32_bf16 v[144:147],a[120:123],a[232:235],v[144:147]
v_mfma_f32_16x16x32_bf16 v[144:147],a[124:127],a[236:239],v[144:147]
v_mfma_f32_16x16x32_bf16 v[148:151],a[128:131],a[236:239],v[196:199]
v_mfma_f32_16x16x32_bf16 v[148:151],a[132:135],a[232:235],v[148:151]
v_mfma_f32_16x16x32_bf16 v[148:151],a[136:139],a[228:231],v[148:151]
v_mfma_f32_16x16x32_bf16 v[148:151],a[140:143],a[224:227],v[148:151]
v_mfma_f32_16x16x32_bf16 v[128:131],a[32:35],a[224:227],v[196:199]
v_mfma_f32_16x16x32_bf16 v[128:131],a[36:39],a[228:231],v[128:131]
v_mfma_f32_16x16x32_bf16 v[128:131],a[40:43],a[232:235],v[128:131]
v_mfma_f32_16x16x32_bf16 v[128:131],a[44:47],a[236:239],v[128:131]
v_exp_f32 v144,v144
v_mfma_f32_16x16x32_bf16 v[132:135],a[48:51],a[236:239],v[196:199]
v_exp_f32 v145,v145
v_mfma_f32_16x16x32_bf16 v[132:135],a[52:55],a[232:235],v[132:135]
v_exp_f32 v146,v146
v_mfma_f32_16x16x32_bf16 v[132:135],a[56:59],a[228:231],v[132:135]
v_exp_f32 v147,v147
v_mfma_f32_16x16x32_bf16 v[132:135],a[60:63],a[224:227],v[132:135]
v_cvt_pk_bf16_f32 v168,v144,v145
v_cvt_pk_bf16_f32 v169,v146,v147
v_mfma_f32_16x16x32_bf16 v[220:223],a[176:179],v[184:187],v[220:223]
v_exp_f32 v148,v148
v_mfma_f32_16x16x32_bf16 a[0:3],a[64:67],v[184:187],a[0:3]
v_exp_f32 v149,v149
v_mfma_f32_16x16x32_bf16 a[4:7],a[68:71],v[184:187],a[4:7]
v_exp_f32 v150,v150
v_mfma_f32_16x16x32_bf16 a[8:11],a[72:75],v[184:187],a[8:11]
s_add_u32 m0,s30,16384
v_exp_f32 v151,v151
v_mfma_f32_16x16x32_bf16 a[12:15],a[76:79],v[184:187],a[12:15]
P274:
s_cbranch_execz L_back
v_mfma_f32_16x16x32_bf16 a[16:19],a[80:83],v[184:187],a[16:19]
s_mov_b32 s34,475136
v_cvt_pk_bf16_f32 v170,v148,v149
v_cvt_pk_bf16_f32 v171,v150,v151
v_mfma_f32_16x16x32_bf16 a[20:23],a[84:87],v[184:187],a[20:23]
v_exp_f32 v128,v128
v_mfma_f32_16x16x32_bf16 a[24:27],a[88:91],v[184:187],a[24:27]
s_waitcnt vmcnt(8) lgkmcnt(0)
s_barrier
v_mfma_f32_16x16x32_bf16 a[28:31],a[92:95],v[184:187],a[28:31]
v_exp_f32 v129,v129
v_mfma_f32_16x16x32_bf16 v[136:139],a[112:115],a[240:243],v[200:203]
v_exp_f32 v130,v130
v_mfma_f32_16x16x32_bf16 v[136:139],a[116:119],a[244:247],v[136:139]
v_exp_f32 v131,v131
v_mfma_f32_16x16x32_bf16 v[136:139],a[120:123],a[248:251],v[136:139]
buffer_load_dwordx4 v227,s[16:19],s34 offen nt lds
v_mfma_f32_16x16x32_bf16 v[136:139],a[124:127],a[252:255],v[136:139]
ds_read_b128 a[112:115],v224
v_cvt_pk_bf16_f32 v172,v128,v129
v_mfma_f32_16x16x32_bf16 v[140:143],a[128:131],a[252:255],v[200:203]
ds_read_b128 a[116:119],v224 offset:256
v_cvt_pk_bf16_f32 v173,v130,v131
v_mfma_f32_16x16x32_bf16 v[140:143],a[132:135],a[248:251],v[140:143]
v_exp_f32 v132,v132
v_mfma_f32_16x16x32_bf16 v[140:143],a[136:139],a[244:247],v[140:143]
v_exp_f32 v133,v133
v_mfma_f32_16x16x32_bf16 v[140:143],a[140:143],a[240:243],v[140:143]
v_exp_f32 v134,v134
v_mfma_f32_16x16x32_bf16 v[144:147],a[32:35],a[240:243],v[200:203]
v_exp_f32 v135,v135
v_mfma_f32_16x16x32_bf16 v[144:147],a[36:39],a[244:247],v[144:147]
ds_read_b128 a[120:123],v224 offset:512
v_cvt_pk_bf16_f32 v174,v132,v133
v_mfma_f32_16x16x32_bf16 v[144:147],a[40:43],a[248:251],v[144:147]
ds_read_b128 a[124:127],v224 offset:768
v_cvt_pk_bf16_f32 v175,v134,v135
v_mfma_f32_16x16x32_bf16 v[144:147],a[44:47],a[252:255],v[144:147]
P275:
s_cbranch_execz L_back
v_mfma_f32_16x16x32_bf16 v[148:151],a[48:51],a[252:255],v[200:203]
ds_read_b128 a[128:131],v224 offset:1792
ds_read_b128 a[132:135],v224 offset:1536
v_mfma_f32_16x16x32_bf16 v[148:151],a[52:55],a[248:251],v[148:151]
v_exp_f32 v136,v136
v_mfma_f32_16x16x32_bf16 v[148:151],a[56:59],a[244:247],v[148:151]
ds_read_b128 a[136:139],v224 offset:1280
ds_read_b128 a[140:143],v224 offset:1024
v_mfma_f32_16x16x32_bf16 v[148:151],a[60:63],a[240:243],v[148:151]
v_exp_f32 v137,v137
v_mfma_f32_16x16x32_bf16 v[216:219],a[184:187],v[168:171],v[216:219]
v_exp_f32 v138,v138
v_mfma_f32_16x16x32_bf16 v[216:219],a[184:187],v[172:175],v[216:219]
v_exp_f32 v139,v139
v_mfma_f32_16x16x32_bf16 v[0:3],a[64:67],v[172:175],v[0:3]
v_xor_b32 v224,0x800,v224
v_cvt_pk_bf16_f32 v176,v136,v137
v_mfma_f32_16x16x32_bf16 v[0:3],a[144:147],v[168:171],v[0:3]
buffer_load_dwordx4 v227,s[16:19],s34 offen offset:1024 nt lds
v_mfma_f32_16x16x32_bf16 v[4:7],a[148:151],v[168:171],v[4:7]
ds_read_b128 a[32:35],v224
ds_read_b128 a[36:39],v224 offset:256
v_mfma_f32_16x16x32_bf16 v[4:7],a[68:71],v[172:175],v[4:7]
v_cvt_pk_bf16_f32 v177,v138,v139
v_mfma_f32_16x16x32_bf16 v[8:11],a[72:75],v[172:175],v[8:11]
ds_read_b128 a[40:43],v224 offset:512
ds_read_b128 a[44:47],v224 offset:768
v_mfma_f32_16x16x32_bf16 v[8:11],a[152:155],v[168:171],v[8:11]
v_exp_f32 v140,v140
v_mfma_f32_16x16x32_bf16 v[12:15],a[156:159],v[168:171],v[12:15]
ds_read_b128 a[48:51],v224 offset:1792
ds_read_b128 a[52:55],v224 offset:1536
v_mfma_f32_16x16x32_bf16 v[12:15],a[76:79],v[172:175],v[12:15]
P276:
s_cbranch_execz L_back
v_mfma_f32_16x16x32_bf16 v[16:19],a[80:83],v[172:175],v[16:19]
v_exp_f32 v141,v141
v_mfma_f32_16x16x32_bf16 v[16:19],a[160:163],v[168:171],v[16:19]
v_exp_f32 v142,v142
v_mfma_f32_16x16x32_bf16 v[20:23],a[164:167],v[168:171],v[20:23]
ds_read_b128 a[56:59],v224 offset:1280
ds_read_b128 a[60:63],v224 offset:1024
v_mfma_f32_16x16x32_bf16 v[20:23],a[84:87],v[172:175],v[20:23]
v_exp_f32 v143,v143
v_mfma_f32_16x16x32_bf16 v[24:27],a[88:91],v[172:175],v[24:27]
v_cvt_pk_bf16_f32 v178,v140,v141
v_cvt_pk_bf16_f32 v179,v142,v143
v_mfma_f32_16x16x32_bf16 v[24:27],a[168:171],v[168:171],v[24:27]
v_exp_f32 v144,v144
v_mfma_f32_16x16x32_bf16 v[28:31],a[172:175],v[168:171],v[28:31]
v_exp_f32 v145,v145
v_mfma_f32_16x16x32_bf16 v[28:31],a[92:95],v[172:175],v[28:31]
s_waitcnt lgkmcnt(2)
v_exp_f32 v146,v146
v_mfma_f32_16x16x32_bf16 v[128:131],a[112:115],a[192:195],v[188:191]
v_exp_f32 v147,v147
v_mfma_f32_16x16x32_bf16 v[128:131],a[116:119],a[196:199],v[128:131]
v_cvt_pk_bf16_f32 v180,v144,v145
v_cvt_pk_bf16_f32 v181,v146,v147
v_mfma_f32_16x16x32_bf16 v[128:131],a[120:123],a[200:203],v[128:131]
buffer_load_dwordx4 v227,s[16:19],s34 offen offset:2048 nt lds
v_mfma_f32_16x16x32_bf16 v[128:131],a[124:127],a[204:207],v[128:131]
v_exp_f32 v148,v148
v_mfma_f32_16x16x32_bf16 v[132:135],a[128:131],a[204:207],v[188:191]
v_exp_f32 v149,v149
v_mfma_f32_16x16x32_bf16 v[132:135],a[132:135],a[200:203],v[132:135]
v_exp_f32 v150,v150
v_mfma_f32_16x16x32_bf16 v[132:135],a[136:139],a[196:199],v[132:135]
v_exp_f32 v151,v151
v_mfma_f32_16x16x32_bf16 v[132:135],a[140:143],a[192:195],v[132:135]
v_cvt_pk_bf16_f32 v182,v148,v149
v_cvt_pk_bf16_f32 v183,v150,v151
v_mfma_f32_16x16x32_bf16 v[136:139],a[32:35],a[192:195],v[188:191]
P277:
s_cbranch_execz L_back
v_mfma_f32_16x16x32_bf16 v[136:139],a[36:39],a[196:199],v[136:139]
v_exp_f32 v128,v128
v_mfma_f32_16x16x32_bf16 v[136:139],a[40:43],a[200:203],v[136:139]
v_exp_f32 v129,v129
v_mfma_f32_16x16x32_bf16 v[136:139],a[44:47],a[204:207],v[136:139]
v_exp_f32 v130,v130
v_mfma_f32_16x16x32_bf16 v[140:143],a[48:51],a[204:207],v[188:191]
v_exp_f32 v131,v131
v_mfma_f32_16x16x32_bf16 v[140:143],a[52:55],a[200:203],v[140:143]
s_waitcnt lgkmcnt(0)
v_cvt_pk_bf16_f32 v168,v128,v129
v_cvt_pk_bf16_f32 v169,v130,v131
v_mfma_f32_16x16x32_bf16 v[140:143],a[56:59],a[196:199],v[140:143]
v_exp_f32 v132,v132
v_mfma_f32_16x16x32_bf16 v[140:143],a[60:63],a[192:195],v[140:143]
v_exp_f32 v133,v133
v_mfma_f32_16x16x32_bf16 v[216:219],a[188:191],v[176:179],v[216:219]
v_exp_f32 v134,v134
v_mfma_f32_16x16x32_bf16 v[216:219],a[188:191],v[180:183],v[216:219]
v_exp_f32 v135,v135
v_mfma_f32_16x16x32_bf16 v[32:35],a[64:67],v[180:183],v[32:35]
v_cvt_pk_bf16_f32 v170,v132,v133
v_cvt_pk_bf16_f32 v171,v134,v135
v_mfma_f32_16x16x32_bf16 v[32:35],a[144:147],v[176:179],v[32:35]
ds_read_b64_tr_b16 a[144:145],v225
ds_read_b64_tr_b16 a[146:147],v225 offset:1024
v_mfma_f32_16x16x32_bf16 v[36:39],a[148:151],v[176:179],v[36:39]
ds_read_b64_tr_b16 a[148:149],v226
ds_read_b64_tr_b16 a[150:151],v226 offset:1024
v_mfma_f32_16x16x32_bf16 v[36:39],a[68:71],v[180:183],v[36:39]
buffer_load_dwordx4 v227,s[16:19],s34 offen offset:3072 nt lds
v_mfma_f32_16x16x32_bf16 v[40:43],a[72:75],v[180:183],v[40:43]
v_exp_f32 v136,v136
v_mfma_f32_16x16x32_bf16 v[40:43],a[152:155],v[176:179],v[40:43]
ds_read_b64_tr_b16 a[152:153],v225 offset:256
ds_read_b64_tr_b16 a[154:155],v225 offset:1280
v_mfma_f32_16x16x32_bf16 v[44:47],a[156:159],v[176:179],v[44:47]
P278:
s_cbranch_execz L_back
v_mfma_f32_16x16x32_bf16 v[44:47],a[76:79],v[180:183],v[44:47]
ds_read_b64_tr_b16 a[156:157],v226 offset:256
ds_read_b64_tr_b16 a[158:159],v226 offset:1280
v_mfma_f32_16x16x32_bf16 v[48:51],a[80:83],v[180:183],v[48:51]
v_exp_f32 v137,v137
v_mfma_f32_16x16x32_bf16 v[48:51],a[160:163],v[176:179],v[48:51]
ds_read_b64_tr_b16 a[160:161],v225 offset:512
ds_read_b64_tr_b16 a[162:163],v225 offset:1536
v_mfma_f32_16x16x32_bf16 v[52:55],a[164:167],v[176:179],v[52:55]
s_add_u32 m0,s30,32768
v_exp_f32 v138,v138
v_mfma_f32_16x16x32_bf16 v[52:55],a[84:87],v[180:183],v[52:55]
s_mov_b32 s34,475136
ds_read_b64_tr_b16 a[164:165],v226 offset:512
ds_read_b64_tr_b16 a[166:167],v226 offset:1536
v_mfma_f32_16x16x32_bf16 v[56:59],a[88:91],v[180:183],v[56:59]
v_exp_f32 v139,v139
v_mfma_f32_16x16x32_bf16 v[56:59],a[168:171],v[176:179],v[56:59]
ds_read_b64_tr_b16 a[168:169],v225 offset:768
ds_read_b64_tr_b16 a[170:171],v225 offset:1792
v_mfma_f32_16x16x32_bf16 v[60:63],a[172:175],v[176:179],v[60:63]
v_cvt_pk_bf16_f32 v172,v136,v137
v_cvt_pk_bf16_f32 v173,v138,v139
v_mfma_f32_16x16x32_bf16 v[60:63],a[92:95],v[180:183],v[60:63]
ds_read_b64_tr_b16 a[172:173],v226 offset:768
ds_read_b64_tr_b16 a[174:175],v226 offset:1792
v_mfma_f32_16x16x32_bf16 v[144:147],a[112:115],a[208:211],v[192:195]
v_xor_b32 v225,0x800,v225
v_xor_b32 v226,0x800,v226
v_mfma_f32_16x16x32_bf16 v[144:147],a[116:119],a[212:215],v[144:147]
ds_read_b64_tr_b16 a[64:65],v225
ds_read_b64_tr_b16 a[66:67],v225 offset:1024
v_mfma_f32_16x16x32_bf16 v[144:147],a[120:123],a[216:219],v[144:147]
P279:
s_cbranch_execz L_back
v_mfma_f32_16x16x32_bf16 v[144:147],a[124:127],a[220:223],v[144:147]
buffer_load_dwordx4 v227,s[20:23],s34 offen nt lds
v_mfma_f32_16x16x32_bf16 v[148:151],a[128:131],a[220:223],v[192:195]
ds_read_b64_tr_b16 a[68:69],v226
ds_read_b64_tr_b16 a[70:71],v226 offset:1024
v_mfma_f32_16x16x32_bf16 v[148:151],a[132:135],a[216:219],v[148:151]
v_exp_f32 v140,v140
v_mfma_f32_16x16x32_bf16 v[148:151],a[136:139],a[212:215],v[148:151]
ds_read_b64_tr_b16 a[72:73],v225 offset:256
ds_read_b64_tr_b16 a[74:75],v225 offset:1280
v_mfma_f32_16x16x32_bf16 v[148:151],a[140:143],a[208:211],v[148:151]
v_exp_f32 v141,v141
v_mfma_f32_16x16x32_bf16 v[128:131],a[32:35],a[208:211],v[192:195]
ds_read_b64_tr_b16 a[76:77],v226 offset:256
ds_read_b64_tr_b16 a[78:79],v226 offset:1280
v_mfma_f32_16x16x32_bf16 v[128:131],a[36:39],a[212:215],v[128:131]
v_exp_f32 v142,v142
v_mfma_f32_16x16x32_bf16 v[128:131],a[40:43],a[216:219],v[128:131]
ds_read_b64_tr_b16 a[80:81],v225 offset:512
ds_read_b64_tr_b16 a[82:83],v225 offset:1536
v_mfma_f32_16x16x32_bf16 v[128:131],a[44:47],a[220:223],v[128:131]
v_exp_f32 v143,v143
v_mfma_f32_16x16x32_bf16 v[132:135],a[48:51],a[220:223],v[192:195]
ds_read_b64_tr_b16 a[84:85],v226 offset:512
v_cvt_pk_bf16_f32 v174,v140,v141
v_mfma_f32_16x16x32_bf16 v[132:135],a[52:55],a[216:219],v[132:135]
ds_read_b64_tr_b16 a[86:87],v226 offset:1536
v_cvt_pk_bf16_f32 v175,v142,v143
v_mfma_f32_16x16x32_bf16 v[132:135],a[56:59],a[212:215],v[132:135]
v_exp_f32 v144,v144
v_mfma_f32_16x16x32_bf16 v[132:135],a[60:63],a[208:211],v[132:135]
ds_read_b64_tr_b16 a[88:89],v225 offset:768
ds_read_b64_tr_b16 a[90:91],v225 offset:1792
v_mfma_f32_16x16x32_bf16 v[216:219],a[176:179],v[168:171],v[216:219]
P280:
s_cbranch_execz L_back
v_mfma_f32_16x16x32_bf16 v[216:219],a[176:179],v[172:175],v[216:219]
s_waitcnt lgkmcnt(4)
ds_read_b64_tr_b16 a[92:93],v226 offset:768
ds_read_b64_tr_b16 a[94:95],v226 offset:1792
v_mfma_f32_16x16x32_bf16 v[64:67],a[64:67],v[172:175],v[64:67]
v_exp_f32 v145,v145
v_mfma_f32_16x16x32_bf16 v[64:67],a[144:147],v[168:171],v[64:67]
buffer_load_dwordx4 v227,s[20:23],s34 offen offset:1024 nt lds
v_mfma_f32_16x16x32_bf16 v[68:71],a[148:151],v[168:171],v[68:71]
v_exp_f32 v146,v146
v_mfma_f32_16x16x32_bf16 v[68:71],a[68:71],v[172:175],v[68:71]
v_exp_f32 v147,v147
v_mfma_f32_16x16x32_bf16 v[72:75],a[72:75],v[172:175],v[72:75]
v_cvt_pk_bf16_f32 v176,v144,v145
v_cvt_pk_bf16_f32 v177,v146,v147
v_mfma_f32_16x16x32_bf16 v[72:75],a[152:155],v[168:171],v[72:75]
v_exp_f32 v148,v148
v_mfma_f32_16x16x32_bf16 v[76:79],a[156:159],v[168:171],v[76:79]
v_exp_f32 v149,v149
v_mfma_f32_16x16x32_bf16 v[76:79],a[76:79],v[172:175],v[76:79]
v_exp_f32 v150,v150
v_mfma_f32_16x16x32_bf16 v[80:83],a[80:83],v[172:175],v[80:83]
v_exp_f32 v151,v151
v_mfma_f32_16x16x32_bf16 v[80:83],a[160:163],v[168:171],v[80:83]
v_cvt_pk_bf16_f32 v178,v148,v149
v_cvt_pk_bf16_f32 v179,v150,v151
v_mfma_f32_16x16x32_bf16 v[84:87],a[164:167],v[168:171],v[84:87]
s_waitcnt lgkmcnt(0)
v_exp_f32 v128,v128
v_mfma_f32_16x16x32_bf16 v[84:87],a[84:87],v[172:175],v[84:87]
v_exp_f32 v129,v129
v_mfma_f32_16x16x32_bf16 v[88:91],a[88:91],v[172:175],v[88:91]
v_exp_f32 v130,v130
v_mfma_f32_16x16x32_bf16 v[88:91],a[168:171],v[168:171],v[88:91]
v_exp_f32 v131,v131
v_mfma_f32_16x16x32_bf16 v[92:95],a[172:175],v[168:171],v[92:95]
P281:
s_cbranch_execz L_back
v_mfma_f32_16x16x32_bf16 v[92:95],a[92:95],v[172:175],v[92:95]
v_cvt_pk_bf16_f32 v180,v128,v129
v_cvt_pk_bf16_f32 v181,v130,v131
v_mfma_f32_16x16x32_bf16 v[136:139],a[32:35],a[96:99],v[204:207]
v_exp_f32 v132,v132
v_mfma_f32_16x16x32_bf16 v[136:139],a[36:39],a[100:103],v[136:139]
v_exp_f32 v133,v133
v_mfma_f32_16x16x32_bf16 v[136:139],a[40:43],a[104:107],v[136:139]
buffer_load_dwordx4 v227,s[20:23],s34 offen offset:2048 nt lds
v_mfma_f32_16x16x32_bf16 v[136:139],a[44:47],a[108:111],v[136:139]
v_exp_f32 v134,v134
v_mfma_f32_16x16x32_bf16 v[140:143],a[48:51],a[108:111],v[204:207]
v_exp_f32 v135,v135
v_mfma_f32_16x16x32_bf16 v[140:143],a[52:55],a[104:107],v[140:143]
v_cvt_pk_bf16_f32 v182,v132,v133
v_cvt_pk_bf16_f32 v183,v134,v135
v_mfma_f32_16x16x32_bf16 v[140:143],a[56:59],a[100:103],v[140:143]
v_xor_b32 v224,0x18800,v224
v_xor_b32 v225,0x10800,v225
v_mfma_f32_16x16x32_bf16 v[140:143],a[60:63],a[96:99],v[140:143]
v_exp_f32 v136,v136
v_mfma_f32_16x16x32_bf16 v[216:219],a[180:183],v[176:179],v[216:219]
v_exp_f32 v137,v137
v_mfma_f32_16x16x32_bf16 v[216:219],a[180:183],v[180:183],v[216:219]
v_exp_f32 v138,v138
v_mfma_f32_16x16x32_bf16 v[96:99],a[64:67],v[180:183],v[96:99]
v_exp_f32 v139,v139
v_mfma_f32_16x16x32_bf16 v[96:99],a[144:147],v[176:179],v[96:99]
v_cvt_pk_bf16_f32 v184,v136,v137
v_cvt_pk_bf16_f32 v185,v138,v139
v_mfma_f32_16x16x32_bf16 v[100:103],a[148:151],v[176:179],v[100:103]
v_exp_f32 v140,v140
v_mfma_f32_16x16x32_bf16 v[100:103],a[68:71],v[180:183],v[100:103]
v_exp_f32 v141,v141
v_mfma_f32_16x16x32_bf16 v[104:107],a[72:75],v[180:183],v[104:107]
v_exp_f32 v142,v142
v_mfma_f32_16x16x32_bf16 v[104:107],a[152:155],v[176:179],v[104:107]
P282:
s_cbranch_execz L_back
v_mfma_f32_16x16x32_bf16 v[108:111],a[156:159],v[176:179],v[108:111]
v_exp_f32 v143,v143
v_mfma_f32_16x16x32_bf16 v[108:111],a[76:79],v[180:183],v[108:111]
v_cvt_pk_bf16_f32 v186,v140,v141
v_cvt_pk_bf16_f32 v187,v142,v143
v_mfma_f32_16x16x32_bf16 v[112:115],a[80:83],v[180:183],v[112:115]
v_xor_b32 v226,0x10800,v226
v_mfma_f32_16x16x32_bf16 v[112:115],a[160:163],v[176:179],v[112:115]
buffer_load_dwordx4 v227,s[20:23],s34 offen offset:3072 nt lds
v_mfma_f32_16x16x32_bf16 v[116:119],a[164:167],v[176:179],v[116:119]
v_mfma_f32_16x16x32_bf16 v[116:119],a[84:87],v[180:183],v[116:119]
v_mfma_f32_16x16x32_bf16 v[120:123],a[88:91],v[180:183],v[120:123]
v_mfma_f32_16x16x32_bf16 v[120:123],a[168:171],v[176:179],v[120:123]
v_mfma_f32_16x16x32_bf16 v[124:127],a[172:175],v[176:179],v[124:127]
v_mfma_f32_16x16x32_bf16 v[124:127],a[92:95],v[180:183],v[124:127]
v_mfma_f32_16x16x32_bf16 v[144:147],a[112:115],a[224:227],v[196:199]
v_mfma_f32_16x16x32_bf16 v[144:147],a[116:119],a[228:231],v[144:147]
v_mfma_f32_16x16x32_bf16 v[144:147],a[120:123],a[232:235],v[144:147]
v_mfma_f32_16x16x32_bf16 v[144:147],a[124:127],a[236:239],v[144:147]
v_mfma_f32_16x16x32_bf16 v[148:151],a[128:131],a[236:239],v[196:199]
v_mfma_f32_16x16x32_bf16 v[148:151],a[132:135],a[232:235],v[148:151]
v_mfma_f32_16x16x32_bf16 v[148:151],a[136:139],a[228:231],v[148:151]
v_mfma_f32_16x16x32_bf16 v[148:151],a[140:143],a[224:227],v[148:151]
v_mfma_f32_16x16x32_bf16 v[128:131],a[32:35],a[224:227],v[196:199]
v_mfma_f32_16x16x32_bf16 v[128:131],a[36:39],a[228:231],v[128:131]
v_mfma_f32_16x16x32_bf16 v[128:131],a[40:43],a[232:235],v[128:131]
v_mfma_f32_16x16x32_bf16 v[128:131],a[44:47],a[236:239],v[128:131]
v_exp_f32 v144,v144
v_mfma_f32_16x16x32_bf16 v[132:135],a[48:51],a[236:239],v[196:199]
v_exp_f32 v145,v145
v_mfma_f32_16x16x32_bf16 v[132:135],a[52:55],a[232:235],v[132:135]
v_exp_f32 v146,v146
v_mfma_f32_16x16x32_bf16 v[132:135],a[56:59],a[228:231],v[132:135]
v_exp_f32 v147,v147
v_mfma_f32_16x16x32_bf16 v[132:135],a[60:63],a[224:227],v[132:135]
P283:
s_cbranch_execz L_back
Z17:
s_cbranch_execz ZB1
v_mfma_f32_16x16x32_bf16 v[220:223],a[176:179],v[184:187],v[220:223]
v_cvt_pk_bf16_f32 v168,v144,v145
v_cvt_pk_bf16_f32 v169,v146,v147
v_mfma_f32_16x16x32_bf16 a[0:3],a[64:67],v[184:187],a[0:3]
v_exp_f32 v148,v148
v_mfma_f32_16x16x32_bf16 a[4:7],a[68:71],v[184:187],a[4:7]
v_exp_f32 v149,v149
v_mfma_f32_16x16x32_bf16 a[8:11],a[72:75],v[184:187],a[8:11]
s_add_u32 m0,s30,49152
v_exp_f32 v150,v150
v_mfma_f32_16x16x32_bf16 a[12:15],a[76:79],v[184:187],a[12:15]
s_mov_b32 s34,491520
v_exp_f32 v151,v151
v_mfma_f32_16x16x32_bf16 a[16:19],a[80:83],v[184:187],a[16:19]
v_cvt_pk_bf16_f32 v170,v148,v149
v_cvt_pk_bf16_f32 v171,v150,v151
v_mfma_f32_16x16x32_bf16 a[20:23],a[84:87],v[184:187],a[20:23]
v_exp_f32 v128,v128
v_mfma_f32_16x16x32_bf16 a[24:27],a[88:91],v[184:187],a[24:27]
s_waitcnt vmcnt(8) lgkmcnt(0)
s_barrier
v_mfma_f32_16x16x32_bf16 a[28:31],a[92:95],v[184:187],a[28:31]
v_exp_f32 v129,v129
v_mfma_f32_16x16x32_bf16 v[136:139],a[112:115],a[240:243],v[200:203]
v_exp_f32 v130,v130
v_mfma_f32_16x16x32_bf16 v[136:139],a[116:119],a[244:247],v[136:139]
v_exp_f32 v131,v131
v_mfma_f32_16x16x32_bf16 v[136:139],a[120:123],a[248:251],v[136:139]
buffer_load_dwordx4 v227,s[16:19],s34 offen nt lds
v_mfma_f32_16x16x32_bf16 v[136:139],a[124:127],a[252:255],v[136:139]
ds_read_b128 a[112:115],v224
v_cvt_pk_bf16_f32 v172,v128,v129
v_mfma_f32_16x16x32_bf16 v[140:143],a[128:131],a[252:255],v[200:203]
ds_read_b128 a[116:119],v224 offset:256
v_cvt_pk_bf16_f32 v173,v130,v131
v_mfma_f32_16x16x32_bf16 v[140:143],a[132:135],a[248:251],v[140:143]
P284:
s_cbranch_execz L_back
v_mfma_f32_16x16x32_bf16 v[140:143],a[136:139],a[244:247],v[140:143]
v_exp_f32 v132,v132
v_mfma_f32_16x16x32_bf16 v[140:143],a[140:143],a[240:243],v[140:143]
v_exp_f32 v133,v133
v_mfma_f32_16x16x32_bf16 v[144:147],a[32:35],a[240:243],v[200:203]
v_exp_f32 v134,v134
v_mfma_f32_16x16x32_bf16 v[144:147],a[36:39],a[244:247],v[144:147]
v_exp_f32 v135,v135
v_mfma_f32_16x16x32_bf16 v[144:147],a[40:43],a[248:251],v[144:147]
ds_read_b128 a[120:123],v224 offset:512
v_cvt_pk_bf16_f32 v174,v132,v133
v_mfma_f32_16x16x32_bf16 v[144:147],a[44:47],a[252:255],v[144:147]
ds_read_b128 a[124:127],v224 offset:768
v_cvt_pk_bf16_f32 v175,v134,v135
v_mfma_f32_16x16x32_bf16 v[148:151],a[48:51],a[252:255],v[200:203]
v_exp_f32 v136,v136
v_mfma_f32_16x16x32_bf16 v[148:151],a[52:55],a[248:251],v[148:151]
ds_read_b128 a[128:131],v224 offset:1792
ds_read_b128 a[132:135],v224 offset:1536
v_mfma_f32_16x16x32_bf16 v[148:151],a[56:59],a[244:247],v[148:151]
v_exp_f32 v137,v137
v_mfma_f32_16x16x32_bf16 v[148:151],a[60:63],a[240:243],v[148:151]
ds_read_b128 a[136:139],v224 offset:1280
ds_read_b128 a[140:143],v224 offset:1024
v_mfma_f32_16x16x32_bf16 v[216:219],a[184:187],v[168:171],v[216:219]
v_exp_f32 v138,v138
v_mfma_f32_16x16x32_bf16 v[216:219],a[184:187],v[172:175],v[216:219]
v_exp_f32 v139,v139
v_mfma_f32_16x16x32_bf16 v[0:3],a[64:67],v[172:175],v[0:3]
v_xor_b32 v224,0x800,v224
v_cvt_pk_bf16_f32 v176,v136,v137
v_mfma_f32_16x16x32_bf16 v[0:3],a[144:147],v[168:171],v[0:3]
buffer_load_dwordx4 v227,s[16:19],s34 offen offset:1024 nt lds
v_mfma_f32_16x16x32_bf16 v[4:7],a[148:151],v[168:171],v[4:7]
ds_read_b128 a[32:35],v224
ds_read_b128 a[36:39],v224 offset:256
v_mfma_f32_16x16x32_bf16 v[4:7],a[68:71],v[172:175],v[4:7]
P285:
s_cbranch_execz L_back
v_mfma_f32_16x16x32_bf16 v[8:11],a[72:75],v[172:175],v[8:11]
ds_read_b128 a[40:43],v224 offset:512
ds_read_b128 a[44:47],v224 offset:768
v_mfma_f32_16x16x32_bf16 v[8:11],a[152:155],v[168:171],v[8:11]
v_cvt_pk_bf16_f32 v177,v138,v139
v_mfma_f32_16x16x32_bf16 v[12:15],a[156:159],v[168:171],v[12:15]
v_exp_f32 v140,v140
v_mfma_f32_16x16x32_bf16 v[12:15],a[76:79],v[172:175],v[12:15]
ds_read_b128 a[48:51],v224 offset:1792
ds_read_b128 a[52:55],v224 offset:1536
v_mfma_f32_16x16x32_bf16 v[16:19],a[80:83],v[172:175],v[16:19]
v_exp_f32 v141,v141
v_mfma_f32_16x16x32_bf16 v[16:19],a[160:163],v[168:171],v[16:19]
v_exp_f32 v142,v142
v_mfma_f32_16x16x32_bf16 v[20:23],a[164:167],v[168:171],v[20:23]
ds_read_b128 a[56:59],v224 offset:1280
ds_read_b128 a[60:63],v224 offset:1024
v_mfma_f32_16x16x32_bf16 v[20:23],a[84:87],v[172:175],v[20:23]
v_exp_f32 v143,v143
v_mfma_f32_16x16x32_bf16 v[24:27],a[88:91],v[172:175],v[24:27]
v_cvt_pk_bf16_f32 v178,v140,v141
v_cvt_pk_bf16_f32 v179,v142,v143
v_mfma_f32_16x16x32_bf16 v[24:27],a[168:171],v[168:171],v[24:27]
v_exp_f32 v144,v144
v_mfma_f32_16x16x32_bf16 v[28:31],a[172:175],v[168:171],v[28:31]
v_exp_f32 v145,v145
v_mfma_f32_16x16x32_bf16 v[28:31],a[92:95],v[172:175],v[28:31]
s_waitcnt lgkmcnt(2)
v_exp_f32 v146,v146
v_mfma_f32_16x16x32_bf16 v[128:131],a[112:115],a[192:195],v[188:191]
v_exp_f32 v147,v147
v_mfma_f32_16x16x32_bf16 v[128:131],a[116:119],a[196:199],v[128:131]
v_cvt_pk_bf16_f32 v180,v144,v145
v_cvt_pk_bf16_f32 v181,v146,v147
v_mfma_f32_16x16x32_bf16 v[128:131],a[120:123],a[200:203],v[128:131]
P286:
s_cbranch_execz L_back
v_mfma_f32_16x16x32_bf16 v[128:131],a[124:127],a[204:207],v[128:131]
buffer_load_dwordx4 v227,s[16:19],s34 offen offset:2048 nt lds
v_mfma_f32_16x16x32_bf16 v[132:135],a[128:131],a[204:207],v[188:191]
v_exp_f32 v148,v148
v_mfma_f32_16x16x32_bf16 v[132:135],a[132:135],a[200:203],v[132:135]
v_exp_f32 v149,v149
v_mfma_f32_16x16x32_bf16 v[132:135],a[136:139],a[196:199],v[132:135]
v_exp_f32 v150,v150
v_mfma_f32_16x16x32_bf16 v[132:135],a[140:143],a[192:195],v[132:135]
v_exp_f32 v151,v151
v_mfma_f32_16x16x32_bf16 v[136:139],a[32:35],a[192:195],v[188:191]
v_cvt_pk_bf16_f32 v182,v148,v149
v_cvt_pk_bf16_f32 v183,v150,v151
v_mfma_f32_16x16x32_bf16 v[136:139],a[36:39],a[196:199],v[136:139]
v_exp_f32 v128,v128
v_mfma_f32_16x16x32_bf16 v[136:139],a[40:43],a[200:203],v[136:139]
v_exp_f32 v129,v129
v_mfma_f32_16x16x32_bf16 v[136:139],a[44:47],a[204:207],v[136:139]
v_exp_f32 v130,v130
v_mfma_f32_16x16x32_bf16 v[140:143],a[48:51],a[204:207],v[188:191]
v_exp_f32 v131,v131
v_mfma_f32_16x16x32_bf16 v[140:143],a[52:55],a[200:203],v[140:143]
s_waitcnt lgkmcnt(0)
v_cvt_pk_bf16_f32 v168,v128,v129
v_cvt_pk_bf16_f32 v169,v130,v131
v_mfma_f32_16x16x32_bf16 v[140:143],a[56:59],a[196:199],v[140:143]
v_exp_f32 v132,v132
v_mfma_f32_16x16x32_bf16 v[140:143],a[60:63],a[192:195],v[140:143]
v_exp_f32 v133,v133
v_mfma_f32_16x16x32_bf16 v[216:219],a[188:191],v[176:179],v[216:219]
v_exp_f32 v134,v134
v_mfma_f32_16x16x32_bf16 v[216:219],a[188:191],v[180:183],v[216:219]
v_exp_f32 v135,v135
v_mfma_f32_16x16x32_bf16 v[32:35],a[64:67],v[180:183],v[32:35]
v_cvt_pk_bf16_f32 v170,v132,v133
v_cvt_pk_bf16_f32 v171,v134,v135
v_mfma_f32_16x16x32_bf16 v[32:35],a[144:147],v[176:179],v[32:35]
ds_read_b64_tr_b16 a[144:145],v225
ds_read_b64_tr_b16 a[146:147],v225 offset:1024
v_mfma_f32_16x16x32_bf16 v[36:39],a[148:151],v[176:179],v[36:39]
ds_read_b64_tr_b16 a[148:149],v226
ds_read_b64_tr_b16 a[150:151],v226 offset:1024
v_mfma_f32_16x16x32_bf16 v[36:39],a[68:71],v[180:183],v[36:39]
P287:
s_cbranch_execz L_back
buffer_load_dwordx4 v227,s[16:19],s34 offen offset:3072 nt lds
v_mfma_f32_16x16x32_bf16 v[40:43],a[72:75],v[180:183],v[40:43]
v_exp_f32 v136,v136
v_mfma_f32_16x16x32_bf16 v[40:43],a[152:155],v[176:179],v[40:43]
ds_read_b64_tr_b16 a[152:153],v225 offset:256
ds_read_b64_tr_b16 a[154:155],v225 offset:1280
v_mfma_f32_16x16x32_bf16 v[44:47],a[156:159],v[176:179],v[44:47]
v_exp_f32 v137,v137
v_mfma_f32_16x16x32_bf16 v[44:47],a[76:79],v[180:183],v[44:47]
ds_read_b64_tr_b16 a[156:157],v226 offset:256
ds_read_b64_tr_b16 a[158:159],v226 offset:1280
v_mfma_f32_16x16x32_bf16 v[48:51],a[80:83],v[180:183],v[48:51]
v_exp_f32 v138,v138
v_mfma_f32_16x16x32_bf16 v[48:51],a[160:163],v[176:179],v[48:51]
ds_read_b64_tr_b16 a[160:161],v225 offset:512
ds_read_b64_tr_b16 a[162:163],v225 offset:1536
v_mfma_f32_16x16x32_bf16 v[52:55],a[164:167],v[176:179],v[52:55]
s_add_u32 m0,s30,65536
v_exp_f32 v139,v139
v_mfma_f32_16x16x32_bf16 v[52:55],a[84:87],v[180:183],v[52:55]
s_mov_b32 s34,491520
ds_read_b64_tr_b16 a[164:165],v226 offset:512
ds_read_b64_tr_b16 a[166:167],v226 offset:1536
v_mfma_f32_16x16x32_bf16 v[56:59],a[88:91],v[180:183],v[56:59]
v_cvt_pk_bf16_f32 v172,v136,v137
v_cvt_pk_bf16_f32 v173,v138,v139
v_mfma_f32_16x16x32_bf16 v[56:59],a[168:171],v[176:179],v[56:59]
P288:
s_cbranch_execz L_back
v_mfma_f32_16x16x32_bf16 v[60:63],a[172:175],v[176:179],v[60:63]
ds_read_b64_tr_b16 a[168:169],v225 offset:768
ds_read_b64_tr_b16 a[170:171],v225 offset:1792
v_mfma_f32_16x16x32_bf16 v[60:63],a[92:95],v[180:183],v[60:63]
v_exp_f32 v140,v140
v_mfma_f32_16x16x32_bf16 v[144:147],a[112:115],a[208:211],v[192:195]
ds_read_b64_tr_b16 a[172:173],v226 offset:768
ds_read_b64_tr_b16 a[174:175],v226 offset:1792
v_mfma_f32_16x16x32_bf16 v[144:147],a[116:119],a[212:215],v[144:147]
v_xor_b32 v225,0x800,v225
v_xor_b32 v226,0x800,v226
v_mfma_f32_16x16x32_bf16 v[144:147],a[120:123],a[216:219],v[144:147]
ds_read_b64_tr_b16 a[64:65],v225
ds_read_b64_tr_b16 a[66:67],v225 offset:1024
v_mfma_f32_16x16x32_bf16 v[144:147],a[124:127],a[220:223],v[144:147]
buffer_load_dwordx4 v227,s[20:23],s34 offen nt lds
v_mfma_f32_16x16x32_bf16 v[148:151],a[128:131],a[220:223],v[192:195]
ds_read_b64_tr_b16 a[68:69],v226
ds_read_b64_tr_b16 a[70:71],v226 offset:1024
v_mfma_f32_16x16x32_bf16 v[148:151],a[132:135],a[216:219],v[148:151]
v_exp_f32 v141,v141
v_mfma_f32_16x16x32_bf16 v[148:151],a[136:139],a[212:215],v[148:151]
ds_read_b64_tr_b16 a[72:73],v225 offset:256
ds_read_b64_tr_b16 a[74:75],v225 offset:1280
v_mfma_f32_16x16x32_bf16 v[148:151],a[140:143],a[208:211],v[148:151]
v_exp_f32 v142,v142
v_mfma_f32_16x16x32_bf16 v[128:131],a[32:35],a[208:211],v[192:195]
ds_read_b64_tr_b16 a[76:77],v226 offset:256
ds_read_b64_tr_b16 a[78:79],v226 offset:1280
v_mfma_f32_16x16x32_bf16 v[128:131],a[36:39],a[212:215],v[128:131]
v_exp_f32 v143,v143
v_mfma_f32_16x16x32_bf16 v[128:131],a[40:43],a[216:219],v[128:131]
ds_read_b64_tr_b16 a[80:81],v225 offset:512
ds_read_b64_tr_b16 a[82:83],v225 offset:1536
v_mfma_f32_16x16x32_bf16 v[128:131],a[44:47],a[220:223],v[128:131]
P289:
s_cbranch_execz L_back
v_mfma_f32_16x16x32_bf16 v[132:135],a[48:51],a[220:223],v[192:195]
ds_read_b64_tr_b16 a[84:85],v226 offset:512
v_cvt_pk_bf16_f32 v174,v140,v141
v_mfma_f32_16x16x32_bf16 v[132:135],a[52:55],a[216:219],v[132:135]
ds_read_b64_tr_b16 a[86:87],v226 offset:1536
v_cvt_pk_bf16_f32 v175,v142,v143
v_mfma_f32_16x16x32_bf16 v[132:135],a[56:59],a[212:215],v[132:135]
v_exp_f32 v144,v144
v_mfma_f32_16x16x32_bf16 v[132:135],a[60:63],a[208:211],v[132:135]
ds_read_b64_tr_b16 a[88:89],v225 offset:768
ds_read_b64_tr_b16 a[90:91],v225 offset:1792
v_mfma_f32_16x16x32_bf16 v[216:219],a[176:179],v[168:171],v[216:219]
v_exp_f32 v145,v145
v_mfma_f32_16x16x32_bf16 v[216:219],a[176:179],v[172:175],v[216:219]
s_waitcnt lgkmcnt(4)
ds_read_b64_tr_b16 a[92:93],v226 offset:768
ds_read_b64_tr_b16 a[94:95],v226 offset:1792
v_mfma_f32_16x16x32_bf16 v[64:67],a[64:67],v[172:175],v[64:67]
v_exp_f32 v146,v146
v_mfma_f32_16x16x32_bf16 v[64:67],a[144:147],v[168:171],v[64:67]
buffer_load_dwordx4 v227,s[20:23],s34 offen offset:1024 nt lds
v_mfma_f32_16x16x32_bf16 v[68:71],a[148:151],v[168:171],v[68:71]
v_exp_f32 v147,v147
v_mfma_f32_16x16x32_bf16 v[68:71],a[68:71],v[172:175],v[68:71]
v_cvt_pk_bf16_f32 v176,v144,v145
v_cvt_pk_bf16_f32 v177,v146,v147
v_mfma_f32_16x16x32_bf16 v[72:75],a[72:75],v[172:175],v[72:75]
v_exp_f32 v148,v148
v_mfma_f32_16x16x32_bf16 v[72:75],a[152:155],v[168:171],v[72:75]
v_exp_f32 v149,v149
v_mfma_f32_16x16x32_bf16 v[76:79],a[156:159],v[168:171],v[76:79]
v_exp_f32 v150,v150
v_mfma_f32_16x16x32_bf16 v[76:79],a[76:79],v[172:175],v[76:79]
v_exp_f32 v151,v151
v_mfma_f32_16x16x32_bf16 v[80:83],a[80:83],v[172:175],v[80:83]
P290:
s_cbranch_execz L_back
v_mfma_f32_16x16x32_bf16 v[80:83],a[160:163],v[168:171],v[80:83]
v_cvt_pk_bf16_f32 v178,v148,v149
v_cvt_pk_bf16_f32 v179,v150,v151
v_mfma_f32_16x16x32_bf16 v[84:87],a[164:167],v[168:171],v[84:87]
s_waitcnt lgkmcnt(0)
v_exp_f32 v128,v128
v_mfma_f32_16x16x32_bf16 v[84:87],a[84:87],v[172:175],v[84:87]
v_exp_f32 v129,v129
v_mfma_f32_16x16x32_bf16 v[88:91],a[88:91],v[172:175],v[88:91]
v_exp_f32 v130,v130
v_mfma_f32_16x16x32_bf16 v[88:91],a[168:171],v[168:171],v[88:91]
v_exp_f32 v131,v131
v_mfma_f32_16x16x32_bf16 v[92:95],a[172:175],v[168:171],v[92:95]
v_cvt_pk_bf16_f32 v180,v128,v129
v_cvt_pk_bf16_f32 v181,v130,v131
v_mfma_f32_16x16x32_bf16 v[92:95],a[92:95],v[172:175],v[92:95]
v_exp_f32 v132,v132
v_mfma_f32_16x16x32_bf16 v[136:139],a[32:35],a[96:99],v[204:207]
v_exp_f32 v133,v133
v_mfma_f32_16x16x32_bf16 v[136:139],a[36:39],a[100:103],v[136:139]
v_exp_f32 v134,v134
v_mfma_f32_16x16x32_bf16 v[136:139],a[40:43],a[104:107],v[136:139]
buffer_load_dwordx4 v227,s[20:23],s34 offen offset:2048 nt lds
v_mfma_f32_16x16x32_bf16 v[136:139],a[44:47],a[108:111],v[136:139]
v_exp_f32 v135,v135
v_mfma_f32_16x16x32_bf16 v[140:143],a[48:51],a[108:111],v[204:207]
v_cvt_pk_bf16_f32 v182,v132,v133
v_cvt_pk_bf16_f32 v183,v134,v135
v_mfma_f32_16x16x32_bf16 v[140:143],a[52:55],a[104:107],v[140:143]
v_xor_b32 v224,0x10800,v224
v_xor_b32 v225,0x8800,v225
v_mfma_f32_16x16x32_bf16 v[140:143],a[56:59],a[100:103],v[140:143]
v_exp_f32 v136,v136
v_mfma_f32_16x16x32_bf16 v[140:143],a[60:63],a[96:99],v[140:143]
v_exp_f32 v137,v137
v_mfma_f32_16x16x32_bf16 v[216:219],a[180:183],v[176:179],v[216:219]
v_exp_f32 v138,v138
v_mfma_f32_16x16x32_bf16 v[216:219],a[180:183],v[180:183],v[216:219]
P291:
s_cbranch_execz L_back
v_mfma_f32_16x16x32_bf16 v[96:99],a[64:67],v[180:183],v[96:99]
v_exp_f32 v139,v139
v_mfma_f32_16x16x32_bf16 v[96:99],a[144:147],v[176:179],v[96:99]
v_cvt_pk_bf16_f32 v184,v136,v137
v_cvt_pk_bf16_f32 v185,v138,v139
v_mfma_f32_16x16x32_bf16 v[100:103],a[148:151],v[176:179],v[100:103]
v_exp_f32 v140,v140
v_mfma_f32_16x16x32_bf16 v[100:103],a[68:71],v[180:183],v[100:103]
v_exp_f32 v141,v141
v_mfma_f32_16x16x32_bf16 v[104:107],a[72:75],v[180:183],v[104:107]
v_exp_f32 v142,v142
v_mfma_f32_16x16x32_bf16 v[104:107],a[152:155],v[176:179],v[104:107]
v_exp_f32 v143,v143
v_mfma_f32_16x16x32_bf16 v[108:111],a[156:159],v[176:179],v[108:111]
v_cvt_pk_bf16_f32 v186,v140,v141
v_cvt_pk_bf16_f32 v187,v142,v143
v_mfma_f32_16x16x32_bf16 v[108:111],a[76:79],v[180:183],v[108:111]
v_xor_b32 v226,0x8800,v226
v_mfma_f32_16x16x32_bf16 v[112:115],a[80:83],v[180:183],v[112:115]
v_mfma_f32_16x16x32_bf16 v[112:115],a[160:163],v[176:179],v[112:115]
buffer_load_dwordx4 v227,s[20:23],s34 offen offset:3072 nt lds
v_mfma_f32_16x16x32_bf16 v[116:119],a[164:167],v[176:179],v[116:119]
v_mfma_f32_16x16x32_bf16 v[116:119],a[84:87],v[180:183],v[116:119]
v_mfma_f32_16x16x32_bf16 v[120:123],a[88:91],v[180:183],v[120:123]
v_mfma_f32_16x16x32_bf16 v[120:123],a[168:171],v[176:179],v[120:123]
v_mfma_f32_16x16x32_bf16 v[124:127],a[172:175],v[176:179],v[124:127]
v_mfma_f32_16x16x32_bf16 v[124:127],a[92:95],v[180:183],v[124:127]
v_mfma_f32_16x16x32_bf16 v[144:147],a[112:115],a[224:227],v[196:199]
v_mfma_f32_16x16x32_bf16 v[144:147],a[116:119],a[228:231],v[144:147]
v_mfma_f32_16x16x32_bf16 v[144:147],a[120:123],a[232:235],v[144:147]
v_mfma_f32_16x16x32_bf16 v[144:147],a[124:127],a[236:239],v[144:147]
v_mfma_f32_16x16x32_bf16 v[148:151],a[128:131],a[236:239],v[196:199]
v_mfma_f32_16x16x32_bf16 v[148:151],a[132:135],a[232:235],v[148:151]
P292:
s_cbranch_execz L_back
v_mfma_f32_16x16x32_bf16 v[148:151],a[136:139],a[228:231],v[148:151]
v_mfma_f32_16x16x32_bf16 v[148:151],a[140:143],a[224:227],v[148:151]
v_mfma_f32_16x16x32_bf16 v[128:131],a[32:35],a[224:227],v[196:199]
v_mfma_f32_16x16x32_bf16 v[128:131],a[36:39],a[228:231],v[128:131]
v_mfma_f32_16x16x32_bf16 v[128:131],a[40:43],a[232:235],v[128:131]
v_exp_f32 v144,v144
v_mfma_f32_16x16x32_bf16 v[128:131],a[44:47],a[236:239],v[128:131]
v_exp_f32 v145,v145
v_mfma_f32_16x16x32_bf16 v[132:135],a[48:51],a[236:239],v[196:199]
v_exp_f32 v146,v146
v_mfma_f32_16x16x32_bf16 v[132:135],a[52:55],a[232:235],v[132:135]
v_exp_f32 v147,v147
v_mfma_f32_16x16x32_bf16 v[132:135],a[56:59],a[228:231],v[132:135]
v_cvt_pk_bf16_f32 v168,v144,v145
v_cvt_pk_bf16_f32 v169,v146,v147
v_mfma_f32_16x16x32_bf16 v[132:135],a[60:63],a[224:227],v[132:135]
v_exp_f32 v148,v148
v_mfma_f32_16x16x32_bf16 v[220:223],a[176:179],v[184:187],v[220:223]
v_exp_f32 v149,v149
v_mfma_f32_16x16x32_bf16 a[0:3],a[64:67],v[184:187],a[0:3]
v_exp_f32 v150,v150
v_mfma_f32_16x16x32_bf16 a[4:7],a[68:71],v[184:187],a[4:7]
v_exp_f32 v151,v151
v_mfma_f32_16x16x32_bf16 a[8:11],a[72:75],v[184:187],a[8:11]
s_add_u32 m0,s30,81920
v_cvt_pk_bf16_f32 v170,v148,v149
v_cvt_pk_bf16_f32 v171,v150,v151
v_mfma_f32_16x16x32_bf16 a[12:15],a[76:79],v[184:187],a[12:15]
s_mov_b32 s34,507904
v_exp_f32 v128,v128
v_mfma_f32_16x16x32_bf16 a[16:19],a[80:83],v[184:187],a[16:19]
v_exp_f32 v129,v129
v_mfma_f32_16x16x32_bf16 a[20:23],a[84:87],v[184:187],a[20:23]
v_exp_f32 v130,v130
v_mfma_f32_16x16x32_bf16 a[24:27],a[88:91],v[184:187],a[24:27]
s_waitcnt vmcnt(8) lgkmcnt(0)
s_barrier
v_mfma_f32_16x16x32_bf16 a[28:31],a[92:95],v[184:187],a[28:31]
P293:
s_cbranch_execz L_back
v_mfma_f32_16x16x32_bf16 v[136:139],a[112:115],a[240:243],v[200:203]
v_exp_f32 v131,v131
v_mfma_f32_16x16x32_bf16 v[136:139],a[116:119],a[244:247],v[136:139]
ds_read_b128 a[112:115],v224
v_cvt_pk_bf16_f32 v172,v128,v129
v_mfma_f32_16x16x32_bf16 v[136:139],a[120:123],a[248:251],v[136:139]
buffer_load_dwordx4 v227,s[16:19],s34 offen nt lds
v_mfma_f32_16x16x32_bf16 v[136:139],a[124:127],a[252:255],v[136:139]
ds_read_b128 a[116:119],v224 offset:256
v_cvt_pk_bf16_f32 v173,v130,v131
v_mfma_f32_16x16x32_bf16 v[140:143],a[128:131],a[252:255],v[200:203]
v_exp_f32 v132,v132
v_mfma_f32_16x16x32_bf16 v[140:143],a[132:135],a[248:251],v[140:143]
v_exp_f32 v133,v133
v_mfma_f32_16x16x32_bf16 v[140:143],a[136:139],a[244:247],v[140:143]
v_exp_f32 v134,v134
v_mfma_f32_16x16x32_bf16 v[140:143],a[140:143],a[240:243],v[140:143]
v_exp_f32 v135,v135
v_mfma_f32_16x16x32_bf16 v[144:147],a[32:35],a[240:243],v[200:203]
ds_read_b128 a[120:123],v224 offset:512
v_cvt_pk_bf16_f32 v174,v132,v133
v_mfma_f32_16x16x32_bf16 v[144:147],a[36:39],a[244:247],v[144:147]
ds_read_b128 a[124:127],v224 offset:768
v_cvt_pk_bf16_f32 v175,v134,v135
v_mfma_f32_16x16x32_bf16 v[144:147],a[40:43],a[248:251],v[144:147]
v_exp_f32 v136,v136
v_mfma_f32_16x16x32_bf16 v[144:147],a[44:47],a[252:255],v[144:147]
ds_read_b128 a[128:131],v224 offset:1792
ds_read_b128 a[132:135],v224 offset:1536
v_mfma_f32_16x16x32_bf16 v[148:151],a[48:51],a[252:255],v[200:203]
v_exp_f32 v137,v137
v_mfma_f32_16x16x32_bf16 v[148:151],a[52:55],a[248:251],v[148:151]
ds_read_b128 a[136:139],v224 offset:1280
ds_read_b128 a[140:143],v224 offset:1024
v_mfma_f32_16x16x32_bf16 v[148:151],a[56:59],a[244:247],v[148:151]
P294:
s_cbranch_execz L_back
v_mfma_f32_16x16x32_bf16 v[148:151],a[60:63],a[240:243],v[148:151]
v_exp_f32 v138,v138
v_mfma_f32_16x16x32_bf16 v[216:219],a[184:187],v[168:171],v[216:219]
v_exp_f32 v139,v139
v_mfma_f32_16x16x32_bf16 v[216:219],a[184:187],v[172:175],v[216:219]
v_xor_b32 v224,0x800,v224
v_cvt_pk_bf16_f32 v176,v136,v137
v_mfma_f32_16x16x32_bf16 v[0:3],a[64:67],v[172:175],v[0:3]
ds_read_b128 a[32:35],v224
ds_read_b128 a[36:39],v224 offset:256
v_mfma_f32_16x16x32_bf16 v[0:3],a[144:147],v[168:171],v[0:3]
buffer_load_dwordx4 v227,s[16:19],s34 offen offset:1024 nt lds
v_mfma_f32_16x16x32_bf16 v[4:7],a[148:151],v[168:171],v[4:7]
ds_read_b128 a[40:43],v224 offset:512
ds_read_b128 a[44:47],v224 offset:768
v_mfma_f32_16x16x32_bf16 v[4:7],a[68:71],v[172:175],v[4:7]
v_cvt_pk_bf16_f32 v177,v138,v139
v_mfma_f32_16x16x32_bf16 v[8:11],a[72:75],v[172:175],v[8:11]
v_exp_f32 v140,v140
v_mfma_f32_16x16x32_bf16 v[8:11],a[152:155],v[168:171],v[8:11]
ds_read_b128 a[48:51],v224 offset:1792
ds_read_b128 a[52:55],v224 offset:1536
v_mfma_f32_16x16x32_bf16 v[12:15],a[156:159],v[168:171],v[12:15]
v_exp_f32 v141,v141
v_mfma_f32_16x16x32_bf16 v[12:15],a[76:79],v[172:175],v[12:15]
v_exp_f32 v142,v142
v_mfma_f32_16x16x32_bf16 v[16:19],a[80:83],v[172:175],v[16:19]
ds_read_b128 a[56:59],v224 offset:1280
ds_read_b128 a[60:63],v224 offset:1024
v_mfma_f32_16x16x32_bf16 v[16:19],a[160:163],v[168:171],v[16:19]
v_exp_f32 v143,v143
v_mfma_f32_16x16x32_bf16 v[20:23],a[164:167],v[168:171],v[20:23]
v_cvt_pk_bf16_f32 v178,v140,v141
v_cvt_pk_bf16_f32 v179,v142,v143
v_mfma_f32_16x16x32_bf16 v[20:23],a[84:87],v[172:175],v[20:23]
P295:
s_cbranch_execz L_back
v_mfma_f32_16x16x32_bf16 v[24:27],a[88:91],v[172:175],v[24:27]
v_exp_f32 v144,v144
v_mfma_f32_16x16x32_bf16 v[24:27],a[168:171],v[168:171],v[24:27]
v_exp_f32 v145,v145
v_mfma_f32_16x16x32_bf16 v[28:31],a[172:175],v[168:171],v[28:31]
v_exp_f32 v146,v146
v_mfma_f32_16x16x32_bf16 v[28:31],a[92:95],v[172:175],v[28:31]
s_waitcnt lgkmcnt(0)
v_exp_f32 v147,v147
v_mfma_f32_16x16x32_bf16 v[128:131],a[112:115],a[192:195],v[188:191]
v_cvt_pk_bf16_f32 v180,v144,v145
v_cvt_pk_bf16_f32 v181,v146,v147
v_mfma_f32_16x16x32_bf16 v[128:131],a[116:119],a[196:199],v[128:131]
v_exp_f32 v148,v148
v_mfma_f32_16x16x32_bf16 v[128:131],a[120:123],a[200:203],v[128:131]
buffer_load_dwordx4 v227,s[16:19],s34 offen offset:2048 nt lds
v_mfma_f32_16x16x32_bf16 v[128:131],a[124:127],a[204:207],v[128:131]
v_exp_f32 v149,v149
v_mfma_f32_16x16x32_bf16 v[132:135],a[128:131],a[204:207],v[188:191]
v_exp_f32 v150,v150
v_mfma_f32_16x16x32_bf16 v[132:135],a[132:135],a[200:203],v[132:135]
v_exp_f32 v151,v151
v_mfma_f32_16x16x32_bf16 v[132:135],a[136:139],a[196:199],v[132:135]
v_cvt_pk_bf16_f32 v182,v148,v149
v_cvt_pk_bf16_f32 v183,v150,v151
v_mfma_f32_16x16x32_bf16 v[132:135],a[140:143],a[192:195],v[132:135]
v_exp_f32 v128,v128
v_mfma_f32_16x16x32_bf16 v[136:139],a[32:35],a[192:195],v[188:191]
v_exp_f32 v129,v129
v_mfma_f32_16x16x32_bf16 v[136:139],a[36:39],a[196:199],v[136:139]
v_exp_f32 v130,v130
v_mfma_f32_16x16x32_bf16 v[136:139],a[40:43],a[200:203],v[136:139]
v_exp_f32 v131,v131
v_mfma_f32_16x16x32_bf16 v[136:139],a[44:47],a[204:207],v[136:139]
v_cvt_pk_bf16_f32 v168,v128,v129
v_cvt_pk_bf16_f32 v169,v130,v131
v_mfma_f32_16x16x32_bf16 v[140:143],a[48:51],a[204:207],v[188:191]
v_exp_f32 v132,v132
v_mfma_f32_16x16x32_bf16 v[140:143],a[52:55],a[200:203],v[140:143]
P296:
s_cbranch_execz L_back
v_mfma_f32_16x16x32_bf16 v[140:143],a[56:59],a[196:199],v[140:143]
v_exp_f32 v133,v133
v_mfma_f32_16x16x32_bf16 v[140:143],a[60:63],a[192:195],v[140:143]
v_exp_f32 v134,v134
v_mfma_f32_16x16x32_bf16 v[216:219],a[188:191],v[176:179],v[216:219]
v_exp_f32 v135,v135
v_mfma_f32_16x16x32_bf16 v[216:219],a[188:191],v[180:183],v[216:219]
v_cvt_pk_bf16_f32 v170,v132,v133
v_cvt_pk_bf16_f32 v171,v134,v135
v_mfma_f32_16x16x32_bf16 v[32:35],a[64:67],v[180:183],v[32:35]
v_exp_f32 v136,v136
v_mfma_f32_16x16x32_bf16 v[32:35],a[144:147],v[176:179],v[32:35]
ds_read_b64_tr_b16 a[144:145],v225
ds_read_b64_tr_b16 a[146:147],v225 offset:1024
v_mfma_f32_16x16x32_bf16 v[36:39],a[148:151],v[176:179],v[36:39]
ds_read_b64_tr_b16 a[148:149],v226
ds_read_b64_tr_b16 a[150:151],v226 offset:1024
v_mfma_f32_16x16x32_bf16 v[36:39],a[68:71],v[180:183],v[36:39]
buffer_load_dwordx4 v227,s[16:19],s34 offen offset:3072 nt lds
v_mfma_f32_16x16x32_bf16 v[40:43],a[72:75],v[180:183],v[40:43]
v_exp_f32 v137,v137
v_mfma_f32_16x16x32_bf16 v[40:43],a[152:155],v[176:179],v[40:43]
ds_read_b64_tr_b16 a[152:153],v225 offset:256
ds_read_b64_tr_b16 a[154:155],v225 offset:1280
v_mfma_f32_16x16x32_bf16 v[44:47],a[156:159],v[176:179],v[44:47]
v_exp_f32 v138,v138
v_mfma_f32_16x16x32_bf16 v[44:47],a[76:79],v[180:183],v[44:47]
ds_read_b64_tr_b16 a[156:157],v226 offset:256
ds_read_b64_tr_b16 a[158:159],v226 offset:1280
v_mfma_f32_16x16x32_bf16 v[48:51],a[80:83],v[180:183],v[48:51]
v_exp_f32 v139,v139
v_mfma_f32_16x16x32_bf16 v[48:51],a[160:163],v[176:179],v[48:51]
ds_read_b64_tr_b16 a[160:161],v225 offset:512
ds_read_b64_tr_b16 a[162:163],v225 offset:1536
v_mfma_f32_16x16x32_bf16 v[52:55],a[164:167],v[176:179],v[52:55]
P297:
s_cbranch_execz L_back
v_mfma_f32_16x16x32_bf16 v[52:55],a[84:87],v[180:183],v[52:55]
s_add_u32 m0,s30,0
ds_read_b64_tr_b16 a[164:165],v226 offset:512
ds_read_b64_tr_b16 a[166:167],v226 offset:1536
v_mfma_f32_16x16x32_bf16 v[56:59],a[88:91],v[180:183],v[56:59]
s_mov_b32 s34,507904
v_cvt_pk_bf16_f32 v172,v136,v137
v_cvt_pk_bf16_f32 v173,v138,v139
v_mfma_f32_16x16x32_bf16 v[56:59],a[168:171],v[176:179],v[56:59]
ds_read_b64_tr_b16 a[168:169],v225 offset:768
ds_read_b64_tr_b16 a[170:171],v225 offset:1792
v_mfma_f32_16x16x32_bf16 v[60:63],a[172:175],v[176:179],v[60:63]
v_exp_f32 v140,v140
v_mfma_f32_16x16x32_bf16 v[60:63],a[92:95],v[180:183],v[60:63]
ds_read_b64_tr_b16 a[172:173],v226 offset:768
ds_read_b64_tr_b16 a[174:175],v226 offset:1792
v_mfma_f32_16x16x32_bf16 v[144:147],a[112:115],a[208:211],v[192:195]
v_xor_b32 v225,0x800,v225
v_xor_b32 v226,0x800,v226
v_mfma_f32_16x16x32_bf16 v[144:147],a[116:119],a[212:215],v[144:147]
ds_read_b64_tr_b16 a[64:65],v225
ds_read_b64_tr_b16 a[66:67],v225 offset:1024
v_mfma_f32_16x16x32_bf16 v[144:147],a[120:123],a[216:219],v[144:147]
buffer_load_dwordx4 v227,s[20:23],s34 offen nt lds
v_mfma_f32_16x16x32_bf16 v[144:147],a[124:127],a[220:223],v[144:147]
ds_read_b64_tr_b16 a[68:69],v226
ds_read_b64_tr_b16 a[70:71],v226 offset:1024
v_mfma_f32_16x16x32_bf16 v[148:151],a[128:131],a[220:223],v[192:195]
v_exp_f32 v141,v141
v_mfma_f32_16x16x32_bf16 v[148:151],a[132:135],a[216:219],v[148:151]
ds_read_b64_tr_b16 a[72:73],v225 offset:256
ds_read_b64_tr_b16 a[74:75],v225 offset:1280
v_mfma_f32_16x16x32_bf16 v[148:151],a[136:139],a[212:215],v[148:151]
P298:
s_cbranch_execz L_back
v_mfma_f32_16x16x32_bf16 v[148:151],a[140:143],a[208:211],v[148:151]
ds_read_b64_tr_b16 a[76:77],v226 offset:256
ds_read_b64_tr_b16 a[78:79],v226 offset:1280
v_mfma_f32_16x16x32_bf16 v[128:131],a[32:35],a[208:211],v[192:195]
v_exp_f32 v142,v142
v_mfma_f32_16x16x32_bf16 v[128:131],a[36:39],a[212:215],v[128:131]
ds_read_b64_tr_b16 a[80:81],v225 offset:512
ds_read_b64_tr_b16 a[82:83],v225 offset:1536
v_mfma_f32_16x16x32_bf16 v[128:131],a[40:43],a[216:219],v[128:131]
v_exp_f32 v143,v143
v_mfma_f32_16x16x32_bf16 v[128:131],a[44:47],a[220:223],v[128:131]
ds_read_b64_tr_b16 a[84:85],v226 offset:512
v_cvt_pk_bf16_f32 v174,v140,v141
v_mfma_f32_16x16x32_bf16 v[132:135],a[48:51],a[220:223],v[192:195]
ds_read_b64_tr_b16 a[86:87],v226 offset:1536
v_cvt_pk_bf16_f32 v175,v142,v143
v_mfma_f32_16x16x32_bf16 v[132:135],a[52:55],a[216:219],v[132:135]
v_exp_f32 v144,v144
v_mfma_f32_16x16x32_bf16 v[132:135],a[56:59],a[212:215],v[132:135]
ds_read_b64_tr_b16 a[88:89],v225 offset:768
ds_read_b64_tr_b16 a[90:91],v225 offset:1792
v_mfma_f32_16x16x32_bf16 v[132:135],a[60:63],a[208:211],v[132:135]
v_exp_f32 v145,v145
v_mfma_f32_16x16x32_bf16 v[216:219],a[176:179],v[168:171],v[216:219]
ds_read_b64_tr_b16 a[92:93],v226 offset:768
ds_read_b64_tr_b16 a[94:95],v226 offset:1792
v_mfma_f32_16x16x32_bf16 v[216:219],a[176:179],v[172:175],v[216:219]
s_waitcnt lgkmcnt(5)
v_exp_f32 v146,v146
v_mfma_f32_16x16x32_bf16 v[64:67],a[64:67],v[172:175],v[64:67]
v_exp_f32 v147,v147
v_mfma_f32_16x16x32_bf16 v[64:67],a[144:147],v[168:171],v[64:67]
buffer_load_dwordx4 v227,s[20:23],s34 offen offset:1024 nt lds
v_mfma_f32_16x16x32_bf16 v[68:71],a[148:151],v[168:171],v[68:71]
P299:
s_cbranch_execz L_back
Z18:
s_cbranch_execz ZB1
v_mfma_f32_16x16x32_bf16 v[68:71],a[68:71],v[172:175],v[68:71]
v_cvt_pk_bf16_f32 v176,v144,v145
v_cvt_pk_bf16_f32 v177,v146,v147
v_mfma_f32_16x16x32_bf16 v[72:75],a[72:75],v[172:175],v[72:75]
v_exp_f32 v148,v148
v_mfma_f32_16x16x32_bf16 v[72:75],a[152:155],v[168:171],v[72:75]
v_exp_f32 v149,v149
v_mfma_f32_16x16x32_bf16 v[76:79],a[156:159],v[168:171],v[76:79]
v_exp_f32 v150,v150
v_mfma_f32_16x16x32_bf16 v[76:79],a[76:79],v[172:175],v[76:79]
v_exp_f32 v151,v151
v_mfma_f32_16x16x32_bf16 v[80:83],a[80:83],v[172:175],v[80:83]
v_cvt_pk_bf16_f32 v178,v148,v149
v_cvt_pk_bf16_f32 v179,v150,v151
v_mfma_f32_16x16x32_bf16 v[80:83],a[160:163],v[168:171],v[80:83]
v_exp_f32 v128,v128
v_mfma_f32_16x16x32_bf16 v[84:87],a[164:167],v[168:171],v[84:87]
s_waitcnt lgkmcnt(0)
v_exp_f32 v129,v129
v_mfma_f32_16x16x32_bf16 v[84:87],a[84:87],v[172:175],v[84:87]
v_exp_f32 v130,v130
v_mfma_f32_16x16x32_bf16 v[88:91],a[88:91],v[172:175],v[88:91]
v_exp_f32 v131,v131
v_mfma_f32_16x16x32_bf16 v[88:91],a[168:171],v[168:171],v[88:91]
v_cvt_pk_bf16_f32 v180,v128,v129
v_cvt_pk_bf16_f32 v181,v130,v131
v_mfma_f32_16x16x32_bf16 v[92:95],a[172:175],v[168:171],v[92:95]
v_exp_f32 v132,v132
v_mfma_f32_16x16x32_bf16 v[92:95],a[92:95],v[172:175],v[92:95]
v_exp_f32 v133,v133
v_mfma_f32_16x16x32_bf16 v[136:139],a[32:35],a[96:99],v[204:207]
v_exp_f32 v134,v134
v_mfma_f32_16x16x32_bf16 v[136:139],a[36:39],a[100:103],v[136:139]
v_exp_f32 v135,v135
v_mfma_f32_16x16x32_bf16 v[136:139],a[40:43],a[104:107],v[136:139]
buffer_load_dwordx4 v227,s[20:23],s34 offen offset:2048 nt lds
v_mfma_f32_16x16x32_bf16 v[136:139],a[44:47],a[108:111],v[136:139]
v_cvt_pk_bf16_f32 v182,v132,v133
v_cvt_pk_bf16_f32 v183,v134,v135
v_mfma_f32_16x16x32_bf16 v[140:143],a[48:51],a[108:111],v[204:207]
P300:
s_cbranch_execz L_back
v_mfma_f32_16x16x32_bf16 v[140:143],a[52:55],a[104:107],v[140:143]
v_xor_b32 v224,0x8800,v224
v_xor_b32 v225,0x18800,v225
v_mfma_f32_16x16x32_bf16 v[140:143],a[56:59],a[100:103],v[140:143]
v_exp_f32 v136,v136
v_mfma_f32_16x16x32_bf16 v[140:143],a[60:63],a[96:99],v[140:143]
v_exp_f32 v137,v137
v_mfma_f32_16x16x32_bf16 v[216:219],a[180:183],v[176:179],v[216:219]
v_exp_f32 v138,v138
v_mfma_f32_16x16x32_bf16 v[216:219],a[180:183],v[180:183],v[216:219]
v_exp_f32 v139,v139
v_mfma_f32_16x16x32_bf16 v[96:99],a[64:67],v[180:183],v[96:99]
v_cvt_pk_bf16_f32 v184,v136,v137
v_cvt_pk_bf16_f32 v185,v138,v139
v_mfma_f32_16x16x32_bf16 v[96:99],a[144:147],v[176:179],v[96:99]
v_exp_f32 v140,v140
v_mfma_f32_16x16x32_bf16 v[100:103],a[148:151],v[176:179],v[100:103]
v_exp_f32 v141,v141
v_mfma_f32_16x16x32_bf16 v[100:103],a[68:71],v[180:183],v[100:103]
v_exp_f32 v142,v142
v_mfma_f32_16x16x32_bf16 v[104:107],a[72:75],v[180:183],v[104:107]
v_exp_f32 v143,v143
v_mfma_f32_16x16x32_bf16 v[104:107],a[152:155],v[176:179],v[104:107]
v_cvt_pk_bf16_f32 v186,v140,v141
v_cvt_pk_bf16_f32 v187,v142,v143
v_mfma_f32_16x16x32_bf16 v[108:111],a[156:159],v[176:179],v[108:111]
v_xor_b32 v226,0x18800,v226
v_mfma_f32_16x16x32_bf16 v[108:111],a[76:79],v[180:183],v[108:111]
v_mfma_f32_16x16x32_bf16 v[112:115],a[80:83],v[180:183],v[112:115]
v_mfma_f32_16x16x32_bf16 v[112:115],a[160:163],v[176:179],v[112:115]
buffer_load_dwordx4 v227,s[20:23],s34 offen offset:3072 nt lds
v_mfma_f32_16x16x32_bf16 v[116:119],a[164:167],v[176:179],v[116:119]
v_mfma_f32_16x16x32_bf16 v[116:119],a[84:87],v[180:183],v[116:119]
P301:
s_cbranch_execz L_back
v_mfma_f32_16x16x32_bf16 v[120:123],a[88:91],v[180:183],v[120:123]
v_mfma_f32_16x16x32_bf16 v[120:123],a[168:171],v[176:179],v[120:123]
v_mfma_f32_16x16x32_bf16 v[124:127],a[172:175],v[176:179],v[124:127]
v_mfma_f32_16x16x32_bf16 v[124:127],a[92:95],v[180:183],v[124:127]
v_mfma_f32_16x16x32_bf16 v[144:147],a[112:115],a[224:227],v[196:199]
v_mfma_f32_16x16x32_bf16 v[144:147],a[116:119],a[228:231],v[144:147]
v_mfma_f32_16x16x32_bf16 v[144:147],a[120:123],a[232:235],v[144:147]
v_mfma_f32_16x16x32_bf16 v[144:147],a[124:127],a[236:239],v[144:147]
v_mfma_f32_16x16x32_bf16 v[148:151],a[128:131],a[236:239],v[196:199]
v_mfma_f32_16x16x32_bf16 v[148:151],a[132:135],a[232:235],v[148:151]
v_mfma_f32_16x16x32_bf16 v[148:151],a[136:139],a[228:231],v[148:151]
v_mfma_f32_16x16x32_bf16 v[148:151],a[140:143],a[224:227],v[148:151]
v_mfma_f32_16x16x32_bf16 v[128:131],a[32:35],a[224:227],v[196:199]
v_mfma_f32_16x16x32_bf16 v[128:131],a[36:39],a[228:231],v[128:131]
v_mfma_f32_16x16x32_bf16 v[128:131],a[40:43],a[232:235],v[128:131]
v_mfma_f32_16x16x32_bf16 v[128:131],a[44:47],a[236:239],v[128:131]
v_exp_f32 v144,v144
v_mfma_f32_16x16x32_bf16 v[132:135],a[48:51],a[236:239],v[196:199]
v_exp_f32 v145,v145
v_mfma_f32_16x16x32_bf16 v[132:135],a[52:55],a[232:235],v[132:135]
v_exp_f32 v146,v146
v_mfma_f32_16x16x32_bf16 v[132:135],a[56:59],a[228:231],v[132:135]
v_exp_f32 v147,v147
v_mfma_f32_16x16x32_bf16 v[132:135],a[60:63],a[224:227],v[132:135]
v_cvt_pk_bf16_f32 v168,v144,v145
v_cvt_pk_bf16_f32 v169,v146,v147
v_mfma_f32_16x16x32_bf16 v[220:223],a[176:179],v[184:187],v[220:223]
v_exp_f32 v148,v148
v_mfma_f32_16x16x32_bf16 a[0:3],a[64:67],v[184:187],a[0:3]
v_exp_f32 v149,v149
v_mfma_f32_16x16x32_bf16 a[4:7],a[68:71],v[184:187],a[4:7]
v_exp_f32 v150,v150
v_mfma_f32_16x16x32_bf16 a[8:11],a[72:75],v[184:187],a[8:11]
v_exp_f32 v151,v151
v_mfma_f32_16x16x32_bf16 a[12:15],a[76:79],v[184:187],a[12:15]
v_cvt_pk_bf16_f32 v170,v148,v149
v_cvt_pk_bf16_f32 v171,v150,v151
v_mfma_f32_16x16x32_bf16 a[16:19],a[80:83],v[184:187],a[16:19]
P302:
s_cbranch_execz L_back
v_mfma_f32_16x16x32_bf16 a[20:23],a[84:87],v[184:187],a[20:23]
v_exp_f32 v128,v128
v_mfma_f32_16x16x32_bf16 a[24:27],a[88:91],v[184:187],a[24:27]
s_waitcnt vmcnt(8) lgkmcnt(0)
s_barrier
v_mfma_f32_16x16x32_bf16 a[28:31],a[92:95],v[184:187],a[28:31]
v_exp_f32 v129,v129
v_mfma_f32_16x16x32_bf16 v[136:139],a[112:115],a[240:243],v[200:203]
v_exp_f32 v130,v130
v_mfma_f32_16x16x32_bf16 v[136:139],a[116:119],a[244:247],v[136:139]
v_exp_f32 v131,v131
v_mfma_f32_16x16x32_bf16 v[136:139],a[120:123],a[248:251],v[136:139]
ds_read_b128 a[112:115],v224
v_cvt_pk_bf16_f32 v172,v128,v129
v_mfma_f32_16x16x32_bf16 v[136:139],a[124:127],a[252:255],v[136:139]
ds_read_b128 a[116:119],v224 offset:256
v_cvt_pk_bf16_f32 v173,v130,v131
v_mfma_f32_16x16x32_bf16 v[140:143],a[128:131],a[252:255],v[200:203]
v_exp_f32 v132,v132
v_mfma_f32_16x16x32_bf16 v[140:143],a[132:135],a[248:251],v[140:143]
v_exp_f32 v133,v133
v_mfma_f32_16x16x32_bf16 v[140:143],a[136:139],a[244:247],v[140:143]
v_exp_f32 v134,v134
v_mfma_f32_16x16x32_bf16 v[140:143],a[140:143],a[240:243],v[140:143]
v_exp_f32 v135,v135
v_mfma_f32_16x16x32_bf16 v[144:147],a[32:35],a[240:243],v[200:203]
ds_read_b128 a[120:123],v224 offset:512
v_cvt_pk_bf16_f32 v174,v132,v133
v_mfma_f32_16x16x32_bf16 v[144:147],a[36:39],a[244:247],v[144:147]
ds_read_b128 a[124:127],v224 offset:768
v_cvt_pk_bf16_f32 v175,v134,v135
v_mfma_f32_16x16x32_bf16 v[144:147],a[40:43],a[248:251],v[144:147]
v_exp_f32 v136,v136
v_mfma_f32_16x16x32_bf16 v[144:147],a[44:47],a[252:255],v[144:147]
ds_read_b128 a[128:131],v224 offset:1792
ds_read_b128 a[132:135],v224 offset:1536
v_mfma_f32_16x16x32_bf16 v[148:151],a[48:51],a[252:255],v[200:203]
P303:
s_cbranch_execz L_back
v_mfma_f32_16x16x32_bf16 v[148:151],a[52:55],a[248:251],v[148:151]
ds_read_b128 a[136:139],v224 offset:1280
ds_read_b128 a[140:143],v224 offset:1024
v_mfma_f32_16x16x32_bf16 v[148:151],a[56:59],a[244:247],v[148:151]
v_exp_f32 v137,v137
v_mfma_f32_16x16x32_bf16 v[148:151],a[60:63],a[240:243],v[148:151]
v_exp_f32 v138,v138
v_mfma_f32_16x16x32_bf16 v[216:219],a[184:187],v[168:171],v[216:219]
v_exp_f32 v139,v139
v_mfma_f32_16x16x32_bf16 v[216:219],a[184:187],v[172:175],v[216:219]
v_cvt_pk_bf16_f32 v176,v136,v137
v_cvt_pk_bf16_f32 v177,v138,v139
v_mfma_f32_16x16x32_bf16 v[0:3],a[64:67],v[172:175],v[0:3]
v_exp_f32 v140,v140
v_mfma_f32_16x16x32_bf16 v[0:3],a[144:147],v[168:171],v[0:3]
v_exp_f32 v141,v141
v_mfma_f32_16x16x32_bf16 v[4:7],a[148:151],v[168:171],v[4:7]
v_exp_f32 v142,v142
v_mfma_f32_16x16x32_bf16 v[4:7],a[68:71],v[172:175],v[4:7]
v_exp_f32 v143,v143
v_mfma_f32_16x16x32_bf16 v[8:11],a[72:75],v[172:175],v[8:11]
v_cvt_pk_bf16_f32 v178,v140,v141
v_cvt_pk_bf16_f32 v179,v142,v143
v_mfma_f32_16x16x32_bf16 v[8:11],a[152:155],v[168:171],v[8:11]
v_exp_f32 v144,v144
v_mfma_f32_16x16x32_bf16 v[12:15],a[156:159],v[168:171],v[12:15]
v_exp_f32 v145,v145
v_mfma_f32_16x16x32_bf16 v[12:15],a[76:79],v[172:175],v[12:15]
v_exp_f32 v146,v146
v_mfma_f32_16x16x32_bf16 v[16:19],a[80:83],v[172:175],v[16:19]
v_exp_f32 v147,v147
v_mfma_f32_16x16x32_bf16 v[16:19],a[160:163],v[168:171],v[16:19]
v_cvt_pk_bf16_f32 v180,v144,v145
v_cvt_pk_bf16_f32 v181,v146,v147
v_mfma_f32_16x16x32_bf16 v[20:23],a[164:167],v[168:171],v[20:23]
P304:
s_cbranch_execz L_back
v_mfma_f32_16x16x32_bf16 v[20:23],a[84:87],v[172:175],v[20:23]
v_exp_f32 v148,v148
v_mfma_f32_16x16x32_bf16 v[24:27],a[88:91],v[172:175],v[24:27]
v_exp_f32 v149,v149
v_mfma_f32_16x16x32_bf16 v[24:27],a[168:171],v[168:171],v[24:27]
v_exp_f32 v150,v150
v_mfma_f32_16x16x32_bf16 v[28:31],a[172:175],v[168:171],v[28:31]
v_exp_f32 v151,v151
v_mfma_f32_16x16x32_bf16 v[28:31],a[92:95],v[172:175],v[28:31]
s_waitcnt lgkmcnt(0)
v_cvt_pk_bf16_f32 v182,v148,v149
v_cvt_pk_bf16_f32 v183,v150,v151
v_mfma_f32_16x16x32_bf16 v[128:131],a[112:115],a[192:195],v[188:191]
v_xor_b32 v224,0x800,v224
v_mfma_f32_16x16x32_bf16 v[128:131],a[116:119],a[196:199],v[128:131]
v_mfma_f32_16x16x32_bf16 v[128:131],a[120:123],a[200:203],v[128:131]
v_mfma_f32_16x16x32_bf16 v[128:131],a[124:127],a[204:207],v[128:131]
v_mfma_f32_16x16x32_bf16 v[132:135],a[128:131],a[204:207],v[188:191]
v_mfma_f32_16x16x32_bf16 v[132:135],a[132:135],a[200:203],v[132:135]
v_mfma_f32_16x16x32_bf16 v[132:135],a[136:139],a[196:199],v[132:135]
v_mfma_f32_16x16x32_bf16 v[132:135],a[140:143],a[192:195],v[132:135]
v_mfma_f32_16x16x32_bf16 v[140:143],a[140:143],a[208:211],v[192:195]
v_mfma_f32_16x16x32_bf16 v[140:143],a[136:139],a[212:215],v[140:143]
v_mfma_f32_16x16x32_bf16 v[140:143],a[132:135],a[216:219],v[140:143]
v_mfma_f32_16x16x32_bf16 v[140:143],a[128:131],a[220:223],v[140:143]
v_exp_f32 v128,v128
v_mfma_f32_16x16x32_bf16 v[136:139],a[124:127],a[220:223],v[192:195]
v_exp_f32 v129,v129
v_mfma_f32_16x16x32_bf16 v[136:139],a[120:123],a[216:219],v[136:139]
v_exp_f32 v130,v130
v_mfma_f32_16x16x32_bf16 v[136:139],a[116:119],a[212:215],v[136:139]
v_exp_f32 v131,v131
v_mfma_f32_16x16x32_bf16 v[136:139],a[112:115],a[208:211],v[136:139]
v_cvt_pk_bf16_f32 v168,v128,v129
v_cvt_pk_bf16_f32 v169,v130,v131
v_mfma_f32_16x16x32_bf16 v[216:219],a[188:191],v[176:179],v[216:219]
P305:
s_cbranch_execz L_back
v_mfma_f32_16x16x32_bf16 v[216:219],a[188:191],v[180:183],v[216:219]
v_exp_f32 v132,v132
v_mfma_f32_16x16x32_bf16 v[32:35],a[64:67],v[180:183],v[32:35]
v_exp_f32 v133,v133
v_mfma_f32_16x16x32_bf16 v[32:35],a[144:147],v[176:179],v[32:35]
ds_read_b64_tr_b16 a[144:145],v225
ds_read_b64_tr_b16 a[146:147],v225 offset:1024
v_mfma_f32_16x16x32_bf16 v[36:39],a[148:151],v[176:179],v[36:39]
v_exp_f32 v134,v134
v_mfma_f32_16x16x32_bf16 v[36:39],a[68:71],v[180:183],v[36:39]
ds_read_b64_tr_b16 a[148:149],v226
ds_read_b64_tr_b16 a[150:151],v226 offset:1024
v_mfma_f32_16x16x32_bf16 v[40:43],a[72:75],v[180:183],v[40:43]
v_exp_f32 v135,v135
v_mfma_f32_16x16x32_bf16 v[40:43],a[152:155],v[176:179],v[40:43]
ds_read_b64_tr_b16 a[152:153],v225 offset:256
ds_read_b64_tr_b16 a[154:155],v225 offset:1280
v_mfma_f32_16x16x32_bf16 v[44:47],a[156:159],v[176:179],v[44:47]
ds_read_b128 v[240:243],v229 offset:49152
v_cvt_pk_bf16_f32 v170,v132,v133
v_mfma_f32_16x16x32_bf16 v[44:47],a[76:79],v[180:183],v[44:47]
ds_read_b64_tr_b16 a[156:157],v226 offset:256
ds_read_b64_tr_b16 a[158:159],v226 offset:1280
v_mfma_f32_16x16x32_bf16 v[48:51],a[80:83],v[180:183],v[48:51]
ds_read_b128 v[244:247],v230 offset:50176
v_cvt_pk_bf16_f32 v171,v134,v135
v_mfma_f32_16x16x32_bf16 v[48:51],a[160:163],v[176:179],v[48:51]
ds_read_b64_tr_b16 a[160:161],v225 offset:512
ds_read_b64_tr_b16 a[162:163],v225 offset:1536
v_mfma_f32_16x16x32_bf16 v[52:55],a[164:167],v[176:179],v[52:55]
v_exp_f32 v140,v140
v_mfma_f32_16x16x32_bf16 v[52:55],a[84:87],v[180:183],v[52:55]
ds_read_b64_tr_b16 a[164:165],v226 offset:512
ds_read_b64_tr_b16 a[166:167],v226 offset:1536
v_mfma_f32_16x16x32_bf16 v[56:59],a[88:91],v[180:183],v[56:59]
P306:
s_cbranch_execz L_back
v_mfma_f32_16x16x32_bf16 v[56:59],a[168:171],v[176:179],v[56:59]
ds_read_b64_tr_b16 a[168:169],v225 offset:768
ds_read_b64_tr_b16 a[170:171],v225 offset:1792
v_mfma_f32_16x16x32_bf16 v[60:63],a[172:175],v[176:179],v[60:63]
v_exp_f32 v141,v141
v_mfma_f32_16x16x32_bf16 v[60:63],a[92:95],v[180:183],v[60:63]
ds_read_b64_tr_b16 a[172:173],v226 offset:768
ds_read_b64_tr_b16 a[174:175],v226 offset:1792
v_mfma_f32_16x16x32_bf16 v[144:147],a[112:115],a[224:227],v[196:199]
v_exp_f32 v142,v142
v_mfma_f32_16x16x32_bf16 v[144:147],a[116:119],a[228:231],v[144:147]
v_exp_f32 v143,v143
v_mfma_f32_16x16x32_bf16 v[144:147],a[120:123],a[232:235],v[144:147]
ds_read_b128 v[248:251],v229 offset:51200
v_cvt_pk_bf16_f32 v174,v140,v141
v_mfma_f32_16x16x32_bf16 v[144:147],a[124:127],a[236:239],v[144:147]
ds_read_b128 v[252:255],v230 offset:52224
v_cvt_pk_bf16_f32 v175,v142,v143
v_mfma_f32_16x16x32_bf16 v[148:151],a[128:131],a[236:239],v[196:199]
v_exp_f32 v136,v136
v_mfma_f32_16x16x32_bf16 v[148:151],a[132:135],a[232:235],v[148:151]
v_exp_f32 v137,v137
v_mfma_f32_16x16x32_bf16 v[148:151],a[136:139],a[228:231],v[148:151]
v_exp_f32 v138,v138
v_mfma_f32_16x16x32_bf16 v[148:151],a[140:143],a[224:227],v[148:151]
v_exp_f32 v139,v139
v_mfma_f32_16x16x32_bf16 v[132:135],a[140:143],a[240:243],v[200:203]
ds_read_b128 v[208:211],v229
v_cvt_pk_bf16_f32 v172,v136,v137
v_mfma_f32_16x16x32_bf16 v[132:135],a[136:139],a[244:247],v[132:135]
ds_read_b128 v[212:215],v230 offset:1024
v_cvt_pk_bf16_f32 v173,v138,v139
v_mfma_f32_16x16x32_bf16 v[132:135],a[132:135],a[248:251],v[132:135]
v_exp_f32 v144,v144
v_mfma_f32_16x16x32_bf16 v[132:135],a[128:131],a[252:255],v[132:135]
P307:
s_cbranch_execz L_back
v_mfma_f32_16x16x32_bf16 v[128:131],a[124:127],a[252:255],v[200:203]
v_exp_f32 v145,v145
v_mfma_f32_16x16x32_bf16 v[128:131],a[120:123],a[248:251],v[128:131]
v_exp_f32 v146,v146
v_mfma_f32_16x16x32_bf16 v[128:131],a[116:119],a[244:247],v[128:131]
v_exp_f32 v147,v147
v_mfma_f32_16x16x32_bf16 v[128:131],a[112:115],a[240:243],v[128:131]
s_waitcnt lgkmcnt(0)
ds_read_b128 a[112:115],v224
ds_read_b128 a[116:119],v224 offset:256
v_mfma_f32_16x16x32_bf16 v[64:67],a[144:147],v[168:171],v[64:67]
v_cvt_pk_bf16_f32 v176,v144,v145
v_cvt_pk_bf16_f32 v177,v146,v147
v_mfma_f32_16x16x32_bf16 v[68:71],a[148:151],v[168:171],v[68:71]
ds_read_b128 a[120:123],v224 offset:512
ds_read_b128 a[124:127],v224 offset:768
v_mfma_f32_16x16x32_bf16 v[72:75],a[152:155],v[168:171],v[72:75]
v_exp_f32 v148,v148
v_mfma_f32_16x16x32_bf16 v[76:79],a[156:159],v[168:171],v[76:79]
ds_read_b128 a[128:131],v224 offset:1792
ds_read_b128 a[132:135],v224 offset:1536
v_mfma_f32_16x16x32_bf16 v[80:83],a[160:163],v[168:171],v[80:83]
v_exp_f32 v149,v149
v_mfma_f32_16x16x32_bf16 v[84:87],a[164:167],v[168:171],v[84:87]
ds_read_b128 a[136:139],v224 offset:1280
ds_read_b128 a[140:143],v224 offset:1024
v_mfma_f32_16x16x32_bf16 v[88:91],a[168:171],v[168:171],v[88:91]
v_exp_f32 v150,v150
v_mfma_f32_16x16x32_bf16 v[92:95],a[172:175],v[168:171],v[92:95]
v_exp_f32 v151,v151
v_mfma_f32_16x16x32_bf16 v[216:219],a[176:179],v[168:171],v[216:219]
v_cvt_pk_bf16_f32 v178,v148,v149
v_cvt_pk_bf16_f32 v179,v150,v151
v_mfma_f32_16x16x32_bf16 v[216:219],a[180:183],v[172:175],v[216:219]
v_exp_f32 v132,v132
v_mfma_f32_16x16x32_bf16 v[96:99],a[144:147],v[172:175],v[96:99]
P308:
s_cbranch_execz L_back
v_mfma_f32_16x16x32_bf16 v[100:103],a[148:151],v[172:175],v[100:103]
buffer_store_dwordx4 v[240:243],v228,s[24:27],s72 offen nt
v_mfma_f32_16x16x32_bf16 v[104:107],a[152:155],v[172:175],v[104:107]
v_exp_f32 v133,v133
v_mfma_f32_16x16x32_bf16 v[108:111],a[156:159],v[172:175],v[108:111]
v_exp_f32 v134,v134
v_mfma_f32_16x16x32_bf16 v[112:115],a[160:163],v[172:175],v[112:115]
v_exp_f32 v135,v135
v_mfma_f32_16x16x32_bf16 v[116:119],a[164:167],v[172:175],v[116:119]
ds_read_b128 v[240:243],v229 offset:2048
v_cvt_pk_bf16_f32 v182,v132,v133
v_mfma_f32_16x16x32_bf16 v[120:123],a[168:171],v[172:175],v[120:123]
v_cvt_pk_bf16_f32 v183,v134,v135
v_xor_b32 v225,0x800,v225
v_mfma_f32_16x16x32_bf16 v[124:127],a[172:175],v[172:175],v[124:127]
s_waitcnt lgkmcnt(1)
v_exp_f32 v128,v128
v_mfma_f32_16x16x32_bf16 v[136:139],a[112:115],a[96:99],v[204:207]
v_exp_f32 v129,v129
v_mfma_f32_16x16x32_bf16 v[136:139],a[116:119],a[100:103],v[136:139]
v_exp_f32 v130,v130
v_mfma_f32_16x16x32_bf16 v[136:139],a[120:123],a[104:107],v[136:139]
buffer_store_dwordx4 v[244:247],v228,s[24:27],s72 offen offset:1024 nt
v_mfma_f32_16x16x32_bf16 v[136:139],a[124:127],a[108:111],v[136:139]
v_exp_f32 v131,v131
v_mfma_f32_16x16x32_bf16 v[140:143],a[128:131],a[108:111],v[204:207]
v_cvt_pk_bf16_f32 v180,v128,v129
v_cvt_pk_bf16_f32 v181,v130,v131
v_mfma_f32_16x16x32_bf16 v[140:143],a[132:135],a[104:107],v[140:143]
ds_read_b128 v[244:247],v230 offset:3072
v_xor_b32 v226,0x800,v226
v_mfma_f32_16x16x32_bf16 v[140:143],a[136:139],a[100:103],v[140:143]
v_exp_f32 v136,v136
v_mfma_f32_16x16x32_bf16 v[140:143],a[140:143],a[96:99],v[140:143]
v_exp_f32 v137,v137
v_mfma_f32_16x16x32_bf16 v[148:151],a[140:143],a[192:195],v[188:191]
P309:
s_cbranch_execz L_back
v_mfma_f32_16x16x32_bf16 v[148:151],a[136:139],a[196:199],v[148:151]
v_exp_f32 v138,v138
v_mfma_f32_16x16x32_bf16 v[148:151],a[132:135],a[200:203],v[148:151]
v_exp_f32 v139,v139
v_mfma_f32_16x16x32_bf16 v[148:151],a[128:131],a[204:207],v[148:151]
v_cvt_pk_bf16_f32 v184,v136,v137
v_cvt_pk_bf16_f32 v185,v138,v139
v_mfma_f32_16x16x32_bf16 v[144:147],a[124:127],a[204:207],v[188:191]
v_exp_f32 v140,v140
v_mfma_f32_16x16x32_bf16 v[144:147],a[120:123],a[200:203],v[144:147]
buffer_store_dwordx4 v[248:251],v228,s[24:27],s72 offen offset:2048 nt
v_mfma_f32_16x16x32_bf16 v[144:147],a[116:119],a[196:199],v[144:147]
v_exp_f32 v141,v141
v_mfma_f32_16x16x32_bf16 v[144:147],a[112:115],a[192:195],v[144:147]
v_exp_f32 v142,v142
v_mfma_f32_16x16x32_bf16 v[0:3],a[144:147],v[176:179],v[0:3]
v_exp_f32 v143,v143
v_mfma_f32_16x16x32_bf16 v[4:7],a[148:151],v[176:179],v[4:7]
ds_read_b128 v[248:251],v229 offset:16384
v_cvt_pk_bf16_f32 v186,v140,v141
v_mfma_f32_16x16x32_bf16 v[8:11],a[152:155],v[176:179],v[8:11]
v_cvt_pk_bf16_f32 v187,v142,v143
v_xor_b32 v224,0x18800,v224
v_mfma_f32_16x16x32_bf16 v[12:15],a[156:159],v[176:179],v[12:15]
v_exp_f32 v148,v148
v_mfma_f32_16x16x32_bf16 v[16:19],a[160:163],v[176:179],v[16:19]
v_exp_f32 v149,v149
v_mfma_f32_16x16x32_bf16 v[20:23],a[164:167],v[176:179],v[20:23]
v_exp_f32 v150,v150
v_mfma_f32_16x16x32_bf16 v[24:27],a[168:171],v[176:179],v[24:27]
v_exp_f32 v151,v151
v_mfma_f32_16x16x32_bf16 v[28:31],a[172:175],v[176:179],v[28:31]
v_cvt_pk_bf16_f32 v170,v148,v149
v_cvt_pk_bf16_f32 v171,v150,v151
v_mfma_f32_16x16x32_bf16 v[216:219],a[184:187],v[176:179],v[216:219]
buffer_store_dwordx4 v[252:255],v228,s[24:27],s72 offen offset:3072 nt
v_mfma_f32_16x16x32_bf16 v[216:219],a[188:191],v[180:183],v[216:219]
P310:
s_cbranch_execz L_back
v_mfma_f32_16x16x32_bf16 v[32:35],a[144:147],v[180:183],v[32:35]
ds_read_b64_tr_b16 a[144:145],v225
ds_read_b64_tr_b16 a[146:147],v225 offset:1024
v_mfma_f32_16x16x32_bf16 v[36:39],a[148:151],v[180:183],v[36:39]
v_exp_f32 v144,v144
v_mfma_f32_16x16x32_bf16 v[40:43],a[152:155],v[180:183],v[40:43]
ds_read_b64_tr_b16 a[148:149],v226
ds_read_b64_tr_b16 a[150:151],v226 offset:1024
v_mfma_f32_16x16x32_bf16 v[44:47],a[156:159],v[180:183],v[44:47]
v_exp_f32 v145,v145
v_mfma_f32_16x16x32_bf16 v[48:51],a[160:163],v[180:183],v[48:51]
ds_read_b64_tr_b16 a[152:153],v225 offset:256
ds_read_b64_tr_b16 a[154:155],v225 offset:1280
v_mfma_f32_16x16x32_bf16 v[52:55],a[164:167],v[180:183],v[52:55]
v_exp_f32 v146,v146
v_mfma_f32_16x16x32_bf16 v[56:59],a[168:171],v[180:183],v[56:59]
ds_read_b64_tr_b16 a[156:157],v226 offset:256
ds_read_b64_tr_b16 a[158:159],v226 offset:1280
v_mfma_f32_16x16x32_bf16 v[60:63],a[172:175],v[180:183],v[60:63]
v_exp_f32 v147,v147
v_mfma_f32_16x16x32_bf16 v[128:131],a[112:115],a[208:211],v[192:195]
buffer_store_dwordx4 v[208:211],v228,s[24:27],s74 offen nt
v_mfma_f32_16x16x32_bf16 v[128:131],a[116:119],a[212:215],v[128:131]
ds_read_b64_tr_b16 a[160:161],v225 offset:512
ds_read_b64_tr_b16 a[162:163],v225 offset:1536
v_mfma_f32_16x16x32_bf16 v[128:131],a[120:123],a[216:219],v[128:131]
ds_read_b128 v[252:255],v230 offset:17408
v_cvt_pk_bf16_f32 v168,v144,v145
v_mfma_f32_16x16x32_bf16 v[128:131],a[124:127],a[220:223],v[128:131]
ds_read_b64_tr_b16 a[164:165],v226 offset:512
ds_read_b64_tr_b16 a[166:167],v226 offset:1536
v_mfma_f32_16x16x32_bf16 v[132:135],a[128:131],a[220:223],v[192:195]
ds_read_b128 v[208:211],v229 offset:18432
v_cvt_pk_bf16_f32 v169,v146,v147
v_mfma_f32_16x16x32_bf16 v[132:135],a[132:135],a[216:219],v[132:135]
P311:
s_cbranch_execz L_back
v_mfma_f32_16x16x32_bf16 v[132:135],a[136:139],a[212:215],v[132:135]
ds_read_b64_tr_b16 a[168:169],v225 offset:768
ds_read_b64_tr_b16 a[170:171],v225 offset:1792
v_mfma_f32_16x16x32_bf16 v[132:135],a[140:143],a[208:211],v[132:135]
v_exp_f32 v128,v128
v_mfma_f32_16x16x32_bf16 v[140:143],a[140:143],a[224:227],v[196:199]
ds_read_b64_tr_b16 a[172:173],v226 offset:768
ds_read_b64_tr_b16 a[174:175],v226 offset:1792
v_mfma_f32_16x16x32_bf16 v[140:143],a[136:139],a[228:231],v[140:143]
v_exp_f32 v129,v129
v_mfma_f32_16x16x32_bf16 v[140:143],a[132:135],a[232:235],v[140:143]
v_exp_f32 v130,v130
v_mfma_f32_16x16x32_bf16 v[140:143],a[128:131],a[236:239],v[140:143]
buffer_store_dwordx4 v[212:215],v228,s[24:27],s74 offen offset:1024 nt
v_mfma_f32_16x16x32_bf16 v[136:139],a[124:127],a[236:239],v[196:199]
v_exp_f32 v131,v131
v_mfma_f32_16x16x32_bf16 v[136:139],a[120:123],a[232:235],v[136:139]
v_cvt_pk_bf16_f32 v172,v128,v129
v_cvt_pk_bf16_f32 v173,v130,v131
v_mfma_f32_16x16x32_bf16 v[136:139],a[116:119],a[228:231],v[136:139]
ds_read_b128 v[212:215],v230 offset:19456
v_xor_b32 v225,0x10000,v225
v_mfma_f32_16x16x32_bf16 v[136:139],a[112:115],a[224:227],v[136:139]
s_waitcnt lgkmcnt(1)
v_exp_f32 v132,v132
v_mfma_f32_16x16x32_bf16 a[0:3],a[144:147],v[184:187],a[0:3]
v_exp_f32 v133,v133
v_mfma_f32_16x16x32_bf16 a[4:7],a[148:151],v[184:187],a[4:7]
v_exp_f32 v134,v134
v_mfma_f32_16x16x32_bf16 a[8:11],a[152:155],v[184:187],a[8:11]
v_exp_f32 v135,v135
v_mfma_f32_16x16x32_bf16 a[12:15],a[156:159],v[184:187],a[12:15]
v_cvt_pk_bf16_f32 v174,v132,v133
v_cvt_pk_bf16_f32 v175,v134,v135
v_mfma_f32_16x16x32_bf16 a[16:19],a[160:163],v[184:187],a[16:19]
P312:
s_cbranch_execz L_back
v_mfma_f32_16x16x32_bf16 a[20:23],a[164:167],v[184:187],a[20:23]
v_exp_f32 v140,v140
v_mfma_f32_16x16x32_bf16 a[24:27],a[168:171],v[184:187],a[24:27]
s_waitcnt vmcnt(6) lgkmcnt(0)
s_barrier
v_mfma_f32_16x16x32_bf16 a[28:31],a[172:175],v[184:187],a[28:31]
buffer_store_dwordx4 v[240:243],v228,s[24:27],s74 offen offset:2048 nt
v_mfma_f32_16x16x32_bf16 v[220:223],a[176:179],v[184:187],v[220:223]
v_exp_f32 v141,v141
v_mfma_f32_16x16x32_bf16 v[216:219],a[176:179],v[168:171],v[216:219]
v_exp_f32 v142,v142
v_mfma_f32_16x16x32_bf16 v[64:67],a[144:147],v[168:171],v[64:67]
v_exp_f32 v143,v143
v_mfma_f32_16x16x32_bf16 v[68:71],a[148:151],v[168:171],v[68:71]
ds_read_b128 v[240:243],v229 offset:32768
v_cvt_pk_bf16_f32 v178,v140,v141
v_mfma_f32_16x16x32_bf16 v[72:75],a[152:155],v[168:171],v[72:75]
v_cvt_pk_bf16_f32 v179,v142,v143
v_xor_b32 v226,0x10000,v226
v_mfma_f32_16x16x32_bf16 v[76:79],a[156:159],v[168:171],v[76:79]
v_exp_f32 v136,v136
v_mfma_f32_16x16x32_bf16 v[80:83],a[160:163],v[168:171],v[80:83]
v_exp_f32 v137,v137
v_mfma_f32_16x16x32_bf16 v[84:87],a[164:167],v[168:171],v[84:87]
v_exp_f32 v138,v138
v_mfma_f32_16x16x32_bf16 v[88:91],a[168:171],v[168:171],v[88:91]
buffer_store_dwordx4 v[244:247],v228,s[24:27],s74 offen offset:3072 nt
v_mfma_f32_16x16x32_bf16 v[92:95],a[172:175],v[168:171],v[92:95]
v_exp_f32 v139,v139
v_mfma_f32_16x16x32_bf16 v[144:147],a[112:115],a[240:243],v[200:203]
ds_read_b64_tr_b16 a[64:65],v225
v_cvt_pk_bf16_f32 v176,v136,v137
v_mfma_f32_16x16x32_bf16 v[144:147],a[116:119],a[244:247],v[144:147]
ds_read_b128 a[112:115],v224
ds_read_b128 a[116:119],v224 offset:256
v_mfma_f32_16x16x32_bf16 v[144:147],a[120:123],a[248:251],v[144:147]
P313:
s_cbranch_execz L_back
v_mfma_f32_16x16x32_bf16 v[144:147],a[124:127],a[252:255],v[144:147]
ds_read_b128 a[120:123],v224 offset:512
ds_read_b128 a[124:127],v224 offset:768
v_mfma_f32_16x16x32_bf16 v[148:151],a[128:131],a[252:255],v[200:203]
ds_read_b64_tr_b16 a[66:67],v225 offset:1024
v_cvt_pk_bf16_f32 v177,v138,v139
v_mfma_f32_16x16x32_bf16 v[148:151],a[132:135],a[248:251],v[148:151]
ds_read_b128 a[128:131],v224 offset:1792
ds_read_b128 a[132:135],v224 offset:1536
v_mfma_f32_16x16x32_bf16 v[148:151],a[136:139],a[244:247],v[148:151]
ds_read_b64_tr_b16 a[68:69],v226
ds_read_b64_tr_b16 a[70:71],v226 offset:1024
v_mfma_f32_16x16x32_bf16 v[148:151],a[140:143],a[240:243],v[148:151]
ds_read_b128 a[136:139],v224 offset:1280
ds_read_b128 a[140:143],v224 offset:1024
v_mfma_f32_16x16x32_bf16 v[96:99],a[144:147],v[172:175],v[96:99]
buffer_store_dwordx4 v[248:251],v228,s[24:27],s75 offen nt
v_mfma_f32_16x16x32_bf16 v[100:103],a[148:151],v[172:175],v[100:103]
ds_read_b64_tr_b16 a[72:73],v225 offset:256
v_xor_b32 v224,0x800,v224
v_mfma_f32_16x16x32_bf16 v[104:107],a[152:155],v[172:175],v[104:107]
ds_read_b128 a[32:35],v224
ds_read_b128 a[36:39],v224 offset:256
v_mfma_f32_16x16x32_bf16 v[108:111],a[156:159],v[172:175],v[108:111]
v_exp_f32 v144,v144
v_mfma_f32_16x16x32_bf16 v[112:115],a[160:163],v[172:175],v[112:115]
ds_read_b128 a[40:43],v224 offset:512
ds_read_b128 a[44:47],v224 offset:768
v_mfma_f32_16x16x32_bf16 v[116:119],a[164:167],v[172:175],v[116:119]
v_exp_f32 v145,v145
v_mfma_f32_16x16x32_bf16 v[120:123],a[168:171],v[172:175],v[120:123]
ds_read_b128 a[48:51],v224 offset:1792
ds_read_b128 a[52:55],v224 offset:1536
v_mfma_f32_16x16x32_bf16 v[124:127],a[172:175],v[172:175],v[124:127]
P314:
s_cbranch_execz L_back
v_mfma_f32_16x16x32_bf16 v[216:219],a[180:183],v[172:175],v[216:219]
ds_read_b128 a[56:59],v224 offset:1280
ds_read_b128 a[60:63],v224 offset:1024
v_mfma_f32_16x16x32_bf16 v[216:219],a[184:187],v[176:179],v[216:219]
ds_read_b64_tr_b16 a[74:75],v225 offset:1280
ds_read_b128 v[244:247],v230 offset:33792
v_mfma_f32_16x16x32_bf16 v[0:3],a[144:147],v[176:179],v[0:3]
buffer_store_dwordx4 v[252:255],v228,s[24:27],s75 offen offset:1024 nt
v_mfma_f32_16x16x32_bf16 v[4:7],a[148:151],v[176:179],v[4:7]
v_exp_f32 v146,v146
v_mfma_f32_16x16x32_bf16 v[8:11],a[152:155],v[176:179],v[8:11]
v_exp_f32 v147,v147
v_mfma_f32_16x16x32_bf16 v[12:15],a[156:159],v[176:179],v[12:15]
ds_read_b64_tr_b16 a[76:77],v226 offset:256
v_cvt_pk_bf16_f32 v180,v144,v145
v_mfma_f32_16x16x32_bf16 v[16:19],a[160:163],v[176:179],v[16:19]
ds_read_b64_tr_b16 a[78:79],v226 offset:1280
v_cvt_pk_bf16_f32 v181,v146,v147
v_mfma_f32_16x16x32_bf16 v[20:23],a[164:167],v[176:179],v[20:23]
v_exp_f32 v148,v148
v_mfma_f32_16x16x32_bf16 v[24:27],a[168:171],v[176:179],v[24:27]
ds_read_b64_tr_b16 a[80:81],v225 offset:512
ds_read_b64_tr_b16 a[82:83],v225 offset:1536
v_mfma_f32_16x16x32_bf16 v[28:31],a[172:175],v[176:179],v[28:31]
s_waitcnt lgkmcnt(4)
v_exp_f32 v149,v149
v_mfma_f32_16x16x32_bf16 v[128:131],a[112:115],a[192:195],v[188:191]
v_exp_f32 v150,v150
v_mfma_f32_16x16x32_bf16 v[128:131],a[116:119],a[196:199],v[128:131]
v_exp_f32 v151,v151
v_mfma_f32_16x16x32_bf16 v[128:131],a[120:123],a[200:203],v[128:131]
ds_read_b64_tr_b16 a[84:85],v226 offset:512
ds_read_b64_tr_b16 a[86:87],v226 offset:1536
v_mfma_f32_16x16x32_bf16 v[128:131],a[124:127],a[204:207],v[128:131]
P315:
s_cbranch_execz L_back
Z19:
s_cbranch_execz ZB1
v_mfma_f32_16x16x32_bf16 v[132:135],a[128:131],a[204:207],v[188:191]
buffer_store_dwordx4 v[208:211],v228,s[24:27],s75 offen offset:2048 nt
v_mfma_f32_16x16x32_bf16 v[132:135],a[132:135],a[200:203],v[132:135]
ds_read_b64_tr_b16 a[88:89],v225 offset:768
v_cvt_pk_bf16_f32 v182,v148,v149
v_mfma_f32_16x16x32_bf16 v[132:135],a[136:139],a[196:199],v[132:135]
ds_read_b64_tr_b16 a[90:91],v225 offset:1792
v_cvt_pk_bf16_f32 v183,v150,v151
v_mfma_f32_16x16x32_bf16 v[132:135],a[140:143],a[192:195],v[132:135]
v_exp_f32 v128,v128
v_mfma_f32_16x16x32_bf16 v[136:139],a[32:35],a[192:195],v[188:191]
ds_read_b64_tr_b16 a[92:93],v226 offset:768
ds_read_b64_tr_b16 a[94:95],v226 offset:1792
v_mfma_f32_16x16x32_bf16 v[136:139],a[36:39],a[196:199],v[136:139]
ds_read_b128 v[248:251],v229 offset:34816
v_xor_b32 v225,0x800,v225
v_mfma_f32_16x16x32_bf16 v[136:139],a[40:43],a[200:203],v[136:139]
ds_read_b128 v[252:255],v230 offset:35840
v_xor_b32 v226,0x800,v226
v_mfma_f32_16x16x32_bf16 v[136:139],a[44:47],a[204:207],v[136:139]
v_exp_f32 v129,v129
v_mfma_f32_16x16x32_bf16 v[140:143],a[48:51],a[204:207],v[188:191]
v_exp_f32 v130,v130
v_mfma_f32_16x16x32_bf16 v[140:143],a[52:55],a[200:203],v[140:143]
buffer_store_dwordx4 v[212:215],v228,s[24:27],s75 offen offset:3072 nt
v_mfma_f32_16x16x32_bf16 v[140:143],a[56:59],a[196:199],v[140:143]
v_exp_f32 v131,v131
v_mfma_f32_16x16x32_bf16 v[140:143],a[60:63],a[192:195],v[140:143]
v_cvt_pk_bf16_f32 v168,v128,v129
v_cvt_pk_bf16_f32 v169,v130,v131
v_mfma_f32_16x16x32_bf16 v[144:147],a[112:115],a[96:99],v[204:207]
v_exp_f32 v132,v132
v_mfma_f32_16x16x32_bf16 v[144:147],a[116:119],a[100:103],v[144:147]
P316:
s_cbranch_execz L_back
v_mfma_f32_16x16x32_bf16 v[144:147],a[120:123],a[104:107],v[144:147]
v_exp_f32 v133,v133
v_mfma_f32_16x16x32_bf16 v[144:147],a[124:127],a[108:111],v[144:147]
v_exp_f32 v134,v134
v_mfma_f32_16x16x32_bf16 v[148:151],a[128:131],a[108:111],v[204:207]
v_exp_f32 v135,v135
v_mfma_f32_16x16x32_bf16 v[148:151],a[132:135],a[104:107],v[148:151]
v_cvt_pk_bf16_f32 v170,v132,v133
v_cvt_pk_bf16_f32 v171,v134,v135
v_mfma_f32_16x16x32_bf16 v[148:151],a[136:139],a[100:103],v[148:151]
v_exp_f32 v136,v136
v_mfma_f32_16x16x32_bf16 v[148:151],a[140:143],a[96:99],v[148:151]
buffer_store_dwordx4 v[240:243],v228,s[24:27],s73 offen nt
v_mfma_f32_16x16x32_bf16 v[216:219],a[188:191],v[180:183],v[216:219]
v_exp_f32 v137,v137
v_mfma_f32_16x16x32_bf16 v[32:35],a[144:147],v[180:183],v[32:35]
ds_read_b64_tr_b16 a[144:145],v225
ds_read_b64_tr_b16 a[146:147],v225 offset:1024
v_mfma_f32_16x16x32_bf16 v[36:39],a[148:151],v[180:183],v[36:39]
ds_read_b64_tr_b16 a[148:149],v226
ds_read_b64_tr_b16 a[150:151],v226 offset:1024
v_mfma_f32_16x16x32_bf16 v[40:43],a[152:155],v[180:183],v[40:43]
ds_read_b64_tr_b16 a[152:153],v225 offset:256
ds_read_b64_tr_b16 a[154:155],v225 offset:1280
v_mfma_f32_16x16x32_bf16 v[44:47],a[156:159],v[180:183],v[44:47]
ds_read_b64_tr_b16 a[156:157],v226 offset:256
ds_read_b64_tr_b16 a[158:159],v226 offset:1280
v_mfma_f32_16x16x32_bf16 v[48:51],a[160:163],v[180:183],v[48:51]
v_exp_f32 v138,v138
v_mfma_f32_16x16x32_bf16 v[52:55],a[164:167],v[180:183],v[52:55]
ds_read_b64_tr_b16 a[160:161],v225 offset:512
ds_read_b64_tr_b16 a[162:163],v225 offset:1536
v_mfma_f32_16x16x32_bf16 v[56:59],a[168:171],v[180:183],v[56:59]
v_exp_f32 v139,v139
v_mfma_f32_16x16x32_bf16 v[60:63],a[172:175],v[180:183],v[60:63]
ds_read_b64_tr_b16 a[164:165],v226 offset:512
ds_read_b64_tr_b16 a[166:167],v226 offset:1536
v_mfma_f32_16x16x32_bf16 v[128:131],a[112:115],a[208:211],v[192:195]
P317:
s_cbranch_execz L_back
v_mfma_f32_16x16x32_bf16 v[128:131],a[116:119],a[212:215],v[128:131]
buffer_store_dwordx4 v[244:247],v228,s[24:27],s73 offen offset:1024 nt
v_mfma_f32_16x16x32_bf16 v[128:131],a[120:123],a[216:219],v[128:131]
ds_read_b64_tr_b16 a[168:169],v225 offset:768
ds_read_b64_tr_b16 a[170:171],v225 offset:1792
v_mfma_f32_16x16x32_bf16 v[128:131],a[124:127],a[220:223],v[128:131]
v_cvt_pk_bf16_f32 v172,v136,v137
v_cvt_pk_bf16_f32 v173,v138,v139
v_mfma_f32_16x16x32_bf16 v[132:135],a[128:131],a[220:223],v[192:195]
ds_read_b64_tr_b16 a[172:173],v226 offset:768
ds_read_b64_tr_b16 a[174:175],v226 offset:1792
v_mfma_f32_16x16x32_bf16 v[132:135],a[132:135],a[216:219],v[132:135]
v_exp_f32 v140,v140
v_mfma_f32_16x16x32_bf16 v[132:135],a[136:139],a[212:215],v[132:135]
v_exp_f32 v141,v141
v_mfma_f32_16x16x32_bf16 v[132:135],a[140:143],a[208:211],v[132:135]
v_exp_f32 v142,v142
v_mfma_f32_16x16x32_bf16 v[216:219],a[176:179],v[168:171],v[216:219]
s_waitcnt lgkmcnt(2)
v_exp_f32 v143,v143
v_mfma_f32_16x16x32_bf16 v[64:67],a[144:147],v[168:171],v[64:67]
v_cvt_pk_bf16_f32 v174,v140,v141
v_cvt_pk_bf16_f32 v175,v142,v143
v_mfma_f32_16x16x32_bf16 v[68:71],a[148:151],v[168:171],v[68:71]
v_exp_f32 v144,v144
v_mfma_f32_16x16x32_bf16 v[72:75],a[152:155],v[168:171],v[72:75]
buffer_store_dwordx4 v[248:251],v228,s[24:27],s73 offen offset:2048 nt
v_mfma_f32_16x16x32_bf16 v[76:79],a[156:159],v[168:171],v[76:79]
v_exp_f32 v145,v145
v_mfma_f32_16x16x32_bf16 v[80:83],a[160:163],v[168:171],v[80:83]
v_exp_f32 v146,v146
v_mfma_f32_16x16x32_bf16 v[84:87],a[164:167],v[168:171],v[84:87]
P318:
s_cbranch_execz L_back
v_mfma_f32_16x16x32_bf16 v[88:91],a[168:171],v[168:171],v[88:91]
s_waitcnt lgkmcnt(0)
v_exp_f32 v147,v147
v_mfma_f32_16x16x32_bf16 v[92:95],a[172:175],v[168:171],v[92:95]
v_cvt_pk_bf16_f32 v176,v144,v145
v_cvt_pk_bf16_f32 v177,v146,v147
v_mfma_f32_16x16x32_bf16 v[136:139],a[32:35],a[208:211],v[192:195]
v_exp_f32 v148,v148
v_mfma_f32_16x16x32_bf16 v[136:139],a[36:39],a[212:215],v[136:139]
v_exp_f32 v149,v149
v_mfma_f32_16x16x32_bf16 v[136:139],a[40:43],a[216:219],v[136:139]
v_exp_f32 v150,v150
v_mfma_f32_16x16x32_bf16 v[136:139],a[44:47],a[220:223],v[136:139]
v_exp_f32 v151,v151
v_mfma_f32_16x16x32_bf16 v[140:143],a[48:51],a[220:223],v[192:195]
buffer_store_dwordx4 v[252:255],v228,s[24:27],s73 offen offset:3072 nt
v_mfma_f32_16x16x32_bf16 v[140:143],a[52:55],a[216:219],v[140:143]
v_cvt_pk_bf16_f32 v178,v148,v149
v_cvt_pk_bf16_f32 v179,v150,v151
v_mfma_f32_16x16x32_bf16 v[140:143],a[56:59],a[212:215],v[140:143]
v_exp_f32 v128,v128
v_mfma_f32_16x16x32_bf16 v[140:143],a[60:63],a[208:211],v[140:143]
v_exp_f32 v129,v129
v_mfma_f32_16x16x32_bf16 v[216:219],a[176:179],v[172:175],v[216:219]
v_exp_f32 v130,v130
v_mfma_f32_16x16x32_bf16 v[64:67],a[64:67],v[172:175],v[64:67]
v_exp_f32 v131,v131
v_mfma_f32_16x16x32_bf16 v[68:71],a[68:71],v[172:175],v[68:71]
v_cvt_pk_bf16_f32 v180,v128,v129
v_cvt_pk_bf16_f32 v181,v130,v131
v_mfma_f32_16x16x32_bf16 v[72:75],a[72:75],v[172:175],v[72:75]
v_exp_f32 v132,v132
v_rcp_f32 v160,v216
v_mfma_f32_16x16x32_bf16 v[76:79],a[76:79],v[172:175],v[76:79]
v_exp_f32 v133,v133
v_pk_mul_f32 v[64:65],v[64:65],v[160:161] op_sel:[0,0] op_sel_hi:[1,0]
v_pk_mul_f32 v[66:67],v[66:67],v[160:161] op_sel:[0,0] op_sel_hi:[1,0]
v_mfma_f32_16x16x32_bf16 v[80:83],a[80:83],v[172:175],v[80:83]
P319:
s_cbranch_execz L_back
v_exp_f32 v134,v134
v_pk_mul_f32 v[68:69],v[68:69],v[160:161] op_sel:[0,0] op_sel_hi:[1,0]
v_pk_mul_f32 v[70:71],v[70:71],v[160:161] op_sel:[0,0] op_sel_hi:[1,0]
v_mfma_f32_16x16x32_bf16 v[84:87],a[84:87],v[172:175],v[84:87]
v_exp_f32 v135,v135
v_cvt_pk_bf16_f32 v64,v64,v65
v_cvt_pk_bf16_f32 v65,v66,v67
v_cvt_pk_bf16_f32 v66,v68,v69
v_cvt_pk_bf16_f32 v67,v70,v71
v_mfma_f32_16x16x32_bf16 v[88:91],a[88:91],v[172:175],v[88:91]
v_cvt_pk_bf16_f32 v182,v132,v133
v_cvt_pk_bf16_f32 v183,v134,v135
v_pk_mul_f32 v[72:73],v[72:73],v[160:161] op_sel:[0,0] op_sel_hi:[1,0]
v_pk_mul_f32 v[74:75],v[74:75],v[160:161] op_sel:[0,0] op_sel_hi:[1,0]
v_pk_mul_f32 v[76:77],v[76:77],v[160:161] op_sel:[0,0] op_sel_hi:[1,0]
v_pk_mul_f32 v[78:79],v[78:79],v[160:161] op_sel:[0,0] op_sel_hi:[1,0]
v_mfma_f32_16x16x32_bf16 v[92:95],a[92:95],v[172:175],v[92:95]
ds_write_b64 v231,v[64:65]
ds_write_b64 v231,v[66:67] offset:32
v_exp_f32 v136,v136
v_cvt_pk_bf16_f32 v72,v72,v73
v_cvt_pk_bf16_f32 v73,v74,v75
v_mfma_f32_16x16x32_bf16 v[144:147],a[112:115],a[224:227],v[196:199]
v_exp_f32 v137,v137
v_cvt_pk_bf16_f32 v74,v76,v77
v_cvt_pk_bf16_f32 v75,v78,v79
v_pk_mul_f32 v[80:81],v[80:81],v[160:161] op_sel:[0,0] op_sel_hi:[1,0]
v_pk_mul_f32 v[82:83],v[82:83],v[160:161] op_sel:[0,0] op_sel_hi:[1,0]
v_mfma_f32_16x16x32_bf16 v[144:147],a[116:119],a[228:231],v[144:147]
v_exp_f32 v138,v138
v_pk_mul_f32 v[84:85],v[84:85],v[160:161] op_sel:[0,0] op_sel_hi:[1,0]
v_pk_mul_f32 v[86:87],v[86:87],v[160:161] op_sel:[0,0] op_sel_hi:[1,0]
v_mfma_f32_16x16x32_bf16 v[144:147],a[120:123],a[232:235],v[144:147]
ds_write_b64 v231,v[72:73] offset:64
ds_write_b64 v231,v[74:75] offset:96
v_exp_f32 v139,v139
v_cvt_pk_bf16_f32 v80,v80,v81
v_cvt_pk_bf16_f32 v81,v82,v83
v_mfma_f32_16x16x32_bf16 v[144:147],a[124:127],a[236:239],v[144:147]
P320:
s_cbranch_execz L_back
v_cvt_pk_bf16_f32 v184,v136,v137
v_cvt_pk_bf16_f32 v185,v138,v139
v_cvt_pk_bf16_f32 v82,v84,v85
v_cvt_pk_bf16_f32 v83,v86,v87
v_mfma_f32_16x16x32_bf16 v[148:151],a[128:131],a[236:239],v[196:199]
v_exp_f32 v140,v140
v_pk_mul_f32 v[88:89],v[88:89],v[160:161] op_sel:[0,0] op_sel_hi:[1,0]
v_pk_mul_f32 v[90:91],v[90:91],v[160:161] op_sel:[0,0] op_sel_hi:[1,0]
v_pk_mul_f32 v[92:93],v[92:93],v[160:161] op_sel:[0,0] op_sel_hi:[1,0]
v_pk_mul_f32 v[94:95],v[94:95],v[160:161] op_sel:[0,0] op_sel_hi:[1,0]
v_mfma_f32_16x16x32_bf16 v[148:151],a[132:135],a[232:235],v[148:151]
ds_write_b64 v231,v[80:81] offset:128
ds_write_b64 v231,v[82:83] offset:160
v_exp_f32 v141,v141
v_cvt_pk_bf16_f32 v88,v88,v89
v_cvt_pk_bf16_f32 v89,v90,v91
v_mfma_f32_16x16x32_bf16 v[148:151],a[136:139],a[228:231],v[148:151]
v_exp_f32 v142,v142
v_cvt_pk_bf16_f32 v90,v92,v93
v_cvt_pk_bf16_f32 v91,v94,v95
v_mfma_f32_16x16x32_bf16 v[148:151],a[140:143],a[224:227],v[148:151]
ds_write_b64 v231,v[88:89] offset:192
ds_write_b64 v231,v[90:91] offset:224
ds_read_b128 a[192:195],v232
ds_read_b128 a[196:199],v232 offset:1088
v_exp_f32 v143,v143
v_mfma_f32_16x16x32_bf16 v[220:223],a[176:179],v[176:179],v[220:223]
ds_read_b128 a[200:203],v232 offset:2176
ds_read_b128 a[204:207],v232 offset:3264
v_cvt_pk_bf16_f32 v186,v140,v141
v_cvt_pk_bf16_f32 v187,v142,v143
v_mfma_f32_16x16x32_bf16 a[0:3],a[144:147],v[176:179],a[0:3]
P321:
s_cbranch_execz L_back
v_exp_f32 v144,v144
v_mfma_f32_16x16x32_bf16 a[4:7],a[148:151],v[176:179],a[4:7]
v_mov_b32 v205,v220
v_exp_f32 v145,v145
v_mfma_f32_16x16x32_bf16 a[8:11],a[152:155],v[176:179],a[8:11]
ds_write_b64 v237,v[204:205]
v_exp_f32 v146,v146
v_mfma_f32_16x16x32_bf16 a[12:15],a[156:159],v[176:179],a[12:15]
ds_write_b128 v235,a[0:3]
v_exp_f32 v147,v147
v_mfma_f32_16x16x32_bf16 a[16:19],a[160:163],v[176:179],a[16:19]
ds_write_b128 v159,a[4:7]
v_cvt_pk_bf16_f32 v168,v144,v145
v_cvt_pk_bf16_f32 v169,v146,v147
v_mfma_f32_16x16x32_bf16 a[20:23],a[164:167],v[176:179],a[20:23]
ds_write_b128 v235,a[8:11] offset:128
ds_write_b128 v159,a[12:15] offset:128
v_exp_f32 v148,v148
v_mfma_f32_16x16x32_bf16 a[24:27],a[168:171],v[176:179],a[24:27]
s_waitcnt lgkmcnt(5)
ds_write_b128 v235,a[16:19] offset:256
buffer_store_dwordx4 a[192:195],v228,s[24:27],s64 offen nt
v_exp_f32 v149,v149
v_mfma_f32_16x16x32_bf16 a[28:31],a[172:175],v[176:179],a[28:31]
ds_write_b128 v159,a[20:23] offset:256
v_exp_f32 v150,v150
v_mfma_f32_16x16x32_bf16 v[128:131],a[32:35],a[224:227],v[196:199]
ds_write_b128 v235,a[24:27] offset:384
v_exp_f32 v151,v151
v_mfma_f32_16x16x32_bf16 v[128:131],a[36:39],a[228:231],v[128:131]
buffer_store_dwordx4 a[196:199],v228,s[24:27],s64 offen offset:1024 nt
v_cvt_pk_bf16_f32 v170,v148,v149
v_cvt_pk_bf16_f32 v171,v150,v151
v_mfma_f32_16x16x32_bf16 v[128:131],a[40:43],a[232:235],v[128:131]
P322:
s_cbranch_execz L_back
ds_write_b128 v159,a[28:31] offset:384
v_mfma_f32_16x16x32_bf16 v[128:131],a[44:47],a[236:239],v[128:131]
v_mfma_f32_16x16x32_bf16 v[132:135],a[48:51],a[236:239],v[196:199]
buffer_store_dwordx4 a[200:203],v228,s[24:27],s64 offen offset:2048 nt
v_mfma_f32_16x16x32_bf16 v[132:135],a[52:55],a[232:235],v[132:135]
v_mfma_f32_16x16x32_bf16 v[132:135],a[56:59],a[228:231],v[132:135]
v_mfma_f32_16x16x32_bf16 v[132:135],a[60:63],a[224:227],v[132:135]
buffer_store_dwordx4 a[204:207],v228,s[24:27],s64 offen offset:3072 nt
v_mfma_f32_16x16x32_bf16 v[216:219],a[180:183],v[180:183],v[216:219]
v_mfma_f32_16x16x32_bf16 v[96:99],a[144:147],v[180:183],v[96:99]
v_exp_f32 v128,v128
v_mfma_f32_16x16x32_bf16 v[100:103],a[148:151],v[180:183],v[100:103]
v_exp_f32 v129,v129
v_mfma_f32_16x16x32_bf16 v[104:107],a[152:155],v[180:183],v[104:107]
v_exp_f32 v130,v130
v_mfma_f32_16x16x32_bf16 v[108:111],a[156:159],v[180:183],v[108:111]
s_waitcnt lgkmcnt(0)
s_barrier
v_exp_f32 v131,v131
v_mfma_f32_16x16x32_bf16 v[112:115],a[160:163],v[180:183],v[112:115]
ds_read_b128 v[208:211],v238
ds_read_b128 v[212:215],v238 offset:64
v_cvt_pk_bf16_f32 v172,v128,v129
v_cvt_pk_bf16_f32 v173,v130,v131
v_xor_b32 v153,16,v236
v_mfma_f32_16x16x32_bf16 v[116:119],a[164:167],v[180:183],v[116:119]
ds_read_b128 v[240:243],v236
ds_read_b128 v[244:247],v153
ds_read_b128 v[248:251],v236 offset:16384
ds_read_b128 v[252:255],v153 offset:16384
v_exp_f32 v132,v132
v_mfma_f32_16x16x32_bf16 v[120:123],a[168:171],v[180:183],v[120:123]
v_exp_f32 v133,v133
v_xor_b32 v152,64,v236
v_xor_b32 v153,64,v153
v_mfma_f32_16x16x32_bf16 v[124:127],a[172:175],v[180:183],v[124:127]
P323:
s_cbranch_execz L_back
v_exp_f32 v134,v134
v_mfma_f32_16x16x32_bf16 v[136:139],a[112:115],a[240:243],v[200:203]
v_exp_f32 v135,v135
v_mfma_f32_16x16x32_bf16 v[136:139],a[116:119],a[244:247],v[136:139]
v_cvt_pk_bf16_f32 v174,v132,v133
v_cvt_pk_bf16_f32 v175,v134,v135
v_mfma_f32_16x16x32_bf16 v[136:139],a[120:123],a[248:251],v[136:139]
v_mfma_f32_16x16x32_bf16 v[136:139],a[124:127],a[252:255],v[136:139]
v_mfma_f32_16x16x32_bf16 v[140:143],a[128:131],a[252:255],v[200:203]
s_waitcnt lgkmcnt(0)
v_min_f32 v154,v208,v212
v_min_f32 v155,v210,v214
v_sub_f32 v208,v154,v208
v_sub_f32 v210,v155,v210
v_sub_f32 v212,v154,v212
v_sub_f32 v214,v155,v214
v_mfma_f32_16x16x32_bf16 v[140:143],a[132:135],a[248:251],v[140:143]
v_exp_f32 v136,v136
v_exp_f32 v208,v208
v_exp_f32 v210,v210
v_mfma_f32_16x16x32_bf16 v[140:143],a[136:139],a[244:247],v[140:143]
v_exp_f32 v137,v137
v_exp_f32 v212,v212
v_exp_f32 v214,v214
v_mfma_f32_16x16x32_bf16 v[140:143],a[140:143],a[240:243],v[140:143]
v_exp_f32 v138,v138
v_mul_f32 v154,v208,v209
v_mul_f32 v155,v210,v211
v_fmac_f32 v154,v212,v213
v_fmac_f32 v155,v214,v215
v_mfma_f32_16x16x32_bf16 v[216:219],a[180:183],v[184:187],v[216:219]
v_exp_f32 v139,v139
v_rcp_f32 v154,v154
v_rcp_f32 v155,v155
v_mfma_f32_16x16x32_bf16 v[96:99],a[64:67],v[184:187],v[96:99]
v_cvt_pk_bf16_f32 v176,v136,v137
v_cvt_pk_bf16_f32 v177,v138,v139
v_mul_f32 v208,v208,v154
v_mul_f32 v210,v210,v155
v_mul_f32 v212,v212,v154
v_mul_f32 v214,v214,v155
v_mfma_f32_16x16x32_bf16 v[100:103],a[68:71],v[184:187],v[100:103]
v_exp_f32 v140,v140
v_rcp_f32 v161,v217
v_mul_f32 v240,v240,v208
v_mul_f32 v241,v241,v208
v_mfma_f32_16x16x32_bf16 v[104:107],a[72:75],v[184:187],v[104:107]
P324:
s_cbranch_execz L_back
v_exp_f32 v141,v141
v_mul_f32 v242,v242,v208
v_mul_f32 v243,v243,v208
v_mfma_f32_16x16x32_bf16 v[108:111],a[76:79],v[184:187],v[108:111]
v_exp_f32 v142,v142
v_pk_mul_f32 v[96:97],v[96:97],v[160:161] op_sel:[0,1] op_sel_hi:[1,1]
v_pk_mul_f32 v[98:99],v[98:99],v[160:161] op_sel:[0,1] op_sel_hi:[1,1]
v_mul_f32 v244,v244,v208
v_mul_f32 v245,v245,v208
v_mfma_f32_16x16x32_bf16 v[112:115],a[80:83],v[184:187],v[112:115]
v_exp_f32 v143,v143
v_pk_mul_f32 v[100:101],v[100:101],v[160:161] op_sel:[0,1] op_sel_hi:[1,1]
v_pk_mul_f32 v[102:103],v[102:103],v[160:161] op_sel:[0,1] op_sel_hi:[1,1]
v_cvt_pk_bf16_f32 v96,v96,v97
v_cvt_pk_bf16_f32 v97,v98,v99
v_mfma_f32_16x16x32_bf16 v[116:119],a[84:87],v[184:187],v[116:119]
v_cvt_pk_bf16_f32 v178,v140,v141
v_cvt_pk_bf16_f32 v179,v142,v143
v_cvt_pk_bf16_f32 v98,v100,v101
v_cvt_pk_bf16_f32 v99,v102,v103
v_pk_mul_f32 v[104:105],v[104:105],v[160:161] op_sel:[0,1] op_sel_hi:[1,1]
v_pk_mul_f32 v[106:107],v[106:107],v[160:161] op_sel:[0,1] op_sel_hi:[1,1]
v_mfma_f32_16x16x32_bf16 v[120:123],a[88:91],v[184:187],v[120:123]
v_pk_mul_f32 v[108:109],v[108:109],v[160:161] op_sel:[0,1] op_sel_hi:[1,1]
v_pk_mul_f32 v[110:111],v[110:111],v[160:161] op_sel:[0,1] op_sel_hi:[1,1]
v_mul_f32 v246,v246,v208
v_mul_f32 v247,v247,v208
v_fmac_f32 v240,v248,v212
v_fmac_f32 v241,v249,v212
v_mfma_f32_16x16x32_bf16 v[124:127],a[92:95],v[184:187],v[124:127]
ds_write_b64 v231,v[96:97] offset:4352
ds_write_b64 v231,v[98:99] offset:4384
v_cvt_pk_bf16_f32 v104,v104,v105
v_cvt_pk_bf16_f32 v105,v106,v107
v_cvt_pk_bf16_f32 v106,v108,v109
v_cvt_pk_bf16_f32 v107,v110,v111
v_mfma_f32_16x16x32_bf16 v[144:147],a[32:35],a[240:243],v[200:203]
P325:
s_cbranch_execz L_back
v_pk_mul_f32 v[112:113],v[112:113],v[160:161] op_sel:[0,1] op_sel_hi:[1,1]
v_pk_mul_f32 v[114:115],v[114:115],v[160:161] op_sel:[0,1] op_sel_hi:[1,1]
v_pk_mul_f32 v[116:117],v[116:117],v[160:161] op_sel:[0,1] op_sel_hi:[1,1]
v_pk_mul_f32 v[118:119],v[118:119],v[160:161] op_sel:[0,1] op_sel_hi:[1,1]
v_mfma_f32_16x16x32_bf16 v[144:147],a[36:39],a[244:247],v[144:147]
ds_write_b64 v231,v[104:105] offset:4416
ds_write_b64 v231,v[106:107] offset:4448
v_cvt_pk_bf16_f32 v112,v112,v113
v_cvt_pk_bf16_f32 v113,v114,v115
v_cvt_pk_bf16_f32 v114,v116,v117
v_cvt_pk_bf16_f32 v115,v118,v119
v_mfma_f32_16x16x32_bf16 v[144:147],a[40:43],a[248:251],v[144:147]
v_pk_mul_f32 v[120:121],v[120:121],v[160:161] op_sel:[0,1] op_sel_hi:[1,1]
v_pk_mul_f32 v[122:123],v[122:123],v[160:161] op_sel:[0,1] op_sel_hi:[1,1]
v_pk_mul_f32 v[124:125],v[124:125],v[160:161] op_sel:[0,1] op_sel_hi:[1,1]
v_pk_mul_f32 v[126:127],v[126:127],v[160:161] op_sel:[0,1] op_sel_hi:[1,1]
v_fmac_f32 v242,v250,v212
v_fmac_f32 v243,v251,v212
v_mfma_f32_16x16x32_bf16 v[144:147],a[44:47],a[252:255],v[144:147]
ds_write_b64 v231,v[112:113] offset:4480
ds_write_b64 v231,v[114:115] offset:4512
v_cvt_pk_bf16_f32 v120,v120,v121
v_cvt_pk_bf16_f32 v121,v122,v123
v_cvt_pk_bf16_f32 v122,v124,v125
v_cvt_pk_bf16_f32 v123,v126,v127
v_mfma_f32_16x16x32_bf16 v[148:151],a[48:51],a[252:255],v[200:203]
ds_write_b64 v231,v[120:121] offset:4544
ds_write_b64 v231,v[122:123] offset:4576
ds_read_b128 a[208:211],v232 offset:4352
ds_read_b128 a[212:215],v232 offset:5440
v_exp_f32 v144,v144
v_mfma_f32_16x16x32_bf16 v[148:151],a[52:55],a[248:251],v[148:151]
ds_read_b128 a[216:219],v232 offset:6528
ds_read_b128 a[220:223],v232 offset:7616
v_exp_f32 v145,v145
v_fmac_f32 v244,v252,v212
v_fmac_f32 v245,v253,v212
v_mfma_f32_16x16x32_bf16 v[148:151],a[56:59],a[244:247],v[148:151]
P326:
s_cbranch_execz L_back
v_exp_f32 v146,v146
v_fmac_f32 v246,v254,v212
v_fmac_f32 v247,v255,v212
v_mfma_f32_16x16x32_bf16 v[148:151],a[60:63],a[240:243],v[148:151]
ds_read_b128 v[248:251],v152 offset:18432
ds_read_b128 v[252:255],v153 offset:18432
v_exp_f32 v147,v147
v_cvt_pk_bf16_f32 v240,v240,v241
v_cvt_pk_bf16_f32 v241,v242,v243
v_mfma_f32_16x16x32_bf16 v[216:219],a[184:187],v[168:171],v[216:219]
v_cvt_pk_bf16_f32 v180,v144,v145
v_cvt_pk_bf16_f32 v181,v146,v147
v_cvt_pk_bf16_f32 v242,v244,v245
v_cvt_pk_bf16_f32 v243,v246,v247
v_mfma_f32_16x16x32_bf16 v[0:3],a[144:147],v[168:171],v[0:3]
buffer_store_dwordx4 v[240:243],v228,s[24:27],s76 offen nt
ds_read_b128 v[244:247],v153 offset:2048
v_exp_f32 v148,v148
v_mfma_f32_16x16x32_bf16 v[4:7],a[148:151],v[168:171],v[4:7]
ds_read_b128 v[240:243],v152 offset:2048
v_exp_f32 v149,v149
v_mfma_f32_16x16x32_bf16 v[8:11],a[152:155],v[168:171],v[8:11]
v_exp_f32 v150,v150
v_mfma_f32_16x16x32_bf16 v[12:15],a[156:159],v[168:171],v[12:15]
s_waitcnt lgkmcnt(4)
buffer_store_dwordx4 a[208:211],v228,s[24:27],s65 offen nt
v_exp_f32 v151,v151
v_mfma_f32_16x16x32_bf16 v[16:19],a[160:163],v[168:171],v[16:19]
v_cvt_pk_bf16_f32 v182,v148,v149
v_cvt_pk_bf16_f32 v183,v150,v151
v_mfma_f32_16x16x32_bf16 v[20:23],a[164:167],v[168:171],v[20:23]
v_mfma_f32_16x16x32_bf16 v[24:27],a[168:171],v[168:171],v[24:27]
s_waitcnt lgkmcnt(1)
P327:
s_cbranch_execz L_back
buffer_store_dwordx4 a[212:215],v228,s[24:27],s65 offen offset:1024 nt
v_mul_f32 v248,v248,v214
v_mul_f32 v249,v249,v214
v_mfma_f32_16x16x32_bf16 v[28:31],a[172:175],v[168:171],v[28:31]
v_mul_f32 v250,v250,v214
v_mul_f32 v251,v251,v214
v_mul_f32 v252,v252,v214
v_mul_f32 v253,v253,v214
v_mul_f32 v254,v254,v214
v_mul_f32 v255,v255,v214
v_mfma_f32_16x16x32_bf16 v[216:219],a[184:187],v[172:175],v[216:219]
v_fmac_f32 v252,v244,v210
v_fmac_f32 v253,v245,v210
v_fmac_f32 v254,v246,v210
v_fmac_f32 v255,v247,v210
v_mfma_f32_16x16x32_bf16 v[0:3],a[64:67],v[172:175],v[0:3]
s_waitcnt lgkmcnt(0)
buffer_store_dwordx4 a[216:219],v228,s[24:27],s65 offen offset:2048 nt
v_fmac_f32 v248,v240,v210
v_fmac_f32 v249,v241,v210
v_fmac_f32 v250,v242,v210
v_fmac_f32 v251,v243,v210
v_mfma_f32_16x16x32_bf16 v[4:7],a[68:71],v[172:175],v[4:7]
v_rcp_f32 v162,v218
v_cvt_pk_bf16_f32 v240,v248,v249
v_cvt_pk_bf16_f32 v241,v250,v251
v_cvt_pk_bf16_f32 v242,v252,v253
v_cvt_pk_bf16_f32 v243,v254,v255
v_mfma_f32_16x16x32_bf16 v[8:11],a[72:75],v[172:175],v[8:11]
buffer_store_dwordx4 v[240:243],v228,s[24:27],s76 offen offset:1024 nt
v_mfma_f32_16x16x32_bf16 v[12:15],a[76:79],v[172:175],v[12:15]
buffer_store_dwordx4 a[220:223],v228,s[24:27],s65 offen offset:3072 nt
v_pk_mul_f32 v[0:1],v[0:1],v[162:163] op_sel:[0,0] op_sel_hi:[1,0]
v_pk_mul_f32 v[2:3],v[2:3],v[162:163] op_sel:[0,0] op_sel_hi:[1,0]
v_mfma_f32_16x16x32_bf16 v[16:19],a[80:83],v[172:175],v[16:19]
v_pk_mul_f32 v[4:5],v[4:5],v[162:163] op_sel:[0,0] op_sel_hi:[1,0]
v_pk_mul_f32 v[6:7],v[6:7],v[162:163] op_sel:[0,0] op_sel_hi:[1,0]
v_cvt_pk_bf16_f32 v0,v0,v1
v_cvt_pk_bf16_f32 v1,v2,v3
v_cvt_pk_bf16_f32 v2,v4,v5
v_cvt_pk_bf16_f32 v3,v6,v7
v_mfma_f32_16x16x32_bf16 v[20:23],a[84:87],v[172:175],v[20:23]
P328:
s_cbranch_execz L_back
v_pk_mul_f32 v[8:9],v[8:9],v[162:163] op_sel:[0,0] op_sel_hi:[1,0]
v_pk_mul_f32 v[10:11],v[10:11],v[162:163] op_sel:[0,0] op_sel_hi:[1,0]
v_mfma_f32_16x16x32_bf16 v[24:27],a[88:91],v[172:175],v[24:27]
v_pk_mul_f32 v[12:13],v[12:13],v[162:163] op_sel:[0,0] op_sel_hi:[1,0]
v_pk_mul_f32 v[14:15],v[14:15],v[162:163] op_sel:[0,0] op_sel_hi:[1,0]
v_mfma_f32_16x16x32_bf16 v[28:31],a[92:95],v[172:175],v[28:31]
ds_write_b64 v231,v[0:1]
ds_write_b64 v231,v[2:3] offset:32
v_cvt_pk_bf16_f32 v8,v8,v9
v_cvt_pk_bf16_f32 v9,v10,v11
v_cvt_pk_bf16_f32 v10,v12,v13
v_cvt_pk_bf16_f32 v11,v14,v15
v_mfma_f32_16x16x32_bf16 v[216:219],a[188:191],v[176:179],v[216:219]
v_pk_mul_f32 v[16:17],v[16:17],v[162:163] op_sel:[0,0] op_sel_hi:[1,0]
v_pk_mul_f32 v[18:19],v[18:19],v[162:163] op_sel:[0,0] op_sel_hi:[1,0]
v_pk_mul_f32 v[20:21],v[20:21],v[162:163] op_sel:[0,0] op_sel_hi:[1,0]
v_pk_mul_f32 v[22:23],v[22:23],v[162:163] op_sel:[0,0] op_sel_hi:[1,0]
v_mfma_f32_16x16x32_bf16 v[32:35],a[144:147],v[176:179],v[32:35]
ds_write_b64 v231,v[8:9] offset:64
ds_write_b64 v231,v[10:11] offset:96
v_cvt_pk_bf16_f32 v16,v16,v17
v_cvt_pk_bf16_f32 v17,v18,v19
v_cvt_pk_bf16_f32 v18,v20,v21
v_cvt_pk_bf16_f32 v19,v22,v23
v_mfma_f32_16x16x32_bf16 v[36:39],a[148:151],v[176:179],v[36:39]
v_pk_mul_f32 v[24:25],v[24:25],v[162:163] op_sel:[0,0] op_sel_hi:[1,0]
v_pk_mul_f32 v[26:27],v[26:27],v[162:163] op_sel:[0,0] op_sel_hi:[1,0]
v_pk_mul_f32 v[28:29],v[28:29],v[162:163] op_sel:[0,0] op_sel_hi:[1,0]
v_pk_mul_f32 v[30:31],v[30:31],v[162:163] op_sel:[0,0] op_sel_hi:[1,0]
v_mfma_f32_16x16x32_bf16 v[40:43],a[152:155],v[176:179],v[40:43]
P329:
s_cbranch_execz L_back
ds_write_b64 v231,v[16:17] offset:128
ds_write_b64 v231,v[18:19] offset:160
v_cvt_pk_bf16_f32 v24,v24,v25
v_cvt_pk_bf16_f32 v25,v26,v27
v_mfma_f32_16x16x32_bf16 v[44:47],a[156:159],v[176:179],v[44:47]
v_cvt_pk_bf16_f32 v26,v28,v29
v_cvt_pk_bf16_f32 v27,v30,v31
v_mfma_f32_16x16x32_bf16 v[48:51],a[160:163],v[176:179],v[48:51]
ds_write_b64 v231,v[24:25] offset:192
ds_write_b64 v231,v[26:27] offset:224
ds_read_b128 a[224:227],v232
ds_read_b128 a[228:231],v232 offset:1088
ds_read_b128 a[232:235],v232 offset:2176
ds_read_b128 a[236:239],v232 offset:3264
v_mfma_f32_16x16x32_bf16 v[52:55],a[164:167],v[176:179],v[52:55]
v_mfma_f32_16x16x32_bf16 v[56:59],a[168:171],v[176:179],v[56:59]
v_mfma_f32_16x16x32_bf16 v[60:63],a[172:175],v[176:179],v[60:63]
v_mfma_f32_16x16x32_bf16 v[216:219],a[188:191],v[180:183],v[216:219]
v_mfma_f32_16x16x32_bf16 v[32:35],a[64:67],v[180:183],v[32:35]
v_mfma_f32_16x16x32_bf16 v[36:39],a[68:71],v[180:183],v[36:39]
v_mfma_f32_16x16x32_bf16 v[40:43],a[72:75],v[180:183],v[40:43]
v_mfma_f32_16x16x32_bf16 v[44:47],a[76:79],v[180:183],v[44:47]
s_waitcnt lgkmcnt(0)
buffer_store_dwordx4 a[224:227],v228,s[24:27],s66 offen nt
v_mfma_f32_16x16x32_bf16 v[48:51],a[80:83],v[180:183],v[48:51]
v_mfma_f32_16x16x32_bf16 v[52:55],a[84:87],v[180:183],v[52:55]
v_rcp_f32 v163,v219
v_mfma_f32_16x16x32_bf16 v[56:59],a[88:91],v[180:183],v[56:59]
buffer_store_dwordx4 a[228:231],v228,s[24:27],s66 offen offset:1024 nt
v_pk_mul_f32 v[32:33],v[32:33],v[162:163] op_sel:[0,1] op_sel_hi:[1,1]
v_pk_mul_f32 v[34:35],v[34:35],v[162:163] op_sel:[0,1] op_sel_hi:[1,1]
v_pk_mul_f32 v[36:37],v[36:37],v[162:163] op_sel:[0,1] op_sel_hi:[1,1]
v_pk_mul_f32 v[38:39],v[38:39],v[162:163] op_sel:[0,1] op_sel_hi:[1,1]
v_mfma_f32_16x16x32_bf16 v[60:63],a[92:95],v[180:183],v[60:63]
P330:
s_cbranch_execz L_back
v_cvt_pk_bf16_f32 v32,v32,v33
v_cvt_pk_bf16_f32 v33,v34,v35
v_cvt_pk_bf16_f32 v34,v36,v37
v_cvt_pk_bf16_f32 v35,v38,v39
buffer_store_dwordx4 a[232:235],v228,s[24:27],s66 offen offset:2048 nt
buffer_store_dwordx4 a[236:239],v228,s[24:27],s66 offen offset:3072 nt
v_pk_mul_f32 v[40:41],v[40:41],v[162:163] op_sel:[0,1] op_sel_hi:[1,1]
v_pk_mul_f32 v[42:43],v[42:43],v[162:163] op_sel:[0,1] op_sel_hi:[1,1]
v_pk_mul_f32 v[44:45],v[44:45],v[162:163] op_sel:[0,1] op_sel_hi:[1,1]
v_pk_mul_f32 v[46:47],v[46:47],v[162:163] op_sel:[0,1] op_sel_hi:[1,1]
ds_write_b64 v231,v[32:33] offset:4352
ds_write_b64 v231,v[34:35] offset:4384
v_cvt_pk_bf16_f32 v40,v40,v41
v_cvt_pk_bf16_f32 v41,v42,v43
v_cvt_pk_bf16_f32 v42,v44,v45
v_cvt_pk_bf16_f32 v43,v46,v47
v_pk_mul_f32 v[48:49],v[48:49],v[162:163] op_sel:[0,1] op_sel_hi:[1,1]
v_pk_mul_f32 v[50:51],v[50:51],v[162:163] op_sel:[0,1] op_sel_hi:[1,1]
v_pk_mul_f32 v[52:53],v[52:53],v[162:163] op_sel:[0,1] op_sel_hi:[1,1]
v_pk_mul_f32 v[54:55],v[54:55],v[162:163] op_sel:[0,1] op_sel_hi:[1,1]
ds_write_b64 v231,v[40:41] offset:4416
ds_write_b64 v231,v[42:43] offset:4448
v_cvt_pk_bf16_f32 v48,v48,v49
v_cvt_pk_bf16_f32 v49,v50,v51
v_cvt_pk_bf16_f32 v50,v52,v53
v_cvt_pk_bf16_f32 v51,v54,v55
v_pk_mul_f32 v[56:57],v[56:57],v[162:163] op_sel:[0,1] op_sel_hi:[1,1]
v_pk_mul_f32 v[58:59],v[58:59],v[162:163] op_sel:[0,1] op_sel_hi:[1,1]
v_pk_mul_f32 v[60:61],v[60:61],v[162:163] op_sel:[0,1] op_sel_hi:[1,1]
v_pk_mul_f32 v[62:63],v[62:63],v[162:163] op_sel:[0,1] op_sel_hi:[1,1]
P331:
s_cbranch_execz L_back
ds_write_b64 v231,v[48:49] offset:4480
ds_write_b64 v231,v[50:51] offset:4512
v_cvt_pk_bf16_f32 v56,v56,v57
v_cvt_pk_bf16_f32 v57,v58,v59
v_cvt_pk_bf16_f32 v58,v60,v61
v_cvt_pk_bf16_f32 v59,v62,v63
ds_write_b64 v231,v[56:57] offset:4544
ds_write_b64 v231,v[58:59] offset:4576
ds_read_b128 a[240:243],v232 offset:4352
ds_read_b128 a[244:247],v232 offset:5440
ds_read_b128 a[248:251],v232 offset:6528
ds_read_b128 a[252:255],v232 offset:7616
v_max3_u32 v239,v239,v216,v217
v_max_u32 v239,v239,v218
v_max3_u32 v239,v239,v219,v220
s_waitcnt lgkmcnt(3)
buffer_store_dwordx4 a[240:243],v228,s[24:27],s67 offen nt
s_waitcnt lgkmcnt(2)
buffer_store_dwordx4 a[244:247],v228,s[24:27],s67 offen offset:1024 nt
s_waitcnt lgkmcnt(1)
buffer_store_dwordx4 a[248:251],v228,s[24:27],s67 offen offset:2048 nt
s_waitcnt lgkmcnt(0)
buffer_store_dwordx4 a[252:255],v228,s[24:27],s67 offen offset:3072 nt
v_lshrrev_b32 v128,2,v228
v_add_u32 v134,0x20000,v128
v_add_u32 v129,s30,v134
ds_write_b32 v129,v239
s_waitcnt lgkmcnt(0)
s_barrier
ds_read2st64_b32 v[130:131],v134 offset0:0 offset1:16
ds_read2st64_b32 v[132:133],v134 offset0:32 offset1:48
s_waitcnt lgkmcnt(0)
v_max3_u32 v130,v130,v131,v132
v_max_u32 v130,v130,v133
v_cmp_le_u32 vcc,0x47800000,v130
s_nop 4
s_cbranch_vccnz L_redo
L_end:
s_endpgm
L_redo:
v_lshrrev_b32 v0,4,v228
s_lshl_b32 s34,s3,6
v_add_u32 v0,s34,v0
s_waitcnt vmcnt(0) lgkmcnt(0)
s_barrier
s_cmp_ge_u32 s2,256
s_cbranch_scc1 S_end
s_load_dwordx4 s[4:7],s[0:1],0
s_load_dwordx4 s[8:11],s[0:1],16
v_lshrrev_b32 v144,6,v0
v_and_b32 v145,63,v0
v_readfirstlane_b32 s3,v144
v_lshlrev_b32 v232,4,v145
s_mul_i32 s28,s2,147456
s_lshl_b32 s29,s2,19
s_lshl_b32 s64,s3,14
s_add_u32 s65,s64,4096
s_add_u32 s66,s64,8192
s_add_u32 s67,s64,12288
s_lshl_b32 s68,s3,11
s_add_u32 s68,s68,65536
v_lshrrev_b32 v147,4,v145
v_lshlrev_b32 v148,6,v147
v_bfe_u32 v149,v145,2,2
v_lshl_add_u32 v148,v149,8,v148
v_lshl_add_u32 v148,v144,13,v148
v_and_b32 v150,1,v144
v_and_b32 v149,3,v145
v_lshlrev_b32 v149,4,v149
v_lshlrev_b32 v231,5,v150
v_xor_b32 v149,v149,v231
v_add_u32 v231,v148,v149
s_lshl_b32 s34,s3,13
s_add_u32 s44,s34,98304
s_add_u32 s45,s34,131072
s_add_u32 s46,s34,0
s_add_u32 s47,s34,32768
s_add_u32 s48,s34,65536
s_waitcnt lgkmcnt(0)
s_add_u32 s12,s4,s28
s_addc_u32 s13,s5,0
s_mov_b32 s14,147456
s_mov_b32 s15,0x20000
buffer_load_dwordx4 v[240:243],v232,s[12:15],s68 offen nt
buffer_load_dwordx4 v[244:247],v232,s[12:15],s68 offen offset:1024 nt
buffer_load_dwordx4 v[0:3],v232,s[12:15],s64 offen nt
buffer_load_dwordx4 v[4:7],v232,s[12:15],s64 offen offset:1024 nt
buffer_load_dwordx4 v[8:11],v232,s[12:15],s64 offen offset:2048 nt
buffer_load_dwordx4 v[12:15],v232,s[12:15],s64 offen offset:3072 nt
buffer_load_dwordx4 v[16:19],v232,s[12:15],s65 offen nt
buffer_load_dwordx4 v[20:23],v232,s[12:15],s65 offen offset:1024 nt
buffer_load_dwordx4 v[24:27],v232,s[12:15],s65 offen offset:2048 nt
buffer_load_dwordx4 v[28:31],v232,s[12:15],s65 offen offset:3072 nt
buffer_load_dwordx4 v[32:35],v232,s[12:15],s66 offen nt
buffer_load_dwordx4 v[36:39],v232,s[12:15],s66 offen offset:1024 nt
buffer_load_dwordx4 v[40:43],v232,s[12:15],s66 offen offset:2048 nt
buffer_load_dwordx4 v[44:47],v232,s[12:15],s66 offen offset:3072 nt
buffer_load_dwordx4 v[48:51],v232,s[12:15],s67 offen nt
buffer_load_dwordx4 v[52:55],v232,s[12:15],s67 offen offset:1024 nt
buffer_load_dwordx4 v[56:59],v232,s[12:15],s67 offen offset:2048 nt
buffer_load_dwordx4 v[60:63],v232,s[12:15],s67 offen offset:3072 nt
s_add_u32 s16,s6,s29
s_addc_u32 s17,s7,0
s_mov_b32 s18,524288
s_mov_b32 s19,0x20000
s_add_u32 s20,s8,s29
s_addc_u32 s21,s9,0
s_mov_b32 s22,524288
s_mov_b32 s23,0x20000
s_add_u32 s24,s10,s28
s_addc_u32 s25,s11,0
s_mov_b32 s26,147456
s_mov_b32 s27,0x20000
s_add_u32 m0,s46,0
s_mov_b32 s35,0
buffer_load_dwordx4 v231,s[16:19],s35 offen nt lds
buffer_load_dwordx4 v231,s[16:19],s35 offen offset:1024 nt lds
buffer_load_dwordx4 v231,s[16:19],s35 offen offset:2048 nt lds
buffer_load_dwordx4 v231,s[16:19],s35 offen offset:3072 nt lds
s_add_u32 m0,s46,4096
s_mov_b32 s35,4096
buffer_load_dwordx4 v231,s[16:19],s35 offen nt lds
buffer_load_dwordx4 v231,s[16:19],s35 offen offset:1024 nt lds
buffer_load_dwordx4 v231,s[16:19],s35 offen offset:2048 nt lds
buffer_load_dwordx4 v231,s[16:19],s35 offen offset:3072 nt lds
v_and_b32 v146,15,v145
v_lshrrev_b32 v149,2,v146
v_lshlrev_b32 v148,13,v149
v_and_b32 v149,1,v149
v_lshlrev_b32 v149,1,v149
v_xor_b32 v149,v149,v147
v_lshl_add_u32 v148,v149,4,v148
v_and_b32 v149,3,v146
v_lshl_add_u32 v148,v149,6,v148
v_lshl_add_u32 v228,v150,11,v148
v_lshlrev_b32 v148,13,v147
v_lshl_add_u32 v148,v149,3,v148
v_lshrrev_b32 v149,2,v146
v_lshl_add_u32 v148,v149,6,v148
v_and_b32 v149,1,v147
v_lshl_add_u32 v148,v149,5,v148
v_xor_b32 v149,3,v150
v_lshl_add_u32 v148,v149,11,v148
v_add_u32 v229,131072,v148
v_xor_b32 v230,32,v229
s_and_b32 s34,s3,1
s_xor_b32 s42,s34,3
s_sub_u32 s42,s34,s42
s_lshl_b32 s42,s42,11
s_mov_b32 s43,0
s_mov_b32 s38,0x47800000
s_mov_b32 s80,0x3e0293ee
s_mov_b32 s81,0x3e0293ee
v_xor_b32 v148,v146,v147
v_lshlrev_b32 v148,4,v148
v_lshl_add_u32 v233,v147,8,v148
v_and_b32 v149,7,v146
v_xor_b32 v148,v149,v147
v_lshlrev_b32 v148,4,v148
v_lshl_add_u32 v234,v146,8,v148
v_and_b32 v148,1,v147
v_lshlrev_b32 v148,1,v148
v_xor_b32 v148,v148,v149
v_lshrrev_b32 v149,1,v147
v_xor_b32 v148,v148,v149
v_lshlrev_b32 v148,4,v148
v_lshl_add_u32 v235,v146,8,v148
v_lshrrev_b32 v149,3,v146
v_mul_u32_u24 v148,6144,v149
v_add_u32 v148,v148,v234
v_lshlrev_b32 v236,13,v150
v_sub_u32 v236,v148,v236
v_lshlrev_b32 v148,6,v149
v_and_b32 v149,3,v146
v_lshl_add_u32 v148,v149,4,v148
v_bfe_u32 v149,v146,2,1
v_lshl_add_u32 v238,v149,3,v148
v_lshlrev_b32 v148,4,v147
v_lshl_add_u32 v239,v150,6,v148
v_lshlrev_b32 v148,1,v146
v_xor_b32 v148,v148,v147
v_lshlrev_b32 v148,4,v148
v_lshl_add_u32 v148,v147,9,v148
v_lshl_add_u32 v237,v150,12,v148
v_and_b32 v149,3,v145
v_mov_b32 v144,0x3f803f80
v_cmp_eq_u32 vcc,0,v149
s_nop 1
v_cndmask_b32 v148,0,v144,vcc
v_accvgpr_write_b32 a176,v148
v_accvgpr_write_b32 a177,v148
v_accvgpr_write_b32 a178,v148
v_accvgpr_write_b32 a179,v148
v_cmp_eq_u32 vcc,1,v149
s_nop 1
v_cndmask_b32 v148,0,v144,vcc
v_accvgpr_write_b32 a180,v148
v_accvgpr_write_b32 a181,v148
v_accvgpr_write_b32 a182,v148
v_accvgpr_write_b32 a183,v148
v_cmp_eq_u32 vcc,2,v149
s_nop 1
v_cndmask_b32 v148,0,v144,vcc
v_accvgpr_write_b32 a184,v148
v_accvgpr_write_b32 a185,v148
v_accvgpr_write_b32 a186,v148
v_accvgpr_write_b32 a187,v148
v_cmp_eq_u32 vcc,3,v149
s_nop 1
v_cndmask_b32 v148,0,v144,vcc
v_accvgpr_write_b32 a188,v148
v_accvgpr_write_b32 a189,v148
v_accvgpr_write_b32 a190,v148
v_accvgpr_write_b32 a191,v148
s_mov_b32 s30,32768
v_add_u32 v130,s45,v233
v_xor_b32 v131,64,v130
v_add_u32 v132,s45,v234
v_xor_b32 v133,64,v132
v_add_u32 v142,s45,v236
v_xor_b32 v143,64,v142
s_waitcnt vmcnt(24)
v_lshlrev_b32 v188,16,v240
v_and_b32 v189,0xffff0000,v240
v_lshlrev_b32 v190,16,v241
v_and_b32 v191,0xffff0000,v241
v_lshlrev_b32 v192,16,v242
v_and_b32 v193,0xffff0000,v242
v_lshlrev_b32 v194,16,v243
v_and_b32 v195,0xffff0000,v243
v_pk_mul_f32 v[188:189],v[188:189],s[80:81]
v_pk_mul_f32 v[190:191],v[190:191],s[80:81]
v_pk_mul_f32 v[192:193],v[192:193],s[80:81]
v_pk_mul_f32 v[194:195],v[194:195],s[80:81]
v_cvt_pk_bf16_f32 v240,v188,v189
v_cvt_pk_bf16_f32 v241,v190,v191
v_cvt_pk_bf16_f32 v242,v192,v193
v_cvt_pk_bf16_f32 v243,v194,v195
ds_write_b128 v130,v[240:243] offset:4096
s_add_u32 m0,s47,0
s_mov_b32 s35,0
buffer_load_dwordx4 v231,s[20:23],s35 offen nt lds
v_lshlrev_b32 v188,16,v244
v_and_b32 v189,0xffff0000,v244
v_lshlrev_b32 v190,16,v245
v_and_b32 v191,0xffff0000,v245
v_lshlrev_b32 v192,16,v246
v_and_b32 v193,0xffff0000,v246
v_lshlrev_b32 v194,16,v247
v_and_b32 v195,0xffff0000,v247
v_pk_mul_f32 v[188:189],v[188:189],s[80:81]
v_pk_mul_f32 v[190:191],v[190:191],s[80:81]
v_pk_mul_f32 v[192:193],v[192:193],s[80:81]
v_pk_mul_f32 v[194:195],v[194:195],s[80:81]
v_cvt_pk_bf16_f32 v244,v188,v189
v_cvt_pk_bf16_f32 v245,v190,v191
v_cvt_pk_bf16_f32 v246,v192,v193
v_cvt_pk_bf16_f32 v247,v194,v195
ds_write_b128 v131,v[244:247] offset:5120
buffer_load_dwordx4 v231,s[20:23],s35 offen offset:1024 nt lds
s_waitcnt vmcnt(24)
v_lshlrev_b32 v188,16,v0
v_and_b32 v189,0xffff0000,v0
v_lshlrev_b32 v190,16,v1
v_and_b32 v191,0xffff0000,v1
v_lshlrev_b32 v192,16,v2
v_and_b32 v193,0xffff0000,v2
v_lshlrev_b32 v194,16,v3
v_and_b32 v195,0xffff0000,v3
v_pk_mul_f32 v[188:189],v[188:189],s[80:81]
v_pk_mul_f32 v[190:191],v[190:191],s[80:81]
v_pk_mul_f32 v[192:193],v[192:193],s[80:81]
v_pk_mul_f32 v[194:195],v[194:195],s[80:81]
v_cvt_pk_bf16_f32 v0,v188,v189
v_cvt_pk_bf16_f32 v1,v190,v191
v_cvt_pk_bf16_f32 v2,v192,v193
v_cvt_pk_bf16_f32 v3,v194,v195
ds_write_b128 v130,v[0:3]
buffer_load_dwordx4 v231,s[20:23],s35 offen offset:2048 nt lds
v_lshlrev_b32 v200,16,v4
v_and_b32 v201,0xffff0000,v4
v_lshlrev_b32 v202,16,v5
v_and_b32 v203,0xffff0000,v5
v_lshlrev_b32 v204,16,v6
v_and_b32 v205,0xffff0000,v6
v_lshlrev_b32 v206,16,v7
v_and_b32 v207,0xffff0000,v7
v_pk_mul_f32 v[200:201],v[200:201],s[80:81]
v_pk_mul_f32 v[202:203],v[202:203],s[80:81]
v_pk_mul_f32 v[204:205],v[204:205],s[80:81]
v_pk_mul_f32 v[206:207],v[206:207],s[80:81]
v_cvt_pk_bf16_f32 v4,v200,v201
v_cvt_pk_bf16_f32 v5,v202,v203
v_cvt_pk_bf16_f32 v6,v204,v205
v_cvt_pk_bf16_f32 v7,v206,v207
ds_write_b128 v131,v[4:7] offset:1024
buffer_load_dwordx4 v231,s[20:23],s35 offen offset:3072 nt lds
s_waitcnt vmcnt(24)
v_lshlrev_b32 v188,16,v8
v_and_b32 v189,0xffff0000,v8
v_lshlrev_b32 v190,16,v9
v_and_b32 v191,0xffff0000,v9
v_lshlrev_b32 v192,16,v10
v_and_b32 v193,0xffff0000,v10
v_lshlrev_b32 v194,16,v11
v_and_b32 v195,0xffff0000,v11
v_pk_mul_f32 v[188:189],v[188:189],s[80:81]
v_pk_mul_f32 v[190:191],v[190:191],s[80:81]
v_pk_mul_f32 v[192:193],v[192:193],s[80:81]
v_pk_mul_f32 v[194:195],v[194:195],s[80:81]
v_cvt_pk_bf16_f32 v8,v188,v189
v_cvt_pk_bf16_f32 v9,v190,v191
v_cvt_pk_bf16_f32 v10,v192,v193
v_cvt_pk_bf16_f32 v11,v194,v195
ds_write_b128 v130,v[8:11] offset:2048
s_add_u32 m0,s47,4096
s_mov_b32 s35,4096
buffer_load_dwordx4 v231,s[20:23],s35 offen nt lds
v_lshlrev_b32 v200,16,v12
v_and_b32 v201,0xffff0000,v12
v_lshlrev_b32 v202,16,v13
v_and_b32 v203,0xffff0000,v13
v_lshlrev_b32 v204,16,v14
v_and_b32 v205,0xffff0000,v14
v_lshlrev_b32 v206,16,v15
v_and_b32 v207,0xffff0000,v15
v_pk_mul_f32 v[200:201],v[200:201],s[80:81]
v_pk_mul_f32 v[202:203],v[202:203],s[80:81]
v_pk_mul_f32 v[204:205],v[204:205],s[80:81]
v_pk_mul_f32 v[206:207],v[206:207],s[80:81]
v_cvt_pk_bf16_f32 v12,v200,v201
v_cvt_pk_bf16_f32 v13,v202,v203
v_cvt_pk_bf16_f32 v14,v204,v205
v_cvt_pk_bf16_f32 v15,v206,v207
ds_write_b128 v131,v[12:15] offset:3072
ds_read_b128 a[32:35],v132
ds_read_b128 a[36:39],v133
ds_read_b128 a[40:43],v132 offset:128
ds_read_b128 a[44:47],v133 offset:128
buffer_load_dwordx4 v231,s[20:23],s35 offen offset:1024 nt lds
s_waitcnt vmcnt(24)
v_lshlrev_b32 v188,16,v16
v_and_b32 v189,0xffff0000,v16
v_lshlrev_b32 v190,16,v17
v_and_b32 v191,0xffff0000,v17
v_lshlrev_b32 v192,16,v18
v_and_b32 v193,0xffff0000,v18
v_lshlrev_b32 v194,16,v19
v_and_b32 v195,0xffff0000,v19
v_pk_mul_f32 v[188:189],v[188:189],s[80:81]
v_pk_mul_f32 v[190:191],v[190:191],s[80:81]
v_pk_mul_f32 v[192:193],v[192:193],s[80:81]
v_pk_mul_f32 v[194:195],v[194:195],s[80:81]
v_cvt_pk_bf16_f32 v16,v188,v189
v_cvt_pk_bf16_f32 v17,v190,v191
v_cvt_pk_bf16_f32 v18,v192,v193
v_cvt_pk_bf16_f32 v19,v194,v195
ds_write_b128 v130,v[16:19]
buffer_load_dwordx4 v231,s[20:23],s35 offen offset:2048 nt lds
v_lshlrev_b32 v200,16,v20
v_and_b32 v201,0xffff0000,v20
v_lshlrev_b32 v202,16,v21
v_and_b32 v203,0xffff0000,v21
v_lshlrev_b32 v204,16,v22
v_and_b32 v205,0xffff0000,v22
v_lshlrev_b32 v206,16,v23
v_and_b32 v207,0xffff0000,v23
v_pk_mul_f32 v[200:201],v[200:201],s[80:81]
v_pk_mul_f32 v[202:203],v[202:203],s[80:81]
v_pk_mul_f32 v[204:205],v[204:205],s[80:81]
v_pk_mul_f32 v[206:207],v[206:207],s[80:81]
v_cvt_pk_bf16_f32 v20,v200,v201
v_cvt_pk_bf16_f32 v21,v202,v203
v_cvt_pk_bf16_f32 v22,v204,v205
v_cvt_pk_bf16_f32 v23,v206,v207
ds_write_b128 v131,v[20:23] offset:1024
buffer_load_dwordx4 v231,s[20:23],s35 offen offset:3072 nt lds
s_waitcnt vmcnt(24)
v_lshlrev_b32 v188,16,v24
v_and_b32 v189,0xffff0000,v24
v_lshlrev_b32 v190,16,v25
v_and_b32 v191,0xffff0000,v25
v_lshlrev_b32 v192,16,v26
v_and_b32 v193,0xffff0000,v26
v_lshlrev_b32 v194,16,v27
v_and_b32 v195,0xffff0000,v27
v_pk_mul_f32 v[188:189],v[188:189],s[80:81]
v_pk_mul_f32 v[190:191],v[190:191],s[80:81]
v_pk_mul_f32 v[192:193],v[192:193],s[80:81]
v_pk_mul_f32 v[194:195],v[194:195],s[80:81]
v_cvt_pk_bf16_f32 v24,v188,v189
v_cvt_pk_bf16_f32 v25,v190,v191
v_cvt_pk_bf16_f32 v26,v192,v193
v_cvt_pk_bf16_f32 v27,v194,v195
ds_write_b128 v130,v[24:27] offset:2048
s_add_u32 m0,s48,0
s_mov_b32 s35,32768
buffer_load_dwordx4 v231,s[16:19],s35 offen nt lds
v_lshlrev_b32 v200,16,v28
v_and_b32 v201,0xffff0000,v28
v_lshlrev_b32 v202,16,v29
v_and_b32 v203,0xffff0000,v29
v_lshlrev_b32 v204,16,v30
v_and_b32 v205,0xffff0000,v30
v_lshlrev_b32 v206,16,v31
v_and_b32 v207,0xffff0000,v31
v_pk_mul_f32 v[200:201],v[200:201],s[80:81]
v_pk_mul_f32 v[202:203],v[202:203],s[80:81]
v_pk_mul_f32 v[204:205],v[204:205],s[80:81]
v_pk_mul_f32 v[206:207],v[206:207],s[80:81]
v_cvt_pk_bf16_f32 v28,v200,v201
v_cvt_pk_bf16_f32 v29,v202,v203
v_cvt_pk_bf16_f32 v30,v204,v205
v_cvt_pk_bf16_f32 v31,v206,v207
ds_write_b128 v131,v[28:31] offset:3072
ds_read_b128 a[48:51],v132
ds_read_b128 a[52:55],v133
ds_read_b128 a[56:59],v132 offset:128
ds_read_b128 a[60:63],v133 offset:128
buffer_load_dwordx4 v231,s[16:19],s35 offen offset:1024 nt lds
s_waitcnt vmcnt(24)
v_lshlrev_b32 v188,16,v32
v_and_b32 v189,0xffff0000,v32
v_lshlrev_b32 v190,16,v33
v_and_b32 v191,0xffff0000,v33
v_lshlrev_b32 v192,16,v34
v_and_b32 v193,0xffff0000,v34
v_lshlrev_b32 v194,16,v35
v_and_b32 v195,0xffff0000,v35
v_pk_mul_f32 v[188:189],v[188:189],s[80:81]
v_pk_mul_f32 v[190:191],v[190:191],s[80:81]
v_pk_mul_f32 v[192:193],v[192:193],s[80:81]
v_pk_mul_f32 v[194:195],v[194:195],s[80:81]
v_cvt_pk_bf16_f32 v32,v188,v189
v_cvt_pk_bf16_f32 v33,v190,v191
v_cvt_pk_bf16_f32 v34,v192,v193
v_cvt_pk_bf16_f32 v35,v194,v195
ds_write_b128 v130,v[32:35]
buffer_load_dwordx4 v231,s[16:19],s35 offen offset:2048 nt lds
v_lshlrev_b32 v200,16,v36
v_and_b32 v201,0xffff0000,v36
v_lshlrev_b32 v202,16,v37
v_and_b32 v203,0xffff0000,v37
v_lshlrev_b32 v204,16,v38
v_and_b32 v205,0xffff0000,v38
v_lshlrev_b32 v206,16,v39
v_and_b32 v207,0xffff0000,v39
v_pk_mul_f32 v[200:201],v[200:201],s[80:81]
v_pk_mul_f32 v[202:203],v[202:203],s[80:81]
v_pk_mul_f32 v[204:205],v[204:205],s[80:81]
v_pk_mul_f32 v[206:207],v[206:207],s[80:81]
v_cvt_pk_bf16_f32 v36,v200,v201
v_cvt_pk_bf16_f32 v37,v202,v203
v_cvt_pk_bf16_f32 v38,v204,v205
v_cvt_pk_bf16_f32 v39,v206,v207
ds_write_b128 v131,v[36:39] offset:1024
buffer_load_dwordx4 v231,s[16:19],s35 offen offset:3072 nt lds
s_waitcnt vmcnt(24)
v_lshlrev_b32 v188,16,v40
v_and_b32 v189,0xffff0000,v40
v_lshlrev_b32 v190,16,v41
v_and_b32 v191,0xffff0000,v41
v_lshlrev_b32 v192,16,v42
v_and_b32 v193,0xffff0000,v42
v_lshlrev_b32 v194,16,v43
v_and_b32 v195,0xffff0000,v43
v_pk_mul_f32 v[188:189],v[188:189],s[80:81]
v_pk_mul_f32 v[190:191],v[190:191],s[80:81]
v_pk_mul_f32 v[192:193],v[192:193],s[80:81]
v_pk_mul_f32 v[194:195],v[194:195],s[80:81]
v_cvt_pk_bf16_f32 v40,v188,v189
v_cvt_pk_bf16_f32 v41,v190,v191
v_cvt_pk_bf16_f32 v42,v192,v193
v_cvt_pk_bf16_f32 v43,v194,v195
ds_write_b128 v130,v[40:43] offset:2048
s_add_u32 m0,s48,4096
s_mov_b32 s35,36864
buffer_load_dwordx4 v231,s[16:19],s35 offen nt lds
v_lshlrev_b32 v200,16,v44
v_and_b32 v201,0xffff0000,v44
v_lshlrev_b32 v202,16,v45
v_and_b32 v203,0xffff0000,v45
v_lshlrev_b32 v204,16,v46
v_and_b32 v205,0xffff0000,v46
v_lshlrev_b32 v206,16,v47
v_and_b32 v207,0xffff0000,v47
v_pk_mul_f32 v[200:201],v[200:201],s[80:81]
v_pk_mul_f32 v[202:203],v[202:203],s[80:81]
v_pk_mul_f32 v[204:205],v[204:205],s[80:81]
v_pk_mul_f32 v[206:207],v[206:207],s[80:81]
v_cvt_pk_bf16_f32 v44,v200,v201
v_cvt_pk_bf16_f32 v45,v202,v203
v_cvt_pk_bf16_f32 v46,v204,v205
v_cvt_pk_bf16_f32 v47,v206,v207
ds_write_b128 v131,v[44:47] offset:3072
ds_read_b128 a[64:67],v132
ds_read_b128 a[68:71],v133
ds_read_b128 a[72:75],v132 offset:128
ds_read_b128 a[76:79],v133 offset:128
buffer_load_dwordx4 v231,s[16:19],s35 offen offset:1024 nt lds
s_waitcnt vmcnt(24)
v_lshlrev_b32 v188,16,v48
v_and_b32 v189,0xffff0000,v48
v_lshlrev_b32 v190,16,v49
v_and_b32 v191,0xffff0000,v49
v_lshlrev_b32 v192,16,v50
v_and_b32 v193,0xffff0000,v50
v_lshlrev_b32 v194,16,v51
v_and_b32 v195,0xffff0000,v51
v_pk_mul_f32 v[188:189],v[188:189],s[80:81]
v_pk_mul_f32 v[190:191],v[190:191],s[80:81]
v_pk_mul_f32 v[192:193],v[192:193],s[80:81]
v_pk_mul_f32 v[194:195],v[194:195],s[80:81]
v_cvt_pk_bf16_f32 v48,v188,v189
v_cvt_pk_bf16_f32 v49,v190,v191
v_cvt_pk_bf16_f32 v50,v192,v193
v_cvt_pk_bf16_f32 v51,v194,v195
ds_write_b128 v130,v[48:51]
buffer_load_dwordx4 v231,s[16:19],s35 offen offset:2048 nt lds
v_lshlrev_b32 v200,16,v52
v_and_b32 v201,0xffff0000,v52
v_lshlrev_b32 v202,16,v53
v_and_b32 v203,0xffff0000,v53
v_lshlrev_b32 v204,16,v54
v_and_b32 v205,0xffff0000,v54
v_lshlrev_b32 v206,16,v55
v_and_b32 v207,0xffff0000,v55
v_pk_mul_f32 v[200:201],v[200:201],s[80:81]
v_pk_mul_f32 v[202:203],v[202:203],s[80:81]
v_pk_mul_f32 v[204:205],v[204:205],s[80:81]
v_pk_mul_f32 v[206:207],v[206:207],s[80:81]
v_cvt_pk_bf16_f32 v52,v200,v201
v_cvt_pk_bf16_f32 v53,v202,v203
v_cvt_pk_bf16_f32 v54,v204,v205
v_cvt_pk_bf16_f32 v55,v206,v207
ds_write_b128 v131,v[52:55] offset:1024
buffer_load_dwordx4 v231,s[16:19],s35 offen offset:3072 nt lds
s_waitcnt vmcnt(24)
v_lshlrev_b32 v188,16,v56
v_and_b32 v189,0xffff0000,v56
v_lshlrev_b32 v190,16,v57
v_and_b32 v191,0xffff0000,v57
v_lshlrev_b32 v192,16,v58
v_and_b32 v193,0xffff0000,v58
v_lshlrev_b32 v194,16,v59
v_and_b32 v195,0xffff0000,v59
v_pk_mul_f32 v[188:189],v[188:189],s[80:81]
v_pk_mul_f32 v[190:191],v[190:191],s[80:81]
v_pk_mul_f32 v[192:193],v[192:193],s[80:81]
v_pk_mul_f32 v[194:195],v[194:195],s[80:81]
v_cvt_pk_bf16_f32 v56,v188,v189
v_cvt_pk_bf16_f32 v57,v190,v191
v_cvt_pk_bf16_f32 v58,v192,v193
v_cvt_pk_bf16_f32 v59,v194,v195
ds_write_b128 v130,v[56:59] offset:2048
v_lshlrev_b32 v200,16,v60
v_and_b32 v201,0xffff0000,v60
v_lshlrev_b32 v202,16,v61
v_and_b32 v203,0xffff0000,v61
v_lshlrev_b32 v204,16,v62
v_and_b32 v205,0xffff0000,v62
v_lshlrev_b32 v206,16,v63
v_and_b32 v207,0xffff0000,v63
v_pk_mul_f32 v[200:201],v[200:201],s[80:81]
v_pk_mul_f32 v[202:203],v[202:203],s[80:81]
v_pk_mul_f32 v[204:205],v[204:205],s[80:81]
v_pk_mul_f32 v[206:207],v[206:207],s[80:81]
v_cvt_pk_bf16_f32 v60,v200,v201
v_cvt_pk_bf16_f32 v61,v202,v203
v_cvt_pk_bf16_f32 v62,v204,v205
v_cvt_pk_bf16_f32 v63,v206,v207
ds_write_b128 v131,v[60:63] offset:3072
ds_read_b128 a[80:83],v132
ds_read_b128 a[84:87],v133
ds_read_b128 a[88:91],v132 offset:128
ds_read_b128 a[92:95],v133 offset:128
s_waitcnt lgkmcnt(0)
s_barrier
ds_read_b128 a[96:99],v142 offset:4096
ds_read_b128 a[100:103],v143 offset:4096
ds_read_b128 a[104:107],v142 offset:4224
ds_read_b128 a[108:111],v143 offset:4224
s_waitcnt vmcnt(8) lgkmcnt(0)
s_barrier
S_head:
s_mov_b32 s36,0
ds_read_b128 a[112:115],v228
ds_read_b128 a[116:119],v228 offset:1024
ds_read_b128 a[120:123],v228 offset:256
ds_read_b128 a[124:127],v228 offset:1280
ds_read_b128 a[128:131],v228 offset:512
ds_read_b128 a[132:135],v228 offset:1536
ds_read_b128 a[136:139],v228 offset:768
ds_read_b128 a[140:143],v228 offset:1792
s_waitcnt lgkmcnt(7)
v_mfma_f32_16x16x32_bf16 v[128:131],a[112:115],a[32:35],0
s_sub_u32 s29,s47,s45
s_waitcnt lgkmcnt(6)
v_mfma_f32_16x16x32_bf16 v[132:135],a[116:119],a[32:35],0
s_add_u32 m0,s44,0
s_waitcnt lgkmcnt(5)
v_mfma_f32_16x16x32_bf16 v[128:131],a[120:123],a[36:39],v[128:131]
s_add_u32 s34,s30,0
s_waitcnt lgkmcnt(4)
v_mfma_f32_16x16x32_bf16 v[132:135],a[124:127],a[36:39],v[132:135]
s_add_u32 s29,s29,s42
s_waitcnt lgkmcnt(3)
v_mfma_f32_16x16x32_bf16 v[128:131],a[128:131],a[40:43],v[128:131]
v_add_u32 v229,s29,v229
s_waitcnt lgkmcnt(2)
v_mfma_f32_16x16x32_bf16 v[132:135],a[132:135],a[40:43],v[132:135]
v_add_u32 v230,s29,v230
s_waitcnt lgkmcnt(0)
v_mfma_f32_16x16x32_bf16 v[128:131],a[136:139],a[44:47],v[128:131]
ds_read_b64_tr_b16 a[144:145],v229
v_xor_b32 v228,2048,v228
v_mfma_f32_16x16x32_bf16 v[132:135],a[140:143],a[44:47],v[132:135]
s_nop 4
v_max3_f32 v252,v128,v129,v130
s_nop 1
v_max3_f32 v253,v131,v132,v133
v_max3_f32 v252,v252,v134,v135
v_max_f32 v252,v252,v253
v_mov_b32 v253,v252
s_nop 1
v_permlane32_swap_b32 v252,v253
v_max_f32 v252,v252,v253
v_mov_b32 v253,v252
s_nop 1
v_permlane16_swap_b32 v252,v253
v_max_f32 v252,v252,v253
v_sub_f32 v128,v128,v252
v_sub_f32 v129,v129,v252
v_sub_f32 v130,v130,v252
v_sub_f32 v131,v131,v252
v_sub_f32 v132,v132,v252
v_sub_f32 v133,v133,v252
v_sub_f32 v134,v134,v252
v_sub_f32 v135,v135,v252
v_sub_f32 v188,0,v252
v_sub_f32 v189,0,v252
v_sub_f32 v190,0,v252
v_sub_f32 v191,0,v252
v_exp_f32 v224,v128
v_exp_f32 v225,v129
v_exp_f32 v226,v130
v_exp_f32 v227,v131
v_mfma_f32_16x16x32_bf16 v[144:147],a[112:115],a[48:51],0
v_cvt_pk_bf16_f32 v168,v224,v225
v_cvt_pk_bf16_f32 v169,v226,v227
v_mfma_f32_16x16x32_bf16 v[148:151],a[116:119],a[48:51],0
v_exp_f32 v224,v132
v_mfma_f32_16x16x32_bf16 v[144:147],a[120:123],a[52:55],v[144:147]
v_exp_f32 v225,v133
v_mfma_f32_16x16x32_bf16 v[148:151],a[124:127],a[52:55],v[148:151]
buffer_load_dwordx4 v231,s[20:23],s34 offen nt lds
v_mfma_f32_16x16x32_bf16 v[144:147],a[128:131],a[56:59],v[144:147]
v_exp_f32 v226,v134
v_mfma_f32_16x16x32_bf16 v[148:151],a[132:135],a[56:59],v[148:151]
v_exp_f32 v227,v135
v_mfma_f32_16x16x32_bf16 v[144:147],a[136:139],a[60:63],v[144:147]
v_cvt_pk_bf16_f32 v170,v224,v225
v_cvt_pk_bf16_f32 v171,v226,v227
v_mfma_f32_16x16x32_bf16 v[148:151],a[140:143],a[60:63],v[148:151]
s_nop 4
v_max3_f32 v252,v144,v145,v146
s_nop 1
v_max3_f32 v253,v147,v148,v149
v_max3_f32 v252,v252,v150,v151
v_max_f32 v252,v252,v253
v_mov_b32 v253,v252
s_nop 1
v_permlane32_swap_b32 v252,v253
v_max_f32 v252,v252,v253
v_mov_b32 v253,v252
s_nop 1
v_permlane16_swap_b32 v252,v253
v_max_f32 v252,v252,v253
v_sub_f32 v144,v144,v252
v_sub_f32 v145,v145,v252
v_sub_f32 v146,v146,v252
v_sub_f32 v147,v147,v252
v_sub_f32 v148,v148,v252
v_sub_f32 v149,v149,v252
v_sub_f32 v150,v150,v252
v_sub_f32 v151,v151,v252
v_sub_f32 v192,0,v252
v_sub_f32 v193,0,v252
v_sub_f32 v194,0,v252
v_sub_f32 v195,0,v252
v_exp_f32 v224,v144
v_mfma_f32_16x16x32_bf16 v[152:155],a[112:115],a[64:67],0
v_exp_f32 v225,v145
buffer_load_dwordx4 v231,s[20:23],s34 offen offset:1024 nt lds
v_mfma_f32_16x16x32_bf16 v[156:159],a[116:119],a[64:67],0
v_exp_f32 v226,v146
v_mfma_f32_16x16x32_bf16 v[152:155],a[120:123],a[68:71],v[152:155]
v_exp_f32 v227,v147
v_mfma_f32_16x16x32_bf16 v[156:159],a[124:127],a[68:71],v[156:159]
v_cvt_pk_bf16_f32 v172,v224,v225
v_cvt_pk_bf16_f32 v173,v226,v227
v_mfma_f32_16x16x32_bf16 v[152:155],a[128:131],a[72:75],v[152:155]
v_exp_f32 v224,v148
v_mfma_f32_16x16x32_bf16 v[156:159],a[132:135],a[72:75],v[156:159]
buffer_load_dwordx4 v231,s[20:23],s34 offen offset:2048 nt lds
v_exp_f32 v225,v149
v_mfma_f32_16x16x32_bf16 v[152:155],a[136:139],a[76:79],v[152:155]
v_exp_f32 v226,v150
v_mfma_f32_16x16x32_bf16 v[156:159],a[140:143],a[76:79],v[156:159]
v_exp_f32 v227,v151
v_mfma_f32_16x16x32_bf16 v[212:215],a[176:179],v[168:171],0
ds_read_b64_tr_b16 a[146:147],v229 offset:1024
v_cvt_pk_bf16_f32 v174,v224,v225
ds_read_b64_tr_b16 a[148:149],v230
v_mfma_f32_16x16x32_bf16 v[160:163],a[112:115],a[80:83],0
v_cvt_pk_bf16_f32 v175,v226,v227
ds_read_b64_tr_b16 a[150:151],v230 offset:1024
v_max3_f32 v252,v152,v153,v154
ds_read_b64_tr_b16 a[152:153],v229 offset:256
v_mfma_f32_16x16x32_bf16 v[164:167],a[116:119],a[80:83],0
v_max3_f32 v253,v155,v156,v157
ds_read_b64_tr_b16 a[154:155],v229 offset:1280
buffer_load_dwordx4 v231,s[20:23],s34 offen offset:3072 nt lds
v_max3_f32 v252,v252,v158,v159
ds_read_b64_tr_b16 a[156:157],v230 offset:256
v_mfma_f32_16x16x32_bf16 v[160:163],a[120:123],a[84:87],v[160:163]
v_max_f32 v252,v252,v253
ds_read_b64_tr_b16 a[158:159],v230 offset:1280
v_mov_b32 v253,v252
ds_read_b64_tr_b16 a[160:161],v229 offset:512
v_mfma_f32_16x16x32_bf16 v[164:167],a[124:127],a[84:87],v[164:167]
v_permlane32_swap_b32 v252,v253
ds_read_b64_tr_b16 a[162:163],v229 offset:1536
v_max_f32 v252,v252,v253
ds_read_b64_tr_b16 a[164:165],v230 offset:512
v_mfma_f32_16x16x32_bf16 v[160:163],a[128:131],a[88:91],v[160:163]
v_mov_b32 v253,v252
ds_read_b64_tr_b16 a[166:167],v230 offset:1536
s_nop 0
v_permlane16_swap_b32 v252,v253
ds_read_b64_tr_b16 a[168:169],v229 offset:768
s_add_u32 m0,s44,4096
v_mfma_f32_16x16x32_bf16 v[164:167],a[132:135],a[88:91],v[164:167]
v_max_f32 v252,v252,v253
ds_read_b64_tr_b16 a[170:171],v229 offset:1792
s_add_u32 s34,s30,4096
v_sub_f32 v152,v152,v252
ds_read_b64_tr_b16 a[172:173],v230 offset:768
v_mfma_f32_16x16x32_bf16 v[160:163],a[136:139],a[92:95],v[160:163]
v_sub_f32 v153,v153,v252
ds_read_b64_tr_b16 a[174:175],v230 offset:1792
buffer_load_dwordx4 v231,s[20:23],s34 offen nt lds
v_sub_f32 v154,v154,v252
v_mfma_f32_16x16x32_bf16 v[164:167],a[140:143],a[92:95],v[164:167]
v_sub_f32 v155,v155,v252
v_sub_f32 v156,v156,v252
s_waitcnt lgkmcnt(9)
v_mfma_f32_16x16x32_bf16 v[0:3],a[144:147],v[168:171],0
v_sub_f32 v157,v157,v252
ds_read_b128 a[112:115],v228
v_sub_f32 v158,v158,v252
v_mfma_f32_16x16x32_bf16 v[4:7],a[148:151],v[168:171],0
v_sub_f32 v159,v159,v252
ds_read_b128 a[116:119],v228 offset:1024
v_sub_f32 v196,0,v252
v_mfma_f32_16x16x32_bf16 v[8:11],a[152:155],v[168:171],0
v_sub_f32 v197,0,v252
ds_read_b128 a[120:123],v228 offset:256
v_sub_f32 v198,0,v252
s_waitcnt lgkmcnt(6)
v_mfma_f32_16x16x32_bf16 v[12:15],a[156:159],v[168:171],0
v_sub_f32 v199,0,v252
ds_read_b128 a[124:127],v228 offset:1280
buffer_load_dwordx4 v231,s[20:23],s34 offen offset:1024 nt lds
v_mfma_f32_16x16x32_bf16 v[16:19],a[160:163],v[168:171],0
v_exp_f32 v224,v152
ds_read_b128 a[128:131],v228 offset:512
v_mfma_f32_16x16x32_bf16 v[20:23],a[164:167],v[168:171],0
v_exp_f32 v225,v153
ds_read_b128 a[132:135],v228 offset:1536
s_waitcnt lgkmcnt(6)
v_mfma_f32_16x16x32_bf16 v[24:27],a[168:171],v[168:171],0
v_exp_f32 v226,v154
ds_read_b128 a[136:139],v228 offset:768
v_mfma_f32_16x16x32_bf16 v[28:31],a[172:175],v[168:171],0
v_exp_f32 v227,v155
ds_read_b128 a[140:143],v228 offset:1792
v_mfma_f32_16x16x32_bf16 v[208:211],a[180:183],v[172:175],v[212:215]
v_cvt_pk_bf16_f32 v176,v224,v225
buffer_load_dwordx4 v231,s[20:23],s34 offen offset:2048 nt lds
v_cvt_pk_bf16_f32 v177,v226,v227
s_waitcnt lgkmcnt(5)
v_mfma_f32_16x16x32_bf16 v[136:139],a[112:115],a[96:99],0
v_exp_f32 v224,v156
v_mfma_f32_16x16x32_bf16 v[140:143],a[116:119],a[96:99],0
v_exp_f32 v225,v157
v_mfma_f32_16x16x32_bf16 v[136:139],a[120:123],a[100:103],v[136:139]
v_exp_f32 v226,v158
s_waitcnt lgkmcnt(2)
v_mfma_f32_16x16x32_bf16 v[140:143],a[124:127],a[100:103],v[140:143]
v_exp_f32 v227,v159
v_mfma_f32_16x16x32_bf16 v[136:139],a[128:131],a[104:107],v[136:139]
buffer_load_dwordx4 v231,s[20:23],s34 offen offset:3072 nt lds
v_cvt_pk_bf16_f32 v178,v224,v225
v_mfma_f32_16x16x32_bf16 v[140:143],a[132:135],a[104:107],v[140:143]
v_cvt_pk_bf16_f32 v179,v226,v227
v_max3_f32 v252,v160,v161,v162
s_waitcnt lgkmcnt(0)
v_mfma_f32_16x16x32_bf16 v[136:139],a[136:139],a[108:111],v[136:139]
v_max3_f32 v253,v163,v164,v165
v_max3_f32 v252,v252,v166,v167
v_mfma_f32_16x16x32_bf16 v[140:143],a[140:143],a[108:111],v[140:143]
v_max_f32 v252,v252,v253
v_mov_b32 v253,v252
s_add_u32 m0,s45,0
v_mfma_f32_16x16x32_bf16 v[32:35],a[144:147],v[172:175],0
v_permlane32_swap_b32 v252,v253
s_add_u32 s34,s30,32768
v_max_f32 v252,v252,v253
v_mfma_f32_16x16x32_bf16 v[36:39],a[148:151],v[172:175],0
v_mov_b32 v253,v252
buffer_load_dwordx4 v231,s[16:19],s34 offen nt lds
s_nop 0
v_permlane16_swap_b32 v252,v253
v_mfma_f32_16x16x32_bf16 v[40:43],a[152:155],v[172:175],0
v_max_f32 v252,v252,v253
v_sub_f32 v160,v160,v252
v_mfma_f32_16x16x32_bf16 v[44:47],a[156:159],v[172:175],0
v_sub_f32 v161,v161,v252
v_sub_f32 v162,v162,v252
v_mfma_f32_16x16x32_bf16 v[48:51],a[160:163],v[172:175],0
v_sub_f32 v163,v163,v252
v_sub_f32 v164,v164,v252
v_mfma_f32_16x16x32_bf16 v[52:55],a[164:167],v[172:175],0
v_sub_f32 v165,v165,v252
v_sub_f32 v166,v166,v252
v_mfma_f32_16x16x32_bf16 v[56:59],a[168:171],v[172:175],0
v_sub_f32 v167,v167,v252
buffer_load_dwordx4 v231,s[16:19],s34 offen offset:1024 nt lds
v_sub_f32 v200,0,v252
v_mfma_f32_16x16x32_bf16 v[60:63],a[172:175],v[172:175],0
v_sub_f32 v201,0,v252
v_sub_f32 v202,0,v252
v_mfma_f32_16x16x32_bf16 v[212:215],a[184:187],v[176:179],v[208:211]
v_sub_f32 v203,0,v252
v_xor_b32 v229,2048,v229
v_mfma_f32_16x16x32_bf16 v[128:131],a[112:115],a[32:35],v[188:191]
v_exp_f32 v224,v160
v_mfma_f32_16x16x32_bf16 v[132:135],a[116:119],a[32:35],v[188:191]
v_exp_f32 v225,v161
v_mfma_f32_16x16x32_bf16 v[128:131],a[120:123],a[36:39],v[128:131]
v_exp_f32 v226,v162
buffer_load_dwordx4 v231,s[16:19],s34 offen offset:2048 nt lds
v_mfma_f32_16x16x32_bf16 v[132:135],a[124:127],a[36:39],v[132:135]
v_exp_f32 v227,v163
v_mfma_f32_16x16x32_bf16 v[128:131],a[128:131],a[40:43],v[128:131]
v_cvt_pk_bf16_f32 v180,v224,v225
v_cvt_pk_bf16_f32 v181,v226,v227
v_mfma_f32_16x16x32_bf16 v[132:135],a[132:135],a[40:43],v[132:135]
v_exp_f32 v224,v164
v_mfma_f32_16x16x32_bf16 v[128:131],a[136:139],a[44:47],v[128:131]
v_exp_f32 v225,v165
v_mfma_f32_16x16x32_bf16 v[132:135],a[140:143],a[44:47],v[132:135]
buffer_load_dwordx4 v231,s[16:19],s34 offen offset:3072 nt lds
v_exp_f32 v226,v166
v_mfma_f32_16x16x32_bf16 v[64:67],a[144:147],v[176:179],0
v_exp_f32 v227,v167
v_mfma_f32_16x16x32_bf16 v[68:71],a[148:151],v[176:179],0
v_cvt_pk_bf16_f32 v182,v224,v225
v_cvt_pk_bf16_f32 v183,v226,v227
v_mfma_f32_16x16x32_bf16 v[72:75],a[152:155],v[176:179],0
v_max3_f32 v252,v136,v137,v138
s_add_u32 m0,s45,4096
v_mfma_f32_16x16x32_bf16 v[76:79],a[156:159],v[176:179],0
v_max3_f32 v253,v139,v140,v141
s_add_u32 s34,s30,36864
v_max3_f32 v252,v252,v142,v143
v_mfma_f32_16x16x32_bf16 v[80:83],a[160:163],v[176:179],0
v_max_f32 v252,v252,v253
buffer_load_dwordx4 v231,s[16:19],s34 offen nt lds
v_mov_b32 v253,v252
v_mfma_f32_16x16x32_bf16 v[84:87],a[164:167],v[176:179],0
s_nop 0
v_permlane32_swap_b32 v252,v253
v_max_f32 v252,v252,v253
v_mfma_f32_16x16x32_bf16 v[88:91],a[168:171],v[176:179],0
v_mov_b32 v253,v252
s_nop 1
v_permlane16_swap_b32 v252,v253
v_mfma_f32_16x16x32_bf16 v[92:95],a[172:175],v[176:179],0
v_max_f32 v252,v252,v253
v_sub_f32 v136,v136,v252
v_mfma_f32_16x16x32_bf16 v[208:211],a[188:191],v[180:183],v[212:215]
v_sub_f32 v137,v137,v252
v_sub_f32 v138,v138,v252
v_mfma_f32_16x16x32_bf16 v[144:147],a[112:115],a[48:51],v[192:195]
v_sub_f32 v139,v139,v252
buffer_load_dwordx4 v231,s[16:19],s34 offen offset:1024 nt lds
v_sub_f32 v140,v140,v252
v_mfma_f32_16x16x32_bf16 v[148:151],a[116:119],a[48:51],v[192:195]
v_sub_f32 v141,v141,v252
v_sub_f32 v142,v142,v252
v_mfma_f32_16x16x32_bf16 v[144:147],a[120:123],a[52:55],v[144:147]
v_sub_f32 v143,v143,v252
v_sub_f32 v204,0,v252
v_mfma_f32_16x16x32_bf16 v[148:151],a[124:127],a[52:55],v[148:151]
v_sub_f32 v205,0,v252
v_sub_f32 v206,0,v252
v_mfma_f32_16x16x32_bf16 v[144:147],a[128:131],a[56:59],v[144:147]
v_sub_f32 v207,0,v252
v_xor_b32 v230,2048,v230
v_mfma_f32_16x16x32_bf16 v[148:151],a[132:135],a[56:59],v[148:151]
v_exp_f32 v224,v136
buffer_load_dwordx4 v231,s[16:19],s34 offen offset:2048 nt lds
v_mfma_f32_16x16x32_bf16 v[144:147],a[136:139],a[60:63],v[144:147]
v_exp_f32 v225,v137
v_mfma_f32_16x16x32_bf16 v[148:151],a[140:143],a[60:63],v[148:151]
v_exp_f32 v226,v138
v_mfma_f32_16x16x32_bf16 v[96:99],a[144:147],v[180:183],0
v_exp_f32 v227,v139
v_mfma_f32_16x16x32_bf16 v[100:103],a[148:151],v[180:183],0
v_cvt_pk_bf16_f32 v184,v224,v225
v_cvt_pk_bf16_f32 v185,v226,v227
v_mfma_f32_16x16x32_bf16 v[104:107],a[152:155],v[180:183],0
buffer_load_dwordx4 v231,s[16:19],s34 offen offset:3072 nt lds
v_exp_f32 v224,v140
v_mfma_f32_16x16x32_bf16 v[108:111],a[156:159],v[180:183],0
v_exp_f32 v225,v141
v_mfma_f32_16x16x32_bf16 v[112:115],a[160:163],v[180:183],0
v_exp_f32 v226,v142
v_mfma_f32_16x16x32_bf16 v[116:119],a[164:167],v[180:183],0
v_exp_f32 v227,v143
v_mfma_f32_16x16x32_bf16 v[120:123],a[168:171],v[180:183],0
v_cvt_pk_bf16_f32 v186,v224,v225
v_cvt_pk_bf16_f32 v187,v226,v227
v_mfma_f32_16x16x32_bf16 v[124:127],a[172:175],v[180:183],0
ds_read_b64_tr_b16 a[144:145],v229
ds_read_b64_tr_b16 a[146:147],v229 offset:1024
v_mfma_f32_16x16x32_bf16 v[220:223],a[176:179],v[184:187],0
ds_read_b64_tr_b16 a[148:149],v230
ds_read_b64_tr_b16 a[150:151],v230 offset:1024
v_mfma_f32_16x16x32_bf16 v[152:155],a[112:115],a[64:67],v[196:199]
ds_read_b64_tr_b16 a[152:153],v229 offset:256
ds_read_b64_tr_b16 a[154:155],v229 offset:1280
v_mfma_f32_16x16x32_bf16 v[156:159],a[116:119],a[64:67],v[196:199]
ds_read_b64_tr_b16 a[156:157],v230 offset:256
ds_read_b64_tr_b16 a[158:159],v230 offset:1280
v_mfma_f32_16x16x32_bf16 v[152:155],a[120:123],a[68:71],v[152:155]
ds_read_b64_tr_b16 a[160:161],v229 offset:512
ds_read_b64_tr_b16 a[162:163],v229 offset:1536
v_mfma_f32_16x16x32_bf16 v[156:159],a[124:127],a[68:71],v[156:159]
ds_read_b64_tr_b16 a[164:165],v230 offset:512
ds_read_b64_tr_b16 a[166:167],v230 offset:1536
v_mfma_f32_16x16x32_bf16 v[152:155],a[128:131],a[72:75],v[152:155]
ds_read_b64_tr_b16 a[168:169],v229 offset:768
ds_read_b64_tr_b16 a[170:171],v229 offset:1792
v_mfma_f32_16x16x32_bf16 v[156:159],a[132:135],a[72:75],v[156:159]
v_exp_f32 v224,v128
ds_read_b64_tr_b16 a[172:173],v230 offset:768
v_mfma_f32_16x16x32_bf16 v[152:155],a[136:139],a[76:79],v[152:155]
v_exp_f32 v225,v129
ds_read_b64_tr_b16 a[174:175],v230 offset:1792
v_mfma_f32_16x16x32_bf16 v[156:159],a[140:143],a[76:79],v[156:159]
v_exp_f32 v226,v130
s_waitcnt lgkmcnt(8)
v_mfma_f32_16x16x32_bf16 a[0:3],a[144:147],v[184:187],0
v_exp_f32 v227,v131
v_mfma_f32_16x16x32_bf16 a[4:7],a[148:151],v[184:187],0
v_cvt_pk_bf16_f32 v168,v224,v225
v_cvt_pk_bf16_f32 v169,v226,v227
v_mfma_f32_16x16x32_bf16 a[8:11],a[152:155],v[184:187],0
v_exp_f32 v224,v132
v_mfma_f32_16x16x32_bf16 a[12:15],a[156:159],v[184:187],0
v_exp_f32 v225,v133
s_waitcnt lgkmcnt(1)
v_mfma_f32_16x16x32_bf16 a[16:19],a[160:163],v[184:187],0
v_exp_f32 v226,v134
v_mfma_f32_16x16x32_bf16 a[20:23],a[164:167],v[184:187],0
v_exp_f32 v227,v135
v_mfma_f32_16x16x32_bf16 a[24:27],a[168:171],v[184:187],0
v_cvt_pk_bf16_f32 v170,v224,v225
s_waitcnt lgkmcnt(0)
v_mfma_f32_16x16x32_bf16 a[28:31],a[172:175],v[184:187],0
v_cvt_pk_bf16_f32 v171,v226,v227
v_xor_b32 v228,6144,v228
s_nop 0
v_mfma_f32_16x16x32_bf16 v[212:215],a[176:179],v[168:171],v[208:211]
v_exp_f32 v224,v144
v_mfma_f32_16x16x32_bf16 v[160:163],a[112:115],a[80:83],v[200:203]
v_exp_f32 v225,v145
v_mfma_f32_16x16x32_bf16 v[164:167],a[116:119],a[80:83],v[200:203]
v_exp_f32 v226,v146
v_mfma_f32_16x16x32_bf16 v[160:163],a[120:123],a[84:87],v[160:163]
v_exp_f32 v227,v147
v_mfma_f32_16x16x32_bf16 v[164:167],a[124:127],a[84:87],v[164:167]
v_cmp_ngt_f32 vcc,s38,v212
ds_read_b128 a[112:115],v228
v_mfma_f32_16x16x32_bf16 v[160:163],a[128:131],a[88:91],v[160:163]
s_cbranch_vccnz S_rare_f_8
S_back_f_8:
v_cvt_pk_bf16_f32 v172,v224,v225
v_mfma_f32_16x16x32_bf16 v[164:167],a[132:135],a[88:91],v[164:167]
ds_read_b128 a[116:119],v228 offset:1024
v_cvt_pk_bf16_f32 v173,v226,v227
v_mfma_f32_16x16x32_bf16 v[160:163],a[136:139],a[92:95],v[160:163]
ds_read_b128 a[120:123],v228 offset:256
ds_read_b128 a[124:127],v228 offset:1280
v_mfma_f32_16x16x32_bf16 v[164:167],a[140:143],a[92:95],v[164:167]
v_exp_f32 v224,v148
v_mfma_f32_16x16x32_bf16 v[0:3],a[144:147],v[168:171],v[0:3]
v_exp_f32 v225,v149
v_mfma_f32_16x16x32_bf16 v[4:7],a[148:151],v[168:171],v[4:7]
ds_read_b128 a[128:131],v228 offset:512
ds_read_b128 a[132:135],v228 offset:1536
v_mfma_f32_16x16x32_bf16 v[8:11],a[152:155],v[168:171],v[8:11]
v_exp_f32 v226,v150
v_mfma_f32_16x16x32_bf16 v[12:15],a[156:159],v[168:171],v[12:15]
v_exp_f32 v227,v151
v_mfma_f32_16x16x32_bf16 v[16:19],a[160:163],v[168:171],v[16:19]
ds_read_b128 a[136:139],v228 offset:768
v_cvt_pk_bf16_f32 v174,v224,v225
v_mfma_f32_16x16x32_bf16 v[20:23],a[164:167],v[168:171],v[20:23]
v_cvt_pk_bf16_f32 v175,v226,v227
ds_read_b128 a[140:143],v228 offset:1792
v_mfma_f32_16x16x32_bf16 v[24:27],a[168:171],v[168:171],v[24:27]
v_exp_f32 v224,v152
v_mfma_f32_16x16x32_bf16 v[28:31],a[172:175],v[168:171],v[28:31]
v_exp_f32 v225,v153
v_mfma_f32_16x16x32_bf16 v[208:211],a[180:183],v[172:175],v[212:215]
v_xor_b32 v229,6144,v229
s_waitcnt lgkmcnt(2)
v_mfma_f32_16x16x32_bf16 v[128:131],a[112:115],a[32:35],v[188:191]
v_exp_f32 v226,v154
v_mfma_f32_16x16x32_bf16 v[132:135],a[116:119],a[32:35],v[188:191]
v_exp_f32 v227,v155
v_mfma_f32_16x16x32_bf16 v[128:131],a[120:123],a[36:39],v[128:131]
v_cvt_pk_bf16_f32 v176,v224,v225
v_cmp_ngt_f32 vcc,s38,v209
v_mfma_f32_16x16x32_bf16 v[132:135],a[124:127],a[36:39],v[132:135]
s_cbranch_vccnz S_rare_f_9
S_back_f_9:
v_cvt_pk_bf16_f32 v177,v226,v227
v_mfma_f32_16x16x32_bf16 v[128:131],a[128:131],a[40:43],v[128:131]
v_exp_f32 v224,v156
v_mfma_f32_16x16x32_bf16 v[132:135],a[132:135],a[40:43],v[132:135]
v_xor_b32 v230,6144,v230
s_waitcnt lgkmcnt(0)
v_mfma_f32_16x16x32_bf16 v[128:131],a[136:139],a[44:47],v[128:131]
v_exp_f32 v225,v157
v_mfma_f32_16x16x32_bf16 v[132:135],a[140:143],a[44:47],v[132:135]
v_exp_f32 v226,v158
v_mfma_f32_16x16x32_bf16 v[32:35],a[144:147],v[172:175],v[32:35]
v_exp_f32 v227,v159
v_mfma_f32_16x16x32_bf16 v[36:39],a[148:151],v[172:175],v[36:39]
v_cvt_pk_bf16_f32 v178,v224,v225
v_cvt_pk_bf16_f32 v179,v226,v227
v_mfma_f32_16x16x32_bf16 v[40:43],a[152:155],v[172:175],v[40:43]
v_exp_f32 v224,v160
v_mfma_f32_16x16x32_bf16 v[44:47],a[156:159],v[172:175],v[44:47]
v_exp_f32 v225,v161
v_mfma_f32_16x16x32_bf16 v[48:51],a[160:163],v[172:175],v[48:51]
v_exp_f32 v226,v162
v_mfma_f32_16x16x32_bf16 v[52:55],a[164:167],v[172:175],v[52:55]
v_exp_f32 v227,v163
v_mfma_f32_16x16x32_bf16 v[56:59],a[168:171],v[172:175],v[56:59]
v_cvt_pk_bf16_f32 v180,v224,v225
v_cvt_pk_bf16_f32 v181,v226,v227
v_mfma_f32_16x16x32_bf16 v[60:63],a[172:175],v[172:175],v[60:63]
v_exp_f32 v224,v164
v_mfma_f32_16x16x32_bf16 v[212:215],a[184:187],v[176:179],v[208:211]
v_exp_f32 v225,v165
v_mfma_f32_16x16x32_bf16 v[144:147],a[112:115],a[48:51],v[192:195]
v_exp_f32 v226,v166
v_mfma_f32_16x16x32_bf16 v[148:151],a[116:119],a[48:51],v[192:195]
v_exp_f32 v227,v167
v_mfma_f32_16x16x32_bf16 v[144:147],a[120:123],a[52:55],v[144:147]
v_cvt_pk_bf16_f32 v182,v224,v225
v_cvt_pk_bf16_f32 v183,v226,v227
v_mfma_f32_16x16x32_bf16 v[148:151],a[124:127],a[52:55],v[148:151]
v_cmp_ngt_f32 vcc,s38,v214
v_xor_b32 v228,2048,v228
v_mfma_f32_16x16x32_bf16 v[144:147],a[128:131],a[56:59],v[144:147]
s_cbranch_vccnz S_rare_f_10
S_back_f_10:
v_mfma_f32_16x16x32_bf16 v[148:151],a[132:135],a[56:59],v[148:151]
v_exp_f32 v224,v128
v_mfma_f32_16x16x32_bf16 v[144:147],a[136:139],a[60:63],v[144:147]
v_exp_f32 v225,v129
v_mfma_f32_16x16x32_bf16 v[148:151],a[140:143],a[60:63],v[148:151]
v_exp_f32 v226,v130
v_mfma_f32_16x16x32_bf16 v[64:67],a[144:147],v[176:179],v[64:67]
v_exp_f32 v227,v131
v_mfma_f32_16x16x32_bf16 v[68:71],a[148:151],v[176:179],v[68:71]
v_cvt_pk_bf16_f32 v168,v224,v225
v_cvt_pk_bf16_f32 v169,v226,v227
v_mfma_f32_16x16x32_bf16 v[72:75],a[152:155],v[176:179],v[72:75]
v_exp_f32 v224,v132
v_mfma_f32_16x16x32_bf16 v[76:79],a[156:159],v[176:179],v[76:79]
v_exp_f32 v225,v133
v_mfma_f32_16x16x32_bf16 v[80:83],a[160:163],v[176:179],v[80:83]
v_exp_f32 v226,v134
v_mfma_f32_16x16x32_bf16 v[84:87],a[164:167],v[176:179],v[84:87]
v_exp_f32 v227,v135
v_mfma_f32_16x16x32_bf16 v[88:91],a[168:171],v[176:179],v[88:91]
v_cvt_pk_bf16_f32 v170,v224,v225
v_cvt_pk_bf16_f32 v171,v226,v227
v_mfma_f32_16x16x32_bf16 v[92:95],a[172:175],v[176:179],v[92:95]
v_exp_f32 v224,v144
v_mfma_f32_16x16x32_bf16 v[208:211],a[188:191],v[180:183],v[212:215]
v_exp_f32 v225,v145
v_mfma_f32_16x16x32_bf16 v[152:155],a[112:115],a[64:67],v[196:199]
v_exp_f32 v226,v146
v_mfma_f32_16x16x32_bf16 v[156:159],a[116:119],a[64:67],v[196:199]
v_exp_f32 v227,v147
v_mfma_f32_16x16x32_bf16 v[152:155],a[120:123],a[68:71],v[152:155]
v_cvt_pk_bf16_f32 v172,v224,v225
v_cvt_pk_bf16_f32 v173,v226,v227
v_mfma_f32_16x16x32_bf16 v[156:159],a[124:127],a[68:71],v[156:159]
v_cmp_ngt_f32 vcc,s38,v211
v_mfma_f32_16x16x32_bf16 v[152:155],a[128:131],a[72:75],v[152:155]
s_cbranch_vccnz S_rare_f_11
S_back_f_11:
v_mfma_f32_16x16x32_bf16 v[156:159],a[132:135],a[72:75],v[156:159]
v_exp_f32 v224,v148
v_mfma_f32_16x16x32_bf16 v[152:155],a[136:139],a[76:79],v[152:155]
v_exp_f32 v225,v149
v_mfma_f32_16x16x32_bf16 v[156:159],a[140:143],a[76:79],v[156:159]
v_exp_f32 v226,v150
v_mfma_f32_16x16x32_bf16 v[96:99],a[144:147],v[180:183],v[96:99]
ds_read_b64_tr_b16 a[144:145],v229
ds_read_b64_tr_b16 a[146:147],v229 offset:1024
v_mfma_f32_16x16x32_bf16 v[100:103],a[148:151],v[180:183],v[100:103]
ds_read_b64_tr_b16 a[148:149],v230
ds_read_b64_tr_b16 a[150:151],v230 offset:1024
v_mfma_f32_16x16x32_bf16 v[104:107],a[152:155],v[180:183],v[104:107]
ds_read_b64_tr_b16 a[152:153],v229 offset:256
ds_read_b64_tr_b16 a[154:155],v229 offset:1280
v_mfma_f32_16x16x32_bf16 v[108:111],a[156:159],v[180:183],v[108:111]
ds_read_b64_tr_b16 a[156:157],v230 offset:256
ds_read_b64_tr_b16 a[158:159],v230 offset:1280
v_mfma_f32_16x16x32_bf16 v[112:115],a[160:163],v[180:183],v[112:115]
ds_read_b64_tr_b16 a[160:161],v229 offset:512
ds_read_b64_tr_b16 a[162:163],v229 offset:1536
v_mfma_f32_16x16x32_bf16 v[116:119],a[164:167],v[180:183],v[116:119]
ds_read_b64_tr_b16 a[164:165],v230 offset:512
ds_read_b64_tr_b16 a[166:167],v230 offset:1536
v_mfma_f32_16x16x32_bf16 v[120:123],a[168:171],v[180:183],v[120:123]
ds_read_b64_tr_b16 a[168:169],v229 offset:768
ds_read_b64_tr_b16 a[170:171],v229 offset:1792
v_mfma_f32_16x16x32_bf16 v[124:127],a[172:175],v[180:183],v[124:127]
ds_read_b64_tr_b16 a[172:173],v230 offset:768
ds_read_b64_tr_b16 a[174:175],v230 offset:1792
v_mfma_f32_16x16x32_bf16 v[212:215],a[176:179],v[168:171],v[208:211]
v_exp_f32 v227,v151
v_mfma_f32_16x16x32_bf16 v[160:163],a[112:115],a[80:83],v[200:203]
ds_read_b128 a[112:115],v228
v_cvt_pk_bf16_f32 v174,v224,v225
v_mfma_f32_16x16x32_bf16 v[164:167],a[116:119],a[80:83],v[200:203]
ds_read_b128 a[116:119],v228 offset:1024
v_cvt_pk_bf16_f32 v175,v226,v227
v_mfma_f32_16x16x32_bf16 v[160:163],a[120:123],a[84:87],v[160:163]
v_cmp_ngt_f32 vcc,s38,v212
ds_read_b128 a[120:123],v228 offset:256
v_mfma_f32_16x16x32_bf16 v[164:167],a[124:127],a[84:87],v[164:167]
s_cbranch_vccnz S_rare_f_12
S_back_f_12:
ds_read_b128 a[124:127],v228 offset:1280
v_mfma_f32_16x16x32_bf16 v[160:163],a[128:131],a[88:91],v[160:163]
ds_read_b128 a[128:131],v228 offset:512
v_xor_b32 v229,2048,v229
v_mfma_f32_16x16x32_bf16 v[164:167],a[132:135],a[88:91],v[164:167]
ds_read_b128 a[132:135],v228 offset:1536
v_xor_b32 v230,2048,v230
v_mfma_f32_16x16x32_bf16 v[160:163],a[136:139],a[92:95],v[160:163]
v_exp_f32 v224,v152
v_mfma_f32_16x16x32_bf16 v[164:167],a[140:143],a[92:95],v[164:167]
ds_read_b128 a[136:139],v228 offset:768
s_waitcnt lgkmcnt(5)
v_mfma_f32_16x16x32_bf16 v[0:3],a[144:147],v[168:171],v[0:3]
ds_read_b128 a[140:143],v228 offset:1792
s_sub_u32 s35,s48,s46
v_mfma_f32_16x16x32_bf16 v[4:7],a[148:151],v[168:171],v[4:7]
v_exp_f32 v225,v153
v_mfma_f32_16x16x32_bf16 v[8:11],a[152:155],v[168:171],v[8:11]
v_exp_f32 v226,v154
v_mfma_f32_16x16x32_bf16 v[12:15],a[156:159],v[168:171],v[12:15]
v_exp_f32 v227,v155
v_mfma_f32_16x16x32_bf16 v[16:19],a[160:163],v[168:171],v[16:19]
v_cvt_pk_bf16_f32 v176,v224,v225
v_cvt_pk_bf16_f32 v177,v226,v227
v_mfma_f32_16x16x32_bf16 v[20:23],a[164:167],v[168:171],v[20:23]
v_exp_f32 v224,v156
v_mfma_f32_16x16x32_bf16 v[24:27],a[168:171],v[168:171],v[24:27]
v_exp_f32 v225,v157
v_mfma_f32_16x16x32_bf16 v[28:31],a[172:175],v[168:171],v[28:31]
v_exp_f32 v226,v158
v_mfma_f32_16x16x32_bf16 v[208:211],a[180:183],v[172:175],v[212:215]
v_exp_f32 v227,v159
v_mfma_f32_16x16x32_bf16 v[136:139],a[112:115],a[96:99],v[204:207]
v_cvt_pk_bf16_f32 v178,v224,v225
v_cvt_pk_bf16_f32 v179,v226,v227
v_mfma_f32_16x16x32_bf16 v[140:143],a[116:119],a[96:99],v[204:207]
s_add_u32 s35,s35,s42
s_waitcnt lgkmcnt(0)
v_mfma_f32_16x16x32_bf16 v[136:139],a[120:123],a[100:103],v[136:139]
v_cmp_ngt_f32 vcc,s38,v209
v_add_u32 v228,s35,v228
v_mfma_f32_16x16x32_bf16 v[140:143],a[124:127],a[100:103],v[140:143]
s_cbranch_vccnz S_rare_f_13
S_back_f_13:
s_mov_b32 s35,s44
v_mfma_f32_16x16x32_bf16 v[136:139],a[128:131],a[104:107],v[136:139]
v_exp_f32 v224,v160
v_mfma_f32_16x16x32_bf16 v[140:143],a[132:135],a[104:107],v[140:143]
v_exp_f32 v225,v161
v_mfma_f32_16x16x32_bf16 v[136:139],a[136:139],a[108:111],v[136:139]
v_exp_f32 v226,v162
v_mfma_f32_16x16x32_bf16 v[140:143],a[140:143],a[108:111],v[140:143]
v_exp_f32 v227,v163
v_mfma_f32_16x16x32_bf16 v[32:35],a[144:147],v[172:175],v[32:35]
v_cvt_pk_bf16_f32 v180,v224,v225
v_cvt_pk_bf16_f32 v181,v226,v227
v_mfma_f32_16x16x32_bf16 v[36:39],a[148:151],v[172:175],v[36:39]
v_exp_f32 v224,v164
v_mfma_f32_16x16x32_bf16 v[40:43],a[152:155],v[172:175],v[40:43]
v_exp_f32 v225,v165
v_mfma_f32_16x16x32_bf16 v[44:47],a[156:159],v[172:175],v[44:47]
v_exp_f32 v226,v166
v_mfma_f32_16x16x32_bf16 v[48:51],a[160:163],v[172:175],v[48:51]
v_exp_f32 v227,v167
v_mfma_f32_16x16x32_bf16 v[52:55],a[164:167],v[172:175],v[52:55]
v_cvt_pk_bf16_f32 v182,v224,v225
v_cvt_pk_bf16_f32 v183,v226,v227
v_mfma_f32_16x16x32_bf16 v[56:59],a[168:171],v[172:175],v[56:59]
v_exp_f32 v224,v136
v_mfma_f32_16x16x32_bf16 v[60:63],a[172:175],v[172:175],v[60:63]
v_exp_f32 v225,v137
v_mfma_f32_16x16x32_bf16 v[212:215],a[184:187],v[176:179],v[208:211]
v_exp_f32 v226,v138
v_mfma_f32_16x16x32_bf16 v[128:131],a[112:115],a[32:35],v[188:191]
v_exp_f32 v227,v139
v_mfma_f32_16x16x32_bf16 v[132:135],a[116:119],a[32:35],v[188:191]
v_cvt_pk_bf16_f32 v184,v224,v225
v_cvt_pk_bf16_f32 v185,v226,v227
v_mfma_f32_16x16x32_bf16 v[128:131],a[120:123],a[36:39],v[128:131]
v_exp_f32 v224,v140
v_mfma_f32_16x16x32_bf16 v[132:135],a[124:127],a[36:39],v[132:135]
v_cmp_ngt_f32 vcc,s38,v214
s_mov_b32 s28,s45
v_mfma_f32_16x16x32_bf16 v[128:131],a[128:131],a[40:43],v[128:131]
s_cbranch_vccnz S_rare_f_14
S_back_f_14:
s_mov_b32 s44,s46
v_mfma_f32_16x16x32_bf16 v[132:135],a[132:135],a[40:43],v[132:135]
v_exp_f32 v225,v141
v_mfma_f32_16x16x32_bf16 v[128:131],a[136:139],a[44:47],v[128:131]
v_exp_f32 v226,v142
v_mfma_f32_16x16x32_bf16 v[132:135],a[140:143],a[44:47],v[132:135]
v_exp_f32 v227,v143
v_mfma_f32_16x16x32_bf16 v[64:67],a[144:147],v[176:179],v[64:67]
v_cvt_pk_bf16_f32 v186,v224,v225
v_cvt_pk_bf16_f32 v187,v226,v227
v_mfma_f32_16x16x32_bf16 v[68:71],a[148:151],v[176:179],v[68:71]
s_mov_b32 s45,s47
s_mov_b32 s46,s48
v_mfma_f32_16x16x32_bf16 v[72:75],a[152:155],v[176:179],v[72:75]
v_exp_f32 v224,v128
v_mfma_f32_16x16x32_bf16 v[76:79],a[156:159],v[176:179],v[76:79]
v_exp_f32 v225,v129
v_mfma_f32_16x16x32_bf16 v[80:83],a[160:163],v[176:179],v[80:83]
v_exp_f32 v226,v130
v_mfma_f32_16x16x32_bf16 v[84:87],a[164:167],v[176:179],v[84:87]
v_exp_f32 v227,v131
v_mfma_f32_16x16x32_bf16 v[88:91],a[168:171],v[176:179],v[88:91]
v_cvt_pk_bf16_f32 v168,v224,v225
v_cvt_pk_bf16_f32 v169,v226,v227
v_mfma_f32_16x16x32_bf16 v[92:95],a[172:175],v[176:179],v[92:95]
v_exp_f32 v224,v132
v_mfma_f32_16x16x32_bf16 v[208:211],a[188:191],v[180:183],v[212:215]
v_exp_f32 v225,v133
v_mfma_f32_16x16x32_bf16 v[144:147],a[112:115],a[48:51],v[192:195]
v_exp_f32 v226,v134
v_mfma_f32_16x16x32_bf16 v[148:151],a[116:119],a[48:51],v[192:195]
v_exp_f32 v227,v135
v_mfma_f32_16x16x32_bf16 v[144:147],a[120:123],a[52:55],v[144:147]
v_cvt_pk_bf16_f32 v170,v224,v225
v_cvt_pk_bf16_f32 v171,v226,v227
v_mfma_f32_16x16x32_bf16 v[148:151],a[124:127],a[52:55],v[148:151]
v_cmp_ngt_f32 vcc,s38,v211
s_mov_b32 s47,s35
v_mfma_f32_16x16x32_bf16 v[144:147],a[128:131],a[56:59],v[144:147]
s_cbranch_vccnz S_rare_f_15
S_back_f_15:
s_mov_b32 s48,s28
v_mfma_f32_16x16x32_bf16 v[148:151],a[132:135],a[56:59],v[148:151]
s_add_u32 s30,s30,32768
s_add_u32 s36,s36,1
v_mfma_f32_16x16x32_bf16 v[144:147],a[136:139],a[60:63],v[144:147]
s_cmp_lt_u32 s36,7
v_mfma_f32_16x16x32_bf16 v[148:151],a[140:143],a[60:63],v[148:151]
v_mfma_f32_16x16x32_bf16 v[96:99],a[144:147],v[180:183],v[96:99]
ds_read_b64_tr_b16 a[144:145],v229
ds_read_b64_tr_b16 a[146:147],v229 offset:1024
v_mfma_f32_16x16x32_bf16 v[100:103],a[148:151],v[180:183],v[100:103]
ds_read_b64_tr_b16 a[148:149],v230
ds_read_b64_tr_b16 a[150:151],v230 offset:1024
v_mfma_f32_16x16x32_bf16 v[104:107],a[152:155],v[180:183],v[104:107]
ds_read_b64_tr_b16 a[152:153],v229 offset:256
ds_read_b64_tr_b16 a[154:155],v229 offset:1280
v_mfma_f32_16x16x32_bf16 v[108:111],a[156:159],v[180:183],v[108:111]
ds_read_b64_tr_b16 a[156:157],v230 offset:256
ds_read_b64_tr_b16 a[158:159],v230 offset:1280
v_mfma_f32_16x16x32_bf16 v[112:115],a[160:163],v[180:183],v[112:115]
ds_read_b64_tr_b16 a[160:161],v229 offset:512
ds_read_b64_tr_b16 a[162:163],v229 offset:1536
v_mfma_f32_16x16x32_bf16 v[116:119],a[164:167],v[180:183],v[116:119]
v_exp_f32 v224,v144
v_mfma_f32_16x16x32_bf16 v[120:123],a[168:171],v[180:183],v[120:123]
ds_read_b64_tr_b16 a[164:165],v230 offset:512
ds_read_b64_tr_b16 a[166:167],v230 offset:1536
v_mfma_f32_16x16x32_bf16 v[124:127],a[172:175],v[180:183],v[124:127]
v_exp_f32 v225,v145
v_mfma_f32_16x16x32_bf16 v[216:219],a[176:179],v[184:187],v[220:223]
ds_read_b64_tr_b16 a[168:169],v229 offset:768
ds_read_b64_tr_b16 a[170:171],v229 offset:1792
v_mfma_f32_16x16x32_bf16 v[152:155],a[112:115],a[64:67],v[196:199]
v_exp_f32 v226,v146
v_mfma_f32_16x16x32_bf16 v[156:159],a[116:119],a[64:67],v[196:199]
ds_read_b64_tr_b16 a[172:173],v230 offset:768
ds_read_b64_tr_b16 a[174:175],v230 offset:1792
v_mfma_f32_16x16x32_bf16 v[152:155],a[120:123],a[68:71],v[152:155]
v_exp_f32 v227,v147
v_mfma_f32_16x16x32_bf16 v[156:159],a[124:127],a[68:71],v[156:159]
v_cmp_ngt_f32 vcc,s38,v216
v_cvt_pk_bf16_f32 v172,v224,v225
v_mfma_f32_16x16x32_bf16 v[152:155],a[128:131],a[72:75],v[152:155]
s_cbranch_vccnz S_rare_f_16
S_back_f_16:
v_cvt_pk_bf16_f32 v173,v226,v227
v_mfma_f32_16x16x32_bf16 v[156:159],a[132:135],a[72:75],v[156:159]
v_exp_f32 v224,v148
v_mfma_f32_16x16x32_bf16 v[152:155],a[136:139],a[76:79],v[152:155]
v_exp_f32 v225,v149
v_mfma_f32_16x16x32_bf16 v[156:159],a[140:143],a[76:79],v[156:159]
s_waitcnt lgkmcnt(0)
v_mfma_f32_16x16x32_bf16 a[0:3],a[144:147],v[184:187],a[0:3]
v_exp_f32 v226,v150
v_mfma_f32_16x16x32_bf16 a[4:7],a[148:151],v[184:187],a[4:7]
v_exp_f32 v227,v151
v_mfma_f32_16x16x32_bf16 a[8:11],a[152:155],v[184:187],a[8:11]
v_cvt_pk_bf16_f32 v174,v224,v225
v_cvt_pk_bf16_f32 v175,v226,v227
v_mfma_f32_16x16x32_bf16 a[12:15],a[156:159],v[184:187],a[12:15]
v_exp_f32 v224,v152
v_mfma_f32_16x16x32_bf16 a[16:19],a[160:163],v[184:187],a[16:19]
v_exp_f32 v225,v153
v_mfma_f32_16x16x32_bf16 a[20:23],a[164:167],v[184:187],a[20:23]
v_exp_f32 v226,v154
v_mfma_f32_16x16x32_bf16 a[24:27],a[168:171],v[184:187],a[24:27]
v_exp_f32 v227,v155
v_mfma_f32_16x16x32_bf16 a[28:31],a[172:175],v[184:187],a[28:31]
v_cvt_pk_bf16_f32 v176,v224,v225
v_cvt_pk_bf16_f32 v177,v226,v227
v_mfma_f32_16x16x32_bf16 v[212:215],a[176:179],v[168:171],v[208:211]
v_exp_f32 v224,v156
v_mfma_f32_16x16x32_bf16 v[160:163],a[112:115],a[80:83],v[200:203]
v_exp_f32 v225,v157
v_mfma_f32_16x16x32_bf16 v[164:167],a[116:119],a[80:83],v[200:203]
v_exp_f32 v226,v158
v_mfma_f32_16x16x32_bf16 v[160:163],a[120:123],a[84:87],v[160:163]
v_exp_f32 v227,v159
v_mfma_f32_16x16x32_bf16 v[164:167],a[124:127],a[84:87],v[164:167]
v_cmp_ngt_f32 vcc,s38,v212
v_cvt_pk_bf16_f32 v178,v224,v225
v_mfma_f32_16x16x32_bf16 v[160:163],a[128:131],a[88:91],v[160:163]
v_cvt_pk_bf16_f32 v179,v226,v227
s_cbranch_vccnz S_rare_f_17
S_back_f_17:
v_mfma_f32_16x16x32_bf16 v[164:167],a[132:135],a[88:91],v[164:167]
v_mfma_f32_16x16x32_bf16 v[160:163],a[136:139],a[92:95],v[160:163]
v_mfma_f32_16x16x32_bf16 v[164:167],a[140:143],a[92:95],v[164:167]
s_waitcnt vmcnt(8) lgkmcnt(0)
s_barrier
S_loop:
v_mfma_f32_16x16x32_bf16 v[0:3],a[144:147],v[168:171],v[0:3]
ds_read_b128 a[112:115],v228
ds_read_b128 a[116:119],v228 offset:1024
v_mfma_f32_16x16x32_bf16 v[4:7],a[148:151],v[168:171],v[4:7]
ds_read_b128 a[120:123],v228 offset:256
ds_read_b128 a[124:127],v228 offset:1280
v_mfma_f32_16x16x32_bf16 v[8:11],a[152:155],v[168:171],v[8:11]
ds_read_b128 a[128:131],v228 offset:512
ds_read_b128 a[132:135],v228 offset:1536
v_mfma_f32_16x16x32_bf16 v[12:15],a[156:159],v[168:171],v[12:15]
ds_read_b128 a[136:139],v228 offset:768
ds_read_b128 a[140:143],v228 offset:1792
v_mfma_f32_16x16x32_bf16 v[16:19],a[160:163],v[168:171],v[16:19]
s_add_u32 m0,s44,0
s_add_u32 s34,s30,0
v_mfma_f32_16x16x32_bf16 v[20:23],a[164:167],v[168:171],v[20:23]
s_sub_u32 s29,s47,s45
s_add_u32 s29,s29,s42
v_mfma_f32_16x16x32_bf16 v[24:27],a[168:171],v[168:171],v[24:27]
v_add_u32 v229,s29,v229
v_add_u32 v230,s29,v230
v_mfma_f32_16x16x32_bf16 v[28:31],a[172:175],v[168:171],v[28:31]
v_exp_f32 v224,v160
v_mfma_f32_16x16x32_bf16 v[208:211],a[180:183],v[172:175],v[212:215]
v_xor_b32 v228,2048,v228
s_waitcnt lgkmcnt(2)
v_mfma_f32_16x16x32_bf16 v[128:131],a[112:115],a[32:35],v[188:191]
buffer_load_dwordx4 v231,s[20:23],s34 offen nt lds
v_mfma_f32_16x16x32_bf16 v[132:135],a[116:119],a[32:35],v[188:191]
v_exp_f32 v225,v161
v_mfma_f32_16x16x32_bf16 v[128:131],a[120:123],a[36:39],v[128:131]
v_exp_f32 v226,v162
v_mfma_f32_16x16x32_bf16 v[132:135],a[124:127],a[36:39],v[132:135]
v_cmp_ngt_f32 vcc,s38,v209
v_mfma_f32_16x16x32_bf16 v[128:131],a[128:131],a[40:43],v[128:131]
s_cbranch_vccnz S_rare_l_0
S_back_l_0:
v_mfma_f32_16x16x32_bf16 v[132:135],a[132:135],a[40:43],v[132:135]
s_waitcnt lgkmcnt(0)
v_mfma_f32_16x16x32_bf16 v[128:131],a[136:139],a[44:47],v[128:131]
buffer_load_dwordx4 v231,s[20:23],s34 offen offset:1024 nt lds
v_mfma_f32_16x16x32_bf16 v[132:135],a[140:143],a[44:47],v[132:135]
v_exp_f32 v227,v163
v_mfma_f32_16x16x32_bf16 v[32:35],a[144:147],v[172:175],v[32:35]
v_cvt_pk_bf16_f32 v180,v224,v225
v_cvt_pk_bf16_f32 v181,v226,v227
v_mfma_f32_16x16x32_bf16 v[36:39],a[148:151],v[172:175],v[36:39]
v_exp_f32 v224,v164
v_mfma_f32_16x16x32_bf16 v[40:43],a[152:155],v[172:175],v[40:43]
buffer_load_dwordx4 v231,s[20:23],s34 offen offset:2048 nt lds
v_mfma_f32_16x16x32_bf16 v[44:47],a[156:159],v[172:175],v[44:47]
v_exp_f32 v225,v165
v_mfma_f32_16x16x32_bf16 v[48:51],a[160:163],v[172:175],v[48:51]
v_exp_f32 v226,v166
v_mfma_f32_16x16x32_bf16 v[52:55],a[164:167],v[172:175],v[52:55]
v_exp_f32 v227,v167
v_mfma_f32_16x16x32_bf16 v[56:59],a[168:171],v[172:175],v[56:59]
v_cvt_pk_bf16_f32 v182,v224,v225
v_cvt_pk_bf16_f32 v183,v226,v227
v_mfma_f32_16x16x32_bf16 v[60:63],a[172:175],v[172:175],v[60:63]
buffer_load_dwordx4 v231,s[20:23],s34 offen offset:3072 nt lds
v_mfma_f32_16x16x32_bf16 v[212:215],a[184:187],v[176:179],v[208:211]
s_add_u32 m0,s44,4096
s_add_u32 s34,s30,4096
v_mfma_f32_16x16x32_bf16 v[144:147],a[112:115],a[48:51],v[192:195]
v_exp_f32 v224,v128
v_mfma_f32_16x16x32_bf16 v[148:151],a[116:119],a[48:51],v[192:195]
v_exp_f32 v225,v129
v_mfma_f32_16x16x32_bf16 v[144:147],a[120:123],a[52:55],v[144:147]
v_exp_f32 v226,v130
v_mfma_f32_16x16x32_bf16 v[148:151],a[124:127],a[52:55],v[148:151]
buffer_load_dwordx4 v231,s[20:23],s34 offen nt lds
v_mfma_f32_16x16x32_bf16 v[144:147],a[128:131],a[56:59],v[144:147]
v_cmp_ngt_f32 vcc,s38,v214
v_mfma_f32_16x16x32_bf16 v[148:151],a[132:135],a[56:59],v[148:151]
s_cbranch_vccnz S_rare_l_1
S_back_l_1:
v_mfma_f32_16x16x32_bf16 v[144:147],a[136:139],a[60:63],v[144:147]
v_exp_f32 v227,v131
v_mfma_f32_16x16x32_bf16 v[148:151],a[140:143],a[60:63],v[148:151]
v_cvt_pk_bf16_f32 v168,v224,v225
v_cvt_pk_bf16_f32 v169,v226,v227
v_mfma_f32_16x16x32_bf16 v[64:67],a[144:147],v[176:179],v[64:67]
buffer_load_dwordx4 v231,s[20:23],s34 offen offset:1024 nt lds
v_mfma_f32_16x16x32_bf16 v[68:71],a[148:151],v[176:179],v[68:71]
v_exp_f32 v224,v132
v_mfma_f32_16x16x32_bf16 v[72:75],a[152:155],v[176:179],v[72:75]
v_exp_f32 v225,v133
v_mfma_f32_16x16x32_bf16 v[76:79],a[156:159],v[176:179],v[76:79]
v_exp_f32 v226,v134
v_mfma_f32_16x16x32_bf16 v[80:83],a[160:163],v[176:179],v[80:83]
v_exp_f32 v227,v135
v_mfma_f32_16x16x32_bf16 v[84:87],a[164:167],v[176:179],v[84:87]
buffer_load_dwordx4 v231,s[20:23],s34 offen offset:2048 nt lds
v_mfma_f32_16x16x32_bf16 v[88:91],a[168:171],v[176:179],v[88:91]
v_cvt_pk_bf16_f32 v170,v224,v225
v_cvt_pk_bf16_f32 v171,v226,v227
v_mfma_f32_16x16x32_bf16 v[92:95],a[172:175],v[176:179],v[92:95]
v_exp_f32 v224,v144
v_mfma_f32_16x16x32_bf16 v[208:211],a[188:191],v[180:183],v[212:215]
v_exp_f32 v225,v145
v_mfma_f32_16x16x32_bf16 v[152:155],a[112:115],a[64:67],v[196:199]
v_exp_f32 v226,v146
v_mfma_f32_16x16x32_bf16 v[156:159],a[116:119],a[64:67],v[196:199]
buffer_load_dwordx4 v231,s[20:23],s34 offen offset:3072 nt lds
v_mfma_f32_16x16x32_bf16 v[152:155],a[120:123],a[68:71],v[152:155]
s_add_u32 m0,s45,0
s_add_u32 s34,s30,32768
v_mfma_f32_16x16x32_bf16 v[156:159],a[124:127],a[68:71],v[156:159]
v_cmp_ngt_f32 vcc,s38,v211
v_mfma_f32_16x16x32_bf16 v[152:155],a[128:131],a[72:75],v[152:155]
s_cbranch_vccnz S_rare_l_2
S_back_l_2:
v_mfma_f32_16x16x32_bf16 v[156:159],a[132:135],a[72:75],v[156:159]
v_exp_f32 v227,v147
v_mfma_f32_16x16x32_bf16 v[152:155],a[136:139],a[76:79],v[152:155]
buffer_load_dwordx4 v231,s[16:19],s34 offen nt lds
v_mfma_f32_16x16x32_bf16 v[156:159],a[140:143],a[76:79],v[156:159]
v_cvt_pk_bf16_f32 v172,v224,v225
v_cvt_pk_bf16_f32 v173,v226,v227
v_mfma_f32_16x16x32_bf16 v[96:99],a[144:147],v[180:183],v[96:99]
ds_read_b64_tr_b16 a[144:145],v229
ds_read_b64_tr_b16 a[146:147],v229 offset:1024
v_mfma_f32_16x16x32_bf16 v[100:103],a[148:151],v[180:183],v[100:103]
ds_read_b64_tr_b16 a[148:149],v230
ds_read_b64_tr_b16 a[150:151],v230 offset:1024
v_mfma_f32_16x16x32_bf16 v[104:107],a[152:155],v[180:183],v[104:107]
ds_read_b64_tr_b16 a[152:153],v229 offset:256
ds_read_b64_tr_b16 a[154:155],v229 offset:1280
v_mfma_f32_16x16x32_bf16 v[108:111],a[156:159],v[180:183],v[108:111]
buffer_load_dwordx4 v231,s[16:19],s34 offen offset:1024 nt lds
v_mfma_f32_16x16x32_bf16 v[112:115],a[160:163],v[180:183],v[112:115]
ds_read_b64_tr_b16 a[156:157],v230 offset:256
ds_read_b64_tr_b16 a[158:159],v230 offset:1280
v_mfma_f32_16x16x32_bf16 v[116:119],a[164:167],v[180:183],v[116:119]
ds_read_b64_tr_b16 a[160:161],v229 offset:512
ds_read_b64_tr_b16 a[162:163],v229 offset:1536
v_mfma_f32_16x16x32_bf16 v[120:123],a[168:171],v[180:183],v[120:123]
ds_read_b64_tr_b16 a[164:165],v230 offset:512
ds_read_b64_tr_b16 a[166:167],v230 offset:1536
v_mfma_f32_16x16x32_bf16 v[124:127],a[172:175],v[180:183],v[124:127]
ds_read_b64_tr_b16 a[168:169],v229 offset:768
ds_read_b64_tr_b16 a[170:171],v229 offset:1792
v_mfma_f32_16x16x32_bf16 v[212:215],a[176:179],v[168:171],v[208:211]
buffer_load_dwordx4 v231,s[16:19],s34 offen offset:2048 nt lds
v_mfma_f32_16x16x32_bf16 v[160:163],a[112:115],a[80:83],v[200:203]
ds_read_b64_tr_b16 a[172:173],v230 offset:768
ds_read_b64_tr_b16 a[174:175],v230 offset:1792
v_mfma_f32_16x16x32_bf16 v[164:167],a[116:119],a[80:83],v[200:203]
ds_read_b128 a[112:115],v228
ds_read_b128 a[116:119],v228 offset:1024
v_mfma_f32_16x16x32_bf16 v[160:163],a[120:123],a[84:87],v[160:163]
v_cmp_ngt_f32 vcc,s38,v212
ds_read_b128 a[120:123],v228 offset:256
v_mfma_f32_16x16x32_bf16 v[164:167],a[124:127],a[84:87],v[164:167]
s_cbranch_vccnz S_rare_l_3
S_back_l_3:
ds_read_b128 a[124:127],v228 offset:1280
v_mfma_f32_16x16x32_bf16 v[160:163],a[128:131],a[88:91],v[160:163]
buffer_load_dwordx4 v231,s[16:19],s34 offen offset:3072 nt lds
v_mfma_f32_16x16x32_bf16 v[164:167],a[132:135],a[88:91],v[164:167]
s_add_u32 m0,s45,4096
s_add_u32 s34,s30,36864
v_mfma_f32_16x16x32_bf16 v[160:163],a[136:139],a[92:95],v[160:163]
v_exp_f32 v224,v148
v_mfma_f32_16x16x32_bf16 v[164:167],a[140:143],a[92:95],v[164:167]
ds_read_b128 a[128:131],v228 offset:512
s_waitcnt lgkmcnt(3)
v_mfma_f32_16x16x32_bf16 v[0:3],a[144:147],v[168:171],v[0:3]
v_exp_f32 v225,v149
v_mfma_f32_16x16x32_bf16 v[4:7],a[148:151],v[168:171],v[4:7]
buffer_load_dwordx4 v231,s[16:19],s34 offen nt lds
v_mfma_f32_16x16x32_bf16 v[8:11],a[152:155],v[168:171],v[8:11]
v_exp_f32 v226,v150
v_mfma_f32_16x16x32_bf16 v[12:15],a[156:159],v[168:171],v[12:15]
ds_read_b128 a[132:135],v228 offset:1536
ds_read_b128 a[136:139],v228 offset:768
v_mfma_f32_16x16x32_bf16 v[16:19],a[160:163],v[168:171],v[16:19]
v_exp_f32 v227,v151
v_mfma_f32_16x16x32_bf16 v[20:23],a[164:167],v[168:171],v[20:23]
v_cvt_pk_bf16_f32 v174,v224,v225
v_cvt_pk_bf16_f32 v175,v226,v227
v_mfma_f32_16x16x32_bf16 v[24:27],a[168:171],v[168:171],v[24:27]
ds_read_b128 a[140:143],v228 offset:1792
v_xor_b32 v229,2048,v229
v_mfma_f32_16x16x32_bf16 v[28:31],a[172:175],v[168:171],v[28:31]
buffer_load_dwordx4 v231,s[16:19],s34 offen offset:1024 nt lds
v_mfma_f32_16x16x32_bf16 v[208:211],a[180:183],v[172:175],v[212:215]
v_exp_f32 v224,v152
v_mfma_f32_16x16x32_bf16 v[136:139],a[112:115],a[96:99],v[204:207]
v_exp_f32 v225,v153
v_mfma_f32_16x16x32_bf16 v[140:143],a[116:119],a[96:99],v[204:207]
v_xor_b32 v230,2048,v230
s_waitcnt lgkmcnt(1)
v_mfma_f32_16x16x32_bf16 v[136:139],a[120:123],a[100:103],v[136:139]
buffer_load_dwordx4 v231,s[16:19],s34 offen offset:2048 nt lds
v_mfma_f32_16x16x32_bf16 v[140:143],a[124:127],a[100:103],v[140:143]
v_cmp_ngt_f32 vcc,s38,v209
v_xor_b32 v228,6144,v228
v_mfma_f32_16x16x32_bf16 v[136:139],a[128:131],a[104:107],v[136:139]
v_exp_f32 v226,v154
v_mfma_f32_16x16x32_bf16 v[140:143],a[132:135],a[104:107],v[140:143]
s_cbranch_vccnz S_rare_l_4
S_back_l_4:
v_mfma_f32_16x16x32_bf16 v[136:139],a[136:139],a[108:111],v[136:139]
s_waitcnt lgkmcnt(0)
v_mfma_f32_16x16x32_bf16 v[140:143],a[140:143],a[108:111],v[140:143]
v_exp_f32 v227,v155
v_mfma_f32_16x16x32_bf16 v[32:35],a[144:147],v[172:175],v[32:35]
v_cvt_pk_bf16_f32 v176,v224,v225
v_cvt_pk_bf16_f32 v177,v226,v227
v_mfma_f32_16x16x32_bf16 v[36:39],a[148:151],v[172:175],v[36:39]
buffer_load_dwordx4 v231,s[16:19],s34 offen offset:3072 nt lds
v_mfma_f32_16x16x32_bf16 v[40:43],a[152:155],v[172:175],v[40:43]
v_exp_f32 v224,v156
v_mfma_f32_16x16x32_bf16 v[44:47],a[156:159],v[172:175],v[44:47]
v_exp_f32 v225,v157
v_mfma_f32_16x16x32_bf16 v[48:51],a[160:163],v[172:175],v[48:51]
v_exp_f32 v226,v158
v_mfma_f32_16x16x32_bf16 v[52:55],a[164:167],v[172:175],v[52:55]
v_exp_f32 v227,v159
v_mfma_f32_16x16x32_bf16 v[56:59],a[168:171],v[172:175],v[56:59]
v_cvt_pk_bf16_f32 v178,v224,v225
v_cvt_pk_bf16_f32 v179,v226,v227
v_mfma_f32_16x16x32_bf16 v[60:63],a[172:175],v[172:175],v[60:63]
v_exp_f32 v224,v160
v_mfma_f32_16x16x32_bf16 v[212:215],a[184:187],v[176:179],v[208:211]
v_exp_f32 v225,v161
v_mfma_f32_16x16x32_bf16 v[128:131],a[112:115],a[32:35],v[188:191]
v_exp_f32 v226,v162
v_mfma_f32_16x16x32_bf16 v[132:135],a[116:119],a[32:35],v[188:191]
v_exp_f32 v227,v163
v_mfma_f32_16x16x32_bf16 v[128:131],a[120:123],a[36:39],v[128:131]
v_cvt_pk_bf16_f32 v180,v224,v225
v_cvt_pk_bf16_f32 v181,v226,v227
v_mfma_f32_16x16x32_bf16 v[132:135],a[124:127],a[36:39],v[132:135]
v_cmp_ngt_f32 vcc,s38,v214
v_mfma_f32_16x16x32_bf16 v[128:131],a[128:131],a[40:43],v[128:131]
s_cbranch_vccnz S_rare_l_5
S_back_l_5:
v_mfma_f32_16x16x32_bf16 v[132:135],a[132:135],a[40:43],v[132:135]
v_exp_f32 v224,v164
v_mfma_f32_16x16x32_bf16 v[128:131],a[136:139],a[44:47],v[128:131]
v_exp_f32 v225,v165
v_mfma_f32_16x16x32_bf16 v[132:135],a[140:143],a[44:47],v[132:135]
v_exp_f32 v226,v166
v_mfma_f32_16x16x32_bf16 v[64:67],a[144:147],v[176:179],v[64:67]
v_exp_f32 v227,v167
v_mfma_f32_16x16x32_bf16 v[68:71],a[148:151],v[176:179],v[68:71]
v_cvt_pk_bf16_f32 v182,v224,v225
v_cvt_pk_bf16_f32 v183,v226,v227
v_mfma_f32_16x16x32_bf16 v[72:75],a[152:155],v[176:179],v[72:75]
v_exp_f32 v224,v136
v_mfma_f32_16x16x32_bf16 v[76:79],a[156:159],v[176:179],v[76:79]
v_exp_f32 v225,v137
v_mfma_f32_16x16x32_bf16 v[80:83],a[160:163],v[176:179],v[80:83]
v_exp_f32 v226,v138
v_mfma_f32_16x16x32_bf16 v[84:87],a[164:167],v[176:179],v[84:87]
v_exp_f32 v227,v139
v_mfma_f32_16x16x32_bf16 v[88:91],a[168:171],v[176:179],v[88:91]
v_cvt_pk_bf16_f32 v184,v224,v225
v_cvt_pk_bf16_f32 v185,v226,v227
v_mfma_f32_16x16x32_bf16 v[92:95],a[172:175],v[176:179],v[92:95]
v_exp_f32 v224,v140
v_mfma_f32_16x16x32_bf16 v[208:211],a[188:191],v[180:183],v[212:215]
v_exp_f32 v225,v141
v_mfma_f32_16x16x32_bf16 v[144:147],a[112:115],a[48:51],v[192:195]
v_exp_f32 v226,v142
v_mfma_f32_16x16x32_bf16 v[148:151],a[116:119],a[48:51],v[192:195]
v_exp_f32 v227,v143
v_mfma_f32_16x16x32_bf16 v[144:147],a[120:123],a[52:55],v[144:147]
v_cvt_pk_bf16_f32 v186,v224,v225
v_cvt_pk_bf16_f32 v187,v226,v227
v_mfma_f32_16x16x32_bf16 v[148:151],a[124:127],a[52:55],v[148:151]
v_cmp_ngt_f32 vcc,s38,v211
v_mfma_f32_16x16x32_bf16 v[144:147],a[128:131],a[56:59],v[144:147]
s_cbranch_vccnz S_rare_l_6
S_back_l_6:
v_mfma_f32_16x16x32_bf16 v[148:151],a[132:135],a[56:59],v[148:151]
v_exp_f32 v224,v128
v_mfma_f32_16x16x32_bf16 v[144:147],a[136:139],a[60:63],v[144:147]
v_exp_f32 v225,v129
v_mfma_f32_16x16x32_bf16 v[148:151],a[140:143],a[60:63],v[148:151]
v_exp_f32 v226,v130
v_mfma_f32_16x16x32_bf16 v[96:99],a[144:147],v[180:183],v[96:99]
ds_read_b64_tr_b16 a[144:145],v229
ds_read_b64_tr_b16 a[146:147],v229 offset:1024
v_mfma_f32_16x16x32_bf16 v[100:103],a[148:151],v[180:183],v[100:103]
ds_read_b64_tr_b16 a[148:149],v230
ds_read_b64_tr_b16 a[150:151],v230 offset:1024
v_mfma_f32_16x16x32_bf16 v[104:107],a[152:155],v[180:183],v[104:107]
ds_read_b64_tr_b16 a[152:153],v229 offset:256
ds_read_b64_tr_b16 a[154:155],v229 offset:1280
v_mfma_f32_16x16x32_bf16 v[108:111],a[156:159],v[180:183],v[108:111]
ds_read_b64_tr_b16 a[156:157],v230 offset:256
ds_read_b64_tr_b16 a[158:159],v230 offset:1280
v_mfma_f32_16x16x32_bf16 v[112:115],a[160:163],v[180:183],v[112:115]
ds_read_b64_tr_b16 a[160:161],v229 offset:512
ds_read_b64_tr_b16 a[162:163],v229 offset:1536
v_mfma_f32_16x16x32_bf16 v[116:119],a[164:167],v[180:183],v[116:119]
ds_read_b64_tr_b16 a[164:165],v230 offset:512
ds_read_b64_tr_b16 a[166:167],v230 offset:1536
v_mfma_f32_16x16x32_bf16 v[120:123],a[168:171],v[180:183],v[120:123]
ds_read_b64_tr_b16 a[168:169],v229 offset:768
ds_read_b64_tr_b16 a[170:171],v229 offset:1792
v_mfma_f32_16x16x32_bf16 v[124:127],a[172:175],v[180:183],v[124:127]
ds_read_b64_tr_b16 a[172:173],v230 offset:768
ds_read_b64_tr_b16 a[174:175],v230 offset:1792
v_mfma_f32_16x16x32_bf16 v[220:223],a[176:179],v[184:187],v[216:219]
v_exp_f32 v227,v131
v_mfma_f32_16x16x32_bf16 v[152:155],a[112:115],a[64:67],v[196:199]
v_cvt_pk_bf16_f32 v168,v224,v225
v_cvt_pk_bf16_f32 v169,v226,v227
v_mfma_f32_16x16x32_bf16 v[156:159],a[116:119],a[64:67],v[196:199]
v_exp_f32 v224,v132
v_mfma_f32_16x16x32_bf16 v[152:155],a[120:123],a[68:71],v[152:155]
v_exp_f32 v225,v133
v_mfma_f32_16x16x32_bf16 v[156:159],a[124:127],a[68:71],v[156:159]
v_cmp_ngt_f32 vcc,s38,v220
v_xor_b32 v229,6144,v229
v_mfma_f32_16x16x32_bf16 v[152:155],a[128:131],a[72:75],v[152:155]
s_cbranch_vccnz S_rare_l_7
S_back_l_7:
v_xor_b32 v230,6144,v230
v_mfma_f32_16x16x32_bf16 v[156:159],a[132:135],a[72:75],v[156:159]
v_exp_f32 v226,v134
v_mfma_f32_16x16x32_bf16 v[152:155],a[136:139],a[76:79],v[152:155]
v_exp_f32 v227,v135
v_mfma_f32_16x16x32_bf16 v[156:159],a[140:143],a[76:79],v[156:159]
v_cvt_pk_bf16_f32 v170,v224,v225
s_waitcnt lgkmcnt(0)
v_mfma_f32_16x16x32_bf16 a[0:3],a[144:147],v[184:187],a[0:3]
v_cvt_pk_bf16_f32 v171,v226,v227
v_mfma_f32_16x16x32_bf16 a[4:7],a[148:151],v[184:187],a[4:7]
v_exp_f32 v224,v144
v_mfma_f32_16x16x32_bf16 a[8:11],a[152:155],v[184:187],a[8:11]
v_exp_f32 v225,v145
v_mfma_f32_16x16x32_bf16 a[12:15],a[156:159],v[184:187],a[12:15]
v_exp_f32 v226,v146
v_mfma_f32_16x16x32_bf16 a[16:19],a[160:163],v[184:187],a[16:19]
v_exp_f32 v227,v147
v_mfma_f32_16x16x32_bf16 a[20:23],a[164:167],v[184:187],a[20:23]
v_cvt_pk_bf16_f32 v172,v224,v225
v_cvt_pk_bf16_f32 v173,v226,v227
v_mfma_f32_16x16x32_bf16 a[24:27],a[168:171],v[184:187],a[24:27]
v_exp_f32 v224,v148
v_mfma_f32_16x16x32_bf16 a[28:31],a[172:175],v[184:187],a[28:31]
v_exp_f32 v225,v149
v_mfma_f32_16x16x32_bf16 v[212:215],a[176:179],v[168:171],v[208:211]
v_exp_f32 v226,v150
v_mfma_f32_16x16x32_bf16 v[160:163],a[112:115],a[80:83],v[200:203]
v_exp_f32 v227,v151
v_mfma_f32_16x16x32_bf16 v[164:167],a[116:119],a[80:83],v[200:203]
ds_read_b128 a[112:115],v228
ds_read_b128 a[116:119],v228 offset:1024
v_mfma_f32_16x16x32_bf16 v[160:163],a[120:123],a[84:87],v[160:163]
ds_read_b128 a[120:123],v228 offset:256
v_cmp_ngt_f32 vcc,s38,v212
v_mfma_f32_16x16x32_bf16 v[164:167],a[124:127],a[84:87],v[164:167]
s_cbranch_vccnz S_rare_l_8
S_back_l_8:
ds_read_b128 a[124:127],v228 offset:1280
v_mfma_f32_16x16x32_bf16 v[160:163],a[128:131],a[88:91],v[160:163]
ds_read_b128 a[128:131],v228 offset:512
v_cvt_pk_bf16_f32 v174,v224,v225
v_mfma_f32_16x16x32_bf16 v[164:167],a[132:135],a[88:91],v[164:167]
ds_read_b128 a[132:135],v228 offset:1536
v_cvt_pk_bf16_f32 v175,v226,v227
v_mfma_f32_16x16x32_bf16 v[160:163],a[136:139],a[92:95],v[160:163]
v_exp_f32 v224,v152
v_mfma_f32_16x16x32_bf16 v[164:167],a[140:143],a[92:95],v[164:167]
ds_read_b128 a[136:139],v228 offset:768
ds_read_b128 a[140:143],v228 offset:1792
v_mfma_f32_16x16x32_bf16 v[0:3],a[144:147],v[168:171],v[0:3]
v_exp_f32 v225,v153
v_mfma_f32_16x16x32_bf16 v[4:7],a[148:151],v[168:171],v[4:7]
v_exp_f32 v226,v154
v_mfma_f32_16x16x32_bf16 v[8:11],a[152:155],v[168:171],v[8:11]
v_exp_f32 v227,v155
v_mfma_f32_16x16x32_bf16 v[12:15],a[156:159],v[168:171],v[12:15]
v_cvt_pk_bf16_f32 v176,v224,v225
v_cvt_pk_bf16_f32 v177,v226,v227
v_mfma_f32_16x16x32_bf16 v[16:19],a[160:163],v[168:171],v[16:19]
v_exp_f32 v224,v156
v_mfma_f32_16x16x32_bf16 v[20:23],a[164:167],v[168:171],v[20:23]
v_exp_f32 v225,v157
v_mfma_f32_16x16x32_bf16 v[24:27],a[168:171],v[168:171],v[24:27]
v_exp_f32 v226,v158
v_mfma_f32_16x16x32_bf16 v[28:31],a[172:175],v[168:171],v[28:31]
v_exp_f32 v227,v159
v_mfma_f32_16x16x32_bf16 v[208:211],a[180:183],v[172:175],v[212:215]
v_cvt_pk_bf16_f32 v178,v224,v225
s_waitcnt lgkmcnt(0)
v_mfma_f32_16x16x32_bf16 v[128:131],a[112:115],a[32:35],v[188:191]
v_cvt_pk_bf16_f32 v179,v226,v227
v_xor_b32 v228,2048,v228
v_mfma_f32_16x16x32_bf16 v[132:135],a[116:119],a[32:35],v[188:191]
v_exp_f32 v224,v160
v_mfma_f32_16x16x32_bf16 v[128:131],a[120:123],a[36:39],v[128:131]
v_exp_f32 v225,v161
v_mfma_f32_16x16x32_bf16 v[132:135],a[124:127],a[36:39],v[132:135]
v_cmp_ngt_f32 vcc,s38,v209
v_mfma_f32_16x16x32_bf16 v[128:131],a[128:131],a[40:43],v[128:131]
s_cbranch_vccnz S_rare_l_9
S_back_l_9:
v_mfma_f32_16x16x32_bf16 v[132:135],a[132:135],a[40:43],v[132:135]
v_exp_f32 v226,v162
v_mfma_f32_16x16x32_bf16 v[128:131],a[136:139],a[44:47],v[128:131]
v_exp_f32 v227,v163
v_mfma_f32_16x16x32_bf16 v[132:135],a[140:143],a[44:47],v[132:135]
v_cvt_pk_bf16_f32 v180,v224,v225
v_cvt_pk_bf16_f32 v181,v226,v227
v_mfma_f32_16x16x32_bf16 v[32:35],a[144:147],v[172:175],v[32:35]
v_exp_f32 v224,v164
v_mfma_f32_16x16x32_bf16 v[36:39],a[148:151],v[172:175],v[36:39]
v_exp_f32 v225,v165
v_mfma_f32_16x16x32_bf16 v[40:43],a[152:155],v[172:175],v[40:43]
v_exp_f32 v226,v166
v_mfma_f32_16x16x32_bf16 v[44:47],a[156:159],v[172:175],v[44:47]
v_exp_f32 v227,v167
v_mfma_f32_16x16x32_bf16 v[48:51],a[160:163],v[172:175],v[48:51]
v_cvt_pk_bf16_f32 v182,v224,v225
v_cvt_pk_bf16_f32 v183,v226,v227
v_mfma_f32_16x16x32_bf16 v[52:55],a[164:167],v[172:175],v[52:55]
v_exp_f32 v224,v128
v_mfma_f32_16x16x32_bf16 v[56:59],a[168:171],v[172:175],v[56:59]
v_exp_f32 v225,v129
v_mfma_f32_16x16x32_bf16 v[60:63],a[172:175],v[172:175],v[60:63]
v_exp_f32 v226,v130
v_mfma_f32_16x16x32_bf16 v[212:215],a[184:187],v[176:179],v[208:211]
v_exp_f32 v227,v131
v_mfma_f32_16x16x32_bf16 v[144:147],a[112:115],a[48:51],v[192:195]
v_cvt_pk_bf16_f32 v168,v224,v225
v_cvt_pk_bf16_f32 v169,v226,v227
v_mfma_f32_16x16x32_bf16 v[148:151],a[116:119],a[48:51],v[192:195]
v_exp_f32 v224,v132
v_mfma_f32_16x16x32_bf16 v[144:147],a[120:123],a[52:55],v[144:147]
v_exp_f32 v225,v133
v_mfma_f32_16x16x32_bf16 v[148:151],a[124:127],a[52:55],v[148:151]
v_cmp_ngt_f32 vcc,s38,v214
v_mfma_f32_16x16x32_bf16 v[144:147],a[128:131],a[56:59],v[144:147]
s_cbranch_vccnz S_rare_l_10
S_back_l_10:
v_mfma_f32_16x16x32_bf16 v[148:151],a[132:135],a[56:59],v[148:151]
v_exp_f32 v226,v134
v_mfma_f32_16x16x32_bf16 v[144:147],a[136:139],a[60:63],v[144:147]
v_exp_f32 v227,v135
v_mfma_f32_16x16x32_bf16 v[148:151],a[140:143],a[60:63],v[148:151]
v_cvt_pk_bf16_f32 v170,v224,v225
v_cvt_pk_bf16_f32 v171,v226,v227
v_mfma_f32_16x16x32_bf16 v[64:67],a[144:147],v[176:179],v[64:67]
v_mfma_f32_16x16x32_bf16 v[68:71],a[148:151],v[176:179],v[68:71]
v_mfma_f32_16x16x32_bf16 v[72:75],a[152:155],v[176:179],v[72:75]
v_mfma_f32_16x16x32_bf16 v[76:79],a[156:159],v[176:179],v[76:79]
v_exp_f32 v224,v144
v_mfma_f32_16x16x32_bf16 v[80:83],a[160:163],v[176:179],v[80:83]
v_exp_f32 v225,v145
v_mfma_f32_16x16x32_bf16 v[84:87],a[164:167],v[176:179],v[84:87]
v_exp_f32 v226,v146
v_mfma_f32_16x16x32_bf16 v[88:91],a[168:171],v[176:179],v[88:91]
v_exp_f32 v227,v147
v_mfma_f32_16x16x32_bf16 v[92:95],a[172:175],v[176:179],v[92:95]
v_cvt_pk_bf16_f32 v172,v224,v225
v_cvt_pk_bf16_f32 v173,v226,v227
v_mfma_f32_16x16x32_bf16 v[208:211],a[188:191],v[180:183],v[212:215]
v_exp_f32 v224,v148
v_mfma_f32_16x16x32_bf16 v[152:155],a[112:115],a[64:67],v[196:199]
v_exp_f32 v225,v149
v_mfma_f32_16x16x32_bf16 v[156:159],a[116:119],a[64:67],v[196:199]
v_exp_f32 v226,v150
v_mfma_f32_16x16x32_bf16 v[152:155],a[120:123],a[68:71],v[152:155]
v_exp_f32 v227,v151
v_mfma_f32_16x16x32_bf16 v[156:159],a[124:127],a[68:71],v[156:159]
v_cmp_ngt_f32 vcc,s38,v211
v_cvt_pk_bf16_f32 v174,v224,v225
v_mfma_f32_16x16x32_bf16 v[152:155],a[128:131],a[72:75],v[152:155]
s_cbranch_vccnz S_rare_l_11
S_back_l_11:
v_cvt_pk_bf16_f32 v175,v226,v227
v_mfma_f32_16x16x32_bf16 v[156:159],a[132:135],a[72:75],v[156:159]
v_mfma_f32_16x16x32_bf16 v[152:155],a[136:139],a[76:79],v[152:155]
v_mfma_f32_16x16x32_bf16 v[156:159],a[140:143],a[76:79],v[156:159]
v_mfma_f32_16x16x32_bf16 v[96:99],a[144:147],v[180:183],v[96:99]
ds_read_b64_tr_b16 a[144:145],v229
ds_read_b64_tr_b16 a[146:147],v229 offset:1024
v_mfma_f32_16x16x32_bf16 v[100:103],a[148:151],v[180:183],v[100:103]
ds_read_b64_tr_b16 a[148:149],v230
ds_read_b64_tr_b16 a[150:151],v230 offset:1024
v_mfma_f32_16x16x32_bf16 v[104:107],a[152:155],v[180:183],v[104:107]
ds_read_b64_tr_b16 a[152:153],v229 offset:256
ds_read_b64_tr_b16 a[154:155],v229 offset:1280
v_mfma_f32_16x16x32_bf16 v[108:111],a[156:159],v[180:183],v[108:111]
ds_read_b64_tr_b16 a[156:157],v230 offset:256
ds_read_b64_tr_b16 a[158:159],v230 offset:1280
v_mfma_f32_16x16x32_bf16 v[112:115],a[160:163],v[180:183],v[112:115]
ds_read_b64_tr_b16 a[160:161],v229 offset:512
ds_read_b64_tr_b16 a[162:163],v229 offset:1536
v_mfma_f32_16x16x32_bf16 v[116:119],a[164:167],v[180:183],v[116:119]
ds_read_b64_tr_b16 a[164:165],v230 offset:512
ds_read_b64_tr_b16 a[166:167],v230 offset:1536
v_mfma_f32_16x16x32_bf16 v[120:123],a[168:171],v[180:183],v[120:123]
ds_read_b64_tr_b16 a[168:169],v229 offset:768
ds_read_b64_tr_b16 a[170:171],v229 offset:1792
v_mfma_f32_16x16x32_bf16 v[124:127],a[172:175],v[180:183],v[124:127]
ds_read_b64_tr_b16 a[172:173],v230 offset:768
ds_read_b64_tr_b16 a[174:175],v230 offset:1792
v_mfma_f32_16x16x32_bf16 v[212:215],a[176:179],v[168:171],v[208:211]
v_exp_f32 v224,v152
v_mfma_f32_16x16x32_bf16 v[160:163],a[112:115],a[80:83],v[200:203]
ds_read_b128 a[112:115],v228
v_xor_b32 v229,2048,v229
v_mfma_f32_16x16x32_bf16 v[164:167],a[116:119],a[80:83],v[200:203]
ds_read_b128 a[116:119],v228 offset:1024
v_xor_b32 v230,2048,v230
v_mfma_f32_16x16x32_bf16 v[160:163],a[120:123],a[84:87],v[160:163]
v_cmp_ngt_f32 vcc,s38,v212
ds_read_b128 a[120:123],v228 offset:256
v_mfma_f32_16x16x32_bf16 v[164:167],a[124:127],a[84:87],v[164:167]
s_cbranch_vccnz S_rare_l_12
S_back_l_12:
ds_read_b128 a[124:127],v228 offset:1280
v_mfma_f32_16x16x32_bf16 v[160:163],a[128:131],a[88:91],v[160:163]
v_exp_f32 v225,v153
v_mfma_f32_16x16x32_bf16 v[164:167],a[132:135],a[88:91],v[164:167]
ds_read_b128 a[128:131],v228 offset:512
ds_read_b128 a[132:135],v228 offset:1536
v_mfma_f32_16x16x32_bf16 v[160:163],a[136:139],a[92:95],v[160:163]
v_exp_f32 v226,v154
v_mfma_f32_16x16x32_bf16 v[164:167],a[140:143],a[92:95],v[164:167]
ds_read_b128 a[136:139],v228 offset:768
s_waitcnt lgkmcnt(5)
v_mfma_f32_16x16x32_bf16 v[0:3],a[144:147],v[168:171],v[0:3]
ds_read_b128 a[140:143],v228 offset:1792
s_sub_u32 s35,s48,s46
v_mfma_f32_16x16x32_bf16 v[4:7],a[148:151],v[168:171],v[4:7]
v_exp_f32 v227,v155
v_mfma_f32_16x16x32_bf16 v[8:11],a[152:155],v[168:171],v[8:11]
v_cvt_pk_bf16_f32 v176,v224,v225
v_cvt_pk_bf16_f32 v177,v226,v227
v_mfma_f32_16x16x32_bf16 v[12:15],a[156:159],v[168:171],v[12:15]
v_exp_f32 v224,v156
v_mfma_f32_16x16x32_bf16 v[16:19],a[160:163],v[168:171],v[16:19]
v_exp_f32 v225,v157
v_mfma_f32_16x16x32_bf16 v[20:23],a[164:167],v[168:171],v[20:23]
v_exp_f32 v226,v158
v_mfma_f32_16x16x32_bf16 v[24:27],a[168:171],v[168:171],v[24:27]
v_exp_f32 v227,v159
v_mfma_f32_16x16x32_bf16 v[28:31],a[172:175],v[168:171],v[28:31]
v_cvt_pk_bf16_f32 v178,v224,v225
v_cvt_pk_bf16_f32 v179,v226,v227
v_mfma_f32_16x16x32_bf16 v[208:211],a[180:183],v[172:175],v[212:215]
v_exp_f32 v224,v160
v_mfma_f32_16x16x32_bf16 v[136:139],a[112:115],a[96:99],v[204:207]
v_exp_f32 v225,v161
v_mfma_f32_16x16x32_bf16 v[140:143],a[116:119],a[96:99],v[204:207]
s_add_u32 s35,s35,s42
s_waitcnt lgkmcnt(0)
v_mfma_f32_16x16x32_bf16 v[136:139],a[120:123],a[100:103],v[136:139]
v_exp_f32 v226,v162
v_mfma_f32_16x16x32_bf16 v[140:143],a[124:127],a[100:103],v[140:143]
v_cmp_ngt_f32 vcc,s38,v209
v_add_u32 v228,s35,v228
v_mfma_f32_16x16x32_bf16 v[136:139],a[128:131],a[104:107],v[136:139]
s_cbranch_vccnz S_rare_l_13
S_back_l_13:
s_mov_b32 s35,s44
v_mfma_f32_16x16x32_bf16 v[140:143],a[132:135],a[104:107],v[140:143]
v_exp_f32 v227,v163
v_mfma_f32_16x16x32_bf16 v[136:139],a[136:139],a[108:111],v[136:139]
v_cvt_pk_bf16_f32 v180,v224,v225
v_cvt_pk_bf16_f32 v181,v226,v227
v_mfma_f32_16x16x32_bf16 v[140:143],a[140:143],a[108:111],v[140:143]
v_exp_f32 v224,v164
v_mfma_f32_16x16x32_bf16 v[32:35],a[144:147],v[172:175],v[32:35]
v_exp_f32 v225,v165
v_mfma_f32_16x16x32_bf16 v[36:39],a[148:151],v[172:175],v[36:39]
v_exp_f32 v226,v166
v_mfma_f32_16x16x32_bf16 v[40:43],a[152:155],v[172:175],v[40:43]
v_exp_f32 v227,v167
v_mfma_f32_16x16x32_bf16 v[44:47],a[156:159],v[172:175],v[44:47]
v_cvt_pk_bf16_f32 v182,v224,v225
v_cvt_pk_bf16_f32 v183,v226,v227
v_mfma_f32_16x16x32_bf16 v[48:51],a[160:163],v[172:175],v[48:51]
v_exp_f32 v224,v136
v_mfma_f32_16x16x32_bf16 v[52:55],a[164:167],v[172:175],v[52:55]
v_exp_f32 v225,v137
v_mfma_f32_16x16x32_bf16 v[56:59],a[168:171],v[172:175],v[56:59]
v_exp_f32 v226,v138
v_mfma_f32_16x16x32_bf16 v[60:63],a[172:175],v[172:175],v[60:63]
v_exp_f32 v227,v139
v_mfma_f32_16x16x32_bf16 v[212:215],a[184:187],v[176:179],v[208:211]
v_cvt_pk_bf16_f32 v184,v224,v225
v_cvt_pk_bf16_f32 v185,v226,v227
v_mfma_f32_16x16x32_bf16 v[128:131],a[112:115],a[32:35],v[188:191]
v_exp_f32 v224,v140
v_mfma_f32_16x16x32_bf16 v[132:135],a[116:119],a[32:35],v[188:191]
v_exp_f32 v225,v141
v_mfma_f32_16x16x32_bf16 v[128:131],a[120:123],a[36:39],v[128:131]
v_exp_f32 v226,v142
v_mfma_f32_16x16x32_bf16 v[132:135],a[124:127],a[36:39],v[132:135]
v_cmp_ngt_f32 vcc,s38,v214
s_mov_b32 s28,s45
v_mfma_f32_16x16x32_bf16 v[128:131],a[128:131],a[40:43],v[128:131]
s_cbranch_vccnz S_rare_l_14
S_back_l_14:
s_mov_b32 s44,s46
v_mfma_f32_16x16x32_bf16 v[132:135],a[132:135],a[40:43],v[132:135]
v_exp_f32 v227,v143
v_mfma_f32_16x16x32_bf16 v[128:131],a[136:139],a[44:47],v[128:131]
v_cvt_pk_bf16_f32 v186,v224,v225
v_cvt_pk_bf16_f32 v187,v226,v227
v_mfma_f32_16x16x32_bf16 v[132:135],a[140:143],a[44:47],v[132:135]
s_mov_b32 s45,s47
s_mov_b32 s46,s48
v_mfma_f32_16x16x32_bf16 v[64:67],a[144:147],v[176:179],v[64:67]
s_mov_b32 s47,s35
s_mov_b32 s48,s28
v_mfma_f32_16x16x32_bf16 v[68:71],a[148:151],v[176:179],v[68:71]
v_exp_f32 v224,v128
v_mfma_f32_16x16x32_bf16 v[72:75],a[152:155],v[176:179],v[72:75]
v_exp_f32 v225,v129
v_mfma_f32_16x16x32_bf16 v[76:79],a[156:159],v[176:179],v[76:79]
v_exp_f32 v226,v130
v_mfma_f32_16x16x32_bf16 v[80:83],a[160:163],v[176:179],v[80:83]
v_exp_f32 v227,v131
v_mfma_f32_16x16x32_bf16 v[84:87],a[164:167],v[176:179],v[84:87]
v_cvt_pk_bf16_f32 v168,v224,v225
v_cvt_pk_bf16_f32 v169,v226,v227
v_mfma_f32_16x16x32_bf16 v[88:91],a[168:171],v[176:179],v[88:91]
v_exp_f32 v224,v132
v_mfma_f32_16x16x32_bf16 v[92:95],a[172:175],v[176:179],v[92:95]
v_exp_f32 v225,v133
v_mfma_f32_16x16x32_bf16 v[208:211],a[188:191],v[180:183],v[212:215]
v_exp_f32 v226,v134
v_mfma_f32_16x16x32_bf16 v[144:147],a[112:115],a[48:51],v[192:195]
v_exp_f32 v227,v135
v_mfma_f32_16x16x32_bf16 v[148:151],a[116:119],a[48:51],v[192:195]
v_cvt_pk_bf16_f32 v170,v224,v225
v_cvt_pk_bf16_f32 v171,v226,v227
v_mfma_f32_16x16x32_bf16 v[144:147],a[120:123],a[52:55],v[144:147]
s_add_u32 s30,s30,32768
v_cmp_ngt_f32 vcc,s38,v211
v_mfma_f32_16x16x32_bf16 v[148:151],a[124:127],a[52:55],v[148:151]
s_cbranch_vccnz S_rare_l_15
S_back_l_15:
s_add_u32 s36,s36,1
v_mfma_f32_16x16x32_bf16 v[144:147],a[128:131],a[56:59],v[144:147]
s_cmp_lt_u32 s36,7
v_mfma_f32_16x16x32_bf16 v[148:151],a[132:135],a[56:59],v[148:151]
v_mfma_f32_16x16x32_bf16 v[144:147],a[136:139],a[60:63],v[144:147]
v_mfma_f32_16x16x32_bf16 v[148:151],a[140:143],a[60:63],v[148:151]
v_mfma_f32_16x16x32_bf16 v[96:99],a[144:147],v[180:183],v[96:99]
ds_read_b64_tr_b16 a[144:145],v229
ds_read_b64_tr_b16 a[146:147],v229 offset:1024
v_mfma_f32_16x16x32_bf16 v[100:103],a[148:151],v[180:183],v[100:103]
ds_read_b64_tr_b16 a[148:149],v230
ds_read_b64_tr_b16 a[150:151],v230 offset:1024
v_mfma_f32_16x16x32_bf16 v[104:107],a[152:155],v[180:183],v[104:107]
ds_read_b64_tr_b16 a[152:153],v229 offset:256
ds_read_b64_tr_b16 a[154:155],v229 offset:1280
v_mfma_f32_16x16x32_bf16 v[108:111],a[156:159],v[180:183],v[108:111]
ds_read_b64_tr_b16 a[156:157],v230 offset:256
ds_read_b64_tr_b16 a[158:159],v230 offset:1280
v_mfma_f32_16x16x32_bf16 v[112:115],a[160:163],v[180:183],v[112:115]
ds_read_b64_tr_b16 a[160:161],v229 offset:512
ds_read_b64_tr_b16 a[162:163],v229 offset:1536
v_mfma_f32_16x16x32_bf16 v[116:119],a[164:167],v[180:183],v[116:119]
v_exp_f32 v224,v144
v_mfma_f32_16x16x32_bf16 v[120:123],a[168:171],v[180:183],v[120:123]
ds_read_b64_tr_b16 a[164:165],v230 offset:512
ds_read_b64_tr_b16 a[166:167],v230 offset:1536
v_mfma_f32_16x16x32_bf16 v[124:127],a[172:175],v[180:183],v[124:127]
v_exp_f32 v225,v145
v_mfma_f32_16x16x32_bf16 v[216:219],a[176:179],v[184:187],v[220:223]
ds_read_b64_tr_b16 a[168:169],v229 offset:768
ds_read_b64_tr_b16 a[170:171],v229 offset:1792
v_mfma_f32_16x16x32_bf16 v[152:155],a[112:115],a[64:67],v[196:199]
v_exp_f32 v226,v146
v_mfma_f32_16x16x32_bf16 v[156:159],a[116:119],a[64:67],v[196:199]
ds_read_b64_tr_b16 a[172:173],v230 offset:768
ds_read_b64_tr_b16 a[174:175],v230 offset:1792
v_mfma_f32_16x16x32_bf16 v[152:155],a[120:123],a[68:71],v[152:155]
v_exp_f32 v227,v147
v_mfma_f32_16x16x32_bf16 v[156:159],a[124:127],a[68:71],v[156:159]
v_cmp_ngt_f32 vcc,s38,v216
v_cvt_pk_bf16_f32 v172,v224,v225
v_mfma_f32_16x16x32_bf16 v[152:155],a[128:131],a[72:75],v[152:155]
s_cbranch_vccnz S_rare_l_16
S_back_l_16:
v_cvt_pk_bf16_f32 v173,v226,v227
v_mfma_f32_16x16x32_bf16 v[156:159],a[132:135],a[72:75],v[156:159]
v_exp_f32 v224,v148
v_mfma_f32_16x16x32_bf16 v[152:155],a[136:139],a[76:79],v[152:155]
v_exp_f32 v225,v149
v_mfma_f32_16x16x32_bf16 v[156:159],a[140:143],a[76:79],v[156:159]
s_waitcnt lgkmcnt(0)
v_mfma_f32_16x16x32_bf16 a[0:3],a[144:147],v[184:187],a[0:3]
v_exp_f32 v226,v150
v_mfma_f32_16x16x32_bf16 a[4:7],a[148:151],v[184:187],a[4:7]
v_exp_f32 v227,v151
v_mfma_f32_16x16x32_bf16 a[8:11],a[152:155],v[184:187],a[8:11]
v_cvt_pk_bf16_f32 v174,v224,v225
v_cvt_pk_bf16_f32 v175,v226,v227
v_mfma_f32_16x16x32_bf16 a[12:15],a[156:159],v[184:187],a[12:15]
v_exp_f32 v224,v152
v_mfma_f32_16x16x32_bf16 a[16:19],a[160:163],v[184:187],a[16:19]
v_exp_f32 v225,v153
v_mfma_f32_16x16x32_bf16 a[20:23],a[164:167],v[184:187],a[20:23]
v_exp_f32 v226,v154
v_mfma_f32_16x16x32_bf16 a[24:27],a[168:171],v[184:187],a[24:27]
v_exp_f32 v227,v155
v_mfma_f32_16x16x32_bf16 a[28:31],a[172:175],v[184:187],a[28:31]
v_cvt_pk_bf16_f32 v176,v224,v225
v_cvt_pk_bf16_f32 v177,v226,v227
v_mfma_f32_16x16x32_bf16 v[212:215],a[176:179],v[168:171],v[208:211]
v_exp_f32 v224,v156
v_mfma_f32_16x16x32_bf16 v[160:163],a[112:115],a[80:83],v[200:203]
v_exp_f32 v225,v157
v_mfma_f32_16x16x32_bf16 v[164:167],a[116:119],a[80:83],v[200:203]
v_exp_f32 v226,v158
v_mfma_f32_16x16x32_bf16 v[160:163],a[120:123],a[84:87],v[160:163]
v_exp_f32 v227,v159
v_mfma_f32_16x16x32_bf16 v[164:167],a[124:127],a[84:87],v[164:167]
v_cmp_ngt_f32 vcc,s38,v212
v_cvt_pk_bf16_f32 v178,v224,v225
v_mfma_f32_16x16x32_bf16 v[160:163],a[128:131],a[88:91],v[160:163]
v_cvt_pk_bf16_f32 v179,v226,v227
s_cbranch_vccnz S_rare_l_17
S_back_l_17:
v_mfma_f32_16x16x32_bf16 v[164:167],a[132:135],a[88:91],v[164:167]
v_mfma_f32_16x16x32_bf16 v[160:163],a[136:139],a[92:95],v[160:163]
v_mfma_f32_16x16x32_bf16 v[164:167],a[140:143],a[92:95],v[164:167]
s_waitcnt vmcnt(8) lgkmcnt(0)
s_barrier
s_cbranch_scc1 S_loop
v_mfma_f32_16x16x32_bf16 v[0:3],a[144:147],v[168:171],v[0:3]
ds_read_b128 a[112:115],v228
ds_read_b128 a[116:119],v228 offset:1024
v_mfma_f32_16x16x32_bf16 v[4:7],a[148:151],v[168:171],v[4:7]
ds_read_b128 a[120:123],v228 offset:256
ds_read_b128 a[124:127],v228 offset:1280
v_mfma_f32_16x16x32_bf16 v[8:11],a[152:155],v[168:171],v[8:11]
ds_read_b128 a[128:131],v228 offset:512
ds_read_b128 a[132:135],v228 offset:1536
v_mfma_f32_16x16x32_bf16 v[12:15],a[156:159],v[168:171],v[12:15]
s_mov_b32 s72,s64
ds_read_b128 a[136:139],v228 offset:768
v_mfma_f32_16x16x32_bf16 v[16:19],a[160:163],v[168:171],v[16:19]
s_mov_b32 s73,s65
s_mov_b32 s74,s66
v_mfma_f32_16x16x32_bf16 v[20:23],a[164:167],v[168:171],v[20:23]
ds_read_b128 a[140:143],v228 offset:1792
s_mov_b32 s75,s67
v_mfma_f32_16x16x32_bf16 v[24:27],a[168:171],v[168:171],v[24:27]
s_mov_b32 s76,s68
s_add_u32 s64,s64,73728
v_mfma_f32_16x16x32_bf16 v[28:31],a[172:175],v[168:171],v[28:31]
s_add_u32 s65,s65,73728
s_add_u32 s66,s66,73728
v_mfma_f32_16x16x32_bf16 v[208:211],a[180:183],v[172:175],v[212:215]
s_add_u32 s67,s67,73728
s_waitcnt lgkmcnt(2)
v_mfma_f32_16x16x32_bf16 v[128:131],a[112:115],a[32:35],v[188:191]
s_add_u32 s68,s68,73728
s_sub_u32 s29,s47,s45
v_mfma_f32_16x16x32_bf16 v[132:135],a[116:119],a[32:35],v[188:191]
s_add_u32 s29,s29,s42
v_add_u32 v229,s29,v229
v_mfma_f32_16x16x32_bf16 v[128:131],a[120:123],a[36:39],v[128:131]
buffer_load_dwordx4 v[240:243],v232,s[12:15],s68 offen nt
v_mfma_f32_16x16x32_bf16 v[132:135],a[124:127],a[36:39],v[132:135]
v_add_u32 v230,s29,v230
v_cmp_ngt_f32 vcc,s38,v209
v_mfma_f32_16x16x32_bf16 v[128:131],a[128:131],a[40:43],v[128:131]
s_cbranch_vccnz S_rare_z_0
S_back_z_0:
v_xor_b32 v228,2048,v228
v_mfma_f32_16x16x32_bf16 v[132:135],a[132:135],a[40:43],v[132:135]
s_waitcnt lgkmcnt(0)
v_mfma_f32_16x16x32_bf16 v[128:131],a[136:139],a[44:47],v[128:131]
buffer_load_dwordx4 v[244:247],v232,s[12:15],s68 offen offset:1024 nt
v_mfma_f32_16x16x32_bf16 v[132:135],a[140:143],a[44:47],v[132:135]
s_add_u32 m0,s44,0
s_add_u32 s34,s30,0
v_mfma_f32_16x16x32_bf16 v[32:35],a[144:147],v[172:175],v[32:35]
v_exp_f32 v224,v160
v_mfma_f32_16x16x32_bf16 v[36:39],a[148:151],v[172:175],v[36:39]
v_exp_f32 v225,v161
v_mfma_f32_16x16x32_bf16 v[40:43],a[152:155],v[172:175],v[40:43]
buffer_load_dwordx4 v231,s[20:23],s34 offen nt lds
v_mfma_f32_16x16x32_bf16 v[44:47],a[156:159],v[172:175],v[44:47]
v_exp_f32 v226,v162
v_mfma_f32_16x16x32_bf16 v[48:51],a[160:163],v[172:175],v[48:51]
v_exp_f32 v227,v163
v_mfma_f32_16x16x32_bf16 v[52:55],a[164:167],v[172:175],v[52:55]
v_cvt_pk_bf16_f32 v180,v224,v225
v_cvt_pk_bf16_f32 v181,v226,v227
v_mfma_f32_16x16x32_bf16 v[56:59],a[168:171],v[172:175],v[56:59]
v_exp_f32 v224,v164
v_mfma_f32_16x16x32_bf16 v[60:63],a[172:175],v[172:175],v[60:63]
buffer_load_dwordx4 v231,s[20:23],s34 offen offset:1024 nt lds
v_mfma_f32_16x16x32_bf16 v[212:215],a[184:187],v[176:179],v[208:211]
v_exp_f32 v225,v165
v_mfma_f32_16x16x32_bf16 v[144:147],a[112:115],a[48:51],v[192:195]
v_exp_f32 v226,v166
v_mfma_f32_16x16x32_bf16 v[148:151],a[116:119],a[48:51],v[192:195]
v_exp_f32 v227,v167
v_mfma_f32_16x16x32_bf16 v[144:147],a[120:123],a[52:55],v[144:147]
v_cvt_pk_bf16_f32 v182,v224,v225
v_cvt_pk_bf16_f32 v183,v226,v227
v_mfma_f32_16x16x32_bf16 v[148:151],a[124:127],a[52:55],v[148:151]
buffer_load_dwordx4 v231,s[20:23],s34 offen offset:2048 nt lds
v_mfma_f32_16x16x32_bf16 v[144:147],a[128:131],a[56:59],v[144:147]
v_cmp_ngt_f32 vcc,s38,v214
v_mfma_f32_16x16x32_bf16 v[148:151],a[132:135],a[56:59],v[148:151]
s_cbranch_vccnz S_rare_z_1
S_back_z_1:
v_mfma_f32_16x16x32_bf16 v[144:147],a[136:139],a[60:63],v[144:147]
v_exp_f32 v224,v128
v_mfma_f32_16x16x32_bf16 v[148:151],a[140:143],a[60:63],v[148:151]
v_exp_f32 v225,v129
v_mfma_f32_16x16x32_bf16 v[64:67],a[144:147],v[176:179],v[64:67]
buffer_load_dwordx4 v231,s[20:23],s34 offen offset:3072 nt lds
v_mfma_f32_16x16x32_bf16 v[68:71],a[148:151],v[176:179],v[68:71]
s_add_u32 m0,s44,4096
s_add_u32 s34,s30,4096
v_mfma_f32_16x16x32_bf16 v[72:75],a[152:155],v[176:179],v[72:75]
v_exp_f32 v226,v130
v_mfma_f32_16x16x32_bf16 v[76:79],a[156:159],v[176:179],v[76:79]
v_exp_f32 v227,v131
v_mfma_f32_16x16x32_bf16 v[80:83],a[160:163],v[176:179],v[80:83]
v_cvt_pk_bf16_f32 v168,v224,v225
v_cvt_pk_bf16_f32 v169,v226,v227
v_mfma_f32_16x16x32_bf16 v[84:87],a[164:167],v[176:179],v[84:87]
buffer_load_dwordx4 v231,s[20:23],s34 offen nt lds
v_mfma_f32_16x16x32_bf16 v[88:91],a[168:171],v[176:179],v[88:91]
v_exp_f32 v224,v132
v_mfma_f32_16x16x32_bf16 v[92:95],a[172:175],v[176:179],v[92:95]
v_exp_f32 v225,v133
v_mfma_f32_16x16x32_bf16 v[208:211],a[188:191],v[180:183],v[212:215]
v_exp_f32 v226,v134
v_mfma_f32_16x16x32_bf16 v[152:155],a[112:115],a[64:67],v[196:199]
v_exp_f32 v227,v135
v_mfma_f32_16x16x32_bf16 v[156:159],a[116:119],a[64:67],v[196:199]
buffer_load_dwordx4 v231,s[20:23],s34 offen offset:1024 nt lds
v_mfma_f32_16x16x32_bf16 v[152:155],a[120:123],a[68:71],v[152:155]
v_cvt_pk_bf16_f32 v170,v224,v225
v_cvt_pk_bf16_f32 v171,v226,v227
v_mfma_f32_16x16x32_bf16 v[156:159],a[124:127],a[68:71],v[156:159]
v_cmp_ngt_f32 vcc,s38,v211
v_mfma_f32_16x16x32_bf16 v[152:155],a[128:131],a[72:75],v[152:155]
s_cbranch_vccnz S_rare_z_2
S_back_z_2:
v_mfma_f32_16x16x32_bf16 v[156:159],a[132:135],a[72:75],v[156:159]
v_exp_f32 v224,v144
v_mfma_f32_16x16x32_bf16 v[152:155],a[136:139],a[76:79],v[152:155]
buffer_load_dwordx4 v231,s[20:23],s34 offen offset:2048 nt lds
v_mfma_f32_16x16x32_bf16 v[156:159],a[140:143],a[76:79],v[156:159]
v_exp_f32 v225,v145
v_mfma_f32_16x16x32_bf16 v[96:99],a[144:147],v[180:183],v[96:99]
ds_read_b64_tr_b16 a[144:145],v229
ds_read_b64_tr_b16 a[146:147],v229 offset:1024
v_mfma_f32_16x16x32_bf16 v[100:103],a[148:151],v[180:183],v[100:103]
ds_read_b64_tr_b16 a[148:149],v230
ds_read_b64_tr_b16 a[150:151],v230 offset:1024
v_mfma_f32_16x16x32_bf16 v[104:107],a[152:155],v[180:183],v[104:107]
ds_read_b64_tr_b16 a[152:153],v229 offset:256
ds_read_b64_tr_b16 a[154:155],v229 offset:1280
v_mfma_f32_16x16x32_bf16 v[108:111],a[156:159],v[180:183],v[108:111]
buffer_load_dwordx4 v231,s[20:23],s34 offen offset:3072 nt lds
v_mfma_f32_16x16x32_bf16 v[112:115],a[160:163],v[180:183],v[112:115]
ds_read_b64_tr_b16 a[156:157],v230 offset:256
ds_read_b64_tr_b16 a[158:159],v230 offset:1280
v_mfma_f32_16x16x32_bf16 v[116:119],a[164:167],v[180:183],v[116:119]
ds_read_b64_tr_b16 a[160:161],v229 offset:512
ds_read_b64_tr_b16 a[162:163],v229 offset:1536
v_mfma_f32_16x16x32_bf16 v[120:123],a[168:171],v[180:183],v[120:123]
ds_read_b64_tr_b16 a[164:165],v230 offset:512
ds_read_b64_tr_b16 a[166:167],v230 offset:1536
v_mfma_f32_16x16x32_bf16 v[124:127],a[172:175],v[180:183],v[124:127]
ds_read_b64_tr_b16 a[168:169],v229 offset:768
ds_read_b64_tr_b16 a[170:171],v229 offset:1792
v_mfma_f32_16x16x32_bf16 v[212:215],a[176:179],v[168:171],v[208:211]
buffer_load_dwordx4 a[192:195],v232,s[12:15],s64 offen nt
v_mfma_f32_16x16x32_bf16 v[160:163],a[112:115],a[80:83],v[200:203]
ds_read_b64_tr_b16 a[172:173],v230 offset:768
ds_read_b64_tr_b16 a[174:175],v230 offset:1792
v_mfma_f32_16x16x32_bf16 v[164:167],a[116:119],a[80:83],v[200:203]
v_exp_f32 v226,v146
v_mfma_f32_16x16x32_bf16 v[160:163],a[120:123],a[84:87],v[160:163]
v_exp_f32 v227,v147
v_mfma_f32_16x16x32_bf16 v[164:167],a[124:127],a[84:87],v[164:167]
v_cmp_ngt_f32 vcc,s38,v212
ds_read_b128 a[112:115],v228
v_mfma_f32_16x16x32_bf16 v[160:163],a[128:131],a[88:91],v[160:163]
buffer_load_dwordx4 a[196:199],v232,s[12:15],s64 offen offset:1024 nt
v_mfma_f32_16x16x32_bf16 v[164:167],a[132:135],a[88:91],v[164:167]
s_cbranch_vccnz S_rare_z_3
S_back_z_3:
v_cvt_pk_bf16_f32 v172,v224,v225
v_mfma_f32_16x16x32_bf16 v[160:163],a[136:139],a[92:95],v[160:163]
ds_read_b128 a[116:119],v228 offset:1024
v_cvt_pk_bf16_f32 v173,v226,v227
v_mfma_f32_16x16x32_bf16 v[164:167],a[140:143],a[92:95],v[164:167]
ds_read_b128 a[120:123],v228 offset:256
s_waitcnt lgkmcnt(3)
v_mfma_f32_16x16x32_bf16 v[0:3],a[144:147],v[168:171],v[0:3]
v_exp_f32 v224,v148
v_mfma_f32_16x16x32_bf16 v[4:7],a[148:151],v[168:171],v[4:7]
ds_read_b128 a[124:127],v228 offset:1280
ds_read_b128 a[128:131],v228 offset:512
v_mfma_f32_16x16x32_bf16 v[8:11],a[152:155],v[168:171],v[8:11]
buffer_load_dwordx4 a[200:203],v232,s[12:15],s64 offen offset:2048 nt
v_mfma_f32_16x16x32_bf16 v[12:15],a[156:159],v[168:171],v[12:15]
v_exp_f32 v225,v149
v_mfma_f32_16x16x32_bf16 v[16:19],a[160:163],v[168:171],v[16:19]
v_exp_f32 v226,v150
v_mfma_f32_16x16x32_bf16 v[20:23],a[164:167],v[168:171],v[20:23]
ds_read_b128 a[132:135],v228 offset:1536
v_exp_f32 v227,v151
v_mfma_f32_16x16x32_bf16 v[24:27],a[168:171],v[168:171],v[24:27]
ds_read_b128 a[136:139],v228 offset:768
v_cvt_pk_bf16_f32 v174,v224,v225
v_mfma_f32_16x16x32_bf16 v[28:31],a[172:175],v[168:171],v[28:31]
v_cvt_pk_bf16_f32 v175,v226,v227
ds_read_b128 a[140:143],v228 offset:1792
s_nop 0
v_mfma_f32_16x16x32_bf16 v[208:211],a[180:183],v[172:175],v[212:215]
buffer_load_dwordx4 a[204:207],v232,s[12:15],s64 offen offset:3072 nt
s_waitcnt lgkmcnt(3)
v_mfma_f32_16x16x32_bf16 v[136:139],a[112:115],a[96:99],v[204:207]
v_exp_f32 v224,v152
v_mfma_f32_16x16x32_bf16 v[140:143],a[116:119],a[96:99],v[204:207]
v_exp_f32 v225,v153
v_mfma_f32_16x16x32_bf16 v[136:139],a[120:123],a[100:103],v[136:139]
buffer_load_dwordx4 a[208:211],v232,s[12:15],s65 offen nt
v_mfma_f32_16x16x32_bf16 v[140:143],a[124:127],a[100:103],v[140:143]
v_cmp_ngt_f32 vcc,s38,v209
v_xor_b32 v229,2048,v229
v_mfma_f32_16x16x32_bf16 v[136:139],a[128:131],a[104:107],v[136:139]
s_cbranch_vccnz S_rare_z_4
S_back_z_4:
s_waitcnt lgkmcnt(0)
v_mfma_f32_16x16x32_bf16 v[140:143],a[132:135],a[104:107],v[140:143]
v_exp_f32 v226,v154
v_mfma_f32_16x16x32_bf16 v[136:139],a[136:139],a[108:111],v[136:139]
v_exp_f32 v227,v155
v_mfma_f32_16x16x32_bf16 v[140:143],a[140:143],a[108:111],v[140:143]
v_cvt_pk_bf16_f32 v176,v224,v225
v_cvt_pk_bf16_f32 v177,v226,v227
v_mfma_f32_16x16x32_bf16 v[32:35],a[144:147],v[172:175],v[32:35]
buffer_load_dwordx4 a[212:215],v232,s[12:15],s65 offen offset:1024 nt
v_mfma_f32_16x16x32_bf16 v[36:39],a[148:151],v[172:175],v[36:39]
v_exp_f32 v224,v156
v_mfma_f32_16x16x32_bf16 v[40:43],a[152:155],v[172:175],v[40:43]
v_exp_f32 v225,v157
v_mfma_f32_16x16x32_bf16 v[44:47],a[156:159],v[172:175],v[44:47]
v_exp_f32 v226,v158
v_mfma_f32_16x16x32_bf16 v[48:51],a[160:163],v[172:175],v[48:51]
v_exp_f32 v227,v159
v_mfma_f32_16x16x32_bf16 v[52:55],a[164:167],v[172:175],v[52:55]
buffer_load_dwordx4 a[216:219],v232,s[12:15],s65 offen offset:2048 nt
v_mfma_f32_16x16x32_bf16 v[56:59],a[168:171],v[172:175],v[56:59]
v_cvt_pk_bf16_f32 v178,v224,v225
v_cvt_pk_bf16_f32 v179,v226,v227
v_mfma_f32_16x16x32_bf16 v[60:63],a[172:175],v[172:175],v[60:63]
v_exp_f32 v224,v160
v_mfma_f32_16x16x32_bf16 v[212:215],a[184:187],v[176:179],v[208:211]
v_exp_f32 v225,v161
v_mfma_f32_16x16x32_bf16 v[128:131],a[112:115],a[32:35],v[188:191]
buffer_load_dwordx4 a[220:223],v232,s[12:15],s65 offen offset:3072 nt
v_mfma_f32_16x16x32_bf16 v[132:135],a[116:119],a[32:35],v[188:191]
v_exp_f32 v226,v162
v_mfma_f32_16x16x32_bf16 v[128:131],a[120:123],a[36:39],v[128:131]
v_exp_f32 v227,v163
v_mfma_f32_16x16x32_bf16 v[132:135],a[124:127],a[36:39],v[132:135]
v_cmp_ngt_f32 vcc,s38,v214
v_cvt_pk_bf16_f32 v180,v224,v225
v_mfma_f32_16x16x32_bf16 v[128:131],a[128:131],a[40:43],v[128:131]
s_cbranch_vccnz S_rare_z_5
S_back_z_5:
v_cvt_pk_bf16_f32 v181,v226,v227
v_mfma_f32_16x16x32_bf16 v[132:135],a[132:135],a[40:43],v[132:135]
buffer_load_dwordx4 a[224:227],v232,s[12:15],s66 offen nt
v_mfma_f32_16x16x32_bf16 v[128:131],a[136:139],a[44:47],v[128:131]
v_exp_f32 v224,v164
v_mfma_f32_16x16x32_bf16 v[132:135],a[140:143],a[44:47],v[132:135]
v_exp_f32 v225,v165
v_mfma_f32_16x16x32_bf16 v[64:67],a[144:147],v[176:179],v[64:67]
v_exp_f32 v226,v166
v_mfma_f32_16x16x32_bf16 v[68:71],a[148:151],v[176:179],v[68:71]
v_exp_f32 v227,v167
v_mfma_f32_16x16x32_bf16 v[72:75],a[152:155],v[176:179],v[72:75]
buffer_load_dwordx4 a[228:231],v232,s[12:15],s66 offen offset:1024 nt
v_mfma_f32_16x16x32_bf16 v[76:79],a[156:159],v[176:179],v[76:79]
v_cvt_pk_bf16_f32 v182,v224,v225
v_cvt_pk_bf16_f32 v183,v226,v227
v_mfma_f32_16x16x32_bf16 v[80:83],a[160:163],v[176:179],v[80:83]
v_exp_f32 v224,v136
v_mfma_f32_16x16x32_bf16 v[84:87],a[164:167],v[176:179],v[84:87]
v_exp_f32 v225,v137
v_mfma_f32_16x16x32_bf16 v[88:91],a[168:171],v[176:179],v[88:91]
v_exp_f32 v226,v138
v_mfma_f32_16x16x32_bf16 v[92:95],a[172:175],v[176:179],v[92:95]
buffer_load_dwordx4 a[232:235],v232,s[12:15],s66 offen offset:2048 nt
v_mfma_f32_16x16x32_bf16 v[208:211],a[188:191],v[180:183],v[212:215]
v_xor_b32 v230,2048,v230
v_xor_b32 v228,6144,v228
v_mfma_f32_16x16x32_bf16 v[144:147],a[112:115],a[48:51],v[192:195]
v_exp_f32 v227,v139
v_mfma_f32_16x16x32_bf16 v[148:151],a[116:119],a[48:51],v[192:195]
v_cvt_pk_bf16_f32 v184,v224,v225
v_cvt_pk_bf16_f32 v185,v226,v227
v_mfma_f32_16x16x32_bf16 v[144:147],a[120:123],a[52:55],v[144:147]
v_exp_f32 v224,v140
v_mfma_f32_16x16x32_bf16 v[148:151],a[124:127],a[52:55],v[148:151]
buffer_load_dwordx4 a[236:239],v232,s[12:15],s66 offen offset:3072 nt
v_mfma_f32_16x16x32_bf16 v[144:147],a[128:131],a[56:59],v[144:147]
v_cmp_ngt_f32 vcc,s38,v211
v_mfma_f32_16x16x32_bf16 v[148:151],a[132:135],a[56:59],v[148:151]
s_cbranch_vccnz S_rare_z_6
S_back_z_6:
v_mfma_f32_16x16x32_bf16 v[144:147],a[136:139],a[60:63],v[144:147]
v_exp_f32 v225,v141
v_mfma_f32_16x16x32_bf16 v[148:151],a[140:143],a[60:63],v[148:151]
v_exp_f32 v226,v142
v_mfma_f32_16x16x32_bf16 v[96:99],a[144:147],v[180:183],v[96:99]
buffer_load_dwordx4 a[240:243],v232,s[12:15],s67 offen nt
v_mfma_f32_16x16x32_bf16 v[100:103],a[148:151],v[180:183],v[100:103]
v_exp_f32 v227,v143
v_mfma_f32_16x16x32_bf16 v[104:107],a[152:155],v[180:183],v[104:107]
v_cvt_pk_bf16_f32 v186,v224,v225
v_cvt_pk_bf16_f32 v187,v226,v227
v_mfma_f32_16x16x32_bf16 v[108:111],a[156:159],v[180:183],v[108:111]
ds_read_b64_tr_b16 a[144:145],v229
ds_read_b64_tr_b16 a[146:147],v229 offset:1024
v_mfma_f32_16x16x32_bf16 v[112:115],a[160:163],v[180:183],v[112:115]
ds_read_b64_tr_b16 a[148:149],v230
ds_read_b64_tr_b16 a[150:151],v230 offset:1024
v_mfma_f32_16x16x32_bf16 v[116:119],a[164:167],v[180:183],v[116:119]
buffer_load_dwordx4 a[244:247],v232,s[12:15],s67 offen offset:1024 nt
v_mfma_f32_16x16x32_bf16 v[120:123],a[168:171],v[180:183],v[120:123]
ds_read_b64_tr_b16 a[152:153],v229 offset:256
ds_read_b64_tr_b16 a[154:155],v229 offset:1280
v_mfma_f32_16x16x32_bf16 v[124:127],a[172:175],v[180:183],v[124:127]
ds_read_b64_tr_b16 a[156:157],v230 offset:256
ds_read_b64_tr_b16 a[158:159],v230 offset:1280
v_mfma_f32_16x16x32_bf16 v[220:223],a[176:179],v[184:187],v[216:219]
ds_read_b64_tr_b16 a[160:161],v229 offset:512
ds_read_b64_tr_b16 a[162:163],v229 offset:1536
v_mfma_f32_16x16x32_bf16 v[152:155],a[112:115],a[64:67],v[196:199]
ds_read_b64_tr_b16 a[164:165],v230 offset:512
ds_read_b64_tr_b16 a[166:167],v230 offset:1536
v_mfma_f32_16x16x32_bf16 v[156:159],a[116:119],a[64:67],v[196:199]
buffer_load_dwordx4 a[248:251],v232,s[12:15],s67 offen offset:2048 nt
v_mfma_f32_16x16x32_bf16 v[152:155],a[120:123],a[68:71],v[152:155]
ds_read_b64_tr_b16 a[168:169],v229 offset:768
ds_read_b64_tr_b16 a[170:171],v229 offset:1792
v_mfma_f32_16x16x32_bf16 v[156:159],a[124:127],a[68:71],v[156:159]
v_exp_f32 v224,v128
v_mfma_f32_16x16x32_bf16 v[152:155],a[128:131],a[72:75],v[152:155]
ds_read_b64_tr_b16 a[172:173],v230 offset:768
v_cmp_ngt_f32 vcc,s38,v220
v_mfma_f32_16x16x32_bf16 v[156:159],a[132:135],a[72:75],v[156:159]
v_exp_f32 v225,v129
v_mfma_f32_16x16x32_bf16 v[152:155],a[136:139],a[76:79],v[152:155]
ds_read_b64_tr_b16 a[174:175],v230 offset:1792
s_cbranch_vccnz S_rare_z_7
S_back_z_7:
v_mfma_f32_16x16x32_bf16 v[156:159],a[140:143],a[76:79],v[156:159]
v_exp_f32 v226,v130
s_waitcnt lgkmcnt(4)
v_mfma_f32_16x16x32_bf16 a[0:3],a[144:147],v[184:187],a[0:3]
v_exp_f32 v227,v131
buffer_load_dwordx4 a[252:255],v232,s[12:15],s67 offen offset:3072 nt
v_mfma_f32_16x16x32_bf16 a[4:7],a[148:151],v[184:187],a[4:7]
v_cvt_pk_bf16_f32 v168,v224,v225
v_cvt_pk_bf16_f32 v169,v226,v227
v_mfma_f32_16x16x32_bf16 a[8:11],a[152:155],v[184:187],a[8:11]
v_exp_f32 v224,v132
v_mfma_f32_16x16x32_bf16 a[12:15],a[156:159],v[184:187],a[12:15]
v_exp_f32 v225,v133
s_add_u32 m0,s45,0
v_mfma_f32_16x16x32_bf16 a[16:19],a[160:163],v[184:187],a[16:19]
s_add_u32 s34,s30,32768
v_exp_f32 v226,v134
v_mfma_f32_16x16x32_bf16 a[20:23],a[164:167],v[184:187],a[20:23]
buffer_load_dwordx4 v231,s[16:19],s34 offen nt lds
v_exp_f32 v227,v135
s_waitcnt lgkmcnt(0)
v_mfma_f32_16x16x32_bf16 a[24:27],a[168:171],v[184:187],a[24:27]
v_cvt_pk_bf16_f32 v170,v224,v225
v_cvt_pk_bf16_f32 v171,v226,v227
v_mfma_f32_16x16x32_bf16 a[28:31],a[172:175],v[184:187],a[28:31]
v_exp_f32 v224,v144
v_mfma_f32_16x16x32_bf16 v[212:215],a[176:179],v[168:171],v[208:211]
buffer_load_dwordx4 v231,s[16:19],s34 offen offset:1024 nt lds
v_mfma_f32_16x16x32_bf16 v[160:163],a[112:115],a[80:83],v[200:203]
v_exp_f32 v225,v145
v_mfma_f32_16x16x32_bf16 v[164:167],a[116:119],a[80:83],v[200:203]
v_exp_f32 v226,v146
v_mfma_f32_16x16x32_bf16 v[160:163],a[120:123],a[84:87],v[160:163]
v_exp_f32 v227,v147
v_mfma_f32_16x16x32_bf16 v[164:167],a[124:127],a[84:87],v[164:167]
v_cmp_ngt_f32 vcc,s38,v212
ds_read_b128 a[112:115],v228
v_mfma_f32_16x16x32_bf16 v[160:163],a[128:131],a[88:91],v[160:163]
buffer_load_dwordx4 v231,s[16:19],s34 offen offset:2048 nt lds
v_mfma_f32_16x16x32_bf16 v[164:167],a[132:135],a[88:91],v[164:167]
s_cbranch_vccnz S_rare_z_8
S_back_z_8:
v_cvt_pk_bf16_f32 v172,v224,v225
v_mfma_f32_16x16x32_bf16 v[160:163],a[136:139],a[92:95],v[160:163]
ds_read_b128 a[116:119],v228 offset:1024
v_cvt_pk_bf16_f32 v173,v226,v227
v_mfma_f32_16x16x32_bf16 v[164:167],a[140:143],a[92:95],v[164:167]
ds_read_b128 a[120:123],v228 offset:256
ds_read_b128 a[124:127],v228 offset:1280
v_mfma_f32_16x16x32_bf16 v[0:3],a[144:147],v[168:171],v[0:3]
v_exp_f32 v224,v148
v_mfma_f32_16x16x32_bf16 v[4:7],a[148:151],v[168:171],v[4:7]
buffer_load_dwordx4 v231,s[16:19],s34 offen offset:3072 nt lds
v_mfma_f32_16x16x32_bf16 v[8:11],a[152:155],v[168:171],v[8:11]
v_exp_f32 v225,v149
v_mfma_f32_16x16x32_bf16 v[12:15],a[156:159],v[168:171],v[12:15]
ds_read_b128 a[128:131],v228 offset:512
ds_read_b128 a[132:135],v228 offset:1536
v_mfma_f32_16x16x32_bf16 v[16:19],a[160:163],v[168:171],v[16:19]
v_exp_f32 v226,v150
v_mfma_f32_16x16x32_bf16 v[20:23],a[164:167],v[168:171],v[20:23]
v_exp_f32 v227,v151
v_mfma_f32_16x16x32_bf16 v[24:27],a[168:171],v[168:171],v[24:27]
ds_read_b128 a[136:139],v228 offset:768
v_cvt_pk_bf16_f32 v174,v224,v225
s_add_u32 m0,s45,4096
v_mfma_f32_16x16x32_bf16 v[28:31],a[172:175],v[168:171],v[28:31]
v_cvt_pk_bf16_f32 v175,v226,v227
ds_read_b128 a[140:143],v228 offset:1792
s_add_u32 s34,s30,36864
v_mfma_f32_16x16x32_bf16 v[208:211],a[180:183],v[172:175],v[212:215]
buffer_load_dwordx4 v231,s[16:19],s34 offen nt lds
s_waitcnt lgkmcnt(4)
v_mfma_f32_16x16x32_bf16 v[128:131],a[112:115],a[32:35],v[188:191]
v_exp_f32 v224,v152
v_mfma_f32_16x16x32_bf16 v[132:135],a[116:119],a[32:35],v[188:191]
v_exp_f32 v225,v153
v_mfma_f32_16x16x32_bf16 v[128:131],a[120:123],a[36:39],v[128:131]
buffer_load_dwordx4 v231,s[16:19],s34 offen offset:1024 nt lds
v_mfma_f32_16x16x32_bf16 v[132:135],a[124:127],a[36:39],v[132:135]
v_cmp_ngt_f32 vcc,s38,v209
s_waitcnt lgkmcnt(1)
v_mfma_f32_16x16x32_bf16 v[128:131],a[128:131],a[40:43],v[128:131]
v_exp_f32 v226,v154
v_mfma_f32_16x16x32_bf16 v[132:135],a[132:135],a[40:43],v[132:135]
s_cbranch_vccnz S_rare_z_9
S_back_z_9:
v_xor_b32 v229,6144,v229
v_mfma_f32_16x16x32_bf16 v[128:131],a[136:139],a[44:47],v[128:131]
v_xor_b32 v230,6144,v230
s_waitcnt lgkmcnt(0)
v_mfma_f32_16x16x32_bf16 v[132:135],a[140:143],a[44:47],v[132:135]
v_exp_f32 v227,v155
v_mfma_f32_16x16x32_bf16 v[32:35],a[144:147],v[172:175],v[32:35]
v_cvt_pk_bf16_f32 v176,v224,v225
v_cvt_pk_bf16_f32 v177,v226,v227
v_mfma_f32_16x16x32_bf16 v[36:39],a[148:151],v[172:175],v[36:39]
buffer_load_dwordx4 v231,s[16:19],s34 offen offset:2048 nt lds
v_mfma_f32_16x16x32_bf16 v[40:43],a[152:155],v[172:175],v[40:43]
v_exp_f32 v224,v156
v_mfma_f32_16x16x32_bf16 v[44:47],a[156:159],v[172:175],v[44:47]
v_exp_f32 v225,v157
v_mfma_f32_16x16x32_bf16 v[48:51],a[160:163],v[172:175],v[48:51]
v_exp_f32 v226,v158
v_mfma_f32_16x16x32_bf16 v[52:55],a[164:167],v[172:175],v[52:55]
v_exp_f32 v227,v159
v_mfma_f32_16x16x32_bf16 v[56:59],a[168:171],v[172:175],v[56:59]
buffer_load_dwordx4 v231,s[16:19],s34 offen offset:3072 nt lds
v_cvt_pk_bf16_f32 v178,v224,v225
v_mfma_f32_16x16x32_bf16 v[60:63],a[172:175],v[172:175],v[60:63]
v_cvt_pk_bf16_f32 v179,v226,v227
v_xor_b32 v228,2048,v228
s_nop 0
v_mfma_f32_16x16x32_bf16 v[212:215],a[184:187],v[176:179],v[208:211]
v_exp_f32 v224,v160
v_mfma_f32_16x16x32_bf16 v[144:147],a[112:115],a[48:51],v[192:195]
v_exp_f32 v225,v161
v_mfma_f32_16x16x32_bf16 v[148:151],a[116:119],a[48:51],v[192:195]
v_exp_f32 v226,v162
v_mfma_f32_16x16x32_bf16 v[144:147],a[120:123],a[52:55],v[144:147]
v_exp_f32 v227,v163
v_mfma_f32_16x16x32_bf16 v[148:151],a[124:127],a[52:55],v[148:151]
v_cmp_ngt_f32 vcc,s38,v214
v_cvt_pk_bf16_f32 v180,v224,v225
v_mfma_f32_16x16x32_bf16 v[144:147],a[128:131],a[56:59],v[144:147]
s_cbranch_vccnz S_rare_z_10
S_back_z_10:
v_cvt_pk_bf16_f32 v181,v226,v227
v_mfma_f32_16x16x32_bf16 v[148:151],a[132:135],a[56:59],v[148:151]
v_exp_f32 v224,v164
v_mfma_f32_16x16x32_bf16 v[144:147],a[136:139],a[60:63],v[144:147]
v_exp_f32 v225,v165
v_mfma_f32_16x16x32_bf16 v[148:151],a[140:143],a[60:63],v[148:151]
v_exp_f32 v226,v166
v_mfma_f32_16x16x32_bf16 v[64:67],a[144:147],v[176:179],v[64:67]
v_exp_f32 v227,v167
v_mfma_f32_16x16x32_bf16 v[68:71],a[148:151],v[176:179],v[68:71]
v_cvt_pk_bf16_f32 v182,v224,v225
v_cvt_pk_bf16_f32 v183,v226,v227
v_mfma_f32_16x16x32_bf16 v[72:75],a[152:155],v[176:179],v[72:75]
v_exp_f32 v224,v128
v_mfma_f32_16x16x32_bf16 v[76:79],a[156:159],v[176:179],v[76:79]
v_exp_f32 v225,v129
v_mfma_f32_16x16x32_bf16 v[80:83],a[160:163],v[176:179],v[80:83]
v_exp_f32 v226,v130
v_mfma_f32_16x16x32_bf16 v[84:87],a[164:167],v[176:179],v[84:87]
v_exp_f32 v227,v131
v_mfma_f32_16x16x32_bf16 v[88:91],a[168:171],v[176:179],v[88:91]
v_cvt_pk_bf16_f32 v168,v224,v225
v_cvt_pk_bf16_f32 v169,v226,v227
v_mfma_f32_16x16x32_bf16 v[92:95],a[172:175],v[176:179],v[92:95]
v_exp_f32 v224,v132
v_mfma_f32_16x16x32_bf16 v[208:211],a[188:191],v[180:183],v[212:215]
v_exp_f32 v225,v133
v_mfma_f32_16x16x32_bf16 v[152:155],a[112:115],a[64:67],v[196:199]
v_exp_f32 v226,v134
v_mfma_f32_16x16x32_bf16 v[156:159],a[116:119],a[64:67],v[196:199]
v_exp_f32 v227,v135
v_mfma_f32_16x16x32_bf16 v[152:155],a[120:123],a[68:71],v[152:155]
v_cvt_pk_bf16_f32 v170,v224,v225
v_cvt_pk_bf16_f32 v171,v226,v227
v_mfma_f32_16x16x32_bf16 v[156:159],a[124:127],a[68:71],v[156:159]
v_cmp_ngt_f32 vcc,s38,v211
v_mfma_f32_16x16x32_bf16 v[152:155],a[128:131],a[72:75],v[152:155]
s_cbranch_vccnz S_rare_z_11
S_back_z_11:
v_mfma_f32_16x16x32_bf16 v[156:159],a[132:135],a[72:75],v[156:159]
v_exp_f32 v224,v144
v_mfma_f32_16x16x32_bf16 v[152:155],a[136:139],a[76:79],v[152:155]
v_exp_f32 v225,v145
v_mfma_f32_16x16x32_bf16 v[156:159],a[140:143],a[76:79],v[156:159]
v_exp_f32 v226,v146
v_mfma_f32_16x16x32_bf16 v[96:99],a[144:147],v[180:183],v[96:99]
ds_read_b64_tr_b16 a[144:145],v229
ds_read_b64_tr_b16 a[146:147],v229 offset:1024
v_mfma_f32_16x16x32_bf16 v[100:103],a[148:151],v[180:183],v[100:103]
ds_read_b64_tr_b16 a[148:149],v230
ds_read_b64_tr_b16 a[150:151],v230 offset:1024
v_mfma_f32_16x16x32_bf16 v[104:107],a[152:155],v[180:183],v[104:107]
ds_read_b64_tr_b16 a[152:153],v229 offset:256
ds_read_b64_tr_b16 a[154:155],v229 offset:1280
v_mfma_f32_16x16x32_bf16 v[108:111],a[156:159],v[180:183],v[108:111]
ds_read_b64_tr_b16 a[156:157],v230 offset:256
ds_read_b64_tr_b16 a[158:159],v230 offset:1280
v_mfma_f32_16x16x32_bf16 v[112:115],a[160:163],v[180:183],v[112:115]
ds_read_b64_tr_b16 a[160:161],v229 offset:512
ds_read_b64_tr_b16 a[162:163],v229 offset:1536
v_mfma_f32_16x16x32_bf16 v[116:119],a[164:167],v[180:183],v[116:119]
ds_read_b64_tr_b16 a[164:165],v230 offset:512
ds_read_b64_tr_b16 a[166:167],v230 offset:1536
v_mfma_f32_16x16x32_bf16 v[120:123],a[168:171],v[180:183],v[120:123]
ds_read_b64_tr_b16 a[168:169],v229 offset:768
ds_read_b64_tr_b16 a[170:171],v229 offset:1792
v_mfma_f32_16x16x32_bf16 v[124:127],a[172:175],v[180:183],v[124:127]
ds_read_b64_tr_b16 a[172:173],v230 offset:768
ds_read_b64_tr_b16 a[174:175],v230 offset:1792
v_mfma_f32_16x16x32_bf16 v[212:215],a[176:179],v[168:171],v[208:211]
v_exp_f32 v227,v147
v_mfma_f32_16x16x32_bf16 v[160:163],a[112:115],a[80:83],v[200:203]
ds_read_b128 a[112:115],v228
v_cvt_pk_bf16_f32 v172,v224,v225
v_mfma_f32_16x16x32_bf16 v[164:167],a[116:119],a[80:83],v[200:203]
ds_read_b128 a[116:119],v228 offset:1024
v_cvt_pk_bf16_f32 v173,v226,v227
v_mfma_f32_16x16x32_bf16 v[160:163],a[120:123],a[84:87],v[160:163]
v_cmp_ngt_f32 vcc,s38,v212
ds_read_b128 a[120:123],v228 offset:256
v_mfma_f32_16x16x32_bf16 v[164:167],a[124:127],a[84:87],v[164:167]
s_cbranch_vccnz S_rare_z_12
S_back_z_12:
ds_read_b128 a[124:127],v228 offset:1280
v_mfma_f32_16x16x32_bf16 v[160:163],a[128:131],a[88:91],v[160:163]
v_exp_f32 v224,v148
v_mfma_f32_16x16x32_bf16 v[164:167],a[132:135],a[88:91],v[164:167]
v_exp_f32 v225,v149
v_mfma_f32_16x16x32_bf16 v[160:163],a[136:139],a[92:95],v[160:163]
ds_read_b128 a[128:131],v228 offset:512
ds_read_b128 a[132:135],v228 offset:1536
v_mfma_f32_16x16x32_bf16 v[164:167],a[140:143],a[92:95],v[164:167]
ds_read_b128 a[136:139],v228 offset:768
s_waitcnt lgkmcnt(5)
v_mfma_f32_16x16x32_bf16 v[0:3],a[144:147],v[168:171],v[0:3]
v_exp_f32 v226,v150
v_mfma_f32_16x16x32_bf16 v[4:7],a[148:151],v[168:171],v[4:7]
v_exp_f32 v227,v151
v_mfma_f32_16x16x32_bf16 v[8:11],a[152:155],v[168:171],v[8:11]
v_cvt_pk_bf16_f32 v174,v224,v225
v_cvt_pk_bf16_f32 v175,v226,v227
v_mfma_f32_16x16x32_bf16 v[12:15],a[156:159],v[168:171],v[12:15]
ds_read_b128 a[140:143],v228 offset:1792
s_sub_u32 s35,s48,s46
v_mfma_f32_16x16x32_bf16 v[16:19],a[160:163],v[168:171],v[16:19]
v_exp_f32 v224,v152
v_mfma_f32_16x16x32_bf16 v[20:23],a[164:167],v[168:171],v[20:23]
v_exp_f32 v225,v153
v_mfma_f32_16x16x32_bf16 v[24:27],a[168:171],v[168:171],v[24:27]
v_exp_f32 v226,v154
v_mfma_f32_16x16x32_bf16 v[28:31],a[172:175],v[168:171],v[28:31]
v_exp_f32 v227,v155
v_mfma_f32_16x16x32_bf16 v[208:211],a[180:183],v[172:175],v[212:215]
v_cvt_pk_bf16_f32 v176,v224,v225
v_cvt_pk_bf16_f32 v177,v226,v227
v_mfma_f32_16x16x32_bf16 v[136:139],a[112:115],a[96:99],v[204:207]
v_exp_f32 v224,v156
v_mfma_f32_16x16x32_bf16 v[140:143],a[116:119],a[96:99],v[204:207]
s_add_u32 s35,s35,s42
s_waitcnt lgkmcnt(0)
v_mfma_f32_16x16x32_bf16 v[136:139],a[120:123],a[100:103],v[136:139]
v_cmp_ngt_f32 vcc,s38,v209
v_add_u32 v228,s35,v228
v_mfma_f32_16x16x32_bf16 v[140:143],a[124:127],a[100:103],v[140:143]
s_cbranch_vccnz S_rare_z_13
S_back_z_13:
v_xor_b32 v229,2048,v229
v_mfma_f32_16x16x32_bf16 v[136:139],a[128:131],a[104:107],v[136:139]
v_exp_f32 v225,v157
v_mfma_f32_16x16x32_bf16 v[140:143],a[132:135],a[104:107],v[140:143]
v_exp_f32 v226,v158
v_mfma_f32_16x16x32_bf16 v[136:139],a[136:139],a[108:111],v[136:139]
v_exp_f32 v227,v159
v_mfma_f32_16x16x32_bf16 v[140:143],a[140:143],a[108:111],v[140:143]
v_cvt_pk_bf16_f32 v178,v224,v225
v_cvt_pk_bf16_f32 v179,v226,v227
v_mfma_f32_16x16x32_bf16 v[32:35],a[144:147],v[172:175],v[32:35]
v_exp_f32 v224,v160
v_mfma_f32_16x16x32_bf16 v[36:39],a[148:151],v[172:175],v[36:39]
v_exp_f32 v225,v161
v_mfma_f32_16x16x32_bf16 v[40:43],a[152:155],v[172:175],v[40:43]
v_exp_f32 v226,v162
v_mfma_f32_16x16x32_bf16 v[44:47],a[156:159],v[172:175],v[44:47]
v_exp_f32 v227,v163
v_mfma_f32_16x16x32_bf16 v[48:51],a[160:163],v[172:175],v[48:51]
v_cvt_pk_bf16_f32 v180,v224,v225
v_cvt_pk_bf16_f32 v181,v226,v227
v_mfma_f32_16x16x32_bf16 v[52:55],a[164:167],v[172:175],v[52:55]
v_exp_f32 v224,v164
v_mfma_f32_16x16x32_bf16 v[56:59],a[168:171],v[172:175],v[56:59]
v_exp_f32 v225,v165
v_mfma_f32_16x16x32_bf16 v[60:63],a[172:175],v[172:175],v[60:63]
v_exp_f32 v226,v166
v_mfma_f32_16x16x32_bf16 v[212:215],a[184:187],v[176:179],v[208:211]
v_exp_f32 v227,v167
v_mfma_f32_16x16x32_bf16 v[128:131],a[112:115],a[32:35],v[188:191]
v_cvt_pk_bf16_f32 v182,v224,v225
v_cvt_pk_bf16_f32 v183,v226,v227
v_mfma_f32_16x16x32_bf16 v[132:135],a[116:119],a[32:35],v[188:191]
v_exp_f32 v224,v136
v_mfma_f32_16x16x32_bf16 v[128:131],a[120:123],a[36:39],v[128:131]
v_exp_f32 v225,v137
v_mfma_f32_16x16x32_bf16 v[132:135],a[124:127],a[36:39],v[132:135]
v_cmp_ngt_f32 vcc,s38,v214
v_xor_b32 v230,2048,v230
v_mfma_f32_16x16x32_bf16 v[128:131],a[128:131],a[40:43],v[128:131]
s_cbranch_vccnz S_rare_z_14
S_back_z_14:
s_mov_b32 s35,s44
v_mfma_f32_16x16x32_bf16 v[132:135],a[132:135],a[40:43],v[132:135]
v_exp_f32 v226,v138
v_mfma_f32_16x16x32_bf16 v[128:131],a[136:139],a[44:47],v[128:131]
v_exp_f32 v227,v139
v_mfma_f32_16x16x32_bf16 v[132:135],a[140:143],a[44:47],v[132:135]
v_cvt_pk_bf16_f32 v184,v224,v225
v_cvt_pk_bf16_f32 v185,v226,v227
v_mfma_f32_16x16x32_bf16 v[64:67],a[144:147],v[176:179],v[64:67]
v_exp_f32 v224,v140
v_mfma_f32_16x16x32_bf16 v[68:71],a[148:151],v[176:179],v[68:71]
v_exp_f32 v225,v141
v_mfma_f32_16x16x32_bf16 v[72:75],a[152:155],v[176:179],v[72:75]
v_exp_f32 v226,v142
v_mfma_f32_16x16x32_bf16 v[76:79],a[156:159],v[176:179],v[76:79]
v_exp_f32 v227,v143
v_mfma_f32_16x16x32_bf16 v[80:83],a[160:163],v[176:179],v[80:83]
v_cvt_pk_bf16_f32 v186,v224,v225
v_cvt_pk_bf16_f32 v187,v226,v227
v_mfma_f32_16x16x32_bf16 v[84:87],a[164:167],v[176:179],v[84:87]
v_exp_f32 v224,v128
v_mfma_f32_16x16x32_bf16 v[88:91],a[168:171],v[176:179],v[88:91]
v_exp_f32 v225,v129
v_mfma_f32_16x16x32_bf16 v[92:95],a[172:175],v[176:179],v[92:95]
v_exp_f32 v226,v130
v_mfma_f32_16x16x32_bf16 v[208:211],a[188:191],v[180:183],v[212:215]
v_exp_f32 v227,v131
v_mfma_f32_16x16x32_bf16 v[144:147],a[112:115],a[48:51],v[192:195]
v_cvt_pk_bf16_f32 v168,v224,v225
v_cvt_pk_bf16_f32 v169,v226,v227
v_mfma_f32_16x16x32_bf16 v[148:151],a[116:119],a[48:51],v[192:195]
v_exp_f32 v224,v132
v_mfma_f32_16x16x32_bf16 v[144:147],a[120:123],a[52:55],v[144:147]
v_exp_f32 v225,v133
v_mfma_f32_16x16x32_bf16 v[148:151],a[124:127],a[52:55],v[148:151]
v_cmp_ngt_f32 vcc,s38,v211
s_mov_b32 s28,s45
v_mfma_f32_16x16x32_bf16 v[144:147],a[128:131],a[56:59],v[144:147]
s_cbranch_vccnz S_rare_z_15
S_back_z_15:
s_mov_b32 s44,s46
v_mfma_f32_16x16x32_bf16 v[148:151],a[132:135],a[56:59],v[148:151]
v_exp_f32 v226,v134
v_mfma_f32_16x16x32_bf16 v[144:147],a[136:139],a[60:63],v[144:147]
v_exp_f32 v227,v135
v_mfma_f32_16x16x32_bf16 v[148:151],a[140:143],a[60:63],v[148:151]
v_cvt_pk_bf16_f32 v170,v224,v225
v_cvt_pk_bf16_f32 v171,v226,v227
v_mfma_f32_16x16x32_bf16 v[96:99],a[144:147],v[180:183],v[96:99]
ds_read_b64_tr_b16 a[144:145],v229
ds_read_b64_tr_b16 a[146:147],v229 offset:1024
v_mfma_f32_16x16x32_bf16 v[100:103],a[148:151],v[180:183],v[100:103]
ds_read_b64_tr_b16 a[148:149],v230
ds_read_b64_tr_b16 a[150:151],v230 offset:1024
v_mfma_f32_16x16x32_bf16 v[104:107],a[152:155],v[180:183],v[104:107]
ds_read_b64_tr_b16 a[152:153],v229 offset:256
ds_read_b64_tr_b16 a[154:155],v229 offset:1280
v_mfma_f32_16x16x32_bf16 v[108:111],a[156:159],v[180:183],v[108:111]
ds_read_b64_tr_b16 a[156:157],v230 offset:256
s_mov_b32 s45,s47
v_mfma_f32_16x16x32_bf16 v[112:115],a[160:163],v[180:183],v[112:115]
ds_read_b64_tr_b16 a[158:159],v230 offset:1280
s_mov_b32 s46,s48
v_mfma_f32_16x16x32_bf16 v[116:119],a[164:167],v[180:183],v[116:119]
ds_read_b64_tr_b16 a[160:161],v229 offset:512
s_mov_b32 s47,s35
v_mfma_f32_16x16x32_bf16 v[120:123],a[168:171],v[180:183],v[120:123]
v_exp_f32 v224,v144
v_mfma_f32_16x16x32_bf16 v[124:127],a[172:175],v[180:183],v[124:127]
ds_read_b64_tr_b16 a[162:163],v229 offset:1536
s_mov_b32 s48,s28
v_mfma_f32_16x16x32_bf16 v[216:219],a[176:179],v[184:187],v[220:223]
ds_read_b64_tr_b16 a[164:165],v230 offset:512
s_add_u32 s30,s30,32768
v_mfma_f32_16x16x32_bf16 v[152:155],a[112:115],a[64:67],v[196:199]
v_exp_f32 v225,v145
v_mfma_f32_16x16x32_bf16 v[156:159],a[116:119],a[64:67],v[196:199]
ds_read_b64_tr_b16 a[166:167],v230 offset:1536
ds_read_b64_tr_b16 a[168:169],v229 offset:768
v_mfma_f32_16x16x32_bf16 v[152:155],a[120:123],a[68:71],v[152:155]
v_exp_f32 v226,v146
v_mfma_f32_16x16x32_bf16 v[156:159],a[124:127],a[68:71],v[156:159]
ds_read_b64_tr_b16 a[170:171],v229 offset:1792
ds_read_b64_tr_b16 a[172:173],v230 offset:768
v_mfma_f32_16x16x32_bf16 v[152:155],a[128:131],a[72:75],v[152:155]
v_exp_f32 v227,v147
v_mfma_f32_16x16x32_bf16 v[156:159],a[132:135],a[72:75],v[156:159]
v_cmp_ngt_f32 vcc,s38,v216
ds_read_b64_tr_b16 a[174:175],v230 offset:1792
v_mfma_f32_16x16x32_bf16 v[152:155],a[136:139],a[76:79],v[152:155]
v_cvt_pk_bf16_f32 v172,v224,v225
s_cbranch_vccnz S_rare_z_16
S_back_z_16:
v_mfma_f32_16x16x32_bf16 v[156:159],a[140:143],a[76:79],v[156:159]
v_cvt_pk_bf16_f32 v173,v226,v227
s_waitcnt lgkmcnt(3)
v_mfma_f32_16x16x32_bf16 a[0:3],a[144:147],v[184:187],a[0:3]
v_exp_f32 v224,v148
v_mfma_f32_16x16x32_bf16 a[4:7],a[148:151],v[184:187],a[4:7]
v_exp_f32 v225,v149
v_mfma_f32_16x16x32_bf16 a[8:11],a[152:155],v[184:187],a[8:11]
v_exp_f32 v226,v150
v_mfma_f32_16x16x32_bf16 a[12:15],a[156:159],v[184:187],a[12:15]
v_exp_f32 v227,v151
v_mfma_f32_16x16x32_bf16 a[16:19],a[160:163],v[184:187],a[16:19]
v_cvt_pk_bf16_f32 v174,v224,v225
v_cvt_pk_bf16_f32 v175,v226,v227
v_mfma_f32_16x16x32_bf16 a[20:23],a[164:167],v[184:187],a[20:23]
s_waitcnt lgkmcnt(0)
v_mfma_f32_16x16x32_bf16 a[24:27],a[168:171],v[184:187],a[24:27]
v_exp_f32 v224,v152
v_mfma_f32_16x16x32_bf16 a[28:31],a[172:175],v[184:187],a[28:31]
v_exp_f32 v225,v153
v_mfma_f32_16x16x32_bf16 v[212:215],a[176:179],v[168:171],v[208:211]
v_exp_f32 v226,v154
v_mfma_f32_16x16x32_bf16 v[160:163],a[112:115],a[80:83],v[200:203]
v_exp_f32 v227,v155
v_mfma_f32_16x16x32_bf16 v[164:167],a[116:119],a[80:83],v[200:203]
v_cvt_pk_bf16_f32 v176,v224,v225
v_cvt_pk_bf16_f32 v177,v226,v227
v_mfma_f32_16x16x32_bf16 v[160:163],a[120:123],a[84:87],v[160:163]
v_exp_f32 v224,v156
v_mfma_f32_16x16x32_bf16 v[164:167],a[124:127],a[84:87],v[164:167]
v_exp_f32 v225,v157
v_mfma_f32_16x16x32_bf16 v[160:163],a[128:131],a[88:91],v[160:163]
v_exp_f32 v226,v158
v_mfma_f32_16x16x32_bf16 v[164:167],a[132:135],a[88:91],v[164:167]
v_exp_f32 v227,v159
v_mfma_f32_16x16x32_bf16 v[160:163],a[136:139],a[92:95],v[160:163]
v_cmp_ngt_f32 vcc,s38,v212
v_cvt_pk_bf16_f32 v178,v224,v225
v_mfma_f32_16x16x32_bf16 v[164:167],a[140:143],a[92:95],v[164:167]
v_cvt_pk_bf16_f32 v179,v226,v227
s_cbranch_vccnz S_rare_z_17
S_back_z_17:
s_waitcnt lgkmcnt(0)
s_barrier
v_mfma_f32_16x16x32_bf16 v[208:211],a[180:183],v[172:175],v[212:215]
v_exp_f32 v224,v160
v_and_b32 v135,0xf00,v234
v_mfma_f32_16x16x32_bf16 v[0:3],a[144:147],v[168:171],v[0:3]
v_exp_f32 v225,v161
v_add3_u32 v134,v135,v234,s44
v_mfma_f32_16x16x32_bf16 v[4:7],a[148:151],v[168:171],v[4:7]
v_exp_f32 v226,v162
v_xor_b32 v135,64,v134
v_mfma_f32_16x16x32_bf16 v[8:11],a[152:155],v[168:171],v[8:11]
v_cmp_ngt_f32 vcc,s38,v209
v_exp_f32 v227,v163
v_mfma_f32_16x16x32_bf16 v[12:15],a[156:159],v[168:171],v[12:15]
s_cbranch_vccnz S_rare_tail_15
S_back_tail_15:
v_cvt_pk_bf16_f32 v180,v224,v225
v_cvt_pk_bf16_f32 v181,v226,v227
v_mfma_f32_16x16x32_bf16 v[16:19],a[160:163],v[168:171],v[16:19]
v_exp_f32 v224,v164
ds_write_b128 v134,a[0:3]
v_mfma_f32_16x16x32_bf16 v[20:23],a[164:167],v[168:171],v[20:23]
v_exp_f32 v225,v165
ds_write_b128 v135,a[4:7]
v_mfma_f32_16x16x32_bf16 v[24:27],a[168:171],v[168:171],v[24:27]
v_exp_f32 v226,v166
ds_write_b128 v134,a[8:11] offset:128
v_mfma_f32_16x16x32_bf16 v[28:31],a[172:175],v[168:171],v[28:31]
v_exp_f32 v227,v167
v_cvt_pk_bf16_f32 v182,v224,v225
v_mfma_f32_16x16x32_bf16 v[212:215],a[184:187],v[176:179],v[208:211]
v_cvt_pk_bf16_f32 v183,v226,v227
ds_write_b128 v135,a[12:15] offset:128
ds_write_b128 v134,a[16:19] offset:256
v_mfma_f32_16x16x32_bf16 v[32:35],a[144:147],v[172:175],v[32:35]
ds_write_b128 v135,a[20:23] offset:256
ds_write_b128 v134,a[24:27] offset:384
ds_write_b128 v135,a[28:31] offset:384
v_mfma_f32_16x16x32_bf16 v[36:39],a[148:151],v[172:175],v[36:39]
v_cmp_ngt_f32 vcc,s38,v214
v_add_u32 v140,s45,v238
v_mov_b32 v205,v216
v_mfma_f32_16x16x32_bf16 v[40:43],a[152:155],v[172:175],v[40:43]
s_cbranch_vccnz S_rare_tail_16
S_back_tail_16:
ds_write_b64 v140,v[204:205] offset:6144
v_add_u32 v130,s45,v233
v_mfma_f32_16x16x32_bf16 v[44:47],a[156:159],v[172:175],v[44:47]
v_xor_b32 v131,64,v130
v_add_u32 v128,s45,v235
v_xor_b32 v129,64,v128
v_mfma_f32_16x16x32_bf16 v[48:51],a[160:163],v[172:175],v[48:51]
v_add_u32 v132,s45,v234
v_xor_b32 v133,64,v132
v_add_u32 v142,s45,v236
v_mfma_f32_16x16x32_bf16 v[52:55],a[164:167],v[172:175],v[52:55]
v_xor_b32 v143,64,v142
v_add_u32 v136,s44,v237
v_xor_b32 v137,16,v136
v_mfma_f32_16x16x32_bf16 v[56:59],a[168:171],v[172:175],v[56:59]
v_xor_b32 v138,64,v136
v_xor_b32 v139,0x50,v136
v_add_u32 v141,s45,v239
v_mfma_f32_16x16x32_bf16 v[60:63],a[172:175],v[172:175],v[60:63]
v_mfma_f32_16x16x32_bf16 v[208:211],a[188:191],v[180:183],v[212:215]
v_mfma_f32_16x16x32_bf16 v[64:67],a[144:147],v[176:179],v[64:67]
v_mfma_f32_16x16x32_bf16 v[68:71],a[148:151],v[176:179],v[68:71]
v_mfma_f32_16x16x32_bf16 v[72:75],a[152:155],v[176:179],v[72:75]
v_mfma_f32_16x16x32_bf16 v[76:79],a[156:159],v[176:179],v[76:79]
v_mfma_f32_16x16x32_bf16 v[80:83],a[160:163],v[176:179],v[80:83]
v_mfma_f32_16x16x32_bf16 v[84:87],a[164:167],v[176:179],v[84:87]
v_mfma_f32_16x16x32_bf16 v[88:91],a[168:171],v[176:179],v[88:91]
s_nop 0
v_cmp_ngt_f32 vcc,s38,v211
v_mfma_f32_16x16x32_bf16 v[92:95],a[172:175],v[176:179],v[92:95]
s_cbranch_vccnz S_rare_tail_17
S_back_tail_17:
v_mfma_f32_16x16x32_bf16 v[96:99],a[144:147],v[180:183],v[96:99]
v_mfma_f32_16x16x32_bf16 v[100:103],a[148:151],v[180:183],v[100:103]
v_mfma_f32_16x16x32_bf16 v[104:107],a[152:155],v[180:183],v[104:107]
v_mfma_f32_16x16x32_bf16 v[108:111],a[156:159],v[180:183],v[108:111]
v_mfma_f32_16x16x32_bf16 v[112:115],a[160:163],v[180:183],v[112:115]
v_mfma_f32_16x16x32_bf16 v[116:119],a[164:167],v[180:183],v[116:119]
v_mfma_f32_16x16x32_bf16 v[120:123],a[168:171],v[180:183],v[120:123]
v_mfma_f32_16x16x32_bf16 v[124:127],a[172:175],v[180:183],v[124:127]
s_waitcnt vmcnt(32)
v_lshlrev_b32 v188,16,v240
v_and_b32 v189,0xffff0000,v240
v_lshlrev_b32 v190,16,v241
v_and_b32 v191,0xffff0000,v241
v_lshlrev_b32 v192,16,v242
v_and_b32 v193,0xffff0000,v242
v_lshlrev_b32 v194,16,v243
v_and_b32 v195,0xffff0000,v243
v_pk_mul_f32 v[188:189],v[188:189],s[80:81]
v_pk_mul_f32 v[190:191],v[190:191],s[80:81]
v_pk_mul_f32 v[192:193],v[192:193],s[80:81]
v_pk_mul_f32 v[194:195],v[194:195],s[80:81]
v_cvt_pk_bf16_f32 v240,v188,v189
v_cvt_pk_bf16_f32 v241,v190,v191
v_cvt_pk_bf16_f32 v242,v192,v193
v_cvt_pk_bf16_f32 v243,v194,v195
ds_write_b128 v130,v[240:243] offset:4096
v_lshlrev_b32 v188,16,v244
v_and_b32 v189,0xffff0000,v244
v_lshlrev_b32 v190,16,v245
v_and_b32 v191,0xffff0000,v245
v_lshlrev_b32 v192,16,v246
v_and_b32 v193,0xffff0000,v246
v_lshlrev_b32 v194,16,v247
v_and_b32 v195,0xffff0000,v247
v_pk_mul_f32 v[188:189],v[188:189],s[80:81]
v_pk_mul_f32 v[190:191],v[190:191],s[80:81]
v_pk_mul_f32 v[192:193],v[192:193],s[80:81]
v_pk_mul_f32 v[194:195],v[194:195],s[80:81]
v_cvt_pk_bf16_f32 v244,v188,v189
v_cvt_pk_bf16_f32 v245,v190,v191
v_cvt_pk_bf16_f32 v246,v192,v193
v_cvt_pk_bf16_f32 v247,v194,v195
ds_write_b128 v131,v[244:247] offset:5120
v_rcp_f32 v248,v208
v_rcp_f32 v249,v209
v_rcp_f32 v250,v210
v_rcp_f32 v251,v211
s_waitcnt lgkmcnt(0)
s_barrier
ds_read_b128 v[176:179],v141 offset:6144
v_pk_mul_f32 v[0:1],v[0:1],v[248:249] op_sel:[0,0] op_sel_hi:[1,0]
v_pk_mul_f32 v[2:3],v[2:3],v[248:249] op_sel:[0,0] op_sel_hi:[1,0]
v_xor_b32 v141,0x2000,v141
v_pk_mul_f32 v[4:5],v[4:5],v[248:249] op_sel:[0,0] op_sel_hi:[1,0]
v_pk_mul_f32 v[6:7],v[6:7],v[248:249] op_sel:[0,0] op_sel_hi:[1,0]
v_cvt_pk_bf16_f32 v0,v0,v1
ds_read_b128 v[180:183],v141 offset:6144
v_cvt_pk_bf16_f32 v1,v2,v3
v_cvt_pk_bf16_f32 v2,v4,v5
v_cvt_pk_bf16_f32 v3,v6,v7
ds_read_b128 v[144:147],v136
v_pk_mul_f32 v[8:9],v[8:9],v[248:249] op_sel:[0,0] op_sel_hi:[1,0]
v_pk_mul_f32 v[10:11],v[10:11],v[248:249] op_sel:[0,0] op_sel_hi:[1,0]
ds_read_b128 v[148:151],v137
v_pk_mul_f32 v[12:13],v[12:13],v[248:249] op_sel:[0,0] op_sel_hi:[1,0]
v_pk_mul_f32 v[14:15],v[14:15],v[248:249] op_sel:[0,0] op_sel_hi:[1,0]
v_permlane16_swap_b32 v0,v2
ds_read_b128 v[152:155],v138 offset:2048
v_permlane16_swap_b32 v1,v3
ds_write_b128 v128,v[0:3]
v_cvt_pk_bf16_f32 v8,v8,v9
ds_read_b128 v[156:159],v139 offset:2048
v_cvt_pk_bf16_f32 v9,v10,v11
v_cvt_pk_bf16_f32 v10,v12,v13
v_cvt_pk_bf16_f32 v11,v14,v15
v_xor_b32 v136,0x2000,v136
ds_read_b128 v[160:163],v136
v_pk_mul_f32 v[16:17],v[16:17],v[248:249] op_sel:[0,0] op_sel_hi:[1,0]
v_pk_mul_f32 v[18:19],v[18:19],v[248:249] op_sel:[0,0] op_sel_hi:[1,0]
v_xor_b32 v137,0x2000,v137
ds_read_b128 v[164:167],v137
v_pk_mul_f32 v[20:21],v[20:21],v[248:249] op_sel:[0,0] op_sel_hi:[1,0]
v_pk_mul_f32 v[22:23],v[22:23],v[248:249] op_sel:[0,0] op_sel_hi:[1,0]
v_permlane16_swap_b32 v8,v10
v_xor_b32 v138,0x2000,v138
ds_read_b128 v[168:171],v138 offset:2048
v_permlane16_swap_b32 v9,v11
ds_write_b128 v129,v[8:11]
v_cvt_pk_bf16_f32 v16,v16,v17
v_xor_b32 v139,0x2000,v139
ds_read_b128 v[172:175],v139 offset:2048
v_cvt_pk_bf16_f32 v17,v18,v19
v_cvt_pk_bf16_f32 v18,v20,v21
v_cvt_pk_bf16_f32 v19,v22,v23
ds_read_b128 a[96:99],v142 offset:4096
v_pk_mul_f32 v[24:25],v[24:25],v[248:249] op_sel:[0,0] op_sel_hi:[1,0]
v_pk_mul_f32 v[26:27],v[26:27],v[248:249] op_sel:[0,0] op_sel_hi:[1,0]
ds_read_b128 a[100:103],v143 offset:4096
v_pk_mul_f32 v[28:29],v[28:29],v[248:249] op_sel:[0,0] op_sel_hi:[1,0]
v_pk_mul_f32 v[30:31],v[30:31],v[248:249] op_sel:[0,0] op_sel_hi:[1,0]
v_permlane16_swap_b32 v16,v18
ds_read_b128 a[104:107],v142 offset:4224
v_permlane16_swap_b32 v17,v19
ds_write_b128 v128,v[16:19] offset:128
v_cvt_pk_bf16_f32 v24,v24,v25
ds_read_b128 a[108:111],v143 offset:4224
v_cvt_pk_bf16_f32 v25,v26,v27
v_cvt_pk_bf16_f32 v26,v28,v29
v_cvt_pk_bf16_f32 v27,v30,v31
v_pk_mul_f32 v[32:33],v[32:33],v[248:249] op_sel:[0,1] op_sel_hi:[1,1]
v_pk_mul_f32 v[34:35],v[34:35],v[248:249] op_sel:[0,1] op_sel_hi:[1,1]
v_pk_mul_f32 v[36:37],v[36:37],v[248:249] op_sel:[0,1] op_sel_hi:[1,1]
v_pk_mul_f32 v[38:39],v[38:39],v[248:249] op_sel:[0,1] op_sel_hi:[1,1]
v_permlane16_swap_b32 v24,v26
v_permlane16_swap_b32 v25,v27
ds_write_b128 v129,v[24:27] offset:128
ds_read_b128 v[4:7],v130
ds_read_b128 v[12:15],v131 offset:1024
ds_read_b128 v[20:23],v130 offset:2048
ds_read_b128 v[28:31],v131 offset:3072
v_cvt_pk_bf16_f32 v32,v32,v33
v_cvt_pk_bf16_f32 v33,v34,v35
v_cvt_pk_bf16_f32 v34,v36,v37
v_cvt_pk_bf16_f32 v35,v38,v39
v_pk_mul_f32 v[40:41],v[40:41],v[248:249] op_sel:[0,1] op_sel_hi:[1,1]
v_pk_mul_f32 v[42:43],v[42:43],v[248:249] op_sel:[0,1] op_sel_hi:[1,1]
v_pk_mul_f32 v[44:45],v[44:45],v[248:249] op_sel:[0,1] op_sel_hi:[1,1]
v_pk_mul_f32 v[46:47],v[46:47],v[248:249] op_sel:[0,1] op_sel_hi:[1,1]
v_permlane16_swap_b32 v32,v34
v_permlane16_swap_b32 v33,v35
ds_write_b128 v128,v[32:35]
v_cvt_pk_bf16_f32 v40,v40,v41
v_cvt_pk_bf16_f32 v41,v42,v43
v_cvt_pk_bf16_f32 v42,v44,v45
v_cvt_pk_bf16_f32 v43,v46,v47
v_pk_mul_f32 v[48:49],v[48:49],v[248:249] op_sel:[0,1] op_sel_hi:[1,1]
v_pk_mul_f32 v[50:51],v[50:51],v[248:249] op_sel:[0,1] op_sel_hi:[1,1]
s_waitcnt lgkmcnt(4)
buffer_store_dwordx4 v[4:7],v232,s[24:27],s72 offen nt
v_pk_mul_f32 v[52:53],v[52:53],v[248:249] op_sel:[0,1] op_sel_hi:[1,1]
v_pk_mul_f32 v[54:55],v[54:55],v[248:249] op_sel:[0,1] op_sel_hi:[1,1]
v_permlane16_swap_b32 v40,v42
v_permlane16_swap_b32 v41,v43
ds_write_b128 v129,v[40:43]
s_waitcnt lgkmcnt(4)
buffer_store_dwordx4 v[12:15],v232,s[24:27],s72 offen offset:1024 nt
v_cvt_pk_bf16_f32 v48,v48,v49
v_cvt_pk_bf16_f32 v49,v50,v51
v_cvt_pk_bf16_f32 v50,v52,v53
v_cvt_pk_bf16_f32 v51,v54,v55
v_pk_mul_f32 v[56:57],v[56:57],v[248:249] op_sel:[0,1] op_sel_hi:[1,1]
s_waitcnt lgkmcnt(3)
buffer_store_dwordx4 v[20:23],v232,s[24:27],s72 offen offset:2048 nt
v_pk_mul_f32 v[58:59],v[58:59],v[248:249] op_sel:[0,1] op_sel_hi:[1,1]
v_pk_mul_f32 v[60:61],v[60:61],v[248:249] op_sel:[0,1] op_sel_hi:[1,1]
v_pk_mul_f32 v[62:63],v[62:63],v[248:249] op_sel:[0,1] op_sel_hi:[1,1]
v_permlane16_swap_b32 v48,v50
v_permlane16_swap_b32 v49,v51
s_waitcnt lgkmcnt(2)
buffer_store_dwordx4 v[28:31],v232,s[24:27],s72 offen offset:3072 nt
ds_write_b128 v128,v[48:51] offset:128
v_cvt_pk_bf16_f32 v56,v56,v57
v_cvt_pk_bf16_f32 v57,v58,v59
v_cvt_pk_bf16_f32 v58,v60,v61
v_cvt_pk_bf16_f32 v59,v62,v63
v_pk_mul_f32 v[64:65],v[64:65],v[250:251] op_sel:[0,0] op_sel_hi:[1,0]
v_pk_mul_f32 v[66:67],v[66:67],v[250:251] op_sel:[0,0] op_sel_hi:[1,0]
v_pk_mul_f32 v[68:69],v[68:69],v[250:251] op_sel:[0,0] op_sel_hi:[1,0]
v_pk_mul_f32 v[70:71],v[70:71],v[250:251] op_sel:[0,0] op_sel_hi:[1,0]
v_permlane16_swap_b32 v56,v58
v_permlane16_swap_b32 v57,v59
ds_write_b128 v129,v[56:59] offset:128
ds_read_b128 v[36:39],v130
ds_read_b128 v[44:47],v131 offset:1024
ds_read_b128 v[52:55],v130 offset:2048
ds_read_b128 v[60:63],v131 offset:3072
v_cvt_pk_bf16_f32 v64,v64,v65
v_cvt_pk_bf16_f32 v65,v66,v67
v_cvt_pk_bf16_f32 v66,v68,v69
v_cvt_pk_bf16_f32 v67,v70,v71
v_pk_mul_f32 v[72:73],v[72:73],v[250:251] op_sel:[0,0] op_sel_hi:[1,0]
v_pk_mul_f32 v[74:75],v[74:75],v[250:251] op_sel:[0,0] op_sel_hi:[1,0]
v_pk_mul_f32 v[76:77],v[76:77],v[250:251] op_sel:[0,0] op_sel_hi:[1,0]
v_pk_mul_f32 v[78:79],v[78:79],v[250:251] op_sel:[0,0] op_sel_hi:[1,0]
v_permlane16_swap_b32 v64,v66
v_permlane16_swap_b32 v65,v67
ds_write_b128 v128,v[64:67]
v_cvt_pk_bf16_f32 v72,v72,v73
v_cvt_pk_bf16_f32 v73,v74,v75
v_cvt_pk_bf16_f32 v74,v76,v77
v_cvt_pk_bf16_f32 v75,v78,v79
v_pk_mul_f32 v[80:81],v[80:81],v[250:251] op_sel:[0,0] op_sel_hi:[1,0]
v_pk_mul_f32 v[82:83],v[82:83],v[250:251] op_sel:[0,0] op_sel_hi:[1,0]
s_waitcnt lgkmcnt(4)
buffer_store_dwordx4 v[36:39],v232,s[24:27],s73 offen nt
v_pk_mul_f32 v[84:85],v[84:85],v[250:251] op_sel:[0,0] op_sel_hi:[1,0]
v_pk_mul_f32 v[86:87],v[86:87],v[250:251] op_sel:[0,0] op_sel_hi:[1,0]
v_permlane16_swap_b32 v72,v74
v_permlane16_swap_b32 v73,v75
ds_write_b128 v129,v[72:75]
s_waitcnt lgkmcnt(4)
buffer_store_dwordx4 v[44:47],v232,s[24:27],s73 offen offset:1024 nt
v_cvt_pk_bf16_f32 v80,v80,v81
v_cvt_pk_bf16_f32 v81,v82,v83
v_cvt_pk_bf16_f32 v82,v84,v85
v_cvt_pk_bf16_f32 v83,v86,v87
v_pk_mul_f32 v[88:89],v[88:89],v[250:251] op_sel:[0,0] op_sel_hi:[1,0]
s_waitcnt lgkmcnt(3)
buffer_store_dwordx4 v[52:55],v232,s[24:27],s73 offen offset:2048 nt
v_pk_mul_f32 v[90:91],v[90:91],v[250:251] op_sel:[0,0] op_sel_hi:[1,0]
v_pk_mul_f32 v[92:93],v[92:93],v[250:251] op_sel:[0,0] op_sel_hi:[1,0]
v_pk_mul_f32 v[94:95],v[94:95],v[250:251] op_sel:[0,0] op_sel_hi:[1,0]
v_permlane16_swap_b32 v80,v82
v_permlane16_swap_b32 v81,v83
s_waitcnt lgkmcnt(2)
buffer_store_dwordx4 v[60:63],v232,s[24:27],s73 offen offset:3072 nt
ds_write_b128 v128,v[80:83] offset:128
v_cvt_pk_bf16_f32 v88,v88,v89
v_cvt_pk_bf16_f32 v89,v90,v91
v_cvt_pk_bf16_f32 v90,v92,v93
v_cvt_pk_bf16_f32 v91,v94,v95
v_pk_mul_f32 v[96:97],v[96:97],v[250:251] op_sel:[0,1] op_sel_hi:[1,1]
v_pk_mul_f32 v[98:99],v[98:99],v[250:251] op_sel:[0,1] op_sel_hi:[1,1]
v_pk_mul_f32 v[100:101],v[100:101],v[250:251] op_sel:[0,1] op_sel_hi:[1,1]
v_pk_mul_f32 v[102:103],v[102:103],v[250:251] op_sel:[0,1] op_sel_hi:[1,1]
v_permlane16_swap_b32 v88,v90
v_permlane16_swap_b32 v89,v91
ds_write_b128 v129,v[88:91] offset:128
ds_read_b128 v[68:71],v130
ds_read_b128 v[76:79],v131 offset:1024
ds_read_b128 v[84:87],v130 offset:2048
ds_read_b128 v[92:95],v131 offset:3072
v_cvt_pk_bf16_f32 v96,v96,v97
v_cvt_pk_bf16_f32 v97,v98,v99
v_cvt_pk_bf16_f32 v98,v100,v101
v_cvt_pk_bf16_f32 v99,v102,v103
v_pk_mul_f32 v[104:105],v[104:105],v[250:251] op_sel:[0,1] op_sel_hi:[1,1]
v_pk_mul_f32 v[106:107],v[106:107],v[250:251] op_sel:[0,1] op_sel_hi:[1,1]
v_pk_mul_f32 v[108:109],v[108:109],v[250:251] op_sel:[0,1] op_sel_hi:[1,1]
v_pk_mul_f32 v[110:111],v[110:111],v[250:251] op_sel:[0,1] op_sel_hi:[1,1]
v_permlane16_swap_b32 v96,v98
v_permlane16_swap_b32 v97,v99
ds_write_b128 v128,v[96:99]
v_cvt_pk_bf16_f32 v104,v104,v105
v_cvt_pk_bf16_f32 v105,v106,v107
v_cvt_pk_bf16_f32 v106,v108,v109
v_cvt_pk_bf16_f32 v107,v110,v111
v_pk_mul_f32 v[112:113],v[112:113],v[250:251] op_sel:[0,1] op_sel_hi:[1,1]
v_pk_mul_f32 v[114:115],v[114:115],v[250:251] op_sel:[0,1] op_sel_hi:[1,1]
s_waitcnt lgkmcnt(4)
buffer_store_dwordx4 v[68:71],v232,s[24:27],s74 offen nt
v_pk_mul_f32 v[116:117],v[116:117],v[250:251] op_sel:[0,1] op_sel_hi:[1,1]
v_pk_mul_f32 v[118:119],v[118:119],v[250:251] op_sel:[0,1] op_sel_hi:[1,1]
v_permlane16_swap_b32 v104,v106
v_permlane16_swap_b32 v105,v107
ds_write_b128 v129,v[104:107]
s_waitcnt lgkmcnt(4)
buffer_store_dwordx4 v[76:79],v232,s[24:27],s74 offen offset:1024 nt
v_cvt_pk_bf16_f32 v112,v112,v113
v_cvt_pk_bf16_f32 v113,v114,v115
v_cvt_pk_bf16_f32 v114,v116,v117
v_cvt_pk_bf16_f32 v115,v118,v119
v_pk_mul_f32 v[120:121],v[120:121],v[250:251] op_sel:[0,1] op_sel_hi:[1,1]
s_waitcnt lgkmcnt(3)
buffer_store_dwordx4 v[84:87],v232,s[24:27],s74 offen offset:2048 nt
v_pk_mul_f32 v[122:123],v[122:123],v[250:251] op_sel:[0,1] op_sel_hi:[1,1]
v_pk_mul_f32 v[124:125],v[124:125],v[250:251] op_sel:[0,1] op_sel_hi:[1,1]
v_pk_mul_f32 v[126:127],v[126:127],v[250:251] op_sel:[0,1] op_sel_hi:[1,1]
v_permlane16_swap_b32 v112,v114
v_permlane16_swap_b32 v113,v115
s_waitcnt lgkmcnt(2)
buffer_store_dwordx4 v[92:95],v232,s[24:27],s74 offen offset:3072 nt
ds_write_b128 v128,v[112:115] offset:128
v_cvt_pk_bf16_f32 v120,v120,v121
v_cvt_pk_bf16_f32 v121,v122,v123
v_cvt_pk_bf16_f32 v122,v124,v125
v_cvt_pk_bf16_f32 v123,v126,v127
v_min_f32 v252,v176,v180
v_min_f32 v253,v178,v182
v_sub_f32 v176,v252,v176
v_sub_f32 v178,v253,v178
v_permlane16_swap_b32 v120,v122
v_permlane16_swap_b32 v121,v123
ds_write_b128 v129,v[120:123] offset:128
ds_read_b128 v[100:103],v130
ds_read_b128 v[108:111],v131 offset:1024
ds_read_b128 v[116:119],v130 offset:2048
ds_read_b128 v[124:127],v131 offset:3072
v_sub_f32 v180,v252,v180
v_sub_f32 v182,v253,v182
v_exp_f32 v176,v176
v_exp_f32 v178,v178
v_exp_f32 v180,v180
v_exp_f32 v182,v182
v_mul_f32 v252,v176,v177
v_mul_f32 v253,v178,v179
v_fmac_f32 v252,v180,v181
v_fmac_f32 v253,v182,v183
v_rcp_f32 v252,v252
v_rcp_f32 v253,v253
v_mul_f32 v176,v176,v252
v_mul_f32 v178,v178,v253
v_mul_f32 v180,v180,v252
v_mul_f32 v182,v182,v253
v_mul_f32 v144,v144,v176
v_mul_f32 v145,v145,v176
v_mul_f32 v146,v146,v176
v_mul_f32 v147,v147,v176
v_mul_f32 v148,v148,v176
v_mul_f32 v149,v149,v176
v_mul_f32 v150,v150,v176
v_mul_f32 v151,v151,v176
v_mul_f32 v152,v152,v178
v_mul_f32 v153,v153,v178
v_mul_f32 v154,v154,v178
s_waitcnt lgkmcnt(3)
buffer_store_dwordx4 v[100:103],v232,s[24:27],s75 offen nt
v_mul_f32 v155,v155,v178
v_mul_f32 v156,v156,v178
v_mul_f32 v157,v157,v178
v_mul_f32 v158,v158,v178
v_mul_f32 v159,v159,v178
v_fmac_f32 v144,v160,v180
v_fmac_f32 v145,v161,v180
s_waitcnt lgkmcnt(2)
buffer_store_dwordx4 v[108:111],v232,s[24:27],s75 offen offset:1024 nt
v_fmac_f32 v146,v162,v180
v_fmac_f32 v147,v163,v180
v_fmac_f32 v148,v164,v180
v_fmac_f32 v149,v165,v180
v_fmac_f32 v150,v166,v180
v_fmac_f32 v151,v167,v180
v_fmac_f32 v152,v168,v182
v_fmac_f32 v153,v169,v182
s_waitcnt lgkmcnt(1)
buffer_store_dwordx4 v[116:119],v232,s[24:27],s75 offen offset:2048 nt
v_fmac_f32 v154,v170,v182
v_fmac_f32 v155,v171,v182
v_fmac_f32 v156,v172,v182
v_fmac_f32 v157,v173,v182
v_fmac_f32 v158,v174,v182
v_fmac_f32 v159,v175,v182
v_cvt_pk_bf16_f32 v144,v144,v145
s_waitcnt lgkmcnt(0)
buffer_store_dwordx4 v[124:127],v232,s[24:27],s75 offen offset:3072 nt
v_cvt_pk_bf16_f32 v145,v146,v147
v_cvt_pk_bf16_f32 v146,v148,v149
v_cvt_pk_bf16_f32 v147,v150,v151
v_cvt_pk_bf16_f32 v152,v152,v153
v_cvt_pk_bf16_f32 v153,v154,v155
v_cvt_pk_bf16_f32 v154,v156,v157
v_cvt_pk_bf16_f32 v155,v158,v159
buffer_store_dwordx4 v[144:147],v232,s[24:27],s76 offen nt
buffer_store_dwordx4 v[152:155],v232,s[24:27],s76 offen offset:1024 nt
s_add_u32 s43,s43,1
s_cmp_ge_u32 s43,2
s_cbranch_scc1 S_fin
s_waitcnt vmcnt(38)
v_accvgpr_read_b32 v196,a192
v_accvgpr_read_b32 v197,a193
v_accvgpr_read_b32 v198,a194
v_accvgpr_read_b32 v199,a195
v_lshlrev_b32 v188,16,v196
v_and_b32 v189,0xffff0000,v196
v_lshlrev_b32 v190,16,v197
v_and_b32 v191,0xffff0000,v197
v_lshlrev_b32 v192,16,v198
v_and_b32 v193,0xffff0000,v198
v_lshlrev_b32 v194,16,v199
v_and_b32 v195,0xffff0000,v199
v_pk_mul_f32 v[188:189],v[188:189],s[80:81]
v_pk_mul_f32 v[190:191],v[190:191],s[80:81]
v_pk_mul_f32 v[192:193],v[192:193],s[80:81]
v_pk_mul_f32 v[194:195],v[194:195],s[80:81]
v_cvt_pk_bf16_f32 v196,v188,v189
v_cvt_pk_bf16_f32 v197,v190,v191
v_cvt_pk_bf16_f32 v198,v192,v193
v_cvt_pk_bf16_f32 v199,v194,v195
ds_write_b128 v130,v[196:199]
v_accvgpr_read_b32 v224,a196
v_accvgpr_read_b32 v225,a197
v_accvgpr_read_b32 v226,a198
v_accvgpr_read_b32 v227,a199
v_lshlrev_b32 v200,16,v224
v_and_b32 v201,0xffff0000,v224
v_lshlrev_b32 v202,16,v225
v_and_b32 v203,0xffff0000,v225
v_lshlrev_b32 v204,16,v226
v_and_b32 v205,0xffff0000,v226
v_lshlrev_b32 v206,16,v227
v_and_b32 v207,0xffff0000,v227
v_pk_mul_f32 v[200:201],v[200:201],s[80:81]
v_pk_mul_f32 v[202:203],v[202:203],s[80:81]
v_pk_mul_f32 v[204:205],v[204:205],s[80:81]
v_pk_mul_f32 v[206:207],v[206:207],s[80:81]
v_cvt_pk_bf16_f32 v224,v200,v201
v_cvt_pk_bf16_f32 v225,v202,v203
v_cvt_pk_bf16_f32 v226,v204,v205
v_cvt_pk_bf16_f32 v227,v206,v207
ds_write_b128 v131,v[224:227] offset:1024
v_accvgpr_read_b32 v196,a200
v_accvgpr_read_b32 v197,a201
v_accvgpr_read_b32 v198,a202
v_accvgpr_read_b32 v199,a203
v_lshlrev_b32 v188,16,v196
v_and_b32 v189,0xffff0000,v196
v_lshlrev_b32 v190,16,v197
v_and_b32 v191,0xffff0000,v197
v_lshlrev_b32 v192,16,v198
v_and_b32 v193,0xffff0000,v198
v_lshlrev_b32 v194,16,v199
v_and_b32 v195,0xffff0000,v199
v_pk_mul_f32 v[188:189],v[188:189],s[80:81]
v_pk_mul_f32 v[190:191],v[190:191],s[80:81]
v_pk_mul_f32 v[192:193],v[192:193],s[80:81]
v_pk_mul_f32 v[194:195],v[194:195],s[80:81]
v_cvt_pk_bf16_f32 v196,v188,v189
v_cvt_pk_bf16_f32 v197,v190,v191
v_cvt_pk_bf16_f32 v198,v192,v193
v_cvt_pk_bf16_f32 v199,v194,v195
ds_write_b128 v130,v[196:199] offset:2048
v_accvgpr_read_b32 v224,a204
v_accvgpr_read_b32 v225,a205
v_accvgpr_read_b32 v226,a206
v_accvgpr_read_b32 v227,a207
v_lshlrev_b32 v200,16,v224
v_and_b32 v201,0xffff0000,v224
v_lshlrev_b32 v202,16,v225
v_and_b32 v203,0xffff0000,v225
v_lshlrev_b32 v204,16,v226
v_and_b32 v205,0xffff0000,v226
v_lshlrev_b32 v206,16,v227
v_and_b32 v207,0xffff0000,v227
v_pk_mul_f32 v[200:201],v[200:201],s[80:81]
v_pk_mul_f32 v[202:203],v[202:203],s[80:81]
v_pk_mul_f32 v[204:205],v[204:205],s[80:81]
v_pk_mul_f32 v[206:207],v[206:207],s[80:81]
v_cvt_pk_bf16_f32 v224,v200,v201
v_cvt_pk_bf16_f32 v225,v202,v203
v_cvt_pk_bf16_f32 v226,v204,v205
v_cvt_pk_bf16_f32 v227,v206,v207
ds_write_b128 v131,v[224:227] offset:3072
ds_read_b128 a[32:35],v132
ds_read_b128 a[36:39],v133
ds_read_b128 a[40:43],v132 offset:128
ds_read_b128 a[44:47],v133 offset:128
s_waitcnt vmcnt(34)
v_accvgpr_read_b32 v196,a208
v_accvgpr_read_b32 v197,a209
v_accvgpr_read_b32 v198,a210
v_accvgpr_read_b32 v199,a211
v_lshlrev_b32 v188,16,v196
v_and_b32 v189,0xffff0000,v196
v_lshlrev_b32 v190,16,v197
v_and_b32 v191,0xffff0000,v197
v_lshlrev_b32 v192,16,v198
v_and_b32 v193,0xffff0000,v198
v_lshlrev_b32 v194,16,v199
v_and_b32 v195,0xffff0000,v199
v_pk_mul_f32 v[188:189],v[188:189],s[80:81]
v_pk_mul_f32 v[190:191],v[190:191],s[80:81]
v_pk_mul_f32 v[192:193],v[192:193],s[80:81]
v_pk_mul_f32 v[194:195],v[194:195],s[80:81]
v_cvt_pk_bf16_f32 v196,v188,v189
v_cvt_pk_bf16_f32 v197,v190,v191
v_cvt_pk_bf16_f32 v198,v192,v193
v_cvt_pk_bf16_f32 v199,v194,v195
ds_write_b128 v130,v[196:199]
v_accvgpr_read_b32 v224,a212
v_accvgpr_read_b32 v225,a213
v_accvgpr_read_b32 v226,a214
v_accvgpr_read_b32 v227,a215
v_lshlrev_b32 v200,16,v224
v_and_b32 v201,0xffff0000,v224
v_lshlrev_b32 v202,16,v225
v_and_b32 v203,0xffff0000,v225
v_lshlrev_b32 v204,16,v226
v_and_b32 v205,0xffff0000,v226
v_lshlrev_b32 v206,16,v227
v_and_b32 v207,0xffff0000,v227
v_pk_mul_f32 v[200:201],v[200:201],s[80:81]
v_pk_mul_f32 v[202:203],v[202:203],s[80:81]
v_pk_mul_f32 v[204:205],v[204:205],s[80:81]
v_pk_mul_f32 v[206:207],v[206:207],s[80:81]
v_cvt_pk_bf16_f32 v224,v200,v201
v_cvt_pk_bf16_f32 v225,v202,v203
v_cvt_pk_bf16_f32 v226,v204,v205
v_cvt_pk_bf16_f32 v227,v206,v207
ds_write_b128 v131,v[224:227] offset:1024
v_accvgpr_read_b32 v196,a216
v_accvgpr_read_b32 v197,a217
v_accvgpr_read_b32 v198,a218
v_accvgpr_read_b32 v199,a219
v_lshlrev_b32 v188,16,v196
v_and_b32 v189,0xffff0000,v196
v_lshlrev_b32 v190,16,v197
v_and_b32 v191,0xffff0000,v197
v_lshlrev_b32 v192,16,v198
v_and_b32 v193,0xffff0000,v198
v_lshlrev_b32 v194,16,v199
v_and_b32 v195,0xffff0000,v199
v_pk_mul_f32 v[188:189],v[188:189],s[80:81]
v_pk_mul_f32 v[190:191],v[190:191],s[80:81]
v_pk_mul_f32 v[192:193],v[192:193],s[80:81]
v_pk_mul_f32 v[194:195],v[194:195],s[80:81]
v_cvt_pk_bf16_f32 v196,v188,v189
v_cvt_pk_bf16_f32 v197,v190,v191
v_cvt_pk_bf16_f32 v198,v192,v193
v_cvt_pk_bf16_f32 v199,v194,v195
ds_write_b128 v130,v[196:199] offset:2048
v_accvgpr_read_b32 v224,a220
v_accvgpr_read_b32 v225,a221
v_accvgpr_read_b32 v226,a222
v_accvgpr_read_b32 v227,a223
v_lshlrev_b32 v200,16,v224
v_and_b32 v201,0xffff0000,v224
v_lshlrev_b32 v202,16,v225
v_and_b32 v203,0xffff0000,v225
v_lshlrev_b32 v204,16,v226
v_and_b32 v205,0xffff0000,v226
v_lshlrev_b32 v206,16,v227
v_and_b32 v207,0xffff0000,v227
v_pk_mul_f32 v[200:201],v[200:201],s[80:81]
v_pk_mul_f32 v[202:203],v[202:203],s[80:81]
v_pk_mul_f32 v[204:205],v[204:205],s[80:81]
v_pk_mul_f32 v[206:207],v[206:207],s[80:81]
v_cvt_pk_bf16_f32 v224,v200,v201
v_cvt_pk_bf16_f32 v225,v202,v203
v_cvt_pk_bf16_f32 v226,v204,v205
v_cvt_pk_bf16_f32 v227,v206,v207
ds_write_b128 v131,v[224:227] offset:3072
ds_read_b128 a[48:51],v132
ds_read_b128 a[52:55],v133
ds_read_b128 a[56:59],v132 offset:128
ds_read_b128 a[60:63],v133 offset:128
s_waitcnt vmcnt(30)
v_accvgpr_read_b32 v196,a224
v_accvgpr_read_b32 v197,a225
v_accvgpr_read_b32 v198,a226
v_accvgpr_read_b32 v199,a227
v_lshlrev_b32 v188,16,v196
v_and_b32 v189,0xffff0000,v196
v_lshlrev_b32 v190,16,v197
v_and_b32 v191,0xffff0000,v197
v_lshlrev_b32 v192,16,v198
v_and_b32 v193,0xffff0000,v198
v_lshlrev_b32 v194,16,v199
v_and_b32 v195,0xffff0000,v199
v_pk_mul_f32 v[188:189],v[188:189],s[80:81]
v_pk_mul_f32 v[190:191],v[190:191],s[80:81]
v_pk_mul_f32 v[192:193],v[192:193],s[80:81]
v_pk_mul_f32 v[194:195],v[194:195],s[80:81]
v_cvt_pk_bf16_f32 v196,v188,v189
v_cvt_pk_bf16_f32 v197,v190,v191
v_cvt_pk_bf16_f32 v198,v192,v193
v_cvt_pk_bf16_f32 v199,v194,v195
ds_write_b128 v130,v[196:199]
v_accvgpr_read_b32 v224,a228
v_accvgpr_read_b32 v225,a229
v_accvgpr_read_b32 v226,a230
v_accvgpr_read_b32 v227,a231
v_lshlrev_b32 v200,16,v224
v_and_b32 v201,0xffff0000,v224
v_lshlrev_b32 v202,16,v225
v_and_b32 v203,0xffff0000,v225
v_lshlrev_b32 v204,16,v226
v_and_b32 v205,0xffff0000,v226
v_lshlrev_b32 v206,16,v227
v_and_b32 v207,0xffff0000,v227
v_pk_mul_f32 v[200:201],v[200:201],s[80:81]
v_pk_mul_f32 v[202:203],v[202:203],s[80:81]
v_pk_mul_f32 v[204:205],v[204:205],s[80:81]
v_pk_mul_f32 v[206:207],v[206:207],s[80:81]
v_cvt_pk_bf16_f32 v224,v200,v201
v_cvt_pk_bf16_f32 v225,v202,v203
v_cvt_pk_bf16_f32 v226,v204,v205
v_cvt_pk_bf16_f32 v227,v206,v207
ds_write_b128 v131,v[224:227] offset:1024
v_accvgpr_read_b32 v196,a232
v_accvgpr_read_b32 v197,a233
v_accvgpr_read_b32 v198,a234
v_accvgpr_read_b32 v199,a235
v_lshlrev_b32 v188,16,v196
v_and_b32 v189,0xffff0000,v196
v_lshlrev_b32 v190,16,v197
v_and_b32 v191,0xffff0000,v197
v_lshlrev_b32 v192,16,v198
v_and_b32 v193,0xffff0000,v198
v_lshlrev_b32 v194,16,v199
v_and_b32 v195,0xffff0000,v199
v_pk_mul_f32 v[188:189],v[188:189],s[80:81]
v_pk_mul_f32 v[190:191],v[190:191],s[80:81]
v_pk_mul_f32 v[192:193],v[192:193],s[80:81]
v_pk_mul_f32 v[194:195],v[194:195],s[80:81]
v_cvt_pk_bf16_f32 v196,v188,v189
v_cvt_pk_bf16_f32 v197,v190,v191
v_cvt_pk_bf16_f32 v198,v192,v193
v_cvt_pk_bf16_f32 v199,v194,v195
ds_write_b128 v130,v[196:199] offset:2048
v_accvgpr_read_b32 v224,a236
v_accvgpr_read_b32 v225,a237
v_accvgpr_read_b32 v226,a238
v_accvgpr_read_b32 v227,a239
v_lshlrev_b32 v200,16,v224
v_and_b32 v201,0xffff0000,v224
v_lshlrev_b32 v202,16,v225
v_and_b32 v203,0xffff0000,v225
v_lshlrev_b32 v204,16,v226
v_and_b32 v205,0xffff0000,v226
v_lshlrev_b32 v206,16,v227
v_and_b32 v207,0xffff0000,v227
v_pk_mul_f32 v[200:201],v[200:201],s[80:81]
v_pk_mul_f32 v[202:203],v[202:203],s[80:81]
v_pk_mul_f32 v[204:205],v[204:205],s[80:81]
v_pk_mul_f32 v[206:207],v[206:207],s[80:81]
v_cvt_pk_bf16_f32 v224,v200,v201
v_cvt_pk_bf16_f32 v225,v202,v203
v_cvt_pk_bf16_f32 v226,v204,v205
v_cvt_pk_bf16_f32 v227,v206,v207
ds_write_b128 v131,v[224:227] offset:3072
ds_read_b128 a[64:67],v132
ds_read_b128 a[68:71],v133
ds_read_b128 a[72:75],v132 offset:128
ds_read_b128 a[76:79],v133 offset:128
s_waitcnt vmcnt(26)
v_accvgpr_read_b32 v196,a240
v_accvgpr_read_b32 v197,a241
v_accvgpr_read_b32 v198,a242
v_accvgpr_read_b32 v199,a243
v_lshlrev_b32 v188,16,v196
v_and_b32 v189,0xffff0000,v196
v_lshlrev_b32 v190,16,v197
v_and_b32 v191,0xffff0000,v197
v_lshlrev_b32 v192,16,v198
v_and_b32 v193,0xffff0000,v198
v_lshlrev_b32 v194,16,v199
v_and_b32 v195,0xffff0000,v199
v_pk_mul_f32 v[188:189],v[188:189],s[80:81]
v_pk_mul_f32 v[190:191],v[190:191],s[80:81]
v_pk_mul_f32 v[192:193],v[192:193],s[80:81]
v_pk_mul_f32 v[194:195],v[194:195],s[80:81]
v_cvt_pk_bf16_f32 v196,v188,v189
v_cvt_pk_bf16_f32 v197,v190,v191
v_cvt_pk_bf16_f32 v198,v192,v193
v_cvt_pk_bf16_f32 v199,v194,v195
ds_write_b128 v130,v[196:199]
v_accvgpr_read_b32 v224,a244
v_accvgpr_read_b32 v225,a245
v_accvgpr_read_b32 v226,a246
v_accvgpr_read_b32 v227,a247
v_lshlrev_b32 v200,16,v224
v_and_b32 v201,0xffff0000,v224
v_lshlrev_b32 v202,16,v225
v_and_b32 v203,0xffff0000,v225
v_lshlrev_b32 v204,16,v226
v_and_b32 v205,0xffff0000,v226
v_lshlrev_b32 v206,16,v227
v_and_b32 v207,0xffff0000,v227
v_pk_mul_f32 v[200:201],v[200:201],s[80:81]
v_pk_mul_f32 v[202:203],v[202:203],s[80:81]
v_pk_mul_f32 v[204:205],v[204:205],s[80:81]
v_pk_mul_f32 v[206:207],v[206:207],s[80:81]
v_cvt_pk_bf16_f32 v224,v200,v201
v_cvt_pk_bf16_f32 v225,v202,v203
v_cvt_pk_bf16_f32 v226,v204,v205
v_cvt_pk_bf16_f32 v227,v206,v207
ds_write_b128 v131,v[224:227] offset:1024
v_accvgpr_read_b32 v196,a248
v_accvgpr_read_b32 v197,a249
v_accvgpr_read_b32 v198,a250
v_accvgpr_read_b32 v199,a251
v_lshlrev_b32 v188,16,v196
v_and_b32 v189,0xffff0000,v196
v_lshlrev_b32 v190,16,v197
v_and_b32 v191,0xffff0000,v197
v_lshlrev_b32 v192,16,v198
v_and_b32 v193,0xffff0000,v198
v_lshlrev_b32 v194,16,v199
v_and_b32 v195,0xffff0000,v199
v_pk_mul_f32 v[188:189],v[188:189],s[80:81]
v_pk_mul_f32 v[190:191],v[190:191],s[80:81]
v_pk_mul_f32 v[192:193],v[192:193],s[80:81]
v_pk_mul_f32 v[194:195],v[194:195],s[80:81]
v_cvt_pk_bf16_f32 v196,v188,v189
v_cvt_pk_bf16_f32 v197,v190,v191
v_cvt_pk_bf16_f32 v198,v192,v193
v_cvt_pk_bf16_f32 v199,v194,v195
ds_write_b128 v130,v[196:199] offset:2048
v_accvgpr_read_b32 v224,a252
v_accvgpr_read_b32 v225,a253
v_accvgpr_read_b32 v226,a254
v_accvgpr_read_b32 v227,a255
v_lshlrev_b32 v200,16,v224
v_and_b32 v201,0xffff0000,v224
v_lshlrev_b32 v202,16,v225
v_and_b32 v203,0xffff0000,v225
v_lshlrev_b32 v204,16,v226
v_and_b32 v205,0xffff0000,v226
v_lshlrev_b32 v206,16,v227
v_and_b32 v207,0xffff0000,v227
v_pk_mul_f32 v[200:201],v[200:201],s[80:81]
v_pk_mul_f32 v[202:203],v[202:203],s[80:81]
v_pk_mul_f32 v[204:205],v[204:205],s[80:81]
v_pk_mul_f32 v[206:207],v[206:207],s[80:81]
v_cvt_pk_bf16_f32 v224,v200,v201
v_cvt_pk_bf16_f32 v225,v202,v203
v_cvt_pk_bf16_f32 v226,v204,v205
v_cvt_pk_bf16_f32 v227,v206,v207
ds_write_b128 v131,v[224:227] offset:3072
ds_read_b128 a[80:83],v132
ds_read_b128 a[84:87],v133
ds_read_b128 a[88:91],v132 offset:128
ds_read_b128 a[92:95],v133 offset:128
s_waitcnt lgkmcnt(0)
s_barrier
s_branch S_head
S_fin:
S_end:
s_endpgm
S_rare_f_8:
s_nop 7
v_max3_f32 v248,v128,v129,v130
v_max3_f32 v249,v131,v132,v133
v_max3_f32 v248,v248,v134,v135
v_max_f32 v248,v248,v249
v_mov_b32 v249,v248
s_nop 1
v_permlane32_swap_b32 v248,v249
v_max_f32 v248,v248,v249
v_mov_b32 v249,v248
s_nop 1
v_permlane16_swap_b32 v248,v249
v_max_f32 v248,v248,v249
v_max_f32 v248,0,v248
v_exp_f32 v249,-v248
v_sub_f32 v128,v128,v248
v_sub_f32 v129,v129,v248
v_sub_f32 v130,v130,v248
v_sub_f32 v131,v131,v248
v_sub_f32 v132,v132,v248
v_sub_f32 v133,v133,v248
v_sub_f32 v134,v134,v248
v_sub_f32 v135,v135,v248
v_sub_f32 v188,v188,v248
v_sub_f32 v189,v189,v248
v_sub_f32 v190,v190,v248
v_sub_f32 v191,v191,v248
v_exp_f32 v128,v128
v_exp_f32 v129,v129
v_exp_f32 v130,v130
v_exp_f32 v131,v131
v_exp_f32 v132,v132
v_exp_f32 v133,v133
v_exp_f32 v134,v134
v_exp_f32 v135,v135
v_mul_f32 v208,v208,v249
v_cvt_pk_bf16_f32 v168,v128,v129
v_cvt_pk_bf16_f32 v169,v130,v131
v_cvt_pk_bf16_f32 v170,v132,v133
v_cvt_pk_bf16_f32 v171,v134,v135
v_mul_f32 v0,v0,v249
v_mul_f32 v1,v1,v249
v_mul_f32 v2,v2,v249
v_mul_f32 v3,v3,v249
v_mul_f32 v4,v4,v249
v_mul_f32 v5,v5,v249
v_mul_f32 v6,v6,v249
v_mul_f32 v7,v7,v249
v_mul_f32 v8,v8,v249
v_mul_f32 v9,v9,v249
v_mul_f32 v10,v10,v249
v_mul_f32 v11,v11,v249
v_mul_f32 v12,v12,v249
v_mul_f32 v13,v13,v249
v_mul_f32 v14,v14,v249
v_mul_f32 v15,v15,v249
v_mul_f32 v16,v16,v249
v_mul_f32 v17,v17,v249
v_mul_f32 v18,v18,v249
v_mul_f32 v19,v19,v249
v_mul_f32 v20,v20,v249
v_mul_f32 v21,v21,v249
v_mul_f32 v22,v22,v249
v_mul_f32 v23,v23,v249
v_mul_f32 v24,v24,v249
v_mul_f32 v25,v25,v249
v_mul_f32 v26,v26,v249
v_mul_f32 v27,v27,v249
v_mul_f32 v28,v28,v249
v_mul_f32 v29,v29,v249
v_mul_f32 v30,v30,v249
v_mul_f32 v31,v31,v249
v_mfma_f32_16x16x32_bf16 v[212:215],a[176:179],v[168:171],v[208:211]
s_nop 7
s_branch S_back_f_8
S_rare_f_9:
s_nop 7
v_max3_f32 v248,v144,v145,v146
v_max3_f32 v249,v147,v148,v149
v_max3_f32 v248,v248,v150,v151
v_max_f32 v248,v248,v249
v_mov_b32 v249,v248
s_nop 1
v_permlane32_swap_b32 v248,v249
v_max_f32 v248,v248,v249
v_mov_b32 v249,v248
s_nop 1
v_permlane16_swap_b32 v248,v249
v_max_f32 v248,v248,v249
v_max_f32 v248,0,v248
v_exp_f32 v249,-v248
v_sub_f32 v144,v144,v248
v_sub_f32 v145,v145,v248
v_sub_f32 v146,v146,v248
v_sub_f32 v147,v147,v248
v_sub_f32 v148,v148,v248
v_sub_f32 v149,v149,v248
v_sub_f32 v150,v150,v248
v_sub_f32 v151,v151,v248
v_sub_f32 v192,v192,v248
v_sub_f32 v193,v193,v248
v_sub_f32 v194,v194,v248
v_sub_f32 v195,v195,v248
v_exp_f32 v144,v144
v_exp_f32 v145,v145
v_exp_f32 v146,v146
v_exp_f32 v147,v147
v_exp_f32 v148,v148
v_exp_f32 v149,v149
v_exp_f32 v150,v150
v_exp_f32 v151,v151
v_mul_f32 v213,v213,v249
v_cvt_pk_bf16_f32 v172,v144,v145
v_cvt_pk_bf16_f32 v173,v146,v147
v_cvt_pk_bf16_f32 v174,v148,v149
v_cvt_pk_bf16_f32 v175,v150,v151
v_mul_f32 v32,v32,v249
v_mul_f32 v33,v33,v249
v_mul_f32 v34,v34,v249
v_mul_f32 v35,v35,v249
v_mul_f32 v36,v36,v249
v_mul_f32 v37,v37,v249
v_mul_f32 v38,v38,v249
v_mul_f32 v39,v39,v249
v_mul_f32 v40,v40,v249
v_mul_f32 v41,v41,v249
v_mul_f32 v42,v42,v249
v_mul_f32 v43,v43,v249
v_mul_f32 v44,v44,v249
v_mul_f32 v45,v45,v249
v_mul_f32 v46,v46,v249
v_mul_f32 v47,v47,v249
v_mul_f32 v48,v48,v249
v_mul_f32 v49,v49,v249
v_mul_f32 v50,v50,v249
v_mul_f32 v51,v51,v249
v_mul_f32 v52,v52,v249
v_mul_f32 v53,v53,v249
v_mul_f32 v54,v54,v249
v_mul_f32 v55,v55,v249
v_mul_f32 v56,v56,v249
v_mul_f32 v57,v57,v249
v_mul_f32 v58,v58,v249
v_mul_f32 v59,v59,v249
v_mul_f32 v60,v60,v249
v_mul_f32 v61,v61,v249
v_mul_f32 v62,v62,v249
v_mul_f32 v63,v63,v249
v_mfma_f32_16x16x32_bf16 v[208:211],a[180:183],v[172:175],v[212:215]
s_nop 7
s_branch S_back_f_9
S_rare_f_10:
s_nop 7
v_max3_f32 v248,v152,v153,v154
v_max3_f32 v249,v155,v156,v157
v_max3_f32 v248,v248,v158,v159
v_max_f32 v248,v248,v249
v_mov_b32 v249,v248
s_nop 1
v_permlane32_swap_b32 v248,v249
v_max_f32 v248,v248,v249
v_mov_b32 v249,v248
s_nop 1
v_permlane16_swap_b32 v248,v249
v_max_f32 v248,v248,v249
v_max_f32 v248,0,v248
v_exp_f32 v249,-v248
v_sub_f32 v152,v152,v248
v_sub_f32 v153,v153,v248
v_sub_f32 v154,v154,v248
v_sub_f32 v155,v155,v248
v_sub_f32 v156,v156,v248
v_sub_f32 v157,v157,v248
v_sub_f32 v158,v158,v248
v_sub_f32 v159,v159,v248
v_sub_f32 v196,v196,v248
v_sub_f32 v197,v197,v248
v_sub_f32 v198,v198,v248
v_sub_f32 v199,v199,v248
v_exp_f32 v152,v152
v_exp_f32 v153,v153
v_exp_f32 v154,v154
v_exp_f32 v155,v155
v_exp_f32 v156,v156
v_exp_f32 v157,v157
v_exp_f32 v158,v158
v_exp_f32 v159,v159
v_mul_f32 v210,v210,v249
v_cvt_pk_bf16_f32 v176,v152,v153
v_cvt_pk_bf16_f32 v177,v154,v155
v_cvt_pk_bf16_f32 v178,v156,v157
v_cvt_pk_bf16_f32 v179,v158,v159
v_mul_f32 v64,v64,v249
v_mul_f32 v65,v65,v249
v_mul_f32 v66,v66,v249
v_mul_f32 v67,v67,v249
v_mul_f32 v68,v68,v249
v_mul_f32 v69,v69,v249
v_mul_f32 v70,v70,v249
v_mul_f32 v71,v71,v249
v_mul_f32 v72,v72,v249
v_mul_f32 v73,v73,v249
v_mul_f32 v74,v74,v249
v_mul_f32 v75,v75,v249
v_mul_f32 v76,v76,v249
v_mul_f32 v77,v77,v249
v_mul_f32 v78,v78,v249
v_mul_f32 v79,v79,v249
v_mul_f32 v80,v80,v249
v_mul_f32 v81,v81,v249
v_mul_f32 v82,v82,v249
v_mul_f32 v83,v83,v249
v_mul_f32 v84,v84,v249
v_mul_f32 v85,v85,v249
v_mul_f32 v86,v86,v249
v_mul_f32 v87,v87,v249
v_mul_f32 v88,v88,v249
v_mul_f32 v89,v89,v249
v_mul_f32 v90,v90,v249
v_mul_f32 v91,v91,v249
v_mul_f32 v92,v92,v249
v_mul_f32 v93,v93,v249
v_mul_f32 v94,v94,v249
v_mul_f32 v95,v95,v249
v_mfma_f32_16x16x32_bf16 v[212:215],a[184:187],v[176:179],v[208:211]
s_nop 7
s_branch S_back_f_10
S_rare_f_11:
s_nop 7
v_max3_f32 v248,v160,v161,v162
v_max3_f32 v249,v163,v164,v165
v_max3_f32 v248,v248,v166,v167
v_max_f32 v248,v248,v249
v_mov_b32 v249,v248
s_nop 1
v_permlane32_swap_b32 v248,v249
v_max_f32 v248,v248,v249
v_mov_b32 v249,v248
s_nop 1
v_permlane16_swap_b32 v248,v249
v_max_f32 v248,v248,v249
v_max_f32 v248,0,v248
v_exp_f32 v249,-v248
v_sub_f32 v160,v160,v248
v_sub_f32 v161,v161,v248
v_sub_f32 v162,v162,v248
v_sub_f32 v163,v163,v248
v_sub_f32 v164,v164,v248
v_sub_f32 v165,v165,v248
v_sub_f32 v166,v166,v248
v_sub_f32 v167,v167,v248
v_sub_f32 v200,v200,v248
v_sub_f32 v201,v201,v248
v_sub_f32 v202,v202,v248
v_sub_f32 v203,v203,v248
v_exp_f32 v160,v160
v_exp_f32 v161,v161
v_exp_f32 v162,v162
v_exp_f32 v163,v163
v_exp_f32 v164,v164
v_exp_f32 v165,v165
v_exp_f32 v166,v166
v_exp_f32 v167,v167
v_mul_f32 v215,v215,v249
v_cvt_pk_bf16_f32 v180,v160,v161
v_cvt_pk_bf16_f32 v181,v162,v163
v_cvt_pk_bf16_f32 v182,v164,v165
v_cvt_pk_bf16_f32 v183,v166,v167
v_mul_f32 v96,v96,v249
v_mul_f32 v97,v97,v249
v_mul_f32 v98,v98,v249
v_mul_f32 v99,v99,v249
v_mul_f32 v100,v100,v249
v_mul_f32 v101,v101,v249
v_mul_f32 v102,v102,v249
v_mul_f32 v103,v103,v249
v_mul_f32 v104,v104,v249
v_mul_f32 v105,v105,v249
v_mul_f32 v106,v106,v249
v_mul_f32 v107,v107,v249
v_mul_f32 v108,v108,v249
v_mul_f32 v109,v109,v249
v_mul_f32 v110,v110,v249
v_mul_f32 v111,v111,v249
v_mul_f32 v112,v112,v249
v_mul_f32 v113,v113,v249
v_mul_f32 v114,v114,v249
v_mul_f32 v115,v115,v249
v_mul_f32 v116,v116,v249
v_mul_f32 v117,v117,v249
v_mul_f32 v118,v118,v249
v_mul_f32 v119,v119,v249
v_mul_f32 v120,v120,v249
v_mul_f32 v121,v121,v249
v_mul_f32 v122,v122,v249
v_mul_f32 v123,v123,v249
v_mul_f32 v124,v124,v249
v_mul_f32 v125,v125,v249
v_mul_f32 v126,v126,v249
v_mul_f32 v127,v127,v249
v_mfma_f32_16x16x32_bf16 v[208:211],a[188:191],v[180:183],v[212:215]
s_nop 7
s_branch S_back_f_11
S_rare_f_12:
s_nop 7
v_max3_f32 v248,v128,v129,v130
v_max3_f32 v249,v131,v132,v133
v_max3_f32 v248,v248,v134,v135
v_max_f32 v248,v248,v249
v_mov_b32 v249,v248
s_nop 1
v_permlane32_swap_b32 v248,v249
v_max_f32 v248,v248,v249
v_mov_b32 v249,v248
s_nop 1
v_permlane16_swap_b32 v248,v249
v_max_f32 v248,v248,v249
v_max_f32 v248,0,v248
v_exp_f32 v249,-v248
v_sub_f32 v128,v128,v248
v_sub_f32 v129,v129,v248
v_sub_f32 v130,v130,v248
v_sub_f32 v131,v131,v248
v_sub_f32 v132,v132,v248
v_sub_f32 v133,v133,v248
v_sub_f32 v134,v134,v248
v_sub_f32 v135,v135,v248
v_sub_f32 v188,v188,v248
v_sub_f32 v189,v189,v248
v_sub_f32 v190,v190,v248
v_sub_f32 v191,v191,v248
v_exp_f32 v128,v128
v_exp_f32 v129,v129
v_exp_f32 v130,v130
v_exp_f32 v131,v131
v_exp_f32 v132,v132
v_exp_f32 v133,v133
v_exp_f32 v134,v134
v_exp_f32 v135,v135
v_mul_f32 v208,v208,v249
v_cvt_pk_bf16_f32 v168,v128,v129
v_cvt_pk_bf16_f32 v169,v130,v131
v_cvt_pk_bf16_f32 v170,v132,v133
v_cvt_pk_bf16_f32 v171,v134,v135
v_mul_f32 v0,v0,v249
v_mul_f32 v1,v1,v249
v_mul_f32 v2,v2,v249
v_mul_f32 v3,v3,v249
v_mul_f32 v4,v4,v249
v_mul_f32 v5,v5,v249
v_mul_f32 v6,v6,v249
v_mul_f32 v7,v7,v249
v_mul_f32 v8,v8,v249
v_mul_f32 v9,v9,v249
v_mul_f32 v10,v10,v249
v_mul_f32 v11,v11,v249
v_mul_f32 v12,v12,v249
v_mul_f32 v13,v13,v249
v_mul_f32 v14,v14,v249
v_mul_f32 v15,v15,v249
v_mul_f32 v16,v16,v249
v_mul_f32 v17,v17,v249
v_mul_f32 v18,v18,v249
v_mul_f32 v19,v19,v249
v_mul_f32 v20,v20,v249
v_mul_f32 v21,v21,v249
v_mul_f32 v22,v22,v249
v_mul_f32 v23,v23,v249
v_mul_f32 v24,v24,v249
v_mul_f32 v25,v25,v249
v_mul_f32 v26,v26,v249
v_mul_f32 v27,v27,v249
v_mul_f32 v28,v28,v249
v_mul_f32 v29,v29,v249
v_mul_f32 v30,v30,v249
v_mul_f32 v31,v31,v249
v_mfma_f32_16x16x32_bf16 v[212:215],a[176:179],v[168:171],v[208:211]
s_nop 7
s_branch S_back_f_12
S_rare_f_13:
s_nop 7
v_max3_f32 v248,v144,v145,v146
v_max3_f32 v249,v147,v148,v149
v_max3_f32 v248,v248,v150,v151
v_max_f32 v248,v248,v249
v_mov_b32 v249,v248
s_nop 1
v_permlane32_swap_b32 v248,v249
v_max_f32 v248,v248,v249
v_mov_b32 v249,v248
s_nop 1
v_permlane16_swap_b32 v248,v249
v_max_f32 v248,v248,v249
v_max_f32 v248,0,v248
v_exp_f32 v249,-v248
v_sub_f32 v144,v144,v248
v_sub_f32 v145,v145,v248
v_sub_f32 v146,v146,v248
v_sub_f32 v147,v147,v248
v_sub_f32 v148,v148,v248
v_sub_f32 v149,v149,v248
v_sub_f32 v150,v150,v248
v_sub_f32 v151,v151,v248
v_sub_f32 v192,v192,v248
v_sub_f32 v193,v193,v248
v_sub_f32 v194,v194,v248
v_sub_f32 v195,v195,v248
v_exp_f32 v144,v144
v_exp_f32 v145,v145
v_exp_f32 v146,v146
v_exp_f32 v147,v147
v_exp_f32 v148,v148
v_exp_f32 v149,v149
v_exp_f32 v150,v150
v_exp_f32 v151,v151
v_mul_f32 v213,v213,v249
v_cvt_pk_bf16_f32 v172,v144,v145
v_cvt_pk_bf16_f32 v173,v146,v147
v_cvt_pk_bf16_f32 v174,v148,v149
v_cvt_pk_bf16_f32 v175,v150,v151
v_mul_f32 v32,v32,v249
v_mul_f32 v33,v33,v249
v_mul_f32 v34,v34,v249
v_mul_f32 v35,v35,v249
v_mul_f32 v36,v36,v249
v_mul_f32 v37,v37,v249
v_mul_f32 v38,v38,v249
v_mul_f32 v39,v39,v249
v_mul_f32 v40,v40,v249
v_mul_f32 v41,v41,v249
v_mul_f32 v42,v42,v249
v_mul_f32 v43,v43,v249
v_mul_f32 v44,v44,v249
v_mul_f32 v45,v45,v249
v_mul_f32 v46,v46,v249
v_mul_f32 v47,v47,v249
v_mul_f32 v48,v48,v249
v_mul_f32 v49,v49,v249
v_mul_f32 v50,v50,v249
v_mul_f32 v51,v51,v249
v_mul_f32 v52,v52,v249
v_mul_f32 v53,v53,v249
v_mul_f32 v54,v54,v249
v_mul_f32 v55,v55,v249
v_mul_f32 v56,v56,v249
v_mul_f32 v57,v57,v249
v_mul_f32 v58,v58,v249
v_mul_f32 v59,v59,v249
v_mul_f32 v60,v60,v249
v_mul_f32 v61,v61,v249
v_mul_f32 v62,v62,v249
v_mul_f32 v63,v63,v249
v_mfma_f32_16x16x32_bf16 v[208:211],a[180:183],v[172:175],v[212:215]
s_nop 7
s_branch S_back_f_13
S_rare_f_14:
s_nop 7
v_max3_f32 v248,v152,v153,v154
v_max3_f32 v249,v155,v156,v157
v_max3_f32 v248,v248,v158,v159
v_max_f32 v248,v248,v249
v_mov_b32 v249,v248
s_nop 1
v_permlane32_swap_b32 v248,v249
v_max_f32 v248,v248,v249
v_mov_b32 v249,v248
s_nop 1
v_permlane16_swap_b32 v248,v249
v_max_f32 v248,v248,v249
v_max_f32 v248,0,v248
v_exp_f32 v249,-v248
v_sub_f32 v152,v152,v248
v_sub_f32 v153,v153,v248
v_sub_f32 v154,v154,v248
v_sub_f32 v155,v155,v248
v_sub_f32 v156,v156,v248
v_sub_f32 v157,v157,v248
v_sub_f32 v158,v158,v248
v_sub_f32 v159,v159,v248
v_sub_f32 v196,v196,v248
v_sub_f32 v197,v197,v248
v_sub_f32 v198,v198,v248
v_sub_f32 v199,v199,v248
v_exp_f32 v152,v152
v_exp_f32 v153,v153
v_exp_f32 v154,v154
v_exp_f32 v155,v155
v_exp_f32 v156,v156
v_exp_f32 v157,v157
v_exp_f32 v158,v158
v_exp_f32 v159,v159
v_mul_f32 v210,v210,v249
v_cvt_pk_bf16_f32 v176,v152,v153
v_cvt_pk_bf16_f32 v177,v154,v155
v_cvt_pk_bf16_f32 v178,v156,v157
v_cvt_pk_bf16_f32 v179,v158,v159
v_mul_f32 v64,v64,v249
v_mul_f32 v65,v65,v249
v_mul_f32 v66,v66,v249
v_mul_f32 v67,v67,v249
v_mul_f32 v68,v68,v249
v_mul_f32 v69,v69,v249
v_mul_f32 v70,v70,v249
v_mul_f32 v71,v71,v249
v_mul_f32 v72,v72,v249
v_mul_f32 v73,v73,v249
v_mul_f32 v74,v74,v249
v_mul_f32 v75,v75,v249
v_mul_f32 v76,v76,v249
v_mul_f32 v77,v77,v249
v_mul_f32 v78,v78,v249
v_mul_f32 v79,v79,v249
v_mul_f32 v80,v80,v249
v_mul_f32 v81,v81,v249
v_mul_f32 v82,v82,v249
v_mul_f32 v83,v83,v249
v_mul_f32 v84,v84,v249
v_mul_f32 v85,v85,v249
v_mul_f32 v86,v86,v249
v_mul_f32 v87,v87,v249
v_mul_f32 v88,v88,v249
v_mul_f32 v89,v89,v249
v_mul_f32 v90,v90,v249
v_mul_f32 v91,v91,v249
v_mul_f32 v92,v92,v249
v_mul_f32 v93,v93,v249
v_mul_f32 v94,v94,v249
v_mul_f32 v95,v95,v249
v_mfma_f32_16x16x32_bf16 v[212:215],a[184:187],v[176:179],v[208:211]
s_nop 7
s_branch S_back_f_14
S_rare_f_15:
s_nop 7
v_max3_f32 v248,v160,v161,v162
v_max3_f32 v249,v163,v164,v165
v_max3_f32 v248,v248,v166,v167
v_max_f32 v248,v248,v249
v_mov_b32 v249,v248
s_nop 1
v_permlane32_swap_b32 v248,v249
v_max_f32 v248,v248,v249
v_mov_b32 v249,v248
s_nop 1
v_permlane16_swap_b32 v248,v249
v_max_f32 v248,v248,v249
v_max_f32 v248,0,v248
v_exp_f32 v249,-v248
v_sub_f32 v160,v160,v248
v_sub_f32 v161,v161,v248
v_sub_f32 v162,v162,v248
v_sub_f32 v163,v163,v248
v_sub_f32 v164,v164,v248
v_sub_f32 v165,v165,v248
v_sub_f32 v166,v166,v248
v_sub_f32 v167,v167,v248
v_sub_f32 v200,v200,v248
v_sub_f32 v201,v201,v248
v_sub_f32 v202,v202,v248
v_sub_f32 v203,v203,v248
v_exp_f32 v160,v160
v_exp_f32 v161,v161
v_exp_f32 v162,v162
v_exp_f32 v163,v163
v_exp_f32 v164,v164
v_exp_f32 v165,v165
v_exp_f32 v166,v166
v_exp_f32 v167,v167
v_mul_f32 v215,v215,v249
v_cvt_pk_bf16_f32 v180,v160,v161
v_cvt_pk_bf16_f32 v181,v162,v163
v_cvt_pk_bf16_f32 v182,v164,v165
v_cvt_pk_bf16_f32 v183,v166,v167
v_mul_f32 v96,v96,v249
v_mul_f32 v97,v97,v249
v_mul_f32 v98,v98,v249
v_mul_f32 v99,v99,v249
v_mul_f32 v100,v100,v249
v_mul_f32 v101,v101,v249
v_mul_f32 v102,v102,v249
v_mul_f32 v103,v103,v249
v_mul_f32 v104,v104,v249
v_mul_f32 v105,v105,v249
v_mul_f32 v106,v106,v249
v_mul_f32 v107,v107,v249
v_mul_f32 v108,v108,v249
v_mul_f32 v109,v109,v249
v_mul_f32 v110,v110,v249
v_mul_f32 v111,v111,v249
v_mul_f32 v112,v112,v249
v_mul_f32 v113,v113,v249
v_mul_f32 v114,v114,v249
v_mul_f32 v115,v115,v249
v_mul_f32 v116,v116,v249
v_mul_f32 v117,v117,v249
v_mul_f32 v118,v118,v249
v_mul_f32 v119,v119,v249
v_mul_f32 v120,v120,v249
v_mul_f32 v121,v121,v249
v_mul_f32 v122,v122,v249
v_mul_f32 v123,v123,v249
v_mul_f32 v124,v124,v249
v_mul_f32 v125,v125,v249
v_mul_f32 v126,v126,v249
v_mul_f32 v127,v127,v249
v_mfma_f32_16x16x32_bf16 v[208:211],a[188:191],v[180:183],v[212:215]
s_nop 7
s_branch S_back_f_15
S_rare_f_16:
s_nop 7
v_max3_f32 v248,v136,v137,v138
v_max3_f32 v249,v139,v140,v141
v_max3_f32 v248,v248,v142,v143
v_max_f32 v248,v248,v249
v_mov_b32 v249,v248
s_nop 1
v_permlane32_swap_b32 v248,v249
v_max_f32 v248,v248,v249
v_mov_b32 v249,v248
s_nop 1
v_permlane16_swap_b32 v248,v249
v_max_f32 v248,v248,v249
v_max_f32 v248,0,v248
v_exp_f32 v249,-v248
v_sub_f32 v136,v136,v248
v_sub_f32 v137,v137,v248
v_sub_f32 v138,v138,v248
v_sub_f32 v139,v139,v248
v_sub_f32 v140,v140,v248
v_sub_f32 v141,v141,v248
v_sub_f32 v142,v142,v248
v_sub_f32 v143,v143,v248
v_sub_f32 v204,v204,v248
v_sub_f32 v205,v205,v248
v_sub_f32 v206,v206,v248
v_sub_f32 v207,v207,v248
v_exp_f32 v136,v136
v_exp_f32 v137,v137
v_exp_f32 v138,v138
v_exp_f32 v139,v139
v_exp_f32 v140,v140
v_exp_f32 v141,v141
v_exp_f32 v142,v142
v_exp_f32 v143,v143
v_mul_f32 v220,v220,v249
v_cvt_pk_bf16_f32 v184,v136,v137
v_cvt_pk_bf16_f32 v185,v138,v139
v_cvt_pk_bf16_f32 v186,v140,v141
v_cvt_pk_bf16_f32 v187,v142,v143
v_accvgpr_read_b32 v250,a0
v_accvgpr_read_b32 v251,a1
v_mul_f32 v250,v250,v249
v_mul_f32 v251,v251,v249
v_accvgpr_write_b32 a0,v250
v_accvgpr_write_b32 a1,v251
v_accvgpr_read_b32 v250,a2
v_accvgpr_read_b32 v251,a3
v_mul_f32 v250,v250,v249
v_mul_f32 v251,v251,v249
v_accvgpr_write_b32 a2,v250
v_accvgpr_write_b32 a3,v251
v_accvgpr_read_b32 v250,a4
v_accvgpr_read_b32 v251,a5
v_mul_f32 v250,v250,v249
v_mul_f32 v251,v251,v249
v_accvgpr_write_b32 a4,v250
v_accvgpr_write_b32 a5,v251
v_accvgpr_read_b32 v250,a6
v_accvgpr_read_b32 v251,a7
v_mul_f32 v250,v250,v249
v_mul_f32 v251,v251,v249
v_accvgpr_write_b32 a6,v250
v_accvgpr_write_b32 a7,v251
v_accvgpr_read_b32 v250,a8
v_accvgpr_read_b32 v251,a9
v_mul_f32 v250,v250,v249
v_mul_f32 v251,v251,v249
v_accvgpr_write_b32 a8,v250
v_accvgpr_write_b32 a9,v251
v_accvgpr_read_b32 v250,a10
v_accvgpr_read_b32 v251,a11
v_mul_f32 v250,v250,v249
v_mul_f32 v251,v251,v249
v_accvgpr_write_b32 a10,v250
v_accvgpr_write_b32 a11,v251
v_accvgpr_read_b32 v250,a12
v_accvgpr_read_b32 v251,a13
v_mul_f32 v250,v250,v249
v_mul_f32 v251,v251,v249
v_accvgpr_write_b32 a12,v250
v_accvgpr_write_b32 a13,v251
v_accvgpr_read_b32 v250,a14
v_accvgpr_read_b32 v251,a15
v_mul_f32 v250,v250,v249
v_mul_f32 v251,v251,v249
v_accvgpr_write_b32 a14,v250
v_accvgpr_write_b32 a15,v251
v_accvgpr_read_b32 v250,a16
v_accvgpr_read_b32 v251,a17
v_mul_f32 v250,v250,v249
v_mul_f32 v251,v251,v249
v_accvgpr_write_b32 a16,v250
v_accvgpr_write_b32 a17,v251
v_accvgpr_read_b32 v250,a18
v_accvgpr_read_b32 v251,a19
v_mul_f32 v250,v250,v249
v_mul_f32 v251,v251,v249
v_accvgpr_write_b32 a18,v250
v_accvgpr_write_b32 a19,v251
v_accvgpr_read_b32 v250,a20
v_accvgpr_read_b32 v251,a21
v_mul_f32 v250,v250,v249
v_mul_f32 v251,v251,v249
v_accvgpr_write_b32 a20,v250
v_accvgpr_write_b32 a21,v251
v_accvgpr_read_b32 v250,a22
v_accvgpr_read_b32 v251,a23
v_mul_f32 v250,v250,v249
v_mul_f32 v251,v251,v249
v_accvgpr_write_b32 a22,v250
v_accvgpr_write_b32 a23,v251
v_accvgpr_read_b32 v250,a24
v_accvgpr_read_b32 v251,a25
v_mul_f32 v250,v250,v249
v_mul_f32 v251,v251,v249
v_accvgpr_write_b32 a24,v250
v_accvgpr_write_b32 a25,v251
v_accvgpr_read_b32 v250,a26
v_accvgpr_read_b32 v251,a27
v_mul_f32 v250,v250,v249
v_mul_f32 v251,v251,v249
v_accvgpr_write_b32 a26,v250
v_accvgpr_write_b32 a27,v251
v_accvgpr_read_b32 v250,a28
v_accvgpr_read_b32 v251,a29
v_mul_f32 v250,v250,v249
v_mul_f32 v251,v251,v249
v_accvgpr_write_b32 a28,v250
v_accvgpr_write_b32 a29,v251
v_accvgpr_read_b32 v250,a30
v_accvgpr_read_b32 v251,a31
v_mul_f32 v250,v250,v249
v_mul_f32 v251,v251,v249
v_accvgpr_write_b32 a30,v250
v_accvgpr_write_b32 a31,v251
v_mfma_f32_16x16x32_bf16 v[216:219],a[176:179],v[184:187],v[220:223]
s_nop 7
s_branch S_back_f_16
S_rare_f_17:
s_nop 7
v_max3_f32 v248,v128,v129,v130
v_max3_f32 v249,v131,v132,v133
v_max3_f32 v248,v248,v134,v135
v_max_f32 v248,v248,v249
v_mov_b32 v249,v248
s_nop 1
v_permlane32_swap_b32 v248,v249
v_max_f32 v248,v248,v249
v_mov_b32 v249,v248
s_nop 1
v_permlane16_swap_b32 v248,v249
v_max_f32 v248,v248,v249
v_max_f32 v248,0,v248
v_exp_f32 v249,-v248
v_sub_f32 v128,v128,v248
v_sub_f32 v129,v129,v248
v_sub_f32 v130,v130,v248
v_sub_f32 v131,v131,v248
v_sub_f32 v132,v132,v248
v_sub_f32 v133,v133,v248
v_sub_f32 v134,v134,v248
v_sub_f32 v135,v135,v248
v_sub_f32 v188,v188,v248
v_sub_f32 v189,v189,v248
v_sub_f32 v190,v190,v248
v_sub_f32 v191,v191,v248
v_exp_f32 v128,v128
v_exp_f32 v129,v129
v_exp_f32 v130,v130
v_exp_f32 v131,v131
v_exp_f32 v132,v132
v_exp_f32 v133,v133
v_exp_f32 v134,v134
v_exp_f32 v135,v135
v_mul_f32 v208,v208,v249
v_cvt_pk_bf16_f32 v168,v128,v129
v_cvt_pk_bf16_f32 v169,v130,v131
v_cvt_pk_bf16_f32 v170,v132,v133
v_cvt_pk_bf16_f32 v171,v134,v135
v_mul_f32 v0,v0,v249
v_mul_f32 v1,v1,v249
v_mul_f32 v2,v2,v249
v_mul_f32 v3,v3,v249
v_mul_f32 v4,v4,v249
v_mul_f32 v5,v5,v249
v_mul_f32 v6,v6,v249
v_mul_f32 v7,v7,v249
v_mul_f32 v8,v8,v249
v_mul_f32 v9,v9,v249
v_mul_f32 v10,v10,v249
v_mul_f32 v11,v11,v249
v_mul_f32 v12,v12,v249
v_mul_f32 v13,v13,v249
v_mul_f32 v14,v14,v249
v_mul_f32 v15,v15,v249
v_mul_f32 v16,v16,v249
v_mul_f32 v17,v17,v249
v_mul_f32 v18,v18,v249
v_mul_f32 v19,v19,v249
v_mul_f32 v20,v20,v249
v_mul_f32 v21,v21,v249
v_mul_f32 v22,v22,v249
v_mul_f32 v23,v23,v249
v_mul_f32 v24,v24,v249
v_mul_f32 v25,v25,v249
v_mul_f32 v26,v26,v249
v_mul_f32 v27,v27,v249
v_mul_f32 v28,v28,v249
v_mul_f32 v29,v29,v249
v_mul_f32 v30,v30,v249
v_mul_f32 v31,v31,v249
v_mfma_f32_16x16x32_bf16 v[212:215],a[176:179],v[168:171],v[208:211]
s_nop 7
s_branch S_back_f_17
S_rare_l_0:
s_nop 7
v_max3_f32 v248,v144,v145,v146
v_max3_f32 v249,v147,v148,v149
v_max3_f32 v248,v248,v150,v151
v_max_f32 v248,v248,v249
v_mov_b32 v249,v248
s_nop 1
v_permlane32_swap_b32 v248,v249
v_max_f32 v248,v248,v249
v_mov_b32 v249,v248
s_nop 1
v_permlane16_swap_b32 v248,v249
v_max_f32 v248,v248,v249
v_max_f32 v248,0,v248
v_exp_f32 v249,-v248
v_sub_f32 v144,v144,v248
v_sub_f32 v145,v145,v248
v_sub_f32 v146,v146,v248
v_sub_f32 v147,v147,v248
v_sub_f32 v148,v148,v248
v_sub_f32 v149,v149,v248
v_sub_f32 v150,v150,v248
v_sub_f32 v151,v151,v248
v_sub_f32 v192,v192,v248
v_sub_f32 v193,v193,v248
v_sub_f32 v194,v194,v248
v_sub_f32 v195,v195,v248
v_exp_f32 v144,v144
v_exp_f32 v145,v145
v_exp_f32 v146,v146
v_exp_f32 v147,v147
v_exp_f32 v148,v148
v_exp_f32 v149,v149
v_exp_f32 v150,v150
v_exp_f32 v151,v151
v_mul_f32 v213,v213,v249
v_cvt_pk_bf16_f32 v172,v144,v145
v_cvt_pk_bf16_f32 v173,v146,v147
v_cvt_pk_bf16_f32 v174,v148,v149
v_cvt_pk_bf16_f32 v175,v150,v151
v_mul_f32 v32,v32,v249
v_mul_f32 v33,v33,v249
v_mul_f32 v34,v34,v249
v_mul_f32 v35,v35,v249
v_mul_f32 v36,v36,v249
v_mul_f32 v37,v37,v249
v_mul_f32 v38,v38,v249
v_mul_f32 v39,v39,v249
v_mul_f32 v40,v40,v249
v_mul_f32 v41,v41,v249
v_mul_f32 v42,v42,v249
v_mul_f32 v43,v43,v249
v_mul_f32 v44,v44,v249
v_mul_f32 v45,v45,v249
v_mul_f32 v46,v46,v249
v_mul_f32 v47,v47,v249
v_mul_f32 v48,v48,v249
v_mul_f32 v49,v49,v249
v_mul_f32 v50,v50,v249
v_mul_f32 v51,v51,v249
v_mul_f32 v52,v52,v249
v_mul_f32 v53,v53,v249
v_mul_f32 v54,v54,v249
v_mul_f32 v55,v55,v249
v_mul_f32 v56,v56,v249
v_mul_f32 v57,v57,v249
v_mul_f32 v58,v58,v249
v_mul_f32 v59,v59,v249
v_mul_f32 v60,v60,v249
v_mul_f32 v61,v61,v249
v_mul_f32 v62,v62,v249
v_mul_f32 v63,v63,v249
v_mfma_f32_16x16x32_bf16 v[208:211],a[180:183],v[172:175],v[212:215]
s_nop 7
s_branch S_back_l_0
S_rare_l_1:
s_nop 7
v_max3_f32 v248,v152,v153,v154
v_max3_f32 v249,v155,v156,v157
v_max3_f32 v248,v248,v158,v159
v_max_f32 v248,v248,v249
v_mov_b32 v249,v248
s_nop 1
v_permlane32_swap_b32 v248,v249
v_max_f32 v248,v248,v249
v_mov_b32 v249,v248
s_nop 1
v_permlane16_swap_b32 v248,v249
v_max_f32 v248,v248,v249
v_max_f32 v248,0,v248
v_exp_f32 v249,-v248
v_sub_f32 v152,v152,v248
v_sub_f32 v153,v153,v248
v_sub_f32 v154,v154,v248
v_sub_f32 v155,v155,v248
v_sub_f32 v156,v156,v248
v_sub_f32 v157,v157,v248
v_sub_f32 v158,v158,v248
v_sub_f32 v159,v159,v248
v_sub_f32 v196,v196,v248
v_sub_f32 v197,v197,v248
v_sub_f32 v198,v198,v248
v_sub_f32 v199,v199,v248
v_exp_f32 v152,v152
v_exp_f32 v153,v153
v_exp_f32 v154,v154
v_exp_f32 v155,v155
v_exp_f32 v156,v156
v_exp_f32 v157,v157
v_exp_f32 v158,v158
v_exp_f32 v159,v159
v_mul_f32 v210,v210,v249
v_cvt_pk_bf16_f32 v176,v152,v153
v_cvt_pk_bf16_f32 v177,v154,v155
v_cvt_pk_bf16_f32 v178,v156,v157
v_cvt_pk_bf16_f32 v179,v158,v159
v_mul_f32 v64,v64,v249
v_mul_f32 v65,v65,v249
v_mul_f32 v66,v66,v249
v_mul_f32 v67,v67,v249
v_mul_f32 v68,v68,v249
v_mul_f32 v69,v69,v249
v_mul_f32 v70,v70,v249
v_mul_f32 v71,v71,v249
v_mul_f32 v72,v72,v249
v_mul_f32 v73,v73,v249
v_mul_f32 v74,v74,v249
v_mul_f32 v75,v75,v249
v_mul_f32 v76,v76,v249
v_mul_f32 v77,v77,v249
v_mul_f32 v78,v78,v249
v_mul_f32 v79,v79,v249
v_mul_f32 v80,v80,v249
v_mul_f32 v81,v81,v249
v_mul_f32 v82,v82,v249
v_mul_f32 v83,v83,v249
v_mul_f32 v84,v84,v249
v_mul_f32 v85,v85,v249
v_mul_f32 v86,v86,v249
v_mul_f32 v87,v87,v249
v_mul_f32 v88,v88,v249
v_mul_f32 v89,v89,v249
v_mul_f32 v90,v90,v249
v_mul_f32 v91,v91,v249
v_mul_f32 v92,v92,v249
v_mul_f32 v93,v93,v249
v_mul_f32 v94,v94,v249
v_mul_f32 v95,v95,v249
v_mfma_f32_16x16x32_bf16 v[212:215],a[184:187],v[176:179],v[208:211]
s_nop 7
s_branch S_back_l_1
S_rare_l_2:
s_nop 7
v_max3_f32 v248,v160,v161,v162
v_max3_f32 v249,v163,v164,v165
v_max3_f32 v248,v248,v166,v167
v_max_f32 v248,v248,v249
v_mov_b32 v249,v248
s_nop 1
v_permlane32_swap_b32 v248,v249
v_max_f32 v248,v248,v249
v_mov_b32 v249,v248
s_nop 1
v_permlane16_swap_b32 v248,v249
v_max_f32 v248,v248,v249
v_max_f32 v248,0,v248
v_exp_f32 v249,-v248
v_sub_f32 v160,v160,v248
v_sub_f32 v161,v161,v248
v_sub_f32 v162,v162,v248
v_sub_f32 v163,v163,v248
v_sub_f32 v164,v164,v248
v_sub_f32 v165,v165,v248
v_sub_f32 v166,v166,v248
v_sub_f32 v167,v167,v248
v_sub_f32 v200,v200,v248
v_sub_f32 v201,v201,v248
v_sub_f32 v202,v202,v248
v_sub_f32 v203,v203,v248
v_exp_f32 v160,v160
v_exp_f32 v161,v161
v_exp_f32 v162,v162
v_exp_f32 v163,v163
v_exp_f32 v164,v164
v_exp_f32 v165,v165
v_exp_f32 v166,v166
v_exp_f32 v167,v167
v_mul_f32 v215,v215,v249
v_cvt_pk_bf16_f32 v180,v160,v161
v_cvt_pk_bf16_f32 v181,v162,v163
v_cvt_pk_bf16_f32 v182,v164,v165
v_cvt_pk_bf16_f32 v183,v166,v167
v_mul_f32 v96,v96,v249
v_mul_f32 v97,v97,v249
v_mul_f32 v98,v98,v249
v_mul_f32 v99,v99,v249
v_mul_f32 v100,v100,v249
v_mul_f32 v101,v101,v249
v_mul_f32 v102,v102,v249
v_mul_f32 v103,v103,v249
v_mul_f32 v104,v104,v249
v_mul_f32 v105,v105,v249
v_mul_f32 v106,v106,v249
v_mul_f32 v107,v107,v249
v_mul_f32 v108,v108,v249
v_mul_f32 v109,v109,v249
v_mul_f32 v110,v110,v249
v_mul_f32 v111,v111,v249
v_mul_f32 v112,v112,v249
v_mul_f32 v113,v113,v249
v_mul_f32 v114,v114,v249
v_mul_f32 v115,v115,v249
v_mul_f32 v116,v116,v249
v_mul_f32 v117,v117,v249
v_mul_f32 v118,v118,v249
v_mul_f32 v119,v119,v249
v_mul_f32 v120,v120,v249
v_mul_f32 v121,v121,v249
v_mul_f32 v122,v122,v249
v_mul_f32 v123,v123,v249
v_mul_f32 v124,v124,v249
v_mul_f32 v125,v125,v249
v_mul_f32 v126,v126,v249
v_mul_f32 v127,v127,v249
v_mfma_f32_16x16x32_bf16 v[208:211],a[188:191],v[180:183],v[212:215]
s_nop 7
s_branch S_back_l_2
S_rare_l_3:
s_nop 7
v_max3_f32 v248,v128,v129,v130
v_max3_f32 v249,v131,v132,v133
v_max3_f32 v248,v248,v134,v135
v_max_f32 v248,v248,v249
v_mov_b32 v249,v248
s_nop 1
v_permlane32_swap_b32 v248,v249
v_max_f32 v248,v248,v249
v_mov_b32 v249,v248
s_nop 1
v_permlane16_swap_b32 v248,v249
v_max_f32 v248,v248,v249
v_max_f32 v248,0,v248
v_exp_f32 v249,-v248
v_sub_f32 v128,v128,v248
v_sub_f32 v129,v129,v248
v_sub_f32 v130,v130,v248
v_sub_f32 v131,v131,v248
v_sub_f32 v132,v132,v248
v_sub_f32 v133,v133,v248
v_sub_f32 v134,v134,v248
v_sub_f32 v135,v135,v248
v_sub_f32 v188,v188,v248
v_sub_f32 v189,v189,v248
v_sub_f32 v190,v190,v248
v_sub_f32 v191,v191,v248
v_exp_f32 v128,v128
v_exp_f32 v129,v129
v_exp_f32 v130,v130
v_exp_f32 v131,v131
v_exp_f32 v132,v132
v_exp_f32 v133,v133
v_exp_f32 v134,v134
v_exp_f32 v135,v135
v_mul_f32 v208,v208,v249
v_cvt_pk_bf16_f32 v168,v128,v129
v_cvt_pk_bf16_f32 v169,v130,v131
v_cvt_pk_bf16_f32 v170,v132,v133
v_cvt_pk_bf16_f32 v171,v134,v135
v_mul_f32 v0,v0,v249
v_mul_f32 v1,v1,v249
v_mul_f32 v2,v2,v249
v_mul_f32 v3,v3,v249
v_mul_f32 v4,v4,v249
v_mul_f32 v5,v5,v249
v_mul_f32 v6,v6,v249
v_mul_f32 v7,v7,v249
v_mul_f32 v8,v8,v249
v_mul_f32 v9,v9,v249
v_mul_f32 v10,v10,v249
v_mul_f32 v11,v11,v249
v_mul_f32 v12,v12,v249
v_mul_f32 v13,v13,v249
v_mul_f32 v14,v14,v249
v_mul_f32 v15,v15,v249
v_mul_f32 v16,v16,v249
v_mul_f32 v17,v17,v249
v_mul_f32 v18,v18,v249
v_mul_f32 v19,v19,v249
v_mul_f32 v20,v20,v249
v_mul_f32 v21,v21,v249
v_mul_f32 v22,v22,v249
v_mul_f32 v23,v23,v249
v_mul_f32 v24,v24,v249
v_mul_f32 v25,v25,v249
v_mul_f32 v26,v26,v249
v_mul_f32 v27,v27,v249
v_mul_f32 v28,v28,v249
v_mul_f32 v29,v29,v249
v_mul_f32 v30,v30,v249
v_mul_f32 v31,v31,v249
v_mfma_f32_16x16x32_bf16 v[212:215],a[176:179],v[168:171],v[208:211]
s_nop 7
s_branch S_back_l_3
S_rare_l_4:
s_nop 7
v_max3_f32 v248,v144,v145,v146
v_max3_f32 v249,v147,v148,v149
v_max3_f32 v248,v248,v150,v151
v_max_f32 v248,v248,v249
v_mov_b32 v249,v248
s_nop 1
v_permlane32_swap_b32 v248,v249
v_max_f32 v248,v248,v249
v_mov_b32 v249,v248
s_nop 1
v_permlane16_swap_b32 v248,v249
v_max_f32 v248,v248,v249
v_max_f32 v248,0,v248
v_exp_f32 v249,-v248
v_sub_f32 v144,v144,v248
v_sub_f32 v145,v145,v248
v_sub_f32 v146,v146,v248
v_sub_f32 v147,v147,v248
v_sub_f32 v148,v148,v248
v_sub_f32 v149,v149,v248
v_sub_f32 v150,v150,v248
v_sub_f32 v151,v151,v248
v_sub_f32 v192,v192,v248
v_sub_f32 v193,v193,v248
v_sub_f32 v194,v194,v248
v_sub_f32 v195,v195,v248
v_exp_f32 v144,v144
v_exp_f32 v145,v145
v_exp_f32 v146,v146
v_exp_f32 v147,v147
v_exp_f32 v148,v148
v_exp_f32 v149,v149
v_exp_f32 v150,v150
v_exp_f32 v151,v151
v_mul_f32 v213,v213,v249
v_cvt_pk_bf16_f32 v172,v144,v145
v_cvt_pk_bf16_f32 v173,v146,v147
v_cvt_pk_bf16_f32 v174,v148,v149
v_cvt_pk_bf16_f32 v175,v150,v151
v_mul_f32 v32,v32,v249
v_mul_f32 v33,v33,v249
v_mul_f32 v34,v34,v249
v_mul_f32 v35,v35,v249
v_mul_f32 v36,v36,v249
v_mul_f32 v37,v37,v249
v_mul_f32 v38,v38,v249
v_mul_f32 v39,v39,v249
v_mul_f32 v40,v40,v249
v_mul_f32 v41,v41,v249
v_mul_f32 v42,v42,v249
v_mul_f32 v43,v43,v249
v_mul_f32 v44,v44,v249
v_mul_f32 v45,v45,v249
v_mul_f32 v46,v46,v249
v_mul_f32 v47,v47,v249
v_mul_f32 v48,v48,v249
v_mul_f32 v49,v49,v249
v_mul_f32 v50,v50,v249
v_mul_f32 v51,v51,v249
v_mul_f32 v52,v52,v249
v_mul_f32 v53,v53,v249
v_mul_f32 v54,v54,v249
v_mul_f32 v55,v55,v249
v_mul_f32 v56,v56,v249
v_mul_f32 v57,v57,v249
v_mul_f32 v58,v58,v249
v_mul_f32 v59,v59,v249
v_mul_f32 v60,v60,v249
v_mul_f32 v61,v61,v249
v_mul_f32 v62,v62,v249
v_mul_f32 v63,v63,v249
v_mfma_f32_16x16x32_bf16 v[208:211],a[180:183],v[172:175],v[212:215]
s_nop 7
s_branch S_back_l_4
S_rare_l_5:
s_nop 7
v_max3_f32 v248,v152,v153,v154
v_max3_f32 v249,v155,v156,v157
v_max3_f32 v248,v248,v158,v159
v_max_f32 v248,v248,v249
v_mov_b32 v249,v248
s_nop 1
v_permlane32_swap_b32 v248,v249
v_max_f32 v248,v248,v249
v_mov_b32 v249,v248
s_nop 1
v_permlane16_swap_b32 v248,v249
v_max_f32 v248,v248,v249
v_max_f32 v248,0,v248
v_exp_f32 v249,-v248
v_sub_f32 v152,v152,v248
v_sub_f32 v153,v153,v248
v_sub_f32 v154,v154,v248
v_sub_f32 v155,v155,v248
v_sub_f32 v156,v156,v248
v_sub_f32 v157,v157,v248
v_sub_f32 v158,v158,v248
v_sub_f32 v159,v159,v248
v_sub_f32 v196,v196,v248
v_sub_f32 v197,v197,v248
v_sub_f32 v198,v198,v248
v_sub_f32 v199,v199,v248
v_exp_f32 v152,v152
v_exp_f32 v153,v153
v_exp_f32 v154,v154
v_exp_f32 v155,v155
v_exp_f32 v156,v156
v_exp_f32 v157,v157
v_exp_f32 v158,v158
v_exp_f32 v159,v159
v_mul_f32 v210,v210,v249
v_cvt_pk_bf16_f32 v176,v152,v153
v_cvt_pk_bf16_f32 v177,v154,v155
v_cvt_pk_bf16_f32 v178,v156,v157
v_cvt_pk_bf16_f32 v179,v158,v159
v_mul_f32 v64,v64,v249
v_mul_f32 v65,v65,v249
v_mul_f32 v66,v66,v249
v_mul_f32 v67,v67,v249
v_mul_f32 v68,v68,v249
v_mul_f32 v69,v69,v249
v_mul_f32 v70,v70,v249
v_mul_f32 v71,v71,v249
v_mul_f32 v72,v72,v249
v_mul_f32 v73,v73,v249
v_mul_f32 v74,v74,v249
v_mul_f32 v75,v75,v249
v_mul_f32 v76,v76,v249
v_mul_f32 v77,v77,v249
v_mul_f32 v78,v78,v249
v_mul_f32 v79,v79,v249
v_mul_f32 v80,v80,v249
v_mul_f32 v81,v81,v249
v_mul_f32 v82,v82,v249
v_mul_f32 v83,v83,v249
v_mul_f32 v84,v84,v249
v_mul_f32 v85,v85,v249
v_mul_f32 v86,v86,v249
v_mul_f32 v87,v87,v249
v_mul_f32 v88,v88,v249
v_mul_f32 v89,v89,v249
v_mul_f32 v90,v90,v249
v_mul_f32 v91,v91,v249
v_mul_f32 v92,v92,v249
v_mul_f32 v93,v93,v249
v_mul_f32 v94,v94,v249
v_mul_f32 v95,v95,v249
v_mfma_f32_16x16x32_bf16 v[212:215],a[184:187],v[176:179],v[208:211]
s_nop 7
s_branch S_back_l_5
S_rare_l_6:
s_nop 7
v_max3_f32 v248,v160,v161,v162
v_max3_f32 v249,v163,v164,v165
v_max3_f32 v248,v248,v166,v167
v_max_f32 v248,v248,v249
v_mov_b32 v249,v248
s_nop 1
v_permlane32_swap_b32 v248,v249
v_max_f32 v248,v248,v249
v_mov_b32 v249,v248
s_nop 1
v_permlane16_swap_b32 v248,v249
v_max_f32 v248,v248,v249
v_max_f32 v248,0,v248
v_exp_f32 v249,-v248
v_sub_f32 v160,v160,v248
v_sub_f32 v161,v161,v248
v_sub_f32 v162,v162,v248
v_sub_f32 v163,v163,v248
v_sub_f32 v164,v164,v248
v_sub_f32 v165,v165,v248
v_sub_f32 v166,v166,v248
v_sub_f32 v167,v167,v248
v_sub_f32 v200,v200,v248
v_sub_f32 v201,v201,v248
v_sub_f32 v202,v202,v248
v_sub_f32 v203,v203,v248
v_exp_f32 v160,v160
v_exp_f32 v161,v161
v_exp_f32 v162,v162
v_exp_f32 v163,v163
v_exp_f32 v164,v164
v_exp_f32 v165,v165
v_exp_f32 v166,v166
v_exp_f32 v167,v167
v_mul_f32 v215,v215,v249
v_cvt_pk_bf16_f32 v180,v160,v161
v_cvt_pk_bf16_f32 v181,v162,v163
v_cvt_pk_bf16_f32 v182,v164,v165
v_cvt_pk_bf16_f32 v183,v166,v167
v_mul_f32 v96,v96,v249
v_mul_f32 v97,v97,v249
v_mul_f32 v98,v98,v249
v_mul_f32 v99,v99,v249
v_mul_f32 v100,v100,v249
v_mul_f32 v101,v101,v249
v_mul_f32 v102,v102,v249
v_mul_f32 v103,v103,v249
v_mul_f32 v104,v104,v249
v_mul_f32 v105,v105,v249
v_mul_f32 v106,v106,v249
v_mul_f32 v107,v107,v249
v_mul_f32 v108,v108,v249
v_mul_f32 v109,v109,v249
v_mul_f32 v110,v110,v249
v_mul_f32 v111,v111,v249
v_mul_f32 v112,v112,v249
v_mul_f32 v113,v113,v249
v_mul_f32 v114,v114,v249
v_mul_f32 v115,v115,v249
v_mul_f32 v116,v116,v249
v_mul_f32 v117,v117,v249
v_mul_f32 v118,v118,v249
v_mul_f32 v119,v119,v249
v_mul_f32 v120,v120,v249
v_mul_f32 v121,v121,v249
v_mul_f32 v122,v122,v249
v_mul_f32 v123,v123,v249
v_mul_f32 v124,v124,v249
v_mul_f32 v125,v125,v249
v_mul_f32 v126,v126,v249
v_mul_f32 v127,v127,v249
v_mfma_f32_16x16x32_bf16 v[208:211],a[188:191],v[180:183],v[212:215]
s_nop 7
s_branch S_back_l_6
S_rare_l_7:
s_nop 7
v_max3_f32 v248,v136,v137,v138
v_max3_f32 v249,v139,v140,v141
v_max3_f32 v248,v248,v142,v143
v_max_f32 v248,v248,v249
v_mov_b32 v249,v248
s_nop 1
v_permlane32_swap_b32 v248,v249
v_max_f32 v248,v248,v249
v_mov_b32 v249,v248
s_nop 1
v_permlane16_swap_b32 v248,v249
v_max_f32 v248,v248,v249
v_max_f32 v248,0,v248
v_exp_f32 v249,-v248
v_sub_f32 v136,v136,v248
v_sub_f32 v137,v137,v248
v_sub_f32 v138,v138,v248
v_sub_f32 v139,v139,v248
v_sub_f32 v140,v140,v248
v_sub_f32 v141,v141,v248
v_sub_f32 v142,v142,v248
v_sub_f32 v143,v143,v248
v_sub_f32 v204,v204,v248
v_sub_f32 v205,v205,v248
v_sub_f32 v206,v206,v248
v_sub_f32 v207,v207,v248
v_exp_f32 v136,v136
v_exp_f32 v137,v137
v_exp_f32 v138,v138
v_exp_f32 v139,v139
v_exp_f32 v140,v140
v_exp_f32 v141,v141
v_exp_f32 v142,v142
v_exp_f32 v143,v143
v_mul_f32 v216,v216,v249
v_cvt_pk_bf16_f32 v184,v136,v137
v_cvt_pk_bf16_f32 v185,v138,v139
v_cvt_pk_bf16_f32 v186,v140,v141
v_cvt_pk_bf16_f32 v187,v142,v143
v_accvgpr_read_b32 v250,a0
v_accvgpr_read_b32 v251,a1
v_mul_f32 v250,v250,v249
v_mul_f32 v251,v251,v249
v_accvgpr_write_b32 a0,v250
v_accvgpr_write_b32 a1,v251
v_accvgpr_read_b32 v250,a2
v_accvgpr_read_b32 v251,a3
v_mul_f32 v250,v250,v249
v_mul_f32 v251,v251,v249
v_accvgpr_write_b32 a2,v250
v_accvgpr_write_b32 a3,v251
v_accvgpr_read_b32 v250,a4
v_accvgpr_read_b32 v251,a5
v_mul_f32 v250,v250,v249
v_mul_f32 v251,v251,v249
v_accvgpr_write_b32 a4,v250
v_accvgpr_write_b32 a5,v251
v_accvgpr_read_b32 v250,a6
v_accvgpr_read_b32 v251,a7
v_mul_f32 v250,v250,v249
v_mul_f32 v251,v251,v249
v_accvgpr_write_b32 a6,v250
v_accvgpr_write_b32 a7,v251
v_accvgpr_read_b32 v250,a8
v_accvgpr_read_b32 v251,a9
v_mul_f32 v250,v250,v249
v_mul_f32 v251,v251,v249
v_accvgpr_write_b32 a8,v250
v_accvgpr_write_b32 a9,v251
v_accvgpr_read_b32 v250,a10
v_accvgpr_read_b32 v251,a11
v_mul_f32 v250,v250,v249
v_mul_f32 v251,v251,v249
v_accvgpr_write_b32 a10,v250
v_accvgpr_write_b32 a11,v251
v_accvgpr_read_b32 v250,a12
v_accvgpr_read_b32 v251,a13
v_mul_f32 v250,v250,v249
v_mul_f32 v251,v251,v249
v_accvgpr_write_b32 a12,v250
v_accvgpr_write_b32 a13,v251
v_accvgpr_read_b32 v250,a14
v_accvgpr_read_b32 v251,a15
v_mul_f32 v250,v250,v249
v_mul_f32 v251,v251,v249
v_accvgpr_write_b32 a14,v250
v_accvgpr_write_b32 a15,v251
v_accvgpr_read_b32 v250,a16
v_accvgpr_read_b32 v251,a17
v_mul_f32 v250,v250,v249
v_mul_f32 v251,v251,v249
v_accvgpr_write_b32 a16,v250
v_accvgpr_write_b32 a17,v251
v_accvgpr_read_b32 v250,a18
v_accvgpr_read_b32 v251,a19
v_mul_f32 v250,v250,v249
v_mul_f32 v251,v251,v249
v_accvgpr_write_b32 a18,v250
v_accvgpr_write_b32 a19,v251
v_accvgpr_read_b32 v250,a20
v_accvgpr_read_b32 v251,a21
v_mul_f32 v250,v250,v249
v_mul_f32 v251,v251,v249
v_accvgpr_write_b32 a20,v250
v_accvgpr_write_b32 a21,v251
v_accvgpr_read_b32 v250,a22
v_accvgpr_read_b32 v251,a23
v_mul_f32 v250,v250,v249
v_mul_f32 v251,v251,v249
v_accvgpr_write_b32 a22,v250
v_accvgpr_write_b32 a23,v251
v_accvgpr_read_b32 v250,a24
v_accvgpr_read_b32 v251,a25
v_mul_f32 v250,v250,v249
v_mul_f32 v251,v251,v249
v_accvgpr_write_b32 a24,v250
v_accvgpr_write_b32 a25,v251
v_accvgpr_read_b32 v250,a26
v_accvgpr_read_b32 v251,a27
v_mul_f32 v250,v250,v249
v_mul_f32 v251,v251,v249
v_accvgpr_write_b32 a26,v250
v_accvgpr_write_b32 a27,v251
v_accvgpr_read_b32 v250,a28
v_accvgpr_read_b32 v251,a29
v_mul_f32 v250,v250,v249
v_mul_f32 v251,v251,v249
v_accvgpr_write_b32 a28,v250
v_accvgpr_write_b32 a29,v251
v_accvgpr_read_b32 v250,a30
v_accvgpr_read_b32 v251,a31
v_mul_f32 v250,v250,v249
v_mul_f32 v251,v251,v249
v_accvgpr_write_b32 a30,v250
v_accvgpr_write_b32 a31,v251
v_mfma_f32_16x16x32_bf16 v[220:223],a[176:179],v[184:187],v[216:219]
s_nop 7
s_branch S_back_l_7
S_rare_l_8:
s_nop 7
v_max3_f32 v248,v128,v129,v130
v_max3_f32 v249,v131,v132,v133
v_max3_f32 v248,v248,v134,v135
v_max_f32 v248,v248,v249
v_mov_b32 v249,v248
s_nop 1
v_permlane32_swap_b32 v248,v249
v_max_f32 v248,v248,v249
v_mov_b32 v249,v248
s_nop 1
v_permlane16_swap_b32 v248,v249
v_max_f32 v248,v248,v249
v_max_f32 v248,0,v248
v_exp_f32 v249,-v248
v_sub_f32 v128,v128,v248
v_sub_f32 v129,v129,v248
v_sub_f32 v130,v130,v248
v_sub_f32 v131,v131,v248
v_sub_f32 v132,v132,v248
v_sub_f32 v133,v133,v248
v_sub_f32 v134,v134,v248
v_sub_f32 v135,v135,v248
v_sub_f32 v188,v188,v248
v_sub_f32 v189,v189,v248
v_sub_f32 v190,v190,v248
v_sub_f32 v191,v191,v248
v_exp_f32 v128,v128
v_exp_f32 v129,v129
v_exp_f32 v130,v130
v_exp_f32 v131,v131
v_exp_f32 v132,v132
v_exp_f32 v133,v133
v_exp_f32 v134,v134
v_exp_f32 v135,v135
v_mul_f32 v208,v208,v249
v_cvt_pk_bf16_f32 v168,v128,v129
v_cvt_pk_bf16_f32 v169,v130,v131
v_cvt_pk_bf16_f32 v170,v132,v133
v_cvt_pk_bf16_f32 v171,v134,v135
v_mul_f32 v0,v0,v249
v_mul_f32 v1,v1,v249
v_mul_f32 v2,v2,v249
v_mul_f32 v3,v3,v249
v_mul_f32 v4,v4,v249
v_mul_f32 v5,v5,v249
v_mul_f32 v6,v6,v249
v_mul_f32 v7,v7,v249
v_mul_f32 v8,v8,v249
v_mul_f32 v9,v9,v249
v_mul_f32 v10,v10,v249
v_mul_f32 v11,v11,v249
v_mul_f32 v12,v12,v249
v_mul_f32 v13,v13,v249
v_mul_f32 v14,v14,v249
v_mul_f32 v15,v15,v249
v_mul_f32 v16,v16,v249
v_mul_f32 v17,v17,v249
v_mul_f32 v18,v18,v249
v_mul_f32 v19,v19,v249
v_mul_f32 v20,v20,v249
v_mul_f32 v21,v21,v249
v_mul_f32 v22,v22,v249
v_mul_f32 v23,v23,v249
v_mul_f32 v24,v24,v249
v_mul_f32 v25,v25,v249
v_mul_f32 v26,v26,v249
v_mul_f32 v27,v27,v249
v_mul_f32 v28,v28,v249
v_mul_f32 v29,v29,v249
v_mul_f32 v30,v30,v249
v_mul_f32 v31,v31,v249
v_mfma_f32_16x16x32_bf16 v[212:215],a[176:179],v[168:171],v[208:211]
s_nop 7
s_branch S_back_l_8
S_rare_l_9:
s_nop 7
v_max3_f32 v248,v144,v145,v146
v_max3_f32 v249,v147,v148,v149
v_max3_f32 v248,v248,v150,v151
v_max_f32 v248,v248,v249
v_mov_b32 v249,v248
s_nop 1
v_permlane32_swap_b32 v248,v249
v_max_f32 v248,v248,v249
v_mov_b32 v249,v248
s_nop 1
v_permlane16_swap_b32 v248,v249
v_max_f32 v248,v248,v249
v_max_f32 v248,0,v248
v_exp_f32 v249,-v248
v_sub_f32 v144,v144,v248
v_sub_f32 v145,v145,v248
v_sub_f32 v146,v146,v248
v_sub_f32 v147,v147,v248
v_sub_f32 v148,v148,v248
v_sub_f32 v149,v149,v248
v_sub_f32 v150,v150,v248
v_sub_f32 v151,v151,v248
v_sub_f32 v192,v192,v248
v_sub_f32 v193,v193,v248
v_sub_f32 v194,v194,v248
v_sub_f32 v195,v195,v248
v_exp_f32 v144,v144
v_exp_f32 v145,v145
v_exp_f32 v146,v146
v_exp_f32 v147,v147
v_exp_f32 v148,v148
v_exp_f32 v149,v149
v_exp_f32 v150,v150
v_exp_f32 v151,v151
v_mul_f32 v213,v213,v249
v_cvt_pk_bf16_f32 v172,v144,v145
v_cvt_pk_bf16_f32 v173,v146,v147
v_cvt_pk_bf16_f32 v174,v148,v149
v_cvt_pk_bf16_f32 v175,v150,v151
v_mul_f32 v32,v32,v249
v_mul_f32 v33,v33,v249
v_mul_f32 v34,v34,v249
v_mul_f32 v35,v35,v249
v_mul_f32 v36,v36,v249
v_mul_f32 v37,v37,v249
v_mul_f32 v38,v38,v249
v_mul_f32 v39,v39,v249
v_mul_f32 v40,v40,v249
v_mul_f32 v41,v41,v249
v_mul_f32 v42,v42,v249
v_mul_f32 v43,v43,v249
v_mul_f32 v44,v44,v249
v_mul_f32 v45,v45,v249
v_mul_f32 v46,v46,v249
v_mul_f32 v47,v47,v249
v_mul_f32 v48,v48,v249
v_mul_f32 v49,v49,v249
v_mul_f32 v50,v50,v249
v_mul_f32 v51,v51,v249
v_mul_f32 v52,v52,v249
v_mul_f32 v53,v53,v249
v_mul_f32 v54,v54,v249
v_mul_f32 v55,v55,v249
v_mul_f32 v56,v56,v249
v_mul_f32 v57,v57,v249
v_mul_f32 v58,v58,v249
v_mul_f32 v59,v59,v249
v_mul_f32 v60,v60,v249
v_mul_f32 v61,v61,v249
v_mul_f32 v62,v62,v249
v_mul_f32 v63,v63,v249
v_mfma_f32_16x16x32_bf16 v[208:211],a[180:183],v[172:175],v[212:215]
s_nop 7
s_branch S_back_l_9
S_rare_l_10:
s_nop 7
v_max3_f32 v248,v152,v153,v154
v_max3_f32 v249,v155,v156,v157
v_max3_f32 v248,v248,v158,v159
v_max_f32 v248,v248,v249
v_mov_b32 v249,v248
s_nop 1
v_permlane32_swap_b32 v248,v249
v_max_f32 v248,v248,v249
v_mov_b32 v249,v248
s_nop 1
v_permlane16_swap_b32 v248,v249
v_max_f32 v248,v248,v249
v_max_f32 v248,0,v248
v_exp_f32 v249,-v248
v_sub_f32 v152,v152,v248
v_sub_f32 v153,v153,v248
v_sub_f32 v154,v154,v248
v_sub_f32 v155,v155,v248
v_sub_f32 v156,v156,v248
v_sub_f32 v157,v157,v248
v_sub_f32 v158,v158,v248
v_sub_f32 v159,v159,v248
v_sub_f32 v196,v196,v248
v_sub_f32 v197,v197,v248
v_sub_f32 v198,v198,v248
v_sub_f32 v199,v199,v248
v_exp_f32 v152,v152
v_exp_f32 v153,v153
v_exp_f32 v154,v154
v_exp_f32 v155,v155
v_exp_f32 v156,v156
v_exp_f32 v157,v157
v_exp_f32 v158,v158
v_exp_f32 v159,v159
v_mul_f32 v210,v210,v249
v_cvt_pk_bf16_f32 v176,v152,v153
v_cvt_pk_bf16_f32 v177,v154,v155
v_cvt_pk_bf16_f32 v178,v156,v157
v_cvt_pk_bf16_f32 v179,v158,v159
v_mul_f32 v64,v64,v249
v_mul_f32 v65,v65,v249
v_mul_f32 v66,v66,v249
v_mul_f32 v67,v67,v249
v_mul_f32 v68,v68,v249
v_mul_f32 v69,v69,v249
v_mul_f32 v70,v70,v249
v_mul_f32 v71,v71,v249
v_mul_f32 v72,v72,v249
v_mul_f32 v73,v73,v249
v_mul_f32 v74,v74,v249
v_mul_f32 v75,v75,v249
v_mul_f32 v76,v76,v249
v_mul_f32 v77,v77,v249
v_mul_f32 v78,v78,v249
v_mul_f32 v79,v79,v249
v_mul_f32 v80,v80,v249
v_mul_f32 v81,v81,v249
v_mul_f32 v82,v82,v249
v_mul_f32 v83,v83,v249
v_mul_f32 v84,v84,v249
v_mul_f32 v85,v85,v249
v_mul_f32 v86,v86,v249
v_mul_f32 v87,v87,v249
v_mul_f32 v88,v88,v249
v_mul_f32 v89,v89,v249
v_mul_f32 v90,v90,v249
v_mul_f32 v91,v91,v249
v_mul_f32 v92,v92,v249
v_mul_f32 v93,v93,v249
v_mul_f32 v94,v94,v249
v_mul_f32 v95,v95,v249
v_mfma_f32_16x16x32_bf16 v[212:215],a[184:187],v[176:179],v[208:211]
s_nop 7
s_branch S_back_l_10
S_rare_l_11:
s_nop 7
v_max3_f32 v248,v160,v161,v162
v_max3_f32 v249,v163,v164,v165
v_max3_f32 v248,v248,v166,v167
v_max_f32 v248,v248,v249
v_mov_b32 v249,v248
s_nop 1
v_permlane32_swap_b32 v248,v249
v_max_f32 v248,v248,v249
v_mov_b32 v249,v248
s_nop 1
v_permlane16_swap_b32 v248,v249
v_max_f32 v248,v248,v249
v_max_f32 v248,0,v248
v_exp_f32 v249,-v248
v_sub_f32 v160,v160,v248
v_sub_f32 v161,v161,v248
v_sub_f32 v162,v162,v248
v_sub_f32 v163,v163,v248
v_sub_f32 v164,v164,v248
v_sub_f32 v165,v165,v248
v_sub_f32 v166,v166,v248
v_sub_f32 v167,v167,v248
v_sub_f32 v200,v200,v248
v_sub_f32 v201,v201,v248
v_sub_f32 v202,v202,v248
v_sub_f32 v203,v203,v248
v_exp_f32 v160,v160
v_exp_f32 v161,v161
v_exp_f32 v162,v162
v_exp_f32 v163,v163
v_exp_f32 v164,v164
v_exp_f32 v165,v165
v_exp_f32 v166,v166
v_exp_f32 v167,v167
v_mul_f32 v215,v215,v249
v_cvt_pk_bf16_f32 v180,v160,v161
v_cvt_pk_bf16_f32 v181,v162,v163
v_cvt_pk_bf16_f32 v182,v164,v165
v_cvt_pk_bf16_f32 v183,v166,v167
v_mul_f32 v96,v96,v249
v_mul_f32 v97,v97,v249
v_mul_f32 v98,v98,v249
v_mul_f32 v99,v99,v249
v_mul_f32 v100,v100,v249
v_mul_f32 v101,v101,v249
v_mul_f32 v102,v102,v249
v_mul_f32 v103,v103,v249
v_mul_f32 v104,v104,v249
v_mul_f32 v105,v105,v249
v_mul_f32 v106,v106,v249
v_mul_f32 v107,v107,v249
v_mul_f32 v108,v108,v249
v_mul_f32 v109,v109,v249
v_mul_f32 v110,v110,v249
v_mul_f32 v111,v111,v249
v_mul_f32 v112,v112,v249
v_mul_f32 v113,v113,v249
v_mul_f32 v114,v114,v249
v_mul_f32 v115,v115,v249
v_mul_f32 v116,v116,v249
v_mul_f32 v117,v117,v249
v_mul_f32 v118,v118,v249
v_mul_f32 v119,v119,v249
v_mul_f32 v120,v120,v249
v_mul_f32 v121,v121,v249
v_mul_f32 v122,v122,v249
v_mul_f32 v123,v123,v249
v_mul_f32 v124,v124,v249
v_mul_f32 v125,v125,v249
v_mul_f32 v126,v126,v249
v_mul_f32 v127,v127,v249
v_mfma_f32_16x16x32_bf16 v[208:211],a[188:191],v[180:183],v[212:215]
s_nop 7
s_branch S_back_l_11
S_rare_l_12:
s_nop 7
v_max3_f32 v248,v128,v129,v130
v_max3_f32 v249,v131,v132,v133
v_max3_f32 v248,v248,v134,v135
v_max_f32 v248,v248,v249
v_mov_b32 v249,v248
s_nop 1
v_permlane32_swap_b32 v248,v249
v_max_f32 v248,v248,v249
v_mov_b32 v249,v248
s_nop 1
v_permlane16_swap_b32 v248,v249
v_max_f32 v248,v248,v249
v_max_f32 v248,0,v248
v_exp_f32 v249,-v248
v_sub_f32 v128,v128,v248
v_sub_f32 v129,v129,v248
v_sub_f32 v130,v130,v248
v_sub_f32 v131,v131,v248
v_sub_f32 v132,v132,v248
v_sub_f32 v133,v133,v248
v_sub_f32 v134,v134,v248
v_sub_f32 v135,v135,v248
v_sub_f32 v188,v188,v248
v_sub_f32 v189,v189,v248
v_sub_f32 v190,v190,v248
v_sub_f32 v191,v191,v248
v_exp_f32 v128,v128
v_exp_f32 v129,v129
v_exp_f32 v130,v130
v_exp_f32 v131,v131
v_exp_f32 v132,v132
v_exp_f32 v133,v133
v_exp_f32 v134,v134
v_exp_f32 v135,v135
v_mul_f32 v208,v208,v249
v_cvt_pk_bf16_f32 v168,v128,v129
v_cvt_pk_bf16_f32 v169,v130,v131
v_cvt_pk_bf16_f32 v170,v132,v133
v_cvt_pk_bf16_f32 v171,v134,v135
v_mul_f32 v0,v0,v249
v_mul_f32 v1,v1,v249
v_mul_f32 v2,v2,v249
v_mul_f32 v3,v3,v249
v_mul_f32 v4,v4,v249
v_mul_f32 v5,v5,v249
v_mul_f32 v6,v6,v249
v_mul_f32 v7,v7,v249
v_mul_f32 v8,v8,v249
v_mul_f32 v9,v9,v249
v_mul_f32 v10,v10,v249
v_mul_f32 v11,v11,v249
v_mul_f32 v12,v12,v249
v_mul_f32 v13,v13,v249
v_mul_f32 v14,v14,v249
v_mul_f32 v15,v15,v249
v_mul_f32 v16,v16,v249
v_mul_f32 v17,v17,v249
v_mul_f32 v18,v18,v249
v_mul_f32 v19,v19,v249
v_mul_f32 v20,v20,v249
v_mul_f32 v21,v21,v249
v_mul_f32 v22,v22,v249
v_mul_f32 v23,v23,v249
v_mul_f32 v24,v24,v249
v_mul_f32 v25,v25,v249
v_mul_f32 v26,v26,v249
v_mul_f32 v27,v27,v249
v_mul_f32 v28,v28,v249
v_mul_f32 v29,v29,v249
v_mul_f32 v30,v30,v249
v_mul_f32 v31,v31,v249
v_mfma_f32_16x16x32_bf16 v[212:215],a[176:179],v[168:171],v[208:211]
s_nop 7
s_branch S_back_l_12
S_rare_l_13:
s_nop 7
v_max3_f32 v248,v144,v145,v146
v_max3_f32 v249,v147,v148,v149
v_max3_f32 v248,v248,v150,v151
v_max_f32 v248,v248,v249
v_mov_b32 v249,v248
s_nop 1
v_permlane32_swap_b32 v248,v249
v_max_f32 v248,v248,v249
v_mov_b32 v249,v248
s_nop 1
v_permlane16_swap_b32 v248,v249
v_max_f32 v248,v248,v249
v_max_f32 v248,0,v248
v_exp_f32 v249,-v248
v_sub_f32 v144,v144,v248
v_sub_f32 v145,v145,v248
v_sub_f32 v146,v146,v248
v_sub_f32 v147,v147,v248
v_sub_f32 v148,v148,v248
v_sub_f32 v149,v149,v248
v_sub_f32 v150,v150,v248
v_sub_f32 v151,v151,v248
v_sub_f32 v192,v192,v248
v_sub_f32 v193,v193,v248
v_sub_f32 v194,v194,v248
v_sub_f32 v195,v195,v248
v_exp_f32 v144,v144
v_exp_f32 v145,v145
v_exp_f32 v146,v146
v_exp_f32 v147,v147
v_exp_f32 v148,v148
v_exp_f32 v149,v149
v_exp_f32 v150,v150
v_exp_f32 v151,v151
v_mul_f32 v213,v213,v249
v_cvt_pk_bf16_f32 v172,v144,v145
v_cvt_pk_bf16_f32 v173,v146,v147
v_cvt_pk_bf16_f32 v174,v148,v149
v_cvt_pk_bf16_f32 v175,v150,v151
v_mul_f32 v32,v32,v249
v_mul_f32 v33,v33,v249
v_mul_f32 v34,v34,v249
v_mul_f32 v35,v35,v249
v_mul_f32 v36,v36,v249
v_mul_f32 v37,v37,v249
v_mul_f32 v38,v38,v249
v_mul_f32 v39,v39,v249
v_mul_f32 v40,v40,v249
v_mul_f32 v41,v41,v249
v_mul_f32 v42,v42,v249
v_mul_f32 v43,v43,v249
v_mul_f32 v44,v44,v249
v_mul_f32 v45,v45,v249
v_mul_f32 v46,v46,v249
v_mul_f32 v47,v47,v249
v_mul_f32 v48,v48,v249
v_mul_f32 v49,v49,v249
v_mul_f32 v50,v50,v249
v_mul_f32 v51,v51,v249
v_mul_f32 v52,v52,v249
v_mul_f32 v53,v53,v249
v_mul_f32 v54,v54,v249
v_mul_f32 v55,v55,v249
v_mul_f32 v56,v56,v249
v_mul_f32 v57,v57,v249
v_mul_f32 v58,v58,v249
v_mul_f32 v59,v59,v249
v_mul_f32 v60,v60,v249
v_mul_f32 v61,v61,v249
v_mul_f32 v62,v62,v249
v_mul_f32 v63,v63,v249
v_mfma_f32_16x16x32_bf16 v[208:211],a[180:183],v[172:175],v[212:215]
s_nop 7
s_branch S_back_l_13
S_rare_l_14:
s_nop 7
v_max3_f32 v248,v152,v153,v154
v_max3_f32 v249,v155,v156,v157
v_max3_f32 v248,v248,v158,v159
v_max_f32 v248,v248,v249
v_mov_b32 v249,v248
s_nop 1
v_permlane32_swap_b32 v248,v249
v_max_f32 v248,v248,v249
v_mov_b32 v249,v248
s_nop 1
v_permlane16_swap_b32 v248,v249
v_max_f32 v248,v248,v249
v_max_f32 v248,0,v248
v_exp_f32 v249,-v248
v_sub_f32 v152,v152,v248
v_sub_f32 v153,v153,v248
v_sub_f32 v154,v154,v248
v_sub_f32 v155,v155,v248
v_sub_f32 v156,v156,v248
v_sub_f32 v157,v157,v248
v_sub_f32 v158,v158,v248
v_sub_f32 v159,v159,v248
v_sub_f32 v196,v196,v248
v_sub_f32 v197,v197,v248
v_sub_f32 v198,v198,v248
v_sub_f32 v199,v199,v248
v_exp_f32 v152,v152
v_exp_f32 v153,v153
v_exp_f32 v154,v154
v_exp_f32 v155,v155
v_exp_f32 v156,v156
v_exp_f32 v157,v157
v_exp_f32 v158,v158
v_exp_f32 v159,v159
v_mul_f32 v210,v210,v249
v_cvt_pk_bf16_f32 v176,v152,v153
v_cvt_pk_bf16_f32 v177,v154,v155
v_cvt_pk_bf16_f32 v178,v156,v157
v_cvt_pk_bf16_f32 v179,v158,v159
v_mul_f32 v64,v64,v249
v_mul_f32 v65,v65,v249
v_mul_f32 v66,v66,v249
v_mul_f32 v67,v67,v249
v_mul_f32 v68,v68,v249
v_mul_f32 v69,v69,v249
v_mul_f32 v70,v70,v249
v_mul_f32 v71,v71,v249
v_mul_f32 v72,v72,v249
v_mul_f32 v73,v73,v249
v_mul_f32 v74,v74,v249
v_mul_f32 v75,v75,v249
v_mul_f32 v76,v76,v249
v_mul_f32 v77,v77,v249
v_mul_f32 v78,v78,v249
v_mul_f32 v79,v79,v249
v_mul_f32 v80,v80,v249
v_mul_f32 v81,v81,v249
v_mul_f32 v82,v82,v249
v_mul_f32 v83,v83,v249
v_mul_f32 v84,v84,v249
v_mul_f32 v85,v85,v249
v_mul_f32 v86,v86,v249
v_mul_f32 v87,v87,v249
v_mul_f32 v88,v88,v249
v_mul_f32 v89,v89,v249
v_mul_f32 v90,v90,v249
v_mul_f32 v91,v91,v249
v_mul_f32 v92,v92,v249
v_mul_f32 v93,v93,v249
v_mul_f32 v94,v94,v249
v_mul_f32 v95,v95,v249
v_mfma_f32_16x16x32_bf16 v[212:215],a[184:187],v[176:179],v[208:211]
s_nop 7
s_branch S_back_l_14
S_rare_l_15:
s_nop 7
v_max3_f32 v248,v160,v161,v162
v_max3_f32 v249,v163,v164,v165
v_max3_f32 v248,v248,v166,v167
v_max_f32 v248,v248,v249
v_mov_b32 v249,v248
s_nop 1
v_permlane32_swap_b32 v248,v249
v_max_f32 v248,v248,v249
v_mov_b32 v249,v248
s_nop 1
v_permlane16_swap_b32 v248,v249
v_max_f32 v248,v248,v249
v_max_f32 v248,0,v248
v_exp_f32 v249,-v248
v_sub_f32 v160,v160,v248
v_sub_f32 v161,v161,v248
v_sub_f32 v162,v162,v248
v_sub_f32 v163,v163,v248
v_sub_f32 v164,v164,v248
v_sub_f32 v165,v165,v248
v_sub_f32 v166,v166,v248
v_sub_f32 v167,v167,v248
v_sub_f32 v200,v200,v248
v_sub_f32 v201,v201,v248
v_sub_f32 v202,v202,v248
v_sub_f32 v203,v203,v248
v_exp_f32 v160,v160
v_exp_f32 v161,v161
v_exp_f32 v162,v162
v_exp_f32 v163,v163
v_exp_f32 v164,v164
v_exp_f32 v165,v165
v_exp_f32 v166,v166
v_exp_f32 v167,v167
v_mul_f32 v215,v215,v249
v_cvt_pk_bf16_f32 v180,v160,v161
v_cvt_pk_bf16_f32 v181,v162,v163
v_cvt_pk_bf16_f32 v182,v164,v165
v_cvt_pk_bf16_f32 v183,v166,v167
v_mul_f32 v96,v96,v249
v_mul_f32 v97,v97,v249
v_mul_f32 v98,v98,v249
v_mul_f32 v99,v99,v249
v_mul_f32 v100,v100,v249
v_mul_f32 v101,v101,v249
v_mul_f32 v102,v102,v249
v_mul_f32 v103,v103,v249
v_mul_f32 v104,v104,v249
v_mul_f32 v105,v105,v249
v_mul_f32 v106,v106,v249
v_mul_f32 v107,v107,v249
v_mul_f32 v108,v108,v249
v_mul_f32 v109,v109,v249
v_mul_f32 v110,v110,v249
v_mul_f32 v111,v111,v249
v_mul_f32 v112,v112,v249
v_mul_f32 v113,v113,v249
v_mul_f32 v114,v114,v249
v_mul_f32 v115,v115,v249
v_mul_f32 v116,v116,v249
v_mul_f32 v117,v117,v249
v_mul_f32 v118,v118,v249
v_mul_f32 v119,v119,v249
v_mul_f32 v120,v120,v249
v_mul_f32 v121,v121,v249
v_mul_f32 v122,v122,v249
v_mul_f32 v123,v123,v249
v_mul_f32 v124,v124,v249
v_mul_f32 v125,v125,v249
v_mul_f32 v126,v126,v249
v_mul_f32 v127,v127,v249
v_mfma_f32_16x16x32_bf16 v[208:211],a[188:191],v[180:183],v[212:215]
s_nop 7
s_branch S_back_l_15
S_rare_l_16:
s_nop 7
v_max3_f32 v248,v136,v137,v138
v_max3_f32 v249,v139,v140,v141
v_max3_f32 v248,v248,v142,v143
v_max_f32 v248,v248,v249
v_mov_b32 v249,v248
s_nop 1
v_permlane32_swap_b32 v248,v249
v_max_f32 v248,v248,v249
v_mov_b32 v249,v248
s_nop 1
v_permlane16_swap_b32 v248,v249
v_max_f32 v248,v248,v249
v_max_f32 v248,0,v248
v_exp_f32 v249,-v248
v_sub_f32 v136,v136,v248
v_sub_f32 v137,v137,v248
v_sub_f32 v138,v138,v248
v_sub_f32 v139,v139,v248
v_sub_f32 v140,v140,v248
v_sub_f32 v141,v141,v248
v_sub_f32 v142,v142,v248
v_sub_f32 v143,v143,v248
v_sub_f32 v204,v204,v248
v_sub_f32 v205,v205,v248
v_sub_f32 v206,v206,v248
v_sub_f32 v207,v207,v248
v_exp_f32 v136,v136
v_exp_f32 v137,v137
v_exp_f32 v138,v138
v_exp_f32 v139,v139
v_exp_f32 v140,v140
v_exp_f32 v141,v141
v_exp_f32 v142,v142
v_exp_f32 v143,v143
v_mul_f32 v220,v220,v249
v_cvt_pk_bf16_f32 v184,v136,v137
v_cvt_pk_bf16_f32 v185,v138,v139
v_cvt_pk_bf16_f32 v186,v140,v141
v_cvt_pk_bf16_f32 v187,v142,v143
v_accvgpr_read_b32 v250,a0
v_accvgpr_read_b32 v251,a1
v_mul_f32 v250,v250,v249
v_mul_f32 v251,v251,v249
v_accvgpr_write_b32 a0,v250
v_accvgpr_write_b32 a1,v251
v_accvgpr_read_b32 v250,a2
v_accvgpr_read_b32 v251,a3
v_mul_f32 v250,v250,v249
v_mul_f32 v251,v251,v249
v_accvgpr_write_b32 a2,v250
v_accvgpr_write_b32 a3,v251
v_accvgpr_read_b32 v250,a4
v_accvgpr_read_b32 v251,a5
v_mul_f32 v250,v250,v249
v_mul_f32 v251,v251,v249
v_accvgpr_write_b32 a4,v250
v_accvgpr_write_b32 a5,v251
v_accvgpr_read_b32 v250,a6
v_accvgpr_read_b32 v251,a7
v_mul_f32 v250,v250,v249
v_mul_f32 v251,v251,v249
v_accvgpr_write_b32 a6,v250
v_accvgpr_write_b32 a7,v251
v_accvgpr_read_b32 v250,a8
v_accvgpr_read_b32 v251,a9
v_mul_f32 v250,v250,v249
v_mul_f32 v251,v251,v249
v_accvgpr_write_b32 a8,v250
v_accvgpr_write_b32 a9,v251
v_accvgpr_read_b32 v250,a10
v_accvgpr_read_b32 v251,a11
v_mul_f32 v250,v250,v249
v_mul_f32 v251,v251,v249
v_accvgpr_write_b32 a10,v250
v_accvgpr_write_b32 a11,v251
v_accvgpr_read_b32 v250,a12
v_accvgpr_read_b32 v251,a13
v_mul_f32 v250,v250,v249
v_mul_f32 v251,v251,v249
v_accvgpr_write_b32 a12,v250
v_accvgpr_write_b32 a13,v251
v_accvgpr_read_b32 v250,a14
v_accvgpr_read_b32 v251,a15
v_mul_f32 v250,v250,v249
v_mul_f32 v251,v251,v249
v_accvgpr_write_b32 a14,v250
v_accvgpr_write_b32 a15,v251
v_accvgpr_read_b32 v250,a16
v_accvgpr_read_b32 v251,a17
v_mul_f32 v250,v250,v249
v_mul_f32 v251,v251,v249
v_accvgpr_write_b32 a16,v250
v_accvgpr_write_b32 a17,v251
v_accvgpr_read_b32 v250,a18
v_accvgpr_read_b32 v251,a19
v_mul_f32 v250,v250,v249
v_mul_f32 v251,v251,v249
v_accvgpr_write_b32 a18,v250
v_accvgpr_write_b32 a19,v251
v_accvgpr_read_b32 v250,a20
v_accvgpr_read_b32 v251,a21
v_mul_f32 v250,v250,v249
v_mul_f32 v251,v251,v249
v_accvgpr_write_b32 a20,v250
v_accvgpr_write_b32 a21,v251
v_accvgpr_read_b32 v250,a22
v_accvgpr_read_b32 v251,a23
v_mul_f32 v250,v250,v249
v_mul_f32 v251,v251,v249
v_accvgpr_write_b32 a22,v250
v_accvgpr_write_b32 a23,v251
v_accvgpr_read_b32 v250,a24
v_accvgpr_read_b32 v251,a25
v_mul_f32 v250,v250,v249
v_mul_f32 v251,v251,v249
v_accvgpr_write_b32 a24,v250
v_accvgpr_write_b32 a25,v251
v_accvgpr_read_b32 v250,a26
v_accvgpr_read_b32 v251,a27
v_mul_f32 v250,v250,v249
v_mul_f32 v251,v251,v249
v_accvgpr_write_b32 a26,v250
v_accvgpr_write_b32 a27,v251
v_accvgpr_read_b32 v250,a28
v_accvgpr_read_b32 v251,a29
v_mul_f32 v250,v250,v249
v_mul_f32 v251,v251,v249
v_accvgpr_write_b32 a28,v250
v_accvgpr_write_b32 a29,v251
v_accvgpr_read_b32 v250,a30
v_accvgpr_read_b32 v251,a31
v_mul_f32 v250,v250,v249
v_mul_f32 v251,v251,v249
v_accvgpr_write_b32 a30,v250
v_accvgpr_write_b32 a31,v251
v_mfma_f32_16x16x32_bf16 v[216:219],a[176:179],v[184:187],v[220:223]
s_nop 7
s_branch S_back_l_16
S_rare_l_17:
s_nop 7
v_max3_f32 v248,v128,v129,v130
v_max3_f32 v249,v131,v132,v133
v_max3_f32 v248,v248,v134,v135
v_max_f32 v248,v248,v249
v_mov_b32 v249,v248
s_nop 1
v_permlane32_swap_b32 v248,v249
v_max_f32 v248,v248,v249
v_mov_b32 v249,v248
s_nop 1
v_permlane16_swap_b32 v248,v249
v_max_f32 v248,v248,v249
v_max_f32 v248,0,v248
v_exp_f32 v249,-v248
v_sub_f32 v128,v128,v248
v_sub_f32 v129,v129,v248
v_sub_f32 v130,v130,v248
v_sub_f32 v131,v131,v248
v_sub_f32 v132,v132,v248
v_sub_f32 v133,v133,v248
v_sub_f32 v134,v134,v248
v_sub_f32 v135,v135,v248
v_sub_f32 v188,v188,v248
v_sub_f32 v189,v189,v248
v_sub_f32 v190,v190,v248
v_sub_f32 v191,v191,v248
v_exp_f32 v128,v128
v_exp_f32 v129,v129
v_exp_f32 v130,v130
v_exp_f32 v131,v131
v_exp_f32 v132,v132
v_exp_f32 v133,v133
v_exp_f32 v134,v134
v_exp_f32 v135,v135
v_mul_f32 v208,v208,v249
v_cvt_pk_bf16_f32 v168,v128,v129
v_cvt_pk_bf16_f32 v169,v130,v131
v_cvt_pk_bf16_f32 v170,v132,v133
v_cvt_pk_bf16_f32 v171,v134,v135
v_mul_f32 v0,v0,v249
v_mul_f32 v1,v1,v249
v_mul_f32 v2,v2,v249
v_mul_f32 v3,v3,v249
v_mul_f32 v4,v4,v249
v_mul_f32 v5,v5,v249
v_mul_f32 v6,v6,v249
v_mul_f32 v7,v7,v249
v_mul_f32 v8,v8,v249
v_mul_f32 v9,v9,v249
v_mul_f32 v10,v10,v249
v_mul_f32 v11,v11,v249
v_mul_f32 v12,v12,v249
v_mul_f32 v13,v13,v249
v_mul_f32 v14,v14,v249
v_mul_f32 v15,v15,v249
v_mul_f32 v16,v16,v249
v_mul_f32 v17,v17,v249
v_mul_f32 v18,v18,v249
v_mul_f32 v19,v19,v249
v_mul_f32 v20,v20,v249
v_mul_f32 v21,v21,v249
v_mul_f32 v22,v22,v249
v_mul_f32 v23,v23,v249
v_mul_f32 v24,v24,v249
v_mul_f32 v25,v25,v249
v_mul_f32 v26,v26,v249
v_mul_f32 v27,v27,v249
v_mul_f32 v28,v28,v249
v_mul_f32 v29,v29,v249
v_mul_f32 v30,v30,v249
v_mul_f32 v31,v31,v249
v_mfma_f32_16x16x32_bf16 v[212:215],a[176:179],v[168:171],v[208:211]
s_nop 7
s_branch S_back_l_17
S_rare_z_0:
s_nop 7
v_max3_f32 v248,v144,v145,v146
v_max3_f32 v249,v147,v148,v149
v_max3_f32 v248,v248,v150,v151
v_max_f32 v248,v248,v249
v_mov_b32 v249,v248
s_nop 1
v_permlane32_swap_b32 v248,v249
v_max_f32 v248,v248,v249
v_mov_b32 v249,v248
s_nop 1
v_permlane16_swap_b32 v248,v249
v_max_f32 v248,v248,v249
v_max_f32 v248,0,v248
v_exp_f32 v249,-v248
v_sub_f32 v144,v144,v248
v_sub_f32 v145,v145,v248
v_sub_f32 v146,v146,v248
v_sub_f32 v147,v147,v248
v_sub_f32 v148,v148,v248
v_sub_f32 v149,v149,v248
v_sub_f32 v150,v150,v248
v_sub_f32 v151,v151,v248
v_sub_f32 v192,v192,v248
v_sub_f32 v193,v193,v248
v_sub_f32 v194,v194,v248
v_sub_f32 v195,v195,v248
v_exp_f32 v144,v144
v_exp_f32 v145,v145
v_exp_f32 v146,v146
v_exp_f32 v147,v147
v_exp_f32 v148,v148
v_exp_f32 v149,v149
v_exp_f32 v150,v150
v_exp_f32 v151,v151
v_mul_f32 v213,v213,v249
v_cvt_pk_bf16_f32 v172,v144,v145
v_cvt_pk_bf16_f32 v173,v146,v147
v_cvt_pk_bf16_f32 v174,v148,v149
v_cvt_pk_bf16_f32 v175,v150,v151
v_mul_f32 v32,v32,v249
v_mul_f32 v33,v33,v249
v_mul_f32 v34,v34,v249
v_mul_f32 v35,v35,v249
v_mul_f32 v36,v36,v249
v_mul_f32 v37,v37,v249
v_mul_f32 v38,v38,v249
v_mul_f32 v39,v39,v249
v_mul_f32 v40,v40,v249
v_mul_f32 v41,v41,v249
v_mul_f32 v42,v42,v249
v_mul_f32 v43,v43,v249
v_mul_f32 v44,v44,v249
v_mul_f32 v45,v45,v249
v_mul_f32 v46,v46,v249
v_mul_f32 v47,v47,v249
v_mul_f32 v48,v48,v249
v_mul_f32 v49,v49,v249
v_mul_f32 v50,v50,v249
v_mul_f32 v51,v51,v249
v_mul_f32 v52,v52,v249
v_mul_f32 v53,v53,v249
v_mul_f32 v54,v54,v249
v_mul_f32 v55,v55,v249
v_mul_f32 v56,v56,v249
v_mul_f32 v57,v57,v249
v_mul_f32 v58,v58,v249
v_mul_f32 v59,v59,v249
v_mul_f32 v60,v60,v249
v_mul_f32 v61,v61,v249
v_mul_f32 v62,v62,v249
v_mul_f32 v63,v63,v249
v_mfma_f32_16x16x32_bf16 v[208:211],a[180:183],v[172:175],v[212:215]
s_nop 7
s_branch S_back_z_0
S_rare_z_1:
s_nop 7
v_max3_f32 v248,v152,v153,v154
v_max3_f32 v249,v155,v156,v157
v_max3_f32 v248,v248,v158,v159
v_max_f32 v248,v248,v249
v_mov_b32 v249,v248
s_nop 1
v_permlane32_swap_b32 v248,v249
v_max_f32 v248,v248,v249
v_mov_b32 v249,v248
s_nop 1
v_permlane16_swap_b32 v248,v249
v_max_f32 v248,v248,v249
v_max_f32 v248,0,v248
v_exp_f32 v249,-v248
v_sub_f32 v152,v152,v248
v_sub_f32 v153,v153,v248
v_sub_f32 v154,v154,v248
v_sub_f32 v155,v155,v248
v_sub_f32 v156,v156,v248
v_sub_f32 v157,v157,v248
v_sub_f32 v158,v158,v248
v_sub_f32 v159,v159,v248
v_sub_f32 v196,v196,v248
v_sub_f32 v197,v197,v248
v_sub_f32 v198,v198,v248
v_sub_f32 v199,v199,v248
v_exp_f32 v152,v152
v_exp_f32 v153,v153
v_exp_f32 v154,v154
v_exp_f32 v155,v155
v_exp_f32 v156,v156
v_exp_f32 v157,v157
v_exp_f32 v158,v158
v_exp_f32 v159,v159
v_mul_f32 v210,v210,v249
v_cvt_pk_bf16_f32 v176,v152,v153
v_cvt_pk_bf16_f32 v177,v154,v155
v_cvt_pk_bf16_f32 v178,v156,v157
v_cvt_pk_bf16_f32 v179,v158,v159
v_mul_f32 v64,v64,v249
v_mul_f32 v65,v65,v249
v_mul_f32 v66,v66,v249
v_mul_f32 v67,v67,v249
v_mul_f32 v68,v68,v249
v_mul_f32 v69,v69,v249
v_mul_f32 v70,v70,v249
v_mul_f32 v71,v71,v249
v_mul_f32 v72,v72,v249
v_mul_f32 v73,v73,v249
v_mul_f32 v74,v74,v249
v_mul_f32 v75,v75,v249
v_mul_f32 v76,v76,v249
v_mul_f32 v77,v77,v249
v_mul_f32 v78,v78,v249
v_mul_f32 v79,v79,v249
v_mul_f32 v80,v80,v249
v_mul_f32 v81,v81,v249
v_mul_f32 v82,v82,v249
v_mul_f32 v83,v83,v249
v_mul_f32 v84,v84,v249
v_mul_f32 v85,v85,v249
v_mul_f32 v86,v86,v249
v_mul_f32 v87,v87,v249
v_mul_f32 v88,v88,v249
v_mul_f32 v89,v89,v249
v_mul_f32 v90,v90,v249
v_mul_f32 v91,v91,v249
v_mul_f32 v92,v92,v249
v_mul_f32 v93,v93,v249
v_mul_f32 v94,v94,v249
v_mul_f32 v95,v95,v249
v_mfma_f32_16x16x32_bf16 v[212:215],a[184:187],v[176:179],v[208:211]
s_nop 7
s_branch S_back_z_1
S_rare_z_2:
s_nop 7
v_max3_f32 v248,v160,v161,v162
v_max3_f32 v249,v163,v164,v165
v_max3_f32 v248,v248,v166,v167
v_max_f32 v248,v248,v249
v_mov_b32 v249,v248
s_nop 1
v_permlane32_swap_b32 v248,v249
v_max_f32 v248,v248,v249
v_mov_b32 v249,v248
s_nop 1
v_permlane16_swap_b32 v248,v249
v_max_f32 v248,v248,v249
v_max_f32 v248,0,v248
v_exp_f32 v249,-v248
v_sub_f32 v160,v160,v248
v_sub_f32 v161,v161,v248
v_sub_f32 v162,v162,v248
v_sub_f32 v163,v163,v248
v_sub_f32 v164,v164,v248
v_sub_f32 v165,v165,v248
v_sub_f32 v166,v166,v248
v_sub_f32 v167,v167,v248
v_sub_f32 v200,v200,v248
v_sub_f32 v201,v201,v248
v_sub_f32 v202,v202,v248
v_sub_f32 v203,v203,v248
v_exp_f32 v160,v160
v_exp_f32 v161,v161
v_exp_f32 v162,v162
v_exp_f32 v163,v163
v_exp_f32 v164,v164
v_exp_f32 v165,v165
v_exp_f32 v166,v166
v_exp_f32 v167,v167
v_mul_f32 v215,v215,v249
v_cvt_pk_bf16_f32 v180,v160,v161
v_cvt_pk_bf16_f32 v181,v162,v163
v_cvt_pk_bf16_f32 v182,v164,v165
v_cvt_pk_bf16_f32 v183,v166,v167
v_mul_f32 v96,v96,v249
v_mul_f32 v97,v97,v249
v_mul_f32 v98,v98,v249
v_mul_f32 v99,v99,v249
v_mul_f32 v100,v100,v249
v_mul_f32 v101,v101,v249
v_mul_f32 v102,v102,v249
v_mul_f32 v103,v103,v249
v_mul_f32 v104,v104,v249
v_mul_f32 v105,v105,v249
v_mul_f32 v106,v106,v249
v_mul_f32 v107,v107,v249
v_mul_f32 v108,v108,v249
v_mul_f32 v109,v109,v249
v_mul_f32 v110,v110,v249
v_mul_f32 v111,v111,v249
v_mul_f32 v112,v112,v249
v_mul_f32 v113,v113,v249
v_mul_f32 v114,v114,v249
v_mul_f32 v115,v115,v249
v_mul_f32 v116,v116,v249
v_mul_f32 v117,v117,v249
v_mul_f32 v118,v118,v249
v_mul_f32 v119,v119,v249
v_mul_f32 v120,v120,v249
v_mul_f32 v121,v121,v249
v_mul_f32 v122,v122,v249
v_mul_f32 v123,v123,v249
v_mul_f32 v124,v124,v249
v_mul_f32 v125,v125,v249
v_mul_f32 v126,v126,v249
v_mul_f32 v127,v127,v249
v_mfma_f32_16x16x32_bf16 v[208:211],a[188:191],v[180:183],v[212:215]
s_nop 7
s_branch S_back_z_2
S_rare_z_3:
s_nop 7
v_max3_f32 v248,v128,v129,v130
v_max3_f32 v249,v131,v132,v133
v_max3_f32 v248,v248,v134,v135
v_max_f32 v248,v248,v249
v_mov_b32 v249,v248
s_nop 1
v_permlane32_swap_b32 v248,v249
v_max_f32 v248,v248,v249
v_mov_b32 v249,v248
s_nop 1
v_permlane16_swap_b32 v248,v249
v_max_f32 v248,v248,v249
v_max_f32 v248,0,v248
v_exp_f32 v249,-v248
v_sub_f32 v128,v128,v248
v_sub_f32 v129,v129,v248
v_sub_f32 v130,v130,v248
v_sub_f32 v131,v131,v248
v_sub_f32 v132,v132,v248
v_sub_f32 v133,v133,v248
v_sub_f32 v134,v134,v248
v_sub_f32 v135,v135,v248
v_sub_f32 v188,v188,v248
v_sub_f32 v189,v189,v248
v_sub_f32 v190,v190,v248
v_sub_f32 v191,v191,v248
v_exp_f32 v128,v128
v_exp_f32 v129,v129
v_exp_f32 v130,v130
v_exp_f32 v131,v131
v_exp_f32 v132,v132
v_exp_f32 v133,v133
v_exp_f32 v134,v134
v_exp_f32 v135,v135
v_mul_f32 v208,v208,v249
v_cvt_pk_bf16_f32 v168,v128,v129
v_cvt_pk_bf16_f32 v169,v130,v131
v_cvt_pk_bf16_f32 v170,v132,v133
v_cvt_pk_bf16_f32 v171,v134,v135
v_mul_f32 v0,v0,v249
v_mul_f32 v1,v1,v249
v_mul_f32 v2,v2,v249
v_mul_f32 v3,v3,v249
v_mul_f32 v4,v4,v249
v_mul_f32 v5,v5,v249
v_mul_f32 v6,v6,v249
v_mul_f32 v7,v7,v249
v_mul_f32 v8,v8,v249
v_mul_f32 v9,v9,v249
v_mul_f32 v10,v10,v249
v_mul_f32 v11,v11,v249
v_mul_f32 v12,v12,v249
v_mul_f32 v13,v13,v249
v_mul_f32 v14,v14,v249
v_mul_f32 v15,v15,v249
v_mul_f32 v16,v16,v249
v_mul_f32 v17,v17,v249
v_mul_f32 v18,v18,v249
v_mul_f32 v19,v19,v249
v_mul_f32 v20,v20,v249
v_mul_f32 v21,v21,v249
v_mul_f32 v22,v22,v249
v_mul_f32 v23,v23,v249
v_mul_f32 v24,v24,v249
v_mul_f32 v25,v25,v249
v_mul_f32 v26,v26,v249
v_mul_f32 v27,v27,v249
v_mul_f32 v28,v28,v249
v_mul_f32 v29,v29,v249
v_mul_f32 v30,v30,v249
v_mul_f32 v31,v31,v249
v_mfma_f32_16x16x32_bf16 v[212:215],a[176:179],v[168:171],v[208:211]
s_nop 7
s_branch S_back_z_3
S_rare_z_4:
s_nop 7
v_max3_f32 v248,v144,v145,v146
v_max3_f32 v249,v147,v148,v149
v_max3_f32 v248,v248,v150,v151
v_max_f32 v248,v248,v249
v_mov_b32 v249,v248
s_nop 1
v_permlane32_swap_b32 v248,v249
v_max_f32 v248,v248,v249
v_mov_b32 v249,v248
s_nop 1
v_permlane16_swap_b32 v248,v249
v_max_f32 v248,v248,v249
v_max_f32 v248,0,v248
v_exp_f32 v249,-v248
v_sub_f32 v144,v144,v248
v_sub_f32 v145,v145,v248
v_sub_f32 v146,v146,v248
v_sub_f32 v147,v147,v248
v_sub_f32 v148,v148,v248
v_sub_f32 v149,v149,v248
v_sub_f32 v150,v150,v248
v_sub_f32 v151,v151,v248
v_sub_f32 v192,v192,v248
v_sub_f32 v193,v193,v248
v_sub_f32 v194,v194,v248
v_sub_f32 v195,v195,v248
v_exp_f32 v144,v144
v_exp_f32 v145,v145
v_exp_f32 v146,v146
v_exp_f32 v147,v147
v_exp_f32 v148,v148
v_exp_f32 v149,v149
v_exp_f32 v150,v150
v_exp_f32 v151,v151
v_mul_f32 v213,v213,v249
v_cvt_pk_bf16_f32 v172,v144,v145
v_cvt_pk_bf16_f32 v173,v146,v147
v_cvt_pk_bf16_f32 v174,v148,v149
v_cvt_pk_bf16_f32 v175,v150,v151
v_mul_f32 v32,v32,v249
v_mul_f32 v33,v33,v249
v_mul_f32 v34,v34,v249
v_mul_f32 v35,v35,v249
v_mul_f32 v36,v36,v249
v_mul_f32 v37,v37,v249
v_mul_f32 v38,v38,v249
v_mul_f32 v39,v39,v249
v_mul_f32 v40,v40,v249
v_mul_f32 v41,v41,v249
v_mul_f32 v42,v42,v249
v_mul_f32 v43,v43,v249
v_mul_f32 v44,v44,v249
v_mul_f32 v45,v45,v249
v_mul_f32 v46,v46,v249
v_mul_f32 v47,v47,v249
v_mul_f32 v48,v48,v249
v_mul_f32 v49,v49,v249
v_mul_f32 v50,v50,v249
v_mul_f32 v51,v51,v249
v_mul_f32 v52,v52,v249
v_mul_f32 v53,v53,v249
v_mul_f32 v54,v54,v249
v_mul_f32 v55,v55,v249
v_mul_f32 v56,v56,v249
v_mul_f32 v57,v57,v249
v_mul_f32 v58,v58,v249
v_mul_f32 v59,v59,v249
v_mul_f32 v60,v60,v249
v_mul_f32 v61,v61,v249
v_mul_f32 v62,v62,v249
v_mul_f32 v63,v63,v249
v_mfma_f32_16x16x32_bf16 v[208:211],a[180:183],v[172:175],v[212:215]
s_nop 7
s_branch S_back_z_4
S_rare_z_5:
s_nop 7
v_max3_f32 v248,v152,v153,v154
v_max3_f32 v249,v155,v156,v157
v_max3_f32 v248,v248,v158,v159
v_max_f32 v248,v248,v249
v_mov_b32 v249,v248
s_nop 1
v_permlane32_swap_b32 v248,v249
v_max_f32 v248,v248,v249
v_mov_b32 v249,v248
s_nop 1
v_permlane16_swap_b32 v248,v249
v_max_f32 v248,v248,v249
v_max_f32 v248,0,v248
v_exp_f32 v249,-v248
v_sub_f32 v152,v152,v248
v_sub_f32 v153,v153,v248
v_sub_f32 v154,v154,v248
v_sub_f32 v155,v155,v248
v_sub_f32 v156,v156,v248
v_sub_f32 v157,v157,v248
v_sub_f32 v158,v158,v248
v_sub_f32 v159,v159,v248
v_sub_f32 v196,v196,v248
v_sub_f32 v197,v197,v248
v_sub_f32 v198,v198,v248
v_sub_f32 v199,v199,v248
v_exp_f32 v152,v152
v_exp_f32 v153,v153
v_exp_f32 v154,v154
v_exp_f32 v155,v155
v_exp_f32 v156,v156
v_exp_f32 v157,v157
v_exp_f32 v158,v158
v_exp_f32 v159,v159
v_mul_f32 v210,v210,v249
v_cvt_pk_bf16_f32 v176,v152,v153
v_cvt_pk_bf16_f32 v177,v154,v155
v_cvt_pk_bf16_f32 v178,v156,v157
v_cvt_pk_bf16_f32 v179,v158,v159
v_mul_f32 v64,v64,v249
v_mul_f32 v65,v65,v249
v_mul_f32 v66,v66,v249
v_mul_f32 v67,v67,v249
v_mul_f32 v68,v68,v249
v_mul_f32 v69,v69,v249
v_mul_f32 v70,v70,v249
v_mul_f32 v71,v71,v249
v_mul_f32 v72,v72,v249
v_mul_f32 v73,v73,v249
v_mul_f32 v74,v74,v249
v_mul_f32 v75,v75,v249
v_mul_f32 v76,v76,v249
v_mul_f32 v77,v77,v249
v_mul_f32 v78,v78,v249
v_mul_f32 v79,v79,v249
v_mul_f32 v80,v80,v249
v_mul_f32 v81,v81,v249
v_mul_f32 v82,v82,v249
v_mul_f32 v83,v83,v249
v_mul_f32 v84,v84,v249
v_mul_f32 v85,v85,v249
v_mul_f32 v86,v86,v249
v_mul_f32 v87,v87,v249
v_mul_f32 v88,v88,v249
v_mul_f32 v89,v89,v249
v_mul_f32 v90,v90,v249
v_mul_f32 v91,v91,v249
v_mul_f32 v92,v92,v249
v_mul_f32 v93,v93,v249
v_mul_f32 v94,v94,v249
v_mul_f32 v95,v95,v249
v_mfma_f32_16x16x32_bf16 v[212:215],a[184:187],v[176:179],v[208:211]
s_nop 7
s_branch S_back_z_5
S_rare_z_6:
s_nop 7
v_max3_f32 v248,v160,v161,v162
v_max3_f32 v249,v163,v164,v165
v_max3_f32 v248,v248,v166,v167
v_max_f32 v248,v248,v249
v_mov_b32 v249,v248
s_nop 1
v_permlane32_swap_b32 v248,v249
v_max_f32 v248,v248,v249
v_mov_b32 v249,v248
s_nop 1
v_permlane16_swap_b32 v248,v249
v_max_f32 v248,v248,v249
v_max_f32 v248,0,v248
v_exp_f32 v249,-v248
v_sub_f32 v160,v160,v248
v_sub_f32 v161,v161,v248
v_sub_f32 v162,v162,v248
v_sub_f32 v163,v163,v248
v_sub_f32 v164,v164,v248
v_sub_f32 v165,v165,v248
v_sub_f32 v166,v166,v248
v_sub_f32 v167,v167,v248
v_sub_f32 v200,v200,v248
v_sub_f32 v201,v201,v248
v_sub_f32 v202,v202,v248
v_sub_f32 v203,v203,v248
v_exp_f32 v160,v160
v_exp_f32 v161,v161
v_exp_f32 v162,v162
v_exp_f32 v163,v163
v_exp_f32 v164,v164
v_exp_f32 v165,v165
v_exp_f32 v166,v166
v_exp_f32 v167,v167
v_mul_f32 v215,v215,v249
v_cvt_pk_bf16_f32 v180,v160,v161
v_cvt_pk_bf16_f32 v181,v162,v163
v_cvt_pk_bf16_f32 v182,v164,v165
v_cvt_pk_bf16_f32 v183,v166,v167
v_mul_f32 v96,v96,v249
v_mul_f32 v97,v97,v249
v_mul_f32 v98,v98,v249
v_mul_f32 v99,v99,v249
v_mul_f32 v100,v100,v249
v_mul_f32 v101,v101,v249
v_mul_f32 v102,v102,v249
v_mul_f32 v103,v103,v249
v_mul_f32 v104,v104,v249
v_mul_f32 v105,v105,v249
v_mul_f32 v106,v106,v249
v_mul_f32 v107,v107,v249
v_mul_f32 v108,v108,v249
v_mul_f32 v109,v109,v249
v_mul_f32 v110,v110,v249
v_mul_f32 v111,v111,v249
v_mul_f32 v112,v112,v249
v_mul_f32 v113,v113,v249
v_mul_f32 v114,v114,v249
v_mul_f32 v115,v115,v249
v_mul_f32 v116,v116,v249
v_mul_f32 v117,v117,v249
v_mul_f32 v118,v118,v249
v_mul_f32 v119,v119,v249
v_mul_f32 v120,v120,v249
v_mul_f32 v121,v121,v249
v_mul_f32 v122,v122,v249
v_mul_f32 v123,v123,v249
v_mul_f32 v124,v124,v249
v_mul_f32 v125,v125,v249
v_mul_f32 v126,v126,v249
v_mul_f32 v127,v127,v249
v_mfma_f32_16x16x32_bf16 v[208:211],a[188:191],v[180:183],v[212:215]
s_nop 7
s_branch S_back_z_6
S_rare_z_7:
s_nop 7
v_max3_f32 v248,v136,v137,v138
v_max3_f32 v249,v139,v140,v141
v_max3_f32 v248,v248,v142,v143
v_max_f32 v248,v248,v249
v_mov_b32 v249,v248
s_nop 1
v_permlane32_swap_b32 v248,v249
v_max_f32 v248,v248,v249
v_mov_b32 v249,v248
s_nop 1
v_permlane16_swap_b32 v248,v249
v_max_f32 v248,v248,v249
v_max_f32 v248,0,v248
v_exp_f32 v249,-v248
v_sub_f32 v136,v136,v248
v_sub_f32 v137,v137,v248
v_sub_f32 v138,v138,v248
v_sub_f32 v139,v139,v248
v_sub_f32 v140,v140,v248
v_sub_f32 v141,v141,v248
v_sub_f32 v142,v142,v248
v_sub_f32 v143,v143,v248
v_sub_f32 v204,v204,v248
v_sub_f32 v205,v205,v248
v_sub_f32 v206,v206,v248
v_sub_f32 v207,v207,v248
v_exp_f32 v136,v136
v_exp_f32 v137,v137
v_exp_f32 v138,v138
v_exp_f32 v139,v139
v_exp_f32 v140,v140
v_exp_f32 v141,v141
v_exp_f32 v142,v142
v_exp_f32 v143,v143
v_mul_f32 v216,v216,v249
v_cvt_pk_bf16_f32 v184,v136,v137
v_cvt_pk_bf16_f32 v185,v138,v139
v_cvt_pk_bf16_f32 v186,v140,v141
v_cvt_pk_bf16_f32 v187,v142,v143
v_accvgpr_read_b32 v250,a0
v_accvgpr_read_b32 v251,a1
v_mul_f32 v250,v250,v249
v_mul_f32 v251,v251,v249
v_accvgpr_write_b32 a0,v250
v_accvgpr_write_b32 a1,v251
v_accvgpr_read_b32 v250,a2
v_accvgpr_read_b32 v251,a3
v_mul_f32 v250,v250,v249
v_mul_f32 v251,v251,v249
v_accvgpr_write_b32 a2,v250
v_accvgpr_write_b32 a3,v251
v_accvgpr_read_b32 v250,a4
v_accvgpr_read_b32 v251,a5
v_mul_f32 v250,v250,v249
v_mul_f32 v251,v251,v249
v_accvgpr_write_b32 a4,v250
v_accvgpr_write_b32 a5,v251
v_accvgpr_read_b32 v250,a6
v_accvgpr_read_b32 v251,a7
v_mul_f32 v250,v250,v249
v_mul_f32 v251,v251,v249
v_accvgpr_write_b32 a6,v250
v_accvgpr_write_b32 a7,v251
v_accvgpr_read_b32 v250,a8
v_accvgpr_read_b32 v251,a9
v_mul_f32 v250,v250,v249
v_mul_f32 v251,v251,v249
v_accvgpr_write_b32 a8,v250
v_accvgpr_write_b32 a9,v251
v_accvgpr_read_b32 v250,a10
v_accvgpr_read_b32 v251,a11
v_mul_f32 v250,v250,v249
v_mul_f32 v251,v251,v249
v_accvgpr_write_b32 a10,v250
v_accvgpr_write_b32 a11,v251
v_accvgpr_read_b32 v250,a12
v_accvgpr_read_b32 v251,a13
v_mul_f32 v250,v250,v249
v_mul_f32 v251,v251,v249
v_accvgpr_write_b32 a12,v250
v_accvgpr_write_b32 a13,v251
v_accvgpr_read_b32 v250,a14
v_accvgpr_read_b32 v251,a15
v_mul_f32 v250,v250,v249
v_mul_f32 v251,v251,v249
v_accvgpr_write_b32 a14,v250
v_accvgpr_write_b32 a15,v251
v_accvgpr_read_b32 v250,a16
v_accvgpr_read_b32 v251,a17
v_mul_f32 v250,v250,v249
v_mul_f32 v251,v251,v249
v_accvgpr_write_b32 a16,v250
v_accvgpr_write_b32 a17,v251
v_accvgpr_read_b32 v250,a18
v_accvgpr_read_b32 v251,a19
v_mul_f32 v250,v250,v249
v_mul_f32 v251,v251,v249
v_accvgpr_write_b32 a18,v250
v_accvgpr_write_b32 a19,v251
v_accvgpr_read_b32 v250,a20
v_accvgpr_read_b32 v251,a21
v_mul_f32 v250,v250,v249
v_mul_f32 v251,v251,v249
v_accvgpr_write_b32 a20,v250
v_accvgpr_write_b32 a21,v251
v_accvgpr_read_b32 v250,a22
v_accvgpr_read_b32 v251,a23
v_mul_f32 v250,v250,v249
v_mul_f32 v251,v251,v249
v_accvgpr_write_b32 a22,v250
v_accvgpr_write_b32 a23,v251
v_accvgpr_read_b32 v250,a24
v_accvgpr_read_b32 v251,a25
v_mul_f32 v250,v250,v249
v_mul_f32 v251,v251,v249
v_accvgpr_write_b32 a24,v250
v_accvgpr_write_b32 a25,v251
v_accvgpr_read_b32 v250,a26
v_accvgpr_read_b32 v251,a27
v_mul_f32 v250,v250,v249
v_mul_f32 v251,v251,v249
v_accvgpr_write_b32 a26,v250
v_accvgpr_write_b32 a27,v251
v_accvgpr_read_b32 v250,a28
v_accvgpr_read_b32 v251,a29
v_mul_f32 v250,v250,v249
v_mul_f32 v251,v251,v249
v_accvgpr_write_b32 a28,v250
v_accvgpr_write_b32 a29,v251
v_accvgpr_read_b32 v250,a30
v_accvgpr_read_b32 v251,a31
v_mul_f32 v250,v250,v249
v_mul_f32 v251,v251,v249
v_accvgpr_write_b32 a30,v250
v_accvgpr_write_b32 a31,v251
v_mfma_f32_16x16x32_bf16 v[220:223],a[176:179],v[184:187],v[216:219]
s_nop 7
s_branch S_back_z_7
S_rare_z_8:
s_nop 7
v_max3_f32 v248,v128,v129,v130
v_max3_f32 v249,v131,v132,v133
v_max3_f32 v248,v248,v134,v135
v_max_f32 v248,v248,v249
v_mov_b32 v249,v248
s_nop 1
v_permlane32_swap_b32 v248,v249
v_max_f32 v248,v248,v249
v_mov_b32 v249,v248
s_nop 1
v_permlane16_swap_b32 v248,v249
v_max_f32 v248,v248,v249
v_max_f32 v248,0,v248
v_exp_f32 v249,-v248
v_sub_f32 v128,v128,v248
v_sub_f32 v129,v129,v248
v_sub_f32 v130,v130,v248
v_sub_f32 v131,v131,v248
v_sub_f32 v132,v132,v248
v_sub_f32 v133,v133,v248
v_sub_f32 v134,v134,v248
v_sub_f32 v135,v135,v248
v_sub_f32 v188,v188,v248
v_sub_f32 v189,v189,v248
v_sub_f32 v190,v190,v248
v_sub_f32 v191,v191,v248
v_exp_f32 v128,v128
v_exp_f32 v129,v129
v_exp_f32 v130,v130
v_exp_f32 v131,v131
v_exp_f32 v132,v132
v_exp_f32 v133,v133
v_exp_f32 v134,v134
v_exp_f32 v135,v135
v_mul_f32 v208,v208,v249
v_cvt_pk_bf16_f32 v168,v128,v129
v_cvt_pk_bf16_f32 v169,v130,v131
v_cvt_pk_bf16_f32 v170,v132,v133
v_cvt_pk_bf16_f32 v171,v134,v135
v_mul_f32 v0,v0,v249
v_mul_f32 v1,v1,v249
v_mul_f32 v2,v2,v249
v_mul_f32 v3,v3,v249
v_mul_f32 v4,v4,v249
v_mul_f32 v5,v5,v249
v_mul_f32 v6,v6,v249
v_mul_f32 v7,v7,v249
v_mul_f32 v8,v8,v249
v_mul_f32 v9,v9,v249
v_mul_f32 v10,v10,v249
v_mul_f32 v11,v11,v249
v_mul_f32 v12,v12,v249
v_mul_f32 v13,v13,v249
v_mul_f32 v14,v14,v249
v_mul_f32 v15,v15,v249
v_mul_f32 v16,v16,v249
v_mul_f32 v17,v17,v249
v_mul_f32 v18,v18,v249
v_mul_f32 v19,v19,v249
v_mul_f32 v20,v20,v249
v_mul_f32 v21,v21,v249
v_mul_f32 v22,v22,v249
v_mul_f32 v23,v23,v249
v_mul_f32 v24,v24,v249
v_mul_f32 v25,v25,v249
v_mul_f32 v26,v26,v249
v_mul_f32 v27,v27,v249
v_mul_f32 v28,v28,v249
v_mul_f32 v29,v29,v249
v_mul_f32 v30,v30,v249
v_mul_f32 v31,v31,v249
v_mfma_f32_16x16x32_bf16 v[212:215],a[176:179],v[168:171],v[208:211]
s_nop 7
s_branch S_back_z_8
S_rare_z_9:
s_nop 7
v_max3_f32 v248,v144,v145,v146
v_max3_f32 v249,v147,v148,v149
v_max3_f32 v248,v248,v150,v151
v_max_f32 v248,v248,v249
v_mov_b32 v249,v248
s_nop 1
v_permlane32_swap_b32 v248,v249
v_max_f32 v248,v248,v249
v_mov_b32 v249,v248
s_nop 1
v_permlane16_swap_b32 v248,v249
v_max_f32 v248,v248,v249
v_max_f32 v248,0,v248
v_exp_f32 v249,-v248
v_sub_f32 v144,v144,v248
v_sub_f32 v145,v145,v248
v_sub_f32 v146,v146,v248
v_sub_f32 v147,v147,v248
v_sub_f32 v148,v148,v248
v_sub_f32 v149,v149,v248
v_sub_f32 v150,v150,v248
v_sub_f32 v151,v151,v248
v_sub_f32 v192,v192,v248
v_sub_f32 v193,v193,v248
v_sub_f32 v194,v194,v248
v_sub_f32 v195,v195,v248
v_exp_f32 v144,v144
v_exp_f32 v145,v145
v_exp_f32 v146,v146
v_exp_f32 v147,v147
v_exp_f32 v148,v148
v_exp_f32 v149,v149
v_exp_f32 v150,v150
v_exp_f32 v151,v151
v_mul_f32 v213,v213,v249
v_cvt_pk_bf16_f32 v172,v144,v145
v_cvt_pk_bf16_f32 v173,v146,v147
v_cvt_pk_bf16_f32 v174,v148,v149
v_cvt_pk_bf16_f32 v175,v150,v151
v_mul_f32 v32,v32,v249
v_mul_f32 v33,v33,v249
v_mul_f32 v34,v34,v249
v_mul_f32 v35,v35,v249
v_mul_f32 v36,v36,v249
v_mul_f32 v37,v37,v249
v_mul_f32 v38,v38,v249
v_mul_f32 v39,v39,v249
v_mul_f32 v40,v40,v249
v_mul_f32 v41,v41,v249
v_mul_f32 v42,v42,v249
v_mul_f32 v43,v43,v249
v_mul_f32 v44,v44,v249
v_mul_f32 v45,v45,v249
v_mul_f32 v46,v46,v249
v_mul_f32 v47,v47,v249
v_mul_f32 v48,v48,v249
v_mul_f32 v49,v49,v249
v_mul_f32 v50,v50,v249
v_mul_f32 v51,v51,v249
v_mul_f32 v52,v52,v249
v_mul_f32 v53,v53,v249
v_mul_f32 v54,v54,v249
v_mul_f32 v55,v55,v249
v_mul_f32 v56,v56,v249
v_mul_f32 v57,v57,v249
v_mul_f32 v58,v58,v249
v_mul_f32 v59,v59,v249
v_mul_f32 v60,v60,v249
v_mul_f32 v61,v61,v249
v_mul_f32 v62,v62,v249
v_mul_f32 v63,v63,v249
v_mfma_f32_16x16x32_bf16 v[208:211],a[180:183],v[172:175],v[212:215]
s_nop 7
s_branch S_back_z_9
S_rare_z_10:
s_nop 7
v_max3_f32 v248,v152,v153,v154
v_max3_f32 v249,v155,v156,v157
v_max3_f32 v248,v248,v158,v159
v_max_f32 v248,v248,v249
v_mov_b32 v249,v248
s_nop 1
v_permlane32_swap_b32 v248,v249
v_max_f32 v248,v248,v249
v_mov_b32 v249,v248
s_nop 1
v_permlane16_swap_b32 v248,v249
v_max_f32 v248,v248,v249
v_max_f32 v248,0,v248
v_exp_f32 v249,-v248
v_sub_f32 v152,v152,v248
v_sub_f32 v153,v153,v248
v_sub_f32 v154,v154,v248
v_sub_f32 v155,v155,v248
v_sub_f32 v156,v156,v248
v_sub_f32 v157,v157,v248
v_sub_f32 v158,v158,v248
v_sub_f32 v159,v159,v248
v_sub_f32 v196,v196,v248
v_sub_f32 v197,v197,v248
v_sub_f32 v198,v198,v248
v_sub_f32 v199,v199,v248
v_exp_f32 v152,v152
v_exp_f32 v153,v153
v_exp_f32 v154,v154
v_exp_f32 v155,v155
v_exp_f32 v156,v156
v_exp_f32 v157,v157
v_exp_f32 v158,v158
v_exp_f32 v159,v159
v_mul_f32 v210,v210,v249
v_cvt_pk_bf16_f32 v176,v152,v153
v_cvt_pk_bf16_f32 v177,v154,v155
v_cvt_pk_bf16_f32 v178,v156,v157
v_cvt_pk_bf16_f32 v179,v158,v159
v_mul_f32 v64,v64,v249
v_mul_f32 v65,v65,v249
v_mul_f32 v66,v66,v249
v_mul_f32 v67,v67,v249
v_mul_f32 v68,v68,v249
v_mul_f32 v69,v69,v249
v_mul_f32 v70,v70,v249
v_mul_f32 v71,v71,v249
v_mul_f32 v72,v72,v249
v_mul_f32 v73,v73,v249
v_mul_f32 v74,v74,v249
v_mul_f32 v75,v75,v249
v_mul_f32 v76,v76,v249
v_mul_f32 v77,v77,v249
v_mul_f32 v78,v78,v249
v_mul_f32 v79,v79,v249
v_mul_f32 v80,v80,v249
v_mul_f32 v81,v81,v249
v_mul_f32 v82,v82,v249
v_mul_f32 v83,v83,v249
v_mul_f32 v84,v84,v249
v_mul_f32 v85,v85,v249
v_mul_f32 v86,v86,v249
v_mul_f32 v87,v87,v249
v_mul_f32 v88,v88,v249
v_mul_f32 v89,v89,v249
v_mul_f32 v90,v90,v249
v_mul_f32 v91,v91,v249
v_mul_f32 v92,v92,v249
v_mul_f32 v93,v93,v249
v_mul_f32 v94,v94,v249
v_mul_f32 v95,v95,v249
v_mfma_f32_16x16x32_bf16 v[212:215],a[184:187],v[176:179],v[208:211]
s_nop 7
s_branch S_back_z_10
S_rare_z_11:
s_nop 7
v_max3_f32 v248,v160,v161,v162
v_max3_f32 v249,v163,v164,v165
v_max3_f32 v248,v248,v166,v167
v_max_f32 v248,v248,v249
v_mov_b32 v249,v248
s_nop 1
v_permlane32_swap_b32 v248,v249
v_max_f32 v248,v248,v249
v_mov_b32 v249,v248
s_nop 1
v_permlane16_swap_b32 v248,v249
v_max_f32 v248,v248,v249
v_max_f32 v248,0,v248
v_exp_f32 v249,-v248
v_sub_f32 v160,v160,v248
v_sub_f32 v161,v161,v248
v_sub_f32 v162,v162,v248
v_sub_f32 v163,v163,v248
v_sub_f32 v164,v164,v248
v_sub_f32 v165,v165,v248
v_sub_f32 v166,v166,v248
v_sub_f32 v167,v167,v248
v_sub_f32 v200,v200,v248
v_sub_f32 v201,v201,v248
v_sub_f32 v202,v202,v248
v_sub_f32 v203,v203,v248
v_exp_f32 v160,v160
v_exp_f32 v161,v161
v_exp_f32 v162,v162
v_exp_f32 v163,v163
v_exp_f32 v164,v164
v_exp_f32 v165,v165
v_exp_f32 v166,v166
v_exp_f32 v167,v167
v_mul_f32 v215,v215,v249
v_cvt_pk_bf16_f32 v180,v160,v161
v_cvt_pk_bf16_f32 v181,v162,v163
v_cvt_pk_bf16_f32 v182,v164,v165
v_cvt_pk_bf16_f32 v183,v166,v167
v_mul_f32 v96,v96,v249
v_mul_f32 v97,v97,v249
v_mul_f32 v98,v98,v249
v_mul_f32 v99,v99,v249
v_mul_f32 v100,v100,v249
v_mul_f32 v101,v101,v249
v_mul_f32 v102,v102,v249
v_mul_f32 v103,v103,v249
v_mul_f32 v104,v104,v249
v_mul_f32 v105,v105,v249
v_mul_f32 v106,v106,v249
v_mul_f32 v107,v107,v249
v_mul_f32 v108,v108,v249
v_mul_f32 v109,v109,v249
v_mul_f32 v110,v110,v249
v_mul_f32 v111,v111,v249
v_mul_f32 v112,v112,v249
v_mul_f32 v113,v113,v249
v_mul_f32 v114,v114,v249
v_mul_f32 v115,v115,v249
v_mul_f32 v116,v116,v249
v_mul_f32 v117,v117,v249
v_mul_f32 v118,v118,v249
v_mul_f32 v119,v119,v249
v_mul_f32 v120,v120,v249
v_mul_f32 v121,v121,v249
v_mul_f32 v122,v122,v249
v_mul_f32 v123,v123,v249
v_mul_f32 v124,v124,v249
v_mul_f32 v125,v125,v249
v_mul_f32 v126,v126,v249
v_mul_f32 v127,v127,v249
v_mfma_f32_16x16x32_bf16 v[208:211],a[188:191],v[180:183],v[212:215]
s_nop 7
s_branch S_back_z_11
S_rare_z_12:
s_nop 7
v_max3_f32 v248,v128,v129,v130
v_max3_f32 v249,v131,v132,v133
v_max3_f32 v248,v248,v134,v135
v_max_f32 v248,v248,v249
v_mov_b32 v249,v248
s_nop 1
v_permlane32_swap_b32 v248,v249
v_max_f32 v248,v248,v249
v_mov_b32 v249,v248
s_nop 1
v_permlane16_swap_b32 v248,v249
v_max_f32 v248,v248,v249
v_max_f32 v248,0,v248
v_exp_f32 v249,-v248
v_sub_f32 v128,v128,v248
v_sub_f32 v129,v129,v248
v_sub_f32 v130,v130,v248
v_sub_f32 v131,v131,v248
v_sub_f32 v132,v132,v248
v_sub_f32 v133,v133,v248
v_sub_f32 v134,v134,v248
v_sub_f32 v135,v135,v248
v_sub_f32 v188,v188,v248
v_sub_f32 v189,v189,v248
v_sub_f32 v190,v190,v248
v_sub_f32 v191,v191,v248
v_exp_f32 v128,v128
v_exp_f32 v129,v129
v_exp_f32 v130,v130
v_exp_f32 v131,v131
v_exp_f32 v132,v132
v_exp_f32 v133,v133
v_exp_f32 v134,v134
v_exp_f32 v135,v135
v_mul_f32 v208,v208,v249
v_cvt_pk_bf16_f32 v168,v128,v129
v_cvt_pk_bf16_f32 v169,v130,v131
v_cvt_pk_bf16_f32 v170,v132,v133
v_cvt_pk_bf16_f32 v171,v134,v135
v_mul_f32 v0,v0,v249
v_mul_f32 v1,v1,v249
v_mul_f32 v2,v2,v249
v_mul_f32 v3,v3,v249
v_mul_f32 v4,v4,v249
v_mul_f32 v5,v5,v249
v_mul_f32 v6,v6,v249
v_mul_f32 v7,v7,v249
v_mul_f32 v8,v8,v249
v_mul_f32 v9,v9,v249
v_mul_f32 v10,v10,v249
v_mul_f32 v11,v11,v249
v_mul_f32 v12,v12,v249
v_mul_f32 v13,v13,v249
v_mul_f32 v14,v14,v249
v_mul_f32 v15,v15,v249
v_mul_f32 v16,v16,v249
v_mul_f32 v17,v17,v249
v_mul_f32 v18,v18,v249
v_mul_f32 v19,v19,v249
v_mul_f32 v20,v20,v249
v_mul_f32 v21,v21,v249
v_mul_f32 v22,v22,v249
v_mul_f32 v23,v23,v249
v_mul_f32 v24,v24,v249
v_mul_f32 v25,v25,v249
v_mul_f32 v26,v26,v249
v_mul_f32 v27,v27,v249
v_mul_f32 v28,v28,v249
v_mul_f32 v29,v29,v249
v_mul_f32 v30,v30,v249
v_mul_f32 v31,v31,v249
v_mfma_f32_16x16x32_bf16 v[212:215],a[176:179],v[168:171],v[208:211]
s_nop 7
s_branch S_back_z_12
S_rare_z_13:
s_nop 7
v_max3_f32 v248,v144,v145,v146
v_max3_f32 v249,v147,v148,v149
v_max3_f32 v248,v248,v150,v151
v_max_f32 v248,v248,v249
v_mov_b32 v249,v248
s_nop 1
v_permlane32_swap_b32 v248,v249
v_max_f32 v248,v248,v249
v_mov_b32 v249,v248
s_nop 1
v_permlane16_swap_b32 v248,v249
v_max_f32 v248,v248,v249
v_max_f32 v248,0,v248
v_exp_f32 v249,-v248
v_sub_f32 v144,v144,v248
v_sub_f32 v145,v145,v248
v_sub_f32 v146,v146,v248
v_sub_f32 v147,v147,v248
v_sub_f32 v148,v148,v248
v_sub_f32 v149,v149,v248
v_sub_f32 v150,v150,v248
v_sub_f32 v151,v151,v248
v_sub_f32 v192,v192,v248
v_sub_f32 v193,v193,v248
v_sub_f32 v194,v194,v248
v_sub_f32 v195,v195,v248
v_exp_f32 v144,v144
v_exp_f32 v145,v145
v_exp_f32 v146,v146
v_exp_f32 v147,v147
v_exp_f32 v148,v148
v_exp_f32 v149,v149
v_exp_f32 v150,v150
v_exp_f32 v151,v151
v_mul_f32 v213,v213,v249
v_cvt_pk_bf16_f32 v172,v144,v145
v_cvt_pk_bf16_f32 v173,v146,v147
v_cvt_pk_bf16_f32 v174,v148,v149
v_cvt_pk_bf16_f32 v175,v150,v151
v_mul_f32 v32,v32,v249
v_mul_f32 v33,v33,v249
v_mul_f32 v34,v34,v249
v_mul_f32 v35,v35,v249
v_mul_f32 v36,v36,v249
v_mul_f32 v37,v37,v249
v_mul_f32 v38,v38,v249
v_mul_f32 v39,v39,v249
v_mul_f32 v40,v40,v249
v_mul_f32 v41,v41,v249
v_mul_f32 v42,v42,v249
v_mul_f32 v43,v43,v249
v_mul_f32 v44,v44,v249
v_mul_f32 v45,v45,v249
v_mul_f32 v46,v46,v249
v_mul_f32 v47,v47,v249
v_mul_f32 v48,v48,v249
v_mul_f32 v49,v49,v249
v_mul_f32 v50,v50,v249
v_mul_f32 v51,v51,v249
v_mul_f32 v52,v52,v249
v_mul_f32 v53,v53,v249
v_mul_f32 v54,v54,v249
v_mul_f32 v55,v55,v249
v_mul_f32 v56,v56,v249
v_mul_f32 v57,v57,v249
v_mul_f32 v58,v58,v249
v_mul_f32 v59,v59,v249
v_mul_f32 v60,v60,v249
v_mul_f32 v61,v61,v249
v_mul_f32 v62,v62,v249
v_mul_f32 v63,v63,v249
v_mfma_f32_16x16x32_bf16 v[208:211],a[180:183],v[172:175],v[212:215]
s_nop 7
s_branch S_back_z_13
S_rare_z_14:
s_nop 7
v_max3_f32 v248,v152,v153,v154
v_max3_f32 v249,v155,v156,v157
v_max3_f32 v248,v248,v158,v159
v_max_f32 v248,v248,v249
v_mov_b32 v249,v248
s_nop 1
v_permlane32_swap_b32 v248,v249
v_max_f32 v248,v248,v249
v_mov_b32 v249,v248
s_nop 1
v_permlane16_swap_b32 v248,v249
v_max_f32 v248,v248,v249
v_max_f32 v248,0,v248
v_exp_f32 v249,-v248
v_sub_f32 v152,v152,v248
v_sub_f32 v153,v153,v248
v_sub_f32 v154,v154,v248
v_sub_f32 v155,v155,v248
v_sub_f32 v156,v156,v248
v_sub_f32 v157,v157,v248
v_sub_f32 v158,v158,v248
v_sub_f32 v159,v159,v248
v_sub_f32 v196,v196,v248
v_sub_f32 v197,v197,v248
v_sub_f32 v198,v198,v248
v_sub_f32 v199,v199,v248
v_exp_f32 v152,v152
v_exp_f32 v153,v153
v_exp_f32 v154,v154
v_exp_f32 v155,v155
v_exp_f32 v156,v156
v_exp_f32 v157,v157
v_exp_f32 v158,v158
v_exp_f32 v159,v159
v_mul_f32 v210,v210,v249
v_cvt_pk_bf16_f32 v176,v152,v153
v_cvt_pk_bf16_f32 v177,v154,v155
v_cvt_pk_bf16_f32 v178,v156,v157
v_cvt_pk_bf16_f32 v179,v158,v159
v_mul_f32 v64,v64,v249
v_mul_f32 v65,v65,v249
v_mul_f32 v66,v66,v249
v_mul_f32 v67,v67,v249
v_mul_f32 v68,v68,v249
v_mul_f32 v69,v69,v249
v_mul_f32 v70,v70,v249
v_mul_f32 v71,v71,v249
v_mul_f32 v72,v72,v249
v_mul_f32 v73,v73,v249
v_mul_f32 v74,v74,v249
v_mul_f32 v75,v75,v249
v_mul_f32 v76,v76,v249
v_mul_f32 v77,v77,v249
v_mul_f32 v78,v78,v249
v_mul_f32 v79,v79,v249
v_mul_f32 v80,v80,v249
v_mul_f32 v81,v81,v249
v_mul_f32 v82,v82,v249
v_mul_f32 v83,v83,v249
v_mul_f32 v84,v84,v249
v_mul_f32 v85,v85,v249
v_mul_f32 v86,v86,v249
v_mul_f32 v87,v87,v249
v_mul_f32 v88,v88,v249
v_mul_f32 v89,v89,v249
v_mul_f32 v90,v90,v249
v_mul_f32 v91,v91,v249
v_mul_f32 v92,v92,v249
v_mul_f32 v93,v93,v249
v_mul_f32 v94,v94,v249
v_mul_f32 v95,v95,v249
v_mfma_f32_16x16x32_bf16 v[212:215],a[184:187],v[176:179],v[208:211]
s_nop 7
s_branch S_back_z_14
S_rare_z_15:
s_nop 7
v_max3_f32 v248,v160,v161,v162
v_max3_f32 v249,v163,v164,v165
v_max3_f32 v248,v248,v166,v167
v_max_f32 v248,v248,v249
v_mov_b32 v249,v248
s_nop 1
v_permlane32_swap_b32 v248,v249
v_max_f32 v248,v248,v249
v_mov_b32 v249,v248
s_nop 1
v_permlane16_swap_b32 v248,v249
v_max_f32 v248,v248,v249
v_max_f32 v248,0,v248
v_exp_f32 v249,-v248
v_sub_f32 v160,v160,v248
v_sub_f32 v161,v161,v248
v_sub_f32 v162,v162,v248
v_sub_f32 v163,v163,v248
v_sub_f32 v164,v164,v248
v_sub_f32 v165,v165,v248
v_sub_f32 v166,v166,v248
v_sub_f32 v167,v167,v248
v_sub_f32 v200,v200,v248
v_sub_f32 v201,v201,v248
v_sub_f32 v202,v202,v248
v_sub_f32 v203,v203,v248
v_exp_f32 v160,v160
v_exp_f32 v161,v161
v_exp_f32 v162,v162
v_exp_f32 v163,v163
v_exp_f32 v164,v164
v_exp_f32 v165,v165
v_exp_f32 v166,v166
v_exp_f32 v167,v167
v_mul_f32 v215,v215,v249
v_cvt_pk_bf16_f32 v180,v160,v161
v_cvt_pk_bf16_f32 v181,v162,v163
v_cvt_pk_bf16_f32 v182,v164,v165
v_cvt_pk_bf16_f32 v183,v166,v167
v_mul_f32 v96,v96,v249
v_mul_f32 v97,v97,v249
v_mul_f32 v98,v98,v249
v_mul_f32 v99,v99,v249
v_mul_f32 v100,v100,v249
v_mul_f32 v101,v101,v249
v_mul_f32 v102,v102,v249
v_mul_f32 v103,v103,v249
v_mul_f32 v104,v104,v249
v_mul_f32 v105,v105,v249
v_mul_f32 v106,v106,v249
v_mul_f32 v107,v107,v249
v_mul_f32 v108,v108,v249
v_mul_f32 v109,v109,v249
v_mul_f32 v110,v110,v249
v_mul_f32 v111,v111,v249
v_mul_f32 v112,v112,v249
v_mul_f32 v113,v113,v249
v_mul_f32 v114,v114,v249
v_mul_f32 v115,v115,v249
v_mul_f32 v116,v116,v249
v_mul_f32 v117,v117,v249
v_mul_f32 v118,v118,v249
v_mul_f32 v119,v119,v249
v_mul_f32 v120,v120,v249
v_mul_f32 v121,v121,v249
v_mul_f32 v122,v122,v249
v_mul_f32 v123,v123,v249
v_mul_f32 v124,v124,v249
v_mul_f32 v125,v125,v249
v_mul_f32 v126,v126,v249
v_mul_f32 v127,v127,v249
v_mfma_f32_16x16x32_bf16 v[208:211],a[188:191],v[180:183],v[212:215]
s_nop 7
s_branch S_back_z_15
S_rare_z_16:
s_nop 7
v_max3_f32 v248,v136,v137,v138
v_max3_f32 v249,v139,v140,v141
v_max3_f32 v248,v248,v142,v143
v_max_f32 v248,v248,v249
v_mov_b32 v249,v248
s_nop 1
v_permlane32_swap_b32 v248,v249
v_max_f32 v248,v248,v249
v_mov_b32 v249,v248
s_nop 1
v_permlane16_swap_b32 v248,v249
v_max_f32 v248,v248,v249
v_max_f32 v248,0,v248
v_exp_f32 v249,-v248
v_sub_f32 v136,v136,v248
v_sub_f32 v137,v137,v248
v_sub_f32 v138,v138,v248
v_sub_f32 v139,v139,v248
v_sub_f32 v140,v140,v248
v_sub_f32 v141,v141,v248
v_sub_f32 v142,v142,v248
v_sub_f32 v143,v143,v248
v_sub_f32 v204,v204,v248
v_sub_f32 v205,v205,v248
v_sub_f32 v206,v206,v248
v_sub_f32 v207,v207,v248
v_exp_f32 v136,v136
v_exp_f32 v137,v137
v_exp_f32 v138,v138
v_exp_f32 v139,v139
v_exp_f32 v140,v140
v_exp_f32 v141,v141
v_exp_f32 v142,v142
v_exp_f32 v143,v143
v_mul_f32 v220,v220,v249
v_cvt_pk_bf16_f32 v184,v136,v137
v_cvt_pk_bf16_f32 v185,v138,v139
v_cvt_pk_bf16_f32 v186,v140,v141
v_cvt_pk_bf16_f32 v187,v142,v143
v_accvgpr_read_b32 v250,a0
v_accvgpr_read_b32 v251,a1
v_mul_f32 v250,v250,v249
v_mul_f32 v251,v251,v249
v_accvgpr_write_b32 a0,v250
v_accvgpr_write_b32 a1,v251
v_accvgpr_read_b32 v250,a2
v_accvgpr_read_b32 v251,a3
v_mul_f32 v250,v250,v249
v_mul_f32 v251,v251,v249
v_accvgpr_write_b32 a2,v250
v_accvgpr_write_b32 a3,v251
v_accvgpr_read_b32 v250,a4
v_accvgpr_read_b32 v251,a5
v_mul_f32 v250,v250,v249
v_mul_f32 v251,v251,v249
v_accvgpr_write_b32 a4,v250
v_accvgpr_write_b32 a5,v251
v_accvgpr_read_b32 v250,a6
v_accvgpr_read_b32 v251,a7
v_mul_f32 v250,v250,v249
v_mul_f32 v251,v251,v249
v_accvgpr_write_b32 a6,v250
v_accvgpr_write_b32 a7,v251
v_accvgpr_read_b32 v250,a8
v_accvgpr_read_b32 v251,a9
v_mul_f32 v250,v250,v249
v_mul_f32 v251,v251,v249
v_accvgpr_write_b32 a8,v250
v_accvgpr_write_b32 a9,v251
v_accvgpr_read_b32 v250,a10
v_accvgpr_read_b32 v251,a11
v_mul_f32 v250,v250,v249
v_mul_f32 v251,v251,v249
v_accvgpr_write_b32 a10,v250
v_accvgpr_write_b32 a11,v251
v_accvgpr_read_b32 v250,a12
v_accvgpr_read_b32 v251,a13
v_mul_f32 v250,v250,v249
v_mul_f32 v251,v251,v249
v_accvgpr_write_b32 a12,v250
v_accvgpr_write_b32 a13,v251
v_accvgpr_read_b32 v250,a14
v_accvgpr_read_b32 v251,a15
v_mul_f32 v250,v250,v249
v_mul_f32 v251,v251,v249
v_accvgpr_write_b32 a14,v250
v_accvgpr_write_b32 a15,v251
v_accvgpr_read_b32 v250,a16
v_accvgpr_read_b32 v251,a17
v_mul_f32 v250,v250,v249
v_mul_f32 v251,v251,v249
v_accvgpr_write_b32 a16,v250
v_accvgpr_write_b32 a17,v251
v_accvgpr_read_b32 v250,a18
v_accvgpr_read_b32 v251,a19
v_mul_f32 v250,v250,v249
v_mul_f32 v251,v251,v249
v_accvgpr_write_b32 a18,v250
v_accvgpr_write_b32 a19,v251
v_accvgpr_read_b32 v250,a20
v_accvgpr_read_b32 v251,a21
v_mul_f32 v250,v250,v249
v_mul_f32 v251,v251,v249
v_accvgpr_write_b32 a20,v250
v_accvgpr_write_b32 a21,v251
v_accvgpr_read_b32 v250,a22
v_accvgpr_read_b32 v251,a23
v_mul_f32 v250,v250,v249
v_mul_f32 v251,v251,v249
v_accvgpr_write_b32 a22,v250
v_accvgpr_write_b32 a23,v251
v_accvgpr_read_b32 v250,a24
v_accvgpr_read_b32 v251,a25
v_mul_f32 v250,v250,v249
v_mul_f32 v251,v251,v249
v_accvgpr_write_b32 a24,v250
v_accvgpr_write_b32 a25,v251
v_accvgpr_read_b32 v250,a26
v_accvgpr_read_b32 v251,a27
v_mul_f32 v250,v250,v249
v_mul_f32 v251,v251,v249
v_accvgpr_write_b32 a26,v250
v_accvgpr_write_b32 a27,v251
v_accvgpr_read_b32 v250,a28
v_accvgpr_read_b32 v251,a29
v_mul_f32 v250,v250,v249
v_mul_f32 v251,v251,v249
v_accvgpr_write_b32 a28,v250
v_accvgpr_write_b32 a29,v251
v_accvgpr_read_b32 v250,a30
v_accvgpr_read_b32 v251,a31
v_mul_f32 v250,v250,v249
v_mul_f32 v251,v251,v249
v_accvgpr_write_b32 a30,v250
v_accvgpr_write_b32 a31,v251
v_mfma_f32_16x16x32_bf16 v[216:219],a[176:179],v[184:187],v[220:223]
s_nop 7
s_branch S_back_z_16
S_rare_z_17:
s_nop 7
v_max3_f32 v248,v128,v129,v130
v_max3_f32 v249,v131,v132,v133
v_max3_f32 v248,v248,v134,v135
v_max_f32 v248,v248,v249
v_mov_b32 v249,v248
s_nop 1
v_permlane32_swap_b32 v248,v249
v_max_f32 v248,v248,v249
v_mov_b32 v249,v248
s_nop 1
v_permlane16_swap_b32 v248,v249
v_max_f32 v248,v248,v249
v_max_f32 v248,0,v248
v_exp_f32 v249,-v248
v_sub_f32 v128,v128,v248
v_sub_f32 v129,v129,v248
v_sub_f32 v130,v130,v248
v_sub_f32 v131,v131,v248
v_sub_f32 v132,v132,v248
v_sub_f32 v133,v133,v248
v_sub_f32 v134,v134,v248
v_sub_f32 v135,v135,v248
v_sub_f32 v188,v188,v248
v_sub_f32 v189,v189,v248
v_sub_f32 v190,v190,v248
v_sub_f32 v191,v191,v248
v_exp_f32 v128,v128
v_exp_f32 v129,v129
v_exp_f32 v130,v130
v_exp_f32 v131,v131
v_exp_f32 v132,v132
v_exp_f32 v133,v133
v_exp_f32 v134,v134
v_exp_f32 v135,v135
v_mul_f32 v208,v208,v249
v_cvt_pk_bf16_f32 v168,v128,v129
v_cvt_pk_bf16_f32 v169,v130,v131
v_cvt_pk_bf16_f32 v170,v132,v133
v_cvt_pk_bf16_f32 v171,v134,v135
v_mul_f32 v0,v0,v249
v_mul_f32 v1,v1,v249
v_mul_f32 v2,v2,v249
v_mul_f32 v3,v3,v249
v_mul_f32 v4,v4,v249
v_mul_f32 v5,v5,v249
v_mul_f32 v6,v6,v249
v_mul_f32 v7,v7,v249
v_mul_f32 v8,v8,v249
v_mul_f32 v9,v9,v249
v_mul_f32 v10,v10,v249
v_mul_f32 v11,v11,v249
v_mul_f32 v12,v12,v249
v_mul_f32 v13,v13,v249
v_mul_f32 v14,v14,v249
v_mul_f32 v15,v15,v249
v_mul_f32 v16,v16,v249
v_mul_f32 v17,v17,v249
v_mul_f32 v18,v18,v249
v_mul_f32 v19,v19,v249
v_mul_f32 v20,v20,v249
v_mul_f32 v21,v21,v249
v_mul_f32 v22,v22,v249
v_mul_f32 v23,v23,v249
v_mul_f32 v24,v24,v249
v_mul_f32 v25,v25,v249
v_mul_f32 v26,v26,v249
v_mul_f32 v27,v27,v249
v_mul_f32 v28,v28,v249
v_mul_f32 v29,v29,v249
v_mul_f32 v30,v30,v249
v_mul_f32 v31,v31,v249
v_mfma_f32_16x16x32_bf16 v[212:215],a[176:179],v[168:171],v[208:211]
s_nop 7
s_branch S_back_z_17
S_rare_tail_15:
s_nop 7
v_max3_f32 v248,v144,v145,v146
v_max3_f32 v249,v147,v148,v149
v_max3_f32 v248,v248,v150,v151
v_max_f32 v248,v248,v249
v_mov_b32 v249,v248
s_nop 1
v_permlane32_swap_b32 v248,v249
v_max_f32 v248,v248,v249
v_mov_b32 v249,v248
s_nop 1
v_permlane16_swap_b32 v248,v249
v_max_f32 v248,v248,v249
v_max_f32 v248,0,v248
v_exp_f32 v249,-v248
v_sub_f32 v144,v144,v248
v_sub_f32 v145,v145,v248
v_sub_f32 v146,v146,v248
v_sub_f32 v147,v147,v248
v_sub_f32 v148,v148,v248
v_sub_f32 v149,v149,v248
v_sub_f32 v150,v150,v248
v_sub_f32 v151,v151,v248
v_sub_f32 v192,v192,v248
v_sub_f32 v193,v193,v248
v_sub_f32 v194,v194,v248
v_sub_f32 v195,v195,v248
v_exp_f32 v144,v144
v_exp_f32 v145,v145
v_exp_f32 v146,v146
v_exp_f32 v147,v147
v_exp_f32 v148,v148
v_exp_f32 v149,v149
v_exp_f32 v150,v150
v_exp_f32 v151,v151
v_mul_f32 v213,v213,v249
v_cvt_pk_bf16_f32 v172,v144,v145
v_cvt_pk_bf16_f32 v173,v146,v147
v_cvt_pk_bf16_f32 v174,v148,v149
v_cvt_pk_bf16_f32 v175,v150,v151
v_mul_f32 v32,v32,v249
v_mul_f32 v33,v33,v249
v_mul_f32 v34,v34,v249
v_mul_f32 v35,v35,v249
v_mul_f32 v36,v36,v249
v_mul_f32 v37,v37,v249
v_mul_f32 v38,v38,v249
v_mul_f32 v39,v39,v249
v_mul_f32 v40,v40,v249
v_mul_f32 v41,v41,v249
v_mul_f32 v42,v42,v249
v_mul_f32 v43,v43,v249
v_mul_f32 v44,v44,v249
v_mul_f32 v45,v45,v249
v_mul_f32 v46,v46,v249
v_mul_f32 v47,v47,v249
v_mul_f32 v48,v48,v249
v_mul_f32 v49,v49,v249
v_mul_f32 v50,v50,v249
v_mul_f32 v51,v51,v249
v_mul_f32 v52,v52,v249
v_mul_f32 v53,v53,v249
v_mul_f32 v54,v54,v249
v_mul_f32 v55,v55,v249
v_mul_f32 v56,v56,v249
v_mul_f32 v57,v57,v249
v_mul_f32 v58,v58,v249
v_mul_f32 v59,v59,v249
v_mul_f32 v60,v60,v249
v_mul_f32 v61,v61,v249
v_mul_f32 v62,v62,v249
v_mul_f32 v63,v63,v249
v_mfma_f32_16x16x32_bf16 v[208:211],a[180:183],v[172:175],v[212:215]
s_nop 7
s_branch S_back_tail_15
S_rare_tail_16:
s_nop 7
v_max3_f32 v248,v152,v153,v154
v_max3_f32 v249,v155,v156,v157
v_max3_f32 v248,v248,v158,v159
v_max_f32 v248,v248,v249
v_mov_b32 v249,v248
s_nop 1
v_permlane32_swap_b32 v248,v249
v_max_f32 v248,v248,v249
v_mov_b32 v249,v248
s_nop 1
v_permlane16_swap_b32 v248,v249
v_max_f32 v248,v248,v249
v_max_f32 v248,0,v248
v_exp_f32 v249,-v248
v_sub_f32 v152,v152,v248
v_sub_f32 v153,v153,v248
v_sub_f32 v154,v154,v248
v_sub_f32 v155,v155,v248
v_sub_f32 v156,v156,v248
v_sub_f32 v157,v157,v248
v_sub_f32 v158,v158,v248
v_sub_f32 v159,v159,v248
v_sub_f32 v196,v196,v248
v_sub_f32 v197,v197,v248
v_sub_f32 v198,v198,v248
v_sub_f32 v199,v199,v248
v_exp_f32 v152,v152
v_exp_f32 v153,v153
v_exp_f32 v154,v154
v_exp_f32 v155,v155
v_exp_f32 v156,v156
v_exp_f32 v157,v157
v_exp_f32 v158,v158
v_exp_f32 v159,v159
v_mul_f32 v210,v210,v249
v_cvt_pk_bf16_f32 v176,v152,v153
v_cvt_pk_bf16_f32 v177,v154,v155
v_cvt_pk_bf16_f32 v178,v156,v157
v_cvt_pk_bf16_f32 v179,v158,v159
v_mul_f32 v64,v64,v249
v_mul_f32 v65,v65,v249
v_mul_f32 v66,v66,v249
v_mul_f32 v67,v67,v249
v_mul_f32 v68,v68,v249
v_mul_f32 v69,v69,v249
v_mul_f32 v70,v70,v249
v_mul_f32 v71,v71,v249
v_mul_f32 v72,v72,v249
v_mul_f32 v73,v73,v249
v_mul_f32 v74,v74,v249
v_mul_f32 v75,v75,v249
v_mul_f32 v76,v76,v249
v_mul_f32 v77,v77,v249
v_mul_f32 v78,v78,v249
v_mul_f32 v79,v79,v249
v_mul_f32 v80,v80,v249
v_mul_f32 v81,v81,v249
v_mul_f32 v82,v82,v249
v_mul_f32 v83,v83,v249
v_mul_f32 v84,v84,v249
v_mul_f32 v85,v85,v249
v_mul_f32 v86,v86,v249
v_mul_f32 v87,v87,v249
v_mul_f32 v88,v88,v249
v_mul_f32 v89,v89,v249
v_mul_f32 v90,v90,v249
v_mul_f32 v91,v91,v249
v_mul_f32 v92,v92,v249
v_mul_f32 v93,v93,v249
v_mul_f32 v94,v94,v249
v_mul_f32 v95,v95,v249
v_mfma_f32_16x16x32_bf16 v[212:215],a[184:187],v[176:179],v[208:211]
s_nop 7
s_branch S_back_tail_16
S_rare_tail_17:
s_nop 7
v_max3_f32 v248,v160,v161,v162
v_max3_f32 v249,v163,v164,v165
v_max3_f32 v248,v248,v166,v167
v_max_f32 v248,v248,v249
v_mov_b32 v249,v248
s_nop 1
v_permlane32_swap_b32 v248,v249
v_max_f32 v248,v248,v249
v_mov_b32 v249,v248
s_nop 1
v_permlane16_swap_b32 v248,v249
v_max_f32 v248,v248,v249
v_max_f32 v248,0,v248
v_exp_f32 v249,-v248
v_sub_f32 v160,v160,v248
v_sub_f32 v161,v161,v248
v_sub_f32 v162,v162,v248
v_sub_f32 v163,v163,v248
v_sub_f32 v164,v164,v248
v_sub_f32 v165,v165,v248
v_sub_f32 v166,v166,v248
v_sub_f32 v167,v167,v248
v_sub_f32 v200,v200,v248
v_sub_f32 v201,v201,v248
v_sub_f32 v202,v202,v248
v_sub_f32 v203,v203,v248
v_exp_f32 v160,v160
v_exp_f32 v161,v161
v_exp_f32 v162,v162
v_exp_f32 v163,v163
v_exp_f32 v164,v164
v_exp_f32 v165,v165
v_exp_f32 v166,v166
v_exp_f32 v167,v167
v_mul_f32 v215,v215,v249
v_cvt_pk_bf16_f32 v180,v160,v161
v_cvt_pk_bf16_f32 v181,v162,v163
v_cvt_pk_bf16_f32 v182,v164,v165
v_cvt_pk_bf16_f32 v183,v166,v167
v_mul_f32 v96,v96,v249
v_mul_f32 v97,v97,v249
v_mul_f32 v98,v98,v249
v_mul_f32 v99,v99,v249
v_mul_f32 v100,v100,v249
v_mul_f32 v101,v101,v249
v_mul_f32 v102,v102,v249
v_mul_f32 v103,v103,v249
v_mul_f32 v104,v104,v249
v_mul_f32 v105,v105,v249
v_mul_f32 v106,v106,v249
v_mul_f32 v107,v107,v249
v_mul_f32 v108,v108,v249
v_mul_f32 v109,v109,v249
v_mul_f32 v110,v110,v249
v_mul_f32 v111,v111,v249
v_mul_f32 v112,v112,v249
v_mul_f32 v113,v113,v249
v_mul_f32 v114,v114,v249
v_mul_f32 v115,v115,v249
v_mul_f32 v116,v116,v249
v_mul_f32 v117,v117,v249
v_mul_f32 v118,v118,v249
v_mul_f32 v119,v119,v249
v_mul_f32 v120,v120,v249
v_mul_f32 v121,v121,v249
v_mul_f32 v122,v122,v249
v_mul_f32 v123,v123,v249
v_mul_f32 v124,v124,v249
v_mul_f32 v125,v125,v249
v_mul_f32 v126,v126,v249
v_mul_f32 v127,v127,v249
v_mfma_f32_16x16x32_bf16 v[208:211],a[188:191],v[180:183],v[212:215]
s_nop 7
s_branch S_back_tail_17

.section .rodata,"a"
.p2align 6
.amdhsa_kernel standalone__mha_softmax__near_ridge_kernel
  .amdhsa_next_free_vgpr 512
  .amdhsa_next_free_sgpr 102
  .amdhsa_accum_offset 256
  .amdhsa_group_segment_fixed_size 0
  .amdhsa_kernarg_size 48
  .amdhsa_user_sgpr_count 2
  .amdhsa_user_sgpr_kernarg_segment_ptr 1
  .amdhsa_system_sgpr_workgroup_id_x 1
.end_amdhsa_kernel
```
